```python
import torch

def _softmax(x, axis=-1):
    return torch.softmax(x, dim=axis)

def _gelu(x):
    return torch.nn.functional.gelu(x, approximate='tanh')

def _silu(x):
    return torch.nn.functional.silu(x)

def _sigmoid(x):
    return torch.sigmoid(x)

def _layernorm(x, axis=-1, eps=1e-05):
    m = x.mean(dim=axis, keepdim=True)
    v = x.var(dim=axis, keepdim=True, unbiased=False)
    return (x - m) / torch.sqrt(v + eps)

def _scatter_add(tgt, idx, src, axis=0):
    return tgt.clone().index_add_(axis, idx, src)

def _segment_sum(src, seg, n):
    out = torch.zeros((n,) + src.shape[1:], dtype=src.dtype)
    return out.index_add_(0, seg, src)

def _pad(x, pw):
    flat = tuple((v for pair in reversed(pw) for v in pair))
    return torch.nn.functional.pad(x, flat)
kernel_name = 'concat_heads__compressed_kv_cla__memory_aug_recurrent_mem_tr__prompt'

def setup_inputs():

    _w = lambda a: (lambda t: t.to(torch.bfloat16) if t.is_floating_point() else t)(torch.as_tensor(a))

    def _A_setup():
        B, H, Sq, Sk, D, M = (1, 32, 2048, 2048, 128, 576)
        Dc = 4 * D
        return {'x': _w((lambda *s: torch.randn(*s, dtype=torch.bfloat16) * 1.6)(B, Sq, M)), 'c_kv': _w((lambda *s: torch.randn(*s, dtype=torch.bfloat16) * 0.2)(B, Sk, Dc)), 'w_q': _w((lambda *s: torch.randn(*s, dtype=torch.bfloat16) * 3.2)(M, H, D) * M ** (-0.5)), 'w_uk': _w((lambda *s: torch.randn(*s, dtype=torch.bfloat16) * 3.2)(Dc, H, D) * Dc ** (-0.5)), 'w_uv': _w((lambda *s: torch.randn(*s, dtype=torch.bfloat16) * 0.2)(Dc, H, D) * Dc ** (-0.5)), 'w_o': _w((lambda *s: torch.randn(*s, dtype=torch.bfloat16) * 0.2)(H, D, M) * (H * D) ** (-0.5))}
    _A_in = _A_setup()

    def _B_setup():
        B, S, Dm = (1, 2048, 576)
        H, Dh = (32, 128)
        M, seg = (8, 32)
        seg = min(seg, S)
        S = S // seg * seg
        return {'x': _w((lambda *s: torch.randn(*s, dtype=torch.bfloat16) * 0.05)(B, S, Dm)), 'mem0': _w((lambda *s: torch.randn(*s, dtype=torch.bfloat16) * 0.4)(B, M, Dm)), 'Wq': _w((lambda *s: torch.randn(*s, dtype=torch.bfloat16) * 6.4)(Dm, H, Dh) * Dm ** (-0.5)), 'Wk': _w((lambda *s: torch.randn(*s, dtype=torch.bfloat16) * 6.4)(Dm, H, Dh) * Dm ** (-0.5)), 'Wv': _w((lambda *s: torch.randn(*s, dtype=torch.bfloat16) * 0.4)(Dm, H, Dh) * Dm ** (-0.5)), 'Wo': _w((lambda *s: torch.randn(*s, dtype=torch.bfloat16) * 0.4)(H, Dh, Dm) * (H * Dh) ** (-0.5)), 'seg_len': seg}
    _B_in = _B_setup()
    return {'A_x': _A_in['x'], 'A_c_kv': _A_in['c_kv'], 'A_w_q': _A_in['w_q'], 'A_w_uk': _A_in['w_uk'], 'A_w_uv': _A_in['w_uv'], 'A_w_o': _A_in['w_o'], 'B_x': _B_in['x'], 'B_mem0': _B_in['mem0'], 'B_Wq': _B_in['Wq'], 'B_Wk': _B_in['Wk'], 'B_Wv': _B_in['Wv'], 'B_Wo': _B_in['Wo'], 'B_seg_len': _B_in['seg_len']}

def reference(A_x, A_c_kv, A_w_q, A_w_uk, A_w_uv, A_w_o, B_x, B_mem0, B_Wq, B_Wk, B_Wv, B_Wo, B_seg_len):

    def _A_ref(x, c_kv, w_q, w_uk, w_uv, w_o):
        B, Sq, M = (x.shape[0], x.shape[1], x.shape[2])
        Sk = c_kv.shape[1]
        H, D = (w_q.shape[1], w_q.shape[2])
        q = torch.einsum('bqm,mhd->bhqd', x, w_q)
        k = torch.einsum('bkc,chd->bhkd', c_kv, w_uk)
        v = torch.einsum('bkc,chd->bhkd', c_kv, w_uv)
        scores = torch.einsum('bhqd,bhkd->bhqk', q, k) * D ** (-0.5)
        off = Sk - Sq
        qi = torch.arange(Sq)[:, None]
        kj = torch.arange(Sk)[None, :]
        cmask = kj <= qi + off
        scores = torch.where(cmask[None, None], scores, -1000000000.0)
        p = _softmax(scores, axis=-1)
        ctx = torch.einsum('bhqk,bhkd->bhqd', p, v)
        return torch.einsum('bhqd,hdm->bqm', ctx, w_o)

    def _B_ref(x, mem0, Wq, Wk, Wv, Wo, seg_len):
        B, S, Dm = x.shape
        H, Dh = (Wq.shape[1], Wq.shape[2])
        M = mem0.shape[1]
        scale = Dh ** (-0.5)
        n_seg = S // seg_len
        L = M + seg_len
        idx = torch.arange(L)
        mask = (idx[:, None] < M) | (idx[:, None] >= idx[None, :])
        mem = mem0
        outs = []
        for s in range(n_seg):
            xs = x[:, s * seg_len:(s + 1) * seg_len, :].clone()
            h = torch.concatenate([mem, xs], axis=1)
            q = torch.einsum('btd,dhe->bhte', h, Wq)
            k = torch.einsum('btd,dhe->bhte', h, Wk)
            v = torch.einsum('btd,dhe->bhte', h, Wv)
            scores = torch.einsum('bhqe,bhke->bhqk', q, k) * scale
            scores = torch.where(mask[None, None], scores, -1000000000.0)
            p = _softmax(scores, axis=-1)
            o = torch.einsum('bhqk,bhke->bhqe', p, v)
            o = torch.einsum('bhte,hed->btd', o, Wo)
            mem = o[:, :M, :].clone()
            outs.append(o[:, M:, :])
        return torch.concatenate(outs, axis=1)
    a = _A_ref(A_x, A_c_kv, A_w_q, A_w_uk, A_w_uv, A_w_o)
    b = _B_ref(B_x, B_mem0, B_Wq, B_Wk, B_Wv, B_Wo, B_seg_len)
    return torch.concatenate([a, b], axis=-1)
```

```asm
; @launch grid=(256,1,1) block=(256,1,1) lds=163840
.amdgcn_target "amdgcn-amd-amdhsa--gfx950"
.text
.globl concat_heads__compressed_kv_cla__memory_aug_recurrent_mem_tr__prompt_kernel
.p2align 8
.type concat_heads__compressed_kv_cla__memory_aug_recurrent_mem_tr__prompt_kernel,@function
concat_heads__compressed_kv_cla__memory_aug_recurrent_mem_tr__prompt_kernel:
 s_cmp_ge_u32 s2, 256
 s_cbranch_scc1 Lend
 s_load_dwordx2 s[20:21], s[0:1], 120
 s_mov_b32 s22, 0x10000000
 s_mov_b32 s23, 0x20000
 s_load_dwordx2 s[28:29], s[0:1], 112
 s_mov_b32 s30, 0x100
 s_mov_b32 s31, 0x20000
 v_lshrrev_b32 v1, 6, v0
 s_and_b32 s5, s2, 7
 s_lshr_b32 s6, s2, 3
 v_readfirstlane_b32 s4, v1
 s_waitcnt lgkmcnt(0)
 s_cmp_eq_u32 s5, 0
 s_cbranch_scc1 Lchain
 s_cmp_eq_u32 s5, 1
 s_cbranch_scc1 Lpb
 s_cmp_lt_u32 s5, 4
 s_cbranch_scc1 Lqa
 s_load_dwordx2 s[8:9], s[0:1], 8
 s_mov_b32 s10, 0x200000
 s_mov_b32 s11, 0x20000
 s_load_dwordx2 s[12:13], s[0:1], 24
 s_mov_b32 s14, 0x400000
 s_mov_b32 s15, 0x20000
 s_load_dwordx2 s[16:17], s[0:1], 32
 s_mov_b32 s18, 0x400000
 s_mov_b32 s19, 0x20000
 s_sub_u32 s3, s5, 4
 s_lshl_b32 s3, s3, 3
 s_lshr_b32 s7, s6, 2
 s_add_u32 s3, s3, s7
 s_lshl_b32 s32, s3, 8
 s_mov_b32 s33, s32
 s_lshl_b32 s34, s3, 14
 s_add_u32 s34, s34, 0x1000000
 s_add_u32 s35, s34, 8192
 s_mov_b32 s36, 16
 s_and_b32 s37, s6, 3
 s_lshl_b32 s7, s3, 5
 s_add_u32 s7, s7, s37
 s_lshl_b32 s7, s7, 2
 s_add_u32 s7, s7, 0x2000
 v_min_u32 v1, 1, v0
 v_lshlrev_b32 v1, 28, v1
 v_add_u32 v13, s7, v1
 s_waitcnt lgkmcnt(0)
 v_and_b32 v1, 63, v0
 v_lshrrev_b32 v2, 3, v0
 v_mul_u32_u24 v10, 1024, v2
 v_lshrrev_b32 v2, 4, v0
 v_xor_b32 v2, v2, v0
 v_and_b32 v2, 7, v2
 v_lshl_add_u32 v10, v2, 4, v10
 v_lshrrev_b32 v2, 4, v1
 v_bfe_u32 v3, v1, 1, 3
 v_xor_b32 v2, v2, v3
 v_and_b32 v3, 15, v1
 v_lshlrev_b32 v3, 7, v3
 v_lshl_add_u32 v4, v2, 4, v3
 v_xor_b32 v5, 64, v4
 v_lshrrev_b32 v2, 4, v0
 v_lshlrev_b32 v11, 13, v2
 v_lshrrev_b32 v2, 7, v0
 v_lshrrev_b32 v3, 4, v1
 v_lshl_add_u32 v3, v2, 2, v3
 v_bfe_u32 v2, v1, 1, 3
 v_xor_b32 v2, v2, v3
 v_lshl_add_u32 v11, v2, 5, v11
 v_and_b32 v2, 1, v1
 v_lshl_add_u32 v11, v2, 4, v11
 v_bfe_u32 v2, v1, 2, 3
 v_xor_b32 v3, s4, v2
 v_lshlrev_b32 v3, 5, v3
 v_and_b32 v2, 3, v2
 v_lshl_add_u32 v3, v2, 8, v3
 v_lshrrev_b32 v2, 4, v1
 v_lshl_add_u32 v3, v2, 11, v3
 v_and_b32 v2, 3, v1
 v_lshl_add_u32 v3, v2, 3, v3
 v_add_u32 v8, 65536, v3
 v_xor_b32 v3, 0x80, v3
 v_add_u32 v9, 65536, v3
 s_lshl_b32 s45, s4, 11
 v_lshl_add_u32 v12, v1, 4, s45
 s_mov_b32 s39, s37
 s_add_u32 s40, s39, 4
 s_lshl_b32 s49, s4, 10
 s_mul_i32 s46, s39, 32768
 s_add_u32 m0, s49, 0
 s_nop 0
 buffer_load_dwordx4 v10, s[8:11], s46 offen offset:0  lds
 s_add_u32 m0, s49, 3968
 s_nop 0
 buffer_load_dwordx4 v10, s[8:11], s46 offen offset:128  lds
 s_add_u32 m0, s49, 7936
 s_nop 0
 buffer_load_dwordx4 v10, s[8:11], s46 offen offset:256  lds
 s_add_u32 m0, s49, 11904
 s_nop 0
 buffer_load_dwordx4 v10, s[8:11], s46 offen offset:384  lds
 s_add_u32 m0, s49, 15872
 s_nop 0
 buffer_load_dwordx4 v10, s[8:11], s46 offen offset:512  lds
 s_add_u32 m0, s49, 19840
 s_nop 0
 buffer_load_dwordx4 v10, s[8:11], s46 offen offset:640  lds
 s_add_u32 m0, s49, 23808
 s_nop 0
 buffer_load_dwordx4 v10, s[8:11], s46 offen offset:768  lds
 s_add_u32 m0, s49, 27776
 s_nop 0
 buffer_load_dwordx4 v10, s[8:11], s46 offen offset:896  lds
 s_lshl_b32 s49, s4, 10
 s_add_u32 s49, s49, 32768
 s_mul_i32 s46, s40, 32768
 s_add_u32 m0, s49, 0
 s_nop 0
 buffer_load_dwordx4 v10, s[8:11], s46 offen offset:0  lds
 s_add_u32 m0, s49, 3968
 s_nop 0
 buffer_load_dwordx4 v10, s[8:11], s46 offen offset:128  lds
 s_add_u32 m0, s49, 7936
 s_nop 0
 buffer_load_dwordx4 v10, s[8:11], s46 offen offset:256  lds
 s_add_u32 m0, s49, 11904
 s_nop 0
 buffer_load_dwordx4 v10, s[8:11], s46 offen offset:384  lds
 s_add_u32 m0, s49, 15872
 s_nop 0
 buffer_load_dwordx4 v10, s[8:11], s46 offen offset:512  lds
 s_add_u32 m0, s49, 19840
 s_nop 0
 buffer_load_dwordx4 v10, s[8:11], s46 offen offset:640  lds
 s_add_u32 m0, s49, 23808
 s_nop 0
 buffer_load_dwordx4 v10, s[8:11], s46 offen offset:768  lds
 s_add_u32 m0, s49, 27776
 s_nop 0
 buffer_load_dwordx4 v10, s[8:11], s46 offen offset:896  lds
 s_lshl_b32 s49, s4, 10
 s_add_u32 m0, s49, 65536
 s_add_u32 s45, s32, 0
 buffer_load_dwordx4 v11, s[12:15], s45 offen nt lds
 s_add_u32 m0, s49, 69632
 s_add_u32 s45, s32, 131072
 buffer_load_dwordx4 v11, s[12:15], s45 offen nt lds
 s_add_u32 m0, s49, 73728
 s_add_u32 s45, s33, 0
 buffer_load_dwordx4 v11, s[16:19], s45 offen nt lds
 s_add_u32 m0, s49, 77824
 s_add_u32 s45, s33, 131072
 buffer_load_dwordx4 v11, s[16:19], s45 offen nt lds
 s_add_u32 m0, s49, 81920
 s_add_u32 s45, s32, 262144
 buffer_load_dwordx4 v11, s[12:15], s45 offen nt lds
 s_add_u32 m0, s49, 86016
 s_add_u32 s45, s32, 393216
 buffer_load_dwordx4 v11, s[12:15], s45 offen nt lds
 s_add_u32 m0, s49, 90112
 s_add_u32 s45, s33, 262144
 buffer_load_dwordx4 v11, s[16:19], s45 offen nt lds
 s_add_u32 m0, s49, 94208
 s_add_u32 s45, s33, 393216
 buffer_load_dwordx4 v11, s[16:19], s45 offen nt lds
 s_add_u32 m0, s49, 98304
 s_add_u32 s45, s32, 524288
 buffer_load_dwordx4 v11, s[12:15], s45 offen nt lds
 s_add_u32 m0, s49, 102400
 s_add_u32 s45, s32, 655360
 buffer_load_dwordx4 v11, s[12:15], s45 offen nt lds
 s_add_u32 m0, s49, 106496
 s_add_u32 s45, s33, 524288
 buffer_load_dwordx4 v11, s[16:19], s45 offen nt lds
 s_add_u32 m0, s49, 110592
 s_add_u32 s45, s33, 655360
 buffer_load_dwordx4 v11, s[16:19], s45 offen nt lds
 s_waitcnt vmcnt(8) lgkmcnt(0)
 s_barrier
 s_add_u32 m0, s49, 114688
 s_add_u32 s45, s32, 786432
 buffer_load_dwordx4 v11, s[12:15], s45 offen nt lds
 s_add_u32 m0, s49, 118784
 s_add_u32 s45, s32, 917504
 buffer_load_dwordx4 v11, s[12:15], s45 offen nt lds
 s_add_u32 m0, s49, 122880
 s_add_u32 s45, s33, 786432
 buffer_load_dwordx4 v11, s[16:19], s45 offen nt lds
 s_add_u32 m0, s49, 126976
 s_add_u32 s45, s33, 917504
 buffer_load_dwordx4 v11, s[16:19], s45 offen nt lds
 ds_read_b64_tr_b16 a[0:1], v8 offset:0
 ds_read_b64_tr_b16 a[2:3], v8 offset:1024
 ds_read_b64_tr_b16 a[64:65], v9 offset:0
 ds_read_b64_tr_b16 a[66:67], v9 offset:1024
 ds_read_b64_tr_b16 a[128:129], v8 offset:8192
 ds_read_b64_tr_b16 a[130:131], v8 offset:9216
 ds_read_b64_tr_b16 a[192:193], v9 offset:8192
 ds_read_b64_tr_b16 a[194:195], v9 offset:9216
 s_waitcnt vmcnt(8) lgkmcnt(0)
 s_barrier
 s_add_u32 m0, s49, 65536
 s_add_u32 s45, s32, 1048576
 buffer_load_dwordx4 v11, s[12:15], s45 offen nt lds
 s_add_u32 m0, s49, 69632
 s_add_u32 s45, s32, 1179648
 buffer_load_dwordx4 v11, s[12:15], s45 offen nt lds
 s_add_u32 m0, s49, 73728
 s_add_u32 s45, s33, 1048576
 buffer_load_dwordx4 v11, s[16:19], s45 offen nt lds
 s_add_u32 m0, s49, 77824
 s_add_u32 s45, s33, 1179648
 buffer_load_dwordx4 v11, s[16:19], s45 offen nt lds
 ds_read_b64_tr_b16 a[4:5], v8 offset:16384
 ds_read_b64_tr_b16 a[6:7], v8 offset:17408
 ds_read_b64_tr_b16 a[68:69], v9 offset:16384
 ds_read_b64_tr_b16 a[70:71], v9 offset:17408
 ds_read_b64_tr_b16 a[132:133], v8 offset:24576
 ds_read_b64_tr_b16 a[134:135], v8 offset:25600
 ds_read_b64_tr_b16 a[196:197], v9 offset:24576
 ds_read_b64_tr_b16 a[198:199], v9 offset:25600
 s_waitcnt vmcnt(8) lgkmcnt(0)
 s_barrier
 s_add_u32 m0, s49, 81920
 s_add_u32 s45, s32, 1310720
 buffer_load_dwordx4 v11, s[12:15], s45 offen nt lds
 s_add_u32 m0, s49, 86016
 s_add_u32 s45, s32, 1441792
 buffer_load_dwordx4 v11, s[12:15], s45 offen nt lds
 s_add_u32 m0, s49, 90112
 s_add_u32 s45, s33, 1310720
 buffer_load_dwordx4 v11, s[16:19], s45 offen nt lds
 s_add_u32 m0, s49, 94208
 s_add_u32 s45, s33, 1441792
 buffer_load_dwordx4 v11, s[16:19], s45 offen nt lds
 ds_read_b64_tr_b16 a[8:9], v8 offset:32768
 ds_read_b64_tr_b16 a[10:11], v8 offset:33792
 ds_read_b64_tr_b16 a[72:73], v9 offset:32768
 ds_read_b64_tr_b16 a[74:75], v9 offset:33792
 ds_read_b64_tr_b16 a[136:137], v8 offset:40960
 ds_read_b64_tr_b16 a[138:139], v8 offset:41984
 ds_read_b64_tr_b16 a[200:201], v9 offset:40960
 ds_read_b64_tr_b16 a[202:203], v9 offset:41984
 s_waitcnt vmcnt(8) lgkmcnt(0)
 s_barrier
 s_add_u32 m0, s49, 98304
 s_add_u32 s45, s32, 1572864
 buffer_load_dwordx4 v11, s[12:15], s45 offen nt lds
 s_add_u32 m0, s49, 102400
 s_add_u32 s45, s32, 1703936
 buffer_load_dwordx4 v11, s[12:15], s45 offen nt lds
 s_add_u32 m0, s49, 106496
 s_add_u32 s45, s33, 1572864
 buffer_load_dwordx4 v11, s[16:19], s45 offen nt lds
 s_add_u32 m0, s49, 110592
 s_add_u32 s45, s33, 1703936
 buffer_load_dwordx4 v11, s[16:19], s45 offen nt lds
 ds_read_b64_tr_b16 a[12:13], v8 offset:49152
 ds_read_b64_tr_b16 a[14:15], v8 offset:50176
 ds_read_b64_tr_b16 a[76:77], v9 offset:49152
 ds_read_b64_tr_b16 a[78:79], v9 offset:50176
 ds_read_b64_tr_b16 a[140:141], v8 offset:57344
 ds_read_b64_tr_b16 a[142:143], v8 offset:58368
 ds_read_b64_tr_b16 a[204:205], v9 offset:57344
 ds_read_b64_tr_b16 a[206:207], v9 offset:58368
 s_waitcnt vmcnt(8) lgkmcnt(0)
 s_barrier
 s_add_u32 m0, s49, 114688
 s_add_u32 s45, s32, 1835008
 buffer_load_dwordx4 v11, s[12:15], s45 offen nt lds
 s_add_u32 m0, s49, 118784
 s_add_u32 s45, s32, 1966080
 buffer_load_dwordx4 v11, s[12:15], s45 offen nt lds
 s_add_u32 m0, s49, 122880
 s_add_u32 s45, s33, 1835008
 buffer_load_dwordx4 v11, s[16:19], s45 offen nt lds
 s_add_u32 m0, s49, 126976
 s_add_u32 s45, s33, 1966080
 buffer_load_dwordx4 v11, s[16:19], s45 offen nt lds
 ds_read_b64_tr_b16 a[16:17], v8 offset:0
 ds_read_b64_tr_b16 a[18:19], v8 offset:1024
 ds_read_b64_tr_b16 a[80:81], v9 offset:0
 ds_read_b64_tr_b16 a[82:83], v9 offset:1024
 ds_read_b64_tr_b16 a[144:145], v8 offset:8192
 ds_read_b64_tr_b16 a[146:147], v8 offset:9216
 ds_read_b64_tr_b16 a[208:209], v9 offset:8192
 ds_read_b64_tr_b16 a[210:211], v9 offset:9216
 s_waitcnt vmcnt(8) lgkmcnt(0)
 s_barrier
 s_add_u32 m0, s49, 65536
 s_add_u32 s45, s32, 2097152
 buffer_load_dwordx4 v11, s[12:15], s45 offen nt lds
 s_add_u32 m0, s49, 69632
 s_add_u32 s45, s32, 2228224
 buffer_load_dwordx4 v11, s[12:15], s45 offen nt lds
 s_add_u32 m0, s49, 73728
 s_add_u32 s45, s33, 2097152
 buffer_load_dwordx4 v11, s[16:19], s45 offen nt lds
 s_add_u32 m0, s49, 77824
 s_add_u32 s45, s33, 2228224
 buffer_load_dwordx4 v11, s[16:19], s45 offen nt lds
 ds_read_b64_tr_b16 a[20:21], v8 offset:16384
 ds_read_b64_tr_b16 a[22:23], v8 offset:17408
 ds_read_b64_tr_b16 a[84:85], v9 offset:16384
 ds_read_b64_tr_b16 a[86:87], v9 offset:17408
 ds_read_b64_tr_b16 a[148:149], v8 offset:24576
 ds_read_b64_tr_b16 a[150:151], v8 offset:25600
 ds_read_b64_tr_b16 a[212:213], v9 offset:24576
 ds_read_b64_tr_b16 a[214:215], v9 offset:25600
 s_waitcnt vmcnt(8) lgkmcnt(0)
 s_barrier
 s_add_u32 m0, s49, 81920
 s_add_u32 s45, s32, 2359296
 buffer_load_dwordx4 v11, s[12:15], s45 offen nt lds
 s_add_u32 m0, s49, 86016
 s_add_u32 s45, s32, 2490368
 buffer_load_dwordx4 v11, s[12:15], s45 offen nt lds
 s_add_u32 m0, s49, 90112
 s_add_u32 s45, s33, 2359296
 buffer_load_dwordx4 v11, s[16:19], s45 offen nt lds
 s_add_u32 m0, s49, 94208
 s_add_u32 s45, s33, 2490368
 buffer_load_dwordx4 v11, s[16:19], s45 offen nt lds
 ds_read_b64_tr_b16 a[24:25], v8 offset:32768
 ds_read_b64_tr_b16 a[26:27], v8 offset:33792
 ds_read_b64_tr_b16 a[88:89], v9 offset:32768
 ds_read_b64_tr_b16 a[90:91], v9 offset:33792
 ds_read_b64_tr_b16 a[152:153], v8 offset:40960
 ds_read_b64_tr_b16 a[154:155], v8 offset:41984
 ds_read_b64_tr_b16 a[216:217], v9 offset:40960
 ds_read_b64_tr_b16 a[218:219], v9 offset:41984
 s_waitcnt vmcnt(8) lgkmcnt(0)
 s_barrier
 s_add_u32 m0, s49, 98304
 s_add_u32 s45, s32, 2621440
 buffer_load_dwordx4 v11, s[12:15], s45 offen nt lds
 s_add_u32 m0, s49, 102400
 s_add_u32 s45, s32, 2752512
 buffer_load_dwordx4 v11, s[12:15], s45 offen nt lds
 s_add_u32 m0, s49, 106496
 s_add_u32 s45, s33, 2621440
 buffer_load_dwordx4 v11, s[16:19], s45 offen nt lds
 s_add_u32 m0, s49, 110592
 s_add_u32 s45, s33, 2752512
 buffer_load_dwordx4 v11, s[16:19], s45 offen nt lds
 ds_read_b64_tr_b16 a[28:29], v8 offset:49152
 ds_read_b64_tr_b16 a[30:31], v8 offset:50176
 ds_read_b64_tr_b16 a[92:93], v9 offset:49152
 ds_read_b64_tr_b16 a[94:95], v9 offset:50176
 ds_read_b64_tr_b16 a[156:157], v8 offset:57344
 ds_read_b64_tr_b16 a[158:159], v8 offset:58368
 ds_read_b64_tr_b16 a[220:221], v9 offset:57344
 ds_read_b64_tr_b16 a[222:223], v9 offset:58368
 s_waitcnt vmcnt(8) lgkmcnt(0)
 s_barrier
 s_add_u32 m0, s49, 114688
 s_add_u32 s45, s32, 2883584
 buffer_load_dwordx4 v11, s[12:15], s45 offen nt lds
 s_add_u32 m0, s49, 118784
 s_add_u32 s45, s32, 3014656
 buffer_load_dwordx4 v11, s[12:15], s45 offen nt lds
 s_add_u32 m0, s49, 122880
 s_add_u32 s45, s33, 2883584
 buffer_load_dwordx4 v11, s[16:19], s45 offen nt lds
 s_add_u32 m0, s49, 126976
 s_add_u32 s45, s33, 3014656
 buffer_load_dwordx4 v11, s[16:19], s45 offen nt lds
 ds_read_b64_tr_b16 a[32:33], v8 offset:0
 ds_read_b64_tr_b16 a[34:35], v8 offset:1024
 ds_read_b64_tr_b16 a[96:97], v9 offset:0
 ds_read_b64_tr_b16 a[98:99], v9 offset:1024
 ds_read_b64_tr_b16 a[160:161], v8 offset:8192
 ds_read_b64_tr_b16 a[162:163], v8 offset:9216
 ds_read_b64_tr_b16 a[224:225], v9 offset:8192
 ds_read_b64_tr_b16 a[226:227], v9 offset:9216
 s_waitcnt vmcnt(8) lgkmcnt(0)
 s_barrier
 s_add_u32 m0, s49, 65536
 s_add_u32 s45, s32, 3145728
 buffer_load_dwordx4 v11, s[12:15], s45 offen nt lds
 s_add_u32 m0, s49, 69632
 s_add_u32 s45, s32, 3276800
 buffer_load_dwordx4 v11, s[12:15], s45 offen nt lds
 s_add_u32 m0, s49, 73728
 s_add_u32 s45, s33, 3145728
 buffer_load_dwordx4 v11, s[16:19], s45 offen nt lds
 s_add_u32 m0, s49, 77824
 s_add_u32 s45, s33, 3276800
 buffer_load_dwordx4 v11, s[16:19], s45 offen nt lds
 ds_read_b64_tr_b16 a[36:37], v8 offset:16384
 ds_read_b64_tr_b16 a[38:39], v8 offset:17408
 ds_read_b64_tr_b16 a[100:101], v9 offset:16384
 ds_read_b64_tr_b16 a[102:103], v9 offset:17408
 ds_read_b64_tr_b16 a[164:165], v8 offset:24576
 ds_read_b64_tr_b16 a[166:167], v8 offset:25600
 ds_read_b64_tr_b16 a[228:229], v9 offset:24576
 ds_read_b64_tr_b16 a[230:231], v9 offset:25600
 s_waitcnt vmcnt(8) lgkmcnt(0)
 s_barrier
 s_add_u32 m0, s49, 81920
 s_add_u32 s45, s32, 3407872
 buffer_load_dwordx4 v11, s[12:15], s45 offen nt lds
 s_add_u32 m0, s49, 86016
 s_add_u32 s45, s32, 3538944
 buffer_load_dwordx4 v11, s[12:15], s45 offen nt lds
 s_add_u32 m0, s49, 90112
 s_add_u32 s45, s33, 3407872
 buffer_load_dwordx4 v11, s[16:19], s45 offen nt lds
 s_add_u32 m0, s49, 94208
 s_add_u32 s45, s33, 3538944
 buffer_load_dwordx4 v11, s[16:19], s45 offen nt lds
 ds_read_b64_tr_b16 a[40:41], v8 offset:32768
 ds_read_b64_tr_b16 a[42:43], v8 offset:33792
 ds_read_b64_tr_b16 a[104:105], v9 offset:32768
 ds_read_b64_tr_b16 a[106:107], v9 offset:33792
 ds_read_b64_tr_b16 a[168:169], v8 offset:40960
 ds_read_b64_tr_b16 a[170:171], v8 offset:41984
 ds_read_b64_tr_b16 a[232:233], v9 offset:40960
 ds_read_b64_tr_b16 a[234:235], v9 offset:41984
 s_waitcnt vmcnt(8) lgkmcnt(0)
 s_barrier
 s_add_u32 m0, s49, 98304
 s_add_u32 s45, s32, 3670016
 buffer_load_dwordx4 v11, s[12:15], s45 offen nt lds
 s_add_u32 m0, s49, 102400
 s_add_u32 s45, s32, 3801088
 buffer_load_dwordx4 v11, s[12:15], s45 offen nt lds
 s_add_u32 m0, s49, 106496
 s_add_u32 s45, s33, 3670016
 buffer_load_dwordx4 v11, s[16:19], s45 offen nt lds
 s_add_u32 m0, s49, 110592
 s_add_u32 s45, s33, 3801088
 buffer_load_dwordx4 v11, s[16:19], s45 offen nt lds
 ds_read_b64_tr_b16 a[44:45], v8 offset:49152
 ds_read_b64_tr_b16 a[46:47], v8 offset:50176
 ds_read_b64_tr_b16 a[108:109], v9 offset:49152
 ds_read_b64_tr_b16 a[110:111], v9 offset:50176
 ds_read_b64_tr_b16 a[172:173], v8 offset:57344
 ds_read_b64_tr_b16 a[174:175], v8 offset:58368
 ds_read_b64_tr_b16 a[236:237], v9 offset:57344
 ds_read_b64_tr_b16 a[238:239], v9 offset:58368
 s_waitcnt vmcnt(8) lgkmcnt(0)
 s_barrier
 s_add_u32 m0, s49, 114688
 s_add_u32 s45, s32, 3932160
 buffer_load_dwordx4 v11, s[12:15], s45 offen nt lds
 s_add_u32 m0, s49, 118784
 s_add_u32 s45, s32, 4063232
 buffer_load_dwordx4 v11, s[12:15], s45 offen nt lds
 s_add_u32 m0, s49, 122880
 s_add_u32 s45, s33, 3932160
 buffer_load_dwordx4 v11, s[16:19], s45 offen nt lds
 s_add_u32 m0, s49, 126976
 s_add_u32 s45, s33, 4063232
 buffer_load_dwordx4 v11, s[16:19], s45 offen nt lds
 ds_read_b64_tr_b16 a[48:49], v8 offset:0
 ds_read_b64_tr_b16 a[50:51], v8 offset:1024
 ds_read_b64_tr_b16 a[112:113], v9 offset:0
 ds_read_b64_tr_b16 a[114:115], v9 offset:1024
 ds_read_b64_tr_b16 a[176:177], v8 offset:8192
 ds_read_b64_tr_b16 a[178:179], v8 offset:9216
 ds_read_b64_tr_b16 a[240:241], v9 offset:8192
 ds_read_b64_tr_b16 a[242:243], v9 offset:9216
 s_waitcnt vmcnt(8) lgkmcnt(0)
 s_barrier
 ds_read_b64_tr_b16 a[52:53], v8 offset:16384
 ds_read_b64_tr_b16 a[54:55], v8 offset:17408
 ds_read_b64_tr_b16 a[116:117], v9 offset:16384
 ds_read_b64_tr_b16 a[118:119], v9 offset:17408
 ds_read_b64_tr_b16 a[180:181], v8 offset:24576
 ds_read_b64_tr_b16 a[182:183], v8 offset:25600
 ds_read_b64_tr_b16 a[244:245], v9 offset:24576
 ds_read_b64_tr_b16 a[246:247], v9 offset:25600
 s_waitcnt vmcnt(4) lgkmcnt(0)
 s_barrier
 ds_read_b64_tr_b16 a[56:57], v8 offset:32768
 ds_read_b64_tr_b16 a[58:59], v8 offset:33792
 ds_read_b64_tr_b16 a[120:121], v9 offset:32768
 ds_read_b64_tr_b16 a[122:123], v9 offset:33792
 ds_read_b64_tr_b16 a[184:185], v8 offset:40960
 ds_read_b64_tr_b16 a[186:187], v8 offset:41984
 ds_read_b64_tr_b16 a[248:249], v9 offset:40960
 ds_read_b64_tr_b16 a[250:251], v9 offset:41984
 s_waitcnt vmcnt(0) lgkmcnt(0)
 s_barrier
 ds_read_b64_tr_b16 a[60:61], v8 offset:49152
 ds_read_b64_tr_b16 a[62:63], v8 offset:50176
 ds_read_b64_tr_b16 a[124:125], v9 offset:49152
 ds_read_b64_tr_b16 a[126:127], v9 offset:50176
 ds_read_b64_tr_b16 a[188:189], v8 offset:57344
 ds_read_b64_tr_b16 a[190:191], v8 offset:58368
 ds_read_b64_tr_b16 a[252:253], v9 offset:57344
 ds_read_b64_tr_b16 a[254:255], v9 offset:58368
 s_mov_b32 s50, 0x3e0293ee
 s_mov_b32 s42, 0
 s_mov_b32 s43, 0
 s_mov_b32 s44, 65536
 v_mov_b32 v6, v4
 v_mov_b32 v7, v5
 s_mov_b32 s95, 0x200000
 v_mov_b32 v21, 0
Lfr_1:
 buffer_load_dword v20, v21, s[28:31], 0 offen sc1
 s_waitcnt vmcnt(0)
 v_cmp_ne_u32 vcc, 0, v20
 s_cbranch_vccnz Lfrk_2
 s_sub_u32 s95, s95, 1
 s_cbranch_scc0 Lfr_1
 s_endpgm
Lfrk_2:
 s_lshl_b32 s47, s2, 13
 s_add_u32 s47, s47, 0x8000000
 s_mov_b32 s48, s47
 v_mov_b32 v14, 0
 s_waitcnt vmcnt(0) lgkmcnt(0)
 s_barrier
 ds_read_b128 v[32:35], v6 offset:0
 ds_read_b128 v[36:39], v6 offset:2048
 ds_read_b128 v[40:43], v7 offset:0
 ds_read_b128 v[44:47], v7 offset:2048
 s_waitcnt lgkmcnt(2)
Lps_loop_3:
 v_mfma_f32_16x16x32_bf16 v[64:67], a[0:3], v[32:35], 0
 ds_read_b128 v[48:51], v6 offset:4096
 v_mfma_f32_16x16x32_bf16 v[72:75], a[64:67], v[32:35], 0
 ds_read_b128 v[52:55], v6 offset:6144
 v_mfma_f32_16x16x32_bf16 v[80:83], v[32:35], a[128:131], 0
 s_add_u32 s41, s40, 4
 v_mfma_f32_16x16x32_bf16 v[88:91], v[32:35], a[192:195], 0
 s_add_u32 s45, s42, 2
 s_mul_i32 s46, s41, 32768
 v_mfma_f32_16x16x32_bf16 v[68:71], a[0:3], v[36:39], 0
 s_cmp_lt_u32 s45, s36
 s_cselect_b32 s46, s46, 0
 v_mfma_f32_16x16x32_bf16 v[76:79], a[64:67], v[36:39], 0
 s_lshl_b32 s49, s4, 10
 s_add_u32 s49, s49, s44
 v_mfma_f32_16x16x32_bf16 v[84:87], v[36:39], a[128:131], 0
 v_mfma_f32_16x16x32_bf16 v[92:95], v[36:39], a[192:195], 0
 s_waitcnt lgkmcnt(2)
 v_mfma_f32_16x16x32_bf16 v[64:67], a[4:7], v[40:43], v[64:67]
 ds_read_b128 v[56:59], v7 offset:4096
 v_mfma_f32_16x16x32_bf16 v[72:75], a[68:71], v[40:43], v[72:75]
 ds_read_b128 v[60:63], v7 offset:6144
 v_mfma_f32_16x16x32_bf16 v[80:83], v[40:43], a[132:135], v[80:83]
 s_add_u32 m0, s49, 0
 v_mfma_f32_16x16x32_bf16 v[88:91], v[40:43], a[196:199], v[88:91]
 buffer_load_dwordx4 v10, s[8:11], s46 offen offset:0  lds
 v_mfma_f32_16x16x32_bf16 v[68:71], a[4:7], v[44:47], v[68:71]
 s_add_u32 m0, s49, 3968
 v_mfma_f32_16x16x32_bf16 v[76:79], a[68:71], v[44:47], v[76:79]
 buffer_load_dwordx4 v10, s[8:11], s46 offen offset:128  lds
 v_mfma_f32_16x16x32_bf16 v[84:87], v[44:47], a[132:135], v[84:87]
 v_mfma_f32_16x16x32_bf16 v[92:95], v[44:47], a[196:199], v[92:95]
 s_waitcnt lgkmcnt(2)
 v_mfma_f32_16x16x32_bf16 v[64:67], a[8:11], v[48:51], v[64:67]
 ds_read_b128 v[32:35], v6 offset:8192
 v_mfma_f32_16x16x32_bf16 v[72:75], a[72:75], v[48:51], v[72:75]
 ds_read_b128 v[36:39], v6 offset:10240
 v_mfma_f32_16x16x32_bf16 v[80:83], v[48:51], a[136:139], v[80:83]
 s_add_u32 m0, s49, 7936
 v_mfma_f32_16x16x32_bf16 v[88:91], v[48:51], a[200:203], v[88:91]
 buffer_load_dwordx4 v10, s[8:11], s46 offen offset:256  lds
 v_mfma_f32_16x16x32_bf16 v[68:71], a[8:11], v[52:55], v[68:71]
 s_add_u32 m0, s49, 11904
 v_mfma_f32_16x16x32_bf16 v[76:79], a[72:75], v[52:55], v[76:79]
 buffer_load_dwordx4 v10, s[8:11], s46 offen offset:384  lds
 v_mfma_f32_16x16x32_bf16 v[84:87], v[52:55], a[136:139], v[84:87]
 v_mfma_f32_16x16x32_bf16 v[92:95], v[52:55], a[200:203], v[92:95]
 s_waitcnt lgkmcnt(2)
 v_mfma_f32_16x16x32_bf16 v[64:67], a[12:15], v[56:59], v[64:67]
 ds_read_b128 v[40:43], v7 offset:8192
 v_mfma_f32_16x16x32_bf16 v[72:75], a[76:79], v[56:59], v[72:75]
 ds_read_b128 v[44:47], v7 offset:10240
 v_mfma_f32_16x16x32_bf16 v[80:83], v[56:59], a[140:143], v[80:83]
 s_add_u32 m0, s49, 15872
 v_mfma_f32_16x16x32_bf16 v[88:91], v[56:59], a[204:207], v[88:91]
 buffer_load_dwordx4 v10, s[8:11], s46 offen offset:512  lds
 v_mfma_f32_16x16x32_bf16 v[68:71], a[12:15], v[60:63], v[68:71]
 s_add_u32 m0, s49, 19840
 v_mfma_f32_16x16x32_bf16 v[76:79], a[76:79], v[60:63], v[76:79]
 buffer_load_dwordx4 v10, s[8:11], s46 offen offset:640  lds
 v_mfma_f32_16x16x32_bf16 v[84:87], v[60:63], a[140:143], v[84:87]
 v_mfma_f32_16x16x32_bf16 v[92:95], v[60:63], a[204:207], v[92:95]
 s_waitcnt lgkmcnt(2)
 v_mfma_f32_16x16x32_bf16 v[64:67], a[16:19], v[32:35], v[64:67]
 ds_read_b128 v[48:51], v6 offset:12288
 v_mfma_f32_16x16x32_bf16 v[72:75], a[80:83], v[32:35], v[72:75]
 ds_read_b128 v[52:55], v6 offset:14336
 v_mfma_f32_16x16x32_bf16 v[80:83], v[32:35], a[144:147], v[80:83]
 s_add_u32 m0, s49, 23808
 v_mfma_f32_16x16x32_bf16 v[88:91], v[32:35], a[208:211], v[88:91]
 buffer_load_dwordx4 v10, s[8:11], s46 offen offset:768  lds
 v_mfma_f32_16x16x32_bf16 v[68:71], a[16:19], v[36:39], v[68:71]
 s_add_u32 m0, s49, 27776
 v_mfma_f32_16x16x32_bf16 v[76:79], a[80:83], v[36:39], v[76:79]
 buffer_load_dwordx4 v10, s[8:11], s46 offen offset:896  lds
 v_mfma_f32_16x16x32_bf16 v[84:87], v[36:39], a[144:147], v[84:87]
 v_mfma_f32_16x16x32_bf16 v[92:95], v[36:39], a[208:211], v[92:95]
 s_waitcnt lgkmcnt(2)
 v_mfma_f32_16x16x32_bf16 v[64:67], a[20:23], v[40:43], v[64:67]
 ds_read_b128 v[56:59], v7 offset:12288
 v_mfma_f32_16x16x32_bf16 v[72:75], a[84:87], v[40:43], v[72:75]
 ds_read_b128 v[60:63], v7 offset:14336
 v_mfma_f32_16x16x32_bf16 v[80:83], v[40:43], a[148:151], v[80:83]
 v_mfma_f32_16x16x32_bf16 v[88:91], v[40:43], a[212:215], v[88:91]
 v_mfma_f32_16x16x32_bf16 v[68:71], a[20:23], v[44:47], v[68:71]
 v_mfma_f32_16x16x32_bf16 v[76:79], a[84:87], v[44:47], v[76:79]
 v_mfma_f32_16x16x32_bf16 v[84:87], v[44:47], a[148:151], v[84:87]
 v_mfma_f32_16x16x32_bf16 v[92:95], v[44:47], a[212:215], v[92:95]
 s_waitcnt lgkmcnt(2)
 v_mfma_f32_16x16x32_bf16 v[64:67], a[24:27], v[48:51], v[64:67]
 ds_read_b128 v[32:35], v6 offset:16384
 v_mfma_f32_16x16x32_bf16 v[72:75], a[88:91], v[48:51], v[72:75]
 ds_read_b128 v[36:39], v6 offset:18432
 v_mfma_f32_16x16x32_bf16 v[80:83], v[48:51], a[152:155], v[80:83]
 v_cvt_pk_bf16_f32 v16, v96, v97
 v_mfma_f32_16x16x32_bf16 v[88:91], v[48:51], a[216:219], v[88:91]
 v_cvt_pk_bf16_f32 v17, v104, v105
 v_mfma_f32_16x16x32_bf16 v[68:71], a[24:27], v[52:55], v[68:71]
 v_mfma_f32_16x16x32_bf16 v[76:79], a[88:91], v[52:55], v[76:79]
 v_cvt_pk_bf16_f32 v18, v98, v99
 v_mfma_f32_16x16x32_bf16 v[84:87], v[52:55], a[152:155], v[84:87]
 v_mfma_f32_16x16x32_bf16 v[92:95], v[52:55], a[216:219], v[92:95]
 s_waitcnt lgkmcnt(2)
 v_mfma_f32_16x16x32_bf16 v[64:67], a[28:31], v[56:59], v[64:67]
 ds_read_b128 v[40:43], v7 offset:16384
 v_mfma_f32_16x16x32_bf16 v[72:75], a[92:95], v[56:59], v[72:75]
 ds_read_b128 v[44:47], v7 offset:18432
 v_mfma_f32_16x16x32_bf16 v[80:83], v[56:59], a[156:159], v[80:83]
 v_cvt_pk_bf16_f32 v19, v106, v107
 v_mfma_f32_16x16x32_bf16 v[88:91], v[56:59], a[220:223], v[88:91]
 v_mfma_f32_16x16x32_bf16 v[68:71], a[28:31], v[60:63], v[68:71]
 buffer_store_dwordx4 v[16:19], v12, s[20:23], s47 offen offset:0 sc1
 v_mfma_f32_16x16x32_bf16 v[76:79], a[92:95], v[60:63], v[76:79]
 v_cvt_pk_bf16_f32 v20, v100, v101
 v_mfma_f32_16x16x32_bf16 v[84:87], v[60:63], a[156:159], v[84:87]
 v_mfma_f32_16x16x32_bf16 v[92:95], v[60:63], a[220:223], v[92:95]
 s_waitcnt lgkmcnt(2)
 v_mfma_f32_16x16x32_bf16 v[64:67], a[32:35], v[32:35], v[64:67]
 ds_read_b128 v[48:51], v6 offset:20480
 v_mfma_f32_16x16x32_bf16 v[72:75], a[96:99], v[32:35], v[72:75]
 ds_read_b128 v[52:55], v6 offset:22528
 v_mfma_f32_16x16x32_bf16 v[80:83], v[32:35], a[160:163], v[80:83]
 v_cvt_pk_bf16_f32 v21, v108, v109
 v_mfma_f32_16x16x32_bf16 v[88:91], v[32:35], a[224:227], v[88:91]
 v_mfma_f32_16x16x32_bf16 v[68:71], a[32:35], v[36:39], v[68:71]
 v_cvt_pk_bf16_f32 v22, v102, v103
 v_mfma_f32_16x16x32_bf16 v[76:79], a[96:99], v[36:39], v[76:79]
 v_mfma_f32_16x16x32_bf16 v[84:87], v[36:39], a[160:163], v[84:87]
 v_cvt_pk_bf16_f32 v23, v110, v111
 v_mfma_f32_16x16x32_bf16 v[92:95], v[36:39], a[224:227], v[92:95]
 s_waitcnt lgkmcnt(2)
 v_mfma_f32_16x16x32_bf16 v[64:67], a[36:39], v[40:43], v[64:67]
 ds_read_b128 v[56:59], v7 offset:20480
 v_mfma_f32_16x16x32_bf16 v[72:75], a[100:103], v[40:43], v[72:75]
 ds_read_b128 v[60:63], v7 offset:22528
 v_mfma_f32_16x16x32_bf16 v[80:83], v[40:43], a[164:167], v[80:83]
 buffer_store_dwordx4 v[20:23], v12, s[20:23], s47 offen offset:1024 sc1
 v_mfma_f32_16x16x32_bf16 v[88:91], v[40:43], a[228:231], v[88:91]
 v_mfma_f32_16x16x32_bf16 v[68:71], a[36:39], v[44:47], v[68:71]
 v_cvt_pk_bf16_f32 v24, v112, v113
 v_mfma_f32_16x16x32_bf16 v[76:79], a[100:103], v[44:47], v[76:79]
 v_mfma_f32_16x16x32_bf16 v[84:87], v[44:47], a[164:167], v[84:87]
 v_cvt_pk_bf16_f32 v25, v116, v117
 v_mfma_f32_16x16x32_bf16 v[92:95], v[44:47], a[228:231], v[92:95]
 s_waitcnt lgkmcnt(2)
 v_mfma_f32_16x16x32_bf16 v[64:67], a[40:43], v[48:51], v[64:67]
 ds_read_b128 v[32:35], v6 offset:24576
 v_mfma_f32_16x16x32_bf16 v[72:75], a[104:107], v[48:51], v[72:75]
 ds_read_b128 v[36:39], v6 offset:26624
 v_mfma_f32_16x16x32_bf16 v[80:83], v[48:51], a[168:171], v[80:83]
 v_mfma_f32_16x16x32_bf16 v[88:91], v[48:51], a[232:235], v[88:91]
 v_cvt_pk_bf16_f32 v26, v114, v115
 v_mfma_f32_16x16x32_bf16 v[68:71], a[40:43], v[52:55], v[68:71]
 v_cvt_pk_bf16_f32 v27, v118, v119
 v_mfma_f32_16x16x32_bf16 v[76:79], a[104:107], v[52:55], v[76:79]
 v_mfma_f32_16x16x32_bf16 v[84:87], v[52:55], a[168:171], v[84:87]
 buffer_store_dwordx4 v[24:27], v12, s[20:23], s48 offen offset:0 sc1
 v_mfma_f32_16x16x32_bf16 v[92:95], v[52:55], a[232:235], v[92:95]
 s_waitcnt lgkmcnt(2)
 v_mfma_f32_16x16x32_bf16 v[64:67], a[44:47], v[56:59], v[64:67]
 ds_read_b128 v[40:43], v7 offset:24576
 v_mfma_f32_16x16x32_bf16 v[72:75], a[108:111], v[56:59], v[72:75]
 ds_read_b128 v[44:47], v7 offset:26624
 v_mfma_f32_16x16x32_bf16 v[80:83], v[56:59], a[172:175], v[80:83]
 s_add_u32 s43, s43, 32768
 s_cmp_eq_u32 s43, 131072
 v_mfma_f32_16x16x32_bf16 v[88:91], v[56:59], a[236:239], v[88:91]
 s_cselect_b32 s43, 0, s43
 s_add_u32 s44, s44, 32768
 v_mfma_f32_16x16x32_bf16 v[68:71], a[44:47], v[60:63], v[68:71]
 s_cmp_eq_u32 s44, 131072
 s_cselect_b32 s44, 0, s44
 v_mfma_f32_16x16x32_bf16 v[76:79], a[108:111], v[60:63], v[76:79]
 v_mfma_f32_16x16x32_bf16 v[84:87], v[60:63], a[172:175], v[84:87]
 v_cvt_pk_bf16_f32 v28, v120, v121
 v_mfma_f32_16x16x32_bf16 v[92:95], v[60:63], a[236:239], v[92:95]
 s_waitcnt lgkmcnt(2)
 v_mfma_f32_16x16x32_bf16 v[64:67], a[48:51], v[32:35], v[64:67]
 ds_read_b128 v[48:51], v6 offset:28672
 v_mfma_f32_16x16x32_bf16 v[72:75], a[112:115], v[32:35], v[72:75]
 ds_read_b128 v[52:55], v6 offset:30720
 v_mfma_f32_16x16x32_bf16 v[80:83], v[32:35], a[176:179], v[80:83]
 v_add_u32 v6, s43, v4
 v_mfma_f32_16x16x32_bf16 v[88:91], v[32:35], a[240:243], v[88:91]
 v_mfma_f32_16x16x32_bf16 v[68:71], a[48:51], v[36:39], v[68:71]
 v_cvt_pk_bf16_f32 v29, v124, v125
 v_mfma_f32_16x16x32_bf16 v[76:79], a[112:115], v[36:39], v[76:79]
 v_cvt_pk_bf16_f32 v30, v122, v123
 v_mfma_f32_16x16x32_bf16 v[84:87], v[36:39], a[176:179], v[84:87]
 v_mfma_f32_16x16x32_bf16 v[92:95], v[36:39], a[240:243], v[92:95]
 s_waitcnt lgkmcnt(2)
 v_mfma_f32_16x16x32_bf16 v[64:67], a[52:55], v[40:43], v[64:67]
 ds_read_b128 v[56:59], v7 offset:28672
 v_mfma_f32_16x16x32_bf16 v[72:75], a[116:119], v[40:43], v[72:75]
 ds_read_b128 v[60:63], v7 offset:30720
 v_mfma_f32_16x16x32_bf16 v[80:83], v[40:43], a[180:183], v[80:83]
 v_add_u32 v7, s43, v5
 v_mfma_f32_16x16x32_bf16 v[88:91], v[40:43], a[244:247], v[88:91]
 v_cvt_pk_bf16_f32 v31, v126, v127
 v_mfma_f32_16x16x32_bf16 v[68:71], a[52:55], v[44:47], v[68:71]
 v_mfma_f32_16x16x32_bf16 v[76:79], a[116:119], v[44:47], v[76:79]
 buffer_store_dwordx4 v[28:31], v12, s[20:23], s48 offen offset:1024 sc1
 v_mfma_f32_16x16x32_bf16 v[84:87], v[44:47], a[180:183], v[84:87]
 v_mfma_f32_16x16x32_bf16 v[92:95], v[44:47], a[244:247], v[92:95]
 s_waitcnt lgkmcnt(2)
 v_mfma_f32_16x16x32_bf16 v[64:67], a[56:59], v[48:51], v[64:67]
 s_waitcnt vmcnt(12)
 s_barrier
 ds_read_b128 v[32:35], v6 offset:0
 v_mfma_f32_16x16x32_bf16 v[72:75], a[120:123], v[48:51], v[72:75]
 ds_read_b128 v[36:39], v6 offset:2048
 v_mfma_f32_16x16x32_bf16 v[80:83], v[48:51], a[184:187], v[80:83]
 v_mfma_f32_16x16x32_bf16 v[88:91], v[48:51], a[248:251], v[88:91]
 v_mfma_f32_16x16x32_bf16 v[68:71], a[56:59], v[52:55], v[68:71]
 v_mfma_f32_16x16x32_bf16 v[76:79], a[120:123], v[52:55], v[76:79]
 v_mfma_f32_16x16x32_bf16 v[84:87], v[52:55], a[184:187], v[84:87]
 v_mfma_f32_16x16x32_bf16 v[92:95], v[52:55], a[248:251], v[92:95]
 s_waitcnt lgkmcnt(2)
 v_mfma_f32_16x16x32_bf16 v[64:67], a[60:63], v[56:59], v[64:67]
 ds_read_b128 v[40:43], v7 offset:0
 v_mfma_f32_16x16x32_bf16 v[72:75], a[124:127], v[56:59], v[72:75]
 ds_read_b128 v[44:47], v7 offset:2048
 v_mfma_f32_16x16x32_bf16 v[80:83], v[56:59], a[188:191], v[80:83]
 s_mul_i32 s45, s39, 524288
 s_add_u32 s47, s34, s45
 v_mfma_f32_16x16x32_bf16 v[88:91], v[56:59], a[252:255], v[88:91]
 s_add_u32 s48, s35, s45
 v_mov_b32 v14, s42
 v_mfma_f32_16x16x32_bf16 v[68:71], a[60:63], v[60:63], v[68:71]
 s_mov_b32 s39, s40
 s_mov_b32 s40, s41
 v_mfma_f32_16x16x32_bf16 v[76:79], a[124:127], v[60:63], v[76:79]
 s_add_u32 s42, s42, 1
 v_mfma_f32_16x16x32_bf16 v[84:87], v[60:63], a[188:191], v[84:87]
 v_mfma_f32_16x16x32_bf16 v[92:95], v[60:63], a[252:255], v[92:95]
 s_waitcnt lgkmcnt(2)
 v_mfma_f32_16x16x32_bf16 v[96:99], a[0:3], v[32:35], 0
 ds_read_b128 v[48:51], v6 offset:4096
 v_mfma_f32_16x16x32_bf16 v[104:107], a[64:67], v[32:35], 0
 ds_read_b128 v[52:55], v6 offset:6144
 v_mfma_f32_16x16x32_bf16 v[112:115], v[32:35], a[128:131], 0
 s_add_u32 s41, s40, 4
 v_mfma_f32_16x16x32_bf16 v[120:123], v[32:35], a[192:195], 0
 s_add_u32 s45, s42, 2
 s_mul_i32 s46, s41, 32768
 v_mfma_f32_16x16x32_bf16 v[100:103], a[0:3], v[36:39], 0
 s_cmp_lt_u32 s45, s36
 s_cselect_b32 s46, s46, 0
 v_mfma_f32_16x16x32_bf16 v[108:111], a[64:67], v[36:39], 0
 s_lshl_b32 s49, s4, 10
 s_add_u32 s49, s49, s44
 v_mfma_f32_16x16x32_bf16 v[116:119], v[36:39], a[128:131], 0
 v_mfma_f32_16x16x32_bf16 v[124:127], v[36:39], a[192:195], 0
 s_waitcnt lgkmcnt(2)
 v_mfma_f32_16x16x32_bf16 v[96:99], a[4:7], v[40:43], v[96:99]
 ds_read_b128 v[56:59], v7 offset:4096
 v_mfma_f32_16x16x32_bf16 v[104:107], a[68:71], v[40:43], v[104:107]
 ds_read_b128 v[60:63], v7 offset:6144
 v_mfma_f32_16x16x32_bf16 v[112:115], v[40:43], a[132:135], v[112:115]
 s_add_u32 m0, s49, 0
 v_mfma_f32_16x16x32_bf16 v[120:123], v[40:43], a[196:199], v[120:123]
 buffer_load_dwordx4 v10, s[8:11], s46 offen offset:0  lds
 v_mfma_f32_16x16x32_bf16 v[100:103], a[4:7], v[44:47], v[100:103]
 s_add_u32 m0, s49, 3968
 v_mfma_f32_16x16x32_bf16 v[108:111], a[68:71], v[44:47], v[108:111]
 buffer_load_dwordx4 v10, s[8:11], s46 offen offset:128  lds
 v_mfma_f32_16x16x32_bf16 v[116:119], v[44:47], a[132:135], v[116:119]
 v_mfma_f32_16x16x32_bf16 v[124:127], v[44:47], a[196:199], v[124:127]
 s_waitcnt lgkmcnt(2)
 v_mfma_f32_16x16x32_bf16 v[96:99], a[8:11], v[48:51], v[96:99]
 ds_read_b128 v[32:35], v6 offset:8192
 v_mfma_f32_16x16x32_bf16 v[104:107], a[72:75], v[48:51], v[104:107]
 ds_read_b128 v[36:39], v6 offset:10240
 v_mfma_f32_16x16x32_bf16 v[112:115], v[48:51], a[136:139], v[112:115]
 s_add_u32 m0, s49, 7936
 v_mfma_f32_16x16x32_bf16 v[120:123], v[48:51], a[200:203], v[120:123]
 buffer_load_dwordx4 v10, s[8:11], s46 offen offset:256  lds
 v_mfma_f32_16x16x32_bf16 v[100:103], a[8:11], v[52:55], v[100:103]
 s_add_u32 m0, s49, 11904
 v_mfma_f32_16x16x32_bf16 v[108:111], a[72:75], v[52:55], v[108:111]
 buffer_load_dwordx4 v10, s[8:11], s46 offen offset:384  lds
 v_mfma_f32_16x16x32_bf16 v[116:119], v[52:55], a[136:139], v[116:119]
 v_mfma_f32_16x16x32_bf16 v[124:127], v[52:55], a[200:203], v[124:127]
 s_waitcnt lgkmcnt(2)
 v_mfma_f32_16x16x32_bf16 v[96:99], a[12:15], v[56:59], v[96:99]
 ds_read_b128 v[40:43], v7 offset:8192
 v_mfma_f32_16x16x32_bf16 v[104:107], a[76:79], v[56:59], v[104:107]
 ds_read_b128 v[44:47], v7 offset:10240
 v_mfma_f32_16x16x32_bf16 v[112:115], v[56:59], a[140:143], v[112:115]
 s_add_u32 m0, s49, 15872
 v_mfma_f32_16x16x32_bf16 v[120:123], v[56:59], a[204:207], v[120:123]
 buffer_load_dwordx4 v10, s[8:11], s46 offen offset:512  lds
 v_mfma_f32_16x16x32_bf16 v[100:103], a[12:15], v[60:63], v[100:103]
 s_add_u32 m0, s49, 19840
 v_mfma_f32_16x16x32_bf16 v[108:111], a[76:79], v[60:63], v[108:111]
 buffer_load_dwordx4 v10, s[8:11], s46 offen offset:640  lds
 v_mfma_f32_16x16x32_bf16 v[116:119], v[60:63], a[140:143], v[116:119]
 v_mfma_f32_16x16x32_bf16 v[124:127], v[60:63], a[204:207], v[124:127]
 s_waitcnt lgkmcnt(2)
 v_mfma_f32_16x16x32_bf16 v[96:99], a[16:19], v[32:35], v[96:99]
 ds_read_b128 v[48:51], v6 offset:12288
 v_mfma_f32_16x16x32_bf16 v[104:107], a[80:83], v[32:35], v[104:107]
 ds_read_b128 v[52:55], v6 offset:14336
 v_mfma_f32_16x16x32_bf16 v[112:115], v[32:35], a[144:147], v[112:115]
 s_add_u32 m0, s49, 23808
 v_mfma_f32_16x16x32_bf16 v[120:123], v[32:35], a[208:211], v[120:123]
 buffer_load_dwordx4 v10, s[8:11], s46 offen offset:768  lds
 v_mfma_f32_16x16x32_bf16 v[100:103], a[16:19], v[36:39], v[100:103]
 s_add_u32 m0, s49, 27776
 v_mfma_f32_16x16x32_bf16 v[108:111], a[80:83], v[36:39], v[108:111]
 buffer_load_dwordx4 v10, s[8:11], s46 offen offset:896  lds
 v_mfma_f32_16x16x32_bf16 v[116:119], v[36:39], a[144:147], v[116:119]
 v_mfma_f32_16x16x32_bf16 v[124:127], v[36:39], a[208:211], v[124:127]
 s_waitcnt lgkmcnt(2)
 v_mfma_f32_16x16x32_bf16 v[96:99], a[20:23], v[40:43], v[96:99]
 ds_read_b128 v[56:59], v7 offset:12288
 v_mfma_f32_16x16x32_bf16 v[104:107], a[84:87], v[40:43], v[104:107]
 ds_read_b128 v[60:63], v7 offset:14336
 v_mfma_f32_16x16x32_bf16 v[112:115], v[40:43], a[148:151], v[112:115]
 v_mfma_f32_16x16x32_bf16 v[120:123], v[40:43], a[212:215], v[120:123]
 v_mfma_f32_16x16x32_bf16 v[100:103], a[20:23], v[44:47], v[100:103]
 v_mfma_f32_16x16x32_bf16 v[108:111], a[84:87], v[44:47], v[108:111]
 v_mfma_f32_16x16x32_bf16 v[116:119], v[44:47], a[148:151], v[116:119]
 v_mfma_f32_16x16x32_bf16 v[124:127], v[44:47], a[212:215], v[124:127]
 s_waitcnt lgkmcnt(2)
 v_mfma_f32_16x16x32_bf16 v[96:99], a[24:27], v[48:51], v[96:99]
 ds_read_b128 v[32:35], v6 offset:16384
 v_mfma_f32_16x16x32_bf16 v[104:107], a[88:91], v[48:51], v[104:107]
 ds_read_b128 v[36:39], v6 offset:18432
 v_mfma_f32_16x16x32_bf16 v[112:115], v[48:51], a[152:155], v[112:115]
 v_cvt_pk_bf16_f32 v16, v64, v65
 v_mfma_f32_16x16x32_bf16 v[120:123], v[48:51], a[216:219], v[120:123]
 v_cvt_pk_bf16_f32 v17, v72, v73
 v_mfma_f32_16x16x32_bf16 v[100:103], a[24:27], v[52:55], v[100:103]
 v_mfma_f32_16x16x32_bf16 v[108:111], a[88:91], v[52:55], v[108:111]
 v_cvt_pk_bf16_f32 v18, v66, v67
 v_mfma_f32_16x16x32_bf16 v[116:119], v[52:55], a[152:155], v[116:119]
 v_mfma_f32_16x16x32_bf16 v[124:127], v[52:55], a[216:219], v[124:127]
 s_waitcnt lgkmcnt(2)
 v_mfma_f32_16x16x32_bf16 v[96:99], a[28:31], v[56:59], v[96:99]
 ds_read_b128 v[40:43], v7 offset:16384
 v_mfma_f32_16x16x32_bf16 v[104:107], a[92:95], v[56:59], v[104:107]
 ds_read_b128 v[44:47], v7 offset:18432
 v_mfma_f32_16x16x32_bf16 v[112:115], v[56:59], a[156:159], v[112:115]
 v_cvt_pk_bf16_f32 v19, v74, v75
 v_mfma_f32_16x16x32_bf16 v[120:123], v[56:59], a[220:223], v[120:123]
 v_mfma_f32_16x16x32_bf16 v[100:103], a[28:31], v[60:63], v[100:103]
 buffer_store_dwordx4 v[16:19], v12, s[20:23], s47 offen offset:0 sc1
 v_mfma_f32_16x16x32_bf16 v[108:111], a[92:95], v[60:63], v[108:111]
 v_cvt_pk_bf16_f32 v20, v68, v69
 v_mfma_f32_16x16x32_bf16 v[116:119], v[60:63], a[156:159], v[116:119]
 v_mfma_f32_16x16x32_bf16 v[124:127], v[60:63], a[220:223], v[124:127]
 s_waitcnt lgkmcnt(2)
 v_mfma_f32_16x16x32_bf16 v[96:99], a[32:35], v[32:35], v[96:99]
 ds_read_b128 v[48:51], v6 offset:20480
 v_mfma_f32_16x16x32_bf16 v[104:107], a[96:99], v[32:35], v[104:107]
 ds_read_b128 v[52:55], v6 offset:22528
 v_mfma_f32_16x16x32_bf16 v[112:115], v[32:35], a[160:163], v[112:115]
 v_cvt_pk_bf16_f32 v21, v76, v77
 v_mfma_f32_16x16x32_bf16 v[120:123], v[32:35], a[224:227], v[120:123]
 v_mfma_f32_16x16x32_bf16 v[100:103], a[32:35], v[36:39], v[100:103]
 v_cvt_pk_bf16_f32 v22, v70, v71
 v_mfma_f32_16x16x32_bf16 v[108:111], a[96:99], v[36:39], v[108:111]
 v_mfma_f32_16x16x32_bf16 v[116:119], v[36:39], a[160:163], v[116:119]
 v_cvt_pk_bf16_f32 v23, v78, v79
 v_mfma_f32_16x16x32_bf16 v[124:127], v[36:39], a[224:227], v[124:127]
 s_waitcnt lgkmcnt(2)
 v_mfma_f32_16x16x32_bf16 v[96:99], a[36:39], v[40:43], v[96:99]
 ds_read_b128 v[56:59], v7 offset:20480
 v_mfma_f32_16x16x32_bf16 v[104:107], a[100:103], v[40:43], v[104:107]
 ds_read_b128 v[60:63], v7 offset:22528
 v_mfma_f32_16x16x32_bf16 v[112:115], v[40:43], a[164:167], v[112:115]
 buffer_store_dwordx4 v[20:23], v12, s[20:23], s47 offen offset:1024 sc1
 v_mfma_f32_16x16x32_bf16 v[120:123], v[40:43], a[228:231], v[120:123]
 v_mfma_f32_16x16x32_bf16 v[100:103], a[36:39], v[44:47], v[100:103]
 v_cvt_pk_bf16_f32 v24, v80, v81
 v_mfma_f32_16x16x32_bf16 v[108:111], a[100:103], v[44:47], v[108:111]
 v_mfma_f32_16x16x32_bf16 v[116:119], v[44:47], a[164:167], v[116:119]
 v_cvt_pk_bf16_f32 v25, v84, v85
 v_mfma_f32_16x16x32_bf16 v[124:127], v[44:47], a[228:231], v[124:127]
 s_waitcnt lgkmcnt(2)
 v_mfma_f32_16x16x32_bf16 v[96:99], a[40:43], v[48:51], v[96:99]
 ds_read_b128 v[32:35], v6 offset:24576
 v_mfma_f32_16x16x32_bf16 v[104:107], a[104:107], v[48:51], v[104:107]
 ds_read_b128 v[36:39], v6 offset:26624
 v_mfma_f32_16x16x32_bf16 v[112:115], v[48:51], a[168:171], v[112:115]
 v_mfma_f32_16x16x32_bf16 v[120:123], v[48:51], a[232:235], v[120:123]
 v_cvt_pk_bf16_f32 v26, v82, v83
 v_mfma_f32_16x16x32_bf16 v[100:103], a[40:43], v[52:55], v[100:103]
 v_cvt_pk_bf16_f32 v27, v86, v87
 v_mfma_f32_16x16x32_bf16 v[108:111], a[104:107], v[52:55], v[108:111]
 v_mfma_f32_16x16x32_bf16 v[116:119], v[52:55], a[168:171], v[116:119]
 buffer_store_dwordx4 v[24:27], v12, s[20:23], s48 offen offset:0 sc1
 v_mfma_f32_16x16x32_bf16 v[124:127], v[52:55], a[232:235], v[124:127]
 s_waitcnt lgkmcnt(2)
 v_mfma_f32_16x16x32_bf16 v[96:99], a[44:47], v[56:59], v[96:99]
 ds_read_b128 v[40:43], v7 offset:24576
 v_mfma_f32_16x16x32_bf16 v[104:107], a[108:111], v[56:59], v[104:107]
 ds_read_b128 v[44:47], v7 offset:26624
 v_mfma_f32_16x16x32_bf16 v[112:115], v[56:59], a[172:175], v[112:115]
 s_add_u32 s43, s43, 32768
 s_cmp_eq_u32 s43, 131072
 v_mfma_f32_16x16x32_bf16 v[120:123], v[56:59], a[236:239], v[120:123]
 s_cselect_b32 s43, 0, s43
 s_add_u32 s44, s44, 32768
 v_mfma_f32_16x16x32_bf16 v[100:103], a[44:47], v[60:63], v[100:103]
 s_cmp_eq_u32 s44, 131072
 s_cselect_b32 s44, 0, s44
 v_mfma_f32_16x16x32_bf16 v[108:111], a[108:111], v[60:63], v[108:111]
 v_mfma_f32_16x16x32_bf16 v[116:119], v[60:63], a[172:175], v[116:119]
 v_cvt_pk_bf16_f32 v28, v88, v89
 v_mfma_f32_16x16x32_bf16 v[124:127], v[60:63], a[236:239], v[124:127]
 s_waitcnt lgkmcnt(2)
 v_mfma_f32_16x16x32_bf16 v[96:99], a[48:51], v[32:35], v[96:99]
 ds_read_b128 v[48:51], v6 offset:28672
 v_mfma_f32_16x16x32_bf16 v[104:107], a[112:115], v[32:35], v[104:107]
 ds_read_b128 v[52:55], v6 offset:30720
 v_mfma_f32_16x16x32_bf16 v[112:115], v[32:35], a[176:179], v[112:115]
 v_add_u32 v6, s43, v4
 v_mfma_f32_16x16x32_bf16 v[120:123], v[32:35], a[240:243], v[120:123]
 v_mfma_f32_16x16x32_bf16 v[100:103], a[48:51], v[36:39], v[100:103]
 v_cvt_pk_bf16_f32 v29, v92, v93
 v_mfma_f32_16x16x32_bf16 v[108:111], a[112:115], v[36:39], v[108:111]
 v_cvt_pk_bf16_f32 v30, v90, v91
 v_mfma_f32_16x16x32_bf16 v[116:119], v[36:39], a[176:179], v[116:119]
 v_mfma_f32_16x16x32_bf16 v[124:127], v[36:39], a[240:243], v[124:127]
 s_waitcnt lgkmcnt(2)
 v_mfma_f32_16x16x32_bf16 v[96:99], a[52:55], v[40:43], v[96:99]
 ds_read_b128 v[56:59], v7 offset:28672
 v_mfma_f32_16x16x32_bf16 v[104:107], a[116:119], v[40:43], v[104:107]
 ds_read_b128 v[60:63], v7 offset:30720
 v_mfma_f32_16x16x32_bf16 v[112:115], v[40:43], a[180:183], v[112:115]
 v_add_u32 v7, s43, v5
 v_mfma_f32_16x16x32_bf16 v[120:123], v[40:43], a[244:247], v[120:123]
 v_cvt_pk_bf16_f32 v31, v94, v95
 v_mfma_f32_16x16x32_bf16 v[100:103], a[52:55], v[44:47], v[100:103]
 v_mfma_f32_16x16x32_bf16 v[108:111], a[116:119], v[44:47], v[108:111]
 buffer_store_dwordx4 v[28:31], v12, s[20:23], s48 offen offset:1024 sc1
 v_mfma_f32_16x16x32_bf16 v[116:119], v[44:47], a[180:183], v[116:119]
 v_mfma_f32_16x16x32_bf16 v[124:127], v[44:47], a[244:247], v[124:127]
 s_waitcnt lgkmcnt(2)
 v_mfma_f32_16x16x32_bf16 v[96:99], a[56:59], v[48:51], v[96:99]
 s_waitcnt vmcnt(12)
 s_barrier
 ds_read_b128 v[32:35], v6 offset:0
 v_mfma_f32_16x16x32_bf16 v[104:107], a[120:123], v[48:51], v[104:107]
 ds_read_b128 v[36:39], v6 offset:2048
 v_mfma_f32_16x16x32_bf16 v[112:115], v[48:51], a[184:187], v[112:115]
 v_mfma_f32_16x16x32_bf16 v[120:123], v[48:51], a[248:251], v[120:123]
 v_mfma_f32_16x16x32_bf16 v[100:103], a[56:59], v[52:55], v[100:103]
 v_mfma_f32_16x16x32_bf16 v[108:111], a[120:123], v[52:55], v[108:111]
 v_mfma_f32_16x16x32_bf16 v[116:119], v[52:55], a[184:187], v[116:119]
 v_mfma_f32_16x16x32_bf16 v[124:127], v[52:55], a[248:251], v[124:127]
 s_waitcnt lgkmcnt(2)
 v_mfma_f32_16x16x32_bf16 v[96:99], a[60:63], v[56:59], v[96:99]
 ds_read_b128 v[40:43], v7 offset:0
 v_mfma_f32_16x16x32_bf16 v[104:107], a[124:127], v[56:59], v[104:107]
 ds_read_b128 v[44:47], v7 offset:2048
 v_mfma_f32_16x16x32_bf16 v[112:115], v[56:59], a[188:191], v[112:115]
 s_mul_i32 s45, s39, 524288
 s_add_u32 s47, s34, s45
 v_mfma_f32_16x16x32_bf16 v[120:123], v[56:59], a[252:255], v[120:123]
 s_add_u32 s48, s35, s45
 v_mov_b32 v14, s42
 v_mfma_f32_16x16x32_bf16 v[100:103], a[60:63], v[60:63], v[100:103]
 s_mov_b32 s39, s40
 s_mov_b32 s40, s41
 v_mfma_f32_16x16x32_bf16 v[108:111], a[124:127], v[60:63], v[108:111]
 s_add_u32 s42, s42, 1
 s_cmp_lt_u32 s42, s36
 v_mfma_f32_16x16x32_bf16 v[116:119], v[60:63], a[188:191], v[116:119]
 v_mfma_f32_16x16x32_bf16 v[124:127], v[60:63], a[252:255], v[124:127]
 s_waitcnt lgkmcnt(2)
 s_cbranch_scc1 Lps_loop_3
 s_nop 7
 v_cvt_pk_bf16_f32 v16, v96, v97
 v_cvt_pk_bf16_f32 v17, v104, v105
 v_cvt_pk_bf16_f32 v18, v98, v99
 v_cvt_pk_bf16_f32 v19, v106, v107
 buffer_store_dwordx4 v[16:19], v12, s[20:23], s47 offen offset:0 sc1
 v_cvt_pk_bf16_f32 v20, v100, v101
 v_cvt_pk_bf16_f32 v21, v108, v109
 v_cvt_pk_bf16_f32 v22, v102, v103
 v_cvt_pk_bf16_f32 v23, v110, v111
 buffer_store_dwordx4 v[20:23], v12, s[20:23], s47 offen offset:1024 sc1
 v_cvt_pk_bf16_f32 v24, v112, v113
 v_cvt_pk_bf16_f32 v25, v116, v117
 v_cvt_pk_bf16_f32 v26, v114, v115
 v_cvt_pk_bf16_f32 v27, v118, v119
 buffer_store_dwordx4 v[24:27], v12, s[20:23], s48 offen offset:0 sc1
 v_cvt_pk_bf16_f32 v28, v120, v121
 v_cvt_pk_bf16_f32 v29, v124, v125
 v_cvt_pk_bf16_f32 v30, v122, v123
 v_cvt_pk_bf16_f32 v31, v126, v127
 buffer_store_dwordx4 v[28:31], v12, s[20:23], s48 offen offset:1024 sc1
 s_waitcnt vmcnt(0) lgkmcnt(0)
 s_barrier
 v_mov_b32 v14, s36
 buffer_store_dword v14, v13, s[20:23], 0 offen sc1
 s_mov_b32 s32, s3
 s_and_b32 s33, s6, 3
 s_sub_u32 s34, 7, s33
 v_and_b32 v1, 63, v0
 v_lshlrev_b32 v1, 4, v1
 v_mov_b32 v4, 0xff800000
 v_min_u32 v5, 1, v0
 v_lshlrev_b32 v5, 28, v5
 v_mov_b32 v6, 0x3f803f80
 v_accvgpr_write_b32 a192, v6
 v_accvgpr_write_b32 a193, v6
 v_accvgpr_write_b32 a194, v6
 v_accvgpr_write_b32 a195, v6
 s_mov_b32 s52, 0xfff0ffff
 s_mov_b32 s53, 0xf000ff00
 s_mov_b32 s54, 0xffe0fffe
 s_mov_b32 s55, 0xe000fe00
 s_mov_b32 s56, 0xffc0fffc
 s_mov_b32 s57, 0xc000fc00
 s_mov_b32 s58, 0xff80fff8
 s_mov_b32 s59, 0x8000f800
 s_mov_b32 s73, 0x53800000
 s_mov_b32 s74, 0x21800000
 s_lshl_b32 s50, s4, 12
 s_lshl_b32 s45, s32, 14
 s_add_u32 s45, s45, s50
 s_add_u32 s45, s45, 0x1000000
 s_lshl_b32 s36, s33, 3
 s_add_u32 s36, s36, 8
 s_lshl_b32 s47, s34, 3
 s_add_u32 s47, s47, 8
 s_mov_b32 s35, 0
 s_mov_b32 s38, 0
 s_mov_b32 s46, 0
 s_lshl_b32 s7, s3, 7
 s_add_u32 s7, s7, 0x2000
 s_lshr_b32 s94, s3, 1
 s_lshl_b32 s94, s94, 7
 s_add_u32 s94, s94, 0x3000
 v_mov_b32 v8, 0
Law_4:
 buffer_load_dwordx4 v[16:19], v8, s[20:23], s7 offen sc1
 buffer_load_dwordx4 v[20:23], v8, s[20:23], s94 offen sc1
 s_waitcnt vmcnt(0)
 v_min3_u32 v16, v16, v17, v18
 v_min3_u32 v16, v16, v19, v20
 v_min3_u32 v16, v16, v21, v22
 v_min_u32 v16, v16, v23
 v_cmp_le_u32 vcc, 16, v16
 s_cbranch_vccnz Lawk_5
 s_sleep 2
 s_sub_u32 s95, s95, 1
 s_cbranch_scc0 Law_4
 s_endpgm
Lawk_5:
 s_lshl_b32 s37, s35, 19
 s_add_u32 m0, s38, s50
 s_add_u32 s37, s37, s45
 buffer_load_dwordx4 v1, s[20:23], s37 offen offset:0 sc1 lds
 buffer_load_dwordx4 v1, s[20:23], s37 offen offset:1024 sc1 lds
 buffer_load_dwordx4 v1, s[20:23], s37 offen offset:2048 sc1 lds
 buffer_load_dwordx4 v1, s[20:23], s37 offen offset:3072 sc1 lds
 s_add_u32 s38, s38, 0x4000
 s_and_b32 s38, s38, 0x1ffff
 s_add_u32 s35, s35, 1
 s_cmp_eq_u32 s35, s36
 s_cselect_b32 s36, s47, s36
 s_cselect_b32 s35, 0, s35
 s_lshl_b32 s44, s33, 3
 s_add_u32 s44, s44, s4
 s_lshl_b32 s44, s44, 5
 s_add_u32 s44, s44, s32
 s_lshl_b32 s44, s44, 13
 s_add_u32 s44, s44, 0x5000000
 buffer_load_dwordx4 a[0:3], v1, s[20:23], s44 offen offset:0 sc1
 buffer_load_dwordx4 a[16:19], v1, s[20:23], s44 offen offset:1024 sc1
 buffer_load_dwordx4 a[4:7], v1, s[20:23], s44 offen offset:2048 sc1
 buffer_load_dwordx4 a[20:23], v1, s[20:23], s44 offen offset:3072 sc1
 s_add_u32 s44, s44, 4096
 buffer_load_dwordx4 a[8:11], v1, s[20:23], s44 offen offset:0 sc1
 buffer_load_dwordx4 a[24:27], v1, s[20:23], s44 offen offset:1024 sc1
 buffer_load_dwordx4 a[12:15], v1, s[20:23], s44 offen offset:2048 sc1
 buffer_load_dwordx4 a[28:31], v1, s[20:23], s44 offen offset:3072 sc1
 s_lshl_b32 s44, s33, 3
 s_add_u32 s44, s44, 7
 s_sub_u32 s44, s44, s4
 s_lshl_b32 s44, s44, 5
 s_add_u32 s44, s44, s32
 s_lshl_b32 s44, s44, 13
 s_add_u32 s44, s44, 0x5000000
 buffer_load_dwordx4 a[32:35], v1, s[20:23], s44 offen offset:0 sc1
 buffer_load_dwordx4 a[48:51], v1, s[20:23], s44 offen offset:1024 sc1
 buffer_load_dwordx4 a[36:39], v1, s[20:23], s44 offen offset:2048 sc1
 buffer_load_dwordx4 a[52:55], v1, s[20:23], s44 offen offset:3072 sc1
 s_add_u32 s44, s44, 4096
 buffer_load_dwordx4 a[40:43], v1, s[20:23], s44 offen offset:0 sc1
 buffer_load_dwordx4 a[56:59], v1, s[20:23], s44 offen offset:1024 sc1
 buffer_load_dwordx4 a[44:47], v1, s[20:23], s44 offen offset:2048 sc1
 buffer_load_dwordx4 a[60:63], v1, s[20:23], s44 offen offset:3072 sc1
 s_lshl_b32 s37, s35, 19
 s_add_u32 m0, s38, s50
 s_add_u32 s37, s37, s45
 buffer_load_dwordx4 v1, s[20:23], s37 offen offset:0 sc1 lds
 buffer_load_dwordx4 v1, s[20:23], s37 offen offset:1024 sc1 lds
 buffer_load_dwordx4 v1, s[20:23], s37 offen offset:2048 sc1 lds
 buffer_load_dwordx4 v1, s[20:23], s37 offen offset:3072 sc1 lds
 s_add_u32 s38, s38, 0x4000
 s_and_b32 s38, s38, 0x1ffff
 s_add_u32 s35, s35, 1
 s_cmp_eq_u32 s35, s36
 s_cselect_b32 s36, s47, s36
 s_cselect_b32 s35, 0, s35
 s_lshl_b32 s37, s35, 19
 s_add_u32 m0, s38, s50
 s_add_u32 s37, s37, s45
 buffer_load_dwordx4 v1, s[20:23], s37 offen offset:0 sc1 lds
 buffer_load_dwordx4 v1, s[20:23], s37 offen offset:1024 sc1 lds
 buffer_load_dwordx4 v1, s[20:23], s37 offen offset:2048 sc1 lds
 buffer_load_dwordx4 v1, s[20:23], s37 offen offset:3072 sc1 lds
 s_add_u32 s38, s38, 0x4000
 s_and_b32 s38, s38, 0x1ffff
 s_add_u32 s35, s35, 1
 s_cmp_eq_u32 s35, s36
 s_cselect_b32 s36, s47, s36
 s_cselect_b32 s35, 0, s35
 s_lshl_b32 s37, s35, 19
 s_add_u32 m0, s38, s50
 s_add_u32 s37, s37, s45
 buffer_load_dwordx4 v1, s[20:23], s37 offen offset:0 sc1 lds
 buffer_load_dwordx4 v1, s[20:23], s37 offen offset:1024 sc1 lds
 buffer_load_dwordx4 v1, s[20:23], s37 offen offset:2048 sc1 lds
 buffer_load_dwordx4 v1, s[20:23], s37 offen offset:3072 sc1 lds
 s_add_u32 s38, s38, 0x4000
 s_and_b32 s38, s38, 0x1ffff
 s_add_u32 s35, s35, 1
 s_cmp_eq_u32 s35, s36
 s_cselect_b32 s36, s47, s36
 s_cselect_b32 s35, 0, s35
 s_lshl_b32 s37, s35, 19
 s_add_u32 m0, s38, s50
 s_add_u32 s37, s37, s45
 buffer_load_dwordx4 v1, s[20:23], s37 offen offset:0 sc1 lds
 buffer_load_dwordx4 v1, s[20:23], s37 offen offset:1024 sc1 lds
 buffer_load_dwordx4 v1, s[20:23], s37 offen offset:2048 sc1 lds
 buffer_load_dwordx4 v1, s[20:23], s37 offen offset:3072 sc1 lds
 s_add_u32 s38, s38, 0x4000
 s_and_b32 s38, s38, 0x1ffff
 s_add_u32 s35, s35, 1
 s_cmp_eq_u32 s35, s36
 s_cselect_b32 s36, s47, s36
 s_cselect_b32 s35, 0, s35
 s_lshl_b32 s37, s35, 19
 s_add_u32 m0, s38, s50
 s_add_u32 s37, s37, s45
 buffer_load_dwordx4 v1, s[20:23], s37 offen offset:0 sc1 lds
 buffer_load_dwordx4 v1, s[20:23], s37 offen offset:1024 sc1 lds
 buffer_load_dwordx4 v1, s[20:23], s37 offen offset:2048 sc1 lds
 buffer_load_dwordx4 v1, s[20:23], s37 offen offset:3072 sc1 lds
 s_add_u32 s38, s38, 0x4000
 s_and_b32 s38, s38, 0x1ffff
 s_add_u32 s35, s35, 1
 s_cmp_eq_u32 s35, s36
 s_cselect_b32 s36, s47, s36
 s_cselect_b32 s35, 0, s35
 s_lshl_b32 s37, s35, 19
 s_add_u32 m0, s38, s50
 s_add_u32 s37, s37, s45
 buffer_load_dwordx4 v1, s[20:23], s37 offen offset:0 sc1 lds
 buffer_load_dwordx4 v1, s[20:23], s37 offen offset:1024 sc1 lds
 buffer_load_dwordx4 v1, s[20:23], s37 offen offset:2048 sc1 lds
 buffer_load_dwordx4 v1, s[20:23], s37 offen offset:3072 sc1 lds
 s_add_u32 s38, s38, 0x4000
 s_and_b32 s38, s38, 0x1ffff
 s_add_u32 s35, s35, 1
 s_cmp_eq_u32 s35, s36
 s_cselect_b32 s36, s47, s36
 s_cselect_b32 s35, 0, s35
 s_lshl_b32 s44, s34, 3
 s_add_u32 s44, s44, s4
 s_lshl_b32 s44, s44, 5
 s_add_u32 s44, s44, s32
 s_lshl_b32 s44, s44, 13
 s_add_u32 s44, s44, 0x5000000
 buffer_load_dwordx4 a[64:67], v1, s[20:23], s44 offen offset:0 sc1
 buffer_load_dwordx4 a[80:83], v1, s[20:23], s44 offen offset:1024 sc1
 buffer_load_dwordx4 a[68:71], v1, s[20:23], s44 offen offset:2048 sc1
 buffer_load_dwordx4 a[84:87], v1, s[20:23], s44 offen offset:3072 sc1
 s_add_u32 s44, s44, 4096
 buffer_load_dwordx4 a[72:75], v1, s[20:23], s44 offen offset:0 sc1
 buffer_load_dwordx4 a[88:91], v1, s[20:23], s44 offen offset:1024 sc1
 buffer_load_dwordx4 a[76:79], v1, s[20:23], s44 offen offset:2048 sc1
 buffer_load_dwordx4 a[92:95], v1, s[20:23], s44 offen offset:3072 sc1
 s_lshl_b32 s44, s34, 3
 s_add_u32 s44, s44, 7
 s_sub_u32 s44, s44, s4
 s_lshl_b32 s44, s44, 5
 s_add_u32 s44, s44, s32
 s_lshl_b32 s44, s44, 13
 s_add_u32 s44, s44, 0x5000000
 buffer_load_dwordx4 a[96:99], v1, s[20:23], s44 offen offset:0 sc1
 buffer_load_dwordx4 a[112:115], v1, s[20:23], s44 offen offset:1024 sc1
 buffer_load_dwordx4 a[100:103], v1, s[20:23], s44 offen offset:2048 sc1
 buffer_load_dwordx4 a[116:119], v1, s[20:23], s44 offen offset:3072 sc1
 s_add_u32 s44, s44, 4096
 buffer_load_dwordx4 a[104:107], v1, s[20:23], s44 offen offset:0 sc1
 buffer_load_dwordx4 a[120:123], v1, s[20:23], s44 offen offset:1024 sc1
 buffer_load_dwordx4 a[108:111], v1, s[20:23], s44 offen offset:2048 sc1
 buffer_load_dwordx4 a[124:127], v1, s[20:23], s44 offen offset:3072 sc1
 s_waitcnt vmcnt(40)
 s_barrier
 v_mov_b32 v2, v1
 ds_read_b128 a[128:131], v2 offset:0
 ds_read_b128 a[132:135], v2 offset:1024
 ds_read_b128 a[136:139], v2 offset:2048
 ds_read_b128 a[140:143], v2 offset:3072
 ds_read_b128 a[144:147], v2 offset:4096
 ds_read_b128 a[148:151], v2 offset:5120
 ds_read_b128 a[152:155], v2 offset:6144
 ds_read_b128 a[156:159], v2 offset:7168
 s_mov_b32 s39, 0
 s_add_u32 s39, s39, 0x4000
 s_and_b32 s39, s39, 0x1ffff
 v_mov_b32 v3, v2
 v_add_u32 v2, s39, v1
 s_mov_b32 s72, 0x8000000
Lablk_6:
 s_lshl_b32 s43, s33, 3
 s_add_u32 s41, s43, s4
 s_add_u32 s42, s43, 7
 s_sub_u32 s42, s42, s4
 s_mov_b32 s49, 0
 s_waitcnt lgkmcnt(0)
 v_mfma_f32_16x16x32_bf16 v[48:51], a[128:131], a[0:3], 0
 s_cmp_lt_u32 s49, s41
 v_mov_b64 v[176:177], 0
 v_mov_b64 v[178:179], 0
 v_mfma_f32_16x16x32_bf16 v[56:59], a[128:131], a[16:19], 0
 s_cselect_b64 s[68:69], -1, 0
 v_mov_b64 v[180:181], 0
 v_mov_b64 v[182:183], 0
 v_mfma_f32_16x16x32_bf16 v[64:67], a[128:131], a[32:35], 0
 v_mfma_f32_16x16x32_bf16 v[72:75], a[128:131], a[48:51], 0
 s_cmp_le_u32 s49, s41
 v_mov_b64 v[184:185], 0
 v_mov_b64 v[186:187], 0
 v_mfma_f32_16x16x32_bf16 v[48:51], a[136:139], a[4:7], v[48:51]
 v_mfma_f32_16x16x32_bf16 v[56:59], a[136:139], a[20:23], v[56:59]
 s_cselect_b64 s[70:71], -1, 0
 v_mov_b64 v[188:189], 0
 v_mov_b64 v[190:191], 0
 v_mfma_f32_16x16x32_bf16 v[64:67], a[136:139], a[36:39], v[64:67]
 v_mfma_f32_16x16x32_bf16 v[72:75], a[136:139], a[52:55], v[72:75]
 s_cmp_eq_u32 s49, s41
 v_mov_b64 v[192:193], 0
 v_mov_b64 v[194:195], 0
 v_mfma_f32_16x16x32_bf16 v[48:51], a[144:147], a[8:11], v[48:51]
 s_cselect_b64 s[60:61], s[52:53], s[68:69]
 v_mfma_f32_16x16x32_bf16 v[56:59], a[144:147], a[24:27], v[56:59]
 v_mov_b64 v[196:197], 0
 v_mov_b64 v[198:199], 0
 v_mfma_f32_16x16x32_bf16 v[64:67], a[144:147], a[40:43], v[64:67]
 s_cselect_b64 s[62:63], s[54:55], s[68:69]
 v_mfma_f32_16x16x32_bf16 v[72:75], a[144:147], a[56:59], v[72:75]
 v_mov_b64 v[200:201], 0
 v_mov_b64 v[202:203], 0
 v_mfma_f32_16x16x32_bf16 v[48:51], a[152:155], a[12:15], v[48:51]
 s_cselect_b64 s[64:65], s[56:57], s[68:69]
 v_mfma_f32_16x16x32_bf16 v[56:59], a[152:155], a[28:31], v[56:59]
 v_mov_b64 v[204:205], 0
 v_mov_b64 v[206:207], 0
 v_mfma_f32_16x16x32_bf16 v[64:67], a[152:155], a[44:47], v[64:67]
 s_cselect_b64 s[66:67], s[58:59], s[68:69]
 v_mfma_f32_16x16x32_bf16 v[72:75], a[152:155], a[60:63], v[72:75]
 s_nop 4
 v_max3_f32 v12, v48, v49, v50
 v_max3_f32 v13, v56, v57, v58
 v_max3_f32 v14, v64, v65, v66
 v_max3_f32 v15, v72, v73, v74
 v_max_f32 v12, v12, v51
 v_max_f32 v13, v13, v59
 v_max_f32 v14, v14, v67
 v_max_f32 v15, v15, v75
 v_mov_b32 v6, v12
 v_mov_b32 v7, v13
 v_mov_b32 v8, v14
 v_mov_b32 v9, v15
 v_permlane16_swap_b32 v12, v6
 v_permlane16_swap_b32 v13, v7
 v_permlane16_swap_b32 v14, v8
 v_permlane16_swap_b32 v15, v9
 v_max_f32 v12, v12, v6
 v_max_f32 v13, v13, v7
 v_max_f32 v14, v14, v8
 v_max_f32 v15, v15, v9
 v_mov_b32 v6, v12
 v_mov_b32 v7, v13
 v_mov_b32 v8, v14
 v_mov_b32 v9, v15
 v_permlane32_swap_b32 v12, v6
 v_permlane32_swap_b32 v13, v7
 v_permlane32_swap_b32 v14, v8
 v_permlane32_swap_b32 v15, v9
 v_max_f32 v12, v12, v6
 v_max_f32 v13, v13, v7
 v_max_f32 v14, v14, v8
 v_max_f32 v15, v15, v9
 v_sub_f32 v12, 0, v12
 v_sub_f32 v13, 0, v13
 v_sub_f32 v14, 0, v14
 v_sub_f32 v15, 0, v15
 v_cndmask_b32 v80, v4, v12, s[60:61]
 v_cndmask_b32 v81, v4, v12, s[62:63]
 v_cndmask_b32 v82, v4, v12, s[64:65]
 v_cndmask_b32 v83, v4, v12, s[66:67]
 v_cndmask_b32 v84, v4, v12, s[68:69]
 v_cndmask_b32 v85, v4, v12, s[68:69]
 v_cndmask_b32 v86, v4, v12, s[68:69]
 v_cndmask_b32 v87, v4, v12, s[68:69]
 v_cndmask_b32 v88, v4, v13, s[70:71]
 v_cndmask_b32 v89, v4, v13, s[70:71]
 v_cndmask_b32 v90, v4, v13, s[70:71]
 v_cndmask_b32 v91, v4, v13, s[70:71]
 v_cndmask_b32 v92, v4, v13, s[60:61]
 v_cndmask_b32 v93, v4, v13, s[62:63]
 v_cndmask_b32 v94, v4, v13, s[64:65]
 v_cndmask_b32 v95, v4, v13, s[66:67]
 v_mov_b32 v96, v14
 v_mov_b32 v97, v14
 v_mov_b32 v98, v14
 v_mov_b32 v99, v14
 v_mov_b32 v100, v14
 v_mov_b32 v101, v14
 v_mov_b32 v102, v14
 v_mov_b32 v103, v14
 v_mov_b32 v104, v15
 v_mov_b32 v105, v15
 v_mov_b32 v106, v15
 v_mov_b32 v107, v15
 v_mov_b32 v108, v15
 v_mov_b32 v109, v15
 v_mov_b32 v110, v15
 v_mov_b32 v111, v15
 v_mov_b32 v6, 1
 s_waitcnt lgkmcnt(0)
 v_mfma_f32_16x16x32_bf16 v[48:51], a[128:131], a[0:3], v[80:83]
 ds_read_b128 a[160:163], v3 offset:8192
 v_mov_b64 v[208:209], 0
 v_mov_b64 v[210:211], 0
 v_mfma_f32_16x16x32_bf16 v[56:59], a[128:131], a[16:19], v[88:91]
 v_mov_b64 v[212:213], 0
 v_mov_b64 v[214:215], 0
 v_mfma_f32_16x16x32_bf16 v[52:55], a[132:135], a[0:3], v[84:87]
 ds_read_b128 a[164:167], v3 offset:9216
 v_mfma_f32_16x16x32_bf16 v[60:63], a[132:135], a[16:19], v[92:95]
 v_mov_b64 v[216:217], 0
 v_mov_b64 v[218:219], 0
 v_mfma_f32_16x16x32_bf16 v[48:51], a[136:139], a[4:7], v[48:51]
 ds_read_b128 a[168:171], v3 offset:10240
 v_mov_b64 v[220:221], 0
 v_mov_b64 v[222:223], 0
 v_mfma_f32_16x16x32_bf16 v[56:59], a[136:139], a[20:23], v[56:59]
 v_mfma_f32_16x16x32_bf16 v[52:55], a[140:143], a[4:7], v[52:55]
 ds_read_b128 a[172:175], v3 offset:11264
 v_mov_b64 v[224:225], 0
 v_mov_b64 v[226:227], 0
 v_mfma_f32_16x16x32_bf16 v[60:63], a[140:143], a[20:23], v[60:63]
 v_mov_b64 v[228:229], 0
 v_mov_b64 v[230:231], 0
 v_mfma_f32_16x16x32_bf16 v[48:51], a[144:147], a[8:11], v[48:51]
 ds_read_b128 a[176:179], v3 offset:12288
 v_mfma_f32_16x16x32_bf16 v[56:59], a[144:147], a[24:27], v[56:59]
 v_mov_b64 v[232:233], 0
 v_mov_b64 v[234:235], 0
 v_mfma_f32_16x16x32_bf16 v[52:55], a[148:151], a[8:11], v[52:55]
 ds_read_b128 a[180:183], v3 offset:13312
 v_mov_b64 v[236:237], 0
 v_mov_b64 v[238:239], 0
 v_mfma_f32_16x16x32_bf16 v[60:63], a[148:151], a[24:27], v[60:63]
 v_mfma_f32_16x16x32_bf16 v[48:51], a[152:155], a[12:15], v[48:51]
 ds_read_b128 a[184:187], v3 offset:14336
 v_mov_b64 v[40:41], 0
 v_mov_b64 v[42:43], 0
 v_mfma_f32_16x16x32_bf16 v[56:59], a[152:155], a[28:31], v[56:59]
 v_mov_b64 v[44:45], 0
 v_mov_b64 v[46:47], 0
 v_mfma_f32_16x16x32_bf16 v[52:55], a[156:159], a[12:15], v[52:55]
 ds_read_b128 a[188:191], v3 offset:15360
 v_mfma_f32_16x16x32_bf16 v[60:63], a[156:159], a[28:31], v[60:63]
 v_mfma_f32_16x16x32_bf16 v[64:67], a[128:131], a[32:35], v[96:99]
 s_waitcnt vmcnt(0)
 s_barrier
 buffer_store_dword v6, v5, s[20:23], s72 offen sc1
 v_mfma_f32_16x16x32_bf16 v[72:75], a[128:131], a[48:51], v[104:107]
 ds_read_b128 a[128:131], v2 offset:0
 v_mfma_f32_16x16x32_bf16 v[68:71], a[132:135], a[32:35], v[100:103]
 s_add_u32 s49, s49, 1
 v_mfma_f32_16x16x32_bf16 v[76:79], a[132:135], a[48:51], v[108:111]
 ds_read_b128 a[132:135], v2 offset:1024
 v_exp_f32 v48, v48
 v_exp_f32 v49, v49
 v_mfma_f32_16x16x32_bf16 v[64:67], a[136:139], a[36:39], v[64:67]
 s_cmp_lt_u32 s49, s41
 v_exp_f32 v52, v52
 v_exp_f32 v53, v53
 v_mfma_f32_16x16x32_bf16 v[72:75], a[136:139], a[52:55], v[72:75]
 ds_read_b128 a[136:139], v2 offset:2048
 v_exp_f32 v50, v50
 v_mfma_f32_16x16x32_bf16 v[68:71], a[140:143], a[36:39], v[68:71]
 s_cselect_b64 s[68:69], -1, 0
 v_cvt_pk_bf16_f32 v16, v48, v49
 v_cvt_pk_bf16_f32 v17, v52, v53
 v_exp_f32 v51, v51
 v_mfma_f32_16x16x32_bf16 v[76:79], a[140:143], a[52:55], v[76:79]
 ds_read_b128 a[140:143], v2 offset:3072
 v_exp_f32 v54, v54
 v_exp_f32 v55, v55
 v_mfma_f32_16x16x32_bf16 v[64:67], a[144:147], a[40:43], v[64:67]
 v_cvt_pk_bf16_f32 v18, v50, v51
 v_cvt_pk_bf16_f32 v19, v54, v55
 v_mfma_f32_16x16x32_bf16 v[72:75], a[144:147], a[56:59], v[72:75]
 ds_read_b128 a[144:147], v2 offset:4096
 v_exp_f32 v56, v56
 v_exp_f32 v57, v57
 v_mfma_f32_16x16x32_bf16 v[68:71], a[148:151], a[40:43], v[68:71]
 s_cmp_le_u32 s49, s41
 v_exp_f32 v60, v60
 v_exp_f32 v61, v61
 v_mfma_f32_16x16x32_bf16 v[76:79], a[148:151], a[56:59], v[76:79]
 ds_read_b128 a[148:151], v2 offset:5120
 v_exp_f32 v58, v58
 v_mfma_f32_16x16x32_bf16 v[64:67], a[152:155], a[44:47], v[64:67]
 s_cselect_b64 s[70:71], -1, 0
 v_cvt_pk_bf16_f32 v20, v56, v57
 v_cvt_pk_bf16_f32 v21, v60, v61
 v_exp_f32 v59, v59
 v_mfma_f32_16x16x32_bf16 v[72:75], a[152:155], a[60:63], v[72:75]
 ds_read_b128 a[152:155], v2 offset:6144
 v_exp_f32 v62, v62
 v_exp_f32 v63, v63
 v_mfma_f32_16x16x32_bf16 v[68:71], a[156:159], a[44:47], v[68:71]
 v_cvt_pk_bf16_f32 v22, v58, v59
 v_cvt_pk_bf16_f32 v23, v62, v63
 v_mfma_f32_16x16x32_bf16 v[76:79], a[156:159], a[60:63], v[76:79]
 ds_read_b128 a[156:159], v2 offset:7168
 s_waitcnt lgkmcnt(8)
 v_mfma_f32_16x16x32_bf16 v[112:115], a[160:163], v[16:19], 0
 s_add_u32 s39, s39, 0x4000
 s_and_b32 s39, s39, 0x1ffff
 v_mfma_f32_16x16x32_bf16 v[144:147], a[160:163], v[20:23], 0
 s_cmp_eq_u32 s49, s41
 v_mfma_f32_16x16x32_bf16 v[116:119], a[164:167], v[16:19], 0
 s_cselect_b64 s[60:61], s[52:53], s[68:69]
 v_mfma_f32_16x16x32_bf16 v[148:151], a[164:167], v[20:23], 0
 s_cselect_b64 s[62:63], s[54:55], s[68:69]
 v_mov_b32 v3, v2
 v_add_u32 v2, s39, v1
 v_exp_f32 v64, v64
 v_mfma_f32_16x16x32_bf16 v[120:123], a[168:171], v[16:19], 0
 s_cselect_b64 s[64:65], s[56:57], s[68:69]
 v_exp_f32 v65, v65
 v_mfma_f32_16x16x32_bf16 v[152:155], a[168:171], v[20:23], 0
 s_cselect_b64 s[66:67], s[58:59], s[68:69]
 v_exp_f32 v68, v68
 v_mfma_f32_16x16x32_bf16 v[124:127], a[172:175], v[16:19], 0
 s_lshl_b32 s37, s35, 19
 v_exp_f32 v69, v69
 v_exp_f32 v66, v66
 v_mfma_f32_16x16x32_bf16 v[156:159], a[172:175], v[20:23], 0
 s_add_u32 m0, s38, s50
 v_cvt_pk_bf16_f32 v24, v64, v65
 v_cvt_pk_bf16_f32 v25, v68, v69
 v_mfma_f32_16x16x32_bf16 v[128:131], a[176:179], v[16:19], 0
 s_add_u32 s37, s37, s45
 v_exp_f32 v67, v67
 v_mfma_f32_16x16x32_bf16 v[160:163], a[176:179], v[20:23], 0
 buffer_load_dwordx4 v1, s[20:23], s37 offen offset:0 sc1 lds
 buffer_load_dwordx4 v1, s[20:23], s37 offen offset:1024 sc1 lds
 v_exp_f32 v70, v70
 v_mfma_f32_16x16x32_bf16 v[132:135], a[180:183], v[16:19], 0
 buffer_load_dwordx4 v1, s[20:23], s37 offen offset:2048 sc1 lds
 v_exp_f32 v71, v71
 v_cvt_pk_bf16_f32 v26, v66, v67
 v_cvt_pk_bf16_f32 v27, v70, v71
 v_mfma_f32_16x16x32_bf16 v[164:167], a[180:183], v[20:23], 0
 buffer_load_dwordx4 v1, s[20:23], s37 offen offset:3072 sc1 lds
 v_cndmask_b32 v80, v4, v12, s[60:61]
 v_cndmask_b32 v81, v4, v12, s[62:63]
 v_mfma_f32_16x16x32_bf16 v[136:139], a[184:187], v[16:19], 0
 s_add_u32 s38, s38, 0x4000
 v_cndmask_b32 v82, v4, v12, s[64:65]
 v_cndmask_b32 v83, v4, v12, s[66:67]
 v_mfma_f32_16x16x32_bf16 v[168:171], a[184:187], v[20:23], 0
 s_and_b32 s38, s38, 0x1ffff
 v_cndmask_b32 v84, v4, v12, s[68:69]
 v_cndmask_b32 v85, v4, v12, s[68:69]
 v_mfma_f32_16x16x32_bf16 v[140:143], a[188:191], v[16:19], 0
 s_add_u32 s35, s35, 1
 v_cndmask_b32 v86, v4, v12, s[68:69]
 v_cndmask_b32 v87, v4, v12, s[68:69]
 v_cndmask_b32 v88, v4, v13, s[70:71]
 v_cndmask_b32 v89, v4, v13, s[70:71]
 v_mfma_f32_16x16x32_bf16 v[172:175], a[188:191], v[20:23], 0
 s_cmp_eq_u32 s35, s36
 v_cndmask_b32 v90, v4, v13, s[70:71]
 v_cndmask_b32 v91, v4, v13, s[70:71]
 v_mfma_f32_16x16x32_bf16 v[32:35], a[192:195], v[16:19], 0
 s_cselect_b32 s36, s47, s36
 v_cndmask_b32 v92, v4, v13, s[60:61]
 v_cndmask_b32 v93, v4, v13, s[62:63]
 v_mfma_f32_16x16x32_bf16 v[36:39], a[192:195], v[20:23], 0
 s_cselect_b32 s35, 0, s35
 v_cndmask_b32 v94, v4, v13, s[64:65]
 v_cndmask_b32 v95, v4, v13, s[66:67]
 s_cmp_eq_u32 s43, 0
 s_cbranch_scc1 Lamk_11
 s_sub_u32 s40, s43, 1
 .p2align 3
Lapl_10:
 s_waitcnt lgkmcnt(0)
 v_mfma_f32_16x16x32_bf16 v[48:51], a[128:131], a[0:3], v[80:83]
 v_exp_f32 v72, v72
 v_mfma_f32_16x16x32_bf16 v[56:59], a[128:131], a[16:19], v[88:91]
 v_exp_f32 v73, v73
 v_mfma_f32_16x16x32_bf16 v[52:55], a[132:135], a[0:3], v[84:87]
 v_mfma_f32_16x16x32_bf16 v[60:63], a[132:135], a[16:19], v[92:95]
 v_exp_f32 v76, v76
 v_mfma_f32_16x16x32_bf16 v[48:51], a[136:139], a[4:7], v[48:51]
 v_exp_f32 v77, v77
 v_mfma_f32_16x16x32_bf16 v[56:59], a[136:139], a[20:23], v[56:59]
 v_mfma_f32_16x16x32_bf16 v[52:55], a[140:143], a[4:7], v[52:55]
 v_exp_f32 v74, v74
 v_mfma_f32_16x16x32_bf16 v[60:63], a[140:143], a[20:23], v[60:63]
 v_cvt_pk_bf16_f32 v28, v72, v73
 v_cvt_pk_bf16_f32 v29, v76, v77
 v_mfma_f32_16x16x32_bf16 v[48:51], a[144:147], a[8:11], v[48:51]
 v_mfma_f32_16x16x32_bf16 v[56:59], a[144:147], a[24:27], v[56:59]
 v_exp_f32 v75, v75
 v_mfma_f32_16x16x32_bf16 v[52:55], a[148:151], a[8:11], v[52:55]
 v_exp_f32 v78, v78
 v_mfma_f32_16x16x32_bf16 v[60:63], a[148:151], a[24:27], v[60:63]
 v_mfma_f32_16x16x32_bf16 v[48:51], a[152:155], a[12:15], v[48:51]
 v_exp_f32 v79, v79
 v_mfma_f32_16x16x32_bf16 v[56:59], a[152:155], a[28:31], v[56:59]
 v_cvt_pk_bf16_f32 v30, v74, v75
 v_cvt_pk_bf16_f32 v31, v78, v79
 v_mfma_f32_16x16x32_bf16 v[52:55], a[156:159], a[12:15], v[52:55]
 v_mfma_f32_16x16x32_bf16 v[60:63], a[156:159], a[28:31], v[60:63]
 v_mfma_f32_16x16x32_bf16 v[176:179], a[160:163], v[24:27], v[176:179]
 v_mfma_f32_16x16x32_bf16 v[208:211], a[160:163], v[28:31], v[208:211]
 ds_read_b128 a[160:163], v3 offset:8192
 v_mfma_f32_16x16x32_bf16 v[180:183], a[164:167], v[24:27], v[180:183]
 v_mfma_f32_16x16x32_bf16 v[212:215], a[164:167], v[28:31], v[212:215]
 ds_read_b128 a[164:167], v3 offset:9216
 v_exp_f32 v48, v48
 v_mfma_f32_16x16x32_bf16 v[184:187], a[168:171], v[24:27], v[184:187]
 v_exp_f32 v49, v49
 v_mfma_f32_16x16x32_bf16 v[216:219], a[168:171], v[28:31], v[216:219]
 ds_read_b128 a[168:171], v3 offset:10240
 v_exp_f32 v52, v52
 v_mfma_f32_16x16x32_bf16 v[188:191], a[172:175], v[24:27], v[188:191]
 v_mfma_f32_16x16x32_bf16 v[220:223], a[172:175], v[28:31], v[220:223]
 ds_read_b128 a[172:175], v3 offset:11264
 v_exp_f32 v53, v53
 v_mfma_f32_16x16x32_bf16 v[192:195], a[176:179], v[24:27], v[192:195]
 v_exp_f32 v50, v50
 v_mfma_f32_16x16x32_bf16 v[224:227], a[176:179], v[28:31], v[224:227]
 ds_read_b128 a[176:179], v3 offset:12288
 v_mfma_f32_16x16x32_bf16 v[196:199], a[180:183], v[24:27], v[196:199]
 v_cvt_pk_bf16_f32 v16, v48, v49
 v_cvt_pk_bf16_f32 v17, v52, v53
 v_mfma_f32_16x16x32_bf16 v[228:231], a[180:183], v[28:31], v[228:231]
 ds_read_b128 a[180:183], v3 offset:13312
 v_exp_f32 v51, v51
 v_mfma_f32_16x16x32_bf16 v[200:203], a[184:187], v[24:27], v[200:203]
 v_exp_f32 v54, v54
 v_mfma_f32_16x16x32_bf16 v[232:235], a[184:187], v[28:31], v[232:235]
 ds_read_b128 a[184:187], v3 offset:14336
 v_mfma_f32_16x16x32_bf16 v[204:207], a[188:191], v[24:27], v[204:207]
 v_exp_f32 v55, v55
 v_mfma_f32_16x16x32_bf16 v[236:239], a[188:191], v[28:31], v[236:239]
 ds_read_b128 a[188:191], v3 offset:15360
 v_cvt_pk_bf16_f32 v18, v50, v51
 v_cvt_pk_bf16_f32 v19, v54, v55
 v_mfma_f32_16x16x32_bf16 v[40:43], a[192:195], v[24:27], v[40:43]
 v_mfma_f32_16x16x32_bf16 v[44:47], a[192:195], v[28:31], v[44:47]
 v_mfma_f32_16x16x32_bf16 v[64:67], a[128:131], a[32:35], v[96:99]
 s_waitcnt vmcnt(20)
 s_barrier
 v_exp_f32 v56, v56
 v_mfma_f32_16x16x32_bf16 v[72:75], a[128:131], a[48:51], v[104:107]
 ds_read_b128 a[128:131], v2 offset:0
 v_exp_f32 v57, v57
 v_mfma_f32_16x16x32_bf16 v[68:71], a[132:135], a[32:35], v[100:103]
 s_add_u32 s39, s39, 0x4000
 v_mfma_f32_16x16x32_bf16 v[76:79], a[132:135], a[48:51], v[108:111]
 ds_read_b128 a[132:135], v2 offset:1024
 v_exp_f32 v60, v60
 v_mfma_f32_16x16x32_bf16 v[64:67], a[136:139], a[36:39], v[64:67]
 v_exp_f32 v61, v61
 v_mfma_f32_16x16x32_bf16 v[72:75], a[136:139], a[52:55], v[72:75]
 ds_read_b128 a[136:139], v2 offset:2048
 v_mfma_f32_16x16x32_bf16 v[68:71], a[140:143], a[36:39], v[68:71]
 v_exp_f32 v58, v58
 v_mfma_f32_16x16x32_bf16 v[76:79], a[140:143], a[52:55], v[76:79]
 ds_read_b128 a[140:143], v2 offset:3072
 v_cvt_pk_bf16_f32 v20, v56, v57
 v_cvt_pk_bf16_f32 v21, v60, v61
 v_mfma_f32_16x16x32_bf16 v[64:67], a[144:147], a[40:43], v[64:67]
 s_and_b32 s39, s39, 0x1ffff
 v_mfma_f32_16x16x32_bf16 v[72:75], a[144:147], a[56:59], v[72:75]
 ds_read_b128 a[144:147], v2 offset:4096
 v_exp_f32 v59, v59
 v_mfma_f32_16x16x32_bf16 v[68:71], a[148:151], a[40:43], v[68:71]
 v_exp_f32 v62, v62
 v_mfma_f32_16x16x32_bf16 v[76:79], a[148:151], a[56:59], v[76:79]
 ds_read_b128 a[148:151], v2 offset:5120
 v_mfma_f32_16x16x32_bf16 v[64:67], a[152:155], a[44:47], v[64:67]
 v_exp_f32 v63, v63
 v_mfma_f32_16x16x32_bf16 v[72:75], a[152:155], a[60:63], v[72:75]
 ds_read_b128 a[152:155], v2 offset:6144
 v_cvt_pk_bf16_f32 v22, v58, v59
 v_cvt_pk_bf16_f32 v23, v62, v63
 v_mfma_f32_16x16x32_bf16 v[68:71], a[156:159], a[44:47], v[68:71]
 v_mfma_f32_16x16x32_bf16 v[76:79], a[156:159], a[60:63], v[76:79]
 ds_read_b128 a[156:159], v2 offset:7168
 s_waitcnt lgkmcnt(8)
 v_mfma_f32_16x16x32_bf16 v[112:115], a[160:163], v[16:19], v[112:115]
 s_lshl_b32 s37, s35, 19
 v_mov_b32 v3, v2
 v_add_u32 v2, s39, v1
 v_mfma_f32_16x16x32_bf16 v[144:147], a[160:163], v[20:23], v[144:147]
 s_add_u32 m0, s38, s50
 v_mfma_f32_16x16x32_bf16 v[116:119], a[164:167], v[16:19], v[116:119]
 s_add_u32 s37, s37, s45
 v_mfma_f32_16x16x32_bf16 v[148:151], a[164:167], v[20:23], v[148:151]
 buffer_load_dwordx4 v1, s[20:23], s37 offen offset:0 sc1 lds
 v_exp_f32 v64, v64
 v_mfma_f32_16x16x32_bf16 v[120:123], a[168:171], v[16:19], v[120:123]
 buffer_load_dwordx4 v1, s[20:23], s37 offen offset:1024 sc1 lds
 v_mfma_f32_16x16x32_bf16 v[152:155], a[168:171], v[20:23], v[152:155]
 v_exp_f32 v65, v65
 v_mfma_f32_16x16x32_bf16 v[124:127], a[172:175], v[16:19], v[124:127]
 buffer_load_dwordx4 v1, s[20:23], s37 offen offset:2048 sc1 lds
 v_exp_f32 v68, v68
 v_mfma_f32_16x16x32_bf16 v[156:159], a[172:175], v[20:23], v[156:159]
 buffer_load_dwordx4 v1, s[20:23], s37 offen offset:3072 sc1 lds
 v_exp_f32 v69, v69
 v_mfma_f32_16x16x32_bf16 v[128:131], a[176:179], v[16:19], v[128:131]
 s_add_u32 s38, s38, 0x4000
 v_mfma_f32_16x16x32_bf16 v[160:163], a[176:179], v[20:23], v[160:163]
 s_and_b32 s38, s38, 0x1ffff
 v_exp_f32 v66, v66
 v_mfma_f32_16x16x32_bf16 v[132:135], a[180:183], v[16:19], v[132:135]
 s_add_u32 s35, s35, 1
 v_cvt_pk_bf16_f32 v24, v64, v65
 v_cvt_pk_bf16_f32 v25, v68, v69
 v_mfma_f32_16x16x32_bf16 v[164:167], a[180:183], v[20:23], v[164:167]
 v_exp_f32 v67, v67
 v_mfma_f32_16x16x32_bf16 v[136:139], a[184:187], v[16:19], v[136:139]
 s_cmp_eq_u32 s35, s36
 v_mfma_f32_16x16x32_bf16 v[168:171], a[184:187], v[20:23], v[168:171]
 s_cselect_b32 s36, s47, s36
 v_exp_f32 v70, v70
 v_mfma_f32_16x16x32_bf16 v[140:143], a[188:191], v[16:19], v[140:143]
 s_cselect_b32 s35, 0, s35
 v_exp_f32 v71, v71
 v_mfma_f32_16x16x32_bf16 v[172:175], a[188:191], v[20:23], v[172:175]
 s_add_u32 s49, s49, 1
 v_cvt_pk_bf16_f32 v26, v66, v67
 v_cvt_pk_bf16_f32 v27, v70, v71
 v_mfma_f32_16x16x32_bf16 v[32:35], a[192:195], v[16:19], v[32:35]
 s_cmp_lt_u32 s49, s40
 v_mfma_f32_16x16x32_bf16 v[36:39], a[192:195], v[20:23], v[36:39]
 s_cbranch_scc1 Lapl_10
Lamk_11:
 s_add_u32 s40, s43, 4
 .p2align 3
Lamk_13:
 s_waitcnt lgkmcnt(0)
 v_mfma_f32_16x16x32_bf16 v[48:51], a[128:131], a[0:3], v[80:83]
 s_add_u32 s49, s49, 1
 v_exp_f32 v72, v72
 v_mfma_f32_16x16x32_bf16 v[56:59], a[128:131], a[16:19], v[88:91]
 s_cmp_lt_u32 s49, s41
 v_exp_f32 v73, v73
 v_mfma_f32_16x16x32_bf16 v[52:55], a[132:135], a[0:3], v[84:87]
 v_mfma_f32_16x16x32_bf16 v[60:63], a[132:135], a[16:19], v[92:95]
 s_cselect_b64 s[68:69], -1, 0
 v_exp_f32 v76, v76
 v_mfma_f32_16x16x32_bf16 v[48:51], a[136:139], a[4:7], v[48:51]
 s_cmp_le_u32 s49, s41
 v_exp_f32 v77, v77
 v_mfma_f32_16x16x32_bf16 v[56:59], a[136:139], a[20:23], v[56:59]
 v_mfma_f32_16x16x32_bf16 v[52:55], a[140:143], a[4:7], v[52:55]
 s_cselect_b64 s[70:71], -1, 0
 v_exp_f32 v74, v74
 v_mfma_f32_16x16x32_bf16 v[60:63], a[140:143], a[20:23], v[60:63]
 v_cvt_pk_bf16_f32 v28, v72, v73
 v_cvt_pk_bf16_f32 v29, v76, v77
 v_mfma_f32_16x16x32_bf16 v[48:51], a[144:147], a[8:11], v[48:51]
 s_cmp_eq_u32 s49, s41
 v_mfma_f32_16x16x32_bf16 v[56:59], a[144:147], a[24:27], v[56:59]
 s_cselect_b64 s[60:61], s[52:53], s[68:69]
 v_exp_f32 v75, v75
 v_mfma_f32_16x16x32_bf16 v[52:55], a[148:151], a[8:11], v[52:55]
 v_exp_f32 v78, v78
 v_mfma_f32_16x16x32_bf16 v[60:63], a[148:151], a[24:27], v[60:63]
 s_cselect_b64 s[62:63], s[54:55], s[68:69]
 v_mfma_f32_16x16x32_bf16 v[48:51], a[152:155], a[12:15], v[48:51]
 s_cselect_b64 s[64:65], s[56:57], s[68:69]
 v_exp_f32 v79, v79
 v_mfma_f32_16x16x32_bf16 v[56:59], a[152:155], a[28:31], v[56:59]
 v_cvt_pk_bf16_f32 v30, v74, v75
 v_cvt_pk_bf16_f32 v31, v78, v79
 v_mfma_f32_16x16x32_bf16 v[52:55], a[156:159], a[12:15], v[52:55]
 s_cselect_b64 s[66:67], s[58:59], s[68:69]
 v_mfma_f32_16x16x32_bf16 v[60:63], a[156:159], a[28:31], v[60:63]
 v_mfma_f32_16x16x32_bf16 v[176:179], a[160:163], v[24:27], v[176:179]
 v_mfma_f32_16x16x32_bf16 v[208:211], a[160:163], v[28:31], v[208:211]
 ds_read_b128 a[160:163], v3 offset:8192
 v_mfma_f32_16x16x32_bf16 v[180:183], a[164:167], v[24:27], v[180:183]
 v_mfma_f32_16x16x32_bf16 v[212:215], a[164:167], v[28:31], v[212:215]
 ds_read_b128 a[164:167], v3 offset:9216
 v_exp_f32 v48, v48
 v_mfma_f32_16x16x32_bf16 v[184:187], a[168:171], v[24:27], v[184:187]
 v_exp_f32 v49, v49
 v_mfma_f32_16x16x32_bf16 v[216:219], a[168:171], v[28:31], v[216:219]
 ds_read_b128 a[168:171], v3 offset:10240
 v_exp_f32 v52, v52
 v_mfma_f32_16x16x32_bf16 v[188:191], a[172:175], v[24:27], v[188:191]
 v_exp_f32 v53, v53
 v_mfma_f32_16x16x32_bf16 v[220:223], a[172:175], v[28:31], v[220:223]
 ds_read_b128 a[172:175], v3 offset:11264
 v_exp_f32 v50, v50
 v_mfma_f32_16x16x32_bf16 v[192:195], a[176:179], v[24:27], v[192:195]
 v_cvt_pk_bf16_f32 v16, v48, v49
 v_cvt_pk_bf16_f32 v17, v52, v53
 v_mfma_f32_16x16x32_bf16 v[224:227], a[176:179], v[28:31], v[224:227]
 ds_read_b128 a[176:179], v3 offset:12288
 v_exp_f32 v51, v51
 v_mfma_f32_16x16x32_bf16 v[196:199], a[180:183], v[24:27], v[196:199]
 v_exp_f32 v54, v54
 v_mfma_f32_16x16x32_bf16 v[228:231], a[180:183], v[28:31], v[228:231]
 ds_read_b128 a[180:183], v3 offset:13312
 v_exp_f32 v55, v55
 v_mfma_f32_16x16x32_bf16 v[200:203], a[184:187], v[24:27], v[200:203]
 v_cvt_pk_bf16_f32 v18, v50, v51
 v_cvt_pk_bf16_f32 v19, v54, v55
 v_mfma_f32_16x16x32_bf16 v[232:235], a[184:187], v[28:31], v[232:235]
 ds_read_b128 a[184:187], v3 offset:14336
 v_cndmask_b32 v80, v4, v12, s[60:61]
 v_cndmask_b32 v81, v4, v12, s[62:63]
 v_mfma_f32_16x16x32_bf16 v[204:207], a[188:191], v[24:27], v[204:207]
 v_cndmask_b32 v82, v4, v12, s[64:65]
 v_cndmask_b32 v83, v4, v12, s[66:67]
 v_mfma_f32_16x16x32_bf16 v[236:239], a[188:191], v[28:31], v[236:239]
 ds_read_b128 a[188:191], v3 offset:15360
 v_cndmask_b32 v84, v4, v12, s[68:69]
 v_cndmask_b32 v85, v4, v12, s[68:69]
 v_mfma_f32_16x16x32_bf16 v[40:43], a[192:195], v[24:27], v[40:43]
 v_cndmask_b32 v86, v4, v12, s[68:69]
 v_cndmask_b32 v87, v4, v12, s[68:69]
 v_mfma_f32_16x16x32_bf16 v[44:47], a[192:195], v[28:31], v[44:47]
 v_mfma_f32_16x16x32_bf16 v[64:67], a[128:131], a[32:35], v[96:99]
 s_waitcnt vmcnt(20)
 s_barrier
 v_exp_f32 v56, v56
 v_mfma_f32_16x16x32_bf16 v[72:75], a[128:131], a[48:51], v[104:107]
 ds_read_b128 a[128:131], v2 offset:0
 v_exp_f32 v57, v57
 v_mfma_f32_16x16x32_bf16 v[68:71], a[132:135], a[32:35], v[100:103]
 s_add_u32 s39, s39, 0x4000
 v_exp_f32 v60, v60
 v_mfma_f32_16x16x32_bf16 v[76:79], a[132:135], a[48:51], v[108:111]
 ds_read_b128 a[132:135], v2 offset:1024
 v_exp_f32 v61, v61
 v_mfma_f32_16x16x32_bf16 v[64:67], a[136:139], a[36:39], v[64:67]
 v_exp_f32 v58, v58
 v_mfma_f32_16x16x32_bf16 v[72:75], a[136:139], a[52:55], v[72:75]
 ds_read_b128 a[136:139], v2 offset:2048
 v_cvt_pk_bf16_f32 v20, v56, v57
 v_cvt_pk_bf16_f32 v21, v60, v61
 v_mfma_f32_16x16x32_bf16 v[68:71], a[140:143], a[36:39], v[68:71]
 v_exp_f32 v59, v59
 v_mfma_f32_16x16x32_bf16 v[76:79], a[140:143], a[52:55], v[76:79]
 ds_read_b128 a[140:143], v2 offset:3072
 v_exp_f32 v62, v62
 v_mfma_f32_16x16x32_bf16 v[64:67], a[144:147], a[40:43], v[64:67]
 s_and_b32 s39, s39, 0x1ffff
 v_exp_f32 v63, v63
 v_mfma_f32_16x16x32_bf16 v[72:75], a[144:147], a[56:59], v[72:75]
 ds_read_b128 a[144:147], v2 offset:4096
 v_cvt_pk_bf16_f32 v22, v58, v59
 v_cvt_pk_bf16_f32 v23, v62, v63
 v_mfma_f32_16x16x32_bf16 v[68:71], a[148:151], a[40:43], v[68:71]
 v_cndmask_b32 v88, v4, v13, s[70:71]
 v_cndmask_b32 v89, v4, v13, s[70:71]
 v_mfma_f32_16x16x32_bf16 v[76:79], a[148:151], a[56:59], v[76:79]
 ds_read_b128 a[148:151], v2 offset:5120
 v_cndmask_b32 v90, v4, v13, s[70:71]
 v_cndmask_b32 v91, v4, v13, s[70:71]
 v_mfma_f32_16x16x32_bf16 v[64:67], a[152:155], a[44:47], v[64:67]
 v_cndmask_b32 v92, v4, v13, s[60:61]
 v_cndmask_b32 v93, v4, v13, s[62:63]
 v_mfma_f32_16x16x32_bf16 v[72:75], a[152:155], a[60:63], v[72:75]
 ds_read_b128 a[152:155], v2 offset:6144
 v_cndmask_b32 v94, v4, v13, s[64:65]
 v_cndmask_b32 v95, v4, v13, s[66:67]
 v_mfma_f32_16x16x32_bf16 v[68:71], a[156:159], a[44:47], v[68:71]
 v_mfma_f32_16x16x32_bf16 v[76:79], a[156:159], a[60:63], v[76:79]
 ds_read_b128 a[156:159], v2 offset:7168
 s_waitcnt lgkmcnt(8)
 v_mfma_f32_16x16x32_bf16 v[112:115], a[160:163], v[16:19], v[112:115]
 s_lshl_b32 s37, s35, 19
 v_mov_b32 v3, v2
 v_add_u32 v2, s39, v1
 v_mfma_f32_16x16x32_bf16 v[144:147], a[160:163], v[20:23], v[144:147]
 s_add_u32 m0, s38, s50
 v_mfma_f32_16x16x32_bf16 v[116:119], a[164:167], v[16:19], v[116:119]
 s_add_u32 s37, s37, s45
 v_mfma_f32_16x16x32_bf16 v[148:151], a[164:167], v[20:23], v[148:151]
 buffer_load_dwordx4 v1, s[20:23], s37 offen offset:0 sc1 lds
 v_exp_f32 v64, v64
 v_mfma_f32_16x16x32_bf16 v[120:123], a[168:171], v[16:19], v[120:123]
 v_mfma_f32_16x16x32_bf16 v[152:155], a[168:171], v[20:23], v[152:155]
 buffer_load_dwordx4 v1, s[20:23], s37 offen offset:1024 sc1 lds
 v_exp_f32 v65, v65
 v_mfma_f32_16x16x32_bf16 v[124:127], a[172:175], v[16:19], v[124:127]
 buffer_load_dwordx4 v1, s[20:23], s37 offen offset:2048 sc1 lds
 v_exp_f32 v68, v68
 v_mfma_f32_16x16x32_bf16 v[156:159], a[172:175], v[20:23], v[156:159]
 buffer_load_dwordx4 v1, s[20:23], s37 offen offset:3072 sc1 lds
 v_exp_f32 v69, v69
 v_mfma_f32_16x16x32_bf16 v[128:131], a[176:179], v[16:19], v[128:131]
 v_mfma_f32_16x16x32_bf16 v[160:163], a[176:179], v[20:23], v[160:163]
 s_add_u32 s38, s38, 0x4000
 v_exp_f32 v66, v66
 v_mfma_f32_16x16x32_bf16 v[132:135], a[180:183], v[16:19], v[132:135]
 s_and_b32 s38, s38, 0x1ffff
 v_cvt_pk_bf16_f32 v24, v64, v65
 v_cvt_pk_bf16_f32 v25, v68, v69
 v_mfma_f32_16x16x32_bf16 v[164:167], a[180:183], v[20:23], v[164:167]
 s_add_u32 s35, s35, 1
 v_exp_f32 v67, v67
 v_mfma_f32_16x16x32_bf16 v[136:139], a[184:187], v[16:19], v[136:139]
 s_cmp_eq_u32 s35, s36
 v_mfma_f32_16x16x32_bf16 v[168:171], a[184:187], v[20:23], v[168:171]
 v_exp_f32 v70, v70
 v_mfma_f32_16x16x32_bf16 v[140:143], a[188:191], v[16:19], v[140:143]
 s_cselect_b32 s36, s47, s36
 v_exp_f32 v71, v71
 v_mfma_f32_16x16x32_bf16 v[172:175], a[188:191], v[20:23], v[172:175]
 s_cselect_b32 s35, 0, s35
 v_cvt_pk_bf16_f32 v26, v66, v67
 v_cvt_pk_bf16_f32 v27, v70, v71
 v_mfma_f32_16x16x32_bf16 v[32:35], a[192:195], v[16:19], v[32:35]
 s_cmp_lt_u32 s49, s40
 v_mfma_f32_16x16x32_bf16 v[36:39], a[192:195], v[20:23], v[36:39]
 s_cbranch_scc1 Lamk_13
 s_add_u32 s40, s43, 8
 s_cmp_lt_u32 s49, s42
 s_cselect_b64 s[68:69], -1, 0
 s_cmp_le_u32 s49, s42
 s_cselect_b64 s[70:71], -1, 0
 s_cmp_eq_u32 s49, s42
 s_cselect_b64 s[60:61], s[52:53], s[68:69]
 s_cselect_b64 s[62:63], s[54:55], s[68:69]
 s_cselect_b64 s[64:65], s[56:57], s[68:69]
 s_cselect_b64 s[66:67], s[58:59], s[68:69]
 v_mfma_f32_16x16x32_bf16 v[176:179], a[160:163], v[24:27], v[176:179]
 v_cndmask_b32 v96, v4, v14, s[60:61]
 v_cndmask_b32 v97, v4, v14, s[62:63]
 v_mfma_f32_16x16x32_bf16 v[180:183], a[164:167], v[24:27], v[180:183]
 v_cndmask_b32 v98, v4, v14, s[64:65]
 v_cndmask_b32 v99, v4, v14, s[66:67]
 v_mfma_f32_16x16x32_bf16 v[184:187], a[168:171], v[24:27], v[184:187]
 v_cndmask_b32 v100, v4, v14, s[68:69]
 v_cndmask_b32 v101, v4, v14, s[68:69]
 v_mfma_f32_16x16x32_bf16 v[188:191], a[172:175], v[24:27], v[188:191]
 v_exp_f32 v72, v72
 v_mfma_f32_16x16x32_bf16 v[192:195], a[176:179], v[24:27], v[192:195]
 v_exp_f32 v73, v73
 v_mfma_f32_16x16x32_bf16 v[196:199], a[180:183], v[24:27], v[196:199]
 v_exp_f32 v76, v76
 v_mfma_f32_16x16x32_bf16 v[200:203], a[184:187], v[24:27], v[200:203]
 v_exp_f32 v77, v77
 v_mfma_f32_16x16x32_bf16 v[204:207], a[188:191], v[24:27], v[204:207]
 v_exp_f32 v74, v74
 v_mfma_f32_16x16x32_bf16 v[40:43], a[192:195], v[24:27], v[40:43]
 v_cndmask_b32 v102, v4, v14, s[68:69]
 v_cndmask_b32 v103, v4, v14, s[68:69]
 s_nop 0
 .p2align 3
Lam1_12:
 s_waitcnt lgkmcnt(0)
 v_mfma_f32_16x16x32_bf16 v[64:67], a[128:131], a[32:35], v[96:99]
 v_cvt_pk_bf16_f32 v28, v72, v73
 v_cvt_pk_bf16_f32 v29, v76, v77
 v_mfma_f32_16x16x32_bf16 v[68:71], a[132:135], a[32:35], v[100:103]
 v_exp_f32 v75, v75
 v_mfma_f32_16x16x32_bf16 v[64:67], a[136:139], a[36:39], v[64:67]
 v_exp_f32 v78, v78
 v_mfma_f32_16x16x32_bf16 v[68:71], a[140:143], a[36:39], v[68:71]
 v_exp_f32 v79, v79
 v_mfma_f32_16x16x32_bf16 v[64:67], a[144:147], a[40:43], v[64:67]
 v_cvt_pk_bf16_f32 v30, v74, v75
 v_cvt_pk_bf16_f32 v31, v78, v79
 v_mfma_f32_16x16x32_bf16 v[68:71], a[148:151], a[40:43], v[68:71]
 v_cndmask_b32 v104, v4, v15, s[70:71]
 v_cndmask_b32 v105, v4, v15, s[70:71]
 v_mfma_f32_16x16x32_bf16 v[64:67], a[152:155], a[44:47], v[64:67]
 v_mfma_f32_16x16x32_bf16 v[68:71], a[156:159], a[44:47], v[68:71]
 v_mfma_f32_16x16x32_bf16 v[208:211], a[160:163], v[28:31], v[208:211]
 ds_read_b128 a[160:163], v3 offset:8192
 v_cndmask_b32 v106, v4, v15, s[70:71]
 v_cndmask_b32 v107, v4, v15, s[70:71]
 v_mfma_f32_16x16x32_bf16 v[212:215], a[164:167], v[28:31], v[212:215]
 ds_read_b128 a[164:167], v3 offset:9216
 v_cndmask_b32 v108, v4, v15, s[60:61]
 v_cndmask_b32 v109, v4, v15, s[62:63]
 v_mfma_f32_16x16x32_bf16 v[216:219], a[168:171], v[28:31], v[216:219]
 ds_read_b128 a[168:171], v3 offset:10240
 v_cndmask_b32 v110, v4, v15, s[64:65]
 v_cndmask_b32 v111, v4, v15, s[66:67]
 v_mfma_f32_16x16x32_bf16 v[220:223], a[172:175], v[28:31], v[220:223]
 ds_read_b128 a[172:175], v3 offset:11264
 v_exp_f32 v64, v64
 v_mfma_f32_16x16x32_bf16 v[224:227], a[176:179], v[28:31], v[224:227]
 ds_read_b128 a[176:179], v3 offset:12288
 v_exp_f32 v65, v65
 v_mfma_f32_16x16x32_bf16 v[228:231], a[180:183], v[28:31], v[228:231]
 ds_read_b128 a[180:183], v3 offset:13312
 v_exp_f32 v68, v68
 v_mfma_f32_16x16x32_bf16 v[232:235], a[184:187], v[28:31], v[232:235]
 ds_read_b128 a[184:187], v3 offset:14336
 v_exp_f32 v69, v69
 v_mfma_f32_16x16x32_bf16 v[236:239], a[188:191], v[28:31], v[236:239]
 ds_read_b128 a[188:191], v3 offset:15360
 v_exp_f32 v66, v66
 v_mfma_f32_16x16x32_bf16 v[44:47], a[192:195], v[28:31], v[44:47]
 v_mfma_f32_16x16x32_bf16 v[72:75], a[128:131], a[48:51], v[104:107]
 s_waitcnt vmcnt(20)
 s_barrier
 ds_read_b128 a[128:131], v2 offset:0
 s_add_u32 s39, s39, 0x4000
 v_cvt_pk_bf16_f32 v24, v64, v65
 v_cvt_pk_bf16_f32 v25, v68, v69
 v_mfma_f32_16x16x32_bf16 v[76:79], a[132:135], a[48:51], v[108:111]
 ds_read_b128 a[132:135], v2 offset:1024
 v_exp_f32 v67, v67
 v_mfma_f32_16x16x32_bf16 v[72:75], a[136:139], a[52:55], v[72:75]
 ds_read_b128 a[136:139], v2 offset:2048
 v_exp_f32 v70, v70
 v_mfma_f32_16x16x32_bf16 v[76:79], a[140:143], a[52:55], v[76:79]
 ds_read_b128 a[140:143], v2 offset:3072
 v_mfma_f32_16x16x32_bf16 v[72:75], a[144:147], a[56:59], v[72:75]
 ds_read_b128 a[144:147], v2 offset:4096
 s_and_b32 s39, s39, 0x1ffff
 v_exp_f32 v71, v71
 v_mfma_f32_16x16x32_bf16 v[76:79], a[148:151], a[56:59], v[76:79]
 ds_read_b128 a[148:151], v2 offset:5120
 v_cvt_pk_bf16_f32 v26, v66, v67
 v_cvt_pk_bf16_f32 v27, v70, v71
 v_mfma_f32_16x16x32_bf16 v[72:75], a[152:155], a[60:63], v[72:75]
 ds_read_b128 a[152:155], v2 offset:6144
 v_mfma_f32_16x16x32_bf16 v[76:79], a[156:159], a[60:63], v[76:79]
 ds_read_b128 a[156:159], v2 offset:7168
 s_waitcnt lgkmcnt(8)
 s_add_u32 s49, s49, 1
 s_cmp_lt_u32 s49, s42
 s_cselect_b64 s[68:69], -1, 0
 s_cmp_le_u32 s49, s42
 s_cselect_b64 s[70:71], -1, 0
 s_cmp_eq_u32 s49, s42
 s_cselect_b64 s[60:61], s[52:53], s[68:69]
 s_cselect_b64 s[62:63], s[54:55], s[68:69]
 s_cselect_b64 s[64:65], s[56:57], s[68:69]
 s_cselect_b64 s[66:67], s[58:59], s[68:69]
 v_mfma_f32_16x16x32_bf16 v[176:179], a[160:163], v[24:27], v[176:179]
 s_lshl_b32 s37, s35, 19
 s_add_u32 m0, s38, s50
 v_mov_b32 v3, v2
 v_add_u32 v2, s39, v1
 v_cndmask_b32 v96, v4, v14, s[60:61]
 v_cndmask_b32 v97, v4, v14, s[62:63]
 v_mfma_f32_16x16x32_bf16 v[180:183], a[164:167], v[24:27], v[180:183]
 s_add_u32 s37, s37, s45
 buffer_load_dwordx4 v1, s[20:23], s37 offen offset:0 sc1 lds
 v_cndmask_b32 v98, v4, v14, s[64:65]
 v_cndmask_b32 v99, v4, v14, s[66:67]
 v_mfma_f32_16x16x32_bf16 v[184:187], a[168:171], v[24:27], v[184:187]
 buffer_load_dwordx4 v1, s[20:23], s37 offen offset:1024 sc1 lds
 v_exp_f32 v72, v72
 v_mfma_f32_16x16x32_bf16 v[188:191], a[172:175], v[24:27], v[188:191]
 buffer_load_dwordx4 v1, s[20:23], s37 offen offset:2048 sc1 lds
 buffer_load_dwordx4 v1, s[20:23], s37 offen offset:3072 sc1 lds
 v_exp_f32 v73, v73
 v_mfma_f32_16x16x32_bf16 v[192:195], a[176:179], v[24:27], v[192:195]
 s_add_u32 s38, s38, 0x4000
 v_exp_f32 v76, v76
 v_mfma_f32_16x16x32_bf16 v[196:199], a[180:183], v[24:27], v[196:199]
 s_and_b32 s38, s38, 0x1ffff
 s_add_u32 s35, s35, 1
 v_exp_f32 v77, v77
 v_mfma_f32_16x16x32_bf16 v[200:203], a[184:187], v[24:27], v[200:203]
 s_cmp_eq_u32 s35, s36
 v_exp_f32 v74, v74
 v_mfma_f32_16x16x32_bf16 v[204:207], a[188:191], v[24:27], v[204:207]
 s_cselect_b32 s36, s47, s36
 s_cselect_b32 s35, 0, s35
 v_cndmask_b32 v100, v4, v14, s[68:69]
 v_cndmask_b32 v101, v4, v14, s[68:69]
 v_mfma_f32_16x16x32_bf16 v[40:43], a[192:195], v[24:27], v[40:43]
 s_cmp_lt_u32 s49, s40
 v_cndmask_b32 v102, v4, v14, s[68:69]
 v_cndmask_b32 v103, v4, v14, s[68:69]
 s_cbranch_scc1 Lam1_12
 v_cvt_pk_bf16_f32 v28, v72, v73
 v_cvt_pk_bf16_f32 v29, v76, v77
 v_exp_f32 v75, v75
 v_exp_f32 v78, v78
 v_exp_f32 v79, v79
 v_cvt_pk_bf16_f32 v30, v74, v75
 v_cvt_pk_bf16_f32 v31, v78, v79
 s_nop 1
 v_mfma_f32_16x16x32_bf16 v[44:47], a[192:195], v[28:31], v[44:47]
 v_mfma_f32_16x16x32_bf16 v[208:211], a[160:163], v[28:31], v[208:211]
 v_mfma_f32_16x16x32_bf16 v[212:215], a[164:167], v[28:31], v[212:215]
 v_mfma_f32_16x16x32_bf16 v[216:219], a[168:171], v[28:31], v[216:219]
 v_mfma_f32_16x16x32_bf16 v[220:223], a[172:175], v[28:31], v[220:223]
 v_mfma_f32_16x16x32_bf16 v[224:227], a[176:179], v[28:31], v[224:227]
 v_mfma_f32_16x16x32_bf16 v[228:231], a[180:183], v[28:31], v[228:231]
 v_mfma_f32_16x16x32_bf16 v[232:235], a[184:187], v[28:31], v[232:235]
 v_mfma_f32_16x16x32_bf16 v[236:239], a[188:191], v[28:31], v[236:239]
 v_cmp_ngt_f32 s[60:61], s73, v32
 v_cmp_nlt_f32 vcc, s74, v32
 s_or_b64 s[60:61], s[60:61], vcc
 v_cmp_ngt_f32 s[62:63], s73, v36
 v_cmp_nlt_f32 vcc, s74, v36
 s_or_b64 s[62:63], s[62:63], vcc
 v_cmp_ngt_f32 s[64:65], s73, v40
 v_cmp_nlt_f32 vcc, s74, v40
 s_or_b64 s[64:65], s[64:65], vcc
 v_cmp_ngt_f32 s[66:67], s73, v44
 v_cmp_nlt_f32 vcc, s74, v44
 s_or_b64 s[66:67], s[66:67], vcc
 s_or_b64 s[60:61], s[60:61], s[62:63]
 s_or_b64 s[64:65], s[64:65], s[66:67]
 s_or_b64 s[60:61], s[60:61], s[64:65]
 s_cbranch_scc1 Laslow_7
Laback_8:
 v_rcp_f32 v32, v32
 v_rcp_f32 v36, v36
 v_rcp_f32 v40, v40
 v_rcp_f32 v44, v44
 s_lshl_b32 s40, s41, 5
 s_add_u32 s40, s40, s32
 s_lshl_b32 s40, s40, 13
 s_add_u32 s40, s40, 0x6000000
 s_add_u32 s44, s40, 4096
 v_pk_mul_f32 v[112:113], v[112:113], v[32:33] op_sel_hi:[1,0]
 v_pk_mul_f32 v[114:115], v[114:115], v[32:33] op_sel_hi:[1,0]
 v_pk_mul_f32 v[116:117], v[116:117], v[32:33] op_sel_hi:[1,0]
 v_pk_mul_f32 v[118:119], v[118:119], v[32:33] op_sel_hi:[1,0]
 v_cvt_pk_bf16_f32 v240, v112, v113
 v_cvt_pk_bf16_f32 v241, v116, v117
 v_cvt_pk_bf16_f32 v242, v114, v115
 v_cvt_pk_bf16_f32 v243, v118, v119
 buffer_store_dwordx4 v[240:243], v1, s[20:23], s40 offen offset:0 sc1
 v_pk_mul_f32 v[120:121], v[120:121], v[32:33] op_sel_hi:[1,0]
 v_pk_mul_f32 v[122:123], v[122:123], v[32:33] op_sel_hi:[1,0]
 v_pk_mul_f32 v[124:125], v[124:125], v[32:33] op_sel_hi:[1,0]
 v_pk_mul_f32 v[126:127], v[126:127], v[32:33] op_sel_hi:[1,0]
 v_cvt_pk_bf16_f32 v244, v120, v121
 v_cvt_pk_bf16_f32 v245, v124, v125
 v_cvt_pk_bf16_f32 v246, v122, v123
 v_cvt_pk_bf16_f32 v247, v126, v127
 buffer_store_dwordx4 v[244:247], v1, s[20:23], s40 offen offset:2048 sc1
 v_pk_mul_f32 v[128:129], v[128:129], v[32:33] op_sel_hi:[1,0]
 v_pk_mul_f32 v[130:131], v[130:131], v[32:33] op_sel_hi:[1,0]
 v_pk_mul_f32 v[132:133], v[132:133], v[32:33] op_sel_hi:[1,0]
 v_pk_mul_f32 v[134:135], v[134:135], v[32:33] op_sel_hi:[1,0]
 v_cvt_pk_bf16_f32 v248, v128, v129
 v_cvt_pk_bf16_f32 v249, v132, v133
 v_cvt_pk_bf16_f32 v250, v130, v131
 v_cvt_pk_bf16_f32 v251, v134, v135
 buffer_store_dwordx4 v[248:251], v1, s[20:23], s44 offen offset:0 sc1
 v_pk_mul_f32 v[136:137], v[136:137], v[32:33] op_sel_hi:[1,0]
 v_pk_mul_f32 v[138:139], v[138:139], v[32:33] op_sel_hi:[1,0]
 v_pk_mul_f32 v[140:141], v[140:141], v[32:33] op_sel_hi:[1,0]
 v_pk_mul_f32 v[142:143], v[142:143], v[32:33] op_sel_hi:[1,0]
 v_cvt_pk_bf16_f32 v252, v136, v137
 v_cvt_pk_bf16_f32 v253, v140, v141
 v_cvt_pk_bf16_f32 v254, v138, v139
 v_cvt_pk_bf16_f32 v255, v142, v143
 buffer_store_dwordx4 v[252:255], v1, s[20:23], s44 offen offset:2048 sc1
 v_pk_mul_f32 v[144:145], v[144:145], v[36:37] op_sel_hi:[1,0]
 v_pk_mul_f32 v[146:147], v[146:147], v[36:37] op_sel_hi:[1,0]
 v_pk_mul_f32 v[148:149], v[148:149], v[36:37] op_sel_hi:[1,0]
 v_pk_mul_f32 v[150:151], v[150:151], v[36:37] op_sel_hi:[1,0]
 v_cvt_pk_bf16_f32 v240, v144, v145
 v_cvt_pk_bf16_f32 v241, v148, v149
 v_cvt_pk_bf16_f32 v242, v146, v147
 v_cvt_pk_bf16_f32 v243, v150, v151
 buffer_store_dwordx4 v[240:243], v1, s[20:23], s40 offen offset:1024 sc1
 v_pk_mul_f32 v[152:153], v[152:153], v[36:37] op_sel_hi:[1,0]
 v_pk_mul_f32 v[154:155], v[154:155], v[36:37] op_sel_hi:[1,0]
 v_pk_mul_f32 v[156:157], v[156:157], v[36:37] op_sel_hi:[1,0]
 v_pk_mul_f32 v[158:159], v[158:159], v[36:37] op_sel_hi:[1,0]
 v_cvt_pk_bf16_f32 v244, v152, v153
 v_cvt_pk_bf16_f32 v245, v156, v157
 v_cvt_pk_bf16_f32 v246, v154, v155
 v_cvt_pk_bf16_f32 v247, v158, v159
 buffer_store_dwordx4 v[244:247], v1, s[20:23], s40 offen offset:3072 sc1
 v_pk_mul_f32 v[160:161], v[160:161], v[36:37] op_sel_hi:[1,0]
 v_pk_mul_f32 v[162:163], v[162:163], v[36:37] op_sel_hi:[1,0]
 v_pk_mul_f32 v[164:165], v[164:165], v[36:37] op_sel_hi:[1,0]
 v_pk_mul_f32 v[166:167], v[166:167], v[36:37] op_sel_hi:[1,0]
 v_cvt_pk_bf16_f32 v248, v160, v161
 v_cvt_pk_bf16_f32 v249, v164, v165
 v_cvt_pk_bf16_f32 v250, v162, v163
 v_cvt_pk_bf16_f32 v251, v166, v167
 buffer_store_dwordx4 v[248:251], v1, s[20:23], s44 offen offset:1024 sc1
 v_pk_mul_f32 v[168:169], v[168:169], v[36:37] op_sel_hi:[1,0]
 v_pk_mul_f32 v[170:171], v[170:171], v[36:37] op_sel_hi:[1,0]
 v_pk_mul_f32 v[172:173], v[172:173], v[36:37] op_sel_hi:[1,0]
 v_pk_mul_f32 v[174:175], v[174:175], v[36:37] op_sel_hi:[1,0]
 v_cvt_pk_bf16_f32 v252, v168, v169
 v_cvt_pk_bf16_f32 v253, v172, v173
 v_cvt_pk_bf16_f32 v254, v170, v171
 v_cvt_pk_bf16_f32 v255, v174, v175
 buffer_store_dwordx4 v[252:255], v1, s[20:23], s44 offen offset:3072 sc1
 s_lshl_b32 s40, s42, 5
 s_add_u32 s40, s40, s32
 s_lshl_b32 s40, s40, 13
 s_add_u32 s40, s40, 0x6000000
 s_add_u32 s44, s40, 4096
 v_pk_mul_f32 v[176:177], v[176:177], v[40:41] op_sel_hi:[1,0]
 v_pk_mul_f32 v[178:179], v[178:179], v[40:41] op_sel_hi:[1,0]
 v_pk_mul_f32 v[180:181], v[180:181], v[40:41] op_sel_hi:[1,0]
 v_pk_mul_f32 v[182:183], v[182:183], v[40:41] op_sel_hi:[1,0]
 v_cvt_pk_bf16_f32 v240, v176, v177
 v_cvt_pk_bf16_f32 v241, v180, v181
 v_cvt_pk_bf16_f32 v242, v178, v179
 v_cvt_pk_bf16_f32 v243, v182, v183
 buffer_store_dwordx4 v[240:243], v1, s[20:23], s40 offen offset:0 sc1
 v_pk_mul_f32 v[184:185], v[184:185], v[40:41] op_sel_hi:[1,0]
 v_pk_mul_f32 v[186:187], v[186:187], v[40:41] op_sel_hi:[1,0]
 v_pk_mul_f32 v[188:189], v[188:189], v[40:41] op_sel_hi:[1,0]
 v_pk_mul_f32 v[190:191], v[190:191], v[40:41] op_sel_hi:[1,0]
 v_cvt_pk_bf16_f32 v244, v184, v185
 v_cvt_pk_bf16_f32 v245, v188, v189
 v_cvt_pk_bf16_f32 v246, v186, v187
 v_cvt_pk_bf16_f32 v247, v190, v191
 buffer_store_dwordx4 v[244:247], v1, s[20:23], s40 offen offset:2048 sc1
 v_pk_mul_f32 v[192:193], v[192:193], v[40:41] op_sel_hi:[1,0]
 v_pk_mul_f32 v[194:195], v[194:195], v[40:41] op_sel_hi:[1,0]
 v_pk_mul_f32 v[196:197], v[196:197], v[40:41] op_sel_hi:[1,0]
 v_pk_mul_f32 v[198:199], v[198:199], v[40:41] op_sel_hi:[1,0]
 v_cvt_pk_bf16_f32 v248, v192, v193
 v_cvt_pk_bf16_f32 v249, v196, v197
 v_cvt_pk_bf16_f32 v250, v194, v195
 v_cvt_pk_bf16_f32 v251, v198, v199
 buffer_store_dwordx4 v[248:251], v1, s[20:23], s44 offen offset:0 sc1
 v_pk_mul_f32 v[200:201], v[200:201], v[40:41] op_sel_hi:[1,0]
 v_pk_mul_f32 v[202:203], v[202:203], v[40:41] op_sel_hi:[1,0]
 v_pk_mul_f32 v[204:205], v[204:205], v[40:41] op_sel_hi:[1,0]
 v_pk_mul_f32 v[206:207], v[206:207], v[40:41] op_sel_hi:[1,0]
 v_cvt_pk_bf16_f32 v252, v200, v201
 v_cvt_pk_bf16_f32 v253, v204, v205
 v_cvt_pk_bf16_f32 v254, v202, v203
 v_cvt_pk_bf16_f32 v255, v206, v207
 buffer_store_dwordx4 v[252:255], v1, s[20:23], s44 offen offset:2048 sc1
 v_pk_mul_f32 v[208:209], v[208:209], v[44:45] op_sel_hi:[1,0]
 v_pk_mul_f32 v[210:211], v[210:211], v[44:45] op_sel_hi:[1,0]
 v_pk_mul_f32 v[212:213], v[212:213], v[44:45] op_sel_hi:[1,0]
 v_pk_mul_f32 v[214:215], v[214:215], v[44:45] op_sel_hi:[1,0]
 v_cvt_pk_bf16_f32 v240, v208, v209
 v_cvt_pk_bf16_f32 v241, v212, v213
 v_cvt_pk_bf16_f32 v242, v210, v211
 v_cvt_pk_bf16_f32 v243, v214, v215
 buffer_store_dwordx4 v[240:243], v1, s[20:23], s40 offen offset:1024 sc1
 v_pk_mul_f32 v[216:217], v[216:217], v[44:45] op_sel_hi:[1,0]
 v_pk_mul_f32 v[218:219], v[218:219], v[44:45] op_sel_hi:[1,0]
 v_pk_mul_f32 v[220:221], v[220:221], v[44:45] op_sel_hi:[1,0]
 v_pk_mul_f32 v[222:223], v[222:223], v[44:45] op_sel_hi:[1,0]
 v_cvt_pk_bf16_f32 v244, v216, v217
 v_cvt_pk_bf16_f32 v245, v220, v221
 v_cvt_pk_bf16_f32 v246, v218, v219
 v_cvt_pk_bf16_f32 v247, v222, v223
 buffer_store_dwordx4 v[244:247], v1, s[20:23], s40 offen offset:3072 sc1
 v_pk_mul_f32 v[224:225], v[224:225], v[44:45] op_sel_hi:[1,0]
 v_pk_mul_f32 v[226:227], v[226:227], v[44:45] op_sel_hi:[1,0]
 v_pk_mul_f32 v[228:229], v[228:229], v[44:45] op_sel_hi:[1,0]
 v_pk_mul_f32 v[230:231], v[230:231], v[44:45] op_sel_hi:[1,0]
 v_cvt_pk_bf16_f32 v248, v224, v225
 v_cvt_pk_bf16_f32 v249, v228, v229
 v_cvt_pk_bf16_f32 v250, v226, v227
 v_cvt_pk_bf16_f32 v251, v230, v231
 buffer_store_dwordx4 v[248:251], v1, s[20:23], s44 offen offset:1024 sc1
 v_pk_mul_f32 v[232:233], v[232:233], v[44:45] op_sel_hi:[1,0]
 v_pk_mul_f32 v[234:235], v[234:235], v[44:45] op_sel_hi:[1,0]
 v_pk_mul_f32 v[236:237], v[236:237], v[44:45] op_sel_hi:[1,0]
 v_pk_mul_f32 v[238:239], v[238:239], v[44:45] op_sel_hi:[1,0]
 v_cvt_pk_bf16_f32 v252, v232, v233
 v_cvt_pk_bf16_f32 v253, v236, v237
 v_cvt_pk_bf16_f32 v254, v234, v235
 v_cvt_pk_bf16_f32 v255, v238, v239
 buffer_store_dwordx4 v[252:255], v1, s[20:23], s44 offen offset:3072 sc1
 s_lshl_b32 s72, s33, 5
 s_add_u32 s72, s72, s32
 s_lshl_b32 s72, s72, 2
 s_add_u32 s72, s72, 0x3c00
 s_cmp_eq_u32 s46, 1
 s_cbranch_scc1 Ladone_9
 s_mov_b32 s46, 1
 s_mov_b32 s33, s34
 v_accvgpr_mov_b32 a0, a64
 v_accvgpr_mov_b32 a1, a65
 v_accvgpr_mov_b32 a2, a66
 v_accvgpr_mov_b32 a3, a67
 v_accvgpr_mov_b32 a4, a68
 v_accvgpr_mov_b32 a5, a69
 v_accvgpr_mov_b32 a6, a70
 v_accvgpr_mov_b32 a7, a71
 v_accvgpr_mov_b32 a8, a72
 v_accvgpr_mov_b32 a9, a73
 v_accvgpr_mov_b32 a10, a74
 v_accvgpr_mov_b32 a11, a75
 v_accvgpr_mov_b32 a12, a76
 v_accvgpr_mov_b32 a13, a77
 v_accvgpr_mov_b32 a14, a78
 v_accvgpr_mov_b32 a15, a79
 v_accvgpr_mov_b32 a16, a80
 v_accvgpr_mov_b32 a17, a81
 v_accvgpr_mov_b32 a18, a82
 v_accvgpr_mov_b32 a19, a83
 v_accvgpr_mov_b32 a20, a84
 v_accvgpr_mov_b32 a21, a85
 v_accvgpr_mov_b32 a22, a86
 v_accvgpr_mov_b32 a23, a87
 v_accvgpr_mov_b32 a24, a88
 v_accvgpr_mov_b32 a25, a89
 v_accvgpr_mov_b32 a26, a90
 v_accvgpr_mov_b32 a27, a91
 v_accvgpr_mov_b32 a28, a92
 v_accvgpr_mov_b32 a29, a93
 v_accvgpr_mov_b32 a30, a94
 v_accvgpr_mov_b32 a31, a95
 v_accvgpr_mov_b32 a32, a96
 v_accvgpr_mov_b32 a33, a97
 v_accvgpr_mov_b32 a34, a98
 v_accvgpr_mov_b32 a35, a99
 v_accvgpr_mov_b32 a36, a100
 v_accvgpr_mov_b32 a37, a101
 v_accvgpr_mov_b32 a38, a102
 v_accvgpr_mov_b32 a39, a103
 v_accvgpr_mov_b32 a40, a104
 v_accvgpr_mov_b32 a41, a105
 v_accvgpr_mov_b32 a42, a106
 v_accvgpr_mov_b32 a43, a107
 v_accvgpr_mov_b32 a44, a108
 v_accvgpr_mov_b32 a45, a109
 v_accvgpr_mov_b32 a46, a110
 v_accvgpr_mov_b32 a47, a111
 v_accvgpr_mov_b32 a48, a112
 v_accvgpr_mov_b32 a49, a113
 v_accvgpr_mov_b32 a50, a114
 v_accvgpr_mov_b32 a51, a115
 v_accvgpr_mov_b32 a52, a116
 v_accvgpr_mov_b32 a53, a117
 v_accvgpr_mov_b32 a54, a118
 v_accvgpr_mov_b32 a55, a119
 v_accvgpr_mov_b32 a56, a120
 v_accvgpr_mov_b32 a57, a121
 v_accvgpr_mov_b32 a58, a122
 v_accvgpr_mov_b32 a59, a123
 v_accvgpr_mov_b32 a60, a124
 v_accvgpr_mov_b32 a61, a125
 v_accvgpr_mov_b32 a62, a126
 v_accvgpr_mov_b32 a63, a127
 s_branch Lablk_6
Laslow_7:
 s_waitcnt vmcnt(0) lgkmcnt(0)
 v_mov_b32 v12, 0
 v_mov_b32 v240, v4
 v_mov_b32 v13, 0
 v_mov_b32 v241, v4
 v_mov_b32 v14, 0
 v_mov_b32 v242, v4
 v_mov_b32 v15, 0
 v_mov_b32 v243, v4
 s_mov_b32 s49, 0
Lsl_14:
 s_lshl_b32 s37, s49, 19
 s_add_u32 s37, s37, s45
 s_sub_u32 s37, s37, s50
 s_add_u32 s44, s37, 0
 buffer_load_dwordx4 a[128:131], v1, s[20:23], s44 offen offset:0 sc1
 buffer_load_dwordx4 a[132:135], v1, s[20:23], s44 offen offset:1024 sc1
 buffer_load_dwordx4 a[136:139], v1, s[20:23], s44 offen offset:2048 sc1
 buffer_load_dwordx4 a[140:143], v1, s[20:23], s44 offen offset:3072 sc1
 s_add_u32 s44, s37, 4096
 buffer_load_dwordx4 a[144:147], v1, s[20:23], s44 offen offset:0 sc1
 buffer_load_dwordx4 a[148:151], v1, s[20:23], s44 offen offset:1024 sc1
 buffer_load_dwordx4 a[152:155], v1, s[20:23], s44 offen offset:2048 sc1
 buffer_load_dwordx4 a[156:159], v1, s[20:23], s44 offen offset:3072 sc1
 s_cmp_lt_u32 s49, s41
 s_cselect_b64 s[68:69], -1, 0
 s_cmp_le_u32 s49, s41
 s_cselect_b64 s[70:71], -1, 0
 s_cmp_eq_u32 s49, s41
 s_cselect_b64 s[60:61], s[52:53], s[68:69]
 s_cselect_b64 s[62:63], s[54:55], s[68:69]
 s_cselect_b64 s[64:65], s[56:57], s[68:69]
 s_cselect_b64 s[66:67], s[58:59], s[68:69]
 v_cndmask_b32 v80, v4, v12, s[60:61]
 v_cndmask_b32 v81, v4, v12, s[62:63]
 v_cndmask_b32 v82, v4, v12, s[64:65]
 v_cndmask_b32 v83, v4, v12, s[66:67]
 v_cndmask_b32 v84, v4, v12, s[68:69]
 v_cndmask_b32 v85, v4, v12, s[68:69]
 v_cndmask_b32 v86, v4, v12, s[68:69]
 v_cndmask_b32 v87, v4, v12, s[68:69]
 v_cndmask_b32 v88, v4, v13, s[70:71]
 v_cndmask_b32 v89, v4, v13, s[70:71]
 v_cndmask_b32 v90, v4, v13, s[70:71]
 v_cndmask_b32 v91, v4, v13, s[70:71]
 v_cndmask_b32 v92, v4, v13, s[60:61]
 v_cndmask_b32 v93, v4, v13, s[62:63]
 v_cndmask_b32 v94, v4, v13, s[64:65]
 v_cndmask_b32 v95, v4, v13, s[66:67]
 s_cmp_lt_u32 s49, s42
 s_cselect_b64 s[68:69], -1, 0
 s_cmp_le_u32 s49, s42
 s_cselect_b64 s[70:71], -1, 0
 s_cmp_eq_u32 s49, s42
 s_cselect_b64 s[60:61], s[52:53], s[68:69]
 s_cselect_b64 s[62:63], s[54:55], s[68:69]
 s_cselect_b64 s[64:65], s[56:57], s[68:69]
 s_cselect_b64 s[66:67], s[58:59], s[68:69]
 v_cndmask_b32 v96, v4, v14, s[60:61]
 v_cndmask_b32 v97, v4, v14, s[62:63]
 v_cndmask_b32 v98, v4, v14, s[64:65]
 v_cndmask_b32 v99, v4, v14, s[66:67]
 v_cndmask_b32 v100, v4, v14, s[68:69]
 v_cndmask_b32 v101, v4, v14, s[68:69]
 v_cndmask_b32 v102, v4, v14, s[68:69]
 v_cndmask_b32 v103, v4, v14, s[68:69]
 v_cndmask_b32 v104, v4, v15, s[70:71]
 v_cndmask_b32 v105, v4, v15, s[70:71]
 v_cndmask_b32 v106, v4, v15, s[70:71]
 v_cndmask_b32 v107, v4, v15, s[70:71]
 v_cndmask_b32 v108, v4, v15, s[60:61]
 v_cndmask_b32 v109, v4, v15, s[62:63]
 v_cndmask_b32 v110, v4, v15, s[64:65]
 v_cndmask_b32 v111, v4, v15, s[66:67]
 s_waitcnt vmcnt(0)
 s_nop 0
 v_mfma_f32_16x16x32_bf16 v[48:51], a[128:131], a[0:3], v[80:83]
 v_mfma_f32_16x16x32_bf16 v[56:59], a[128:131], a[16:19], v[88:91]
 v_mfma_f32_16x16x32_bf16 v[64:67], a[128:131], a[32:35], v[96:99]
 v_mfma_f32_16x16x32_bf16 v[72:75], a[128:131], a[48:51], v[104:107]
 v_mfma_f32_16x16x32_bf16 v[52:55], a[132:135], a[0:3], v[84:87]
 v_mfma_f32_16x16x32_bf16 v[60:63], a[132:135], a[16:19], v[92:95]
 v_mfma_f32_16x16x32_bf16 v[68:71], a[132:135], a[32:35], v[100:103]
 v_mfma_f32_16x16x32_bf16 v[76:79], a[132:135], a[48:51], v[108:111]
 v_mfma_f32_16x16x32_bf16 v[48:51], a[136:139], a[4:7], v[48:51]
 v_mfma_f32_16x16x32_bf16 v[56:59], a[136:139], a[20:23], v[56:59]
 v_mfma_f32_16x16x32_bf16 v[64:67], a[136:139], a[36:39], v[64:67]
 v_mfma_f32_16x16x32_bf16 v[72:75], a[136:139], a[52:55], v[72:75]
 v_mfma_f32_16x16x32_bf16 v[52:55], a[140:143], a[4:7], v[52:55]
 v_mfma_f32_16x16x32_bf16 v[60:63], a[140:143], a[20:23], v[60:63]
 v_mfma_f32_16x16x32_bf16 v[68:71], a[140:143], a[36:39], v[68:71]
 v_mfma_f32_16x16x32_bf16 v[76:79], a[140:143], a[52:55], v[76:79]
 v_mfma_f32_16x16x32_bf16 v[48:51], a[144:147], a[8:11], v[48:51]
 v_mfma_f32_16x16x32_bf16 v[56:59], a[144:147], a[24:27], v[56:59]
 v_mfma_f32_16x16x32_bf16 v[64:67], a[144:147], a[40:43], v[64:67]
 v_mfma_f32_16x16x32_bf16 v[72:75], a[144:147], a[56:59], v[72:75]
 v_mfma_f32_16x16x32_bf16 v[52:55], a[148:151], a[8:11], v[52:55]
 v_mfma_f32_16x16x32_bf16 v[60:63], a[148:151], a[24:27], v[60:63]
 v_mfma_f32_16x16x32_bf16 v[68:71], a[148:151], a[40:43], v[68:71]
 v_mfma_f32_16x16x32_bf16 v[76:79], a[148:151], a[56:59], v[76:79]
 v_mfma_f32_16x16x32_bf16 v[48:51], a[152:155], a[12:15], v[48:51]
 v_mfma_f32_16x16x32_bf16 v[56:59], a[152:155], a[28:31], v[56:59]
 v_mfma_f32_16x16x32_bf16 v[64:67], a[152:155], a[44:47], v[64:67]
 v_mfma_f32_16x16x32_bf16 v[72:75], a[152:155], a[60:63], v[72:75]
 v_mfma_f32_16x16x32_bf16 v[52:55], a[156:159], a[12:15], v[52:55]
 v_mfma_f32_16x16x32_bf16 v[60:63], a[156:159], a[28:31], v[60:63]
 v_mfma_f32_16x16x32_bf16 v[68:71], a[156:159], a[44:47], v[68:71]
 v_mfma_f32_16x16x32_bf16 v[76:79], a[156:159], a[60:63], v[76:79]
 s_nop 7
 v_max3_f32 v240, v240, v48, v49
 v_max3_f32 v240, v240, v50, v51
 v_max3_f32 v240, v240, v52, v53
 v_max3_f32 v240, v240, v54, v55
 v_max3_f32 v241, v241, v56, v57
 v_max3_f32 v241, v241, v58, v59
 v_max3_f32 v241, v241, v60, v61
 v_max3_f32 v241, v241, v62, v63
 v_max3_f32 v242, v242, v64, v65
 v_max3_f32 v242, v242, v66, v67
 v_max3_f32 v242, v242, v68, v69
 v_max3_f32 v242, v242, v70, v71
 v_max3_f32 v243, v243, v72, v73
 v_max3_f32 v243, v243, v74, v75
 v_max3_f32 v243, v243, v76, v77
 v_max3_f32 v243, v243, v78, v79
 s_add_u32 s49, s49, 1
 s_cmp_le_u32 s49, s42
 s_cbranch_scc1 Lsl_14
 v_mov_b32 v244, v240
 v_mov_b32 v245, v241
 v_mov_b32 v246, v242
 v_mov_b32 v247, v243
 v_permlane16_swap_b32 v240, v244
 v_permlane16_swap_b32 v241, v245
 v_permlane16_swap_b32 v242, v246
 v_permlane16_swap_b32 v243, v247
 v_max_f32 v240, v240, v244
 v_max_f32 v241, v241, v245
 v_max_f32 v242, v242, v246
 v_max_f32 v243, v243, v247
 v_mov_b32 v244, v240
 v_mov_b32 v245, v241
 v_mov_b32 v246, v242
 v_mov_b32 v247, v243
 v_permlane32_swap_b32 v240, v244
 v_permlane32_swap_b32 v241, v245
 v_permlane32_swap_b32 v242, v246
 v_permlane32_swap_b32 v243, v247
 v_max_f32 v240, v240, v244
 v_max_f32 v241, v241, v245
 v_max_f32 v242, v242, v246
 v_max_f32 v243, v243, v247
 v_sub_f32 v12, 0, v240
 v_sub_f32 v13, 0, v241
 v_sub_f32 v14, 0, v242
 v_sub_f32 v15, 0, v243
 v_mov_b64 v[112:113], 0
 v_mov_b64 v[114:115], 0
 v_mov_b64 v[116:117], 0
 v_mov_b64 v[118:119], 0
 v_mov_b64 v[120:121], 0
 v_mov_b64 v[122:123], 0
 v_mov_b64 v[124:125], 0
 v_mov_b64 v[126:127], 0
 v_mov_b64 v[128:129], 0
 v_mov_b64 v[130:131], 0
 v_mov_b64 v[132:133], 0
 v_mov_b64 v[134:135], 0
 v_mov_b64 v[136:137], 0
 v_mov_b64 v[138:139], 0
 v_mov_b64 v[140:141], 0
 v_mov_b64 v[142:143], 0
 v_mov_b64 v[144:145], 0
 v_mov_b64 v[146:147], 0
 v_mov_b64 v[148:149], 0
 v_mov_b64 v[150:151], 0
 v_mov_b64 v[152:153], 0
 v_mov_b64 v[154:155], 0
 v_mov_b64 v[156:157], 0
 v_mov_b64 v[158:159], 0
 v_mov_b64 v[160:161], 0
 v_mov_b64 v[162:163], 0
 v_mov_b64 v[164:165], 0
 v_mov_b64 v[166:167], 0
 v_mov_b64 v[168:169], 0
 v_mov_b64 v[170:171], 0
 v_mov_b64 v[172:173], 0
 v_mov_b64 v[174:175], 0
 v_mov_b64 v[176:177], 0
 v_mov_b64 v[178:179], 0
 v_mov_b64 v[180:181], 0
 v_mov_b64 v[182:183], 0
 v_mov_b64 v[184:185], 0
 v_mov_b64 v[186:187], 0
 v_mov_b64 v[188:189], 0
 v_mov_b64 v[190:191], 0
 v_mov_b64 v[192:193], 0
 v_mov_b64 v[194:195], 0
 v_mov_b64 v[196:197], 0
 v_mov_b64 v[198:199], 0
 v_mov_b64 v[200:201], 0
 v_mov_b64 v[202:203], 0
 v_mov_b64 v[204:205], 0
 v_mov_b64 v[206:207], 0
 v_mov_b64 v[208:209], 0
 v_mov_b64 v[210:211], 0
 v_mov_b64 v[212:213], 0
 v_mov_b64 v[214:215], 0
 v_mov_b64 v[216:217], 0
 v_mov_b64 v[218:219], 0
 v_mov_b64 v[220:221], 0
 v_mov_b64 v[222:223], 0
 v_mov_b64 v[224:225], 0
 v_mov_b64 v[226:227], 0
 v_mov_b64 v[228:229], 0
 v_mov_b64 v[230:231], 0
 v_mov_b64 v[232:233], 0
 v_mov_b64 v[234:235], 0
 v_mov_b64 v[236:237], 0
 v_mov_b64 v[238:239], 0
 v_mov_b64 v[32:33], 0
 v_mov_b64 v[34:35], 0
 v_mov_b64 v[36:37], 0
 v_mov_b64 v[38:39], 0
 v_mov_b64 v[40:41], 0
 v_mov_b64 v[42:43], 0
 v_mov_b64 v[44:45], 0
 v_mov_b64 v[46:47], 0
 s_mov_b32 s49, 0
Lsl_15:
 s_lshl_b32 s37, s49, 19
 s_add_u32 s37, s37, s45
 s_sub_u32 s37, s37, s50
 s_add_u32 s44, s37, 0
 buffer_load_dwordx4 a[128:131], v1, s[20:23], s44 offen offset:0 sc1
 buffer_load_dwordx4 a[132:135], v1, s[20:23], s44 offen offset:1024 sc1
 buffer_load_dwordx4 a[136:139], v1, s[20:23], s44 offen offset:2048 sc1
 buffer_load_dwordx4 a[140:143], v1, s[20:23], s44 offen offset:3072 sc1
 s_add_u32 s44, s37, 4096
 buffer_load_dwordx4 a[144:147], v1, s[20:23], s44 offen offset:0 sc1
 buffer_load_dwordx4 a[148:151], v1, s[20:23], s44 offen offset:1024 sc1
 buffer_load_dwordx4 a[152:155], v1, s[20:23], s44 offen offset:2048 sc1
 buffer_load_dwordx4 a[156:159], v1, s[20:23], s44 offen offset:3072 sc1
 s_add_u32 s44, s37, 8192
 buffer_load_dwordx4 a[160:163], v1, s[20:23], s44 offen offset:0 sc1
 buffer_load_dwordx4 a[164:167], v1, s[20:23], s44 offen offset:1024 sc1
 buffer_load_dwordx4 a[168:171], v1, s[20:23], s44 offen offset:2048 sc1
 buffer_load_dwordx4 a[172:175], v1, s[20:23], s44 offen offset:3072 sc1
 s_add_u32 s44, s37, 12288
 buffer_load_dwordx4 a[176:179], v1, s[20:23], s44 offen offset:0 sc1
 buffer_load_dwordx4 a[180:183], v1, s[20:23], s44 offen offset:1024 sc1
 buffer_load_dwordx4 a[184:187], v1, s[20:23], s44 offen offset:2048 sc1
 buffer_load_dwordx4 a[188:191], v1, s[20:23], s44 offen offset:3072 sc1
 s_cmp_lt_u32 s49, s41
 s_cselect_b64 s[68:69], -1, 0
 s_cmp_le_u32 s49, s41
 s_cselect_b64 s[70:71], -1, 0
 s_cmp_eq_u32 s49, s41
 s_cselect_b64 s[60:61], s[52:53], s[68:69]
 s_cselect_b64 s[62:63], s[54:55], s[68:69]
 s_cselect_b64 s[64:65], s[56:57], s[68:69]
 s_cselect_b64 s[66:67], s[58:59], s[68:69]
 v_cndmask_b32 v80, v4, v12, s[60:61]
 v_cndmask_b32 v81, v4, v12, s[62:63]
 v_cndmask_b32 v82, v4, v12, s[64:65]
 v_cndmask_b32 v83, v4, v12, s[66:67]
 v_cndmask_b32 v84, v4, v12, s[68:69]
 v_cndmask_b32 v85, v4, v12, s[68:69]
 v_cndmask_b32 v86, v4, v12, s[68:69]
 v_cndmask_b32 v87, v4, v12, s[68:69]
 v_cndmask_b32 v88, v4, v13, s[70:71]
 v_cndmask_b32 v89, v4, v13, s[70:71]
 v_cndmask_b32 v90, v4, v13, s[70:71]
 v_cndmask_b32 v91, v4, v13, s[70:71]
 v_cndmask_b32 v92, v4, v13, s[60:61]
 v_cndmask_b32 v93, v4, v13, s[62:63]
 v_cndmask_b32 v94, v4, v13, s[64:65]
 v_cndmask_b32 v95, v4, v13, s[66:67]
 s_cmp_lt_u32 s49, s42
 s_cselect_b64 s[68:69], -1, 0
 s_cmp_le_u32 s49, s42
 s_cselect_b64 s[70:71], -1, 0
 s_cmp_eq_u32 s49, s42
 s_cselect_b64 s[60:61], s[52:53], s[68:69]
 s_cselect_b64 s[62:63], s[54:55], s[68:69]
 s_cselect_b64 s[64:65], s[56:57], s[68:69]
 s_cselect_b64 s[66:67], s[58:59], s[68:69]
 v_cndmask_b32 v96, v4, v14, s[60:61]
 v_cndmask_b32 v97, v4, v14, s[62:63]
 v_cndmask_b32 v98, v4, v14, s[64:65]
 v_cndmask_b32 v99, v4, v14, s[66:67]
 v_cndmask_b32 v100, v4, v14, s[68:69]
 v_cndmask_b32 v101, v4, v14, s[68:69]
 v_cndmask_b32 v102, v4, v14, s[68:69]
 v_cndmask_b32 v103, v4, v14, s[68:69]
 v_cndmask_b32 v104, v4, v15, s[70:71]
 v_cndmask_b32 v105, v4, v15, s[70:71]
 v_cndmask_b32 v106, v4, v15, s[70:71]
 v_cndmask_b32 v107, v4, v15, s[70:71]
 v_cndmask_b32 v108, v4, v15, s[60:61]
 v_cndmask_b32 v109, v4, v15, s[62:63]
 v_cndmask_b32 v110, v4, v15, s[64:65]
 v_cndmask_b32 v111, v4, v15, s[66:67]
 s_waitcnt vmcnt(0)
 s_nop 0
 v_mfma_f32_16x16x32_bf16 v[48:51], a[128:131], a[0:3], v[80:83]
 v_mfma_f32_16x16x32_bf16 v[56:59], a[128:131], a[16:19], v[88:91]
 v_mfma_f32_16x16x32_bf16 v[64:67], a[128:131], a[32:35], v[96:99]
 v_mfma_f32_16x16x32_bf16 v[72:75], a[128:131], a[48:51], v[104:107]
 v_mfma_f32_16x16x32_bf16 v[52:55], a[132:135], a[0:3], v[84:87]
 v_mfma_f32_16x16x32_bf16 v[60:63], a[132:135], a[16:19], v[92:95]
 v_mfma_f32_16x16x32_bf16 v[68:71], a[132:135], a[32:35], v[100:103]
 v_mfma_f32_16x16x32_bf16 v[76:79], a[132:135], a[48:51], v[108:111]
 v_mfma_f32_16x16x32_bf16 v[48:51], a[136:139], a[4:7], v[48:51]
 v_mfma_f32_16x16x32_bf16 v[56:59], a[136:139], a[20:23], v[56:59]
 v_mfma_f32_16x16x32_bf16 v[64:67], a[136:139], a[36:39], v[64:67]
 v_mfma_f32_16x16x32_bf16 v[72:75], a[136:139], a[52:55], v[72:75]
 v_mfma_f32_16x16x32_bf16 v[52:55], a[140:143], a[4:7], v[52:55]
 v_mfma_f32_16x16x32_bf16 v[60:63], a[140:143], a[20:23], v[60:63]
 v_mfma_f32_16x16x32_bf16 v[68:71], a[140:143], a[36:39], v[68:71]
 v_mfma_f32_16x16x32_bf16 v[76:79], a[140:143], a[52:55], v[76:79]
 v_mfma_f32_16x16x32_bf16 v[48:51], a[144:147], a[8:11], v[48:51]
 v_mfma_f32_16x16x32_bf16 v[56:59], a[144:147], a[24:27], v[56:59]
 v_mfma_f32_16x16x32_bf16 v[64:67], a[144:147], a[40:43], v[64:67]
 v_mfma_f32_16x16x32_bf16 v[72:75], a[144:147], a[56:59], v[72:75]
 v_mfma_f32_16x16x32_bf16 v[52:55], a[148:151], a[8:11], v[52:55]
 v_mfma_f32_16x16x32_bf16 v[60:63], a[148:151], a[24:27], v[60:63]
 v_mfma_f32_16x16x32_bf16 v[68:71], a[148:151], a[40:43], v[68:71]
 v_mfma_f32_16x16x32_bf16 v[76:79], a[148:151], a[56:59], v[76:79]
 v_mfma_f32_16x16x32_bf16 v[48:51], a[152:155], a[12:15], v[48:51]
 v_mfma_f32_16x16x32_bf16 v[56:59], a[152:155], a[28:31], v[56:59]
 v_mfma_f32_16x16x32_bf16 v[64:67], a[152:155], a[44:47], v[64:67]
 v_mfma_f32_16x16x32_bf16 v[72:75], a[152:155], a[60:63], v[72:75]
 v_mfma_f32_16x16x32_bf16 v[52:55], a[156:159], a[12:15], v[52:55]
 v_mfma_f32_16x16x32_bf16 v[60:63], a[156:159], a[28:31], v[60:63]
 v_mfma_f32_16x16x32_bf16 v[68:71], a[156:159], a[44:47], v[68:71]
 v_mfma_f32_16x16x32_bf16 v[76:79], a[156:159], a[60:63], v[76:79]
 s_nop 7
 v_exp_f32 v48, v48
 v_exp_f32 v49, v49
 v_exp_f32 v52, v52
 v_exp_f32 v53, v53
 v_exp_f32 v50, v50
 v_cvt_pk_bf16_f32 v16, v48, v49
 v_cvt_pk_bf16_f32 v17, v52, v53
 v_exp_f32 v51, v51
 v_exp_f32 v54, v54
 v_exp_f32 v55, v55
 v_cvt_pk_bf16_f32 v18, v50, v51
 v_cvt_pk_bf16_f32 v19, v54, v55
 v_exp_f32 v56, v56
 v_exp_f32 v57, v57
 v_exp_f32 v60, v60
 v_exp_f32 v61, v61
 v_exp_f32 v58, v58
 v_cvt_pk_bf16_f32 v20, v56, v57
 v_cvt_pk_bf16_f32 v21, v60, v61
 v_exp_f32 v59, v59
 v_exp_f32 v62, v62
 v_exp_f32 v63, v63
 v_cvt_pk_bf16_f32 v22, v58, v59
 v_cvt_pk_bf16_f32 v23, v62, v63
 v_exp_f32 v64, v64
 v_exp_f32 v65, v65
 v_exp_f32 v68, v68
 v_exp_f32 v69, v69
 v_exp_f32 v66, v66
 v_cvt_pk_bf16_f32 v24, v64, v65
 v_cvt_pk_bf16_f32 v25, v68, v69
 v_exp_f32 v67, v67
 v_exp_f32 v70, v70
 v_exp_f32 v71, v71
 v_cvt_pk_bf16_f32 v26, v66, v67
 v_cvt_pk_bf16_f32 v27, v70, v71
 v_exp_f32 v72, v72
 v_exp_f32 v73, v73
 v_exp_f32 v76, v76
 v_exp_f32 v77, v77
 v_exp_f32 v74, v74
 v_cvt_pk_bf16_f32 v28, v72, v73
 v_cvt_pk_bf16_f32 v29, v76, v77
 v_exp_f32 v75, v75
 v_exp_f32 v78, v78
 v_exp_f32 v79, v79
 v_cvt_pk_bf16_f32 v30, v74, v75
 v_cvt_pk_bf16_f32 v31, v78, v79
 s_nop 1
 v_mfma_f32_16x16x32_bf16 v[112:115], a[160:163], v[16:19], v[112:115]
 v_mfma_f32_16x16x32_bf16 v[144:147], a[160:163], v[20:23], v[144:147]
 v_mfma_f32_16x16x32_bf16 v[176:179], a[160:163], v[24:27], v[176:179]
 v_mfma_f32_16x16x32_bf16 v[208:211], a[160:163], v[28:31], v[208:211]
 v_mfma_f32_16x16x32_bf16 v[116:119], a[164:167], v[16:19], v[116:119]
 v_mfma_f32_16x16x32_bf16 v[148:151], a[164:167], v[20:23], v[148:151]
 v_mfma_f32_16x16x32_bf16 v[180:183], a[164:167], v[24:27], v[180:183]
 v_mfma_f32_16x16x32_bf16 v[212:215], a[164:167], v[28:31], v[212:215]
 v_mfma_f32_16x16x32_bf16 v[120:123], a[168:171], v[16:19], v[120:123]
 v_mfma_f32_16x16x32_bf16 v[152:155], a[168:171], v[20:23], v[152:155]
 v_mfma_f32_16x16x32_bf16 v[184:187], a[168:171], v[24:27], v[184:187]
 v_mfma_f32_16x16x32_bf16 v[216:219], a[168:171], v[28:31], v[216:219]
 v_mfma_f32_16x16x32_bf16 v[124:127], a[172:175], v[16:19], v[124:127]
 v_mfma_f32_16x16x32_bf16 v[156:159], a[172:175], v[20:23], v[156:159]
 v_mfma_f32_16x16x32_bf16 v[188:191], a[172:175], v[24:27], v[188:191]
 v_mfma_f32_16x16x32_bf16 v[220:223], a[172:175], v[28:31], v[220:223]
 v_mfma_f32_16x16x32_bf16 v[128:131], a[176:179], v[16:19], v[128:131]
 v_mfma_f32_16x16x32_bf16 v[160:163], a[176:179], v[20:23], v[160:163]
 v_mfma_f32_16x16x32_bf16 v[192:195], a[176:179], v[24:27], v[192:195]
 v_mfma_f32_16x16x32_bf16 v[224:227], a[176:179], v[28:31], v[224:227]
 v_mfma_f32_16x16x32_bf16 v[132:135], a[180:183], v[16:19], v[132:135]
 v_mfma_f32_16x16x32_bf16 v[164:167], a[180:183], v[20:23], v[164:167]
 v_mfma_f32_16x16x32_bf16 v[196:199], a[180:183], v[24:27], v[196:199]
 v_mfma_f32_16x16x32_bf16 v[228:231], a[180:183], v[28:31], v[228:231]
 v_mfma_f32_16x16x32_bf16 v[136:139], a[184:187], v[16:19], v[136:139]
 v_mfma_f32_16x16x32_bf16 v[168:171], a[184:187], v[20:23], v[168:171]
 v_mfma_f32_16x16x32_bf16 v[200:203], a[184:187], v[24:27], v[200:203]
 v_mfma_f32_16x16x32_bf16 v[232:235], a[184:187], v[28:31], v[232:235]
 v_mfma_f32_16x16x32_bf16 v[140:143], a[188:191], v[16:19], v[140:143]
 v_mfma_f32_16x16x32_bf16 v[172:175], a[188:191], v[20:23], v[172:175]
 v_mfma_f32_16x16x32_bf16 v[204:207], a[188:191], v[24:27], v[204:207]
 v_mfma_f32_16x16x32_bf16 v[236:239], a[188:191], v[28:31], v[236:239]
 v_mfma_f32_16x16x32_bf16 v[32:35], a[192:195], v[16:19], v[32:35]
 v_mfma_f32_16x16x32_bf16 v[36:39], a[192:195], v[20:23], v[36:39]
 v_mfma_f32_16x16x32_bf16 v[40:43], a[192:195], v[24:27], v[40:43]
 v_mfma_f32_16x16x32_bf16 v[44:47], a[192:195], v[28:31], v[44:47]
 s_add_u32 s49, s49, 1
 s_cmp_le_u32 s49, s42
 s_cbranch_scc1 Lsl_15
 ds_read_b128 a[128:131], v3 offset:0
 ds_read_b128 a[132:135], v3 offset:1024
 ds_read_b128 a[136:139], v3 offset:2048
 ds_read_b128 a[140:143], v3 offset:3072
 ds_read_b128 a[144:147], v3 offset:4096
 ds_read_b128 a[148:151], v3 offset:5120
 ds_read_b128 a[152:155], v3 offset:6144
 ds_read_b128 a[156:159], v3 offset:7168
 s_branch Laback_8
Ladone_9:
 s_waitcnt vmcnt(0) lgkmcnt(0)
 s_barrier
 v_mov_b32 v6, 1
 buffer_store_dword v6, v5, s[20:23], s72 offen sc1
 s_cmp_ge_u32 s6, 24
 s_cbranch_scc1 Lfin
 s_load_dwordx2 s[8:9], s[0:1], 40
 s_mov_b32 s10, 0x480000
 s_mov_b32 s11, 0x20000
 s_cmp_ge_u32 s6, 12
 s_cselect_b32 s7, 1, 0
 s_cselect_b32 s94, 12, 0
 s_sub_u32 s32, s6, s94
 s_sub_u32 s94, s5, 4
 s_lshl_b32 s94, s94, 1
 s_add_u32 s33, s94, s7
 s_mov_b32 s34, 8
 s_mov_b32 s35, 8
 s_mov_b32 s36, 0x6000000
 s_mov_b32 s37, 0
 s_lshl_b32 s38, s4, 5
 s_add_u32 s38, s38, 0x3c00
 s_mov_b32 s39, 1
 s_mov_b32 s40, 0
 s_mov_b32 s93, 0x38
 s_mov_b32 s92, 7
 s_branch Los
Lpb:
 s_load_dwordx2 s[8:9], s[0:1], 48
 s_mov_b32 s10, 0x240000
 s_mov_b32 s11, 0x20000
 s_load_dwordx2 s[12:13], s[0:1], 72
 s_mov_b32 s14, 0x480000
 s_mov_b32 s15, 0x20000
 s_load_dwordx2 s[16:17], s[0:1], 80
 s_mov_b32 s18, 0x480000
 s_mov_b32 s19, 0x20000
 s_lshl_b32 s32, s6, 8
 s_mov_b32 s33, s32
 s_lshl_b32 s34, s6, 14
 s_add_u32 s34, s34, 0x3000000
 s_add_u32 s35, s34, 8192
 s_mov_b32 s36, 64
 s_mov_b32 s37, 0
 s_lshl_b32 s7, s6, 7
 s_add_u32 s7, s7, 0x0
 v_min_u32 v1, 1, v0
 v_lshlrev_b32 v1, 28, v1
 v_add_u32 v13, s7, v1
 s_waitcnt lgkmcnt(0)
 v_and_b32 v1, 63, v0
 v_lshrrev_b32 v2, 3, v0
 v_mul_u32_u24 v10, 1152, v2
 v_lshrrev_b32 v2, 4, v0
 v_xor_b32 v2, v2, v0
 v_and_b32 v2, 7, v2
 v_lshl_add_u32 v10, v2, 4, v10
 v_lshrrev_b32 v2, 4, v1
 v_bfe_u32 v3, v1, 1, 3
 v_xor_b32 v2, v2, v3
 v_and_b32 v3, 15, v1
 v_lshlrev_b32 v3, 7, v3
 v_lshl_add_u32 v4, v2, 4, v3
 v_xor_b32 v5, 64, v4
 v_lshrrev_b32 v2, 4, v0
 v_lshlrev_b32 v11, 13, v2
 v_lshrrev_b32 v2, 7, v0
 v_lshrrev_b32 v3, 4, v1
 v_lshl_add_u32 v3, v2, 2, v3
 v_bfe_u32 v2, v1, 1, 3
 v_xor_b32 v2, v2, v3
 v_lshl_add_u32 v11, v2, 5, v11
 v_and_b32 v2, 1, v1
 v_lshl_add_u32 v11, v2, 4, v11
 v_bfe_u32 v2, v1, 2, 3
 v_xor_b32 v3, s4, v2
 v_lshlrev_b32 v3, 5, v3
 v_and_b32 v2, 3, v2
 v_lshl_add_u32 v3, v2, 8, v3
 v_lshrrev_b32 v2, 4, v1
 v_lshl_add_u32 v3, v2, 11, v3
 v_and_b32 v2, 3, v1
 v_lshl_add_u32 v3, v2, 3, v3
 v_add_u32 v8, 73728, v3
 v_xor_b32 v3, 0x80, v3
 v_add_u32 v9, 73728, v3
 s_lshl_b32 s45, s4, 11
 v_lshl_add_u32 v12, v1, 4, s45
 s_mov_b32 s39, s37
 s_add_u32 s40, s39, 1
 s_lshl_b32 s49, s4, 10
 s_mul_i32 s46, s39, 36864
 s_add_u32 m0, s49, 0
 s_nop 0
 buffer_load_dwordx4 v10, s[8:11], s46 offen offset:0  lds
 s_add_u32 m0, s49, 3968
 s_nop 0
 buffer_load_dwordx4 v10, s[8:11], s46 offen offset:128  lds
 s_add_u32 m0, s49, 7936
 s_nop 0
 buffer_load_dwordx4 v10, s[8:11], s46 offen offset:256  lds
 s_add_u32 m0, s49, 11904
 s_nop 0
 buffer_load_dwordx4 v10, s[8:11], s46 offen offset:384  lds
 s_add_u32 m0, s49, 15872
 s_nop 0
 buffer_load_dwordx4 v10, s[8:11], s46 offen offset:512  lds
 s_add_u32 m0, s49, 19840
 s_nop 0
 buffer_load_dwordx4 v10, s[8:11], s46 offen offset:640  lds
 s_add_u32 m0, s49, 23808
 s_nop 0
 buffer_load_dwordx4 v10, s[8:11], s46 offen offset:768  lds
 s_add_u32 m0, s49, 27776
 s_nop 0
 buffer_load_dwordx4 v10, s[8:11], s46 offen offset:896  lds
 s_add_u32 m0, s49, 31744
 s_nop 0
 buffer_load_dwordx4 v10, s[8:11], s46 offen offset:1024  lds
 s_lshl_b32 s49, s4, 10
 s_add_u32 s49, s49, 36864
 s_mul_i32 s46, s40, 36864
 s_add_u32 m0, s49, 0
 s_nop 0
 buffer_load_dwordx4 v10, s[8:11], s46 offen offset:0  lds
 s_add_u32 m0, s49, 3968
 s_nop 0
 buffer_load_dwordx4 v10, s[8:11], s46 offen offset:128  lds
 s_add_u32 m0, s49, 7936
 s_nop 0
 buffer_load_dwordx4 v10, s[8:11], s46 offen offset:256  lds
 s_add_u32 m0, s49, 11904
 s_nop 0
 buffer_load_dwordx4 v10, s[8:11], s46 offen offset:384  lds
 s_add_u32 m0, s49, 15872
 s_nop 0
 buffer_load_dwordx4 v10, s[8:11], s46 offen offset:512  lds
 s_add_u32 m0, s49, 19840
 s_nop 0
 buffer_load_dwordx4 v10, s[8:11], s46 offen offset:640  lds
 s_add_u32 m0, s49, 23808
 s_nop 0
 buffer_load_dwordx4 v10, s[8:11], s46 offen offset:768  lds
 s_add_u32 m0, s49, 27776
 s_nop 0
 buffer_load_dwordx4 v10, s[8:11], s46 offen offset:896  lds
 s_add_u32 m0, s49, 31744
 s_nop 0
 buffer_load_dwordx4 v10, s[8:11], s46 offen offset:1024  lds
 s_lshl_b32 s49, s4, 10
 s_add_u32 m0, s49, 73728
 s_add_u32 s45, s32, 0
 buffer_load_dwordx4 v11, s[12:15], s45 offen nt lds
 s_add_u32 m0, s49, 77824
 s_add_u32 s45, s32, 131072
 buffer_load_dwordx4 v11, s[12:15], s45 offen nt lds
 s_add_u32 m0, s49, 81920
 s_add_u32 s45, s33, 0
 buffer_load_dwordx4 v11, s[16:19], s45 offen nt lds
 s_add_u32 m0, s49, 86016
 s_add_u32 s45, s33, 131072
 buffer_load_dwordx4 v11, s[16:19], s45 offen nt lds
 s_add_u32 m0, s49, 90112
 s_add_u32 s45, s32, 262144
 buffer_load_dwordx4 v11, s[12:15], s45 offen nt lds
 s_add_u32 m0, s49, 94208
 s_add_u32 s45, s32, 393216
 buffer_load_dwordx4 v11, s[12:15], s45 offen nt lds
 s_add_u32 m0, s49, 98304
 s_add_u32 s45, s33, 262144
 buffer_load_dwordx4 v11, s[16:19], s45 offen nt lds
 s_add_u32 m0, s49, 102400
 s_add_u32 s45, s33, 393216
 buffer_load_dwordx4 v11, s[16:19], s45 offen nt lds
 s_add_u32 m0, s49, 106496
 s_add_u32 s45, s32, 524288
 buffer_load_dwordx4 v11, s[12:15], s45 offen nt lds
 s_add_u32 m0, s49, 110592
 s_add_u32 s45, s32, 655360
 buffer_load_dwordx4 v11, s[12:15], s45 offen nt lds
 s_add_u32 m0, s49, 114688
 s_add_u32 s45, s33, 524288
 buffer_load_dwordx4 v11, s[16:19], s45 offen nt lds
 s_add_u32 m0, s49, 118784
 s_add_u32 s45, s33, 655360
 buffer_load_dwordx4 v11, s[16:19], s45 offen nt lds
 s_waitcnt vmcnt(8) lgkmcnt(0)
 s_barrier
 s_add_u32 m0, s49, 122880
 s_add_u32 s45, s32, 786432
 buffer_load_dwordx4 v11, s[12:15], s45 offen nt lds
 s_add_u32 m0, s49, 126976
 s_add_u32 s45, s32, 917504
 buffer_load_dwordx4 v11, s[12:15], s45 offen nt lds
 s_add_u32 m0, s49, 131072
 s_add_u32 s45, s33, 786432
 buffer_load_dwordx4 v11, s[16:19], s45 offen nt lds
 s_add_u32 m0, s49, 135168
 s_add_u32 s45, s33, 917504
 buffer_load_dwordx4 v11, s[16:19], s45 offen nt lds
 ds_read_b64_tr_b16 a[0:1], v8 offset:0
 ds_read_b64_tr_b16 a[2:3], v8 offset:1024
 ds_read_b64_tr_b16 a[72:73], v9 offset:0
 ds_read_b64_tr_b16 a[74:75], v9 offset:1024
 ds_read_b64_tr_b16 a[144:145], v8 offset:8192
 ds_read_b64_tr_b16 a[146:147], v8 offset:9216
 ds_read_b64_tr_b16 a[216:217], v9 offset:8192
 ds_read_b64_tr_b16 a[218:219], v9 offset:9216
 s_waitcnt vmcnt(8) lgkmcnt(0)
 s_barrier
 s_add_u32 m0, s49, 73728
 s_add_u32 s45, s32, 1048576
 buffer_load_dwordx4 v11, s[12:15], s45 offen nt lds
 s_add_u32 m0, s49, 77824
 s_add_u32 s45, s32, 1179648
 buffer_load_dwordx4 v11, s[12:15], s45 offen nt lds
 s_add_u32 m0, s49, 81920
 s_add_u32 s45, s33, 1048576
 buffer_load_dwordx4 v11, s[16:19], s45 offen nt lds
 s_add_u32 m0, s49, 86016
 s_add_u32 s45, s33, 1179648
 buffer_load_dwordx4 v11, s[16:19], s45 offen nt lds
 ds_read_b64_tr_b16 a[4:5], v8 offset:16384
 ds_read_b64_tr_b16 a[6:7], v8 offset:17408
 ds_read_b64_tr_b16 a[76:77], v9 offset:16384
 ds_read_b64_tr_b16 a[78:79], v9 offset:17408
 ds_read_b64_tr_b16 a[148:149], v8 offset:24576
 ds_read_b64_tr_b16 a[150:151], v8 offset:25600
 ds_read_b64_tr_b16 a[220:221], v9 offset:24576
 ds_read_b64_tr_b16 a[222:223], v9 offset:25600
 s_waitcnt vmcnt(8) lgkmcnt(0)
 s_barrier
 s_add_u32 m0, s49, 90112
 s_add_u32 s45, s32, 1310720
 buffer_load_dwordx4 v11, s[12:15], s45 offen nt lds
 s_add_u32 m0, s49, 94208
 s_add_u32 s45, s32, 1441792
 buffer_load_dwordx4 v11, s[12:15], s45 offen nt lds
 s_add_u32 m0, s49, 98304
 s_add_u32 s45, s33, 1310720
 buffer_load_dwordx4 v11, s[16:19], s45 offen nt lds
 s_add_u32 m0, s49, 102400
 s_add_u32 s45, s33, 1441792
 buffer_load_dwordx4 v11, s[16:19], s45 offen nt lds
 ds_read_b64_tr_b16 a[8:9], v8 offset:32768
 ds_read_b64_tr_b16 a[10:11], v8 offset:33792
 ds_read_b64_tr_b16 a[80:81], v9 offset:32768
 ds_read_b64_tr_b16 a[82:83], v9 offset:33792
 ds_read_b64_tr_b16 a[152:153], v8 offset:40960
 ds_read_b64_tr_b16 a[154:155], v8 offset:41984
 ds_read_b64_tr_b16 a[224:225], v9 offset:40960
 ds_read_b64_tr_b16 a[226:227], v9 offset:41984
 s_waitcnt vmcnt(8) lgkmcnt(0)
 s_barrier
 s_add_u32 m0, s49, 106496
 s_add_u32 s45, s32, 1572864
 buffer_load_dwordx4 v11, s[12:15], s45 offen nt lds
 s_add_u32 m0, s49, 110592
 s_add_u32 s45, s32, 1703936
 buffer_load_dwordx4 v11, s[12:15], s45 offen nt lds
 s_add_u32 m0, s49, 114688
 s_add_u32 s45, s33, 1572864
 buffer_load_dwordx4 v11, s[16:19], s45 offen nt lds
 s_add_u32 m0, s49, 118784
 s_add_u32 s45, s33, 1703936
 buffer_load_dwordx4 v11, s[16:19], s45 offen nt lds
 ds_read_b64_tr_b16 a[12:13], v8 offset:49152
 ds_read_b64_tr_b16 a[14:15], v8 offset:50176
 ds_read_b64_tr_b16 a[84:85], v9 offset:49152
 ds_read_b64_tr_b16 a[86:87], v9 offset:50176
 ds_read_b64_tr_b16 a[156:157], v8 offset:57344
 ds_read_b64_tr_b16 a[158:159], v8 offset:58368
 ds_read_b64_tr_b16 a[228:229], v9 offset:57344
 ds_read_b64_tr_b16 a[230:231], v9 offset:58368
 s_waitcnt vmcnt(8) lgkmcnt(0)
 s_barrier
 s_add_u32 m0, s49, 122880
 s_add_u32 s45, s32, 1835008
 buffer_load_dwordx4 v11, s[12:15], s45 offen nt lds
 s_add_u32 m0, s49, 126976
 s_add_u32 s45, s32, 1966080
 buffer_load_dwordx4 v11, s[12:15], s45 offen nt lds
 s_add_u32 m0, s49, 131072
 s_add_u32 s45, s33, 1835008
 buffer_load_dwordx4 v11, s[16:19], s45 offen nt lds
 s_add_u32 m0, s49, 135168
 s_add_u32 s45, s33, 1966080
 buffer_load_dwordx4 v11, s[16:19], s45 offen nt lds
 ds_read_b64_tr_b16 a[16:17], v8 offset:0
 ds_read_b64_tr_b16 a[18:19], v8 offset:1024
 ds_read_b64_tr_b16 a[88:89], v9 offset:0
 ds_read_b64_tr_b16 a[90:91], v9 offset:1024
 ds_read_b64_tr_b16 a[160:161], v8 offset:8192
 ds_read_b64_tr_b16 a[162:163], v8 offset:9216
 ds_read_b64_tr_b16 a[232:233], v9 offset:8192
 ds_read_b64_tr_b16 a[234:235], v9 offset:9216
 s_waitcnt vmcnt(8) lgkmcnt(0)
 s_barrier
 s_add_u32 m0, s49, 73728
 s_add_u32 s45, s32, 2097152
 buffer_load_dwordx4 v11, s[12:15], s45 offen nt lds
 s_add_u32 m0, s49, 77824
 s_add_u32 s45, s32, 2228224
 buffer_load_dwordx4 v11, s[12:15], s45 offen nt lds
 s_add_u32 m0, s49, 81920
 s_add_u32 s45, s33, 2097152
 buffer_load_dwordx4 v11, s[16:19], s45 offen nt lds
 s_add_u32 m0, s49, 86016
 s_add_u32 s45, s33, 2228224
 buffer_load_dwordx4 v11, s[16:19], s45 offen nt lds
 ds_read_b64_tr_b16 a[20:21], v8 offset:16384
 ds_read_b64_tr_b16 a[22:23], v8 offset:17408
 ds_read_b64_tr_b16 a[92:93], v9 offset:16384
 ds_read_b64_tr_b16 a[94:95], v9 offset:17408
 ds_read_b64_tr_b16 a[164:165], v8 offset:24576
 ds_read_b64_tr_b16 a[166:167], v8 offset:25600
 ds_read_b64_tr_b16 a[236:237], v9 offset:24576
 ds_read_b64_tr_b16 a[238:239], v9 offset:25600
 s_waitcnt vmcnt(8) lgkmcnt(0)
 s_barrier
 s_add_u32 m0, s49, 90112
 s_add_u32 s45, s32, 2359296
 buffer_load_dwordx4 v11, s[12:15], s45 offen nt lds
 s_add_u32 m0, s49, 94208
 s_add_u32 s45, s32, 2490368
 buffer_load_dwordx4 v11, s[12:15], s45 offen nt lds
 s_add_u32 m0, s49, 98304
 s_add_u32 s45, s33, 2359296
 buffer_load_dwordx4 v11, s[16:19], s45 offen nt lds
 s_add_u32 m0, s49, 102400
 s_add_u32 s45, s33, 2490368
 buffer_load_dwordx4 v11, s[16:19], s45 offen nt lds
 ds_read_b64_tr_b16 a[24:25], v8 offset:32768
 ds_read_b64_tr_b16 a[26:27], v8 offset:33792
 ds_read_b64_tr_b16 a[96:97], v9 offset:32768
 ds_read_b64_tr_b16 a[98:99], v9 offset:33792
 ds_read_b64_tr_b16 a[168:169], v8 offset:40960
 ds_read_b64_tr_b16 a[170:171], v8 offset:41984
 ds_read_b64_tr_b16 a[240:241], v9 offset:40960
 ds_read_b64_tr_b16 a[242:243], v9 offset:41984
 s_waitcnt vmcnt(8) lgkmcnt(0)
 s_barrier
 s_add_u32 m0, s49, 106496
 s_add_u32 s45, s32, 2621440
 buffer_load_dwordx4 v11, s[12:15], s45 offen nt lds
 s_add_u32 m0, s49, 110592
 s_add_u32 s45, s32, 2752512
 buffer_load_dwordx4 v11, s[12:15], s45 offen nt lds
 s_add_u32 m0, s49, 114688
 s_add_u32 s45, s33, 2621440
 buffer_load_dwordx4 v11, s[16:19], s45 offen nt lds
 s_add_u32 m0, s49, 118784
 s_add_u32 s45, s33, 2752512
 buffer_load_dwordx4 v11, s[16:19], s45 offen nt lds
 ds_read_b64_tr_b16 a[28:29], v8 offset:49152
 ds_read_b64_tr_b16 a[30:31], v8 offset:50176
 ds_read_b64_tr_b16 a[100:101], v9 offset:49152
 ds_read_b64_tr_b16 a[102:103], v9 offset:50176
 ds_read_b64_tr_b16 a[172:173], v8 offset:57344
 ds_read_b64_tr_b16 a[174:175], v8 offset:58368
 ds_read_b64_tr_b16 a[244:245], v9 offset:57344
 ds_read_b64_tr_b16 a[246:247], v9 offset:58368
 s_waitcnt vmcnt(8) lgkmcnt(0)
 s_barrier
 s_add_u32 m0, s49, 122880
 s_add_u32 s45, s32, 2883584
 buffer_load_dwordx4 v11, s[12:15], s45 offen nt lds
 s_add_u32 m0, s49, 126976
 s_add_u32 s45, s32, 3014656
 buffer_load_dwordx4 v11, s[12:15], s45 offen nt lds
 s_add_u32 m0, s49, 131072
 s_add_u32 s45, s33, 2883584
 buffer_load_dwordx4 v11, s[16:19], s45 offen nt lds
 s_add_u32 m0, s49, 135168
 s_add_u32 s45, s33, 3014656
 buffer_load_dwordx4 v11, s[16:19], s45 offen nt lds
 ds_read_b64_tr_b16 a[32:33], v8 offset:0
 ds_read_b64_tr_b16 a[34:35], v8 offset:1024
 ds_read_b64_tr_b16 a[104:105], v9 offset:0
 ds_read_b64_tr_b16 a[106:107], v9 offset:1024
 ds_read_b64_tr_b16 a[176:177], v8 offset:8192
 ds_read_b64_tr_b16 a[178:179], v8 offset:9216
 ds_read_b64_tr_b16 a[248:249], v9 offset:8192
 ds_read_b64_tr_b16 a[250:251], v9 offset:9216
 s_waitcnt vmcnt(8) lgkmcnt(0)
 s_barrier
 s_add_u32 m0, s49, 73728
 s_add_u32 s45, s32, 3145728
 buffer_load_dwordx4 v11, s[12:15], s45 offen nt lds
 s_add_u32 m0, s49, 77824
 s_add_u32 s45, s32, 3276800
 buffer_load_dwordx4 v11, s[12:15], s45 offen nt lds
 s_add_u32 m0, s49, 81920
 s_add_u32 s45, s33, 3145728
 buffer_load_dwordx4 v11, s[16:19], s45 offen nt lds
 s_add_u32 m0, s49, 86016
 s_add_u32 s45, s33, 3276800
 buffer_load_dwordx4 v11, s[16:19], s45 offen nt lds
 ds_read_b64_tr_b16 a[36:37], v8 offset:16384
 ds_read_b64_tr_b16 a[38:39], v8 offset:17408
 ds_read_b64_tr_b16 a[108:109], v9 offset:16384
 ds_read_b64_tr_b16 a[110:111], v9 offset:17408
 ds_read_b64_tr_b16 a[180:181], v8 offset:24576
 ds_read_b64_tr_b16 a[182:183], v8 offset:25600
 ds_read_b64_tr_b16 a[252:253], v9 offset:24576
 ds_read_b64_tr_b16 a[254:255], v9 offset:25600
 s_waitcnt vmcnt(8) lgkmcnt(0)
 s_barrier
 s_add_u32 m0, s49, 90112
 s_add_u32 s45, s32, 3407872
 buffer_load_dwordx4 v11, s[12:15], s45 offen nt lds
 s_add_u32 m0, s49, 94208
 s_add_u32 s45, s32, 3538944
 buffer_load_dwordx4 v11, s[12:15], s45 offen nt lds
 s_add_u32 m0, s49, 98304
 s_add_u32 s45, s33, 3407872
 buffer_load_dwordx4 v11, s[16:19], s45 offen nt lds
 s_add_u32 m0, s49, 102400
 s_add_u32 s45, s33, 3538944
 buffer_load_dwordx4 v11, s[16:19], s45 offen nt lds
 ds_read_b64_tr_b16 a[40:41], v8 offset:32768
 ds_read_b64_tr_b16 a[42:43], v8 offset:33792
 ds_read_b64_tr_b16 a[112:113], v9 offset:32768
 ds_read_b64_tr_b16 a[114:115], v9 offset:33792
 ds_read_b64_tr_b16 a[184:185], v8 offset:40960
 ds_read_b64_tr_b16 a[186:187], v8 offset:41984
 ds_read_b64_tr_b16 v[224:225], v9 offset:40960
 ds_read_b64_tr_b16 v[226:227], v9 offset:41984
 s_waitcnt vmcnt(8) lgkmcnt(0)
 s_barrier
 s_add_u32 m0, s49, 106496
 s_add_u32 s45, s32, 3670016
 buffer_load_dwordx4 v11, s[12:15], s45 offen nt lds
 s_add_u32 m0, s49, 110592
 s_add_u32 s45, s32, 3801088
 buffer_load_dwordx4 v11, s[12:15], s45 offen nt lds
 s_add_u32 m0, s49, 114688
 s_add_u32 s45, s33, 3670016
 buffer_load_dwordx4 v11, s[16:19], s45 offen nt lds
 s_add_u32 m0, s49, 118784
 s_add_u32 s45, s33, 3801088
 buffer_load_dwordx4 v11, s[16:19], s45 offen nt lds
 ds_read_b64_tr_b16 a[44:45], v8 offset:49152
 ds_read_b64_tr_b16 a[46:47], v8 offset:50176
 ds_read_b64_tr_b16 a[116:117], v9 offset:49152
 ds_read_b64_tr_b16 a[118:119], v9 offset:50176
 ds_read_b64_tr_b16 a[188:189], v8 offset:57344
 ds_read_b64_tr_b16 a[190:191], v8 offset:58368
 ds_read_b64_tr_b16 v[228:229], v9 offset:57344
 ds_read_b64_tr_b16 v[230:231], v9 offset:58368
 s_waitcnt vmcnt(8) lgkmcnt(0)
 s_barrier
 s_add_u32 m0, s49, 122880
 s_add_u32 s45, s32, 3932160
 buffer_load_dwordx4 v11, s[12:15], s45 offen nt lds
 s_add_u32 m0, s49, 126976
 s_add_u32 s45, s32, 4063232
 buffer_load_dwordx4 v11, s[12:15], s45 offen nt lds
 s_add_u32 m0, s49, 131072
 s_add_u32 s45, s33, 3932160
 buffer_load_dwordx4 v11, s[16:19], s45 offen nt lds
 s_add_u32 m0, s49, 135168
 s_add_u32 s45, s33, 4063232
 buffer_load_dwordx4 v11, s[16:19], s45 offen nt lds
 ds_read_b64_tr_b16 a[48:49], v8 offset:0
 ds_read_b64_tr_b16 a[50:51], v8 offset:1024
 ds_read_b64_tr_b16 a[120:121], v9 offset:0
 ds_read_b64_tr_b16 a[122:123], v9 offset:1024
 ds_read_b64_tr_b16 a[192:193], v8 offset:8192
 ds_read_b64_tr_b16 a[194:195], v8 offset:9216
 ds_read_b64_tr_b16 v[232:233], v9 offset:8192
 ds_read_b64_tr_b16 v[234:235], v9 offset:9216
 s_waitcnt vmcnt(8) lgkmcnt(0)
 s_barrier
 s_add_u32 m0, s49, 73728
 s_add_u32 s45, s32, 4194304
 buffer_load_dwordx4 v11, s[12:15], s45 offen nt lds
 s_add_u32 m0, s49, 77824
 s_add_u32 s45, s32, 4325376
 buffer_load_dwordx4 v11, s[12:15], s45 offen nt lds
 s_add_u32 m0, s49, 81920
 s_add_u32 s45, s33, 4194304
 buffer_load_dwordx4 v11, s[16:19], s45 offen nt lds
 s_add_u32 m0, s49, 86016
 s_add_u32 s45, s33, 4325376
 buffer_load_dwordx4 v11, s[16:19], s45 offen nt lds
 ds_read_b64_tr_b16 a[52:53], v8 offset:16384
 ds_read_b64_tr_b16 a[54:55], v8 offset:17408
 ds_read_b64_tr_b16 a[124:125], v9 offset:16384
 ds_read_b64_tr_b16 a[126:127], v9 offset:17408
 ds_read_b64_tr_b16 a[196:197], v8 offset:24576
 ds_read_b64_tr_b16 a[198:199], v8 offset:25600
 ds_read_b64_tr_b16 v[236:237], v9 offset:24576
 ds_read_b64_tr_b16 v[238:239], v9 offset:25600
 s_waitcnt vmcnt(8) lgkmcnt(0)
 s_barrier
 s_add_u32 m0, s49, 90112
 s_add_u32 s45, s32, 4456448
 buffer_load_dwordx4 v11, s[12:15], s45 offen nt lds
 s_add_u32 m0, s49, 94208
 s_add_u32 s45, s32, 4587520
 buffer_load_dwordx4 v11, s[12:15], s45 offen nt lds
 s_add_u32 m0, s49, 98304
 s_add_u32 s45, s33, 4456448
 buffer_load_dwordx4 v11, s[16:19], s45 offen nt lds
 s_add_u32 m0, s49, 102400
 s_add_u32 s45, s33, 4587520
 buffer_load_dwordx4 v11, s[16:19], s45 offen nt lds
 ds_read_b64_tr_b16 a[56:57], v8 offset:32768
 ds_read_b64_tr_b16 a[58:59], v8 offset:33792
 ds_read_b64_tr_b16 a[128:129], v9 offset:32768
 ds_read_b64_tr_b16 a[130:131], v9 offset:33792
 ds_read_b64_tr_b16 a[200:201], v8 offset:40960
 ds_read_b64_tr_b16 a[202:203], v8 offset:41984
 ds_read_b64_tr_b16 v[240:241], v9 offset:40960
 ds_read_b64_tr_b16 v[242:243], v9 offset:41984
 s_waitcnt vmcnt(8) lgkmcnt(0)
 s_barrier
 ds_read_b64_tr_b16 a[60:61], v8 offset:49152
 ds_read_b64_tr_b16 a[62:63], v8 offset:50176
 ds_read_b64_tr_b16 a[132:133], v9 offset:49152
 ds_read_b64_tr_b16 a[134:135], v9 offset:50176
 ds_read_b64_tr_b16 a[204:205], v8 offset:57344
 ds_read_b64_tr_b16 a[206:207], v8 offset:58368
 ds_read_b64_tr_b16 v[244:245], v9 offset:57344
 ds_read_b64_tr_b16 v[246:247], v9 offset:58368
 s_waitcnt vmcnt(4) lgkmcnt(0)
 s_barrier
 ds_read_b64_tr_b16 a[64:65], v8 offset:0
 ds_read_b64_tr_b16 a[66:67], v8 offset:1024
 ds_read_b64_tr_b16 a[136:137], v9 offset:0
 ds_read_b64_tr_b16 a[138:139], v9 offset:1024
 ds_read_b64_tr_b16 a[208:209], v8 offset:8192
 ds_read_b64_tr_b16 a[210:211], v8 offset:9216
 ds_read_b64_tr_b16 v[248:249], v9 offset:8192
 ds_read_b64_tr_b16 v[250:251], v9 offset:9216
 s_waitcnt vmcnt(0) lgkmcnt(0)
 s_barrier
 ds_read_b64_tr_b16 a[68:69], v8 offset:16384
 ds_read_b64_tr_b16 a[70:71], v8 offset:17408
 ds_read_b64_tr_b16 a[140:141], v9 offset:16384
 ds_read_b64_tr_b16 a[142:143], v9 offset:17408
 ds_read_b64_tr_b16 a[212:213], v8 offset:24576
 ds_read_b64_tr_b16 a[214:215], v8 offset:25600
 ds_read_b64_tr_b16 v[252:253], v9 offset:24576
 ds_read_b64_tr_b16 v[254:255], v9 offset:25600
 s_mov_b32 s50, 0x3e0293ee
 s_mov_b32 s42, 0
 s_mov_b32 s43, 0
 s_mov_b32 s44, 73728
 v_mov_b32 v6, v4
 v_mov_b32 v7, v5
 s_mov_b32 s95, 0x200000
 v_mov_b32 v21, 0
Lfr_16:
 buffer_load_dword v20, v21, s[28:31], 0 offen sc1
 s_waitcnt vmcnt(0)
 v_cmp_ne_u32 vcc, 0, v20
 s_cbranch_vccnz Lfrk_17
 s_sub_u32 s95, s95, 1
 s_cbranch_scc0 Lfr_16
 s_endpgm
Lfrk_17:
 s_lshl_b32 s47, s2, 13
 s_add_u32 s47, s47, 0x8000000
 s_mov_b32 s48, s47
 v_mov_b32 v14, 0
 s_waitcnt vmcnt(0) lgkmcnt(0)
 s_barrier
 ds_read_b128 v[32:35], v6 offset:0
 ds_read_b128 v[36:39], v6 offset:2048
 ds_read_b128 v[40:43], v7 offset:0
 ds_read_b128 v[44:47], v7 offset:2048
 s_waitcnt lgkmcnt(2)
Lps_loop_18:
 v_mfma_f32_16x16x32_bf16 v[64:67], a[0:3], v[32:35], 0
 ds_read_b128 v[48:51], v6 offset:4096
 v_mfma_f32_16x16x32_bf16 v[72:75], a[72:75], v[32:35], 0
 ds_read_b128 v[52:55], v6 offset:6144
 v_mfma_f32_16x16x32_bf16 v[80:83], v[32:35], a[144:147], 0
 s_add_u32 s41, s40, 1
 v_mfma_f32_16x16x32_bf16 v[88:91], v[32:35], a[216:219], 0
 s_add_u32 s45, s42, 2
 s_mul_i32 s46, s41, 36864
 v_mfma_f32_16x16x32_bf16 v[68:71], a[0:3], v[36:39], 0
 s_cmp_lt_u32 s45, s36
 s_cselect_b32 s46, s46, 0
 v_mfma_f32_16x16x32_bf16 v[76:79], a[72:75], v[36:39], 0
 s_lshl_b32 s49, s4, 10
 s_add_u32 s49, s49, s44
 v_mfma_f32_16x16x32_bf16 v[84:87], v[36:39], a[144:147], 0
 v_mfma_f32_16x16x32_bf16 v[92:95], v[36:39], a[216:219], 0
 s_waitcnt lgkmcnt(2)
 v_mfma_f32_16x16x32_bf16 v[64:67], a[4:7], v[40:43], v[64:67]
 ds_read_b128 v[56:59], v7 offset:4096
 v_mfma_f32_16x16x32_bf16 v[72:75], a[76:79], v[40:43], v[72:75]
 ds_read_b128 v[60:63], v7 offset:6144
 v_mfma_f32_16x16x32_bf16 v[80:83], v[40:43], a[148:151], v[80:83]
 s_add_u32 m0, s49, 0
 v_mfma_f32_16x16x32_bf16 v[88:91], v[40:43], a[220:223], v[88:91]
 buffer_load_dwordx4 v10, s[8:11], s46 offen offset:0  lds
 v_mfma_f32_16x16x32_bf16 v[68:71], a[4:7], v[44:47], v[68:71]
 s_add_u32 m0, s49, 3968
 v_mfma_f32_16x16x32_bf16 v[76:79], a[76:79], v[44:47], v[76:79]
 buffer_load_dwordx4 v10, s[8:11], s46 offen offset:128  lds
 v_mfma_f32_16x16x32_bf16 v[84:87], v[44:47], a[148:151], v[84:87]
 v_mfma_f32_16x16x32_bf16 v[92:95], v[44:47], a[220:223], v[92:95]
 s_waitcnt lgkmcnt(2)
 v_mfma_f32_16x16x32_bf16 v[64:67], a[8:11], v[48:51], v[64:67]
 ds_read_b128 v[32:35], v6 offset:8192
 v_mfma_f32_16x16x32_bf16 v[72:75], a[80:83], v[48:51], v[72:75]
 ds_read_b128 v[36:39], v6 offset:10240
 v_mfma_f32_16x16x32_bf16 v[80:83], v[48:51], a[152:155], v[80:83]
 s_add_u32 m0, s49, 7936
 v_mfma_f32_16x16x32_bf16 v[88:91], v[48:51], a[224:227], v[88:91]
 buffer_load_dwordx4 v10, s[8:11], s46 offen offset:256  lds
 v_mfma_f32_16x16x32_bf16 v[68:71], a[8:11], v[52:55], v[68:71]
 s_add_u32 m0, s49, 11904
 v_mfma_f32_16x16x32_bf16 v[76:79], a[80:83], v[52:55], v[76:79]
 buffer_load_dwordx4 v10, s[8:11], s46 offen offset:384  lds
 v_mfma_f32_16x16x32_bf16 v[84:87], v[52:55], a[152:155], v[84:87]
 v_mfma_f32_16x16x32_bf16 v[92:95], v[52:55], a[224:227], v[92:95]
 s_waitcnt lgkmcnt(2)
 v_mfma_f32_16x16x32_bf16 v[64:67], a[12:15], v[56:59], v[64:67]
 ds_read_b128 v[40:43], v7 offset:8192
 v_mfma_f32_16x16x32_bf16 v[72:75], a[84:87], v[56:59], v[72:75]
 ds_read_b128 v[44:47], v7 offset:10240
 v_mfma_f32_16x16x32_bf16 v[80:83], v[56:59], a[156:159], v[80:83]
 s_add_u32 m0, s49, 15872
 v_mfma_f32_16x16x32_bf16 v[88:91], v[56:59], a[228:231], v[88:91]
 buffer_load_dwordx4 v10, s[8:11], s46 offen offset:512  lds
 v_mfma_f32_16x16x32_bf16 v[68:71], a[12:15], v[60:63], v[68:71]
 s_add_u32 m0, s49, 19840
 v_mfma_f32_16x16x32_bf16 v[76:79], a[84:87], v[60:63], v[76:79]
 buffer_load_dwordx4 v10, s[8:11], s46 offen offset:640  lds
 v_mfma_f32_16x16x32_bf16 v[84:87], v[60:63], a[156:159], v[84:87]
 v_mfma_f32_16x16x32_bf16 v[92:95], v[60:63], a[228:231], v[92:95]
 s_waitcnt lgkmcnt(2)
 v_mfma_f32_16x16x32_bf16 v[64:67], a[16:19], v[32:35], v[64:67]
 ds_read_b128 v[48:51], v6 offset:12288
 v_mfma_f32_16x16x32_bf16 v[72:75], a[88:91], v[32:35], v[72:75]
 ds_read_b128 v[52:55], v6 offset:14336
 v_mfma_f32_16x16x32_bf16 v[80:83], v[32:35], a[160:163], v[80:83]
 s_add_u32 m0, s49, 23808
 v_mfma_f32_16x16x32_bf16 v[88:91], v[32:35], a[232:235], v[88:91]
 buffer_load_dwordx4 v10, s[8:11], s46 offen offset:768  lds
 v_mfma_f32_16x16x32_bf16 v[68:71], a[16:19], v[36:39], v[68:71]
 s_add_u32 m0, s49, 27776
 v_mfma_f32_16x16x32_bf16 v[76:79], a[88:91], v[36:39], v[76:79]
 buffer_load_dwordx4 v10, s[8:11], s46 offen offset:896  lds
 v_mfma_f32_16x16x32_bf16 v[84:87], v[36:39], a[160:163], v[84:87]
 v_mfma_f32_16x16x32_bf16 v[92:95], v[36:39], a[232:235], v[92:95]
 s_waitcnt lgkmcnt(2)
 v_mfma_f32_16x16x32_bf16 v[64:67], a[20:23], v[40:43], v[64:67]
 ds_read_b128 v[56:59], v7 offset:12288
 v_mfma_f32_16x16x32_bf16 v[72:75], a[92:95], v[40:43], v[72:75]
 ds_read_b128 v[60:63], v7 offset:14336
 v_mfma_f32_16x16x32_bf16 v[80:83], v[40:43], a[164:167], v[80:83]
 s_add_u32 m0, s49, 31744
 v_mfma_f32_16x16x32_bf16 v[88:91], v[40:43], a[236:239], v[88:91]
 buffer_load_dwordx4 v10, s[8:11], s46 offen offset:1024  lds
 v_mfma_f32_16x16x32_bf16 v[68:71], a[20:23], v[44:47], v[68:71]
 v_mfma_f32_16x16x32_bf16 v[76:79], a[92:95], v[44:47], v[76:79]
 v_mfma_f32_16x16x32_bf16 v[84:87], v[44:47], a[164:167], v[84:87]
 v_mfma_f32_16x16x32_bf16 v[92:95], v[44:47], a[236:239], v[92:95]
 s_waitcnt lgkmcnt(2)
 v_mfma_f32_16x16x32_bf16 v[64:67], a[24:27], v[48:51], v[64:67]
 ds_read_b128 v[32:35], v6 offset:16384
 v_mfma_f32_16x16x32_bf16 v[72:75], a[96:99], v[48:51], v[72:75]
 ds_read_b128 v[36:39], v6 offset:18432
 v_mfma_f32_16x16x32_bf16 v[80:83], v[48:51], a[168:171], v[80:83]
 v_cvt_pk_bf16_f32 v16, v96, v97
 v_mfma_f32_16x16x32_bf16 v[88:91], v[48:51], a[240:243], v[88:91]
 v_mfma_f32_16x16x32_bf16 v[68:71], a[24:27], v[52:55], v[68:71]
 v_cvt_pk_bf16_f32 v17, v104, v105
 v_mfma_f32_16x16x32_bf16 v[76:79], a[96:99], v[52:55], v[76:79]
 v_mfma_f32_16x16x32_bf16 v[84:87], v[52:55], a[168:171], v[84:87]
 v_cvt_pk_bf16_f32 v18, v98, v99
 v_mfma_f32_16x16x32_bf16 v[92:95], v[52:55], a[240:243], v[92:95]
 s_waitcnt lgkmcnt(2)
 v_mfma_f32_16x16x32_bf16 v[64:67], a[28:31], v[56:59], v[64:67]
 ds_read_b128 v[40:43], v7 offset:16384
 v_mfma_f32_16x16x32_bf16 v[72:75], a[100:103], v[56:59], v[72:75]
 ds_read_b128 v[44:47], v7 offset:18432
 v_mfma_f32_16x16x32_bf16 v[80:83], v[56:59], a[172:175], v[80:83]
 v_mfma_f32_16x16x32_bf16 v[88:91], v[56:59], a[244:247], v[88:91]
 v_cvt_pk_bf16_f32 v19, v106, v107
 v_mfma_f32_16x16x32_bf16 v[68:71], a[28:31], v[60:63], v[68:71]
 v_mfma_f32_16x16x32_bf16 v[76:79], a[100:103], v[60:63], v[76:79]
 v_mfma_f32_16x16x32_bf16 v[84:87], v[60:63], a[172:175], v[84:87]
 buffer_store_dwordx4 v[16:19], v12, s[20:23], s47 offen offset:0 sc1
 v_mfma_f32_16x16x32_bf16 v[92:95], v[60:63], a[244:247], v[92:95]
 s_waitcnt lgkmcnt(2)
 v_mfma_f32_16x16x32_bf16 v[64:67], a[32:35], v[32:35], v[64:67]
 ds_read_b128 v[48:51], v6 offset:20480
 v_mfma_f32_16x16x32_bf16 v[72:75], a[104:107], v[32:35], v[72:75]
 ds_read_b128 v[52:55], v6 offset:22528
 v_mfma_f32_16x16x32_bf16 v[80:83], v[32:35], a[176:179], v[80:83]
 v_mfma_f32_16x16x32_bf16 v[88:91], v[32:35], a[248:251], v[88:91]
 v_cvt_pk_bf16_f32 v20, v100, v101
 v_mfma_f32_16x16x32_bf16 v[68:71], a[32:35], v[36:39], v[68:71]
 v_mfma_f32_16x16x32_bf16 v[76:79], a[104:107], v[36:39], v[76:79]
 v_cvt_pk_bf16_f32 v21, v108, v109
 v_mfma_f32_16x16x32_bf16 v[84:87], v[36:39], a[176:179], v[84:87]
 v_mfma_f32_16x16x32_bf16 v[92:95], v[36:39], a[248:251], v[92:95]
 s_waitcnt lgkmcnt(2)
 v_mfma_f32_16x16x32_bf16 v[64:67], a[36:39], v[40:43], v[64:67]
 ds_read_b128 v[56:59], v7 offset:20480
 v_mfma_f32_16x16x32_bf16 v[72:75], a[108:111], v[40:43], v[72:75]
 ds_read_b128 v[60:63], v7 offset:22528
 v_mfma_f32_16x16x32_bf16 v[80:83], v[40:43], a[180:183], v[80:83]
 v_cvt_pk_bf16_f32 v22, v102, v103
 v_mfma_f32_16x16x32_bf16 v[88:91], v[40:43], a[252:255], v[88:91]
 v_mfma_f32_16x16x32_bf16 v[68:71], a[36:39], v[44:47], v[68:71]
 v_mfma_f32_16x16x32_bf16 v[76:79], a[108:111], v[44:47], v[76:79]
 v_cvt_pk_bf16_f32 v23, v110, v111
 v_mfma_f32_16x16x32_bf16 v[84:87], v[44:47], a[180:183], v[84:87]
 v_mfma_f32_16x16x32_bf16 v[92:95], v[44:47], a[252:255], v[92:95]
 s_waitcnt lgkmcnt(2)
 v_mfma_f32_16x16x32_bf16 v[64:67], a[40:43], v[48:51], v[64:67]
 ds_read_b128 v[32:35], v6 offset:24576
 v_mfma_f32_16x16x32_bf16 v[72:75], a[112:115], v[48:51], v[72:75]
 ds_read_b128 v[36:39], v6 offset:26624
 v_mfma_f32_16x16x32_bf16 v[80:83], v[48:51], a[184:187], v[80:83]
 buffer_store_dwordx4 v[20:23], v12, s[20:23], s47 offen offset:1024 sc1
 v_mfma_f32_16x16x32_bf16 v[88:91], v[48:51], v[224:227], v[88:91]
 v_mfma_f32_16x16x32_bf16 v[68:71], a[40:43], v[52:55], v[68:71]
 v_cvt_pk_bf16_f32 v24, v112, v113
 v_mfma_f32_16x16x32_bf16 v[76:79], a[112:115], v[52:55], v[76:79]
 v_mfma_f32_16x16x32_bf16 v[84:87], v[52:55], a[184:187], v[84:87]
 v_cvt_pk_bf16_f32 v25, v116, v117
 v_mfma_f32_16x16x32_bf16 v[92:95], v[52:55], v[224:227], v[92:95]
 s_waitcnt lgkmcnt(2)
 v_mfma_f32_16x16x32_bf16 v[64:67], a[44:47], v[56:59], v[64:67]
 ds_read_b128 v[40:43], v7 offset:24576
 v_mfma_f32_16x16x32_bf16 v[72:75], a[116:119], v[56:59], v[72:75]
 ds_read_b128 v[44:47], v7 offset:26624
 v_mfma_f32_16x16x32_bf16 v[80:83], v[56:59], a[188:191], v[80:83]
 v_mfma_f32_16x16x32_bf16 v[88:91], v[56:59], v[228:231], v[88:91]
 v_mfma_f32_16x16x32_bf16 v[68:71], a[44:47], v[60:63], v[68:71]
 v_cvt_pk_bf16_f32 v26, v114, v115
 v_mfma_f32_16x16x32_bf16 v[76:79], a[116:119], v[60:63], v[76:79]
 v_mfma_f32_16x16x32_bf16 v[84:87], v[60:63], a[188:191], v[84:87]
 v_cvt_pk_bf16_f32 v27, v118, v119
 v_mfma_f32_16x16x32_bf16 v[92:95], v[60:63], v[228:231], v[92:95]
 s_waitcnt lgkmcnt(2)
 v_mfma_f32_16x16x32_bf16 v[64:67], a[48:51], v[32:35], v[64:67]
 ds_read_b128 v[48:51], v6 offset:28672
 v_mfma_f32_16x16x32_bf16 v[72:75], a[120:123], v[32:35], v[72:75]
 ds_read_b128 v[52:55], v6 offset:30720
 v_mfma_f32_16x16x32_bf16 v[80:83], v[32:35], a[192:195], v[80:83]
 v_mfma_f32_16x16x32_bf16 v[88:91], v[32:35], v[232:235], v[88:91]
 buffer_store_dwordx4 v[24:27], v12, s[20:23], s48 offen offset:0 sc1
 v_mfma_f32_16x16x32_bf16 v[68:71], a[48:51], v[36:39], v[68:71]
 v_mfma_f32_16x16x32_bf16 v[76:79], a[120:123], v[36:39], v[76:79]
 v_cvt_pk_bf16_f32 v28, v120, v121
 v_mfma_f32_16x16x32_bf16 v[84:87], v[36:39], a[192:195], v[84:87]
 v_mfma_f32_16x16x32_bf16 v[92:95], v[36:39], v[232:235], v[92:95]
 s_waitcnt lgkmcnt(2)
 v_mfma_f32_16x16x32_bf16 v[64:67], a[52:55], v[40:43], v[64:67]
 ds_read_b128 v[56:59], v7 offset:28672
 v_mfma_f32_16x16x32_bf16 v[72:75], a[124:127], v[40:43], v[72:75]
 ds_read_b128 v[60:63], v7 offset:30720
 v_mfma_f32_16x16x32_bf16 v[80:83], v[40:43], a[196:199], v[80:83]
 s_add_u32 s43, s43, 36864
 s_cmp_eq_u32 s43, 147456
 v_mfma_f32_16x16x32_bf16 v[88:91], v[40:43], v[236:239], v[88:91]
 s_cselect_b32 s43, 0, s43
 s_add_u32 s44, s44, 36864
 v_mfma_f32_16x16x32_bf16 v[68:71], a[52:55], v[44:47], v[68:71]
 s_cmp_eq_u32 s44, 147456
 s_cselect_b32 s44, 0, s44
 v_mfma_f32_16x16x32_bf16 v[76:79], a[124:127], v[44:47], v[76:79]
 v_mfma_f32_16x16x32_bf16 v[84:87], v[44:47], a[196:199], v[84:87]
 v_cvt_pk_bf16_f32 v29, v124, v125
 v_mfma_f32_16x16x32_bf16 v[92:95], v[44:47], v[236:239], v[92:95]
 s_waitcnt lgkmcnt(2)
 v_mfma_f32_16x16x32_bf16 v[64:67], a[56:59], v[48:51], v[64:67]
 ds_read_b128 v[32:35], v6 offset:32768
 v_mfma_f32_16x16x32_bf16 v[72:75], a[128:131], v[48:51], v[72:75]
 ds_read_b128 v[36:39], v6 offset:34816
 v_mfma_f32_16x16x32_bf16 v[80:83], v[48:51], a[200:203], v[80:83]
 v_add_u32 v6, s43, v4
 v_mfma_f32_16x16x32_bf16 v[88:91], v[48:51], v[240:243], v[88:91]
 v_mfma_f32_16x16x32_bf16 v[68:71], a[56:59], v[52:55], v[68:71]
 v_cvt_pk_bf16_f32 v30, v122, v123
 v_mfma_f32_16x16x32_bf16 v[76:79], a[128:131], v[52:55], v[76:79]
 v_mfma_f32_16x16x32_bf16 v[84:87], v[52:55], a[200:203], v[84:87]
 v_cvt_pk_bf16_f32 v31, v126, v127
 v_mfma_f32_16x16x32_bf16 v[92:95], v[52:55], v[240:243], v[92:95]
 s_waitcnt lgkmcnt(2)
 v_mfma_f32_16x16x32_bf16 v[64:67], a[60:63], v[56:59], v[64:67]
 ds_read_b128 v[40:43], v7 offset:32768
 v_mfma_f32_16x16x32_bf16 v[72:75], a[132:135], v[56:59], v[72:75]
 ds_read_b128 v[44:47], v7 offset:34816
 v_mfma_f32_16x16x32_bf16 v[80:83], v[56:59], a[204:207], v[80:83]
 v_add_u32 v7, s43, v5
 v_mfma_f32_16x16x32_bf16 v[88:91], v[56:59], v[244:247], v[88:91]
 v_mfma_f32_16x16x32_bf16 v[68:71], a[60:63], v[60:63], v[68:71]
 buffer_store_dwordx4 v[28:31], v12, s[20:23], s48 offen offset:1024 sc1
 v_mfma_f32_16x16x32_bf16 v[76:79], a[132:135], v[60:63], v[76:79]
 v_mfma_f32_16x16x32_bf16 v[84:87], v[60:63], a[204:207], v[84:87]
 v_mfma_f32_16x16x32_bf16 v[92:95], v[60:63], v[244:247], v[92:95]
 s_waitcnt lgkmcnt(2)
 v_mfma_f32_16x16x32_bf16 v[64:67], a[64:67], v[32:35], v[64:67]
 s_waitcnt vmcnt(13)
 s_barrier
 ds_read_b128 v[48:51], v6 offset:0
 v_mfma_f32_16x16x32_bf16 v[72:75], a[136:139], v[32:35], v[72:75]
 ds_read_b128 v[52:55], v6 offset:2048
 v_mfma_f32_16x16x32_bf16 v[80:83], v[32:35], a[208:211], v[80:83]
 buffer_store_dword v14, v13, s[20:23], 0 offen sc1
 v_mfma_f32_16x16x32_bf16 v[88:91], v[32:35], v[248:251], v[88:91]
 v_mfma_f32_16x16x32_bf16 v[68:71], a[64:67], v[36:39], v[68:71]
 v_mfma_f32_16x16x32_bf16 v[76:79], a[136:139], v[36:39], v[76:79]
 v_mfma_f32_16x16x32_bf16 v[84:87], v[36:39], a[208:211], v[84:87]
 v_mfma_f32_16x16x32_bf16 v[92:95], v[36:39], v[248:251], v[92:95]
 s_waitcnt lgkmcnt(2)
 v_mfma_f32_16x16x32_bf16 v[64:67], a[68:71], v[40:43], v[64:67]
 ds_read_b128 v[56:59], v7 offset:0
 v_mfma_f32_16x16x32_bf16 v[72:75], a[140:143], v[40:43], v[72:75]
 ds_read_b128 v[60:63], v7 offset:2048
 v_mfma_f32_16x16x32_bf16 v[80:83], v[40:43], a[212:215], v[80:83]
 s_mul_i32 s45, s39, 524288
 s_add_u32 s47, s34, s45
 v_mfma_f32_16x16x32_bf16 v[88:91], v[40:43], v[252:255], v[88:91]
 s_add_u32 s48, s35, s45
 v_mov_b32 v14, s42
 v_mfma_f32_16x16x32_bf16 v[68:71], a[68:71], v[44:47], v[68:71]
 s_mov_b32 s39, s40
 s_mov_b32 s40, s41
 v_mfma_f32_16x16x32_bf16 v[76:79], a[140:143], v[44:47], v[76:79]
 s_add_u32 s42, s42, 1
 v_mfma_f32_16x16x32_bf16 v[84:87], v[44:47], a[212:215], v[84:87]
 v_mfma_f32_16x16x32_bf16 v[92:95], v[44:47], v[252:255], v[92:95]
 s_waitcnt lgkmcnt(2)
 v_mfma_f32_16x16x32_bf16 v[96:99], a[0:3], v[48:51], 0
 ds_read_b128 v[32:35], v6 offset:4096
 v_mfma_f32_16x16x32_bf16 v[104:107], a[72:75], v[48:51], 0
 ds_read_b128 v[36:39], v6 offset:6144
 v_mfma_f32_16x16x32_bf16 v[112:115], v[48:51], a[144:147], 0
 s_add_u32 s41, s40, 1
 v_mfma_f32_16x16x32_bf16 v[120:123], v[48:51], a[216:219], 0
 s_add_u32 s45, s42, 2
 s_mul_i32 s46, s41, 36864
 v_mfma_f32_16x16x32_bf16 v[100:103], a[0:3], v[52:55], 0
 s_cmp_lt_u32 s45, s36
 s_cselect_b32 s46, s46, 0
 v_mfma_f32_16x16x32_bf16 v[108:111], a[72:75], v[52:55], 0
 s_lshl_b32 s49, s4, 10
 s_add_u32 s49, s49, s44
 v_mfma_f32_16x16x32_bf16 v[116:119], v[52:55], a[144:147], 0
 v_mfma_f32_16x16x32_bf16 v[124:127], v[52:55], a[216:219], 0
 s_waitcnt lgkmcnt(2)
 v_mfma_f32_16x16x32_bf16 v[96:99], a[4:7], v[56:59], v[96:99]
 ds_read_b128 v[40:43], v7 offset:4096
 v_mfma_f32_16x16x32_bf16 v[104:107], a[76:79], v[56:59], v[104:107]
 ds_read_b128 v[44:47], v7 offset:6144
 v_mfma_f32_16x16x32_bf16 v[112:115], v[56:59], a[148:151], v[112:115]
 s_add_u32 m0, s49, 0
 v_mfma_f32_16x16x32_bf16 v[120:123], v[56:59], a[220:223], v[120:123]
 buffer_load_dwordx4 v10, s[8:11], s46 offen offset:0  lds
 v_mfma_f32_16x16x32_bf16 v[100:103], a[4:7], v[60:63], v[100:103]
 s_add_u32 m0, s49, 3968
 v_mfma_f32_16x16x32_bf16 v[108:111], a[76:79], v[60:63], v[108:111]
 buffer_load_dwordx4 v10, s[8:11], s46 offen offset:128  lds
 v_mfma_f32_16x16x32_bf16 v[116:119], v[60:63], a[148:151], v[116:119]
 v_mfma_f32_16x16x32_bf16 v[124:127], v[60:63], a[220:223], v[124:127]
 s_waitcnt lgkmcnt(2)
 v_mfma_f32_16x16x32_bf16 v[96:99], a[8:11], v[32:35], v[96:99]
 ds_read_b128 v[48:51], v6 offset:8192
 v_mfma_f32_16x16x32_bf16 v[104:107], a[80:83], v[32:35], v[104:107]
 ds_read_b128 v[52:55], v6 offset:10240
 v_mfma_f32_16x16x32_bf16 v[112:115], v[32:35], a[152:155], v[112:115]
 s_add_u32 m0, s49, 7936
 v_mfma_f32_16x16x32_bf16 v[120:123], v[32:35], a[224:227], v[120:123]
 buffer_load_dwordx4 v10, s[8:11], s46 offen offset:256  lds
 v_mfma_f32_16x16x32_bf16 v[100:103], a[8:11], v[36:39], v[100:103]
 s_add_u32 m0, s49, 11904
 v_mfma_f32_16x16x32_bf16 v[108:111], a[80:83], v[36:39], v[108:111]
 buffer_load_dwordx4 v10, s[8:11], s46 offen offset:384  lds
 v_mfma_f32_16x16x32_bf16 v[116:119], v[36:39], a[152:155], v[116:119]
 v_mfma_f32_16x16x32_bf16 v[124:127], v[36:39], a[224:227], v[124:127]
 s_waitcnt lgkmcnt(2)
 v_mfma_f32_16x16x32_bf16 v[96:99], a[12:15], v[40:43], v[96:99]
 ds_read_b128 v[56:59], v7 offset:8192
 v_mfma_f32_16x16x32_bf16 v[104:107], a[84:87], v[40:43], v[104:107]
 ds_read_b128 v[60:63], v7 offset:10240
 v_mfma_f32_16x16x32_bf16 v[112:115], v[40:43], a[156:159], v[112:115]
 s_add_u32 m0, s49, 15872
 v_mfma_f32_16x16x32_bf16 v[120:123], v[40:43], a[228:231], v[120:123]
 buffer_load_dwordx4 v10, s[8:11], s46 offen offset:512  lds
 v_mfma_f32_16x16x32_bf16 v[100:103], a[12:15], v[44:47], v[100:103]
 s_add_u32 m0, s49, 19840
 v_mfma_f32_16x16x32_bf16 v[108:111], a[84:87], v[44:47], v[108:111]
 buffer_load_dwordx4 v10, s[8:11], s46 offen offset:640  lds
 v_mfma_f32_16x16x32_bf16 v[116:119], v[44:47], a[156:159], v[116:119]
 v_mfma_f32_16x16x32_bf16 v[124:127], v[44:47], a[228:231], v[124:127]
 s_waitcnt lgkmcnt(2)
 v_mfma_f32_16x16x32_bf16 v[96:99], a[16:19], v[48:51], v[96:99]
 ds_read_b128 v[32:35], v6 offset:12288
 v_mfma_f32_16x16x32_bf16 v[104:107], a[88:91], v[48:51], v[104:107]
 ds_read_b128 v[36:39], v6 offset:14336
 v_mfma_f32_16x16x32_bf16 v[112:115], v[48:51], a[160:163], v[112:115]
 s_add_u32 m0, s49, 23808
 v_mfma_f32_16x16x32_bf16 v[120:123], v[48:51], a[232:235], v[120:123]
 buffer_load_dwordx4 v10, s[8:11], s46 offen offset:768  lds
 v_mfma_f32_16x16x32_bf16 v[100:103], a[16:19], v[52:55], v[100:103]
 s_add_u32 m0, s49, 27776
 v_mfma_f32_16x16x32_bf16 v[108:111], a[88:91], v[52:55], v[108:111]
 buffer_load_dwordx4 v10, s[8:11], s46 offen offset:896  lds
 v_mfma_f32_16x16x32_bf16 v[116:119], v[52:55], a[160:163], v[116:119]
 v_mfma_f32_16x16x32_bf16 v[124:127], v[52:55], a[232:235], v[124:127]
 s_waitcnt lgkmcnt(2)
 v_mfma_f32_16x16x32_bf16 v[96:99], a[20:23], v[56:59], v[96:99]
 ds_read_b128 v[40:43], v7 offset:12288
 v_mfma_f32_16x16x32_bf16 v[104:107], a[92:95], v[56:59], v[104:107]
 ds_read_b128 v[44:47], v7 offset:14336
 v_mfma_f32_16x16x32_bf16 v[112:115], v[56:59], a[164:167], v[112:115]
 s_add_u32 m0, s49, 31744
 v_mfma_f32_16x16x32_bf16 v[120:123], v[56:59], a[236:239], v[120:123]
 buffer_load_dwordx4 v10, s[8:11], s46 offen offset:1024  lds
 v_mfma_f32_16x16x32_bf16 v[100:103], a[20:23], v[60:63], v[100:103]
 v_mfma_f32_16x16x32_bf16 v[108:111], a[92:95], v[60:63], v[108:111]
 v_mfma_f32_16x16x32_bf16 v[116:119], v[60:63], a[164:167], v[116:119]
 v_mfma_f32_16x16x32_bf16 v[124:127], v[60:63], a[236:239], v[124:127]
 s_waitcnt lgkmcnt(2)
 v_mfma_f32_16x16x32_bf16 v[96:99], a[24:27], v[32:35], v[96:99]
 ds_read_b128 v[48:51], v6 offset:16384
 v_mfma_f32_16x16x32_bf16 v[104:107], a[96:99], v[32:35], v[104:107]
 ds_read_b128 v[52:55], v6 offset:18432
 v_mfma_f32_16x16x32_bf16 v[112:115], v[32:35], a[168:171], v[112:115]
 v_cvt_pk_bf16_f32 v16, v64, v65
 v_mfma_f32_16x16x32_bf16 v[120:123], v[32:35], a[240:243], v[120:123]
 v_mfma_f32_16x16x32_bf16 v[100:103], a[24:27], v[36:39], v[100:103]
 v_cvt_pk_bf16_f32 v17, v72, v73
 v_mfma_f32_16x16x32_bf16 v[108:111], a[96:99], v[36:39], v[108:111]
 v_mfma_f32_16x16x32_bf16 v[116:119], v[36:39], a[168:171], v[116:119]
 v_cvt_pk_bf16_f32 v18, v66, v67
 v_mfma_f32_16x16x32_bf16 v[124:127], v[36:39], a[240:243], v[124:127]
 s_waitcnt lgkmcnt(2)
 v_mfma_f32_16x16x32_bf16 v[96:99], a[28:31], v[40:43], v[96:99]
 ds_read_b128 v[56:59], v7 offset:16384
 v_mfma_f32_16x16x32_bf16 v[104:107], a[100:103], v[40:43], v[104:107]
 ds_read_b128 v[60:63], v7 offset:18432
 v_mfma_f32_16x16x32_bf16 v[112:115], v[40:43], a[172:175], v[112:115]
 v_mfma_f32_16x16x32_bf16 v[120:123], v[40:43], a[244:247], v[120:123]
 v_cvt_pk_bf16_f32 v19, v74, v75
 v_mfma_f32_16x16x32_bf16 v[100:103], a[28:31], v[44:47], v[100:103]
 v_mfma_f32_16x16x32_bf16 v[108:111], a[100:103], v[44:47], v[108:111]
 v_mfma_f32_16x16x32_bf16 v[116:119], v[44:47], a[172:175], v[116:119]
 buffer_store_dwordx4 v[16:19], v12, s[20:23], s47 offen offset:0 sc1
 v_mfma_f32_16x16x32_bf16 v[124:127], v[44:47], a[244:247], v[124:127]
 s_waitcnt lgkmcnt(2)
 v_mfma_f32_16x16x32_bf16 v[96:99], a[32:35], v[48:51], v[96:99]
 ds_read_b128 v[32:35], v6 offset:20480
 v_mfma_f32_16x16x32_bf16 v[104:107], a[104:107], v[48:51], v[104:107]
 ds_read_b128 v[36:39], v6 offset:22528
 v_mfma_f32_16x16x32_bf16 v[112:115], v[48:51], a[176:179], v[112:115]
 v_mfma_f32_16x16x32_bf16 v[120:123], v[48:51], a[248:251], v[120:123]
 v_cvt_pk_bf16_f32 v20, v68, v69
 v_mfma_f32_16x16x32_bf16 v[100:103], a[32:35], v[52:55], v[100:103]
 v_mfma_f32_16x16x32_bf16 v[108:111], a[104:107], v[52:55], v[108:111]
 v_cvt_pk_bf16_f32 v21, v76, v77
 v_mfma_f32_16x16x32_bf16 v[116:119], v[52:55], a[176:179], v[116:119]
 v_mfma_f32_16x16x32_bf16 v[124:127], v[52:55], a[248:251], v[124:127]
 s_waitcnt lgkmcnt(2)
 v_mfma_f32_16x16x32_bf16 v[96:99], a[36:39], v[56:59], v[96:99]
 ds_read_b128 v[40:43], v7 offset:20480
 v_mfma_f32_16x16x32_bf16 v[104:107], a[108:111], v[56:59], v[104:107]
 ds_read_b128 v[44:47], v7 offset:22528
 v_mfma_f32_16x16x32_bf16 v[112:115], v[56:59], a[180:183], v[112:115]
 v_cvt_pk_bf16_f32 v22, v70, v71
 v_mfma_f32_16x16x32_bf16 v[120:123], v[56:59], a[252:255], v[120:123]
 v_mfma_f32_16x16x32_bf16 v[100:103], a[36:39], v[60:63], v[100:103]
 v_mfma_f32_16x16x32_bf16 v[108:111], a[108:111], v[60:63], v[108:111]
 v_cvt_pk_bf16_f32 v23, v78, v79
 v_mfma_f32_16x16x32_bf16 v[116:119], v[60:63], a[180:183], v[116:119]
 v_mfma_f32_16x16x32_bf16 v[124:127], v[60:63], a[252:255], v[124:127]
 s_waitcnt lgkmcnt(2)
 v_mfma_f32_16x16x32_bf16 v[96:99], a[40:43], v[32:35], v[96:99]
 ds_read_b128 v[48:51], v6 offset:24576
 v_mfma_f32_16x16x32_bf16 v[104:107], a[112:115], v[32:35], v[104:107]
 ds_read_b128 v[52:55], v6 offset:26624
 v_mfma_f32_16x16x32_bf16 v[112:115], v[32:35], a[184:187], v[112:115]
 buffer_store_dwordx4 v[20:23], v12, s[20:23], s47 offen offset:1024 sc1
 v_mfma_f32_16x16x32_bf16 v[120:123], v[32:35], v[224:227], v[120:123]
 v_mfma_f32_16x16x32_bf16 v[100:103], a[40:43], v[36:39], v[100:103]
 v_cvt_pk_bf16_f32 v24, v80, v81
 v_mfma_f32_16x16x32_bf16 v[108:111], a[112:115], v[36:39], v[108:111]
 v_mfma_f32_16x16x32_bf16 v[116:119], v[36:39], a[184:187], v[116:119]
 v_cvt_pk_bf16_f32 v25, v84, v85
 v_mfma_f32_16x16x32_bf16 v[124:127], v[36:39], v[224:227], v[124:127]
 s_waitcnt lgkmcnt(2)
 v_mfma_f32_16x16x32_bf16 v[96:99], a[44:47], v[40:43], v[96:99]
 ds_read_b128 v[56:59], v7 offset:24576
 v_mfma_f32_16x16x32_bf16 v[104:107], a[116:119], v[40:43], v[104:107]
 ds_read_b128 v[60:63], v7 offset:26624
 v_mfma_f32_16x16x32_bf16 v[112:115], v[40:43], a[188:191], v[112:115]
 v_mfma_f32_16x16x32_bf16 v[120:123], v[40:43], v[228:231], v[120:123]
 v_mfma_f32_16x16x32_bf16 v[100:103], a[44:47], v[44:47], v[100:103]
 v_cvt_pk_bf16_f32 v26, v82, v83
 v_mfma_f32_16x16x32_bf16 v[108:111], a[116:119], v[44:47], v[108:111]
 v_mfma_f32_16x16x32_bf16 v[116:119], v[44:47], a[188:191], v[116:119]
 v_cvt_pk_bf16_f32 v27, v86, v87
 v_mfma_f32_16x16x32_bf16 v[124:127], v[44:47], v[228:231], v[124:127]
 s_waitcnt lgkmcnt(2)
 v_mfma_f32_16x16x32_bf16 v[96:99], a[48:51], v[48:51], v[96:99]
 ds_read_b128 v[32:35], v6 offset:28672
 v_mfma_f32_16x16x32_bf16 v[104:107], a[120:123], v[48:51], v[104:107]
 ds_read_b128 v[36:39], v6 offset:30720
 v_mfma_f32_16x16x32_bf16 v[112:115], v[48:51], a[192:195], v[112:115]
 v_mfma_f32_16x16x32_bf16 v[120:123], v[48:51], v[232:235], v[120:123]
 buffer_store_dwordx4 v[24:27], v12, s[20:23], s48 offen offset:0 sc1
 v_mfma_f32_16x16x32_bf16 v[100:103], a[48:51], v[52:55], v[100:103]
 v_mfma_f32_16x16x32_bf16 v[108:111], a[120:123], v[52:55], v[108:111]
 v_cvt_pk_bf16_f32 v28, v88, v89
 v_mfma_f32_16x16x32_bf16 v[116:119], v[52:55], a[192:195], v[116:119]
 v_mfma_f32_16x16x32_bf16 v[124:127], v[52:55], v[232:235], v[124:127]
 s_waitcnt lgkmcnt(2)
 v_mfma_f32_16x16x32_bf16 v[96:99], a[52:55], v[56:59], v[96:99]
 ds_read_b128 v[40:43], v7 offset:28672
 v_mfma_f32_16x16x32_bf16 v[104:107], a[124:127], v[56:59], v[104:107]
 ds_read_b128 v[44:47], v7 offset:30720
 v_mfma_f32_16x16x32_bf16 v[112:115], v[56:59], a[196:199], v[112:115]
 s_add_u32 s43, s43, 36864
 s_cmp_eq_u32 s43, 147456
 v_mfma_f32_16x16x32_bf16 v[120:123], v[56:59], v[236:239], v[120:123]
 s_cselect_b32 s43, 0, s43
 s_add_u32 s44, s44, 36864
 v_mfma_f32_16x16x32_bf16 v[100:103], a[52:55], v[60:63], v[100:103]
 s_cmp_eq_u32 s44, 147456
 s_cselect_b32 s44, 0, s44
 v_mfma_f32_16x16x32_bf16 v[108:111], a[124:127], v[60:63], v[108:111]
 v_mfma_f32_16x16x32_bf16 v[116:119], v[60:63], a[196:199], v[116:119]
 v_cvt_pk_bf16_f32 v29, v92, v93
 v_mfma_f32_16x16x32_bf16 v[124:127], v[60:63], v[236:239], v[124:127]
 s_waitcnt lgkmcnt(2)
 v_mfma_f32_16x16x32_bf16 v[96:99], a[56:59], v[32:35], v[96:99]
 ds_read_b128 v[48:51], v6 offset:32768
 v_mfma_f32_16x16x32_bf16 v[104:107], a[128:131], v[32:35], v[104:107]
 ds_read_b128 v[52:55], v6 offset:34816
 v_mfma_f32_16x16x32_bf16 v[112:115], v[32:35], a[200:203], v[112:115]
 v_add_u32 v6, s43, v4
 v_mfma_f32_16x16x32_bf16 v[120:123], v[32:35], v[240:243], v[120:123]
 v_mfma_f32_16x16x32_bf16 v[100:103], a[56:59], v[36:39], v[100:103]
 v_cvt_pk_bf16_f32 v30, v90, v91
 v_mfma_f32_16x16x32_bf16 v[108:111], a[128:131], v[36:39], v[108:111]
 v_mfma_f32_16x16x32_bf16 v[116:119], v[36:39], a[200:203], v[116:119]
 v_cvt_pk_bf16_f32 v31, v94, v95
 v_mfma_f32_16x16x32_bf16 v[124:127], v[36:39], v[240:243], v[124:127]
 s_waitcnt lgkmcnt(2)
 v_mfma_f32_16x16x32_bf16 v[96:99], a[60:63], v[40:43], v[96:99]
 ds_read_b128 v[56:59], v7 offset:32768
 v_mfma_f32_16x16x32_bf16 v[104:107], a[132:135], v[40:43], v[104:107]
 ds_read_b128 v[60:63], v7 offset:34816
 v_mfma_f32_16x16x32_bf16 v[112:115], v[40:43], a[204:207], v[112:115]
 v_add_u32 v7, s43, v5
 v_mfma_f32_16x16x32_bf16 v[120:123], v[40:43], v[244:247], v[120:123]
 v_mfma_f32_16x16x32_bf16 v[100:103], a[60:63], v[44:47], v[100:103]
 buffer_store_dwordx4 v[28:31], v12, s[20:23], s48 offen offset:1024 sc1
 v_mfma_f32_16x16x32_bf16 v[108:111], a[132:135], v[44:47], v[108:111]
 v_mfma_f32_16x16x32_bf16 v[116:119], v[44:47], a[204:207], v[116:119]
 v_mfma_f32_16x16x32_bf16 v[124:127], v[44:47], v[244:247], v[124:127]
 s_waitcnt lgkmcnt(2)
 v_mfma_f32_16x16x32_bf16 v[96:99], a[64:67], v[48:51], v[96:99]
 s_waitcnt vmcnt(13)
 s_barrier
 ds_read_b128 v[32:35], v6 offset:0
 v_mfma_f32_16x16x32_bf16 v[104:107], a[136:139], v[48:51], v[104:107]
 ds_read_b128 v[36:39], v6 offset:2048
 v_mfma_f32_16x16x32_bf16 v[112:115], v[48:51], a[208:211], v[112:115]
 buffer_store_dword v14, v13, s[20:23], 0 offen sc1
 v_mfma_f32_16x16x32_bf16 v[120:123], v[48:51], v[248:251], v[120:123]
 v_mfma_f32_16x16x32_bf16 v[100:103], a[64:67], v[52:55], v[100:103]
 v_mfma_f32_16x16x32_bf16 v[108:111], a[136:139], v[52:55], v[108:111]
 v_mfma_f32_16x16x32_bf16 v[116:119], v[52:55], a[208:211], v[116:119]
 v_mfma_f32_16x16x32_bf16 v[124:127], v[52:55], v[248:251], v[124:127]
 s_waitcnt lgkmcnt(2)
 v_mfma_f32_16x16x32_bf16 v[96:99], a[68:71], v[56:59], v[96:99]
 ds_read_b128 v[40:43], v7 offset:0
 v_mfma_f32_16x16x32_bf16 v[104:107], a[140:143], v[56:59], v[104:107]
 ds_read_b128 v[44:47], v7 offset:2048
 v_mfma_f32_16x16x32_bf16 v[112:115], v[56:59], a[212:215], v[112:115]
 s_mul_i32 s45, s39, 524288
 s_add_u32 s47, s34, s45
 v_mfma_f32_16x16x32_bf16 v[120:123], v[56:59], v[252:255], v[120:123]
 s_add_u32 s48, s35, s45
 v_mov_b32 v14, s42
 v_mfma_f32_16x16x32_bf16 v[100:103], a[68:71], v[60:63], v[100:103]
 s_mov_b32 s39, s40
 s_mov_b32 s40, s41
 v_mfma_f32_16x16x32_bf16 v[108:111], a[140:143], v[60:63], v[108:111]
 s_add_u32 s42, s42, 1
 s_cmp_lt_u32 s42, s36
 v_mfma_f32_16x16x32_bf16 v[116:119], v[60:63], a[212:215], v[116:119]
 v_mfma_f32_16x16x32_bf16 v[124:127], v[60:63], v[252:255], v[124:127]
 s_waitcnt lgkmcnt(2)
 s_cbranch_scc1 Lps_loop_18
 s_nop 7
 v_cvt_pk_bf16_f32 v16, v96, v97
 v_cvt_pk_bf16_f32 v17, v104, v105
 v_cvt_pk_bf16_f32 v18, v98, v99
 v_cvt_pk_bf16_f32 v19, v106, v107
 buffer_store_dwordx4 v[16:19], v12, s[20:23], s47 offen offset:0 sc1
 v_cvt_pk_bf16_f32 v20, v100, v101
 v_cvt_pk_bf16_f32 v21, v108, v109
 v_cvt_pk_bf16_f32 v22, v102, v103
 v_cvt_pk_bf16_f32 v23, v110, v111
 buffer_store_dwordx4 v[20:23], v12, s[20:23], s47 offen offset:1024 sc1
 v_cvt_pk_bf16_f32 v24, v112, v113
 v_cvt_pk_bf16_f32 v25, v116, v117
 v_cvt_pk_bf16_f32 v26, v114, v115
 v_cvt_pk_bf16_f32 v27, v118, v119
 buffer_store_dwordx4 v[24:27], v12, s[20:23], s48 offen offset:0 sc1
 v_cvt_pk_bf16_f32 v28, v120, v121
 v_cvt_pk_bf16_f32 v29, v124, v125
 v_cvt_pk_bf16_f32 v30, v122, v123
 v_cvt_pk_bf16_f32 v31, v126, v127
 buffer_store_dwordx4 v[28:31], v12, s[20:23], s48 offen offset:1024 sc1
 s_waitcnt vmcnt(0) lgkmcnt(0)
 s_barrier
 v_mov_b32 v14, s36
 buffer_store_dword v14, v13, s[20:23], 0 offen sc1
 s_branch Lfin
Lqa:
 s_load_dwordx2 s[8:9], s[0:1], 0
 s_mov_b32 s10, 0x240000
 s_mov_b32 s11, 0x20000
 s_load_dwordx2 s[12:13], s[0:1], 16
 s_mov_b32 s14, 0x480000
 s_mov_b32 s15, 0x20000
 s_load_dwordx2 s[16:17], s[0:1], 16
 s_mov_b32 s18, 0x480000
 s_mov_b32 s19, 0x20000
 s_cmp_eq_u32 s2, 251
 s_cbranch_scc0 Lqa1
 v_mov_b32 v4, 0
 v_mov_b32 v5, 0
 v_mov_b32 v6, 0
 v_mov_b32 v7, 0
 v_lshlrev_b32 v1, 4, v0
 s_mov_b32 s7, 0
 buffer_store_dwordx4 v[4:7], v1, s[20:23], s7 offen sc1
 s_mov_b32 s7, 4096
 buffer_store_dwordx4 v[4:7], v1, s[20:23], s7 offen sc1
 s_mov_b32 s7, 8192
 buffer_store_dwordx4 v[4:7], v1, s[20:23], s7 offen sc1
 s_mov_b32 s7, 12288
 buffer_store_dwordx4 v[4:7], v1, s[20:23], s7 offen sc1
 v_min_u32 v1, 1, v0
 v_lshlrev_b32 v1, 28, v1
 v_mov_b32 v2, 1
 s_waitcnt vmcnt(0)
 s_barrier
 buffer_store_dword v2, v1, s[28:31], 0 offen sc1
Lqa1:
 s_sub_u32 s3, s5, 2
 s_lshl_b32 s3, s3, 3
 s_lshr_b32 s7, s6, 2
 s_add_u32 s3, s3, s7
 s_lshl_b32 s32, s3, 9
 s_add_u32 s33, s32, 256
 s_lshl_b32 s34, s3, 14
 s_add_u32 s34, s34, 0x5000000
 s_add_u32 s35, s34, 8192
 s_mov_b32 s36, 16
 s_and_b32 s37, s6, 3
 s_lshl_b32 s7, s3, 5
 s_add_u32 s7, s7, s37
 s_lshl_b32 s7, s7, 2
 s_add_u32 s7, s7, 0x3000
 v_min_u32 v1, 1, v0
 v_lshlrev_b32 v1, 28, v1
 v_add_u32 v13, s7, v1
 s_waitcnt lgkmcnt(0)
 v_and_b32 v1, 63, v0
 v_lshrrev_b32 v2, 3, v0
 v_mul_u32_u24 v10, 1152, v2
 v_lshrrev_b32 v2, 4, v0
 v_xor_b32 v2, v2, v0
 v_and_b32 v2, 7, v2
 v_lshl_add_u32 v10, v2, 4, v10
 v_lshrrev_b32 v2, 4, v1
 v_bfe_u32 v3, v1, 1, 3
 v_xor_b32 v2, v2, v3
 v_and_b32 v3, 15, v1
 v_lshlrev_b32 v3, 7, v3
 v_lshl_add_u32 v4, v2, 4, v3
 v_xor_b32 v5, 64, v4
 v_lshrrev_b32 v2, 4, v0
 v_lshlrev_b32 v11, 13, v2
 v_lshrrev_b32 v2, 7, v0
 v_lshrrev_b32 v3, 4, v1
 v_lshl_add_u32 v3, v2, 2, v3
 v_bfe_u32 v2, v1, 1, 3
 v_xor_b32 v2, v2, v3
 v_lshl_add_u32 v11, v2, 5, v11
 v_and_b32 v2, 1, v1
 v_lshl_add_u32 v11, v2, 4, v11
 v_bfe_u32 v2, v1, 2, 3
 v_xor_b32 v3, s4, v2
 v_lshlrev_b32 v3, 5, v3
 v_and_b32 v2, 3, v2
 v_lshl_add_u32 v3, v2, 8, v3
 v_lshrrev_b32 v2, 4, v1
 v_lshl_add_u32 v3, v2, 11, v3
 v_and_b32 v2, 3, v1
 v_lshl_add_u32 v3, v2, 3, v3
 v_add_u32 v8, 73728, v3
 v_xor_b32 v3, 0x80, v3
 v_add_u32 v9, 73728, v3
 s_lshl_b32 s45, s4, 11
 v_lshl_add_u32 v12, v1, 4, s45
 s_mov_b32 s39, s37
 s_add_u32 s40, s39, 4
 s_lshl_b32 s49, s4, 10
 s_mul_i32 s46, s39, 36864
 s_add_u32 m0, s49, 0
 s_nop 0
 buffer_load_dwordx4 v10, s[8:11], s46 offen offset:0  lds
 s_add_u32 m0, s49, 3968
 s_nop 0
 buffer_load_dwordx4 v10, s[8:11], s46 offen offset:128  lds
 s_add_u32 m0, s49, 7936
 s_nop 0
 buffer_load_dwordx4 v10, s[8:11], s46 offen offset:256  lds
 s_add_u32 m0, s49, 11904
 s_nop 0
 buffer_load_dwordx4 v10, s[8:11], s46 offen offset:384  lds
 s_add_u32 m0, s49, 15872
 s_nop 0
 buffer_load_dwordx4 v10, s[8:11], s46 offen offset:512  lds
 s_add_u32 m0, s49, 19840
 s_nop 0
 buffer_load_dwordx4 v10, s[8:11], s46 offen offset:640  lds
 s_add_u32 m0, s49, 23808
 s_nop 0
 buffer_load_dwordx4 v10, s[8:11], s46 offen offset:768  lds
 s_add_u32 m0, s49, 27776
 s_nop 0
 buffer_load_dwordx4 v10, s[8:11], s46 offen offset:896  lds
 s_add_u32 m0, s49, 31744
 s_nop 0
 buffer_load_dwordx4 v10, s[8:11], s46 offen offset:1024  lds
 s_lshl_b32 s49, s4, 10
 s_add_u32 s49, s49, 36864
 s_mul_i32 s46, s40, 36864
 s_add_u32 m0, s49, 0
 s_nop 0
 buffer_load_dwordx4 v10, s[8:11], s46 offen offset:0  lds
 s_add_u32 m0, s49, 3968
 s_nop 0
 buffer_load_dwordx4 v10, s[8:11], s46 offen offset:128  lds
 s_add_u32 m0, s49, 7936
 s_nop 0
 buffer_load_dwordx4 v10, s[8:11], s46 offen offset:256  lds
 s_add_u32 m0, s49, 11904
 s_nop 0
 buffer_load_dwordx4 v10, s[8:11], s46 offen offset:384  lds
 s_add_u32 m0, s49, 15872
 s_nop 0
 buffer_load_dwordx4 v10, s[8:11], s46 offen offset:512  lds
 s_add_u32 m0, s49, 19840
 s_nop 0
 buffer_load_dwordx4 v10, s[8:11], s46 offen offset:640  lds
 s_add_u32 m0, s49, 23808
 s_nop 0
 buffer_load_dwordx4 v10, s[8:11], s46 offen offset:768  lds
 s_add_u32 m0, s49, 27776
 s_nop 0
 buffer_load_dwordx4 v10, s[8:11], s46 offen offset:896  lds
 s_add_u32 m0, s49, 31744
 s_nop 0
 buffer_load_dwordx4 v10, s[8:11], s46 offen offset:1024  lds
 s_lshl_b32 s49, s4, 10
 s_add_u32 m0, s49, 73728
 s_add_u32 s45, s32, 0
 buffer_load_dwordx4 v11, s[12:15], s45 offen nt lds
 s_add_u32 m0, s49, 77824
 s_add_u32 s45, s32, 131072
 buffer_load_dwordx4 v11, s[12:15], s45 offen nt lds
 s_add_u32 m0, s49, 81920
 s_add_u32 s45, s33, 0
 buffer_load_dwordx4 v11, s[16:19], s45 offen nt lds
 s_add_u32 m0, s49, 86016
 s_add_u32 s45, s33, 131072
 buffer_load_dwordx4 v11, s[16:19], s45 offen nt lds
 s_add_u32 m0, s49, 90112
 s_add_u32 s45, s32, 262144
 buffer_load_dwordx4 v11, s[12:15], s45 offen nt lds
 s_add_u32 m0, s49, 94208
 s_add_u32 s45, s32, 393216
 buffer_load_dwordx4 v11, s[12:15], s45 offen nt lds
 s_add_u32 m0, s49, 98304
 s_add_u32 s45, s33, 262144
 buffer_load_dwordx4 v11, s[16:19], s45 offen nt lds
 s_add_u32 m0, s49, 102400
 s_add_u32 s45, s33, 393216
 buffer_load_dwordx4 v11, s[16:19], s45 offen nt lds
 s_add_u32 m0, s49, 106496
 s_add_u32 s45, s32, 524288
 buffer_load_dwordx4 v11, s[12:15], s45 offen nt lds
 s_add_u32 m0, s49, 110592
 s_add_u32 s45, s32, 655360
 buffer_load_dwordx4 v11, s[12:15], s45 offen nt lds
 s_add_u32 m0, s49, 114688
 s_add_u32 s45, s33, 524288
 buffer_load_dwordx4 v11, s[16:19], s45 offen nt lds
 s_add_u32 m0, s49, 118784
 s_add_u32 s45, s33, 655360
 buffer_load_dwordx4 v11, s[16:19], s45 offen nt lds
 s_waitcnt vmcnt(8) lgkmcnt(0)
 s_barrier
 s_add_u32 m0, s49, 122880
 s_add_u32 s45, s32, 786432
 buffer_load_dwordx4 v11, s[12:15], s45 offen nt lds
 s_add_u32 m0, s49, 126976
 s_add_u32 s45, s32, 917504
 buffer_load_dwordx4 v11, s[12:15], s45 offen nt lds
 s_add_u32 m0, s49, 131072
 s_add_u32 s45, s33, 786432
 buffer_load_dwordx4 v11, s[16:19], s45 offen nt lds
 s_add_u32 m0, s49, 135168
 s_add_u32 s45, s33, 917504
 buffer_load_dwordx4 v11, s[16:19], s45 offen nt lds
 ds_read_b64_tr_b16 a[0:1], v8 offset:0
 ds_read_b64_tr_b16 a[2:3], v8 offset:1024
 ds_read_b64_tr_b16 a[72:73], v9 offset:0
 ds_read_b64_tr_b16 a[74:75], v9 offset:1024
 ds_read_b64_tr_b16 a[144:145], v8 offset:8192
 ds_read_b64_tr_b16 a[146:147], v8 offset:9216
 ds_read_b64_tr_b16 a[216:217], v9 offset:8192
 ds_read_b64_tr_b16 a[218:219], v9 offset:9216
 s_waitcnt vmcnt(8) lgkmcnt(0)
 s_barrier
 s_add_u32 m0, s49, 73728
 s_add_u32 s45, s32, 1048576
 buffer_load_dwordx4 v11, s[12:15], s45 offen nt lds
 s_add_u32 m0, s49, 77824
 s_add_u32 s45, s32, 1179648
 buffer_load_dwordx4 v11, s[12:15], s45 offen nt lds
 s_add_u32 m0, s49, 81920
 s_add_u32 s45, s33, 1048576
 buffer_load_dwordx4 v11, s[16:19], s45 offen nt lds
 s_add_u32 m0, s49, 86016
 s_add_u32 s45, s33, 1179648
 buffer_load_dwordx4 v11, s[16:19], s45 offen nt lds
 ds_read_b64_tr_b16 a[4:5], v8 offset:16384
 ds_read_b64_tr_b16 a[6:7], v8 offset:17408
 ds_read_b64_tr_b16 a[76:77], v9 offset:16384
 ds_read_b64_tr_b16 a[78:79], v9 offset:17408
 ds_read_b64_tr_b16 a[148:149], v8 offset:24576
 ds_read_b64_tr_b16 a[150:151], v8 offset:25600
 ds_read_b64_tr_b16 a[220:221], v9 offset:24576
 ds_read_b64_tr_b16 a[222:223], v9 offset:25600
 s_waitcnt vmcnt(8) lgkmcnt(0)
 s_barrier
 s_add_u32 m0, s49, 90112
 s_add_u32 s45, s32, 1310720
 buffer_load_dwordx4 v11, s[12:15], s45 offen nt lds
 s_add_u32 m0, s49, 94208
 s_add_u32 s45, s32, 1441792
 buffer_load_dwordx4 v11, s[12:15], s45 offen nt lds
 s_add_u32 m0, s49, 98304
 s_add_u32 s45, s33, 1310720
 buffer_load_dwordx4 v11, s[16:19], s45 offen nt lds
 s_add_u32 m0, s49, 102400
 s_add_u32 s45, s33, 1441792
 buffer_load_dwordx4 v11, s[16:19], s45 offen nt lds
 ds_read_b64_tr_b16 a[8:9], v8 offset:32768
 ds_read_b64_tr_b16 a[10:11], v8 offset:33792
 ds_read_b64_tr_b16 a[80:81], v9 offset:32768
 ds_read_b64_tr_b16 a[82:83], v9 offset:33792
 ds_read_b64_tr_b16 a[152:153], v8 offset:40960
 ds_read_b64_tr_b16 a[154:155], v8 offset:41984
 ds_read_b64_tr_b16 a[224:225], v9 offset:40960
 ds_read_b64_tr_b16 a[226:227], v9 offset:41984
 s_waitcnt vmcnt(8) lgkmcnt(0)
 s_barrier
 s_add_u32 m0, s49, 106496
 s_add_u32 s45, s32, 1572864
 buffer_load_dwordx4 v11, s[12:15], s45 offen nt lds
 s_add_u32 m0, s49, 110592
 s_add_u32 s45, s32, 1703936
 buffer_load_dwordx4 v11, s[12:15], s45 offen nt lds
 s_add_u32 m0, s49, 114688
 s_add_u32 s45, s33, 1572864
 buffer_load_dwordx4 v11, s[16:19], s45 offen nt lds
 s_add_u32 m0, s49, 118784
 s_add_u32 s45, s33, 1703936
 buffer_load_dwordx4 v11, s[16:19], s45 offen nt lds
 ds_read_b64_tr_b16 a[12:13], v8 offset:49152
 ds_read_b64_tr_b16 a[14:15], v8 offset:50176
 ds_read_b64_tr_b16 a[84:85], v9 offset:49152
 ds_read_b64_tr_b16 a[86:87], v9 offset:50176
 ds_read_b64_tr_b16 a[156:157], v8 offset:57344
 ds_read_b64_tr_b16 a[158:159], v8 offset:58368
 ds_read_b64_tr_b16 a[228:229], v9 offset:57344
 ds_read_b64_tr_b16 a[230:231], v9 offset:58368
 s_waitcnt vmcnt(8) lgkmcnt(0)
 s_barrier
 s_add_u32 m0, s49, 122880
 s_add_u32 s45, s32, 1835008
 buffer_load_dwordx4 v11, s[12:15], s45 offen nt lds
 s_add_u32 m0, s49, 126976
 s_add_u32 s45, s32, 1966080
 buffer_load_dwordx4 v11, s[12:15], s45 offen nt lds
 s_add_u32 m0, s49, 131072
 s_add_u32 s45, s33, 1835008
 buffer_load_dwordx4 v11, s[16:19], s45 offen nt lds
 s_add_u32 m0, s49, 135168
 s_add_u32 s45, s33, 1966080
 buffer_load_dwordx4 v11, s[16:19], s45 offen nt lds
 ds_read_b64_tr_b16 a[16:17], v8 offset:0
 ds_read_b64_tr_b16 a[18:19], v8 offset:1024
 ds_read_b64_tr_b16 a[88:89], v9 offset:0
 ds_read_b64_tr_b16 a[90:91], v9 offset:1024
 ds_read_b64_tr_b16 a[160:161], v8 offset:8192
 ds_read_b64_tr_b16 a[162:163], v8 offset:9216
 ds_read_b64_tr_b16 a[232:233], v9 offset:8192
 ds_read_b64_tr_b16 a[234:235], v9 offset:9216
 s_waitcnt vmcnt(8) lgkmcnt(0)
 s_barrier
 s_add_u32 m0, s49, 73728
 s_add_u32 s45, s32, 2097152
 buffer_load_dwordx4 v11, s[12:15], s45 offen nt lds
 s_add_u32 m0, s49, 77824
 s_add_u32 s45, s32, 2228224
 buffer_load_dwordx4 v11, s[12:15], s45 offen nt lds
 s_add_u32 m0, s49, 81920
 s_add_u32 s45, s33, 2097152
 buffer_load_dwordx4 v11, s[16:19], s45 offen nt lds
 s_add_u32 m0, s49, 86016
 s_add_u32 s45, s33, 2228224
 buffer_load_dwordx4 v11, s[16:19], s45 offen nt lds
 ds_read_b64_tr_b16 a[20:21], v8 offset:16384
 ds_read_b64_tr_b16 a[22:23], v8 offset:17408
 ds_read_b64_tr_b16 a[92:93], v9 offset:16384
 ds_read_b64_tr_b16 a[94:95], v9 offset:17408
 ds_read_b64_tr_b16 a[164:165], v8 offset:24576
 ds_read_b64_tr_b16 a[166:167], v8 offset:25600
 ds_read_b64_tr_b16 a[236:237], v9 offset:24576
 ds_read_b64_tr_b16 a[238:239], v9 offset:25600
 s_waitcnt vmcnt(8) lgkmcnt(0)
 s_barrier
 s_add_u32 m0, s49, 90112
 s_add_u32 s45, s32, 2359296
 buffer_load_dwordx4 v11, s[12:15], s45 offen nt lds
 s_add_u32 m0, s49, 94208
 s_add_u32 s45, s32, 2490368
 buffer_load_dwordx4 v11, s[12:15], s45 offen nt lds
 s_add_u32 m0, s49, 98304
 s_add_u32 s45, s33, 2359296
 buffer_load_dwordx4 v11, s[16:19], s45 offen nt lds
 s_add_u32 m0, s49, 102400
 s_add_u32 s45, s33, 2490368
 buffer_load_dwordx4 v11, s[16:19], s45 offen nt lds
 ds_read_b64_tr_b16 a[24:25], v8 offset:32768
 ds_read_b64_tr_b16 a[26:27], v8 offset:33792
 ds_read_b64_tr_b16 a[96:97], v9 offset:32768
 ds_read_b64_tr_b16 a[98:99], v9 offset:33792
 ds_read_b64_tr_b16 a[168:169], v8 offset:40960
 ds_read_b64_tr_b16 a[170:171], v8 offset:41984
 ds_read_b64_tr_b16 a[240:241], v9 offset:40960
 ds_read_b64_tr_b16 a[242:243], v9 offset:41984
 s_waitcnt vmcnt(8) lgkmcnt(0)
 s_barrier
 s_add_u32 m0, s49, 106496
 s_add_u32 s45, s32, 2621440
 buffer_load_dwordx4 v11, s[12:15], s45 offen nt lds
 s_add_u32 m0, s49, 110592
 s_add_u32 s45, s32, 2752512
 buffer_load_dwordx4 v11, s[12:15], s45 offen nt lds
 s_add_u32 m0, s49, 114688
 s_add_u32 s45, s33, 2621440
 buffer_load_dwordx4 v11, s[16:19], s45 offen nt lds
 s_add_u32 m0, s49, 118784
 s_add_u32 s45, s33, 2752512
 buffer_load_dwordx4 v11, s[16:19], s45 offen nt lds
 ds_read_b64_tr_b16 a[28:29], v8 offset:49152
 ds_read_b64_tr_b16 a[30:31], v8 offset:50176
 ds_read_b64_tr_b16 a[100:101], v9 offset:49152
 ds_read_b64_tr_b16 a[102:103], v9 offset:50176
 ds_read_b64_tr_b16 a[172:173], v8 offset:57344
 ds_read_b64_tr_b16 a[174:175], v8 offset:58368
 ds_read_b64_tr_b16 a[244:245], v9 offset:57344
 ds_read_b64_tr_b16 a[246:247], v9 offset:58368
 s_waitcnt vmcnt(8) lgkmcnt(0)
 s_barrier
 s_add_u32 m0, s49, 122880
 s_add_u32 s45, s32, 2883584
 buffer_load_dwordx4 v11, s[12:15], s45 offen nt lds
 s_add_u32 m0, s49, 126976
 s_add_u32 s45, s32, 3014656
 buffer_load_dwordx4 v11, s[12:15], s45 offen nt lds
 s_add_u32 m0, s49, 131072
 s_add_u32 s45, s33, 2883584
 buffer_load_dwordx4 v11, s[16:19], s45 offen nt lds
 s_add_u32 m0, s49, 135168
 s_add_u32 s45, s33, 3014656
 buffer_load_dwordx4 v11, s[16:19], s45 offen nt lds
 ds_read_b64_tr_b16 a[32:33], v8 offset:0
 ds_read_b64_tr_b16 a[34:35], v8 offset:1024
 ds_read_b64_tr_b16 a[104:105], v9 offset:0
 ds_read_b64_tr_b16 a[106:107], v9 offset:1024
 ds_read_b64_tr_b16 a[176:177], v8 offset:8192
 ds_read_b64_tr_b16 a[178:179], v8 offset:9216
 ds_read_b64_tr_b16 a[248:249], v9 offset:8192
 ds_read_b64_tr_b16 a[250:251], v9 offset:9216
 s_waitcnt vmcnt(8) lgkmcnt(0)
 s_barrier
 s_add_u32 m0, s49, 73728
 s_add_u32 s45, s32, 3145728
 buffer_load_dwordx4 v11, s[12:15], s45 offen nt lds
 s_add_u32 m0, s49, 77824
 s_add_u32 s45, s32, 3276800
 buffer_load_dwordx4 v11, s[12:15], s45 offen nt lds
 s_add_u32 m0, s49, 81920
 s_add_u32 s45, s33, 3145728
 buffer_load_dwordx4 v11, s[16:19], s45 offen nt lds
 s_add_u32 m0, s49, 86016
 s_add_u32 s45, s33, 3276800
 buffer_load_dwordx4 v11, s[16:19], s45 offen nt lds
 ds_read_b64_tr_b16 a[36:37], v8 offset:16384
 ds_read_b64_tr_b16 a[38:39], v8 offset:17408
 ds_read_b64_tr_b16 a[108:109], v9 offset:16384
 ds_read_b64_tr_b16 a[110:111], v9 offset:17408
 ds_read_b64_tr_b16 a[180:181], v8 offset:24576
 ds_read_b64_tr_b16 a[182:183], v8 offset:25600
 ds_read_b64_tr_b16 a[252:253], v9 offset:24576
 ds_read_b64_tr_b16 a[254:255], v9 offset:25600
 s_waitcnt vmcnt(8) lgkmcnt(0)
 s_barrier
 s_add_u32 m0, s49, 90112
 s_add_u32 s45, s32, 3407872
 buffer_load_dwordx4 v11, s[12:15], s45 offen nt lds
 s_add_u32 m0, s49, 94208
 s_add_u32 s45, s32, 3538944
 buffer_load_dwordx4 v11, s[12:15], s45 offen nt lds
 s_add_u32 m0, s49, 98304
 s_add_u32 s45, s33, 3407872
 buffer_load_dwordx4 v11, s[16:19], s45 offen nt lds
 s_add_u32 m0, s49, 102400
 s_add_u32 s45, s33, 3538944
 buffer_load_dwordx4 v11, s[16:19], s45 offen nt lds
 ds_read_b64_tr_b16 a[40:41], v8 offset:32768
 ds_read_b64_tr_b16 a[42:43], v8 offset:33792
 ds_read_b64_tr_b16 a[112:113], v9 offset:32768
 ds_read_b64_tr_b16 a[114:115], v9 offset:33792
 ds_read_b64_tr_b16 a[184:185], v8 offset:40960
 ds_read_b64_tr_b16 a[186:187], v8 offset:41984
 ds_read_b64_tr_b16 v[224:225], v9 offset:40960
 ds_read_b64_tr_b16 v[226:227], v9 offset:41984
 s_waitcnt vmcnt(8) lgkmcnt(0)
 s_barrier
 s_add_u32 m0, s49, 106496
 s_add_u32 s45, s32, 3670016
 buffer_load_dwordx4 v11, s[12:15], s45 offen nt lds
 s_add_u32 m0, s49, 110592
 s_add_u32 s45, s32, 3801088
 buffer_load_dwordx4 v11, s[12:15], s45 offen nt lds
 s_add_u32 m0, s49, 114688
 s_add_u32 s45, s33, 3670016
 buffer_load_dwordx4 v11, s[16:19], s45 offen nt lds
 s_add_u32 m0, s49, 118784
 s_add_u32 s45, s33, 3801088
 buffer_load_dwordx4 v11, s[16:19], s45 offen nt lds
 ds_read_b64_tr_b16 a[44:45], v8 offset:49152
 ds_read_b64_tr_b16 a[46:47], v8 offset:50176
 ds_read_b64_tr_b16 a[116:117], v9 offset:49152
 ds_read_b64_tr_b16 a[118:119], v9 offset:50176
 ds_read_b64_tr_b16 a[188:189], v8 offset:57344
 ds_read_b64_tr_b16 a[190:191], v8 offset:58368
 ds_read_b64_tr_b16 v[228:229], v9 offset:57344
 ds_read_b64_tr_b16 v[230:231], v9 offset:58368
 s_waitcnt vmcnt(8) lgkmcnt(0)
 s_barrier
 s_add_u32 m0, s49, 122880
 s_add_u32 s45, s32, 3932160
 buffer_load_dwordx4 v11, s[12:15], s45 offen nt lds
 s_add_u32 m0, s49, 126976
 s_add_u32 s45, s32, 4063232
 buffer_load_dwordx4 v11, s[12:15], s45 offen nt lds
 s_add_u32 m0, s49, 131072
 s_add_u32 s45, s33, 3932160
 buffer_load_dwordx4 v11, s[16:19], s45 offen nt lds
 s_add_u32 m0, s49, 135168
 s_add_u32 s45, s33, 4063232
 buffer_load_dwordx4 v11, s[16:19], s45 offen nt lds
 ds_read_b64_tr_b16 a[48:49], v8 offset:0
 ds_read_b64_tr_b16 a[50:51], v8 offset:1024
 ds_read_b64_tr_b16 a[120:121], v9 offset:0
 ds_read_b64_tr_b16 a[122:123], v9 offset:1024
 ds_read_b64_tr_b16 a[192:193], v8 offset:8192
 ds_read_b64_tr_b16 a[194:195], v8 offset:9216
 ds_read_b64_tr_b16 v[232:233], v9 offset:8192
 ds_read_b64_tr_b16 v[234:235], v9 offset:9216
 s_waitcnt vmcnt(8) lgkmcnt(0)
 s_barrier
 s_add_u32 m0, s49, 73728
 s_add_u32 s45, s32, 4194304
 buffer_load_dwordx4 v11, s[12:15], s45 offen nt lds
 s_add_u32 m0, s49, 77824
 s_add_u32 s45, s32, 4325376
 buffer_load_dwordx4 v11, s[12:15], s45 offen nt lds
 s_add_u32 m0, s49, 81920
 s_add_u32 s45, s33, 4194304
 buffer_load_dwordx4 v11, s[16:19], s45 offen nt lds
 s_add_u32 m0, s49, 86016
 s_add_u32 s45, s33, 4325376
 buffer_load_dwordx4 v11, s[16:19], s45 offen nt lds
 ds_read_b64_tr_b16 a[52:53], v8 offset:16384
 ds_read_b64_tr_b16 a[54:55], v8 offset:17408
 ds_read_b64_tr_b16 a[124:125], v9 offset:16384
 ds_read_b64_tr_b16 a[126:127], v9 offset:17408
 ds_read_b64_tr_b16 a[196:197], v8 offset:24576
 ds_read_b64_tr_b16 a[198:199], v8 offset:25600
 ds_read_b64_tr_b16 v[236:237], v9 offset:24576
 ds_read_b64_tr_b16 v[238:239], v9 offset:25600
 s_waitcnt vmcnt(8) lgkmcnt(0)
 s_barrier
 s_add_u32 m0, s49, 90112
 s_add_u32 s45, s32, 4456448
 buffer_load_dwordx4 v11, s[12:15], s45 offen nt lds
 s_add_u32 m0, s49, 94208
 s_add_u32 s45, s32, 4587520
 buffer_load_dwordx4 v11, s[12:15], s45 offen nt lds
 s_add_u32 m0, s49, 98304
 s_add_u32 s45, s33, 4456448
 buffer_load_dwordx4 v11, s[16:19], s45 offen nt lds
 s_add_u32 m0, s49, 102400
 s_add_u32 s45, s33, 4587520
 buffer_load_dwordx4 v11, s[16:19], s45 offen nt lds
 ds_read_b64_tr_b16 a[56:57], v8 offset:32768
 ds_read_b64_tr_b16 a[58:59], v8 offset:33792
 ds_read_b64_tr_b16 a[128:129], v9 offset:32768
 ds_read_b64_tr_b16 a[130:131], v9 offset:33792
 ds_read_b64_tr_b16 a[200:201], v8 offset:40960
 ds_read_b64_tr_b16 a[202:203], v8 offset:41984
 ds_read_b64_tr_b16 v[240:241], v9 offset:40960
 ds_read_b64_tr_b16 v[242:243], v9 offset:41984
 s_waitcnt vmcnt(8) lgkmcnt(0)
 s_barrier
 ds_read_b64_tr_b16 a[60:61], v8 offset:49152
 ds_read_b64_tr_b16 a[62:63], v8 offset:50176
 ds_read_b64_tr_b16 a[132:133], v9 offset:49152
 ds_read_b64_tr_b16 a[134:135], v9 offset:50176
 ds_read_b64_tr_b16 a[204:205], v8 offset:57344
 ds_read_b64_tr_b16 a[206:207], v8 offset:58368
 ds_read_b64_tr_b16 v[244:245], v9 offset:57344
 ds_read_b64_tr_b16 v[246:247], v9 offset:58368
 s_waitcnt vmcnt(4) lgkmcnt(0)
 s_barrier
 ds_read_b64_tr_b16 a[64:65], v8 offset:0
 ds_read_b64_tr_b16 a[66:67], v8 offset:1024
 ds_read_b64_tr_b16 a[136:137], v9 offset:0
 ds_read_b64_tr_b16 a[138:139], v9 offset:1024
 ds_read_b64_tr_b16 a[208:209], v8 offset:8192
 ds_read_b64_tr_b16 a[210:211], v8 offset:9216
 ds_read_b64_tr_b16 v[248:249], v9 offset:8192
 ds_read_b64_tr_b16 v[250:251], v9 offset:9216
 s_waitcnt vmcnt(0) lgkmcnt(0)
 s_barrier
 ds_read_b64_tr_b16 a[68:69], v8 offset:16384
 ds_read_b64_tr_b16 a[70:71], v8 offset:17408
 ds_read_b64_tr_b16 a[140:141], v9 offset:16384
 ds_read_b64_tr_b16 a[142:143], v9 offset:17408
 ds_read_b64_tr_b16 a[212:213], v8 offset:24576
 ds_read_b64_tr_b16 a[214:215], v8 offset:25600
 ds_read_b64_tr_b16 v[252:253], v9 offset:24576
 ds_read_b64_tr_b16 v[254:255], v9 offset:25600
 s_mov_b32 s50, 0x3e0293ee
 s_mov_b32 s42, 0
 s_mov_b32 s43, 0
 s_mov_b32 s44, 73728
 v_mov_b32 v6, v4
 v_mov_b32 v7, v5
 s_mov_b32 s95, 0x200000
 v_mov_b32 v21, 0
Lfr_19:
 buffer_load_dword v20, v21, s[28:31], 0 offen sc1
 s_waitcnt vmcnt(0)
 v_cmp_ne_u32 vcc, 0, v20
 s_cbranch_vccnz Lfrk_20
 s_sub_u32 s95, s95, 1
 s_cbranch_scc0 Lfr_19
 s_endpgm
Lfrk_20:
 s_lshl_b32 s47, s2, 13
 s_add_u32 s47, s47, 0x8000000
 s_mov_b32 s48, s47
 v_mov_b32 v14, 0
 s_waitcnt vmcnt(0) lgkmcnt(0)
 s_barrier
 ds_read_b128 v[32:35], v6 offset:0
 ds_read_b128 v[36:39], v6 offset:2048
 ds_read_b128 v[40:43], v7 offset:0
 ds_read_b128 v[44:47], v7 offset:2048
 s_waitcnt lgkmcnt(2)
Lps_loop_21:
 v_mfma_f32_16x16x32_bf16 v[64:67], a[0:3], v[32:35], 0
 ds_read_b128 v[48:51], v6 offset:4096
 v_mfma_f32_16x16x32_bf16 v[72:75], a[72:75], v[32:35], 0
 ds_read_b128 v[52:55], v6 offset:6144
 v_mfma_f32_16x16x32_bf16 v[80:83], a[144:147], v[32:35], 0
 s_add_u32 s41, s40, 4
 v_mfma_f32_16x16x32_bf16 v[88:91], a[216:219], v[32:35], 0
 s_add_u32 s45, s42, 2
 s_mul_i32 s46, s41, 36864
 v_mfma_f32_16x16x32_bf16 v[68:71], a[0:3], v[36:39], 0
 s_cmp_lt_u32 s45, s36
 s_cselect_b32 s46, s46, 0
 v_mfma_f32_16x16x32_bf16 v[76:79], a[72:75], v[36:39], 0
 s_lshl_b32 s49, s4, 10
 s_add_u32 s49, s49, s44
 v_mfma_f32_16x16x32_bf16 v[84:87], a[144:147], v[36:39], 0
 v_mfma_f32_16x16x32_bf16 v[92:95], a[216:219], v[36:39], 0
 s_waitcnt lgkmcnt(2)
 v_mfma_f32_16x16x32_bf16 v[64:67], a[4:7], v[40:43], v[64:67]
 ds_read_b128 v[56:59], v7 offset:4096
 v_mfma_f32_16x16x32_bf16 v[72:75], a[76:79], v[40:43], v[72:75]
 ds_read_b128 v[60:63], v7 offset:6144
 v_mfma_f32_16x16x32_bf16 v[80:83], a[148:151], v[40:43], v[80:83]
 s_add_u32 m0, s49, 0
 v_mfma_f32_16x16x32_bf16 v[88:91], a[220:223], v[40:43], v[88:91]
 buffer_load_dwordx4 v10, s[8:11], s46 offen offset:0  lds
 v_mfma_f32_16x16x32_bf16 v[68:71], a[4:7], v[44:47], v[68:71]
 s_add_u32 m0, s49, 3968
 v_mfma_f32_16x16x32_bf16 v[76:79], a[76:79], v[44:47], v[76:79]
 buffer_load_dwordx4 v10, s[8:11], s46 offen offset:128  lds
 v_mfma_f32_16x16x32_bf16 v[84:87], a[148:151], v[44:47], v[84:87]
 v_mfma_f32_16x16x32_bf16 v[92:95], a[220:223], v[44:47], v[92:95]
 s_waitcnt lgkmcnt(2)
 v_mfma_f32_16x16x32_bf16 v[64:67], a[8:11], v[48:51], v[64:67]
 ds_read_b128 v[32:35], v6 offset:8192
 v_mfma_f32_16x16x32_bf16 v[72:75], a[80:83], v[48:51], v[72:75]
 ds_read_b128 v[36:39], v6 offset:10240
 v_mfma_f32_16x16x32_bf16 v[80:83], a[152:155], v[48:51], v[80:83]
 s_add_u32 m0, s49, 7936
 v_mfma_f32_16x16x32_bf16 v[88:91], a[224:227], v[48:51], v[88:91]
 buffer_load_dwordx4 v10, s[8:11], s46 offen offset:256  lds
 v_mfma_f32_16x16x32_bf16 v[68:71], a[8:11], v[52:55], v[68:71]
 s_add_u32 m0, s49, 11904
 v_mfma_f32_16x16x32_bf16 v[76:79], a[80:83], v[52:55], v[76:79]
 buffer_load_dwordx4 v10, s[8:11], s46 offen offset:384  lds
 v_mfma_f32_16x16x32_bf16 v[84:87], a[152:155], v[52:55], v[84:87]
 v_mfma_f32_16x16x32_bf16 v[92:95], a[224:227], v[52:55], v[92:95]
 s_waitcnt lgkmcnt(2)
 v_mfma_f32_16x16x32_bf16 v[64:67], a[12:15], v[56:59], v[64:67]
 ds_read_b128 v[40:43], v7 offset:8192
 v_mfma_f32_16x16x32_bf16 v[72:75], a[84:87], v[56:59], v[72:75]
 ds_read_b128 v[44:47], v7 offset:10240
 v_mfma_f32_16x16x32_bf16 v[80:83], a[156:159], v[56:59], v[80:83]
 s_add_u32 m0, s49, 15872
 v_mfma_f32_16x16x32_bf16 v[88:91], a[228:231], v[56:59], v[88:91]
 buffer_load_dwordx4 v10, s[8:11], s46 offen offset:512  lds
 v_mfma_f32_16x16x32_bf16 v[68:71], a[12:15], v[60:63], v[68:71]
 s_add_u32 m0, s49, 19840
 v_mfma_f32_16x16x32_bf16 v[76:79], a[84:87], v[60:63], v[76:79]
 buffer_load_dwordx4 v10, s[8:11], s46 offen offset:640  lds
 v_mfma_f32_16x16x32_bf16 v[84:87], a[156:159], v[60:63], v[84:87]
 v_mfma_f32_16x16x32_bf16 v[92:95], a[228:231], v[60:63], v[92:95]
 s_waitcnt lgkmcnt(2)
 v_mfma_f32_16x16x32_bf16 v[64:67], a[16:19], v[32:35], v[64:67]
 ds_read_b128 v[48:51], v6 offset:12288
 v_mfma_f32_16x16x32_bf16 v[72:75], a[88:91], v[32:35], v[72:75]
 ds_read_b128 v[52:55], v6 offset:14336
 v_mfma_f32_16x16x32_bf16 v[80:83], a[160:163], v[32:35], v[80:83]
 s_add_u32 m0, s49, 23808
 v_mfma_f32_16x16x32_bf16 v[88:91], a[232:235], v[32:35], v[88:91]
 buffer_load_dwordx4 v10, s[8:11], s46 offen offset:768  lds
 v_mfma_f32_16x16x32_bf16 v[68:71], a[16:19], v[36:39], v[68:71]
 s_add_u32 m0, s49, 27776
 v_mfma_f32_16x16x32_bf16 v[76:79], a[88:91], v[36:39], v[76:79]
 buffer_load_dwordx4 v10, s[8:11], s46 offen offset:896  lds
 v_mfma_f32_16x16x32_bf16 v[84:87], a[160:163], v[36:39], v[84:87]
 v_mfma_f32_16x16x32_bf16 v[92:95], a[232:235], v[36:39], v[92:95]
 s_waitcnt lgkmcnt(2)
 v_mfma_f32_16x16x32_bf16 v[64:67], a[20:23], v[40:43], v[64:67]
 ds_read_b128 v[56:59], v7 offset:12288
 v_mfma_f32_16x16x32_bf16 v[72:75], a[92:95], v[40:43], v[72:75]
 ds_read_b128 v[60:63], v7 offset:14336
 v_mfma_f32_16x16x32_bf16 v[80:83], a[164:167], v[40:43], v[80:83]
 s_add_u32 m0, s49, 31744
 v_mfma_f32_16x16x32_bf16 v[88:91], a[236:239], v[40:43], v[88:91]
 buffer_load_dwordx4 v10, s[8:11], s46 offen offset:1024  lds
 v_mfma_f32_16x16x32_bf16 v[68:71], a[20:23], v[44:47], v[68:71]
 v_mfma_f32_16x16x32_bf16 v[76:79], a[92:95], v[44:47], v[76:79]
 v_mfma_f32_16x16x32_bf16 v[84:87], a[164:167], v[44:47], v[84:87]
 v_mfma_f32_16x16x32_bf16 v[92:95], a[236:239], v[44:47], v[92:95]
 s_waitcnt lgkmcnt(2)
 v_mfma_f32_16x16x32_bf16 v[64:67], a[24:27], v[48:51], v[64:67]
 ds_read_b128 v[32:35], v6 offset:16384
 v_mul_f32 v96, s50, v96
 v_mfma_f32_16x16x32_bf16 v[72:75], a[96:99], v[48:51], v[72:75]
 ds_read_b128 v[36:39], v6 offset:18432
 v_mfma_f32_16x16x32_bf16 v[80:83], a[168:171], v[48:51], v[80:83]
 v_mul_f32 v97, s50, v97
 v_mfma_f32_16x16x32_bf16 v[88:91], a[240:243], v[48:51], v[88:91]
 v_mul_f32 v98, s50, v98
 v_mfma_f32_16x16x32_bf16 v[68:71], a[24:27], v[52:55], v[68:71]
 v_mul_f32 v99, s50, v99
 v_mfma_f32_16x16x32_bf16 v[76:79], a[96:99], v[52:55], v[76:79]
 v_mul_f32 v104, s50, v104
 v_mfma_f32_16x16x32_bf16 v[84:87], a[168:171], v[52:55], v[84:87]
 v_mul_f32 v105, s50, v105
 v_mfma_f32_16x16x32_bf16 v[92:95], a[240:243], v[52:55], v[92:95]
 s_waitcnt lgkmcnt(2)
 v_mfma_f32_16x16x32_bf16 v[64:67], a[28:31], v[56:59], v[64:67]
 ds_read_b128 v[40:43], v7 offset:16384
 v_mfma_f32_16x16x32_bf16 v[72:75], a[100:103], v[56:59], v[72:75]
 ds_read_b128 v[44:47], v7 offset:18432
 v_mul_f32 v106, s50, v106
 v_mfma_f32_16x16x32_bf16 v[80:83], a[172:175], v[56:59], v[80:83]
 v_mul_f32 v107, s50, v107
 v_mfma_f32_16x16x32_bf16 v[88:91], a[244:247], v[56:59], v[88:91]
 v_cvt_pk_bf16_f32 v16, v96, v97
 v_mfma_f32_16x16x32_bf16 v[68:71], a[28:31], v[60:63], v[68:71]
 v_mfma_f32_16x16x32_bf16 v[76:79], a[100:103], v[60:63], v[76:79]
 v_cvt_pk_bf16_f32 v17, v104, v105
 v_mfma_f32_16x16x32_bf16 v[84:87], a[172:175], v[60:63], v[84:87]
 v_cvt_pk_bf16_f32 v18, v98, v99
 v_mfma_f32_16x16x32_bf16 v[92:95], a[244:247], v[60:63], v[92:95]
 s_waitcnt lgkmcnt(2)
 v_cvt_pk_bf16_f32 v19, v106, v107
 v_mfma_f32_16x16x32_bf16 v[64:67], a[32:35], v[32:35], v[64:67]
 ds_read_b128 v[48:51], v6 offset:20480
 v_mfma_f32_16x16x32_bf16 v[72:75], a[104:107], v[32:35], v[72:75]
 ds_read_b128 v[52:55], v6 offset:22528
 v_mfma_f32_16x16x32_bf16 v[80:83], a[176:179], v[32:35], v[80:83]
 buffer_store_dwordx4 v[16:19], v12, s[20:23], s47 offen offset:0 sc1
 v_mfma_f32_16x16x32_bf16 v[88:91], a[248:251], v[32:35], v[88:91]
 v_mul_f32 v100, s50, v100
 v_mfma_f32_16x16x32_bf16 v[68:71], a[32:35], v[36:39], v[68:71]
 v_mul_f32 v101, s50, v101
 v_mfma_f32_16x16x32_bf16 v[76:79], a[104:107], v[36:39], v[76:79]
 v_mul_f32 v102, s50, v102
 v_mfma_f32_16x16x32_bf16 v[84:87], a[176:179], v[36:39], v[84:87]
 v_mul_f32 v103, s50, v103
 v_mfma_f32_16x16x32_bf16 v[92:95], a[248:251], v[36:39], v[92:95]
 s_waitcnt lgkmcnt(2)
 v_mfma_f32_16x16x32_bf16 v[64:67], a[36:39], v[40:43], v[64:67]
 ds_read_b128 v[56:59], v7 offset:20480
 v_mul_f32 v108, s50, v108
 v_mfma_f32_16x16x32_bf16 v[72:75], a[108:111], v[40:43], v[72:75]
 ds_read_b128 v[60:63], v7 offset:22528
 v_mfma_f32_16x16x32_bf16 v[80:83], a[180:183], v[40:43], v[80:83]
 v_mul_f32 v109, s50, v109
 v_mfma_f32_16x16x32_bf16 v[88:91], a[252:255], v[40:43], v[88:91]
 v_mul_f32 v110, s50, v110
 v_mfma_f32_16x16x32_bf16 v[68:71], a[36:39], v[44:47], v[68:71]
 v_mul_f32 v111, s50, v111
 v_mfma_f32_16x16x32_bf16 v[76:79], a[108:111], v[44:47], v[76:79]
 v_mfma_f32_16x16x32_bf16 v[84:87], a[180:183], v[44:47], v[84:87]
 v_cvt_pk_bf16_f32 v20, v100, v101
 v_mfma_f32_16x16x32_bf16 v[92:95], a[252:255], v[44:47], v[92:95]
 s_waitcnt lgkmcnt(2)
 v_cvt_pk_bf16_f32 v21, v108, v109
 v_mfma_f32_16x16x32_bf16 v[64:67], a[40:43], v[48:51], v[64:67]
 ds_read_b128 v[32:35], v6 offset:24576
 v_mfma_f32_16x16x32_bf16 v[72:75], a[112:115], v[48:51], v[72:75]
 ds_read_b128 v[36:39], v6 offset:26624
 v_cvt_pk_bf16_f32 v22, v102, v103
 v_mfma_f32_16x16x32_bf16 v[80:83], a[184:187], v[48:51], v[80:83]
 v_mfma_f32_16x16x32_bf16 v[88:91], v[224:227], v[48:51], v[88:91]
 v_cvt_pk_bf16_f32 v23, v110, v111
 v_mfma_f32_16x16x32_bf16 v[68:71], a[40:43], v[52:55], v[68:71]
 buffer_store_dwordx4 v[20:23], v12, s[20:23], s47 offen offset:1024 sc1
 v_mfma_f32_16x16x32_bf16 v[76:79], a[112:115], v[52:55], v[76:79]
 v_mul_f32 v112, s50, v112
 v_mfma_f32_16x16x32_bf16 v[84:87], a[184:187], v[52:55], v[84:87]
 v_mul_f32 v113, s50, v113
 v_mfma_f32_16x16x32_bf16 v[92:95], v[224:227], v[52:55], v[92:95]
 s_waitcnt lgkmcnt(2)
 v_mfma_f32_16x16x32_bf16 v[64:67], a[44:47], v[56:59], v[64:67]
 ds_read_b128 v[40:43], v7 offset:24576
 v_mul_f32 v114, s50, v114
 v_mfma_f32_16x16x32_bf16 v[72:75], a[116:119], v[56:59], v[72:75]
 ds_read_b128 v[44:47], v7 offset:26624
 v_mfma_f32_16x16x32_bf16 v[80:83], a[188:191], v[56:59], v[80:83]
 v_mul_f32 v115, s50, v115
 v_mfma_f32_16x16x32_bf16 v[88:91], v[228:231], v[56:59], v[88:91]
 v_mul_f32 v120, s50, v120
 v_mfma_f32_16x16x32_bf16 v[68:71], a[44:47], v[60:63], v[68:71]
 v_mul_f32 v121, s50, v121
 v_mfma_f32_16x16x32_bf16 v[76:79], a[116:119], v[60:63], v[76:79]
 v_mfma_f32_16x16x32_bf16 v[84:87], a[188:191], v[60:63], v[84:87]
 v_mul_f32 v122, s50, v122
 v_mfma_f32_16x16x32_bf16 v[92:95], v[228:231], v[60:63], v[92:95]
 s_waitcnt lgkmcnt(2)
 v_mul_f32 v123, s50, v123
 v_mfma_f32_16x16x32_bf16 v[64:67], a[48:51], v[32:35], v[64:67]
 ds_read_b128 v[48:51], v6 offset:28672
 v_mfma_f32_16x16x32_bf16 v[72:75], a[120:123], v[32:35], v[72:75]
 ds_read_b128 v[52:55], v6 offset:30720
 v_cvt_pk_bf16_f32 v24, v112, v113
 v_mfma_f32_16x16x32_bf16 v[80:83], a[192:195], v[32:35], v[80:83]
 v_mfma_f32_16x16x32_bf16 v[88:91], v[232:235], v[32:35], v[88:91]
 v_cvt_pk_bf16_f32 v25, v120, v121
 v_mfma_f32_16x16x32_bf16 v[68:71], a[48:51], v[36:39], v[68:71]
 v_cvt_pk_bf16_f32 v26, v114, v115
 v_mfma_f32_16x16x32_bf16 v[76:79], a[120:123], v[36:39], v[76:79]
 v_cvt_pk_bf16_f32 v27, v122, v123
 v_mfma_f32_16x16x32_bf16 v[84:87], a[192:195], v[36:39], v[84:87]
 buffer_store_dwordx4 v[24:27], v12, s[20:23], s48 offen offset:0 sc1
 v_mfma_f32_16x16x32_bf16 v[92:95], v[232:235], v[36:39], v[92:95]
 s_waitcnt lgkmcnt(2)
 v_mfma_f32_16x16x32_bf16 v[64:67], a[52:55], v[40:43], v[64:67]
 ds_read_b128 v[56:59], v7 offset:28672
 v_mul_f32 v116, s50, v116
 v_mfma_f32_16x16x32_bf16 v[72:75], a[124:127], v[40:43], v[72:75]
 ds_read_b128 v[60:63], v7 offset:30720
 v_mfma_f32_16x16x32_bf16 v[80:83], a[196:199], v[40:43], v[80:83]
 s_add_u32 s43, s43, 36864
 s_cmp_eq_u32 s43, 147456
 v_mfma_f32_16x16x32_bf16 v[88:91], v[236:239], v[40:43], v[88:91]
 s_cselect_b32 s43, 0, s43
 s_add_u32 s44, s44, 36864
 v_mfma_f32_16x16x32_bf16 v[68:71], a[52:55], v[44:47], v[68:71]
 s_cmp_eq_u32 s44, 147456
 s_cselect_b32 s44, 0, s44
 v_mfma_f32_16x16x32_bf16 v[76:79], a[124:127], v[44:47], v[76:79]
 v_mul_f32 v117, s50, v117
 v_mfma_f32_16x16x32_bf16 v[84:87], a[196:199], v[44:47], v[84:87]
 v_mul_f32 v118, s50, v118
 v_mfma_f32_16x16x32_bf16 v[92:95], v[236:239], v[44:47], v[92:95]
 s_waitcnt lgkmcnt(2)
 v_mfma_f32_16x16x32_bf16 v[64:67], a[56:59], v[48:51], v[64:67]
 ds_read_b128 v[32:35], v6 offset:32768
 v_mul_f32 v119, s50, v119
 v_mfma_f32_16x16x32_bf16 v[72:75], a[128:131], v[48:51], v[72:75]
 ds_read_b128 v[36:39], v6 offset:34816
 v_mfma_f32_16x16x32_bf16 v[80:83], a[200:203], v[48:51], v[80:83]
 v_add_u32 v6, s43, v4
 v_mul_f32 v124, s50, v124
 v_mfma_f32_16x16x32_bf16 v[88:91], v[240:243], v[48:51], v[88:91]
 v_mfma_f32_16x16x32_bf16 v[68:71], a[56:59], v[52:55], v[68:71]
 v_mul_f32 v125, s50, v125
 v_mfma_f32_16x16x32_bf16 v[76:79], a[128:131], v[52:55], v[76:79]
 v_mul_f32 v126, s50, v126
 v_mfma_f32_16x16x32_bf16 v[84:87], a[200:203], v[52:55], v[84:87]
 v_mul_f32 v127, s50, v127
 v_mfma_f32_16x16x32_bf16 v[92:95], v[240:243], v[52:55], v[92:95]
 s_waitcnt lgkmcnt(2)
 v_mfma_f32_16x16x32_bf16 v[64:67], a[60:63], v[56:59], v[64:67]
 ds_read_b128 v[40:43], v7 offset:32768
 v_cvt_pk_bf16_f32 v28, v116, v117
 v_mfma_f32_16x16x32_bf16 v[72:75], a[132:135], v[56:59], v[72:75]
 ds_read_b128 v[44:47], v7 offset:34816
 v_mfma_f32_16x16x32_bf16 v[80:83], a[204:207], v[56:59], v[80:83]
 v_add_u32 v7, s43, v5
 v_cvt_pk_bf16_f32 v29, v124, v125
 v_mfma_f32_16x16x32_bf16 v[88:91], v[244:247], v[56:59], v[88:91]
 v_cvt_pk_bf16_f32 v30, v118, v119
 v_mfma_f32_16x16x32_bf16 v[68:71], a[60:63], v[60:63], v[68:71]
 v_mfma_f32_16x16x32_bf16 v[76:79], a[132:135], v[60:63], v[76:79]
 v_cvt_pk_bf16_f32 v31, v126, v127
 v_mfma_f32_16x16x32_bf16 v[84:87], a[204:207], v[60:63], v[84:87]
 buffer_store_dwordx4 v[28:31], v12, s[20:23], s48 offen offset:1024 sc1
 v_mfma_f32_16x16x32_bf16 v[92:95], v[244:247], v[60:63], v[92:95]
 s_waitcnt lgkmcnt(2)
 v_mfma_f32_16x16x32_bf16 v[64:67], a[64:67], v[32:35], v[64:67]
 s_waitcnt vmcnt(13)
 s_barrier
 ds_read_b128 v[48:51], v6 offset:0
 v_mfma_f32_16x16x32_bf16 v[72:75], a[136:139], v[32:35], v[72:75]
 ds_read_b128 v[52:55], v6 offset:2048
 v_mfma_f32_16x16x32_bf16 v[80:83], a[208:211], v[32:35], v[80:83]
 v_mfma_f32_16x16x32_bf16 v[88:91], v[248:251], v[32:35], v[88:91]
 v_mfma_f32_16x16x32_bf16 v[68:71], a[64:67], v[36:39], v[68:71]
 v_mfma_f32_16x16x32_bf16 v[76:79], a[136:139], v[36:39], v[76:79]
 v_mfma_f32_16x16x32_bf16 v[84:87], a[208:211], v[36:39], v[84:87]
 v_mfma_f32_16x16x32_bf16 v[92:95], v[248:251], v[36:39], v[92:95]
 s_waitcnt lgkmcnt(2)
 v_mfma_f32_16x16x32_bf16 v[64:67], a[68:71], v[40:43], v[64:67]
 ds_read_b128 v[56:59], v7 offset:0
 v_mfma_f32_16x16x32_bf16 v[72:75], a[140:143], v[40:43], v[72:75]
 ds_read_b128 v[60:63], v7 offset:2048
 v_mfma_f32_16x16x32_bf16 v[80:83], a[212:215], v[40:43], v[80:83]
 s_mul_i32 s45, s39, 262144
 s_add_u32 s47, s34, s45
 v_mfma_f32_16x16x32_bf16 v[88:91], v[252:255], v[40:43], v[88:91]
 s_add_u32 s48, s35, s45
 v_mov_b32 v14, s42
 v_mfma_f32_16x16x32_bf16 v[68:71], a[68:71], v[44:47], v[68:71]
 s_mov_b32 s39, s40
 s_mov_b32 s40, s41
 v_mfma_f32_16x16x32_bf16 v[76:79], a[140:143], v[44:47], v[76:79]
 s_add_u32 s42, s42, 1
 v_mfma_f32_16x16x32_bf16 v[84:87], a[212:215], v[44:47], v[84:87]
 v_mfma_f32_16x16x32_bf16 v[92:95], v[252:255], v[44:47], v[92:95]
 s_waitcnt lgkmcnt(2)
 v_mfma_f32_16x16x32_bf16 v[96:99], a[0:3], v[48:51], 0
 ds_read_b128 v[32:35], v6 offset:4096
 v_mfma_f32_16x16x32_bf16 v[104:107], a[72:75], v[48:51], 0
 ds_read_b128 v[36:39], v6 offset:6144
 v_mfma_f32_16x16x32_bf16 v[112:115], a[144:147], v[48:51], 0
 s_add_u32 s41, s40, 4
 v_mfma_f32_16x16x32_bf16 v[120:123], a[216:219], v[48:51], 0
 s_add_u32 s45, s42, 2
 s_mul_i32 s46, s41, 36864
 v_mfma_f32_16x16x32_bf16 v[100:103], a[0:3], v[52:55], 0
 s_cmp_lt_u32 s45, s36
 s_cselect_b32 s46, s46, 0
 v_mfma_f32_16x16x32_bf16 v[108:111], a[72:75], v[52:55], 0
 s_lshl_b32 s49, s4, 10
 s_add_u32 s49, s49, s44
 v_mfma_f32_16x16x32_bf16 v[116:119], a[144:147], v[52:55], 0
 v_mfma_f32_16x16x32_bf16 v[124:127], a[216:219], v[52:55], 0
 s_waitcnt lgkmcnt(2)
 v_mfma_f32_16x16x32_bf16 v[96:99], a[4:7], v[56:59], v[96:99]
 ds_read_b128 v[40:43], v7 offset:4096
 v_mfma_f32_16x16x32_bf16 v[104:107], a[76:79], v[56:59], v[104:107]
 ds_read_b128 v[44:47], v7 offset:6144
 v_mfma_f32_16x16x32_bf16 v[112:115], a[148:151], v[56:59], v[112:115]
 s_add_u32 m0, s49, 0
 v_mfma_f32_16x16x32_bf16 v[120:123], a[220:223], v[56:59], v[120:123]
 buffer_load_dwordx4 v10, s[8:11], s46 offen offset:0  lds
 v_mfma_f32_16x16x32_bf16 v[100:103], a[4:7], v[60:63], v[100:103]
 s_add_u32 m0, s49, 3968
 v_mfma_f32_16x16x32_bf16 v[108:111], a[76:79], v[60:63], v[108:111]
 buffer_load_dwordx4 v10, s[8:11], s46 offen offset:128  lds
 v_mfma_f32_16x16x32_bf16 v[116:119], a[148:151], v[60:63], v[116:119]
 v_mfma_f32_16x16x32_bf16 v[124:127], a[220:223], v[60:63], v[124:127]
 s_waitcnt lgkmcnt(2)
 v_mfma_f32_16x16x32_bf16 v[96:99], a[8:11], v[32:35], v[96:99]
 ds_read_b128 v[48:51], v6 offset:8192
 v_mfma_f32_16x16x32_bf16 v[104:107], a[80:83], v[32:35], v[104:107]
 ds_read_b128 v[52:55], v6 offset:10240
 v_mfma_f32_16x16x32_bf16 v[112:115], a[152:155], v[32:35], v[112:115]
 s_add_u32 m0, s49, 7936
 v_mfma_f32_16x16x32_bf16 v[120:123], a[224:227], v[32:35], v[120:123]
 buffer_load_dwordx4 v10, s[8:11], s46 offen offset:256  lds
 v_mfma_f32_16x16x32_bf16 v[100:103], a[8:11], v[36:39], v[100:103]
 s_add_u32 m0, s49, 11904
 v_mfma_f32_16x16x32_bf16 v[108:111], a[80:83], v[36:39], v[108:111]
 buffer_load_dwordx4 v10, s[8:11], s46 offen offset:384  lds
 v_mfma_f32_16x16x32_bf16 v[116:119], a[152:155], v[36:39], v[116:119]
 v_mfma_f32_16x16x32_bf16 v[124:127], a[224:227], v[36:39], v[124:127]
 s_waitcnt lgkmcnt(2)
 v_mfma_f32_16x16x32_bf16 v[96:99], a[12:15], v[40:43], v[96:99]
 ds_read_b128 v[56:59], v7 offset:8192
 v_mfma_f32_16x16x32_bf16 v[104:107], a[84:87], v[40:43], v[104:107]
 ds_read_b128 v[60:63], v7 offset:10240
 v_mfma_f32_16x16x32_bf16 v[112:115], a[156:159], v[40:43], v[112:115]
 s_add_u32 m0, s49, 15872
 v_mfma_f32_16x16x32_bf16 v[120:123], a[228:231], v[40:43], v[120:123]
 buffer_load_dwordx4 v10, s[8:11], s46 offen offset:512  lds
 v_mfma_f32_16x16x32_bf16 v[100:103], a[12:15], v[44:47], v[100:103]
 s_add_u32 m0, s49, 19840
 v_mfma_f32_16x16x32_bf16 v[108:111], a[84:87], v[44:47], v[108:111]
 buffer_load_dwordx4 v10, s[8:11], s46 offen offset:640  lds
 v_mfma_f32_16x16x32_bf16 v[116:119], a[156:159], v[44:47], v[116:119]
 v_mfma_f32_16x16x32_bf16 v[124:127], a[228:231], v[44:47], v[124:127]
 s_waitcnt lgkmcnt(2)
 v_mfma_f32_16x16x32_bf16 v[96:99], a[16:19], v[48:51], v[96:99]
 ds_read_b128 v[32:35], v6 offset:12288
 v_mfma_f32_16x16x32_bf16 v[104:107], a[88:91], v[48:51], v[104:107]
 ds_read_b128 v[36:39], v6 offset:14336
 v_mfma_f32_16x16x32_bf16 v[112:115], a[160:163], v[48:51], v[112:115]
 s_add_u32 m0, s49, 23808
 v_mfma_f32_16x16x32_bf16 v[120:123], a[232:235], v[48:51], v[120:123]
 buffer_load_dwordx4 v10, s[8:11], s46 offen offset:768  lds
 v_mfma_f32_16x16x32_bf16 v[100:103], a[16:19], v[52:55], v[100:103]
 s_add_u32 m0, s49, 27776
 v_mfma_f32_16x16x32_bf16 v[108:111], a[88:91], v[52:55], v[108:111]
 buffer_load_dwordx4 v10, s[8:11], s46 offen offset:896  lds
 v_mfma_f32_16x16x32_bf16 v[116:119], a[160:163], v[52:55], v[116:119]
 v_mfma_f32_16x16x32_bf16 v[124:127], a[232:235], v[52:55], v[124:127]
 s_waitcnt lgkmcnt(2)
 v_mfma_f32_16x16x32_bf16 v[96:99], a[20:23], v[56:59], v[96:99]
 ds_read_b128 v[40:43], v7 offset:12288
 v_mfma_f32_16x16x32_bf16 v[104:107], a[92:95], v[56:59], v[104:107]
 ds_read_b128 v[44:47], v7 offset:14336
 v_mfma_f32_16x16x32_bf16 v[112:115], a[164:167], v[56:59], v[112:115]
 s_add_u32 m0, s49, 31744
 v_mfma_f32_16x16x32_bf16 v[120:123], a[236:239], v[56:59], v[120:123]
 buffer_load_dwordx4 v10, s[8:11], s46 offen offset:1024  lds
 v_mfma_f32_16x16x32_bf16 v[100:103], a[20:23], v[60:63], v[100:103]
 v_mfma_f32_16x16x32_bf16 v[108:111], a[92:95], v[60:63], v[108:111]
 v_mfma_f32_16x16x32_bf16 v[116:119], a[164:167], v[60:63], v[116:119]
 v_mfma_f32_16x16x32_bf16 v[124:127], a[236:239], v[60:63], v[124:127]
 s_waitcnt lgkmcnt(2)
 v_mfma_f32_16x16x32_bf16 v[96:99], a[24:27], v[32:35], v[96:99]
 ds_read_b128 v[48:51], v6 offset:16384
 v_mul_f32 v64, s50, v64
 v_mfma_f32_16x16x32_bf16 v[104:107], a[96:99], v[32:35], v[104:107]
 ds_read_b128 v[52:55], v6 offset:18432
 v_mfma_f32_16x16x32_bf16 v[112:115], a[168:171], v[32:35], v[112:115]
 v_mul_f32 v65, s50, v65
 v_mfma_f32_16x16x32_bf16 v[120:123], a[240:243], v[32:35], v[120:123]
 v_mul_f32 v66, s50, v66
 v_mfma_f32_16x16x32_bf16 v[100:103], a[24:27], v[36:39], v[100:103]
 v_mul_f32 v67, s50, v67
 v_mfma_f32_16x16x32_bf16 v[108:111], a[96:99], v[36:39], v[108:111]
 v_mul_f32 v72, s50, v72
 v_mfma_f32_16x16x32_bf16 v[116:119], a[168:171], v[36:39], v[116:119]
 v_mul_f32 v73, s50, v73
 v_mfma_f32_16x16x32_bf16 v[124:127], a[240:243], v[36:39], v[124:127]
 s_waitcnt lgkmcnt(2)
 v_mfma_f32_16x16x32_bf16 v[96:99], a[28:31], v[40:43], v[96:99]
 ds_read_b128 v[56:59], v7 offset:16384
 v_mfma_f32_16x16x32_bf16 v[104:107], a[100:103], v[40:43], v[104:107]
 ds_read_b128 v[60:63], v7 offset:18432
 v_mul_f32 v74, s50, v74
 v_mfma_f32_16x16x32_bf16 v[112:115], a[172:175], v[40:43], v[112:115]
 v_mul_f32 v75, s50, v75
 v_mfma_f32_16x16x32_bf16 v[120:123], a[244:247], v[40:43], v[120:123]
 v_cvt_pk_bf16_f32 v16, v64, v65
 v_mfma_f32_16x16x32_bf16 v[100:103], a[28:31], v[44:47], v[100:103]
 v_mfma_f32_16x16x32_bf16 v[108:111], a[100:103], v[44:47], v[108:111]
 v_cvt_pk_bf16_f32 v17, v72, v73
 v_mfma_f32_16x16x32_bf16 v[116:119], a[172:175], v[44:47], v[116:119]
 v_cvt_pk_bf16_f32 v18, v66, v67
 v_mfma_f32_16x16x32_bf16 v[124:127], a[244:247], v[44:47], v[124:127]
 s_waitcnt lgkmcnt(2)
 v_cvt_pk_bf16_f32 v19, v74, v75
 v_mfma_f32_16x16x32_bf16 v[96:99], a[32:35], v[48:51], v[96:99]
 ds_read_b128 v[32:35], v6 offset:20480
 v_mfma_f32_16x16x32_bf16 v[104:107], a[104:107], v[48:51], v[104:107]
 ds_read_b128 v[36:39], v6 offset:22528
 v_mfma_f32_16x16x32_bf16 v[112:115], a[176:179], v[48:51], v[112:115]
 buffer_store_dwordx4 v[16:19], v12, s[20:23], s47 offen offset:0 sc1
 v_mfma_f32_16x16x32_bf16 v[120:123], a[248:251], v[48:51], v[120:123]
 v_mul_f32 v68, s50, v68
 v_mfma_f32_16x16x32_bf16 v[100:103], a[32:35], v[52:55], v[100:103]
 v_mul_f32 v69, s50, v69
 v_mfma_f32_16x16x32_bf16 v[108:111], a[104:107], v[52:55], v[108:111]
 v_mul_f32 v70, s50, v70
 v_mfma_f32_16x16x32_bf16 v[116:119], a[176:179], v[52:55], v[116:119]
 v_mul_f32 v71, s50, v71
 v_mfma_f32_16x16x32_bf16 v[124:127], a[248:251], v[52:55], v[124:127]
 s_waitcnt lgkmcnt(2)
 v_mfma_f32_16x16x32_bf16 v[96:99], a[36:39], v[56:59], v[96:99]
 ds_read_b128 v[40:43], v7 offset:20480
 v_mul_f32 v76, s50, v76
 v_mfma_f32_16x16x32_bf16 v[104:107], a[108:111], v[56:59], v[104:107]
 ds_read_b128 v[44:47], v7 offset:22528
 v_mfma_f32_16x16x32_bf16 v[112:115], a[180:183], v[56:59], v[112:115]
 v_mul_f32 v77, s50, v77
 v_mfma_f32_16x16x32_bf16 v[120:123], a[252:255], v[56:59], v[120:123]
 v_mul_f32 v78, s50, v78
 v_mfma_f32_16x16x32_bf16 v[100:103], a[36:39], v[60:63], v[100:103]
 v_mul_f32 v79, s50, v79
 v_mfma_f32_16x16x32_bf16 v[108:111], a[108:111], v[60:63], v[108:111]
 v_mfma_f32_16x16x32_bf16 v[116:119], a[180:183], v[60:63], v[116:119]
 v_cvt_pk_bf16_f32 v20, v68, v69
 v_mfma_f32_16x16x32_bf16 v[124:127], a[252:255], v[60:63], v[124:127]
 s_waitcnt lgkmcnt(2)
 v_cvt_pk_bf16_f32 v21, v76, v77
 v_mfma_f32_16x16x32_bf16 v[96:99], a[40:43], v[32:35], v[96:99]
 ds_read_b128 v[48:51], v6 offset:24576
 v_mfma_f32_16x16x32_bf16 v[104:107], a[112:115], v[32:35], v[104:107]
 ds_read_b128 v[52:55], v6 offset:26624
 v_cvt_pk_bf16_f32 v22, v70, v71
 v_mfma_f32_16x16x32_bf16 v[112:115], a[184:187], v[32:35], v[112:115]
 v_mfma_f32_16x16x32_bf16 v[120:123], v[224:227], v[32:35], v[120:123]
 v_cvt_pk_bf16_f32 v23, v78, v79
 v_mfma_f32_16x16x32_bf16 v[100:103], a[40:43], v[36:39], v[100:103]
 buffer_store_dwordx4 v[20:23], v12, s[20:23], s47 offen offset:1024 sc1
 v_mfma_f32_16x16x32_bf16 v[108:111], a[112:115], v[36:39], v[108:111]
 v_mul_f32 v80, s50, v80
 v_mfma_f32_16x16x32_bf16 v[116:119], a[184:187], v[36:39], v[116:119]
 v_mul_f32 v81, s50, v81
 v_mfma_f32_16x16x32_bf16 v[124:127], v[224:227], v[36:39], v[124:127]
 s_waitcnt lgkmcnt(2)
 v_mfma_f32_16x16x32_bf16 v[96:99], a[44:47], v[40:43], v[96:99]
 ds_read_b128 v[56:59], v7 offset:24576
 v_mul_f32 v82, s50, v82
 v_mfma_f32_16x16x32_bf16 v[104:107], a[116:119], v[40:43], v[104:107]
 ds_read_b128 v[60:63], v7 offset:26624
 v_mfma_f32_16x16x32_bf16 v[112:115], a[188:191], v[40:43], v[112:115]
 v_mul_f32 v83, s50, v83
 v_mfma_f32_16x16x32_bf16 v[120:123], v[228:231], v[40:43], v[120:123]
 v_mul_f32 v88, s50, v88
 v_mfma_f32_16x16x32_bf16 v[100:103], a[44:47], v[44:47], v[100:103]
 v_mul_f32 v89, s50, v89
 v_mfma_f32_16x16x32_bf16 v[108:111], a[116:119], v[44:47], v[108:111]
 v_mfma_f32_16x16x32_bf16 v[116:119], a[188:191], v[44:47], v[116:119]
 v_mul_f32 v90, s50, v90
 v_mfma_f32_16x16x32_bf16 v[124:127], v[228:231], v[44:47], v[124:127]
 s_waitcnt lgkmcnt(2)
 v_mul_f32 v91, s50, v91
 v_mfma_f32_16x16x32_bf16 v[96:99], a[48:51], v[48:51], v[96:99]
 ds_read_b128 v[32:35], v6 offset:28672
 v_mfma_f32_16x16x32_bf16 v[104:107], a[120:123], v[48:51], v[104:107]
 ds_read_b128 v[36:39], v6 offset:30720
 v_cvt_pk_bf16_f32 v24, v80, v81
 v_mfma_f32_16x16x32_bf16 v[112:115], a[192:195], v[48:51], v[112:115]
 v_mfma_f32_16x16x32_bf16 v[120:123], v[232:235], v[48:51], v[120:123]
 v_cvt_pk_bf16_f32 v25, v88, v89
 v_mfma_f32_16x16x32_bf16 v[100:103], a[48:51], v[52:55], v[100:103]
 v_cvt_pk_bf16_f32 v26, v82, v83
 v_mfma_f32_16x16x32_bf16 v[108:111], a[120:123], v[52:55], v[108:111]
 v_cvt_pk_bf16_f32 v27, v90, v91
 v_mfma_f32_16x16x32_bf16 v[116:119], a[192:195], v[52:55], v[116:119]
 buffer_store_dwordx4 v[24:27], v12, s[20:23], s48 offen offset:0 sc1
 v_mfma_f32_16x16x32_bf16 v[124:127], v[232:235], v[52:55], v[124:127]
 s_waitcnt lgkmcnt(2)
 v_mfma_f32_16x16x32_bf16 v[96:99], a[52:55], v[56:59], v[96:99]
 ds_read_b128 v[40:43], v7 offset:28672
 v_mul_f32 v84, s50, v84
 v_mfma_f32_16x16x32_bf16 v[104:107], a[124:127], v[56:59], v[104:107]
 ds_read_b128 v[44:47], v7 offset:30720
 v_mfma_f32_16x16x32_bf16 v[112:115], a[196:199], v[56:59], v[112:115]
 s_add_u32 s43, s43, 36864
 s_cmp_eq_u32 s43, 147456
 v_mfma_f32_16x16x32_bf16 v[120:123], v[236:239], v[56:59], v[120:123]
 s_cselect_b32 s43, 0, s43
 s_add_u32 s44, s44, 36864
 v_mfma_f32_16x16x32_bf16 v[100:103], a[52:55], v[60:63], v[100:103]
 s_cmp_eq_u32 s44, 147456
 s_cselect_b32 s44, 0, s44
 v_mfma_f32_16x16x32_bf16 v[108:111], a[124:127], v[60:63], v[108:111]
 v_mul_f32 v85, s50, v85
 v_mfma_f32_16x16x32_bf16 v[116:119], a[196:199], v[60:63], v[116:119]
 v_mul_f32 v86, s50, v86
 v_mfma_f32_16x16x32_bf16 v[124:127], v[236:239], v[60:63], v[124:127]
 s_waitcnt lgkmcnt(2)
 v_mfma_f32_16x16x32_bf16 v[96:99], a[56:59], v[32:35], v[96:99]
 ds_read_b128 v[48:51], v6 offset:32768
 v_mul_f32 v87, s50, v87
 v_mfma_f32_16x16x32_bf16 v[104:107], a[128:131], v[32:35], v[104:107]
 ds_read_b128 v[52:55], v6 offset:34816
 v_mfma_f32_16x16x32_bf16 v[112:115], a[200:203], v[32:35], v[112:115]
 v_add_u32 v6, s43, v4
 v_mul_f32 v92, s50, v92
 v_mfma_f32_16x16x32_bf16 v[120:123], v[240:243], v[32:35], v[120:123]
 v_mfma_f32_16x16x32_bf16 v[100:103], a[56:59], v[36:39], v[100:103]
 v_mul_f32 v93, s50, v93
 v_mfma_f32_16x16x32_bf16 v[108:111], a[128:131], v[36:39], v[108:111]
 v_mul_f32 v94, s50, v94
 v_mfma_f32_16x16x32_bf16 v[116:119], a[200:203], v[36:39], v[116:119]
 v_mul_f32 v95, s50, v95
 v_mfma_f32_16x16x32_bf16 v[124:127], v[240:243], v[36:39], v[124:127]
 s_waitcnt lgkmcnt(2)
 v_mfma_f32_16x16x32_bf16 v[96:99], a[60:63], v[40:43], v[96:99]
 ds_read_b128 v[56:59], v7 offset:32768
 v_cvt_pk_bf16_f32 v28, v84, v85
 v_mfma_f32_16x16x32_bf16 v[104:107], a[132:135], v[40:43], v[104:107]
 ds_read_b128 v[60:63], v7 offset:34816
 v_mfma_f32_16x16x32_bf16 v[112:115], a[204:207], v[40:43], v[112:115]
 v_add_u32 v7, s43, v5
 v_cvt_pk_bf16_f32 v29, v92, v93
 v_mfma_f32_16x16x32_bf16 v[120:123], v[244:247], v[40:43], v[120:123]
 v_cvt_pk_bf16_f32 v30, v86, v87
 v_mfma_f32_16x16x32_bf16 v[100:103], a[60:63], v[44:47], v[100:103]
 v_mfma_f32_16x16x32_bf16 v[108:111], a[132:135], v[44:47], v[108:111]
 v_cvt_pk_bf16_f32 v31, v94, v95
 v_mfma_f32_16x16x32_bf16 v[116:119], a[204:207], v[44:47], v[116:119]
 buffer_store_dwordx4 v[28:31], v12, s[20:23], s48 offen offset:1024 sc1
 v_mfma_f32_16x16x32_bf16 v[124:127], v[244:247], v[44:47], v[124:127]
 s_waitcnt lgkmcnt(2)
 v_mfma_f32_16x16x32_bf16 v[96:99], a[64:67], v[48:51], v[96:99]
 s_waitcnt vmcnt(13)
 s_barrier
 ds_read_b128 v[32:35], v6 offset:0
 v_mfma_f32_16x16x32_bf16 v[104:107], a[136:139], v[48:51], v[104:107]
 ds_read_b128 v[36:39], v6 offset:2048
 v_mfma_f32_16x16x32_bf16 v[112:115], a[208:211], v[48:51], v[112:115]
 v_mfma_f32_16x16x32_bf16 v[120:123], v[248:251], v[48:51], v[120:123]
 v_mfma_f32_16x16x32_bf16 v[100:103], a[64:67], v[52:55], v[100:103]
 v_mfma_f32_16x16x32_bf16 v[108:111], a[136:139], v[52:55], v[108:111]
 v_mfma_f32_16x16x32_bf16 v[116:119], a[208:211], v[52:55], v[116:119]
 v_mfma_f32_16x16x32_bf16 v[124:127], v[248:251], v[52:55], v[124:127]
 s_waitcnt lgkmcnt(2)
 v_mfma_f32_16x16x32_bf16 v[96:99], a[68:71], v[56:59], v[96:99]
 ds_read_b128 v[40:43], v7 offset:0
 v_mfma_f32_16x16x32_bf16 v[104:107], a[140:143], v[56:59], v[104:107]
 ds_read_b128 v[44:47], v7 offset:2048
 v_mfma_f32_16x16x32_bf16 v[112:115], a[212:215], v[56:59], v[112:115]
 s_mul_i32 s45, s39, 262144
 s_add_u32 s47, s34, s45
 v_mfma_f32_16x16x32_bf16 v[120:123], v[252:255], v[56:59], v[120:123]
 s_add_u32 s48, s35, s45
 v_mov_b32 v14, s42
 v_mfma_f32_16x16x32_bf16 v[100:103], a[68:71], v[60:63], v[100:103]
 s_mov_b32 s39, s40
 s_mov_b32 s40, s41
 v_mfma_f32_16x16x32_bf16 v[108:111], a[140:143], v[60:63], v[108:111]
 s_add_u32 s42, s42, 1
 s_cmp_lt_u32 s42, s36
 v_mfma_f32_16x16x32_bf16 v[116:119], a[212:215], v[60:63], v[116:119]
 v_mfma_f32_16x16x32_bf16 v[124:127], v[252:255], v[60:63], v[124:127]
 s_waitcnt lgkmcnt(2)
 s_cbranch_scc1 Lps_loop_21
 s_nop 7
 v_mul_f32 v96, s50, v96
 v_mul_f32 v97, s50, v97
 v_mul_f32 v98, s50, v98
 v_mul_f32 v99, s50, v99
 v_mul_f32 v104, s50, v104
 v_mul_f32 v105, s50, v105
 v_mul_f32 v106, s50, v106
 v_mul_f32 v107, s50, v107
 v_cvt_pk_bf16_f32 v16, v96, v97
 v_cvt_pk_bf16_f32 v17, v104, v105
 v_cvt_pk_bf16_f32 v18, v98, v99
 v_cvt_pk_bf16_f32 v19, v106, v107
 buffer_store_dwordx4 v[16:19], v12, s[20:23], s47 offen offset:0 sc1
 v_mul_f32 v100, s50, v100
 v_mul_f32 v101, s50, v101
 v_mul_f32 v102, s50, v102
 v_mul_f32 v103, s50, v103
 v_mul_f32 v108, s50, v108
 v_mul_f32 v109, s50, v109
 v_mul_f32 v110, s50, v110
 v_mul_f32 v111, s50, v111
 v_cvt_pk_bf16_f32 v20, v100, v101
 v_cvt_pk_bf16_f32 v21, v108, v109
 v_cvt_pk_bf16_f32 v22, v102, v103
 v_cvt_pk_bf16_f32 v23, v110, v111
 buffer_store_dwordx4 v[20:23], v12, s[20:23], s47 offen offset:1024 sc1
 v_mul_f32 v112, s50, v112
 v_mul_f32 v113, s50, v113
 v_mul_f32 v114, s50, v114
 v_mul_f32 v115, s50, v115
 v_mul_f32 v120, s50, v120
 v_mul_f32 v121, s50, v121
 v_mul_f32 v122, s50, v122
 v_mul_f32 v123, s50, v123
 v_cvt_pk_bf16_f32 v24, v112, v113
 v_cvt_pk_bf16_f32 v25, v120, v121
 v_cvt_pk_bf16_f32 v26, v114, v115
 v_cvt_pk_bf16_f32 v27, v122, v123
 buffer_store_dwordx4 v[24:27], v12, s[20:23], s48 offen offset:0 sc1
 v_mul_f32 v116, s50, v116
 v_mul_f32 v117, s50, v117
 v_mul_f32 v118, s50, v118
 v_mul_f32 v119, s50, v119
 v_mul_f32 v124, s50, v124
 v_mul_f32 v125, s50, v125
 v_mul_f32 v126, s50, v126
 v_mul_f32 v127, s50, v127
 v_cvt_pk_bf16_f32 v28, v116, v117
 v_cvt_pk_bf16_f32 v29, v124, v125
 v_cvt_pk_bf16_f32 v30, v118, v119
 v_cvt_pk_bf16_f32 v31, v126, v127
 buffer_store_dwordx4 v[28:31], v12, s[20:23], s48 offen offset:1024 sc1
 s_waitcnt vmcnt(0) lgkmcnt(0)
 s_barrier
 v_mov_b32 v14, s36
 buffer_store_dword v14, v13, s[20:23], 0 offen sc1
 s_cmp_ge_u32 s6, 28
 s_cbranch_scc1 Lfin
 s_sub_u32 s3, s5, 2
 s_cmp_ge_u32 s6, 16
 s_cbranch_scc1 Lob
 s_load_dwordx2 s[8:9], s[0:1], 48
 s_mov_b32 s10, 0x240000
 s_mov_b32 s11, 0x20000
 s_load_dwordx2 s[12:13], s[0:1], 64
 s_mov_b32 s14, 0x480000
 s_mov_b32 s15, 0x20000
 s_load_dwordx2 s[16:17], s[0:1], 64
 s_mov_b32 s18, 0x480000
 s_mov_b32 s19, 0x20000
 s_lshl_b32 s32, s6, 9
 s_add_u32 s33, s32, 256
 s_mov_b32 s36, 32
 s_mov_b32 s37, s3
 s_lshl_b32 s52, s6, 1
 s_lshl_b32 s7, s3, 4
 s_add_u32 s7, s7, s6
 s_lshl_b32 s7, s7, 4
 s_add_u32 s59, s7, 0x3800
 s_waitcnt lgkmcnt(0)
 v_and_b32 v1, 63, v0
 v_lshrrev_b32 v2, 3, v0
 v_mul_u32_u24 v10, 1152, v2
 v_lshrrev_b32 v2, 4, v0
 v_xor_b32 v2, v2, v0
 v_and_b32 v2, 7, v2
 v_lshl_add_u32 v10, v2, 4, v10
 v_lshrrev_b32 v2, 4, v1
 v_bfe_u32 v3, v1, 1, 3
 v_xor_b32 v2, v2, v3
 v_and_b32 v3, 15, v1
 v_lshlrev_b32 v3, 7, v3
 v_lshl_add_u32 v4, v2, 4, v3
 v_xor_b32 v5, 64, v4
 v_lshrrev_b32 v2, 4, v0
 v_lshlrev_b32 v11, 13, v2
 v_lshrrev_b32 v2, 7, v0
 v_lshrrev_b32 v3, 4, v1
 v_lshl_add_u32 v3, v2, 2, v3
 v_bfe_u32 v2, v1, 1, 3
 v_xor_b32 v2, v2, v3
 v_lshl_add_u32 v11, v2, 5, v11
 v_and_b32 v2, 1, v1
 v_lshl_add_u32 v11, v2, 4, v11
 v_bfe_u32 v2, v1, 2, 3
 v_xor_b32 v3, s4, v2
 v_lshlrev_b32 v3, 5, v3
 v_and_b32 v2, 3, v2
 v_lshl_add_u32 v3, v2, 8, v3
 v_lshrrev_b32 v2, 4, v1
 v_lshl_add_u32 v3, v2, 11, v3
 v_and_b32 v2, 3, v1
 v_lshl_add_u32 v3, v2, 3, v3
 v_add_u32 v8, 73728, v3
 v_xor_b32 v3, 0x80, v3
 v_add_u32 v9, 73728, v3
 s_lshl_b32 s45, s4, 11
 v_lshl_add_u32 v12, v1, 4, s45
 s_mov_b32 s39, s37
 s_add_u32 s40, s39, 2
 s_lshl_b32 s49, s4, 10
 s_mul_i32 s46, s39, 36864
 s_add_u32 m0, s49, 0
 s_nop 0
 buffer_load_dwordx4 v10, s[8:11], s46 offen offset:0  lds
 s_add_u32 m0, s49, 3968
 s_nop 0
 buffer_load_dwordx4 v10, s[8:11], s46 offen offset:128  lds
 s_add_u32 m0, s49, 7936
 s_nop 0
 buffer_load_dwordx4 v10, s[8:11], s46 offen offset:256  lds
 s_add_u32 m0, s49, 11904
 s_nop 0
 buffer_load_dwordx4 v10, s[8:11], s46 offen offset:384  lds
 s_add_u32 m0, s49, 15872
 s_nop 0
 buffer_load_dwordx4 v10, s[8:11], s46 offen offset:512  lds
 s_add_u32 m0, s49, 19840
 s_nop 0
 buffer_load_dwordx4 v10, s[8:11], s46 offen offset:640  lds
 s_add_u32 m0, s49, 23808
 s_nop 0
 buffer_load_dwordx4 v10, s[8:11], s46 offen offset:768  lds
 s_add_u32 m0, s49, 27776
 s_nop 0
 buffer_load_dwordx4 v10, s[8:11], s46 offen offset:896  lds
 s_add_u32 m0, s49, 31744
 s_nop 0
 buffer_load_dwordx4 v10, s[8:11], s46 offen offset:1024  lds
 s_lshl_b32 s49, s4, 10
 s_add_u32 s49, s49, 36864
 s_mul_i32 s46, s40, 36864
 s_add_u32 m0, s49, 0
 s_nop 0
 buffer_load_dwordx4 v10, s[8:11], s46 offen offset:0  lds
 s_add_u32 m0, s49, 3968
 s_nop 0
 buffer_load_dwordx4 v10, s[8:11], s46 offen offset:128  lds
 s_add_u32 m0, s49, 7936
 s_nop 0
 buffer_load_dwordx4 v10, s[8:11], s46 offen offset:256  lds
 s_add_u32 m0, s49, 11904
 s_nop 0
 buffer_load_dwordx4 v10, s[8:11], s46 offen offset:384  lds
 s_add_u32 m0, s49, 15872
 s_nop 0
 buffer_load_dwordx4 v10, s[8:11], s46 offen offset:512  lds
 s_add_u32 m0, s49, 19840
 s_nop 0
 buffer_load_dwordx4 v10, s[8:11], s46 offen offset:640  lds
 s_add_u32 m0, s49, 23808
 s_nop 0
 buffer_load_dwordx4 v10, s[8:11], s46 offen offset:768  lds
 s_add_u32 m0, s49, 27776
 s_nop 0
 buffer_load_dwordx4 v10, s[8:11], s46 offen offset:896  lds
 s_add_u32 m0, s49, 31744
 s_nop 0
 buffer_load_dwordx4 v10, s[8:11], s46 offen offset:1024  lds
 s_lshl_b32 s49, s4, 10
 s_add_u32 m0, s49, 73728
 s_add_u32 s45, s32, 0
 buffer_load_dwordx4 v11, s[12:15], s45 offen  lds
 s_add_u32 m0, s49, 77824
 s_add_u32 s45, s32, 131072
 buffer_load_dwordx4 v11, s[12:15], s45 offen  lds
 s_add_u32 m0, s49, 81920
 s_add_u32 s45, s33, 0
 buffer_load_dwordx4 v11, s[16:19], s45 offen  lds
 s_add_u32 m0, s49, 86016
 s_add_u32 s45, s33, 131072
 buffer_load_dwordx4 v11, s[16:19], s45 offen  lds
 s_add_u32 m0, s49, 90112
 s_add_u32 s45, s32, 262144
 buffer_load_dwordx4 v11, s[12:15], s45 offen  lds
 s_add_u32 m0, s49, 94208
 s_add_u32 s45, s32, 393216
 buffer_load_dwordx4 v11, s[12:15], s45 offen  lds
 s_add_u32 m0, s49, 98304
 s_add_u32 s45, s33, 262144
 buffer_load_dwordx4 v11, s[16:19], s45 offen  lds
 s_add_u32 m0, s49, 102400
 s_add_u32 s45, s33, 393216
 buffer_load_dwordx4 v11, s[16:19], s45 offen  lds
 s_add_u32 m0, s49, 106496
 s_add_u32 s45, s32, 524288
 buffer_load_dwordx4 v11, s[12:15], s45 offen  lds
 s_add_u32 m0, s49, 110592
 s_add_u32 s45, s32, 655360
 buffer_load_dwordx4 v11, s[12:15], s45 offen  lds
 s_add_u32 m0, s49, 114688
 s_add_u32 s45, s33, 524288
 buffer_load_dwordx4 v11, s[16:19], s45 offen  lds
 s_add_u32 m0, s49, 118784
 s_add_u32 s45, s33, 655360
 buffer_load_dwordx4 v11, s[16:19], s45 offen  lds
 s_waitcnt vmcnt(8) lgkmcnt(0)
 s_barrier
 s_add_u32 m0, s49, 122880
 s_add_u32 s45, s32, 786432
 buffer_load_dwordx4 v11, s[12:15], s45 offen  lds
 s_add_u32 m0, s49, 126976
 s_add_u32 s45, s32, 917504
 buffer_load_dwordx4 v11, s[12:15], s45 offen  lds
 s_add_u32 m0, s49, 131072
 s_add_u32 s45, s33, 786432
 buffer_load_dwordx4 v11, s[16:19], s45 offen  lds
 s_add_u32 m0, s49, 135168
 s_add_u32 s45, s33, 917504
 buffer_load_dwordx4 v11, s[16:19], s45 offen  lds
 ds_read_b64_tr_b16 a[0:1], v8 offset:0
 ds_read_b64_tr_b16 a[2:3], v8 offset:1024
 ds_read_b64_tr_b16 a[72:73], v9 offset:0
 ds_read_b64_tr_b16 a[74:75], v9 offset:1024
 ds_read_b64_tr_b16 a[144:145], v8 offset:8192
 ds_read_b64_tr_b16 a[146:147], v8 offset:9216
 ds_read_b64_tr_b16 a[216:217], v9 offset:8192
 ds_read_b64_tr_b16 a[218:219], v9 offset:9216
 s_waitcnt vmcnt(8) lgkmcnt(0)
 s_barrier
 s_add_u32 m0, s49, 73728
 s_add_u32 s45, s32, 1048576
 buffer_load_dwordx4 v11, s[12:15], s45 offen  lds
 s_add_u32 m0, s49, 77824
 s_add_u32 s45, s32, 1179648
 buffer_load_dwordx4 v11, s[12:15], s45 offen  lds
 s_add_u32 m0, s49, 81920
 s_add_u32 s45, s33, 1048576
 buffer_load_dwordx4 v11, s[16:19], s45 offen  lds
 s_add_u32 m0, s49, 86016
 s_add_u32 s45, s33, 1179648
 buffer_load_dwordx4 v11, s[16:19], s45 offen  lds
 ds_read_b64_tr_b16 a[4:5], v8 offset:16384
 ds_read_b64_tr_b16 a[6:7], v8 offset:17408
 ds_read_b64_tr_b16 a[76:77], v9 offset:16384
 ds_read_b64_tr_b16 a[78:79], v9 offset:17408
 ds_read_b64_tr_b16 a[148:149], v8 offset:24576
 ds_read_b64_tr_b16 a[150:151], v8 offset:25600
 ds_read_b64_tr_b16 a[220:221], v9 offset:24576
 ds_read_b64_tr_b16 a[222:223], v9 offset:25600
 s_waitcnt vmcnt(8) lgkmcnt(0)
 s_barrier
 s_add_u32 m0, s49, 90112
 s_add_u32 s45, s32, 1310720
 buffer_load_dwordx4 v11, s[12:15], s45 offen  lds
 s_add_u32 m0, s49, 94208
 s_add_u32 s45, s32, 1441792
 buffer_load_dwordx4 v11, s[12:15], s45 offen  lds
 s_add_u32 m0, s49, 98304
 s_add_u32 s45, s33, 1310720
 buffer_load_dwordx4 v11, s[16:19], s45 offen  lds
 s_add_u32 m0, s49, 102400
 s_add_u32 s45, s33, 1441792
 buffer_load_dwordx4 v11, s[16:19], s45 offen  lds
 ds_read_b64_tr_b16 a[8:9], v8 offset:32768
 ds_read_b64_tr_b16 a[10:11], v8 offset:33792
 ds_read_b64_tr_b16 a[80:81], v9 offset:32768
 ds_read_b64_tr_b16 a[82:83], v9 offset:33792
 ds_read_b64_tr_b16 a[152:153], v8 offset:40960
 ds_read_b64_tr_b16 a[154:155], v8 offset:41984
 ds_read_b64_tr_b16 a[224:225], v9 offset:40960
 ds_read_b64_tr_b16 a[226:227], v9 offset:41984
 s_waitcnt vmcnt(8) lgkmcnt(0)
 s_barrier
 s_add_u32 m0, s49, 106496
 s_add_u32 s45, s32, 1572864
 buffer_load_dwordx4 v11, s[12:15], s45 offen  lds
 s_add_u32 m0, s49, 110592
 s_add_u32 s45, s32, 1703936
 buffer_load_dwordx4 v11, s[12:15], s45 offen  lds
 s_add_u32 m0, s49, 114688
 s_add_u32 s45, s33, 1572864
 buffer_load_dwordx4 v11, s[16:19], s45 offen  lds
 s_add_u32 m0, s49, 118784
 s_add_u32 s45, s33, 1703936
 buffer_load_dwordx4 v11, s[16:19], s45 offen  lds
 ds_read_b64_tr_b16 a[12:13], v8 offset:49152
 ds_read_b64_tr_b16 a[14:15], v8 offset:50176
 ds_read_b64_tr_b16 a[84:85], v9 offset:49152
 ds_read_b64_tr_b16 a[86:87], v9 offset:50176
 ds_read_b64_tr_b16 a[156:157], v8 offset:57344
 ds_read_b64_tr_b16 a[158:159], v8 offset:58368
 ds_read_b64_tr_b16 a[228:229], v9 offset:57344
 ds_read_b64_tr_b16 a[230:231], v9 offset:58368
 s_waitcnt vmcnt(8) lgkmcnt(0)
 s_barrier
 s_add_u32 m0, s49, 122880
 s_add_u32 s45, s32, 1835008
 buffer_load_dwordx4 v11, s[12:15], s45 offen  lds
 s_add_u32 m0, s49, 126976
 s_add_u32 s45, s32, 1966080
 buffer_load_dwordx4 v11, s[12:15], s45 offen  lds
 s_add_u32 m0, s49, 131072
 s_add_u32 s45, s33, 1835008
 buffer_load_dwordx4 v11, s[16:19], s45 offen  lds
 s_add_u32 m0, s49, 135168
 s_add_u32 s45, s33, 1966080
 buffer_load_dwordx4 v11, s[16:19], s45 offen  lds
 ds_read_b64_tr_b16 a[16:17], v8 offset:0
 ds_read_b64_tr_b16 a[18:19], v8 offset:1024
 ds_read_b64_tr_b16 a[88:89], v9 offset:0
 ds_read_b64_tr_b16 a[90:91], v9 offset:1024
 ds_read_b64_tr_b16 a[160:161], v8 offset:8192
 ds_read_b64_tr_b16 a[162:163], v8 offset:9216
 ds_read_b64_tr_b16 a[232:233], v9 offset:8192
 ds_read_b64_tr_b16 a[234:235], v9 offset:9216
 s_waitcnt vmcnt(8) lgkmcnt(0)
 s_barrier
 s_add_u32 m0, s49, 73728
 s_add_u32 s45, s32, 2097152
 buffer_load_dwordx4 v11, s[12:15], s45 offen  lds
 s_add_u32 m0, s49, 77824
 s_add_u32 s45, s32, 2228224
 buffer_load_dwordx4 v11, s[12:15], s45 offen  lds
 s_add_u32 m0, s49, 81920
 s_add_u32 s45, s33, 2097152
 buffer_load_dwordx4 v11, s[16:19], s45 offen  lds
 s_add_u32 m0, s49, 86016
 s_add_u32 s45, s33, 2228224
 buffer_load_dwordx4 v11, s[16:19], s45 offen  lds
 ds_read_b64_tr_b16 a[20:21], v8 offset:16384
 ds_read_b64_tr_b16 a[22:23], v8 offset:17408
 ds_read_b64_tr_b16 a[92:93], v9 offset:16384
 ds_read_b64_tr_b16 a[94:95], v9 offset:17408
 ds_read_b64_tr_b16 a[164:165], v8 offset:24576
 ds_read_b64_tr_b16 a[166:167], v8 offset:25600
 ds_read_b64_tr_b16 a[236:237], v9 offset:24576
 ds_read_b64_tr_b16 a[238:239], v9 offset:25600
 s_waitcnt vmcnt(8) lgkmcnt(0)
 s_barrier
 s_add_u32 m0, s49, 90112
 s_add_u32 s45, s32, 2359296
 buffer_load_dwordx4 v11, s[12:15], s45 offen  lds
 s_add_u32 m0, s49, 94208
 s_add_u32 s45, s32, 2490368
 buffer_load_dwordx4 v11, s[12:15], s45 offen  lds
 s_add_u32 m0, s49, 98304
 s_add_u32 s45, s33, 2359296
 buffer_load_dwordx4 v11, s[16:19], s45 offen  lds
 s_add_u32 m0, s49, 102400
 s_add_u32 s45, s33, 2490368
 buffer_load_dwordx4 v11, s[16:19], s45 offen  lds
 ds_read_b64_tr_b16 a[24:25], v8 offset:32768
 ds_read_b64_tr_b16 a[26:27], v8 offset:33792
 ds_read_b64_tr_b16 a[96:97], v9 offset:32768
 ds_read_b64_tr_b16 a[98:99], v9 offset:33792
 ds_read_b64_tr_b16 a[168:169], v8 offset:40960
 ds_read_b64_tr_b16 a[170:171], v8 offset:41984
 ds_read_b64_tr_b16 a[240:241], v9 offset:40960
 ds_read_b64_tr_b16 a[242:243], v9 offset:41984
 s_waitcnt vmcnt(8) lgkmcnt(0)
 s_barrier
 s_add_u32 m0, s49, 106496
 s_add_u32 s45, s32, 2621440
 buffer_load_dwordx4 v11, s[12:15], s45 offen  lds
 s_add_u32 m0, s49, 110592
 s_add_u32 s45, s32, 2752512
 buffer_load_dwordx4 v11, s[12:15], s45 offen  lds
 s_add_u32 m0, s49, 114688
 s_add_u32 s45, s33, 2621440
 buffer_load_dwordx4 v11, s[16:19], s45 offen  lds
 s_add_u32 m0, s49, 118784
 s_add_u32 s45, s33, 2752512
 buffer_load_dwordx4 v11, s[16:19], s45 offen  lds
 ds_read_b64_tr_b16 a[28:29], v8 offset:49152
 ds_read_b64_tr_b16 a[30:31], v8 offset:50176
 ds_read_b64_tr_b16 a[100:101], v9 offset:49152
 ds_read_b64_tr_b16 a[102:103], v9 offset:50176
 ds_read_b64_tr_b16 a[172:173], v8 offset:57344
 ds_read_b64_tr_b16 a[174:175], v8 offset:58368
 ds_read_b64_tr_b16 a[244:245], v9 offset:57344
 ds_read_b64_tr_b16 a[246:247], v9 offset:58368
 s_waitcnt vmcnt(8) lgkmcnt(0)
 s_barrier
 s_add_u32 m0, s49, 122880
 s_add_u32 s45, s32, 2883584
 buffer_load_dwordx4 v11, s[12:15], s45 offen  lds
 s_add_u32 m0, s49, 126976
 s_add_u32 s45, s32, 3014656
 buffer_load_dwordx4 v11, s[12:15], s45 offen  lds
 s_add_u32 m0, s49, 131072
 s_add_u32 s45, s33, 2883584
 buffer_load_dwordx4 v11, s[16:19], s45 offen  lds
 s_add_u32 m0, s49, 135168
 s_add_u32 s45, s33, 3014656
 buffer_load_dwordx4 v11, s[16:19], s45 offen  lds
 ds_read_b64_tr_b16 a[32:33], v8 offset:0
 ds_read_b64_tr_b16 a[34:35], v8 offset:1024
 ds_read_b64_tr_b16 a[104:105], v9 offset:0
 ds_read_b64_tr_b16 a[106:107], v9 offset:1024
 ds_read_b64_tr_b16 a[176:177], v8 offset:8192
 ds_read_b64_tr_b16 a[178:179], v8 offset:9216
 ds_read_b64_tr_b16 a[248:249], v9 offset:8192
 ds_read_b64_tr_b16 a[250:251], v9 offset:9216
 s_waitcnt vmcnt(8) lgkmcnt(0)
 s_barrier
 s_add_u32 m0, s49, 73728
 s_add_u32 s45, s32, 3145728
 buffer_load_dwordx4 v11, s[12:15], s45 offen  lds
 s_add_u32 m0, s49, 77824
 s_add_u32 s45, s32, 3276800
 buffer_load_dwordx4 v11, s[12:15], s45 offen  lds
 s_add_u32 m0, s49, 81920
 s_add_u32 s45, s33, 3145728
 buffer_load_dwordx4 v11, s[16:19], s45 offen  lds
 s_add_u32 m0, s49, 86016
 s_add_u32 s45, s33, 3276800
 buffer_load_dwordx4 v11, s[16:19], s45 offen  lds
 ds_read_b64_tr_b16 a[36:37], v8 offset:16384
 ds_read_b64_tr_b16 a[38:39], v8 offset:17408
 ds_read_b64_tr_b16 a[108:109], v9 offset:16384
 ds_read_b64_tr_b16 a[110:111], v9 offset:17408
 ds_read_b64_tr_b16 a[180:181], v8 offset:24576
 ds_read_b64_tr_b16 a[182:183], v8 offset:25600
 ds_read_b64_tr_b16 a[252:253], v9 offset:24576
 ds_read_b64_tr_b16 a[254:255], v9 offset:25600
 s_waitcnt vmcnt(8) lgkmcnt(0)
 s_barrier
 s_add_u32 m0, s49, 90112
 s_add_u32 s45, s32, 3407872
 buffer_load_dwordx4 v11, s[12:15], s45 offen  lds
 s_add_u32 m0, s49, 94208
 s_add_u32 s45, s32, 3538944
 buffer_load_dwordx4 v11, s[12:15], s45 offen  lds
 s_add_u32 m0, s49, 98304
 s_add_u32 s45, s33, 3407872
 buffer_load_dwordx4 v11, s[16:19], s45 offen  lds
 s_add_u32 m0, s49, 102400
 s_add_u32 s45, s33, 3538944
 buffer_load_dwordx4 v11, s[16:19], s45 offen  lds
 ds_read_b64_tr_b16 a[40:41], v8 offset:32768
 ds_read_b64_tr_b16 a[42:43], v8 offset:33792
 ds_read_b64_tr_b16 a[112:113], v9 offset:32768
 ds_read_b64_tr_b16 a[114:115], v9 offset:33792
 ds_read_b64_tr_b16 a[184:185], v8 offset:40960
 ds_read_b64_tr_b16 a[186:187], v8 offset:41984
 ds_read_b64_tr_b16 v[224:225], v9 offset:40960
 ds_read_b64_tr_b16 v[226:227], v9 offset:41984
 s_waitcnt vmcnt(8) lgkmcnt(0)
 s_barrier
 s_add_u32 m0, s49, 106496
 s_add_u32 s45, s32, 3670016
 buffer_load_dwordx4 v11, s[12:15], s45 offen  lds
 s_add_u32 m0, s49, 110592
 s_add_u32 s45, s32, 3801088
 buffer_load_dwordx4 v11, s[12:15], s45 offen  lds
 s_add_u32 m0, s49, 114688
 s_add_u32 s45, s33, 3670016
 buffer_load_dwordx4 v11, s[16:19], s45 offen  lds
 s_add_u32 m0, s49, 118784
 s_add_u32 s45, s33, 3801088
 buffer_load_dwordx4 v11, s[16:19], s45 offen  lds
 ds_read_b64_tr_b16 a[44:45], v8 offset:49152
 ds_read_b64_tr_b16 a[46:47], v8 offset:50176
 ds_read_b64_tr_b16 a[116:117], v9 offset:49152
 ds_read_b64_tr_b16 a[118:119], v9 offset:50176
 ds_read_b64_tr_b16 a[188:189], v8 offset:57344
 ds_read_b64_tr_b16 a[190:191], v8 offset:58368
 ds_read_b64_tr_b16 v[228:229], v9 offset:57344
 ds_read_b64_tr_b16 v[230:231], v9 offset:58368
 s_waitcnt vmcnt(8) lgkmcnt(0)
 s_barrier
 s_add_u32 m0, s49, 122880
 s_add_u32 s45, s32, 3932160
 buffer_load_dwordx4 v11, s[12:15], s45 offen  lds
 s_add_u32 m0, s49, 126976
 s_add_u32 s45, s32, 4063232
 buffer_load_dwordx4 v11, s[12:15], s45 offen  lds
 s_add_u32 m0, s49, 131072
 s_add_u32 s45, s33, 3932160
 buffer_load_dwordx4 v11, s[16:19], s45 offen  lds
 s_add_u32 m0, s49, 135168
 s_add_u32 s45, s33, 4063232
 buffer_load_dwordx4 v11, s[16:19], s45 offen  lds
 ds_read_b64_tr_b16 a[48:49], v8 offset:0
 ds_read_b64_tr_b16 a[50:51], v8 offset:1024
 ds_read_b64_tr_b16 a[120:121], v9 offset:0
 ds_read_b64_tr_b16 a[122:123], v9 offset:1024
 ds_read_b64_tr_b16 a[192:193], v8 offset:8192
 ds_read_b64_tr_b16 a[194:195], v8 offset:9216
 ds_read_b64_tr_b16 v[232:233], v9 offset:8192
 ds_read_b64_tr_b16 v[234:235], v9 offset:9216
 s_waitcnt vmcnt(8) lgkmcnt(0)
 s_barrier
 s_add_u32 m0, s49, 73728
 s_add_u32 s45, s32, 4194304
 buffer_load_dwordx4 v11, s[12:15], s45 offen  lds
 s_add_u32 m0, s49, 77824
 s_add_u32 s45, s32, 4325376
 buffer_load_dwordx4 v11, s[12:15], s45 offen  lds
 s_add_u32 m0, s49, 81920
 s_add_u32 s45, s33, 4194304
 buffer_load_dwordx4 v11, s[16:19], s45 offen  lds
 s_add_u32 m0, s49, 86016
 s_add_u32 s45, s33, 4325376
 buffer_load_dwordx4 v11, s[16:19], s45 offen  lds
 ds_read_b64_tr_b16 a[52:53], v8 offset:16384
 ds_read_b64_tr_b16 a[54:55], v8 offset:17408
 ds_read_b64_tr_b16 a[124:125], v9 offset:16384
 ds_read_b64_tr_b16 a[126:127], v9 offset:17408
 ds_read_b64_tr_b16 a[196:197], v8 offset:24576
 ds_read_b64_tr_b16 a[198:199], v8 offset:25600
 ds_read_b64_tr_b16 v[236:237], v9 offset:24576
 ds_read_b64_tr_b16 v[238:239], v9 offset:25600
 s_waitcnt vmcnt(8) lgkmcnt(0)
 s_barrier
 s_add_u32 m0, s49, 90112
 s_add_u32 s45, s32, 4456448
 buffer_load_dwordx4 v11, s[12:15], s45 offen  lds
 s_add_u32 m0, s49, 94208
 s_add_u32 s45, s32, 4587520
 buffer_load_dwordx4 v11, s[12:15], s45 offen  lds
 s_add_u32 m0, s49, 98304
 s_add_u32 s45, s33, 4456448
 buffer_load_dwordx4 v11, s[16:19], s45 offen  lds
 s_add_u32 m0, s49, 102400
 s_add_u32 s45, s33, 4587520
 buffer_load_dwordx4 v11, s[16:19], s45 offen  lds
 ds_read_b64_tr_b16 a[56:57], v8 offset:32768
 ds_read_b64_tr_b16 a[58:59], v8 offset:33792
 ds_read_b64_tr_b16 a[128:129], v9 offset:32768
 ds_read_b64_tr_b16 a[130:131], v9 offset:33792
 ds_read_b64_tr_b16 a[200:201], v8 offset:40960
 ds_read_b64_tr_b16 a[202:203], v8 offset:41984
 ds_read_b64_tr_b16 v[240:241], v9 offset:40960
 ds_read_b64_tr_b16 v[242:243], v9 offset:41984
 s_waitcnt vmcnt(8) lgkmcnt(0)
 s_barrier
 ds_read_b64_tr_b16 a[60:61], v8 offset:49152
 ds_read_b64_tr_b16 a[62:63], v8 offset:50176
 ds_read_b64_tr_b16 a[132:133], v9 offset:49152
 ds_read_b64_tr_b16 a[134:135], v9 offset:50176
 ds_read_b64_tr_b16 a[204:205], v8 offset:57344
 ds_read_b64_tr_b16 a[206:207], v8 offset:58368
 ds_read_b64_tr_b16 v[244:245], v9 offset:57344
 ds_read_b64_tr_b16 v[246:247], v9 offset:58368
 s_waitcnt vmcnt(4) lgkmcnt(0)
 s_barrier
 ds_read_b64_tr_b16 a[64:65], v8 offset:0
 ds_read_b64_tr_b16 a[66:67], v8 offset:1024
 ds_read_b64_tr_b16 a[136:137], v9 offset:0
 ds_read_b64_tr_b16 a[138:139], v9 offset:1024
 ds_read_b64_tr_b16 a[208:209], v8 offset:8192
 ds_read_b64_tr_b16 a[210:211], v8 offset:9216
 ds_read_b64_tr_b16 v[248:249], v9 offset:8192
 ds_read_b64_tr_b16 v[250:251], v9 offset:9216
 s_waitcnt vmcnt(0) lgkmcnt(0)
 s_barrier
 ds_read_b64_tr_b16 a[68:69], v8 offset:16384
 ds_read_b64_tr_b16 a[70:71], v8 offset:17408
 ds_read_b64_tr_b16 a[140:141], v9 offset:16384
 ds_read_b64_tr_b16 a[142:143], v9 offset:17408
 ds_read_b64_tr_b16 a[212:213], v8 offset:24576
 ds_read_b64_tr_b16 a[214:215], v8 offset:25600
 ds_read_b64_tr_b16 v[252:253], v9 offset:24576
 ds_read_b64_tr_b16 v[254:255], v9 offset:25600
 s_mov_b32 s50, 0x3e0293ee
 s_mov_b32 s42, 0
 s_mov_b32 s43, 0
 s_mov_b32 s44, 73728
 v_mov_b32 v6, v4
 v_mov_b32 v7, v5
 v_and_b32 v17, 63, v0
 v_lshlrev_b32 v1, 4, v17
 s_lshl_b32 s45, s4, 11
 s_add_u32 s45, s45, 147456
 v_add_u32 v2, s45, v1
 s_lshr_b32 s53, s4, 1
 s_and_b32 s54, s4, 1
 s_add_u32 s52, s52, s53
 s_lshl_b32 s53, s53, 13
 s_lshl_b32 s54, s54, 10
 s_add_u32 s45, s53, s54
 s_add_u32 s45, s45, 147456
 v_add_u32 v3, s45, v1
 s_lshl_b32 s63, s52, 13
 s_add_u32 s63, s63, s54
 s_add_u32 s63, s63, 0x7000000
 s_lshl_b32 s61, s52, 14
 s_add_u32 s61, s61, 0x3000000
 s_lshl_b32 s62, s52, 12
 s_add_u32 s62, s62, 0x400000
 s_lshl_b32 s57, s52, 7
 s_add_u32 s57, s57, 0x1000
 s_lshl_b32 s45, s4, 2
 s_add_u32 s59, s59, s45
 s_mov_b32 s58, 0x200000
 v_mov_b32 v13, 0
 v_mov_b32 v14, 0
 v_min_u32 v15, 1, v17
 v_lshlrev_b32 v15, 28, v15
 v_mov_b32 v18, 0x44444444
 v_mov_b32 v19, 0xeeeeeeee
 v_and_b32 v20, 2, v17
 v_cmp_eq_u32 vcc, 0, v20
 s_nop 1
 v_cndmask_b32 v12, v19, v18, vcc
 v_mov_b32 v217, 0
 v_mov_b32 v218, 0
 v_mov_b32 v220, 0x3f803f80
 v_mov_b32 v221, 0x3f803f80
 v_mov_b32 v222, 0x3f803f80
 v_mov_b32 v223, 0x3f803f80
 v_and_b32 v18, 15, v17
 v_lshrrev_b32 v19, 4, v17
 v_lshlrev_b32 v19, 2, v19
 v_sub_u32 v18, v18, v19
 s_lshr_b32 s45, s54, 6
 v_add_u32 v18, s45, v18
 v_mov_b32 v19, 0xff800000
 v_cmp_le_i32 vcc, 0, v18
 s_nop 1
 v_cndmask_b32 v208, v19, v13, vcc
 v_cmp_le_i32 vcc, 1, v18
 s_nop 1
 v_cndmask_b32 v209, v19, v13, vcc
 v_cmp_le_i32 vcc, 2, v18
 s_nop 1
 v_cndmask_b32 v210, v19, v13, vcc
 v_cmp_le_i32 vcc, 3, v18
 s_nop 1
 v_cndmask_b32 v211, v19, v13, vcc
 v_cmp_le_i32 vcc, 16, v18
 s_nop 1
 v_cndmask_b32 v212, v19, v13, vcc
 v_cmp_le_i32 vcc, 17, v18
 s_nop 1
 v_cndmask_b32 v213, v19, v13, vcc
 v_cmp_le_i32 vcc, 18, v18
 s_nop 1
 v_cndmask_b32 v214, v19, v13, vcc
 v_cmp_le_i32 vcc, 19, v18
 s_nop 1
 v_cndmask_b32 v215, v19, v13, vcc
Lqs_22:
 buffer_load_dword v16, v15, s[20:23], s57 offen sc1
 s_waitcnt vmcnt(0)
 v_cmp_le_u32 vcc, 1, v16
 s_cbranch_vccnz Lqsk_23
 s_sub_u32 s58, s58, 1
 s_cbranch_scc0 Lqs_22
 s_endpgm
Lqsk_23:
 s_waitcnt vmcnt(0) lgkmcnt(0)
 s_barrier
 ds_read_b128 v[32:35], v6 offset:0
 ds_read_b128 v[36:39], v6 offset:2048
 ds_read_b128 v[40:43], v7 offset:0
 ds_read_b128 v[44:47], v7 offset:2048
 s_waitcnt lgkmcnt(2)
Lqb_loop_24:
 v_mfma_f32_16x16x32_bf16 v[64:67], a[0:3], v[32:35], 0
 ds_read_b128 v[48:51], v6 offset:4096
 v_mfma_f32_16x16x32_bf16 v[72:75], a[72:75], v[32:35], 0
 ds_read_b128 v[52:55], v6 offset:6144
 v_mfma_f32_16x16x32_bf16 v[80:83], a[144:147], v[32:35], 0
 s_add_u32 s41, s40, 2
 v_mfma_f32_16x16x32_bf16 v[88:91], a[216:219], v[32:35], 0
 s_add_u32 s45, s42, 2
 s_mul_i32 s46, s41, 36864
 v_mfma_f32_16x16x32_bf16 v[68:71], a[0:3], v[36:39], 0
 s_cmp_lt_u32 s45, s36
 s_cselect_b32 s46, s46, 0
 v_mfma_f32_16x16x32_bf16 v[76:79], a[72:75], v[36:39], 0
 s_lshl_b32 s49, s4, 10
 s_add_u32 s49, s49, s44
 v_mfma_f32_16x16x32_bf16 v[84:87], a[144:147], v[36:39], 0
 s_lshl_b32 s53, s39, 19
 s_add_u32 s53, s53, s61
 v_mfma_f32_16x16x32_bf16 v[92:95], a[216:219], v[36:39], 0
 s_waitcnt lgkmcnt(2)
 v_mfma_f32_16x16x32_bf16 v[64:67], a[4:7], v[40:43], v[64:67]
 ds_read_b128 v[56:59], v7 offset:4096
 v_mfma_f32_16x16x32_bf16 v[72:75], a[76:79], v[40:43], v[72:75]
 ds_read_b128 v[60:63], v7 offset:6144
 v_mfma_f32_16x16x32_bf16 v[80:83], a[148:151], v[40:43], v[80:83]
 s_add_u32 m0, s49, 0
 v_mfma_f32_16x16x32_bf16 v[88:91], a[220:223], v[40:43], v[88:91]
 buffer_load_dwordx4 v10, s[8:11], s46 offen offset:0  lds
 v_mfma_f32_16x16x32_bf16 v[68:71], a[4:7], v[44:47], v[68:71]
 s_add_u32 m0, s49, 3968
 v_mfma_f32_16x16x32_bf16 v[76:79], a[76:79], v[44:47], v[76:79]
 buffer_load_dwordx4 v10, s[8:11], s46 offen offset:128  lds
 v_mfma_f32_16x16x32_bf16 v[84:87], a[148:151], v[44:47], v[84:87]
 s_lshl_b32 s55, s39, 17
 s_add_u32 s55, s55, s62
 v_mfma_f32_16x16x32_bf16 v[92:95], a[220:223], v[44:47], v[92:95]
 s_waitcnt lgkmcnt(2)
 v_mfma_f32_16x16x32_bf16 v[64:67], a[8:11], v[48:51], v[64:67]
 ds_read_b128 v[32:35], v6 offset:8192
 v_mfma_f32_16x16x32_bf16 v[72:75], a[80:83], v[48:51], v[72:75]
 ds_read_b128 v[36:39], v6 offset:10240
 v_mfma_f32_16x16x32_bf16 v[80:83], a[152:155], v[48:51], v[80:83]
 s_add_u32 m0, s49, 7936
 v_mfma_f32_16x16x32_bf16 v[88:91], a[224:227], v[48:51], v[88:91]
 buffer_load_dwordx4 v10, s[8:11], s46 offen offset:256  lds
 v_mfma_f32_16x16x32_bf16 v[68:71], a[8:11], v[52:55], v[68:71]
 s_add_u32 m0, s49, 11904
 v_mfma_f32_16x16x32_bf16 v[76:79], a[80:83], v[52:55], v[76:79]
 buffer_load_dwordx4 v10, s[8:11], s46 offen offset:384  lds
 v_mfma_f32_16x16x32_bf16 v[84:87], a[152:155], v[52:55], v[84:87]
 s_lshl_b32 s56, s39, 18
 s_add_u32 s56, s56, s63
 v_mfma_f32_16x16x32_bf16 v[92:95], a[224:227], v[52:55], v[92:95]
 s_waitcnt lgkmcnt(2)
 v_mfma_f32_16x16x32_bf16 v[64:67], a[12:15], v[56:59], v[64:67]
 ds_read_b128 v[40:43], v7 offset:8192
 v_mfma_f32_16x16x32_bf16 v[72:75], a[84:87], v[56:59], v[72:75]
 ds_read_b128 v[44:47], v7 offset:10240
 v_mfma_f32_16x16x32_bf16 v[80:83], a[156:159], v[56:59], v[80:83]
 s_add_u32 m0, s49, 15872
 v_mfma_f32_16x16x32_bf16 v[88:91], a[228:231], v[56:59], v[88:91]
 buffer_load_dwordx4 v10, s[8:11], s46 offen offset:512  lds
 v_mfma_f32_16x16x32_bf16 v[68:71], a[12:15], v[60:63], v[68:71]
 s_add_u32 m0, s49, 19840
 v_mfma_f32_16x16x32_bf16 v[76:79], a[84:87], v[60:63], v[76:79]
 buffer_load_dwordx4 v10, s[8:11], s46 offen offset:640  lds
 v_mfma_f32_16x16x32_bf16 v[84:87], a[156:159], v[60:63], v[84:87]
 s_add_u32 s60, s39, 1
 v_mfma_f32_16x16x32_bf16 v[92:95], a[228:231], v[60:63], v[92:95]
 s_waitcnt lgkmcnt(2)
 v_mfma_f32_16x16x32_bf16 v[64:67], a[16:19], v[32:35], v[64:67]
 ds_read_b128 v[48:51], v6 offset:12288
 v_mfma_f32_16x16x32_bf16 v[72:75], a[88:91], v[32:35], v[72:75]
 ds_read_b128 v[52:55], v6 offset:14336
 v_mfma_f32_16x16x32_bf16 v[80:83], a[160:163], v[32:35], v[80:83]
 s_add_u32 m0, s49, 23808
 v_mfma_f32_16x16x32_bf16 v[88:91], a[232:235], v[32:35], v[88:91]
 buffer_load_dwordx4 v10, s[8:11], s46 offen offset:768  lds
 v_mfma_f32_16x16x32_bf16 v[68:71], a[16:19], v[36:39], v[68:71]
 s_add_u32 m0, s49, 27776
 v_mfma_f32_16x16x32_bf16 v[76:79], a[88:91], v[36:39], v[76:79]
 buffer_load_dwordx4 v10, s[8:11], s46 offen offset:896  lds
 v_mfma_f32_16x16x32_bf16 v[84:87], a[160:163], v[36:39], v[84:87]
 v_mfma_f32_16x16x32_bf16 v[92:95], a[232:235], v[36:39], v[92:95]
 s_waitcnt lgkmcnt(2)
 v_mfma_f32_16x16x32_bf16 v[64:67], a[20:23], v[40:43], v[64:67]
 ds_read_b128 v[56:59], v7 offset:12288
 v_mfma_f32_16x16x32_bf16 v[72:75], a[92:95], v[40:43], v[72:75]
 ds_read_b128 v[60:63], v7 offset:14336
 v_mfma_f32_16x16x32_bf16 v[80:83], a[164:167], v[40:43], v[80:83]
 s_add_u32 m0, s49, 31744
 v_mfma_f32_16x16x32_bf16 v[88:91], a[236:239], v[40:43], v[88:91]
 buffer_load_dwordx4 v10, s[8:11], s46 offen offset:1024  lds
 v_mfma_f32_16x16x32_bf16 v[68:71], a[20:23], v[44:47], v[68:71]
 v_mfma_f32_16x16x32_bf16 v[76:79], a[92:95], v[44:47], v[76:79]
 v_mfma_f32_16x16x32_bf16 v[84:87], a[164:167], v[44:47], v[84:87]
 v_mfma_f32_16x16x32_bf16 v[92:95], a[236:239], v[44:47], v[92:95]
 s_waitcnt lgkmcnt(2)
 v_mfma_f32_16x16x32_bf16 v[64:67], a[24:27], v[48:51], v[64:67]
 ds_read_b128 v[32:35], v6 offset:16384
 v_mfma_f32_16x16x32_bf16 v[72:75], a[96:99], v[48:51], v[72:75]
 ds_read_b128 v[36:39], v6 offset:18432
 v_mfma_f32_16x16x32_bf16 v[80:83], a[168:171], v[48:51], v[80:83]
 s_waitcnt vmcnt(9)
 buffer_store_dword v14, v15, s[20:23], s59 offen sc1
 v_mfma_f32_16x16x32_bf16 v[88:91], a[240:243], v[48:51], v[88:91]
 v_mfma_f32_16x16x32_bf16 v[68:71], a[24:27], v[52:55], v[68:71]
 v_mfma_f32_16x16x32_bf16 v[76:79], a[96:99], v[52:55], v[76:79]
 v_mfma_f32_16x16x32_bf16 v[84:87], a[168:171], v[52:55], v[84:87]
 v_mfma_f32_16x16x32_bf16 v[92:95], a[240:243], v[52:55], v[92:95]
 s_waitcnt lgkmcnt(2)
 v_mfma_f32_16x16x32_bf16 v[64:67], a[28:31], v[56:59], v[64:67]
 ds_read_b128 v[40:43], v7 offset:16384
 v_mfma_f32_16x16x32_bf16 v[72:75], a[100:103], v[56:59], v[72:75]
 ds_read_b128 v[44:47], v7 offset:18432
 v_mfma_f32_16x16x32_bf16 v[80:83], a[172:175], v[56:59], v[80:83]
 buffer_load_dwordx4 v[128:131], v1, s[20:23], s53 offen offset:0 sc1
 v_mfma_f32_16x16x32_bf16 v[88:91], a[244:247], v[56:59], v[88:91]
 v_mfma_f32_16x16x32_bf16 v[68:71], a[28:31], v[60:63], v[68:71]
 buffer_load_dwordx4 v[132:135], v1, s[20:23], s53 offen offset:1024 sc1
 v_mfma_f32_16x16x32_bf16 v[76:79], a[100:103], v[60:63], v[76:79]
 v_mfma_f32_16x16x32_bf16 v[84:87], a[172:175], v[60:63], v[84:87]
 v_mfma_f32_16x16x32_bf16 v[92:95], a[244:247], v[60:63], v[92:95]
 s_waitcnt lgkmcnt(2)
 v_mfma_f32_16x16x32_bf16 v[64:67], a[32:35], v[32:35], v[64:67]
 ds_read_b128 v[48:51], v6 offset:20480
 v_mfma_f32_16x16x32_bf16 v[72:75], a[104:107], v[32:35], v[72:75]
 ds_read_b128 v[52:55], v6 offset:22528
 v_mfma_f32_16x16x32_bf16 v[80:83], a[176:179], v[32:35], v[80:83]
 buffer_load_dwordx4 v[136:139], v1, s[20:23], s53 offen offset:2048 sc1
 v_mfma_f32_16x16x32_bf16 v[88:91], a[248:251], v[32:35], v[88:91]
 v_mfma_f32_16x16x32_bf16 v[68:71], a[32:35], v[36:39], v[68:71]
 buffer_load_dwordx4 v[140:143], v1, s[20:23], s53 offen offset:3072 sc1
 v_mfma_f32_16x16x32_bf16 v[76:79], a[104:107], v[36:39], v[76:79]
 v_mfma_f32_16x16x32_bf16 v[84:87], a[176:179], v[36:39], v[84:87]
 s_add_u32 s53, s53, 4096
 v_mfma_f32_16x16x32_bf16 v[92:95], a[248:251], v[36:39], v[92:95]
 s_waitcnt lgkmcnt(2)
 v_mfma_f32_16x16x32_bf16 v[64:67], a[36:39], v[40:43], v[64:67]
 ds_read_b128 v[56:59], v7 offset:20480
 v_mfma_f32_16x16x32_bf16 v[72:75], a[108:111], v[40:43], v[72:75]
 ds_read_b128 v[60:63], v7 offset:22528
 v_mfma_f32_16x16x32_bf16 v[80:83], a[180:183], v[40:43], v[80:83]
 buffer_load_dwordx4 v[144:147], v1, s[20:23], s53 offen offset:0 sc1
 v_mfma_f32_16x16x32_bf16 v[88:91], a[252:255], v[40:43], v[88:91]
 v_mfma_f32_16x16x32_bf16 v[68:71], a[36:39], v[44:47], v[68:71]
 buffer_load_dwordx4 v[148:151], v1, s[20:23], s53 offen offset:1024 sc1
 v_mfma_f32_16x16x32_bf16 v[76:79], a[108:111], v[44:47], v[76:79]
 v_mfma_f32_16x16x32_bf16 v[84:87], a[180:183], v[44:47], v[84:87]
 v_mfma_f32_16x16x32_bf16 v[92:95], a[252:255], v[44:47], v[92:95]
 s_waitcnt lgkmcnt(2)
 v_mfma_f32_16x16x32_bf16 v[64:67], a[40:43], v[48:51], v[64:67]
 ds_read_b128 v[32:35], v6 offset:24576
 v_mfma_f32_16x16x32_bf16 v[72:75], a[112:115], v[48:51], v[72:75]
 ds_read_b128 v[36:39], v6 offset:26624
 v_mfma_f32_16x16x32_bf16 v[80:83], a[184:187], v[48:51], v[80:83]
 buffer_load_dwordx4 v[152:155], v1, s[20:23], s53 offen offset:2048 sc1
 v_mfma_f32_16x16x32_bf16 v[88:91], v[224:227], v[48:51], v[88:91]
 v_mfma_f32_16x16x32_bf16 v[68:71], a[40:43], v[52:55], v[68:71]
 buffer_load_dwordx4 v[156:159], v1, s[20:23], s53 offen offset:3072 sc1
 v_mfma_f32_16x16x32_bf16 v[76:79], a[112:115], v[52:55], v[76:79]
 v_mfma_f32_16x16x32_bf16 v[84:87], a[184:187], v[52:55], v[84:87]
 s_add_u32 s53, s53, 4096
 v_mfma_f32_16x16x32_bf16 v[92:95], v[224:227], v[52:55], v[92:95]
 s_waitcnt lgkmcnt(2)
 v_mfma_f32_16x16x32_bf16 v[64:67], a[44:47], v[56:59], v[64:67]
 ds_read_b128 v[40:43], v7 offset:24576
 v_mfma_f32_16x16x32_bf16 v[72:75], a[116:119], v[56:59], v[72:75]
 ds_read_b128 v[44:47], v7 offset:26624
 v_mfma_f32_16x16x32_bf16 v[80:83], a[188:191], v[56:59], v[80:83]
 buffer_load_dwordx4 v[160:163], v1, s[20:23], s53 offen offset:0 sc1
 v_mfma_f32_16x16x32_bf16 v[88:91], v[228:231], v[56:59], v[88:91]
 v_mfma_f32_16x16x32_bf16 v[68:71], a[44:47], v[60:63], v[68:71]
 buffer_load_dwordx4 v[164:167], v1, s[20:23], s53 offen offset:1024 sc1
 v_mfma_f32_16x16x32_bf16 v[76:79], a[116:119], v[60:63], v[76:79]
 v_mfma_f32_16x16x32_bf16 v[84:87], a[188:191], v[60:63], v[84:87]
 v_mfma_f32_16x16x32_bf16 v[92:95], v[228:231], v[60:63], v[92:95]
 s_waitcnt lgkmcnt(2)
 v_mfma_f32_16x16x32_bf16 v[64:67], a[48:51], v[32:35], v[64:67]
 ds_read_b128 v[48:51], v6 offset:28672
 v_mfma_f32_16x16x32_bf16 v[72:75], a[120:123], v[32:35], v[72:75]
 ds_read_b128 v[52:55], v6 offset:30720
 v_mfma_f32_16x16x32_bf16 v[80:83], a[192:195], v[32:35], v[80:83]
 buffer_load_dwordx4 v[168:171], v1, s[20:23], s53 offen offset:2048 sc1
 v_mfma_f32_16x16x32_bf16 v[88:91], v[232:235], v[32:35], v[88:91]
 v_mfma_f32_16x16x32_bf16 v[68:71], a[48:51], v[36:39], v[68:71]
 buffer_load_dwordx4 v[172:175], v1, s[20:23], s53 offen offset:3072 sc1
 v_mfma_f32_16x16x32_bf16 v[76:79], a[120:123], v[36:39], v[76:79]
 v_mfma_f32_16x16x32_bf16 v[84:87], a[192:195], v[36:39], v[84:87]
 s_add_u32 s53, s53, 4096
 v_mfma_f32_16x16x32_bf16 v[92:95], v[232:235], v[36:39], v[92:95]
 s_waitcnt lgkmcnt(2)
 v_mfma_f32_16x16x32_bf16 v[64:67], a[52:55], v[40:43], v[64:67]
 ds_read_b128 v[56:59], v7 offset:28672
 v_mfma_f32_16x16x32_bf16 v[72:75], a[124:127], v[40:43], v[72:75]
 ds_read_b128 v[60:63], v7 offset:30720
 v_mfma_f32_16x16x32_bf16 v[80:83], a[196:199], v[40:43], v[80:83]
 s_add_u32 s43, s43, 36864
 s_cmp_eq_u32 s43, 147456
 buffer_load_dwordx4 v[176:179], v1, s[20:23], s53 offen offset:0 sc1
 v_mfma_f32_16x16x32_bf16 v[88:91], v[236:239], v[40:43], v[88:91]
 s_cselect_b32 s43, 0, s43
 s_add_u32 s44, s44, 36864
 v_mfma_f32_16x16x32_bf16 v[68:71], a[52:55], v[44:47], v[68:71]
 s_cmp_eq_u32 s44, 147456
 s_cselect_b32 s44, 0, s44
 buffer_load_dwordx4 v[180:183], v1, s[20:23], s53 offen offset:1024 sc1
 v_mfma_f32_16x16x32_bf16 v[76:79], a[124:127], v[44:47], v[76:79]
 v_mfma_f32_16x16x32_bf16 v[84:87], a[196:199], v[44:47], v[84:87]
 v_mfma_f32_16x16x32_bf16 v[92:95], v[236:239], v[44:47], v[92:95]
 s_waitcnt lgkmcnt(2)
 v_mfma_f32_16x16x32_bf16 v[64:67], a[56:59], v[48:51], v[64:67]
 ds_read_b128 v[32:35], v6 offset:32768
 v_mfma_f32_16x16x32_bf16 v[72:75], a[128:131], v[48:51], v[72:75]
 ds_read_b128 v[36:39], v6 offset:34816
 v_mfma_f32_16x16x32_bf16 v[80:83], a[200:203], v[48:51], v[80:83]
 v_add_u32 v6, s43, v4
 buffer_load_dwordx4 v[184:187], v1, s[20:23], s53 offen offset:2048 sc1
 v_mfma_f32_16x16x32_bf16 v[88:91], v[240:243], v[48:51], v[88:91]
 v_mfma_f32_16x16x32_bf16 v[68:71], a[56:59], v[52:55], v[68:71]
 buffer_load_dwordx4 v[188:191], v1, s[20:23], s53 offen offset:3072 sc1
 v_mfma_f32_16x16x32_bf16 v[76:79], a[128:131], v[52:55], v[76:79]
 v_mfma_f32_16x16x32_bf16 v[84:87], a[200:203], v[52:55], v[84:87]
 v_mfma_f32_16x16x32_bf16 v[92:95], v[240:243], v[52:55], v[92:95]
 s_waitcnt lgkmcnt(2)
 v_mfma_f32_16x16x32_bf16 v[64:67], a[60:63], v[56:59], v[64:67]
 ds_read_b128 v[40:43], v7 offset:32768
 v_mfma_f32_16x16x32_bf16 v[72:75], a[132:135], v[56:59], v[72:75]
 ds_read_b128 v[44:47], v7 offset:34816
 v_mfma_f32_16x16x32_bf16 v[80:83], a[204:207], v[56:59], v[80:83]
 v_add_u32 v7, s43, v5
 v_mfma_f32_16x16x32_bf16 v[88:91], v[244:247], v[56:59], v[88:91]
 v_mfma_f32_16x16x32_bf16 v[68:71], a[60:63], v[60:63], v[68:71]
 v_mfma_f32_16x16x32_bf16 v[76:79], a[132:135], v[60:63], v[76:79]
 v_mfma_f32_16x16x32_bf16 v[84:87], a[204:207], v[60:63], v[84:87]
 v_mfma_f32_16x16x32_bf16 v[92:95], v[244:247], v[60:63], v[92:95]
 s_waitcnt lgkmcnt(2)
 v_mfma_f32_16x16x32_bf16 v[64:67], a[64:67], v[32:35], v[64:67]
 s_waitcnt vmcnt(26)
 s_barrier
 ds_read_b128 v[48:51], v6 offset:0
 v_mfma_f32_16x16x32_bf16 v[72:75], a[136:139], v[32:35], v[72:75]
 ds_read_b128 v[52:55], v6 offset:2048
 v_mfma_f32_16x16x32_bf16 v[80:83], a[208:211], v[32:35], v[80:83]
 v_mfma_f32_16x16x32_bf16 v[88:91], v[248:251], v[32:35], v[88:91]
 v_mfma_f32_16x16x32_bf16 v[68:71], a[64:67], v[36:39], v[68:71]
 v_mfma_f32_16x16x32_bf16 v[76:79], a[136:139], v[36:39], v[76:79]
 v_mfma_f32_16x16x32_bf16 v[84:87], a[208:211], v[36:39], v[84:87]
 v_mfma_f32_16x16x32_bf16 v[92:95], v[248:251], v[36:39], v[92:95]
 s_waitcnt lgkmcnt(2)
 v_mfma_f32_16x16x32_bf16 v[64:67], a[68:71], v[40:43], v[64:67]
 ds_read_b128 v[56:59], v7 offset:0
 v_mfma_f32_16x16x32_bf16 v[72:75], a[140:143], v[40:43], v[72:75]
 ds_read_b128 v[60:63], v7 offset:2048
 v_mfma_f32_16x16x32_bf16 v[80:83], a[212:215], v[40:43], v[80:83]
 v_mfma_f32_16x16x32_bf16 v[88:91], v[252:255], v[40:43], v[88:91]
 s_mov_b32 s39, s40
 s_mov_b32 s40, s41
 v_mfma_f32_16x16x32_bf16 v[68:71], a[68:71], v[44:47], v[68:71]
 s_add_u32 s42, s42, 1
 v_mov_b32 v14, s42
 v_mfma_f32_16x16x32_bf16 v[76:79], a[140:143], v[44:47], v[76:79]
 v_mfma_f32_16x16x32_bf16 v[84:87], a[212:215], v[44:47], v[84:87]
 v_mfma_f32_16x16x32_bf16 v[92:95], v[252:255], v[44:47], v[92:95]
 s_waitcnt lgkmcnt(2)
 s_nop 3
 v_mul_f32 v64, s50, v64
 v_mul_f32 v65, s50, v65
 v_mul_f32 v66, s50, v66
 v_mul_f32 v67, s50, v67
 v_mul_f32 v72, s50, v72
 v_mul_f32 v73, s50, v73
 v_mul_f32 v74, s50, v74
 v_mul_f32 v75, s50, v75
 v_cvt_pk_bf16_f32 v16, v64, v65
 v_cvt_pk_bf16_f32 v17, v72, v73
 v_cvt_pk_bf16_f32 v18, v66, v67
 v_cvt_pk_bf16_f32 v19, v74, v75
 ds_write_b128 v2, v[16:19] offset:0
 v_mul_f32 v68, s50, v68
 v_mul_f32 v69, s50, v69
 v_mul_f32 v70, s50, v70
 v_mul_f32 v71, s50, v71
 v_mul_f32 v76, s50, v76
 v_mul_f32 v77, s50, v77
 v_mul_f32 v78, s50, v78
 v_mul_f32 v79, s50, v79
 v_cvt_pk_bf16_f32 v20, v68, v69
 v_cvt_pk_bf16_f32 v21, v76, v77
 v_cvt_pk_bf16_f32 v22, v70, v71
 v_cvt_pk_bf16_f32 v23, v78, v79
 ds_write_b128 v2, v[20:23] offset:1024
 v_mul_f32 v80, s50, v80
 v_mul_f32 v81, s50, v81
 v_mul_f32 v82, s50, v82
 v_mul_f32 v83, s50, v83
 v_mul_f32 v88, s50, v88
 v_mul_f32 v89, s50, v89
 v_mul_f32 v90, s50, v90
 v_mul_f32 v91, s50, v91
 v_cvt_pk_bf16_f32 v24, v80, v81
 v_cvt_pk_bf16_f32 v25, v88, v89
 v_cvt_pk_bf16_f32 v26, v82, v83
 v_cvt_pk_bf16_f32 v27, v90, v91
 ds_write_b128 v2, v[24:27] offset:8192
 v_mul_f32 v84, s50, v84
 v_mul_f32 v85, s50, v85
 v_mul_f32 v86, s50, v86
 v_mul_f32 v87, s50, v87
 v_mul_f32 v92, s50, v92
 v_mul_f32 v93, s50, v93
 v_mul_f32 v94, s50, v94
 v_mul_f32 v95, s50, v95
 v_cvt_pk_bf16_f32 v28, v84, v85
 v_cvt_pk_bf16_f32 v29, v92, v93
 v_cvt_pk_bf16_f32 v30, v86, v87
 v_cvt_pk_bf16_f32 v31, v94, v95
 ds_write_b128 v2, v[28:31] offset:9216
 v_mov_b64 v[120:121], 0
 v_mov_b64 v[122:123], 0
 s_waitcnt lgkmcnt(0)
 s_barrier
 ds_read_b128 v[96:99], v3 offset:0
 ds_read_b128 v[100:103], v3 offset:2048
 ds_read_b128 v[104:107], v3 offset:4096
 ds_read_b128 v[108:111], v3 offset:6144
Lqs_25:
 buffer_load_dword v16, v15, s[20:23], s57 offen sc1
 s_waitcnt vmcnt(0)
 v_cmp_le_u32 vcc, s60, v16
 s_cbranch_vccnz Lqsk_26
 s_sub_u32 s58, s58, 1
 s_cbranch_scc0 Lqs_25
 s_endpgm
Lqsk_26:
 buffer_load_dwordx4 v[192:195], v1, s[20:23], s55 offen offset:0 sc1
 buffer_load_dwordx4 v[196:199], v1, s[20:23], s55 offen offset:1024 sc1
 buffer_load_dwordx4 v[200:203], v1, s[20:23], s55 offen offset:2048 sc1
 buffer_load_dwordx4 v[204:207], v1, s[20:23], s55 offen offset:3072 sc1
 s_waitcnt lgkmcnt(0)
 v_mfma_f32_16x16x32_bf16 v[112:115], v[128:131], v[96:99], v[208:211]
 v_mfma_f32_16x16x32_bf16 v[116:119], v[132:135], v[96:99], v[212:215]
 v_mfma_f32_16x16x32_bf16 v[112:115], v[136:139], v[100:103], v[112:115]
 v_mfma_f32_16x16x32_bf16 v[116:119], v[140:143], v[100:103], v[116:119]
 v_mfma_f32_16x16x32_bf16 v[112:115], v[144:147], v[104:107], v[112:115]
 v_mfma_f32_16x16x32_bf16 v[116:119], v[148:151], v[104:107], v[116:119]
 v_mfma_f32_16x16x32_bf16 v[112:115], v[152:155], v[108:111], v[112:115]
 v_mfma_f32_16x16x32_bf16 v[116:119], v[156:159], v[108:111], v[116:119]
 s_nop 7
 v_max3_f32 v24, v112, v113, v114
 v_max3_f32 v24, v24, v115, v116
 v_max3_f32 v24, v24, v117, v118
 v_max_f32 v24, v24, v119
 s_waitcnt vmcnt(2)
 v_mov_b64 v[16:17], v[192:193]
 v_mov_b64 v[18:19], v[196:197]
 s_nop 1
 v_smfmac_f32_16x16x64_bf16 v[120:123], v[16:19], v[96:103], v12
 s_waitcnt vmcnt(0)
 v_mov_b64 v[20:21], v[200:201]
 v_mov_b64 v[22:23], v[204:205]
 s_nop 1
 v_smfmac_f32_16x16x64_bf16 v[120:123], v[20:23], v[104:111], v12
 s_nop 7
 v_add_f32 v120, v120, v122
 v_add_f32 v121, v121, v123
 v_max3_f32 v24, v24, v120, v121
 v_mov_b32 v25, v24
 s_nop 1
 v_permlane16_swap_b32 v24, v25
 v_max_f32 v24, v24, v25
 v_mov_b32 v25, v24
 s_nop 1
 v_permlane32_swap_b32 v24, v25
 v_max_f32 v24, v24, v25
 v_sub_f32 v112, v112, v24
 v_sub_f32 v113, v113, v24
 v_sub_f32 v114, v114, v24
 v_sub_f32 v115, v115, v24
 v_sub_f32 v116, v116, v24
 v_sub_f32 v117, v117, v24
 v_sub_f32 v118, v118, v24
 v_sub_f32 v119, v119, v24
 v_sub_f32 v120, v120, v24
 v_sub_f32 v121, v121, v24
 v_exp_f32 v120, v120
 v_exp_f32 v121, v121
 v_exp_f32 v112, v112
 v_exp_f32 v113, v113
 v_exp_f32 v114, v114
 v_exp_f32 v115, v115
 v_exp_f32 v116, v116
 v_exp_f32 v117, v117
 v_exp_f32 v118, v118
 v_exp_f32 v119, v119
 v_cvt_pk_bf16_f32 v216, v120, v121
 v_cvt_pk_bf16_f32 v219, v120, v121
 v_cvt_pk_bf16_f32 v28, v112, v113
 v_cvt_pk_bf16_f32 v29, v116, v117
 v_cvt_pk_bf16_f32 v30, v114, v115
 v_cvt_pk_bf16_f32 v31, v118, v119
 v_mfma_f32_16x16x16_bf16 v[124:127], v[220:221], v[216:217], 0
 v_mfma_f32_16x16x16_bf16 v[64:67], v[194:195], v[216:217], 0
 v_mfma_f32_16x16x16_bf16 v[68:71], v[194:195], v[218:219], 0
 v_mfma_f32_16x16x16_bf16 v[72:75], v[198:199], v[216:217], 0
 v_mfma_f32_16x16x16_bf16 v[76:79], v[198:199], v[218:219], 0
 v_mfma_f32_16x16x16_bf16 v[80:83], v[202:203], v[216:217], 0
 v_mfma_f32_16x16x16_bf16 v[84:87], v[202:203], v[218:219], 0
 v_mfma_f32_16x16x16_bf16 v[88:91], v[206:207], v[216:217], 0
 v_mfma_f32_16x16x16_bf16 v[92:95], v[206:207], v[218:219], 0
 v_mfma_f32_16x16x32_bf16 v[124:127], v[220:223], v[28:31], v[124:127]
 v_mfma_f32_16x16x32_bf16 v[64:67], v[160:163], v[28:31], v[64:67]
 v_mfma_f32_16x16x32_bf16 v[68:71], v[164:167], v[28:31], v[68:71]
 v_mfma_f32_16x16x32_bf16 v[72:75], v[168:171], v[28:31], v[72:75]
 v_mfma_f32_16x16x32_bf16 v[76:79], v[172:175], v[28:31], v[76:79]
 v_mfma_f32_16x16x32_bf16 v[80:83], v[176:179], v[28:31], v[80:83]
 v_mfma_f32_16x16x32_bf16 v[84:87], v[180:183], v[28:31], v[84:87]
 v_mfma_f32_16x16x32_bf16 v[88:91], v[184:187], v[28:31], v[88:91]
 v_mfma_f32_16x16x32_bf16 v[92:95], v[188:191], v[28:31], v[92:95]
 v_rcp_f32 v124, v124
 s_add_u32 s45, s56, 4096
 v_mul_f32 v64, v64, v124
 v_mul_f32 v65, v65, v124
 v_mul_f32 v66, v66, v124
 v_mul_f32 v67, v67, v124
 v_mul_f32 v68, v68, v124
 v_mul_f32 v69, v69, v124
 v_mul_f32 v70, v70, v124
 v_mul_f32 v71, v71, v124
 v_cvt_pk_bf16_f32 v96, v64, v65
 v_cvt_pk_bf16_f32 v97, v68, v69
 v_cvt_pk_bf16_f32 v98, v66, v67
 v_cvt_pk_bf16_f32 v99, v70, v71
 buffer_store_dwordx4 v[96:99], v1, s[20:23], s56 offen offset:0 sc1
 v_mul_f32 v72, v72, v124
 v_mul_f32 v73, v73, v124
 v_mul_f32 v74, v74, v124
 v_mul_f32 v75, v75, v124
 v_mul_f32 v76, v76, v124
 v_mul_f32 v77, v77, v124
 v_mul_f32 v78, v78, v124
 v_mul_f32 v79, v79, v124
 v_cvt_pk_bf16_f32 v100, v72, v73
 v_cvt_pk_bf16_f32 v101, v76, v77
 v_cvt_pk_bf16_f32 v102, v74, v75
 v_cvt_pk_bf16_f32 v103, v78, v79
 buffer_store_dwordx4 v[100:103], v1, s[20:23], s56 offen offset:2048 sc1
 v_mul_f32 v80, v80, v124
 v_mul_f32 v81, v81, v124
 v_mul_f32 v82, v82, v124
 v_mul_f32 v83, v83, v124
 v_mul_f32 v84, v84, v124
 v_mul_f32 v85, v85, v124
 v_mul_f32 v86, v86, v124
 v_mul_f32 v87, v87, v124
 v_cvt_pk_bf16_f32 v104, v80, v81
 v_cvt_pk_bf16_f32 v105, v84, v85
 v_cvt_pk_bf16_f32 v106, v82, v83
 v_cvt_pk_bf16_f32 v107, v86, v87
 buffer_store_dwordx4 v[104:107], v1, s[20:23], s45 offen offset:0 sc1
 v_mul_f32 v88, v88, v124
 v_mul_f32 v89, v89, v124
 v_mul_f32 v90, v90, v124
 v_mul_f32 v91, v91, v124
 v_mul_f32 v92, v92, v124
 v_mul_f32 v93, v93, v124
 v_mul_f32 v94, v94, v124
 v_mul_f32 v95, v95, v124
 v_cvt_pk_bf16_f32 v108, v88, v89
 v_cvt_pk_bf16_f32 v109, v92, v93
 v_cvt_pk_bf16_f32 v110, v90, v91
 v_cvt_pk_bf16_f32 v111, v94, v95
 buffer_store_dwordx4 v[108:111], v1, s[20:23], s45 offen offset:2048 sc1
 v_mfma_f32_16x16x32_bf16 v[64:67], a[0:3], v[48:51], 0
 ds_read_b128 v[32:35], v6 offset:4096
 v_mfma_f32_16x16x32_bf16 v[72:75], a[72:75], v[48:51], 0
 ds_read_b128 v[36:39], v6 offset:6144
 v_mfma_f32_16x16x32_bf16 v[80:83], a[144:147], v[48:51], 0
 s_add_u32 s41, s40, 2
 v_mfma_f32_16x16x32_bf16 v[88:91], a[216:219], v[48:51], 0
 s_add_u32 s45, s42, 2
 s_mul_i32 s46, s41, 36864
 v_mfma_f32_16x16x32_bf16 v[68:71], a[0:3], v[52:55], 0
 s_cmp_lt_u32 s45, s36
 s_cselect_b32 s46, s46, 0
 v_mfma_f32_16x16x32_bf16 v[76:79], a[72:75], v[52:55], 0
 s_lshl_b32 s49, s4, 10
 s_add_u32 s49, s49, s44
 v_mfma_f32_16x16x32_bf16 v[84:87], a[144:147], v[52:55], 0
 s_lshl_b32 s53, s39, 19
 s_add_u32 s53, s53, s61
 v_mfma_f32_16x16x32_bf16 v[92:95], a[216:219], v[52:55], 0
 s_waitcnt lgkmcnt(2)
 v_mfma_f32_16x16x32_bf16 v[64:67], a[4:7], v[56:59], v[64:67]
 ds_read_b128 v[40:43], v7 offset:4096
 v_mfma_f32_16x16x32_bf16 v[72:75], a[76:79], v[56:59], v[72:75]
 ds_read_b128 v[44:47], v7 offset:6144
 v_mfma_f32_16x16x32_bf16 v[80:83], a[148:151], v[56:59], v[80:83]
 s_add_u32 m0, s49, 0
 v_mfma_f32_16x16x32_bf16 v[88:91], a[220:223], v[56:59], v[88:91]
 buffer_load_dwordx4 v10, s[8:11], s46 offen offset:0  lds
 v_mfma_f32_16x16x32_bf16 v[68:71], a[4:7], v[60:63], v[68:71]
 s_add_u32 m0, s49, 3968
 v_mfma_f32_16x16x32_bf16 v[76:79], a[76:79], v[60:63], v[76:79]
 buffer_load_dwordx4 v10, s[8:11], s46 offen offset:128  lds
 v_mfma_f32_16x16x32_bf16 v[84:87], a[148:151], v[60:63], v[84:87]
 s_lshl_b32 s55, s39, 17
 s_add_u32 s55, s55, s62
 v_mfma_f32_16x16x32_bf16 v[92:95], a[220:223], v[60:63], v[92:95]
 s_waitcnt lgkmcnt(2)
 v_mfma_f32_16x16x32_bf16 v[64:67], a[8:11], v[32:35], v[64:67]
 ds_read_b128 v[48:51], v6 offset:8192
 v_mfma_f32_16x16x32_bf16 v[72:75], a[80:83], v[32:35], v[72:75]
 ds_read_b128 v[52:55], v6 offset:10240
 v_mfma_f32_16x16x32_bf16 v[80:83], a[152:155], v[32:35], v[80:83]
 s_add_u32 m0, s49, 7936
 v_mfma_f32_16x16x32_bf16 v[88:91], a[224:227], v[32:35], v[88:91]
 buffer_load_dwordx4 v10, s[8:11], s46 offen offset:256  lds
 v_mfma_f32_16x16x32_bf16 v[68:71], a[8:11], v[36:39], v[68:71]
 s_add_u32 m0, s49, 11904
 v_mfma_f32_16x16x32_bf16 v[76:79], a[80:83], v[36:39], v[76:79]
 buffer_load_dwordx4 v10, s[8:11], s46 offen offset:384  lds
 v_mfma_f32_16x16x32_bf16 v[84:87], a[152:155], v[36:39], v[84:87]
 s_lshl_b32 s56, s39, 18
 s_add_u32 s56, s56, s63
 v_mfma_f32_16x16x32_bf16 v[92:95], a[224:227], v[36:39], v[92:95]
 s_waitcnt lgkmcnt(2)
 v_mfma_f32_16x16x32_bf16 v[64:67], a[12:15], v[40:43], v[64:67]
 ds_read_b128 v[56:59], v7 offset:8192
 v_mfma_f32_16x16x32_bf16 v[72:75], a[84:87], v[40:43], v[72:75]
 ds_read_b128 v[60:63], v7 offset:10240
 v_mfma_f32_16x16x32_bf16 v[80:83], a[156:159], v[40:43], v[80:83]
 s_add_u32 m0, s49, 15872
 v_mfma_f32_16x16x32_bf16 v[88:91], a[228:231], v[40:43], v[88:91]
 buffer_load_dwordx4 v10, s[8:11], s46 offen offset:512  lds
 v_mfma_f32_16x16x32_bf16 v[68:71], a[12:15], v[44:47], v[68:71]
 s_add_u32 m0, s49, 19840
 v_mfma_f32_16x16x32_bf16 v[76:79], a[84:87], v[44:47], v[76:79]
 buffer_load_dwordx4 v10, s[8:11], s46 offen offset:640  lds
 v_mfma_f32_16x16x32_bf16 v[84:87], a[156:159], v[44:47], v[84:87]
 s_add_u32 s60, s39, 1
 v_mfma_f32_16x16x32_bf16 v[92:95], a[228:231], v[44:47], v[92:95]
 s_waitcnt lgkmcnt(2)
 v_mfma_f32_16x16x32_bf16 v[64:67], a[16:19], v[48:51], v[64:67]
 ds_read_b128 v[32:35], v6 offset:12288
 v_mfma_f32_16x16x32_bf16 v[72:75], a[88:91], v[48:51], v[72:75]
 ds_read_b128 v[36:39], v6 offset:14336
 v_mfma_f32_16x16x32_bf16 v[80:83], a[160:163], v[48:51], v[80:83]
 s_add_u32 m0, s49, 23808
 v_mfma_f32_16x16x32_bf16 v[88:91], a[232:235], v[48:51], v[88:91]
 buffer_load_dwordx4 v10, s[8:11], s46 offen offset:768  lds
 v_mfma_f32_16x16x32_bf16 v[68:71], a[16:19], v[52:55], v[68:71]
 s_add_u32 m0, s49, 27776
 v_mfma_f32_16x16x32_bf16 v[76:79], a[88:91], v[52:55], v[76:79]
 buffer_load_dwordx4 v10, s[8:11], s46 offen offset:896  lds
 v_mfma_f32_16x16x32_bf16 v[84:87], a[160:163], v[52:55], v[84:87]
 v_mfma_f32_16x16x32_bf16 v[92:95], a[232:235], v[52:55], v[92:95]
 s_waitcnt lgkmcnt(2)
 v_mfma_f32_16x16x32_bf16 v[64:67], a[20:23], v[56:59], v[64:67]
 ds_read_b128 v[40:43], v7 offset:12288
 v_mfma_f32_16x16x32_bf16 v[72:75], a[92:95], v[56:59], v[72:75]
 ds_read_b128 v[44:47], v7 offset:14336
 v_mfma_f32_16x16x32_bf16 v[80:83], a[164:167], v[56:59], v[80:83]
 s_add_u32 m0, s49, 31744
 v_mfma_f32_16x16x32_bf16 v[88:91], a[236:239], v[56:59], v[88:91]
 buffer_load_dwordx4 v10, s[8:11], s46 offen offset:1024  lds
 v_mfma_f32_16x16x32_bf16 v[68:71], a[20:23], v[60:63], v[68:71]
 v_mfma_f32_16x16x32_bf16 v[76:79], a[92:95], v[60:63], v[76:79]
 v_mfma_f32_16x16x32_bf16 v[84:87], a[164:167], v[60:63], v[84:87]
 v_mfma_f32_16x16x32_bf16 v[92:95], a[236:239], v[60:63], v[92:95]
 s_waitcnt lgkmcnt(2)
 v_mfma_f32_16x16x32_bf16 v[64:67], a[24:27], v[32:35], v[64:67]
 ds_read_b128 v[48:51], v6 offset:16384
 v_mfma_f32_16x16x32_bf16 v[72:75], a[96:99], v[32:35], v[72:75]
 ds_read_b128 v[52:55], v6 offset:18432
 v_mfma_f32_16x16x32_bf16 v[80:83], a[168:171], v[32:35], v[80:83]
 s_waitcnt vmcnt(9)
 buffer_store_dword v14, v15, s[20:23], s59 offen sc1
 v_mfma_f32_16x16x32_bf16 v[88:91], a[240:243], v[32:35], v[88:91]
 v_mfma_f32_16x16x32_bf16 v[68:71], a[24:27], v[36:39], v[68:71]
 v_mfma_f32_16x16x32_bf16 v[76:79], a[96:99], v[36:39], v[76:79]
 v_mfma_f32_16x16x32_bf16 v[84:87], a[168:171], v[36:39], v[84:87]
 v_mfma_f32_16x16x32_bf16 v[92:95], a[240:243], v[36:39], v[92:95]
 s_waitcnt lgkmcnt(2)
 v_mfma_f32_16x16x32_bf16 v[64:67], a[28:31], v[40:43], v[64:67]
 ds_read_b128 v[56:59], v7 offset:16384
 v_mfma_f32_16x16x32_bf16 v[72:75], a[100:103], v[40:43], v[72:75]
 ds_read_b128 v[60:63], v7 offset:18432
 v_mfma_f32_16x16x32_bf16 v[80:83], a[172:175], v[40:43], v[80:83]
 buffer_load_dwordx4 v[128:131], v1, s[20:23], s53 offen offset:0 sc1
 v_mfma_f32_16x16x32_bf16 v[88:91], a[244:247], v[40:43], v[88:91]
 v_mfma_f32_16x16x32_bf16 v[68:71], a[28:31], v[44:47], v[68:71]
 buffer_load_dwordx4 v[132:135], v1, s[20:23], s53 offen offset:1024 sc1
 v_mfma_f32_16x16x32_bf16 v[76:79], a[100:103], v[44:47], v[76:79]
 v_mfma_f32_16x16x32_bf16 v[84:87], a[172:175], v[44:47], v[84:87]
 v_mfma_f32_16x16x32_bf16 v[92:95], a[244:247], v[44:47], v[92:95]
 s_waitcnt lgkmcnt(2)
 v_mfma_f32_16x16x32_bf16 v[64:67], a[32:35], v[48:51], v[64:67]
 ds_read_b128 v[32:35], v6 offset:20480
 v_mfma_f32_16x16x32_bf16 v[72:75], a[104:107], v[48:51], v[72:75]
 ds_read_b128 v[36:39], v6 offset:22528
 v_mfma_f32_16x16x32_bf16 v[80:83], a[176:179], v[48:51], v[80:83]
 buffer_load_dwordx4 v[136:139], v1, s[20:23], s53 offen offset:2048 sc1
 v_mfma_f32_16x16x32_bf16 v[88:91], a[248:251], v[48:51], v[88:91]
 v_mfma_f32_16x16x32_bf16 v[68:71], a[32:35], v[52:55], v[68:71]
 buffer_load_dwordx4 v[140:143], v1, s[20:23], s53 offen offset:3072 sc1
 v_mfma_f32_16x16x32_bf16 v[76:79], a[104:107], v[52:55], v[76:79]
 v_mfma_f32_16x16x32_bf16 v[84:87], a[176:179], v[52:55], v[84:87]
 s_add_u32 s53, s53, 4096
 v_mfma_f32_16x16x32_bf16 v[92:95], a[248:251], v[52:55], v[92:95]
 s_waitcnt lgkmcnt(2)
 v_mfma_f32_16x16x32_bf16 v[64:67], a[36:39], v[56:59], v[64:67]
 ds_read_b128 v[40:43], v7 offset:20480
 v_mfma_f32_16x16x32_bf16 v[72:75], a[108:111], v[56:59], v[72:75]
 ds_read_b128 v[44:47], v7 offset:22528
 v_mfma_f32_16x16x32_bf16 v[80:83], a[180:183], v[56:59], v[80:83]
 buffer_load_dwordx4 v[144:147], v1, s[20:23], s53 offen offset:0 sc1
 v_mfma_f32_16x16x32_bf16 v[88:91], a[252:255], v[56:59], v[88:91]
 v_mfma_f32_16x16x32_bf16 v[68:71], a[36:39], v[60:63], v[68:71]
 buffer_load_dwordx4 v[148:151], v1, s[20:23], s53 offen offset:1024 sc1
 v_mfma_f32_16x16x32_bf16 v[76:79], a[108:111], v[60:63], v[76:79]
 v_mfma_f32_16x16x32_bf16 v[84:87], a[180:183], v[60:63], v[84:87]
 v_mfma_f32_16x16x32_bf16 v[92:95], a[252:255], v[60:63], v[92:95]
 s_waitcnt lgkmcnt(2)
 v_mfma_f32_16x16x32_bf16 v[64:67], a[40:43], v[32:35], v[64:67]
 ds_read_b128 v[48:51], v6 offset:24576
 v_mfma_f32_16x16x32_bf16 v[72:75], a[112:115], v[32:35], v[72:75]
 ds_read_b128 v[52:55], v6 offset:26624
 v_mfma_f32_16x16x32_bf16 v[80:83], a[184:187], v[32:35], v[80:83]
 buffer_load_dwordx4 v[152:155], v1, s[20:23], s53 offen offset:2048 sc1
 v_mfma_f32_16x16x32_bf16 v[88:91], v[224:227], v[32:35], v[88:91]
 v_mfma_f32_16x16x32_bf16 v[68:71], a[40:43], v[36:39], v[68:71]
 buffer_load_dwordx4 v[156:159], v1, s[20:23], s53 offen offset:3072 sc1
 v_mfma_f32_16x16x32_bf16 v[76:79], a[112:115], v[36:39], v[76:79]
 v_mfma_f32_16x16x32_bf16 v[84:87], a[184:187], v[36:39], v[84:87]
 s_add_u32 s53, s53, 4096
 v_mfma_f32_16x16x32_bf16 v[92:95], v[224:227], v[36:39], v[92:95]
 s_waitcnt lgkmcnt(2)
 v_mfma_f32_16x16x32_bf16 v[64:67], a[44:47], v[40:43], v[64:67]
 ds_read_b128 v[56:59], v7 offset:24576
 v_mfma_f32_16x16x32_bf16 v[72:75], a[116:119], v[40:43], v[72:75]
 ds_read_b128 v[60:63], v7 offset:26624
 v_mfma_f32_16x16x32_bf16 v[80:83], a[188:191], v[40:43], v[80:83]
 buffer_load_dwordx4 v[160:163], v1, s[20:23], s53 offen offset:0 sc1
 v_mfma_f32_16x16x32_bf16 v[88:91], v[228:231], v[40:43], v[88:91]
 v_mfma_f32_16x16x32_bf16 v[68:71], a[44:47], v[44:47], v[68:71]
 buffer_load_dwordx4 v[164:167], v1, s[20:23], s53 offen offset:1024 sc1
 v_mfma_f32_16x16x32_bf16 v[76:79], a[116:119], v[44:47], v[76:79]
 v_mfma_f32_16x16x32_bf16 v[84:87], a[188:191], v[44:47], v[84:87]
 v_mfma_f32_16x16x32_bf16 v[92:95], v[228:231], v[44:47], v[92:95]
 s_waitcnt lgkmcnt(2)
 v_mfma_f32_16x16x32_bf16 v[64:67], a[48:51], v[48:51], v[64:67]
 ds_read_b128 v[32:35], v6 offset:28672
 v_mfma_f32_16x16x32_bf16 v[72:75], a[120:123], v[48:51], v[72:75]
 ds_read_b128 v[36:39], v6 offset:30720
 v_mfma_f32_16x16x32_bf16 v[80:83], a[192:195], v[48:51], v[80:83]
 buffer_load_dwordx4 v[168:171], v1, s[20:23], s53 offen offset:2048 sc1
 v_mfma_f32_16x16x32_bf16 v[88:91], v[232:235], v[48:51], v[88:91]
 v_mfma_f32_16x16x32_bf16 v[68:71], a[48:51], v[52:55], v[68:71]
 buffer_load_dwordx4 v[172:175], v1, s[20:23], s53 offen offset:3072 sc1
 v_mfma_f32_16x16x32_bf16 v[76:79], a[120:123], v[52:55], v[76:79]
 v_mfma_f32_16x16x32_bf16 v[84:87], a[192:195], v[52:55], v[84:87]
 s_add_u32 s53, s53, 4096
 v_mfma_f32_16x16x32_bf16 v[92:95], v[232:235], v[52:55], v[92:95]
 s_waitcnt lgkmcnt(2)
 v_mfma_f32_16x16x32_bf16 v[64:67], a[52:55], v[56:59], v[64:67]
 ds_read_b128 v[40:43], v7 offset:28672
 v_mfma_f32_16x16x32_bf16 v[72:75], a[124:127], v[56:59], v[72:75]
 ds_read_b128 v[44:47], v7 offset:30720
 v_mfma_f32_16x16x32_bf16 v[80:83], a[196:199], v[56:59], v[80:83]
 s_add_u32 s43, s43, 36864
 s_cmp_eq_u32 s43, 147456
 buffer_load_dwordx4 v[176:179], v1, s[20:23], s53 offen offset:0 sc1
 v_mfma_f32_16x16x32_bf16 v[88:91], v[236:239], v[56:59], v[88:91]
 s_cselect_b32 s43, 0, s43
 s_add_u32 s44, s44, 36864
 v_mfma_f32_16x16x32_bf16 v[68:71], a[52:55], v[60:63], v[68:71]
 s_cmp_eq_u32 s44, 147456
 s_cselect_b32 s44, 0, s44
 buffer_load_dwordx4 v[180:183], v1, s[20:23], s53 offen offset:1024 sc1
 v_mfma_f32_16x16x32_bf16 v[76:79], a[124:127], v[60:63], v[76:79]
 v_mfma_f32_16x16x32_bf16 v[84:87], a[196:199], v[60:63], v[84:87]
 v_mfma_f32_16x16x32_bf16 v[92:95], v[236:239], v[60:63], v[92:95]
 s_waitcnt lgkmcnt(2)
 v_mfma_f32_16x16x32_bf16 v[64:67], a[56:59], v[32:35], v[64:67]
 ds_read_b128 v[48:51], v6 offset:32768
 v_mfma_f32_16x16x32_bf16 v[72:75], a[128:131], v[32:35], v[72:75]
 ds_read_b128 v[52:55], v6 offset:34816
 v_mfma_f32_16x16x32_bf16 v[80:83], a[200:203], v[32:35], v[80:83]
 v_add_u32 v6, s43, v4
 buffer_load_dwordx4 v[184:187], v1, s[20:23], s53 offen offset:2048 sc1
 v_mfma_f32_16x16x32_bf16 v[88:91], v[240:243], v[32:35], v[88:91]
 v_mfma_f32_16x16x32_bf16 v[68:71], a[56:59], v[36:39], v[68:71]
 buffer_load_dwordx4 v[188:191], v1, s[20:23], s53 offen offset:3072 sc1
 v_mfma_f32_16x16x32_bf16 v[76:79], a[128:131], v[36:39], v[76:79]
 v_mfma_f32_16x16x32_bf16 v[84:87], a[200:203], v[36:39], v[84:87]
 v_mfma_f32_16x16x32_bf16 v[92:95], v[240:243], v[36:39], v[92:95]
 s_waitcnt lgkmcnt(2)
 v_mfma_f32_16x16x32_bf16 v[64:67], a[60:63], v[40:43], v[64:67]
 ds_read_b128 v[56:59], v7 offset:32768
 v_mfma_f32_16x16x32_bf16 v[72:75], a[132:135], v[40:43], v[72:75]
 ds_read_b128 v[60:63], v7 offset:34816
 v_mfma_f32_16x16x32_bf16 v[80:83], a[204:207], v[40:43], v[80:83]
 v_add_u32 v7, s43, v5
 v_mfma_f32_16x16x32_bf16 v[88:91], v[244:247], v[40:43], v[88:91]
 v_mfma_f32_16x16x32_bf16 v[68:71], a[60:63], v[44:47], v[68:71]
 v_mfma_f32_16x16x32_bf16 v[76:79], a[132:135], v[44:47], v[76:79]
 v_mfma_f32_16x16x32_bf16 v[84:87], a[204:207], v[44:47], v[84:87]
 v_mfma_f32_16x16x32_bf16 v[92:95], v[244:247], v[44:47], v[92:95]
 s_waitcnt lgkmcnt(2)
 v_mfma_f32_16x16x32_bf16 v[64:67], a[64:67], v[48:51], v[64:67]
 s_waitcnt vmcnt(26)
 s_barrier
 ds_read_b128 v[32:35], v6 offset:0
 v_mfma_f32_16x16x32_bf16 v[72:75], a[136:139], v[48:51], v[72:75]
 ds_read_b128 v[36:39], v6 offset:2048
 v_mfma_f32_16x16x32_bf16 v[80:83], a[208:211], v[48:51], v[80:83]
 v_mfma_f32_16x16x32_bf16 v[88:91], v[248:251], v[48:51], v[88:91]
 v_mfma_f32_16x16x32_bf16 v[68:71], a[64:67], v[52:55], v[68:71]
 v_mfma_f32_16x16x32_bf16 v[76:79], a[136:139], v[52:55], v[76:79]
 v_mfma_f32_16x16x32_bf16 v[84:87], a[208:211], v[52:55], v[84:87]
 v_mfma_f32_16x16x32_bf16 v[92:95], v[248:251], v[52:55], v[92:95]
 s_waitcnt lgkmcnt(2)
 v_mfma_f32_16x16x32_bf16 v[64:67], a[68:71], v[56:59], v[64:67]
 ds_read_b128 v[40:43], v7 offset:0
 v_mfma_f32_16x16x32_bf16 v[72:75], a[140:143], v[56:59], v[72:75]
 ds_read_b128 v[44:47], v7 offset:2048
 v_mfma_f32_16x16x32_bf16 v[80:83], a[212:215], v[56:59], v[80:83]
 v_mfma_f32_16x16x32_bf16 v[88:91], v[252:255], v[56:59], v[88:91]
 s_mov_b32 s39, s40
 s_mov_b32 s40, s41
 v_mfma_f32_16x16x32_bf16 v[68:71], a[68:71], v[60:63], v[68:71]
 s_add_u32 s42, s42, 1
 v_mov_b32 v14, s42
 v_mfma_f32_16x16x32_bf16 v[76:79], a[140:143], v[60:63], v[76:79]
 v_mfma_f32_16x16x32_bf16 v[84:87], a[212:215], v[60:63], v[84:87]
 v_mfma_f32_16x16x32_bf16 v[92:95], v[252:255], v[60:63], v[92:95]
 s_waitcnt lgkmcnt(2)
 s_nop 3
 v_mul_f32 v64, s50, v64
 v_mul_f32 v65, s50, v65
 v_mul_f32 v66, s50, v66
 v_mul_f32 v67, s50, v67
 v_mul_f32 v72, s50, v72
 v_mul_f32 v73, s50, v73
 v_mul_f32 v74, s50, v74
 v_mul_f32 v75, s50, v75
 v_cvt_pk_bf16_f32 v16, v64, v65
 v_cvt_pk_bf16_f32 v17, v72, v73
 v_cvt_pk_bf16_f32 v18, v66, v67
 v_cvt_pk_bf16_f32 v19, v74, v75
 ds_write_b128 v2, v[16:19] offset:0
 v_mul_f32 v68, s50, v68
 v_mul_f32 v69, s50, v69
 v_mul_f32 v70, s50, v70
 v_mul_f32 v71, s50, v71
 v_mul_f32 v76, s50, v76
 v_mul_f32 v77, s50, v77
 v_mul_f32 v78, s50, v78
 v_mul_f32 v79, s50, v79
 v_cvt_pk_bf16_f32 v20, v68, v69
 v_cvt_pk_bf16_f32 v21, v76, v77
 v_cvt_pk_bf16_f32 v22, v70, v71
 v_cvt_pk_bf16_f32 v23, v78, v79
 ds_write_b128 v2, v[20:23] offset:1024
 v_mul_f32 v80, s50, v80
 v_mul_f32 v81, s50, v81
 v_mul_f32 v82, s50, v82
 v_mul_f32 v83, s50, v83
 v_mul_f32 v88, s50, v88
 v_mul_f32 v89, s50, v89
 v_mul_f32 v90, s50, v90
 v_mul_f32 v91, s50, v91
 v_cvt_pk_bf16_f32 v24, v80, v81
 v_cvt_pk_bf16_f32 v25, v88, v89
 v_cvt_pk_bf16_f32 v26, v82, v83
 v_cvt_pk_bf16_f32 v27, v90, v91
 ds_write_b128 v2, v[24:27] offset:8192
 v_mul_f32 v84, s50, v84
 v_mul_f32 v85, s50, v85
 v_mul_f32 v86, s50, v86
 v_mul_f32 v87, s50, v87
 v_mul_f32 v92, s50, v92
 v_mul_f32 v93, s50, v93
 v_mul_f32 v94, s50, v94
 v_mul_f32 v95, s50, v95
 v_cvt_pk_bf16_f32 v28, v84, v85
 v_cvt_pk_bf16_f32 v29, v92, v93
 v_cvt_pk_bf16_f32 v30, v86, v87
 v_cvt_pk_bf16_f32 v31, v94, v95
 ds_write_b128 v2, v[28:31] offset:9216
 v_mov_b64 v[120:121], 0
 v_mov_b64 v[122:123], 0
 s_waitcnt lgkmcnt(0)
 s_barrier
 ds_read_b128 v[96:99], v3 offset:0
 ds_read_b128 v[100:103], v3 offset:2048
 ds_read_b128 v[104:107], v3 offset:4096
 ds_read_b128 v[108:111], v3 offset:6144
Lqs_27:
 buffer_load_dword v16, v15, s[20:23], s57 offen sc1
 s_waitcnt vmcnt(0)
 v_cmp_le_u32 vcc, s60, v16
 s_cbranch_vccnz Lqsk_28
 s_sub_u32 s58, s58, 1
 s_cbranch_scc0 Lqs_27
 s_endpgm
Lqsk_28:
 buffer_load_dwordx4 v[192:195], v1, s[20:23], s55 offen offset:0 sc1
 buffer_load_dwordx4 v[196:199], v1, s[20:23], s55 offen offset:1024 sc1
 buffer_load_dwordx4 v[200:203], v1, s[20:23], s55 offen offset:2048 sc1
 buffer_load_dwordx4 v[204:207], v1, s[20:23], s55 offen offset:3072 sc1
 s_waitcnt lgkmcnt(0)
 v_mfma_f32_16x16x32_bf16 v[112:115], v[128:131], v[96:99], v[208:211]
 v_mfma_f32_16x16x32_bf16 v[116:119], v[132:135], v[96:99], v[212:215]
 v_mfma_f32_16x16x32_bf16 v[112:115], v[136:139], v[100:103], v[112:115]
 v_mfma_f32_16x16x32_bf16 v[116:119], v[140:143], v[100:103], v[116:119]
 v_mfma_f32_16x16x32_bf16 v[112:115], v[144:147], v[104:107], v[112:115]
 v_mfma_f32_16x16x32_bf16 v[116:119], v[148:151], v[104:107], v[116:119]
 v_mfma_f32_16x16x32_bf16 v[112:115], v[152:155], v[108:111], v[112:115]
 v_mfma_f32_16x16x32_bf16 v[116:119], v[156:159], v[108:111], v[116:119]
 s_nop 7
 v_max3_f32 v24, v112, v113, v114
 v_max3_f32 v24, v24, v115, v116
 v_max3_f32 v24, v24, v117, v118
 v_max_f32 v24, v24, v119
 s_waitcnt vmcnt(2)
 v_mov_b64 v[16:17], v[192:193]
 v_mov_b64 v[18:19], v[196:197]
 s_nop 1
 v_smfmac_f32_16x16x64_bf16 v[120:123], v[16:19], v[96:103], v12
 s_waitcnt vmcnt(0)
 v_mov_b64 v[20:21], v[200:201]
 v_mov_b64 v[22:23], v[204:205]
 s_nop 1
 v_smfmac_f32_16x16x64_bf16 v[120:123], v[20:23], v[104:111], v12
 s_nop 7
 v_add_f32 v120, v120, v122
 v_add_f32 v121, v121, v123
 v_max3_f32 v24, v24, v120, v121
 v_mov_b32 v25, v24
 s_nop 1
 v_permlane16_swap_b32 v24, v25
 v_max_f32 v24, v24, v25
 v_mov_b32 v25, v24
 s_nop 1
 v_permlane32_swap_b32 v24, v25
 v_max_f32 v24, v24, v25
 v_sub_f32 v112, v112, v24
 v_sub_f32 v113, v113, v24
 v_sub_f32 v114, v114, v24
 v_sub_f32 v115, v115, v24
 v_sub_f32 v116, v116, v24
 v_sub_f32 v117, v117, v24
 v_sub_f32 v118, v118, v24
 v_sub_f32 v119, v119, v24
 v_sub_f32 v120, v120, v24
 v_sub_f32 v121, v121, v24
 v_exp_f32 v120, v120
 v_exp_f32 v121, v121
 v_exp_f32 v112, v112
 v_exp_f32 v113, v113
 v_exp_f32 v114, v114
 v_exp_f32 v115, v115
 v_exp_f32 v116, v116
 v_exp_f32 v117, v117
 v_exp_f32 v118, v118
 v_exp_f32 v119, v119
 v_cvt_pk_bf16_f32 v216, v120, v121
 v_cvt_pk_bf16_f32 v219, v120, v121
 v_cvt_pk_bf16_f32 v28, v112, v113
 v_cvt_pk_bf16_f32 v29, v116, v117
 v_cvt_pk_bf16_f32 v30, v114, v115
 v_cvt_pk_bf16_f32 v31, v118, v119
 v_mfma_f32_16x16x16_bf16 v[124:127], v[220:221], v[216:217], 0
 v_mfma_f32_16x16x16_bf16 v[64:67], v[194:195], v[216:217], 0
 v_mfma_f32_16x16x16_bf16 v[68:71], v[194:195], v[218:219], 0
 v_mfma_f32_16x16x16_bf16 v[72:75], v[198:199], v[216:217], 0
 v_mfma_f32_16x16x16_bf16 v[76:79], v[198:199], v[218:219], 0
 v_mfma_f32_16x16x16_bf16 v[80:83], v[202:203], v[216:217], 0
 v_mfma_f32_16x16x16_bf16 v[84:87], v[202:203], v[218:219], 0
 v_mfma_f32_16x16x16_bf16 v[88:91], v[206:207], v[216:217], 0
 v_mfma_f32_16x16x16_bf16 v[92:95], v[206:207], v[218:219], 0
 v_mfma_f32_16x16x32_bf16 v[124:127], v[220:223], v[28:31], v[124:127]
 v_mfma_f32_16x16x32_bf16 v[64:67], v[160:163], v[28:31], v[64:67]
 v_mfma_f32_16x16x32_bf16 v[68:71], v[164:167], v[28:31], v[68:71]
 v_mfma_f32_16x16x32_bf16 v[72:75], v[168:171], v[28:31], v[72:75]
 v_mfma_f32_16x16x32_bf16 v[76:79], v[172:175], v[28:31], v[76:79]
 v_mfma_f32_16x16x32_bf16 v[80:83], v[176:179], v[28:31], v[80:83]
 v_mfma_f32_16x16x32_bf16 v[84:87], v[180:183], v[28:31], v[84:87]
 v_mfma_f32_16x16x32_bf16 v[88:91], v[184:187], v[28:31], v[88:91]
 v_mfma_f32_16x16x32_bf16 v[92:95], v[188:191], v[28:31], v[92:95]
 v_rcp_f32 v124, v124
 s_add_u32 s45, s56, 4096
 v_mul_f32 v64, v64, v124
 v_mul_f32 v65, v65, v124
 v_mul_f32 v66, v66, v124
 v_mul_f32 v67, v67, v124
 v_mul_f32 v68, v68, v124
 v_mul_f32 v69, v69, v124
 v_mul_f32 v70, v70, v124
 v_mul_f32 v71, v71, v124
 v_cvt_pk_bf16_f32 v96, v64, v65
 v_cvt_pk_bf16_f32 v97, v68, v69
 v_cvt_pk_bf16_f32 v98, v66, v67
 v_cvt_pk_bf16_f32 v99, v70, v71
 buffer_store_dwordx4 v[96:99], v1, s[20:23], s56 offen offset:0 sc1
 v_mul_f32 v72, v72, v124
 v_mul_f32 v73, v73, v124
 v_mul_f32 v74, v74, v124
 v_mul_f32 v75, v75, v124
 v_mul_f32 v76, v76, v124
 v_mul_f32 v77, v77, v124
 v_mul_f32 v78, v78, v124
 v_mul_f32 v79, v79, v124
 v_cvt_pk_bf16_f32 v100, v72, v73
 v_cvt_pk_bf16_f32 v101, v76, v77
 v_cvt_pk_bf16_f32 v102, v74, v75
 v_cvt_pk_bf16_f32 v103, v78, v79
 buffer_store_dwordx4 v[100:103], v1, s[20:23], s56 offen offset:2048 sc1
 v_mul_f32 v80, v80, v124
 v_mul_f32 v81, v81, v124
 v_mul_f32 v82, v82, v124
 v_mul_f32 v83, v83, v124
 v_mul_f32 v84, v84, v124
 v_mul_f32 v85, v85, v124
 v_mul_f32 v86, v86, v124
 v_mul_f32 v87, v87, v124
 v_cvt_pk_bf16_f32 v104, v80, v81
 v_cvt_pk_bf16_f32 v105, v84, v85
 v_cvt_pk_bf16_f32 v106, v82, v83
 v_cvt_pk_bf16_f32 v107, v86, v87
 buffer_store_dwordx4 v[104:107], v1, s[20:23], s45 offen offset:0 sc1
 v_mul_f32 v88, v88, v124
 v_mul_f32 v89, v89, v124
 v_mul_f32 v90, v90, v124
 v_mul_f32 v91, v91, v124
 v_mul_f32 v92, v92, v124
 v_mul_f32 v93, v93, v124
 v_mul_f32 v94, v94, v124
 v_mul_f32 v95, v95, v124
 v_cvt_pk_bf16_f32 v108, v88, v89
 v_cvt_pk_bf16_f32 v109, v92, v93
 v_cvt_pk_bf16_f32 v110, v90, v91
 v_cvt_pk_bf16_f32 v111, v94, v95
 buffer_store_dwordx4 v[108:111], v1, s[20:23], s45 offen offset:2048 sc1
 s_cmp_lt_u32 s42, s36
 s_cbranch_scc1 Lqb_loop_24
 s_waitcnt vmcnt(0)
 buffer_store_dword v14, v15, s[20:23], s59 offen sc1
 s_branch Lfin
Lob:
 s_load_dwordx2 s[8:9], s[0:1], 88
 s_mov_b32 s10, 0x480000
 s_mov_b32 s11, 0x20000
 s_sub_u32 s32, s6, 16
 s_mov_b32 s33, s3
 s_mov_b32 s34, 2
 s_mov_b32 s35, 32
 s_mov_b32 s36, 0x7000000
 s_mov_b32 s37, 1152
 s_lshl_b32 s7, s3, 2
 s_add_u32 s7, s7, s4
 s_lshl_b32 s7, s7, 6
 s_add_u32 s38, s7, 0x3800
 s_mov_b32 s39, 1
 s_mov_b32 s40, 1
 s_mov_b32 s93, 0
 s_mov_b32 s92, 15
Los:
 s_load_dwordx2 s[24:25], s[0:1], 104
 s_mov_b32 s26, 0x480000
 s_mov_b32 s27, 0x20000
 s_waitcnt lgkmcnt(0)
 v_and_b32 v7, 63, v0
 v_lshlrev_b32 v1, 4, v7
 v_and_b32 v3, s92, v7
 v_lshlrev_b32 v3, 2, v3
 s_and_b32 s44, s32, 7
 s_mov_b32 s50, 0x200000
 v_add_u32 v12, 0, v7
 v_mul_u32_u24 v13, 171, v12
 v_lshrrev_b32 v13, 10, v13
 v_mul_u32_u24 v14, 6, v13
 v_sub_u32 v14, v12, v14
 v_mul_u32_u24 v13, 1152, v13
 v_lshl_add_u32 v8, v14, 4, v13
 v_add_u32 v12, 64, v7
 v_mul_u32_u24 v13, 171, v12
 v_lshrrev_b32 v13, 10, v13
 v_mul_u32_u24 v14, 6, v13
 v_sub_u32 v14, v12, v14
 v_mul_u32_u24 v13, 1152, v13
 v_lshl_add_u32 v9, v14, 4, v13
 v_add_u32 v12, 128, v7
 v_mul_u32_u24 v13, 171, v12
 v_lshrrev_b32 v13, 10, v13
 v_mul_u32_u24 v14, 6, v13
 v_sub_u32 v14, v12, v14
 v_mul_u32_u24 v13, 1152, v13
 v_lshl_add_u32 v10, v14, 4, v13
 v_bfe_u32 v12, v7, 2, 1
 v_bfe_u32 v13, v7, 3, 1
 v_lshl_add_u32 v12, v13, 6, v12
 v_lshrrev_b32 v13, 4, v7
 v_lshl_add_u32 v12, v13, 2, v12
 v_mul_u32_u24 v12, 96, v12
 v_and_b32 v13, 3, v7
 v_lshl_add_u32 v12, v13, 3, v12
 s_mul_i32 s49, s4, 36864
 v_add_u32 v11, s49, v12
 s_mul_i32 s47, s32, 96
 s_add_u32 s46, s44, 0
 s_and_b32 s46, s46, 7
 s_lshl_b32 s45, s4, 3
 s_add_u32 s46, s46, s45
 s_mul_i32 s46, s46, 147456
 s_add_u32 s46, s46, s47
 s_add_u32 m0, s49, 0
 s_nop 0
 buffer_load_dwordx4 v8, s[8:11], s46 offen  lds
 s_add_u32 m0, s49, 1024
 s_nop 0
 buffer_load_dwordx4 v9, s[8:11], s46 offen  lds
 s_add_u32 m0, s49, 2048
 s_nop 0
 buffer_load_dwordx4 v10, s[8:11], s46 offen  lds
 s_add_u32 m0, s49, 3072
 s_add_u32 s46, s46, 36864
 buffer_load_dwordx4 v8, s[8:11], s46 offen  lds
 s_add_u32 m0, s49, 4096
 s_nop 0
 buffer_load_dwordx4 v9, s[8:11], s46 offen  lds
 s_add_u32 m0, s49, 5120
 s_nop 0
 buffer_load_dwordx4 v10, s[8:11], s46 offen  lds
 s_add_u32 m0, s49, 6144
 s_add_u32 s46, s46, 36864
 buffer_load_dwordx4 v8, s[8:11], s46 offen  lds
 s_add_u32 m0, s49, 7168
 s_nop 0
 buffer_load_dwordx4 v9, s[8:11], s46 offen  lds
 s_add_u32 m0, s49, 8192
 s_nop 0
 buffer_load_dwordx4 v10, s[8:11], s46 offen  lds
 s_add_u32 m0, s49, 9216
 s_add_u32 s46, s46, 36864
 buffer_load_dwordx4 v8, s[8:11], s46 offen  lds
 s_add_u32 m0, s49, 10240
 s_nop 0
 buffer_load_dwordx4 v9, s[8:11], s46 offen  lds
 s_add_u32 m0, s49, 11264
 s_nop 0
 buffer_load_dwordx4 v10, s[8:11], s46 offen  lds
 s_add_u32 s46, s44, 1
 s_and_b32 s46, s46, 7
 s_lshl_b32 s45, s4, 3
 s_add_u32 s46, s46, s45
 s_mul_i32 s46, s46, 147456
 s_add_u32 s46, s46, s47
 s_add_u32 m0, s49, 12288
 s_nop 0
 buffer_load_dwordx4 v8, s[8:11], s46 offen  lds
 s_add_u32 m0, s49, 13312
 s_nop 0
 buffer_load_dwordx4 v9, s[8:11], s46 offen  lds
 s_add_u32 m0, s49, 14336
 s_nop 0
 buffer_load_dwordx4 v10, s[8:11], s46 offen  lds
 s_add_u32 m0, s49, 15360
 s_add_u32 s46, s46, 36864
 buffer_load_dwordx4 v8, s[8:11], s46 offen  lds
 s_add_u32 m0, s49, 16384
 s_nop 0
 buffer_load_dwordx4 v9, s[8:11], s46 offen  lds
 s_add_u32 m0, s49, 17408
 s_nop 0
 buffer_load_dwordx4 v10, s[8:11], s46 offen  lds
 s_add_u32 m0, s49, 18432
 s_add_u32 s46, s46, 36864
 buffer_load_dwordx4 v8, s[8:11], s46 offen  lds
 s_add_u32 m0, s49, 19456
 s_nop 0
 buffer_load_dwordx4 v9, s[8:11], s46 offen  lds
 s_add_u32 m0, s49, 20480
 s_nop 0
 buffer_load_dwordx4 v10, s[8:11], s46 offen  lds
 s_add_u32 m0, s49, 21504
 s_add_u32 s46, s46, 36864
 buffer_load_dwordx4 v8, s[8:11], s46 offen  lds
 s_add_u32 m0, s49, 22528
 s_nop 0
 buffer_load_dwordx4 v9, s[8:11], s46 offen  lds
 s_add_u32 m0, s49, 23552
 s_nop 0
 buffer_load_dwordx4 v10, s[8:11], s46 offen  lds
 s_waitcnt lgkmcnt(0)
 s_add_u32 s46, s44, 2
 s_and_b32 s46, s46, 7
 s_lshl_b32 s45, s4, 3
 s_add_u32 s46, s46, s45
 s_mul_i32 s46, s46, 147456
 s_add_u32 s46, s46, s47
 s_add_u32 m0, s49, 24576
 s_nop 0
 buffer_load_dwordx4 v8, s[8:11], s46 offen  lds
 s_add_u32 m0, s49, 25600
 s_nop 0
 buffer_load_dwordx4 v9, s[8:11], s46 offen  lds
 s_add_u32 m0, s49, 26624
 s_nop 0
 buffer_load_dwordx4 v10, s[8:11], s46 offen  lds
 s_add_u32 m0, s49, 27648
 s_add_u32 s46, s46, 36864
 buffer_load_dwordx4 v8, s[8:11], s46 offen  lds
 s_add_u32 m0, s49, 28672
 s_nop 0
 buffer_load_dwordx4 v9, s[8:11], s46 offen  lds
 s_add_u32 m0, s49, 29696
 s_nop 0
 buffer_load_dwordx4 v10, s[8:11], s46 offen  lds
 s_add_u32 m0, s49, 30720
 s_add_u32 s46, s46, 36864
 buffer_load_dwordx4 v8, s[8:11], s46 offen  lds
 s_add_u32 m0, s49, 31744
 s_nop 0
 buffer_load_dwordx4 v9, s[8:11], s46 offen  lds
 s_add_u32 m0, s49, 32768
 s_nop 0
 buffer_load_dwordx4 v10, s[8:11], s46 offen  lds
 s_add_u32 m0, s49, 33792
 s_add_u32 s46, s46, 36864
 buffer_load_dwordx4 v8, s[8:11], s46 offen  lds
 s_add_u32 m0, s49, 34816
 s_nop 0
 buffer_load_dwordx4 v9, s[8:11], s46 offen  lds
 s_add_u32 m0, s49, 35840
 s_nop 0
 buffer_load_dwordx4 v10, s[8:11], s46 offen  lds
 s_waitcnt vmcnt(24)
 ds_read_b64_tr_b16 a[0:1], v11 offset:0
 ds_read_b64_tr_b16 a[2:3], v11 offset:192
 ds_read_b64_tr_b16 a[4:5], v11 offset:32
 ds_read_b64_tr_b16 a[6:7], v11 offset:224
 ds_read_b64_tr_b16 a[8:9], v11 offset:64
 ds_read_b64_tr_b16 a[10:11], v11 offset:256
 ds_read_b64_tr_b16 a[12:13], v11 offset:1536
 ds_read_b64_tr_b16 a[14:15], v11 offset:1728
 ds_read_b64_tr_b16 a[16:17], v11 offset:1568
 ds_read_b64_tr_b16 a[18:19], v11 offset:1760
 ds_read_b64_tr_b16 a[20:21], v11 offset:1600
 ds_read_b64_tr_b16 a[22:23], v11 offset:1792
 ds_read_b64_tr_b16 a[24:25], v11 offset:3072
 ds_read_b64_tr_b16 a[26:27], v11 offset:3264
 ds_read_b64_tr_b16 a[28:29], v11 offset:3104
 ds_read_b64_tr_b16 a[30:31], v11 offset:3296
 ds_read_b64_tr_b16 a[32:33], v11 offset:3136
 ds_read_b64_tr_b16 a[34:35], v11 offset:3328
 ds_read_b64_tr_b16 a[36:37], v11 offset:4608
 ds_read_b64_tr_b16 a[38:39], v11 offset:4800
 ds_read_b64_tr_b16 a[40:41], v11 offset:4640
 ds_read_b64_tr_b16 a[42:43], v11 offset:4832
 ds_read_b64_tr_b16 a[44:45], v11 offset:4672
 ds_read_b64_tr_b16 a[46:47], v11 offset:4864
 s_waitcnt lgkmcnt(0)
 s_add_u32 s46, s44, 3
 s_and_b32 s46, s46, 7
 s_lshl_b32 s45, s4, 3
 s_add_u32 s46, s46, s45
 s_mul_i32 s46, s46, 147456
 s_add_u32 s46, s46, s47
 s_add_u32 m0, s49, 0
 s_nop 0
 buffer_load_dwordx4 v8, s[8:11], s46 offen  lds
 s_add_u32 m0, s49, 1024
 s_nop 0
 buffer_load_dwordx4 v9, s[8:11], s46 offen  lds
 s_add_u32 m0, s49, 2048
 s_nop 0
 buffer_load_dwordx4 v10, s[8:11], s46 offen  lds
 s_add_u32 m0, s49, 3072
 s_add_u32 s46, s46, 36864
 buffer_load_dwordx4 v8, s[8:11], s46 offen  lds
 s_add_u32 m0, s49, 4096
 s_nop 0
 buffer_load_dwordx4 v9, s[8:11], s46 offen  lds
 s_add_u32 m0, s49, 5120
 s_nop 0
 buffer_load_dwordx4 v10, s[8:11], s46 offen  lds
 s_add_u32 m0, s49, 6144
 s_add_u32 s46, s46, 36864
 buffer_load_dwordx4 v8, s[8:11], s46 offen  lds
 s_add_u32 m0, s49, 7168
 s_nop 0
 buffer_load_dwordx4 v9, s[8:11], s46 offen  lds
 s_add_u32 m0, s49, 8192
 s_nop 0
 buffer_load_dwordx4 v10, s[8:11], s46 offen  lds
 s_add_u32 m0, s49, 9216
 s_add_u32 s46, s46, 36864
 buffer_load_dwordx4 v8, s[8:11], s46 offen  lds
 s_add_u32 m0, s49, 10240
 s_nop 0
 buffer_load_dwordx4 v9, s[8:11], s46 offen  lds
 s_add_u32 m0, s49, 11264
 s_nop 0
 buffer_load_dwordx4 v10, s[8:11], s46 offen  lds
 s_waitcnt vmcnt(24)
 ds_read_b64_tr_b16 a[48:49], v11 offset:12288
 ds_read_b64_tr_b16 a[50:51], v11 offset:12480
 ds_read_b64_tr_b16 a[52:53], v11 offset:12320
 ds_read_b64_tr_b16 a[54:55], v11 offset:12512
 ds_read_b64_tr_b16 a[56:57], v11 offset:12352
 ds_read_b64_tr_b16 a[58:59], v11 offset:12544
 ds_read_b64_tr_b16 a[60:61], v11 offset:13824
 ds_read_b64_tr_b16 a[62:63], v11 offset:14016
 ds_read_b64_tr_b16 a[64:65], v11 offset:13856
 ds_read_b64_tr_b16 a[66:67], v11 offset:14048
 ds_read_b64_tr_b16 a[68:69], v11 offset:13888
 ds_read_b64_tr_b16 a[70:71], v11 offset:14080
 ds_read_b64_tr_b16 a[72:73], v11 offset:15360
 ds_read_b64_tr_b16 a[74:75], v11 offset:15552
 ds_read_b64_tr_b16 a[76:77], v11 offset:15392
 ds_read_b64_tr_b16 a[78:79], v11 offset:15584
 ds_read_b64_tr_b16 a[80:81], v11 offset:15424
 ds_read_b64_tr_b16 a[82:83], v11 offset:15616
 ds_read_b64_tr_b16 a[84:85], v11 offset:16896
 ds_read_b64_tr_b16 a[86:87], v11 offset:17088
 ds_read_b64_tr_b16 a[88:89], v11 offset:16928
 ds_read_b64_tr_b16 a[90:91], v11 offset:17120
 ds_read_b64_tr_b16 a[92:93], v11 offset:16960
 ds_read_b64_tr_b16 a[94:95], v11 offset:17152
 s_waitcnt lgkmcnt(0)
 s_add_u32 s46, s44, 4
 s_and_b32 s46, s46, 7
 s_lshl_b32 s45, s4, 3
 s_add_u32 s46, s46, s45
 s_mul_i32 s46, s46, 147456
 s_add_u32 s46, s46, s47
 s_add_u32 m0, s49, 12288
 s_nop 0
 buffer_load_dwordx4 v8, s[8:11], s46 offen  lds
 s_add_u32 m0, s49, 13312
 s_nop 0
 buffer_load_dwordx4 v9, s[8:11], s46 offen  lds
 s_add_u32 m0, s49, 14336
 s_nop 0
 buffer_load_dwordx4 v10, s[8:11], s46 offen  lds
 s_add_u32 m0, s49, 15360
 s_add_u32 s46, s46, 36864
 buffer_load_dwordx4 v8, s[8:11], s46 offen  lds
 s_add_u32 m0, s49, 16384
 s_nop 0
 buffer_load_dwordx4 v9, s[8:11], s46 offen  lds
 s_add_u32 m0, s49, 17408
 s_nop 0
 buffer_load_dwordx4 v10, s[8:11], s46 offen  lds
 s_add_u32 m0, s49, 18432
 s_add_u32 s46, s46, 36864
 buffer_load_dwordx4 v8, s[8:11], s46 offen  lds
 s_add_u32 m0, s49, 19456
 s_nop 0
 buffer_load_dwordx4 v9, s[8:11], s46 offen  lds
 s_add_u32 m0, s49, 20480
 s_nop 0
 buffer_load_dwordx4 v10, s[8:11], s46 offen  lds
 s_add_u32 m0, s49, 21504
 s_add_u32 s46, s46, 36864
 buffer_load_dwordx4 v8, s[8:11], s46 offen  lds
 s_add_u32 m0, s49, 22528
 s_nop 0
 buffer_load_dwordx4 v9, s[8:11], s46 offen  lds
 s_add_u32 m0, s49, 23552
 s_nop 0
 buffer_load_dwordx4 v10, s[8:11], s46 offen  lds
 s_waitcnt vmcnt(24)
 ds_read_b64_tr_b16 a[96:97], v11 offset:24576
 ds_read_b64_tr_b16 a[98:99], v11 offset:24768
 ds_read_b64_tr_b16 a[100:101], v11 offset:24608
 ds_read_b64_tr_b16 a[102:103], v11 offset:24800
 ds_read_b64_tr_b16 a[104:105], v11 offset:24640
 ds_read_b64_tr_b16 a[106:107], v11 offset:24832
 ds_read_b64_tr_b16 a[108:109], v11 offset:26112
 ds_read_b64_tr_b16 a[110:111], v11 offset:26304
 ds_read_b64_tr_b16 a[112:113], v11 offset:26144
 ds_read_b64_tr_b16 a[114:115], v11 offset:26336
 ds_read_b64_tr_b16 a[116:117], v11 offset:26176
 ds_read_b64_tr_b16 a[118:119], v11 offset:26368
 ds_read_b64_tr_b16 a[120:121], v11 offset:27648
 ds_read_b64_tr_b16 a[122:123], v11 offset:27840
 ds_read_b64_tr_b16 a[124:125], v11 offset:27680
 ds_read_b64_tr_b16 a[126:127], v11 offset:27872
 ds_read_b64_tr_b16 a[128:129], v11 offset:27712
 ds_read_b64_tr_b16 a[130:131], v11 offset:27904
 ds_read_b64_tr_b16 a[132:133], v11 offset:29184
 ds_read_b64_tr_b16 a[134:135], v11 offset:29376
 ds_read_b64_tr_b16 a[136:137], v11 offset:29216
 ds_read_b64_tr_b16 a[138:139], v11 offset:29408
 ds_read_b64_tr_b16 a[140:141], v11 offset:29248
 ds_read_b64_tr_b16 a[142:143], v11 offset:29440
 s_waitcnt lgkmcnt(0)
 s_add_u32 s46, s44, 5
 s_and_b32 s46, s46, 7
 s_lshl_b32 s45, s4, 3
 s_add_u32 s46, s46, s45
 s_mul_i32 s46, s46, 147456
 s_add_u32 s46, s46, s47
 s_add_u32 m0, s49, 24576
 s_nop 0
 buffer_load_dwordx4 v8, s[8:11], s46 offen  lds
 s_add_u32 m0, s49, 25600
 s_nop 0
 buffer_load_dwordx4 v9, s[8:11], s46 offen  lds
 s_add_u32 m0, s49, 26624
 s_nop 0
 buffer_load_dwordx4 v10, s[8:11], s46 offen  lds
 s_add_u32 m0, s49, 27648
 s_add_u32 s46, s46, 36864
 buffer_load_dwordx4 v8, s[8:11], s46 offen  lds
 s_add_u32 m0, s49, 28672
 s_nop 0
 buffer_load_dwordx4 v9, s[8:11], s46 offen  lds
 s_add_u32 m0, s49, 29696
 s_nop 0
 buffer_load_dwordx4 v10, s[8:11], s46 offen  lds
 s_add_u32 m0, s49, 30720
 s_add_u32 s46, s46, 36864
 buffer_load_dwordx4 v8, s[8:11], s46 offen  lds
 s_add_u32 m0, s49, 31744
 s_nop 0
 buffer_load_dwordx4 v9, s[8:11], s46 offen  lds
 s_add_u32 m0, s49, 32768
 s_nop 0
 buffer_load_dwordx4 v10, s[8:11], s46 offen  lds
 s_add_u32 m0, s49, 33792
 s_add_u32 s46, s46, 36864
 buffer_load_dwordx4 v8, s[8:11], s46 offen  lds
 s_add_u32 m0, s49, 34816
 s_nop 0
 buffer_load_dwordx4 v9, s[8:11], s46 offen  lds
 s_add_u32 m0, s49, 35840
 s_nop 0
 buffer_load_dwordx4 v10, s[8:11], s46 offen  lds
 s_waitcnt vmcnt(24)
 ds_read_b64_tr_b16 a[144:145], v11 offset:0
 ds_read_b64_tr_b16 a[146:147], v11 offset:192
 ds_read_b64_tr_b16 a[148:149], v11 offset:32
 ds_read_b64_tr_b16 a[150:151], v11 offset:224
 ds_read_b64_tr_b16 a[152:153], v11 offset:64
 ds_read_b64_tr_b16 a[154:155], v11 offset:256
 ds_read_b64_tr_b16 a[156:157], v11 offset:1536
 ds_read_b64_tr_b16 a[158:159], v11 offset:1728
 ds_read_b64_tr_b16 a[160:161], v11 offset:1568
 ds_read_b64_tr_b16 a[162:163], v11 offset:1760
 ds_read_b64_tr_b16 a[164:165], v11 offset:1600
 ds_read_b64_tr_b16 a[166:167], v11 offset:1792
 ds_read_b64_tr_b16 a[168:169], v11 offset:3072
 ds_read_b64_tr_b16 a[170:171], v11 offset:3264
 ds_read_b64_tr_b16 a[172:173], v11 offset:3104
 ds_read_b64_tr_b16 a[174:175], v11 offset:3296
 ds_read_b64_tr_b16 a[176:177], v11 offset:3136
 ds_read_b64_tr_b16 a[178:179], v11 offset:3328
 ds_read_b64_tr_b16 a[180:181], v11 offset:4608
 ds_read_b64_tr_b16 a[182:183], v11 offset:4800
 ds_read_b64_tr_b16 a[184:185], v11 offset:4640
 ds_read_b64_tr_b16 a[186:187], v11 offset:4832
 ds_read_b64_tr_b16 a[188:189], v11 offset:4672
 ds_read_b64_tr_b16 a[190:191], v11 offset:4864
 s_waitcnt lgkmcnt(0)
 s_add_u32 s46, s44, 6
 s_and_b32 s46, s46, 7
 s_lshl_b32 s45, s4, 3
 s_add_u32 s46, s46, s45
 s_mul_i32 s46, s46, 147456
 s_add_u32 s46, s46, s47
 s_add_u32 m0, s49, 0
 s_nop 0
 buffer_load_dwordx4 v8, s[8:11], s46 offen  lds
 s_add_u32 m0, s49, 1024
 s_nop 0
 buffer_load_dwordx4 v9, s[8:11], s46 offen  lds
 s_add_u32 m0, s49, 2048
 s_nop 0
 buffer_load_dwordx4 v10, s[8:11], s46 offen  lds
 s_add_u32 m0, s49, 3072
 s_add_u32 s46, s46, 36864
 buffer_load_dwordx4 v8, s[8:11], s46 offen  lds
 s_add_u32 m0, s49, 4096
 s_nop 0
 buffer_load_dwordx4 v9, s[8:11], s46 offen  lds
 s_add_u32 m0, s49, 5120
 s_nop 0
 buffer_load_dwordx4 v10, s[8:11], s46 offen  lds
 s_add_u32 m0, s49, 6144
 s_add_u32 s46, s46, 36864
 buffer_load_dwordx4 v8, s[8:11], s46 offen  lds
 s_add_u32 m0, s49, 7168
 s_nop 0
 buffer_load_dwordx4 v9, s[8:11], s46 offen  lds
 s_add_u32 m0, s49, 8192
 s_nop 0
 buffer_load_dwordx4 v10, s[8:11], s46 offen  lds
 s_add_u32 m0, s49, 9216
 s_add_u32 s46, s46, 36864
 buffer_load_dwordx4 v8, s[8:11], s46 offen  lds
 s_add_u32 m0, s49, 10240
 s_nop 0
 buffer_load_dwordx4 v9, s[8:11], s46 offen  lds
 s_add_u32 m0, s49, 11264
 s_nop 0
 buffer_load_dwordx4 v10, s[8:11], s46 offen  lds
 s_waitcnt vmcnt(24)
 ds_read_b64_tr_b16 a[192:193], v11 offset:12288
 ds_read_b64_tr_b16 a[194:195], v11 offset:12480
 ds_read_b64_tr_b16 a[196:197], v11 offset:12320
 ds_read_b64_tr_b16 a[198:199], v11 offset:12512
 ds_read_b64_tr_b16 a[200:201], v11 offset:12352
 ds_read_b64_tr_b16 a[202:203], v11 offset:12544
 ds_read_b64_tr_b16 a[204:205], v11 offset:13824
 ds_read_b64_tr_b16 a[206:207], v11 offset:14016
 ds_read_b64_tr_b16 a[208:209], v11 offset:13856
 ds_read_b64_tr_b16 a[210:211], v11 offset:14048
 ds_read_b64_tr_b16 a[212:213], v11 offset:13888
 ds_read_b64_tr_b16 a[214:215], v11 offset:14080
 ds_read_b64_tr_b16 a[216:217], v11 offset:15360
 ds_read_b64_tr_b16 a[218:219], v11 offset:15552
 ds_read_b64_tr_b16 a[220:221], v11 offset:15392
 ds_read_b64_tr_b16 a[222:223], v11 offset:15584
 ds_read_b64_tr_b16 a[224:225], v11 offset:15424
 ds_read_b64_tr_b16 a[226:227], v11 offset:15616
 ds_read_b64_tr_b16 a[228:229], v11 offset:16896
 ds_read_b64_tr_b16 a[230:231], v11 offset:17088
 ds_read_b64_tr_b16 a[232:233], v11 offset:16928
 ds_read_b64_tr_b16 a[234:235], v11 offset:17120
 ds_read_b64_tr_b16 a[236:237], v11 offset:16960
 ds_read_b64_tr_b16 a[238:239], v11 offset:17152
 s_waitcnt lgkmcnt(0)
 s_add_u32 s46, s44, 7
 s_and_b32 s46, s46, 7
 s_lshl_b32 s45, s4, 3
 s_add_u32 s46, s46, s45
 s_mul_i32 s46, s46, 147456
 s_add_u32 s46, s46, s47
 s_add_u32 m0, s49, 12288
 s_nop 0
 buffer_load_dwordx4 v8, s[8:11], s46 offen  lds
 s_add_u32 m0, s49, 13312
 s_nop 0
 buffer_load_dwordx4 v9, s[8:11], s46 offen  lds
 s_add_u32 m0, s49, 14336
 s_nop 0
 buffer_load_dwordx4 v10, s[8:11], s46 offen  lds
 s_add_u32 m0, s49, 15360
 s_add_u32 s46, s46, 36864
 buffer_load_dwordx4 v8, s[8:11], s46 offen  lds
 s_add_u32 m0, s49, 16384
 s_nop 0
 buffer_load_dwordx4 v9, s[8:11], s46 offen  lds
 s_add_u32 m0, s49, 17408
 s_nop 0
 buffer_load_dwordx4 v10, s[8:11], s46 offen  lds
 s_add_u32 m0, s49, 18432
 s_add_u32 s46, s46, 36864
 buffer_load_dwordx4 v8, s[8:11], s46 offen  lds
 s_add_u32 m0, s49, 19456
 s_nop 0
 buffer_load_dwordx4 v9, s[8:11], s46 offen  lds
 s_add_u32 m0, s49, 20480
 s_nop 0
 buffer_load_dwordx4 v10, s[8:11], s46 offen  lds
 s_add_u32 m0, s49, 21504
 s_add_u32 s46, s46, 36864
 buffer_load_dwordx4 v8, s[8:11], s46 offen  lds
 s_add_u32 m0, s49, 22528
 s_nop 0
 buffer_load_dwordx4 v9, s[8:11], s46 offen  lds
 s_add_u32 m0, s49, 23552
 s_nop 0
 buffer_load_dwordx4 v10, s[8:11], s46 offen  lds
 s_waitcnt vmcnt(24)
 ds_read_b64_tr_b16 a[240:241], v11 offset:24576
 ds_read_b64_tr_b16 a[242:243], v11 offset:24768
 ds_read_b64_tr_b16 a[244:245], v11 offset:24608
 ds_read_b64_tr_b16 a[246:247], v11 offset:24800
 ds_read_b64_tr_b16 a[248:249], v11 offset:24640
 ds_read_b64_tr_b16 a[250:251], v11 offset:24832
 ds_read_b64_tr_b16 a[252:253], v11 offset:26112
 ds_read_b64_tr_b16 a[254:255], v11 offset:26304
 ds_read_b64_tr_b16 v[128:129], v11 offset:26144
 ds_read_b64_tr_b16 v[130:131], v11 offset:26336
 ds_read_b64_tr_b16 v[132:133], v11 offset:26176
 ds_read_b64_tr_b16 v[134:135], v11 offset:26368
 ds_read_b64_tr_b16 v[136:137], v11 offset:27648
 ds_read_b64_tr_b16 v[138:139], v11 offset:27840
 ds_read_b64_tr_b16 v[140:141], v11 offset:27680
 ds_read_b64_tr_b16 v[142:143], v11 offset:27872
 ds_read_b64_tr_b16 v[144:145], v11 offset:27712
 ds_read_b64_tr_b16 v[146:147], v11 offset:27904
 ds_read_b64_tr_b16 v[148:149], v11 offset:29184
 ds_read_b64_tr_b16 v[150:151], v11 offset:29376
 ds_read_b64_tr_b16 v[152:153], v11 offset:29216
 ds_read_b64_tr_b16 v[154:155], v11 offset:29408
 ds_read_b64_tr_b16 v[156:157], v11 offset:29248
 ds_read_b64_tr_b16 v[158:159], v11 offset:29440
 s_waitcnt lgkmcnt(0)
 s_waitcnt vmcnt(12)
 ds_read_b64_tr_b16 v[160:161], v11 offset:0
 ds_read_b64_tr_b16 v[162:163], v11 offset:192
 ds_read_b64_tr_b16 v[164:165], v11 offset:32
 ds_read_b64_tr_b16 v[166:167], v11 offset:224
 ds_read_b64_tr_b16 v[168:169], v11 offset:64
 ds_read_b64_tr_b16 v[170:171], v11 offset:256
 ds_read_b64_tr_b16 v[172:173], v11 offset:1536
 ds_read_b64_tr_b16 v[174:175], v11 offset:1728
 ds_read_b64_tr_b16 v[176:177], v11 offset:1568
 ds_read_b64_tr_b16 v[178:179], v11 offset:1760
 ds_read_b64_tr_b16 v[180:181], v11 offset:1600
 ds_read_b64_tr_b16 v[182:183], v11 offset:1792
 ds_read_b64_tr_b16 v[184:185], v11 offset:3072
 ds_read_b64_tr_b16 v[186:187], v11 offset:3264
 ds_read_b64_tr_b16 v[188:189], v11 offset:3104
 ds_read_b64_tr_b16 v[190:191], v11 offset:3296
 ds_read_b64_tr_b16 v[192:193], v11 offset:3136
 ds_read_b64_tr_b16 v[194:195], v11 offset:3328
 ds_read_b64_tr_b16 v[196:197], v11 offset:4608
 ds_read_b64_tr_b16 v[198:199], v11 offset:4800
 ds_read_b64_tr_b16 v[200:201], v11 offset:4640
 ds_read_b64_tr_b16 v[202:203], v11 offset:4832
 ds_read_b64_tr_b16 v[204:205], v11 offset:4672
 ds_read_b64_tr_b16 v[206:207], v11 offset:4864
 s_waitcnt lgkmcnt(0)
 s_waitcnt vmcnt(0)
 ds_read_b64_tr_b16 v[208:209], v11 offset:12288
 ds_read_b64_tr_b16 v[210:211], v11 offset:12480
 ds_read_b64_tr_b16 v[212:213], v11 offset:12320
 ds_read_b64_tr_b16 v[214:215], v11 offset:12512
 ds_read_b64_tr_b16 v[216:217], v11 offset:12352
 ds_read_b64_tr_b16 v[218:219], v11 offset:12544
 ds_read_b64_tr_b16 v[220:221], v11 offset:13824
 ds_read_b64_tr_b16 v[222:223], v11 offset:14016
 ds_read_b64_tr_b16 v[224:225], v11 offset:13856
 ds_read_b64_tr_b16 v[226:227], v11 offset:14048
 ds_read_b64_tr_b16 v[228:229], v11 offset:13888
 ds_read_b64_tr_b16 v[230:231], v11 offset:14080
 ds_read_b64_tr_b16 v[232:233], v11 offset:15360
 ds_read_b64_tr_b16 v[234:235], v11 offset:15552
 ds_read_b64_tr_b16 v[236:237], v11 offset:15392
 ds_read_b64_tr_b16 v[238:239], v11 offset:15584
 ds_read_b64_tr_b16 v[240:241], v11 offset:15424
 ds_read_b64_tr_b16 v[242:243], v11 offset:15616
 ds_read_b64_tr_b16 v[244:245], v11 offset:16896
 ds_read_b64_tr_b16 v[246:247], v11 offset:17088
 ds_read_b64_tr_b16 v[248:249], v11 offset:16928
 ds_read_b64_tr_b16 v[250:251], v11 offset:17120
 ds_read_b64_tr_b16 v[252:253], v11 offset:16960
 ds_read_b64_tr_b16 v[254:255], v11 offset:17152
 v_mul_u32_u24 v13, 171, v0
 v_lshrrev_b32 v13, 10, v13
 v_mul_u32_u24 v14, 6, v13
 v_sub_u32 v14, v0, v14
 v_mul_u32_u24 v6, 2304, v13
 v_lshl_add_u32 v6, v14, 4, v6
 v_lshrrev_b32 v12, 4, v13
 v_mul_u32_u24 v12, 3072, v12
 v_lshl_add_u32 v12, v14, 9, v12
 v_and_b32 v13, 15, v13
 v_lshl_add_u32 v4, v13, 4, v12
 s_mul_i32 s45, s4, 6144
 v_add_u32 v5, s45, v1
 s_mul_i32 s45, s32, 96
 s_add_u32 s37, s37, s45
 s_lshl_b32 s45, s4, 16
 s_add_u32 s36, s36, s45
 s_mov_b32 s42, s33
 s_mov_b32 s51, s39
 s_mov_b32 s43, 0
 s_and_b32 s53, s42, s93
 s_lshl_b32 s53, s53, 4
 s_add_u32 s53, s53, s38
Los0_29:
 buffer_load_dword v2, v3, s[20:23], s53 offen sc1
 s_waitcnt vmcnt(0)
 v_cmp_gt_u32 vcc, s51, v2
 s_cbranch_vccz Los0k_30
 s_sleep 1
 s_sub_u32 s50, s50, 1
 s_cbranch_scc0 Los0_29
 s_endpgm
Los0k_30:
 s_lshl_b32 s48, s42, 18
 s_add_u32 s48, s48, s36
 s_add_u32 s52, s44, 0
 s_and_b32 s52, s52, 7
 s_lshl_b32 s52, s52, 13
 s_add_u32 s46, s48, s52
 s_add_u32 s47, s46, 4096
 buffer_load_dwordx4 v[32:35], v1, s[20:23], s46 offen offset:0 sc1
 buffer_load_dwordx4 v[36:39], v1, s[20:23], s46 offen offset:1024 sc1
 buffer_load_dwordx4 v[40:43], v1, s[20:23], s46 offen offset:2048 sc1
 buffer_load_dwordx4 v[44:47], v1, s[20:23], s46 offen offset:3072 sc1
 buffer_load_dwordx4 v[48:51], v1, s[20:23], s47 offen offset:0 sc1
 buffer_load_dwordx4 v[52:55], v1, s[20:23], s47 offen offset:1024 sc1
 buffer_load_dwordx4 v[56:59], v1, s[20:23], s47 offen offset:2048 sc1
 buffer_load_dwordx4 v[60:63], v1, s[20:23], s47 offen offset:3072 sc1
 s_add_u32 s52, s44, 1
 s_and_b32 s52, s52, 7
 s_lshl_b32 s52, s52, 13
 s_add_u32 s46, s48, s52
 s_add_u32 s47, s46, 4096
 buffer_load_dwordx4 v[64:67], v1, s[20:23], s46 offen offset:0 sc1
 buffer_load_dwordx4 v[68:71], v1, s[20:23], s46 offen offset:1024 sc1
 buffer_load_dwordx4 v[72:75], v1, s[20:23], s46 offen offset:2048 sc1
 buffer_load_dwordx4 v[76:79], v1, s[20:23], s46 offen offset:3072 sc1
 buffer_load_dwordx4 v[80:83], v1, s[20:23], s47 offen offset:0 sc1
 buffer_load_dwordx4 v[84:87], v1, s[20:23], s47 offen offset:1024 sc1
 buffer_load_dwordx4 v[88:91], v1, s[20:23], s47 offen offset:2048 sc1
 buffer_load_dwordx4 v[92:95], v1, s[20:23], s47 offen offset:3072 sc1
 s_waitcnt lgkmcnt(0)
 s_barrier
 .p2align 3
Losl_31:
 s_waitcnt vmcnt(14)
 v_mfma_f32_16x16x32_bf16 v[96:99], a[0:3], v[32:35], 0
 s_add_u32 s52, s44, 2
 s_and_b32 s52, s52, 7
 s_lshl_b32 s52, s52, 13
 v_mfma_f32_16x16x32_bf16 v[100:103], a[4:7], v[32:35], 0
 s_add_u32 s46, s48, s52
 s_add_u32 s47, s46, 4096
 v_mfma_f32_16x16x32_bf16 v[104:107], a[8:11], v[32:35], 0
 buffer_load_dwordx4 v[32:35], v1, s[20:23], s46 offen offset:0 sc1
 v_mfma_f32_16x16x32_bf16 v[108:111], a[0:3], v[36:39], 0
 v_mfma_f32_16x16x32_bf16 v[112:115], a[4:7], v[36:39], 0
 v_mfma_f32_16x16x32_bf16 v[116:119], a[8:11], v[36:39], 0
 buffer_load_dwordx4 v[36:39], v1, s[20:23], s46 offen offset:1024 sc1
 s_waitcnt vmcnt(14)
 v_mfma_f32_16x16x32_bf16 v[96:99], a[12:15], v[40:43], v[96:99]
 s_mov_b32 s41, s42
 s_add_u32 s43, s43, 1
 s_cmp_lt_u32 s43, s35
 v_mfma_f32_16x16x32_bf16 v[100:103], a[16:19], v[40:43], v[100:103]
 s_cselect_b32 s45, s34, 0
 s_cselect_b32 s54, s40, 0
 v_mfma_f32_16x16x32_bf16 v[104:107], a[20:23], v[40:43], v[104:107]
 buffer_load_dwordx4 v[40:43], v1, s[20:23], s46 offen offset:2048 sc1
 v_mfma_f32_16x16x32_bf16 v[108:111], a[12:15], v[44:47], v[108:111]
 v_mfma_f32_16x16x32_bf16 v[112:115], a[16:19], v[44:47], v[112:115]
 v_mfma_f32_16x16x32_bf16 v[116:119], a[20:23], v[44:47], v[116:119]
 buffer_load_dwordx4 v[44:47], v1, s[20:23], s46 offen offset:3072 sc1
 s_waitcnt vmcnt(14)
 v_mfma_f32_16x16x32_bf16 v[96:99], a[24:27], v[48:51], v[96:99]
 s_add_u32 s42, s42, s45
 s_add_u32 s51, s51, s54
 s_and_b32 s53, s42, s93
 v_mfma_f32_16x16x32_bf16 v[100:103], a[28:31], v[48:51], v[100:103]
 s_lshl_b32 s53, s53, 4
 s_add_u32 s53, s53, s38
 v_mfma_f32_16x16x32_bf16 v[104:107], a[32:35], v[48:51], v[104:107]
 buffer_load_dwordx4 v[48:51], v1, s[20:23], s47 offen offset:0 sc1
 v_mfma_f32_16x16x32_bf16 v[108:111], a[24:27], v[52:55], v[108:111]
 v_mfma_f32_16x16x32_bf16 v[112:115], a[28:31], v[52:55], v[112:115]
 v_mfma_f32_16x16x32_bf16 v[116:119], a[32:35], v[52:55], v[116:119]
 buffer_load_dwordx4 v[52:55], v1, s[20:23], s47 offen offset:1024 sc1
 s_waitcnt vmcnt(14)
 v_mfma_f32_16x16x32_bf16 v[96:99], a[36:39], v[56:59], v[96:99]
 s_mul_i32 s54, s41, 73728
 s_add_u32 s54, s54, s37
 v_mfma_f32_16x16x32_bf16 v[100:103], a[40:43], v[56:59], v[100:103]
 v_mfma_f32_16x16x32_bf16 v[104:107], a[44:47], v[56:59], v[104:107]
 buffer_load_dwordx4 v[56:59], v1, s[20:23], s47 offen offset:2048 sc1
 v_mfma_f32_16x16x32_bf16 v[108:111], a[36:39], v[60:63], v[108:111]
 v_mfma_f32_16x16x32_bf16 v[112:115], a[40:43], v[60:63], v[112:115]
 v_mfma_f32_16x16x32_bf16 v[116:119], a[44:47], v[60:63], v[116:119]
 buffer_load_dwordx4 v[60:63], v1, s[20:23], s47 offen offset:3072 sc1
 s_waitcnt vmcnt(14)
 v_mfma_f32_16x16x32_bf16 v[96:99], a[48:51], v[64:67], v[96:99]
 s_add_u32 s52, s44, 3
 s_and_b32 s52, s52, 7
 s_lshl_b32 s52, s52, 13
 v_mfma_f32_16x16x32_bf16 v[100:103], a[52:55], v[64:67], v[100:103]
 s_add_u32 s46, s48, s52
 s_add_u32 s47, s46, 4096
 v_mfma_f32_16x16x32_bf16 v[104:107], a[56:59], v[64:67], v[104:107]
 buffer_load_dwordx4 v[64:67], v1, s[20:23], s46 offen offset:0 sc1
 v_mfma_f32_16x16x32_bf16 v[108:111], a[48:51], v[68:71], v[108:111]
 v_mfma_f32_16x16x32_bf16 v[112:115], a[52:55], v[68:71], v[112:115]
 v_mfma_f32_16x16x32_bf16 v[116:119], a[56:59], v[68:71], v[116:119]
 buffer_load_dwordx4 v[68:71], v1, s[20:23], s46 offen offset:1024 sc1
 s_waitcnt vmcnt(14)
 v_mfma_f32_16x16x32_bf16 v[96:99], a[60:63], v[72:75], v[96:99]
 v_mfma_f32_16x16x32_bf16 v[100:103], a[64:67], v[72:75], v[100:103]
 v_mfma_f32_16x16x32_bf16 v[104:107], a[68:71], v[72:75], v[104:107]
 buffer_load_dwordx4 v[72:75], v1, s[20:23], s46 offen offset:2048 sc1
 v_mfma_f32_16x16x32_bf16 v[108:111], a[60:63], v[76:79], v[108:111]
 v_mfma_f32_16x16x32_bf16 v[112:115], a[64:67], v[76:79], v[112:115]
 v_mfma_f32_16x16x32_bf16 v[116:119], a[68:71], v[76:79], v[116:119]
 buffer_load_dwordx4 v[76:79], v1, s[20:23], s46 offen offset:3072 sc1
 s_waitcnt vmcnt(14)
 v_mfma_f32_16x16x32_bf16 v[96:99], a[72:75], v[80:83], v[96:99]
 v_mfma_f32_16x16x32_bf16 v[100:103], a[76:79], v[80:83], v[100:103]
 v_mfma_f32_16x16x32_bf16 v[104:107], a[80:83], v[80:83], v[104:107]
 buffer_load_dwordx4 v[80:83], v1, s[20:23], s47 offen offset:0 sc1
 v_mfma_f32_16x16x32_bf16 v[108:111], a[72:75], v[84:87], v[108:111]
 v_mfma_f32_16x16x32_bf16 v[112:115], a[76:79], v[84:87], v[112:115]
 v_mfma_f32_16x16x32_bf16 v[116:119], a[80:83], v[84:87], v[116:119]
 buffer_load_dwordx4 v[84:87], v1, s[20:23], s47 offen offset:1024 sc1
 s_waitcnt vmcnt(14)
 v_mfma_f32_16x16x32_bf16 v[96:99], a[84:87], v[88:91], v[96:99]
 v_mfma_f32_16x16x32_bf16 v[100:103], a[88:91], v[88:91], v[100:103]
 v_mfma_f32_16x16x32_bf16 v[104:107], a[92:95], v[88:91], v[104:107]
 buffer_load_dwordx4 v[88:91], v1, s[20:23], s47 offen offset:2048 sc1
 v_mfma_f32_16x16x32_bf16 v[108:111], a[84:87], v[92:95], v[108:111]
 v_mfma_f32_16x16x32_bf16 v[112:115], a[88:91], v[92:95], v[112:115]
 v_mfma_f32_16x16x32_bf16 v[116:119], a[92:95], v[92:95], v[116:119]
 buffer_load_dwordx4 v[92:95], v1, s[20:23], s47 offen offset:3072 sc1
 s_waitcnt vmcnt(14)
 v_mfma_f32_16x16x32_bf16 v[96:99], a[96:99], v[32:35], v[96:99]
 s_add_u32 s52, s44, 4
 s_and_b32 s52, s52, 7
 s_lshl_b32 s52, s52, 13
 v_mfma_f32_16x16x32_bf16 v[100:103], a[100:103], v[32:35], v[100:103]
 s_add_u32 s46, s48, s52
 s_add_u32 s47, s46, 4096
 v_mfma_f32_16x16x32_bf16 v[104:107], a[104:107], v[32:35], v[104:107]
 buffer_load_dwordx4 v[32:35], v1, s[20:23], s46 offen offset:0 sc1
 v_mfma_f32_16x16x32_bf16 v[108:111], a[96:99], v[36:39], v[108:111]
 v_mfma_f32_16x16x32_bf16 v[112:115], a[100:103], v[36:39], v[112:115]
 v_mfma_f32_16x16x32_bf16 v[116:119], a[104:107], v[36:39], v[116:119]
 buffer_load_dwordx4 v[36:39], v1, s[20:23], s46 offen offset:1024 sc1
 s_waitcnt vmcnt(14)
 v_mfma_f32_16x16x32_bf16 v[96:99], a[108:111], v[40:43], v[96:99]
 v_mfma_f32_16x16x32_bf16 v[100:103], a[112:115], v[40:43], v[100:103]
 v_mfma_f32_16x16x32_bf16 v[104:107], a[116:119], v[40:43], v[104:107]
 buffer_load_dwordx4 v[40:43], v1, s[20:23], s46 offen offset:2048 sc1
 v_mfma_f32_16x16x32_bf16 v[108:111], a[108:111], v[44:47], v[108:111]
 v_mfma_f32_16x16x32_bf16 v[112:115], a[112:115], v[44:47], v[112:115]
 v_mfma_f32_16x16x32_bf16 v[116:119], a[116:119], v[44:47], v[116:119]
 buffer_load_dwordx4 v[44:47], v1, s[20:23], s46 offen offset:3072 sc1
 s_waitcnt vmcnt(14)
 v_mfma_f32_16x16x32_bf16 v[96:99], a[120:123], v[48:51], v[96:99]
 v_mfma_f32_16x16x32_bf16 v[100:103], a[124:127], v[48:51], v[100:103]
 v_mfma_f32_16x16x32_bf16 v[104:107], a[128:131], v[48:51], v[104:107]
 buffer_load_dwordx4 v[48:51], v1, s[20:23], s47 offen offset:0 sc1
 v_mfma_f32_16x16x32_bf16 v[108:111], a[120:123], v[52:55], v[108:111]
 v_mfma_f32_16x16x32_bf16 v[112:115], a[124:127], v[52:55], v[112:115]
 v_mfma_f32_16x16x32_bf16 v[116:119], a[128:131], v[52:55], v[116:119]
 buffer_load_dwordx4 v[52:55], v1, s[20:23], s47 offen offset:1024 sc1
 s_waitcnt vmcnt(14)
 v_mfma_f32_16x16x32_bf16 v[96:99], a[132:135], v[56:59], v[96:99]
 v_mfma_f32_16x16x32_bf16 v[100:103], a[136:139], v[56:59], v[100:103]
 v_mfma_f32_16x16x32_bf16 v[104:107], a[140:143], v[56:59], v[104:107]
 buffer_load_dwordx4 v[56:59], v1, s[20:23], s47 offen offset:2048 sc1
 v_mfma_f32_16x16x32_bf16 v[108:111], a[132:135], v[60:63], v[108:111]
 v_mfma_f32_16x16x32_bf16 v[112:115], a[136:139], v[60:63], v[112:115]
 v_mfma_f32_16x16x32_bf16 v[116:119], a[140:143], v[60:63], v[116:119]
 buffer_load_dwordx4 v[60:63], v1, s[20:23], s47 offen offset:3072 sc1
 s_waitcnt vmcnt(14)
 v_mfma_f32_16x16x32_bf16 v[96:99], a[144:147], v[64:67], v[96:99]
 s_add_u32 s52, s44, 5
 s_and_b32 s52, s52, 7
 s_lshl_b32 s52, s52, 13
 v_mfma_f32_16x16x32_bf16 v[100:103], a[148:151], v[64:67], v[100:103]
 s_add_u32 s46, s48, s52
 s_add_u32 s47, s46, 4096
 v_mfma_f32_16x16x32_bf16 v[104:107], a[152:155], v[64:67], v[104:107]
 buffer_load_dwordx4 v[64:67], v1, s[20:23], s46 offen offset:0 sc1
 v_mfma_f32_16x16x32_bf16 v[108:111], a[144:147], v[68:71], v[108:111]
 v_mfma_f32_16x16x32_bf16 v[112:115], a[148:151], v[68:71], v[112:115]
 v_mfma_f32_16x16x32_bf16 v[116:119], a[152:155], v[68:71], v[116:119]
 buffer_load_dwordx4 v[68:71], v1, s[20:23], s46 offen offset:1024 sc1
 s_waitcnt vmcnt(14)
 v_mfma_f32_16x16x32_bf16 v[96:99], a[156:159], v[72:75], v[96:99]
 buffer_load_dword v2, v3, s[20:23], s53 offen sc1
 v_mfma_f32_16x16x32_bf16 v[100:103], a[160:163], v[72:75], v[100:103]
 v_mfma_f32_16x16x32_bf16 v[104:107], a[164:167], v[72:75], v[104:107]
 buffer_load_dwordx4 v[72:75], v1, s[20:23], s46 offen offset:2048 sc1
 v_mfma_f32_16x16x32_bf16 v[108:111], a[156:159], v[76:79], v[108:111]
 v_mfma_f32_16x16x32_bf16 v[112:115], a[160:163], v[76:79], v[112:115]
 v_mfma_f32_16x16x32_bf16 v[116:119], a[164:167], v[76:79], v[116:119]
 buffer_load_dwordx4 v[76:79], v1, s[20:23], s46 offen offset:3072 sc1
 s_waitcnt vmcnt(14)
 v_mfma_f32_16x16x32_bf16 v[96:99], a[168:171], v[80:83], v[96:99]
 v_mfma_f32_16x16x32_bf16 v[100:103], a[172:175], v[80:83], v[100:103]
 v_mfma_f32_16x16x32_bf16 v[104:107], a[176:179], v[80:83], v[104:107]
 buffer_load_dwordx4 v[80:83], v1, s[20:23], s47 offen offset:0 sc1
 v_mfma_f32_16x16x32_bf16 v[108:111], a[168:171], v[84:87], v[108:111]
 v_mfma_f32_16x16x32_bf16 v[112:115], a[172:175], v[84:87], v[112:115]
 v_mfma_f32_16x16x32_bf16 v[116:119], a[176:179], v[84:87], v[116:119]
 buffer_load_dwordx4 v[84:87], v1, s[20:23], s47 offen offset:1024 sc1
 s_waitcnt vmcnt(14)
 v_mfma_f32_16x16x32_bf16 v[96:99], a[180:183], v[88:91], v[96:99]
 v_mfma_f32_16x16x32_bf16 v[100:103], a[184:187], v[88:91], v[100:103]
 v_mfma_f32_16x16x32_bf16 v[104:107], a[188:191], v[88:91], v[104:107]
 buffer_load_dwordx4 v[88:91], v1, s[20:23], s47 offen offset:2048 sc1
 v_mfma_f32_16x16x32_bf16 v[108:111], a[180:183], v[92:95], v[108:111]
 v_mfma_f32_16x16x32_bf16 v[112:115], a[184:187], v[92:95], v[112:115]
 v_mfma_f32_16x16x32_bf16 v[116:119], a[188:191], v[92:95], v[116:119]
 buffer_load_dwordx4 v[92:95], v1, s[20:23], s47 offen offset:3072 sc1
 s_waitcnt vmcnt(14)
 v_mfma_f32_16x16x32_bf16 v[96:99], a[192:195], v[32:35], v[96:99]
 s_add_u32 s52, s44, 6
 s_and_b32 s52, s52, 7
 s_lshl_b32 s52, s52, 13
 v_mfma_f32_16x16x32_bf16 v[100:103], a[196:199], v[32:35], v[100:103]
 s_add_u32 s46, s48, s52
 s_add_u32 s47, s46, 4096
 v_mfma_f32_16x16x32_bf16 v[104:107], a[200:203], v[32:35], v[104:107]
 buffer_load_dwordx4 v[32:35], v1, s[20:23], s46 offen offset:0 sc1
 v_mfma_f32_16x16x32_bf16 v[108:111], a[192:195], v[36:39], v[108:111]
 v_mfma_f32_16x16x32_bf16 v[112:115], a[196:199], v[36:39], v[112:115]
 v_mfma_f32_16x16x32_bf16 v[116:119], a[200:203], v[36:39], v[116:119]
 buffer_load_dwordx4 v[36:39], v1, s[20:23], s46 offen offset:1024 sc1
 s_waitcnt vmcnt(14)
 v_mfma_f32_16x16x32_bf16 v[96:99], a[204:207], v[40:43], v[96:99]
 v_mfma_f32_16x16x32_bf16 v[100:103], a[208:211], v[40:43], v[100:103]
 v_mfma_f32_16x16x32_bf16 v[104:107], a[212:215], v[40:43], v[104:107]
 buffer_load_dwordx4 v[40:43], v1, s[20:23], s46 offen offset:2048 sc1
 v_mfma_f32_16x16x32_bf16 v[108:111], a[204:207], v[44:47], v[108:111]
 v_mfma_f32_16x16x32_bf16 v[112:115], a[208:211], v[44:47], v[112:115]
 v_mfma_f32_16x16x32_bf16 v[116:119], a[212:215], v[44:47], v[116:119]
 buffer_load_dwordx4 v[44:47], v1, s[20:23], s46 offen offset:3072 sc1
 s_waitcnt vmcnt(14)
 v_mfma_f32_16x16x32_bf16 v[96:99], a[216:219], v[48:51], v[96:99]
 v_mfma_f32_16x16x32_bf16 v[100:103], a[220:223], v[48:51], v[100:103]
 v_mfma_f32_16x16x32_bf16 v[104:107], a[224:227], v[48:51], v[104:107]
 buffer_load_dwordx4 v[48:51], v1, s[20:23], s47 offen offset:0 sc1
 v_mfma_f32_16x16x32_bf16 v[108:111], a[216:219], v[52:55], v[108:111]
 v_mfma_f32_16x16x32_bf16 v[112:115], a[220:223], v[52:55], v[112:115]
 v_mfma_f32_16x16x32_bf16 v[116:119], a[224:227], v[52:55], v[116:119]
 buffer_load_dwordx4 v[52:55], v1, s[20:23], s47 offen offset:1024 sc1
 s_waitcnt vmcnt(14)
 v_mfma_f32_16x16x32_bf16 v[96:99], a[228:231], v[56:59], v[96:99]
 v_mfma_f32_16x16x32_bf16 v[100:103], a[232:235], v[56:59], v[100:103]
 v_mfma_f32_16x16x32_bf16 v[104:107], a[236:239], v[56:59], v[104:107]
 buffer_load_dwordx4 v[56:59], v1, s[20:23], s47 offen offset:2048 sc1
 v_mfma_f32_16x16x32_bf16 v[108:111], a[228:231], v[60:63], v[108:111]
 v_mfma_f32_16x16x32_bf16 v[112:115], a[232:235], v[60:63], v[112:115]
 v_mfma_f32_16x16x32_bf16 v[116:119], a[236:239], v[60:63], v[116:119]
 buffer_load_dwordx4 v[60:63], v1, s[20:23], s47 offen offset:3072 sc1
 s_waitcnt vmcnt(14)
 v_mfma_f32_16x16x32_bf16 v[96:99], a[240:243], v[64:67], v[96:99]
 s_add_u32 s52, s44, 7
 s_and_b32 s52, s52, 7
 s_lshl_b32 s52, s52, 13
 v_mfma_f32_16x16x32_bf16 v[100:103], a[244:247], v[64:67], v[100:103]
 s_add_u32 s46, s48, s52
 s_add_u32 s47, s46, 4096
 v_mfma_f32_16x16x32_bf16 v[104:107], a[248:251], v[64:67], v[104:107]
 buffer_load_dwordx4 v[64:67], v1, s[20:23], s46 offen offset:0 sc1
 v_mfma_f32_16x16x32_bf16 v[108:111], a[240:243], v[68:71], v[108:111]
 v_mfma_f32_16x16x32_bf16 v[112:115], a[244:247], v[68:71], v[112:115]
 v_mfma_f32_16x16x32_bf16 v[116:119], a[248:251], v[68:71], v[116:119]
 buffer_load_dwordx4 v[68:71], v1, s[20:23], s46 offen offset:1024 sc1
 s_waitcnt vmcnt(14)
 v_mfma_f32_16x16x32_bf16 v[96:99], a[252:255], v[72:75], v[96:99]
 v_mfma_f32_16x16x32_bf16 v[100:103], v[128:131], v[72:75], v[100:103]
 v_mfma_f32_16x16x32_bf16 v[104:107], v[132:135], v[72:75], v[104:107]
 buffer_load_dwordx4 v[72:75], v1, s[20:23], s46 offen offset:2048 sc1
 v_mfma_f32_16x16x32_bf16 v[108:111], a[252:255], v[76:79], v[108:111]
 v_mfma_f32_16x16x32_bf16 v[112:115], v[128:131], v[76:79], v[112:115]
 v_mfma_f32_16x16x32_bf16 v[116:119], v[132:135], v[76:79], v[116:119]
 buffer_load_dwordx4 v[76:79], v1, s[20:23], s46 offen offset:3072 sc1
 s_waitcnt vmcnt(14)
 v_mfma_f32_16x16x32_bf16 v[96:99], v[136:139], v[80:83], v[96:99]
 v_cmp_gt_u32 vcc, s51, v2
 v_mfma_f32_16x16x32_bf16 v[100:103], v[140:143], v[80:83], v[100:103]
 v_mfma_f32_16x16x32_bf16 v[104:107], v[144:147], v[80:83], v[104:107]
 buffer_load_dwordx4 v[80:83], v1, s[20:23], s47 offen offset:0 sc1
 v_mfma_f32_16x16x32_bf16 v[108:111], v[136:139], v[84:87], v[108:111]
 v_mfma_f32_16x16x32_bf16 v[112:115], v[140:143], v[84:87], v[112:115]
 v_mfma_f32_16x16x32_bf16 v[116:119], v[144:147], v[84:87], v[116:119]
 buffer_load_dwordx4 v[84:87], v1, s[20:23], s47 offen offset:1024 sc1
 s_waitcnt vmcnt(14)
 v_mfma_f32_16x16x32_bf16 v[96:99], v[148:151], v[88:91], v[96:99]
 s_cbranch_vccnz Losw_32
Loswk_33:
 s_lshl_b32 s48, s42, 18
 v_mfma_f32_16x16x32_bf16 v[100:103], v[152:155], v[88:91], v[100:103]
 s_add_u32 s48, s48, s36
 v_mfma_f32_16x16x32_bf16 v[104:107], v[156:159], v[88:91], v[104:107]
 buffer_load_dwordx4 v[88:91], v1, s[20:23], s47 offen offset:2048 sc1
 v_mfma_f32_16x16x32_bf16 v[108:111], v[148:151], v[92:95], v[108:111]
 v_mfma_f32_16x16x32_bf16 v[112:115], v[152:155], v[92:95], v[112:115]
 v_mfma_f32_16x16x32_bf16 v[116:119], v[156:159], v[92:95], v[116:119]
 buffer_load_dwordx4 v[92:95], v1, s[20:23], s47 offen offset:3072 sc1
 s_waitcnt vmcnt(14)
 v_mfma_f32_16x16x32_bf16 v[96:99], v[160:163], v[32:35], v[96:99]
 s_add_u32 s52, s44, 0
 s_and_b32 s52, s52, 7
 s_lshl_b32 s52, s52, 13
 v_mfma_f32_16x16x32_bf16 v[100:103], v[164:167], v[32:35], v[100:103]
 s_add_u32 s46, s48, s52
 s_add_u32 s47, s46, 4096
 v_mfma_f32_16x16x32_bf16 v[104:107], v[168:171], v[32:35], v[104:107]
 buffer_load_dwordx4 v[32:35], v1, s[20:23], s46 offen offset:0 sc1
 v_mfma_f32_16x16x32_bf16 v[108:111], v[160:163], v[36:39], v[108:111]
 v_mfma_f32_16x16x32_bf16 v[112:115], v[164:167], v[36:39], v[112:115]
 v_mfma_f32_16x16x32_bf16 v[116:119], v[168:171], v[36:39], v[116:119]
 buffer_load_dwordx4 v[36:39], v1, s[20:23], s46 offen offset:1024 sc1
 s_waitcnt vmcnt(14)
 v_mfma_f32_16x16x32_bf16 v[96:99], v[172:175], v[40:43], v[96:99]
 v_mfma_f32_16x16x32_bf16 v[100:103], v[176:179], v[40:43], v[100:103]
 v_mfma_f32_16x16x32_bf16 v[104:107], v[180:183], v[40:43], v[104:107]
 buffer_load_dwordx4 v[40:43], v1, s[20:23], s46 offen offset:2048 sc1
 v_mfma_f32_16x16x32_bf16 v[108:111], v[172:175], v[44:47], v[108:111]
 v_mfma_f32_16x16x32_bf16 v[112:115], v[176:179], v[44:47], v[112:115]
 v_mfma_f32_16x16x32_bf16 v[116:119], v[180:183], v[44:47], v[116:119]
 buffer_load_dwordx4 v[44:47], v1, s[20:23], s46 offen offset:3072 sc1
 s_waitcnt vmcnt(14)
 v_mfma_f32_16x16x32_bf16 v[96:99], v[184:187], v[48:51], v[96:99]
 v_mfma_f32_16x16x32_bf16 v[100:103], v[188:191], v[48:51], v[100:103]
 v_mfma_f32_16x16x32_bf16 v[104:107], v[192:195], v[48:51], v[104:107]
 buffer_load_dwordx4 v[48:51], v1, s[20:23], s47 offen offset:0 sc1
 v_mfma_f32_16x16x32_bf16 v[108:111], v[184:187], v[52:55], v[108:111]
 v_mfma_f32_16x16x32_bf16 v[112:115], v[188:191], v[52:55], v[112:115]
 v_mfma_f32_16x16x32_bf16 v[116:119], v[192:195], v[52:55], v[116:119]
 buffer_load_dwordx4 v[52:55], v1, s[20:23], s47 offen offset:1024 sc1
 s_waitcnt vmcnt(14)
 v_mfma_f32_16x16x32_bf16 v[96:99], v[196:199], v[56:59], v[96:99]
 v_mfma_f32_16x16x32_bf16 v[100:103], v[200:203], v[56:59], v[100:103]
 v_mfma_f32_16x16x32_bf16 v[104:107], v[204:207], v[56:59], v[104:107]
 buffer_load_dwordx4 v[56:59], v1, s[20:23], s47 offen offset:2048 sc1
 v_mfma_f32_16x16x32_bf16 v[108:111], v[196:199], v[60:63], v[108:111]
 v_mfma_f32_16x16x32_bf16 v[112:115], v[200:203], v[60:63], v[112:115]
 v_mfma_f32_16x16x32_bf16 v[116:119], v[204:207], v[60:63], v[116:119]
 buffer_load_dwordx4 v[60:63], v1, s[20:23], s47 offen offset:3072 sc1
 s_waitcnt vmcnt(14)
 v_mfma_f32_16x16x32_bf16 v[96:99], v[208:211], v[64:67], v[96:99]
 s_add_u32 s52, s44, 1
 s_and_b32 s52, s52, 7
 s_lshl_b32 s52, s52, 13
 v_mfma_f32_16x16x32_bf16 v[100:103], v[212:215], v[64:67], v[100:103]
 s_add_u32 s46, s48, s52
 s_add_u32 s47, s46, 4096
 v_mfma_f32_16x16x32_bf16 v[104:107], v[216:219], v[64:67], v[104:107]
 buffer_load_dwordx4 v[64:67], v1, s[20:23], s46 offen offset:0 sc1
 v_mfma_f32_16x16x32_bf16 v[108:111], v[208:211], v[68:71], v[108:111]
 v_mfma_f32_16x16x32_bf16 v[112:115], v[212:215], v[68:71], v[112:115]
 v_mfma_f32_16x16x32_bf16 v[116:119], v[216:219], v[68:71], v[116:119]
 buffer_load_dwordx4 v[68:71], v1, s[20:23], s46 offen offset:1024 sc1
 s_waitcnt vmcnt(14)
 v_mfma_f32_16x16x32_bf16 v[96:99], v[220:223], v[72:75], v[96:99]
 v_mfma_f32_16x16x32_bf16 v[100:103], v[224:227], v[72:75], v[100:103]
 v_mfma_f32_16x16x32_bf16 v[104:107], v[228:231], v[72:75], v[104:107]
 buffer_load_dwordx4 v[72:75], v1, s[20:23], s46 offen offset:2048 sc1
 v_mfma_f32_16x16x32_bf16 v[108:111], v[220:223], v[76:79], v[108:111]
 v_mfma_f32_16x16x32_bf16 v[112:115], v[224:227], v[76:79], v[112:115]
 v_mfma_f32_16x16x32_bf16 v[116:119], v[228:231], v[76:79], v[116:119]
 buffer_load_dwordx4 v[76:79], v1, s[20:23], s46 offen offset:3072 sc1
 s_waitcnt vmcnt(14)
 v_mfma_f32_16x16x32_bf16 v[96:99], v[232:235], v[80:83], v[96:99]
 v_mfma_f32_16x16x32_bf16 v[100:103], v[236:239], v[80:83], v[100:103]
 v_mfma_f32_16x16x32_bf16 v[104:107], v[240:243], v[80:83], v[104:107]
 buffer_load_dwordx4 v[80:83], v1, s[20:23], s47 offen offset:0 sc1
 v_mfma_f32_16x16x32_bf16 v[108:111], v[232:235], v[84:87], v[108:111]
 v_mfma_f32_16x16x32_bf16 v[112:115], v[236:239], v[84:87], v[112:115]
 v_mfma_f32_16x16x32_bf16 v[116:119], v[240:243], v[84:87], v[116:119]
 buffer_load_dwordx4 v[84:87], v1, s[20:23], s47 offen offset:1024 sc1
 s_waitcnt vmcnt(14)
 v_mfma_f32_16x16x32_bf16 v[96:99], v[244:247], v[88:91], v[96:99]
 v_mfma_f32_16x16x32_bf16 v[100:103], v[248:251], v[88:91], v[100:103]
 v_mfma_f32_16x16x32_bf16 v[104:107], v[252:255], v[88:91], v[104:107]
 buffer_load_dwordx4 v[88:91], v1, s[20:23], s47 offen offset:2048 sc1
 v_mfma_f32_16x16x32_bf16 v[108:111], v[244:247], v[92:95], v[108:111]
 v_mfma_f32_16x16x32_bf16 v[112:115], v[248:251], v[92:95], v[112:115]
 v_mfma_f32_16x16x32_bf16 v[116:119], v[252:255], v[92:95], v[116:119]
 buffer_load_dwordx4 v[92:95], v1, s[20:23], s47 offen offset:3072 sc1
 s_cmp_eq_u32 s4, 3
 s_nop 2
 ds_write_b128 v5, v[96:99] offset:0
 ds_write_b128 v5, v[100:103] offset:1024
 ds_write_b128 v5, v[104:107] offset:2048
 ds_write_b128 v5, v[108:111] offset:3072
 ds_write_b128 v5, v[112:115] offset:4096
 ds_write_b128 v5, v[116:119] offset:5120
 v_xor_b32 v5, 0x8000, v5
 s_waitcnt lgkmcnt(0)
 s_barrier
 s_cbranch_scc1 Loss_35
 ds_read_b128 v[96:99], v4 offset:0
 ds_read_b128 v[100:103], v4 offset:256
 ds_read_b128 v[104:107], v4 offset:6144
 ds_read_b128 v[108:111], v4 offset:6400
 ds_read_b128 v[112:115], v4 offset:12288
 ds_read_b128 v[116:119], v4 offset:12544
 ds_read_b128 v[120:123], v4 offset:18432
 ds_read_b128 v[124:127], v4 offset:18688
 v_xor_b32 v4, 0x8000, v4
 s_waitcnt lgkmcnt(4)
 v_pk_add_f32 v[96:97], v[96:97], v[104:105]
 v_pk_add_f32 v[98:99], v[98:99], v[106:107]
 v_pk_add_f32 v[100:101], v[100:101], v[108:109]
 v_pk_add_f32 v[102:103], v[102:103], v[110:111]
 s_waitcnt lgkmcnt(2)
 v_pk_add_f32 v[96:97], v[96:97], v[112:113]
 v_pk_add_f32 v[98:99], v[98:99], v[114:115]
 v_pk_add_f32 v[100:101], v[100:101], v[116:117]
 v_pk_add_f32 v[102:103], v[102:103], v[118:119]
 s_waitcnt lgkmcnt(0)
 v_pk_add_f32 v[96:97], v[96:97], v[120:121]
 v_pk_add_f32 v[98:99], v[98:99], v[122:123]
 v_pk_add_f32 v[100:101], v[100:101], v[124:125]
 v_pk_add_f32 v[102:103], v[102:103], v[126:127]
 v_cvt_pk_bf16_f32 v8, v96, v97
 v_cvt_pk_bf16_f32 v9, v98, v99
 v_cvt_pk_bf16_f32 v10, v100, v101
 v_cvt_pk_bf16_f32 v11, v102, v103
 buffer_store_dwordx4 v[8:11], v6, s[24:27], s54 offen
Loss_35:
 s_cmp_lt_u32 s43, s35
 s_cbranch_scc1 Losl_31
 s_branch Lose_34
Losw_32:
 buffer_load_dword v2, v3, s[20:23], s53 offen sc1
 s_waitcnt vmcnt(0)
 v_cmp_gt_u32 vcc, s51, v2
 s_cbranch_vccz Loswk_33
 s_sleep 1
 s_sub_u32 s50, s50, 1
 s_cbranch_scc0 Losw_32
 s_endpgm
Lose_34:
 s_waitcnt vmcnt(0)
 s_branch Lfin
Lchain:
 s_load_dwordx2 s[8:9], s[0:1], 64
 s_mov_b32 s10, 0x480000
 s_mov_b32 s11, 0x20000
 s_load_dwordx2 s[12:13], s[0:1], 72
 s_mov_b32 s14, 0x480000
 s_mov_b32 s15, 0x20000
 s_load_dwordx2 s[16:17], s[0:1], 80
 s_mov_b32 s18, 0x480000
 s_mov_b32 s19, 0x20000
 s_load_dwordx2 s[24:25], s[0:1], 88
 s_mov_b32 s26, 0x480000
 s_mov_b32 s27, 0x20000
 s_load_dwordx2 s[28:29], s[0:1], 112
 s_mov_b32 s30, 0x100
 s_mov_b32 s31, 0x20000
 v_and_b32 v20, 63, v0
 v_lshlrev_b32 v3, 4, v20
 v_mov_b32 v7, 0
 s_mov_b32 s48, 0xcccccccc
 s_mov_b32 s49, 0xcccccccc
 v_mov_b32 v21, 0x44444444
 v_mov_b32 v22, 0xeeeeeeee
 v_cndmask_b32 v5, v21, v22, s[48:49]
 s_mul_i32 s47, s4, 544
 v_lshrrev_b32 v21, 4, v20
 v_lshlrev_b32 v21, 7, v21
 v_and_b32 v22, 32, v20
 v_add3_u32 v21, v21, v22, s47
 v_and_b32 v22, 15, v20
 v_lshl_add_u32 v8, v22, 3, v21
 v_lshrrev_b32 v21, 5, v20
 v_mul_u32_u24 v21, 544, v21
 v_and_b32 v22, 3, v20
 v_lshl_add_u32 v21, v22, 7, v21
 v_and_b32 v22, 2, v20
 v_lshl_add_u32 v21, v22, 4, v21
 v_and_b32 v22, 16, v20
 v_lshl_add_u32 v21, v22, 2, v21
 v_and_b32 v22, 12, v20
 v_lshl_add_u32 v9, v22, 1, v21
 v_lshrrev_b32 v21, 4, v0
 v_lshlrev_b32 v21, 7, v21
 v_and_b32 v22, 14, v20
 v_lshl_add_u32 v21, v22, 2, v21
 v_and_b32 v22, 1, v20
 v_lshl_add_u32 v10, v22, 1, v21
 v_and_b32 v21, 12, v20
 v_lshlrev_b32 v21, 5, v21
 v_lshl_add_u32 v21, v22, 6, v21
 v_and_b32 v22, 48, v20
 v_add_u32 v11, v21, v22
 s_mov_b32 s55, 0x3e0293ee
 s_mov_b32 s54, 0x200000
 s_lshl_b32 s47, s6, 6
 s_add_u32 s60, s47, 0x100000
 s_add_u32 s61, s47, 0x101000
 s_add_u32 s62, s47, 0x102000
 s_lshl_b32 s47, s6, 7
 s_add_u32 s56, s47, 0x0
 s_add_u32 s57, s47, 0x1000
 s_mul_i32 s47, s6, 10496
 s_add_u32 s40, s47, 0x102000
 s_lshl_b32 s58, s4, 11
 s_add_u32 s47, s47, s58
 s_add_u32 s39, s47, 0x100000
 s_lshl_b32 s42, s4, 11
 s_add_u32 s41, s42, 0x1e0000
 s_mov_b32 s43, 0x1e2000
 s_lshr_b32 s69, s4, 1
 s_mul_i32 s69, s69, 1088
 s_and_b32 s47, s4, 1
 s_lshl_b32 s47, s47, 5
 s_add_u32 s69, s69, s47
 s_lshl_b32 s47, s6, 5
 s_add_u32 s65, s47, 0x1e2000
 s_add_u32 s66, s47, 0x162000
 s_lshr_b32 s47, s6, 3
 s_lshl_b32 s47, s47, 9
 s_and_b32 s58, s6, 1
 s_lshl_b32 s58, s58, 8
 s_add_u32 s47, s47, s58
 s_and_b32 s58, s6, 6
 s_lshl_b32 s58, s58, 5
 s_add_u32 s47, s47, s58
 s_lshl_b32 s58, s4, 11
 s_add_u32 s47, s47, s58
 s_add_u32 s44, s47, 0x1e0000
 s_add_u32 s45, s47, 0x160000
 s_lshl_b32 s47, s6, 14
 s_add_u32 s37, s47, 0x3000000
 s_add_u32 s67, s37, s58
 s_add_u32 s59, s67, 8192
 s_lshl_b32 s47, s6, 12
 s_add_u32 s38, s47, 0x3d0000
 s_mov_b32 s36, 0
 s_mov_b32 s46, 0
 s_waitcnt lgkmcnt(0)
 v_mov_b32 v20, 0
 v_mov_b32 v21, 0
 v_mov_b32 v22, 0
 v_mov_b32 v23, 0
 v_mov_b32 v27, -1
 v_bfe_u32 v24, v3, 8, 1
 v_bfe_u32 v25, v3, 9, 1
 v_lshl_or_b32 v24, v24, 1, v25
 v_bfe_u32 v25, v3, 5, 1
 v_lshl_or_b32 v24, v24, 1, v25
 v_and_b32 v25, 0xd0, v3
 v_lshlrev_b32 v25, 24, v25
 v_lshl_or_b32 v24, v24, 2, v25
 v_bfe_u32 v26, v3, 8, 2
 v_bfe_u32 v25, v3, 2, 4
 v_lshl_or_b32 v26, v26, 4, v25
 v_and_b32 v25, 0xc0, v3
 v_lshl_or_b32 v26, v25, 24, v26
 buffer_store_dwordx4 v[20:23], v3, s[20:23], s39 offen offset:0 sc1
 buffer_store_dwordx4 v[20:23], v3, s[20:23], s39 offen offset:1024 sc1
 buffer_store_dwordx4 v[20:23], v3, s[20:23], s40 offen offset:0 sc1
 buffer_store_dwordx4 v[20:23], v3, s[20:23], s40 offen offset:1024 sc1
 buffer_store_dword v27, v26, s[20:23], s44 offen sc1
 buffer_store_dword v27, v26, s[20:23], s45 offen sc1
 buffer_store_dword v27, v24, s[20:23], s65 offen sc1
 buffer_store_dword v27, v24, s[20:23], s66 offen sc1
 v_and_b32 v30, 63, v0
 v_bfe_u32 v31, v30, 1, 2
 v_lshrrev_b32 v32, 5, v30
 v_xor_b32 v31, v31, v32
 v_lshlrev_b32 v31, 5, v31
 v_and_b32 v32, 1, v30
 v_lshl_add_u32 v31, v32, 4, v31
 v_xor_b32 v33, 64, v31
 v_lshrrev_b32 v32, 3, v30
 s_lshl_b32 s47, s4, 4
 v_and_b32 v34, 3, v32
 v_lshrrev_b32 v35, 2, v32
 v_lshl_add_u32 v34, v34, 1, v35
 v_add_u32 v34, s47, v34
 v_lshl_add_u32 v12, v34, 13, v31
 v_add_u32 v34, 8, v34
 v_lshl_add_u32 v13, v34, 13, v33
 v_and_b32 v34, 1, v32
 v_lshlrev_b32 v34, 6, v34
 v_and_b32 v35, 6, v32
 s_lshl_b32 s47, s4, 3
 v_add3_u32 v34, v34, v35, s47
 v_lshl_add_u32 v56, v34, 13, v31
 v_add_u32 v34, 1, v34
 v_lshl_add_u32 v57, v34, 13, v33
 v_lshrrev_b32 v34, 3, v0
 v_mul_u32_u24 v34, 1152, v34
 v_add_u32 v14, v34, v31
 v_add_u32 v34, 73728, v34
 v_add_u32 v15, v34, v33
 v_bfe_u32 v31, v30, 4, 1
 v_bfe_u32 v32, v30, 3, 1
 v_lshl_add_u32 v33, v32, 1, v31
 v_xor_b32 v33, s4, v33
 v_lshlrev_b32 v33, 5, v33
 v_lshl_add_u32 v33, v31, 9, v33
 v_lshl_add_u32 v33, v32, 10, v33
 v_bfe_u32 v31, v30, 2, 1
 v_lshl_add_u32 v33, v31, 7, v33
 v_lshrrev_b32 v31, 5, v30
 v_lshl_add_u32 v33, v31, 11, v33
 v_and_b32 v31, 3, v30
 v_lshl_add_u32 v16, v31, 3, v33
 v_add_u32 v17, 0x10000, v16
 v_add_u32 v18, 0x20000, v16
 v_lshlrev_b32 v60, 4, v0
 v_add_u32 v61, 0x10000, v60
 v_add_u32 v62, 0x20000, v60
 s_lshl_b32 s70, s6, 8
 s_mul_i32 s71, s6, 147456
 s_lshl_b32 s72, s4, 11
 s_add_u32 m0, s72, 24576
 s_add_u32 s47, s70, 0
 buffer_load_dwordx4 v56, s[8:11], s47 offen nt lds
 s_add_u32 m0, s72, 25600
 s_nop 0
 buffer_load_dwordx4 v57, s[8:11], s47 offen nt lds
 s_add_u32 m0, s72, 32768
 s_add_u32 s47, s70, 128
 buffer_load_dwordx4 v56, s[8:11], s47 offen nt lds
 s_add_u32 m0, s72, 33792
 s_nop 0
 buffer_load_dwordx4 v57, s[8:11], s47 offen nt lds
 s_add_u32 m0, s72, 40960
 s_add_u32 s47, s70, 0
 buffer_load_dwordx4 v56, s[12:15], s47 offen nt lds
 s_add_u32 m0, s72, 41984
 s_nop 0
 buffer_load_dwordx4 v57, s[12:15], s47 offen nt lds
 s_add_u32 m0, s72, 49152
 s_add_u32 s47, s70, 0
 buffer_load_dwordx4 v56, s[16:19], s47 offen nt lds
 s_add_u32 m0, s72, 50176
 s_nop 0
 buffer_load_dwordx4 v57, s[16:19], s47 offen nt lds
 s_add_u32 m0, s72, 57344
 s_add_u32 s47, s70, 128
 buffer_load_dwordx4 v56, s[16:19], s47 offen nt lds
 s_add_u32 m0, s72, 58368
 s_nop 0
 buffer_load_dwordx4 v57, s[16:19], s47 offen nt lds
 s_add_u32 m0, s72, 65536
 s_add_u32 s47, s70, 262144
 buffer_load_dwordx4 v56, s[8:11], s47 offen nt lds
 s_add_u32 m0, s72, 66560
 s_nop 0
 buffer_load_dwordx4 v57, s[8:11], s47 offen nt lds
 s_add_u32 m0, s72, 73728
 s_add_u32 s47, s70, 262272
 buffer_load_dwordx4 v56, s[8:11], s47 offen nt lds
 s_add_u32 m0, s72, 74752
 s_nop 0
 buffer_load_dwordx4 v57, s[8:11], s47 offen nt lds
 s_add_u32 m0, s72, 81920
 s_add_u32 s47, s70, 262144
 buffer_load_dwordx4 v56, s[12:15], s47 offen nt lds
 s_add_u32 m0, s72, 82944
 s_nop 0
 buffer_load_dwordx4 v57, s[12:15], s47 offen nt lds
 s_waitcnt vmcnt(14)
 s_waitcnt lgkmcnt(0)
 s_barrier
 s_getreg_b32 s73, hwreg(HW_REG_XCC_ID, 0, 3)
 s_lshl_b32 s73, s73, 3
 s_lshl_b64 s[74:75], 1, s73
 v_mov_b32 v64, s74
 v_mov_b32 v65, s75
 v_mov_b32 v66, 0x7ff00000
 v_cmp_eq_u32 vcc, 0, v0
 s_nop 1
 v_cndmask_b32 v66, v66, v7, vcc
 buffer_atomic_add_x2 v[64:65], v66, s[28:31], 0 offen offset:8
 s_add_u32 m0, s72, 90112
 s_add_u32 s47, s70, 262144
 buffer_load_dwordx4 v56, s[16:19], s47 offen nt lds
 s_add_u32 m0, s72, 91136
 s_nop 0
 buffer_load_dwordx4 v57, s[16:19], s47 offen nt lds
 ds_read_b64_tr_b16 v[72:73], v16 offset:24576
 ds_read_b64_tr_b16 v[74:75], v16 offset:24832
 ds_read_b64_tr_b16 v[76:77], v16 offset:28672
 ds_read_b64_tr_b16 v[78:79], v16 offset:28928
 s_waitcnt vmcnt(15)
 s_waitcnt lgkmcnt(0)
 s_barrier
 s_add_u32 m0, s72, 98304
 s_add_u32 s47, s70, 262272
 buffer_load_dwordx4 v56, s[16:19], s47 offen nt lds
 s_add_u32 m0, s72, 99328
 s_nop 0
 buffer_load_dwordx4 v57, s[16:19], s47 offen nt lds
 ds_read_b64_tr_b16 v[80:81], v16 offset:32768
 ds_read_b64_tr_b16 v[82:83], v16 offset:33024
 ds_read_b64_tr_b16 v[84:85], v16 offset:36864
 ds_read_b64_tr_b16 v[86:87], v16 offset:37120
 s_waitcnt vmcnt(15)
 s_waitcnt lgkmcnt(0)
 s_barrier
 s_add_u32 m0, s72, 106496
 s_add_u32 s47, s70, 1048576
 buffer_load_dwordx4 v56, s[8:11], s47 offen nt lds
 s_add_u32 m0, s72, 107520
 s_nop 0
 buffer_load_dwordx4 v57, s[8:11], s47 offen nt lds
 ds_read_b64_tr_b16 v[88:89], v16 offset:40960
 ds_read_b64_tr_b16 v[90:91], v16 offset:41216
 ds_read_b64_tr_b16 v[92:93], v16 offset:45056
 ds_read_b64_tr_b16 v[94:95], v16 offset:45312
 s_waitcnt vmcnt(15)
 s_waitcnt lgkmcnt(0)
 s_barrier
 s_add_u32 m0, s72, 114688
 s_add_u32 s47, s70, 1048704
 buffer_load_dwordx4 v56, s[8:11], s47 offen nt lds
 s_add_u32 m0, s72, 115712
 s_nop 0
 buffer_load_dwordx4 v57, s[8:11], s47 offen nt lds
 ds_read_b64_tr_b16 v[96:97], v16 offset:49152
 ds_read_b64_tr_b16 v[98:99], v16 offset:49408
 ds_read_b64_tr_b16 v[100:101], v16 offset:53248
 ds_read_b64_tr_b16 v[102:103], v16 offset:53504
 s_waitcnt vmcnt(15)
 s_waitcnt lgkmcnt(0)
 s_barrier
 s_add_u32 m0, s72, 122880
 s_add_u32 s47, s70, 1048576
 buffer_load_dwordx4 v56, s[12:15], s47 offen nt lds
 s_add_u32 m0, s72, 123904
 s_nop 0
 buffer_load_dwordx4 v57, s[12:15], s47 offen nt lds
 ds_read_b64_tr_b16 v[104:105], v16 offset:57344
 ds_read_b64_tr_b16 v[106:107], v16 offset:57600
 ds_read_b64_tr_b16 v[108:109], v16 offset:61440
 ds_read_b64_tr_b16 v[110:111], v16 offset:61696
 s_waitcnt vmcnt(15)
 s_waitcnt lgkmcnt(0)
 s_barrier
 s_add_u32 m0, s72, 131072
 s_add_u32 s47, s70, 1048576
 buffer_load_dwordx4 v56, s[16:19], s47 offen nt lds
 s_add_u32 m0, s72, 132096
 s_nop 0
 buffer_load_dwordx4 v57, s[16:19], s47 offen nt lds
 ds_read_b64_tr_b16 v[112:113], v17 offset:0
 ds_read_b64_tr_b16 v[114:115], v17 offset:256
 ds_read_b64_tr_b16 v[116:117], v17 offset:4096
 ds_read_b64_tr_b16 v[118:119], v17 offset:4352
 s_waitcnt vmcnt(15)
 s_waitcnt lgkmcnt(0)
 s_barrier
 s_add_u32 m0, s72, 139264
 s_add_u32 s47, s70, 1048704
 buffer_load_dwordx4 v56, s[16:19], s47 offen nt lds
 s_add_u32 m0, s72, 140288
 s_nop 0
 buffer_load_dwordx4 v57, s[16:19], s47 offen nt lds
 ds_read_b64_tr_b16 v[120:121], v17 offset:8192
 ds_read_b64_tr_b16 v[122:123], v17 offset:8448
 ds_read_b64_tr_b16 v[124:125], v17 offset:12288
 ds_read_b64_tr_b16 v[126:127], v17 offset:12544
 s_waitcnt vmcnt(15)
 s_waitcnt lgkmcnt(0)
 s_barrier
 s_add_u32 m0, s72, 147456
 s_add_u32 s47, s70, 1310720
 buffer_load_dwordx4 v56, s[8:11], s47 offen nt lds
 s_add_u32 m0, s72, 148480
 s_nop 0
 buffer_load_dwordx4 v57, s[8:11], s47 offen nt lds
 ds_read_b64_tr_b16 v[128:129], v17 offset:16384
 ds_read_b64_tr_b16 v[130:131], v17 offset:16640
 ds_read_b64_tr_b16 v[132:133], v17 offset:20480
 ds_read_b64_tr_b16 v[134:135], v17 offset:20736
 s_waitcnt vmcnt(14)
 s_waitcnt lgkmcnt(0)
 s_barrier
 s_add_u32 m0, s72, 155648
 s_add_u32 s47, s70, 1310848
 buffer_load_dwordx4 v56, s[8:11], s47 offen nt lds
 s_add_u32 m0, s72, 156672
 s_nop 0
 buffer_load_dwordx4 v57, s[8:11], s47 offen nt lds
 ds_read_b64_tr_b16 v[136:137], v17 offset:24576
 ds_read_b64_tr_b16 v[138:139], v17 offset:24832
 ds_read_b64_tr_b16 v[140:141], v17 offset:28672
 ds_read_b64_tr_b16 v[142:143], v17 offset:28928
 s_waitcnt vmcnt(14)
 s_waitcnt lgkmcnt(0)
 s_barrier
 s_add_u32 m0, s72, 24576
 s_add_u32 s47, s70, 1310720
 buffer_load_dwordx4 v56, s[12:15], s47 offen nt lds
 s_add_u32 m0, s72, 25600
 s_nop 0
 buffer_load_dwordx4 v57, s[12:15], s47 offen nt lds
 ds_read_b64_tr_b16 v[144:145], v17 offset:32768
 ds_read_b64_tr_b16 v[146:147], v17 offset:33024
 ds_read_b64_tr_b16 v[148:149], v17 offset:36864
 ds_read_b64_tr_b16 v[150:151], v17 offset:37120
 s_waitcnt vmcnt(14)
 s_waitcnt lgkmcnt(0)
 s_barrier
 s_add_u32 m0, s72, 32768
 s_add_u32 s47, s70, 1310720
 buffer_load_dwordx4 v56, s[16:19], s47 offen nt lds
 s_add_u32 m0, s72, 33792
 s_nop 0
 buffer_load_dwordx4 v57, s[16:19], s47 offen nt lds
 ds_read_b64_tr_b16 v[152:153], v17 offset:40960
 ds_read_b64_tr_b16 v[154:155], v17 offset:41216
 ds_read_b64_tr_b16 v[156:157], v17 offset:45056
 ds_read_b64_tr_b16 v[158:159], v17 offset:45312
 s_waitcnt vmcnt(14)
 s_waitcnt lgkmcnt(0)
 s_barrier
 s_add_u32 m0, s72, 40960
 s_add_u32 s47, s70, 1310848
 buffer_load_dwordx4 v56, s[16:19], s47 offen nt lds
 s_add_u32 m0, s72, 41984
 s_nop 0
 buffer_load_dwordx4 v57, s[16:19], s47 offen nt lds
 ds_read_b64_tr_b16 v[160:161], v17 offset:49152
 ds_read_b64_tr_b16 v[162:163], v17 offset:49408
 ds_read_b64_tr_b16 v[164:165], v17 offset:53248
 ds_read_b64_tr_b16 v[166:167], v17 offset:53504
 s_waitcnt vmcnt(14)
 s_waitcnt lgkmcnt(0)
 s_barrier
 s_add_u32 m0, s72, 49152
 s_add_u32 s47, s70, 2097152
 buffer_load_dwordx4 v56, s[8:11], s47 offen nt lds
 s_add_u32 m0, s72, 50176
 s_nop 0
 buffer_load_dwordx4 v57, s[8:11], s47 offen nt lds
 ds_read_b64_tr_b16 v[168:169], v17 offset:57344
 ds_read_b64_tr_b16 v[170:171], v17 offset:57600
 ds_read_b64_tr_b16 v[172:173], v17 offset:61440
 ds_read_b64_tr_b16 v[174:175], v17 offset:61696
 s_waitcnt vmcnt(14)
 s_waitcnt lgkmcnt(0)
 s_barrier
 s_add_u32 m0, s72, 57344
 s_add_u32 s47, s70, 2097280
 buffer_load_dwordx4 v56, s[8:11], s47 offen nt lds
 s_add_u32 m0, s72, 58368
 s_nop 0
 buffer_load_dwordx4 v57, s[8:11], s47 offen nt lds
 ds_read_b64_tr_b16 v[176:177], v18 offset:0
 ds_read_b64_tr_b16 v[178:179], v18 offset:256
 ds_read_b64_tr_b16 v[180:181], v18 offset:4096
 ds_read_b64_tr_b16 v[182:183], v18 offset:4352
 s_waitcnt vmcnt(14)
 s_waitcnt lgkmcnt(0)
 s_barrier
 s_add_u32 m0, s72, 65536
 s_add_u32 s47, s70, 2097152
 buffer_load_dwordx4 v56, s[12:15], s47 offen nt lds
 s_add_u32 m0, s72, 66560
 s_nop 0
 buffer_load_dwordx4 v57, s[12:15], s47 offen nt lds
 ds_read_b64_tr_b16 v[184:185], v18 offset:8192
 ds_read_b64_tr_b16 v[186:187], v18 offset:8448
 ds_read_b64_tr_b16 v[188:189], v18 offset:12288
 ds_read_b64_tr_b16 v[190:191], v18 offset:12544
 s_waitcnt vmcnt(14)
 s_waitcnt lgkmcnt(0)
 s_barrier
 s_add_u32 m0, s72, 73728
 s_add_u32 s47, s70, 2097152
 buffer_load_dwordx4 v56, s[16:19], s47 offen nt lds
 s_add_u32 m0, s72, 74752
 s_nop 0
 buffer_load_dwordx4 v57, s[16:19], s47 offen nt lds
 ds_read_b64_tr_b16 v[192:193], v18 offset:16384
 ds_read_b64_tr_b16 v[194:195], v18 offset:16640
 ds_read_b64_tr_b16 v[196:197], v18 offset:20480
 ds_read_b64_tr_b16 v[198:199], v18 offset:20736
 s_waitcnt vmcnt(14)
 s_waitcnt lgkmcnt(0)
 s_barrier
 s_add_u32 m0, s72, 81920
 s_add_u32 s47, s70, 2097280
 buffer_load_dwordx4 v56, s[16:19], s47 offen nt lds
 s_add_u32 m0, s72, 82944
 s_nop 0
 buffer_load_dwordx4 v57, s[16:19], s47 offen nt lds
 ds_read_b64_tr_b16 v[200:201], v18 offset:24576
 ds_read_b64_tr_b16 v[202:203], v18 offset:24832
 ds_read_b64_tr_b16 v[204:205], v18 offset:28672
 ds_read_b64_tr_b16 v[206:207], v18 offset:28928
 s_waitcnt vmcnt(14)
 s_waitcnt lgkmcnt(0)
 s_barrier
 s_add_u32 m0, s72, 90112
 s_add_u32 s47, s70, 2359296
 buffer_load_dwordx4 v56, s[8:11], s47 offen nt lds
 s_add_u32 m0, s72, 91136
 s_nop 0
 buffer_load_dwordx4 v57, s[8:11], s47 offen nt lds
 ds_read_b64_tr_b16 v[208:209], v16 offset:24576
 ds_read_b64_tr_b16 v[210:211], v16 offset:24832
 ds_read_b64_tr_b16 v[212:213], v16 offset:28672
 ds_read_b64_tr_b16 v[214:215], v16 offset:28928
 s_waitcnt vmcnt(14)
 s_waitcnt lgkmcnt(0)
 s_barrier
 s_add_u32 m0, s72, 98304
 s_add_u32 s47, s70, 2359424
 buffer_load_dwordx4 v56, s[8:11], s47 offen nt lds
 s_add_u32 m0, s72, 99328
 s_nop 0
 buffer_load_dwordx4 v57, s[8:11], s47 offen nt lds
 ds_read_b64_tr_b16 v[216:217], v16 offset:32768
 ds_read_b64_tr_b16 v[218:219], v16 offset:33024
 ds_read_b64_tr_b16 v[220:221], v16 offset:36864
 ds_read_b64_tr_b16 v[222:223], v16 offset:37120
 s_waitcnt vmcnt(14)
 s_waitcnt lgkmcnt(0)
 s_barrier
 s_add_u32 m0, s72, 106496
 s_add_u32 s47, s70, 2359296
 buffer_load_dwordx4 v56, s[12:15], s47 offen nt lds
 s_add_u32 m0, s72, 107520
 s_nop 0
 buffer_load_dwordx4 v57, s[12:15], s47 offen nt lds
 ds_read_b64_tr_b16 v[224:225], v16 offset:40960
 ds_read_b64_tr_b16 v[226:227], v16 offset:41216
 ds_read_b64_tr_b16 v[228:229], v16 offset:45056
 ds_read_b64_tr_b16 v[230:231], v16 offset:45312
 s_waitcnt vmcnt(14)
 s_waitcnt lgkmcnt(0)
 s_barrier
 s_add_u32 m0, s72, 114688
 s_add_u32 s47, s70, 2359296
 buffer_load_dwordx4 v56, s[16:19], s47 offen nt lds
 s_add_u32 m0, s72, 115712
 s_nop 0
 buffer_load_dwordx4 v57, s[16:19], s47 offen nt lds
 ds_read_b64_tr_b16 v[232:233], v16 offset:49152
 ds_read_b64_tr_b16 v[234:235], v16 offset:49408
 ds_read_b64_tr_b16 v[236:237], v16 offset:53248
 ds_read_b64_tr_b16 v[238:239], v16 offset:53504
 s_waitcnt vmcnt(14)
 s_waitcnt lgkmcnt(0)
 s_barrier
 s_add_u32 m0, s72, 122880
 s_add_u32 s47, s70, 2359424
 buffer_load_dwordx4 v56, s[16:19], s47 offen nt lds
 s_add_u32 m0, s72, 123904
 s_nop 0
 buffer_load_dwordx4 v57, s[16:19], s47 offen nt lds
 ds_read_b64_tr_b16 v[240:241], v16 offset:57344
 ds_read_b64_tr_b16 v[242:243], v16 offset:57600
 ds_read_b64_tr_b16 v[244:245], v16 offset:61440
 ds_read_b64_tr_b16 v[246:247], v16 offset:61696
 s_waitcnt vmcnt(14)
 s_waitcnt lgkmcnt(0)
 s_barrier
 s_add_u32 m0, s72, 131072
 s_add_u32 s47, s70, 3145728
 buffer_load_dwordx4 v56, s[8:11], s47 offen nt lds
 s_add_u32 m0, s72, 132096
 s_nop 0
 buffer_load_dwordx4 v57, s[8:11], s47 offen nt lds
 ds_read_b64_tr_b16 v[248:249], v17 offset:0
 ds_read_b64_tr_b16 v[250:251], v17 offset:256
 ds_read_b64_tr_b16 v[252:253], v17 offset:4096
 ds_read_b64_tr_b16 v[254:255], v17 offset:4352
 s_waitcnt vmcnt(14)
 s_waitcnt lgkmcnt(0)
 s_barrier
 s_add_u32 m0, s72, 139264
 s_add_u32 s47, s70, 3145856
 buffer_load_dwordx4 v56, s[8:11], s47 offen nt lds
 s_add_u32 m0, s72, 140288
 s_nop 0
 buffer_load_dwordx4 v57, s[8:11], s47 offen nt lds
 ds_read_b64_tr_b16 a[0:1], v17 offset:8192
 ds_read_b64_tr_b16 a[2:3], v17 offset:8448
 ds_read_b64_tr_b16 a[4:5], v17 offset:12288
 ds_read_b64_tr_b16 a[6:7], v17 offset:12544
 s_waitcnt vmcnt(14)
 s_waitcnt lgkmcnt(0)
 s_barrier
 s_add_u32 m0, s72, 147456
 s_add_u32 s47, s70, 3145728
 buffer_load_dwordx4 v56, s[12:15], s47 offen nt lds
 s_add_u32 m0, s72, 148480
 s_nop 0
 buffer_load_dwordx4 v57, s[12:15], s47 offen nt lds
 ds_read_b64_tr_b16 a[8:9], v17 offset:16384
 ds_read_b64_tr_b16 a[10:11], v17 offset:16640
 ds_read_b64_tr_b16 a[12:13], v17 offset:20480
 ds_read_b64_tr_b16 a[14:15], v17 offset:20736
 s_waitcnt vmcnt(14)
 s_waitcnt lgkmcnt(0)
 s_barrier
 s_add_u32 m0, s72, 155648
 s_add_u32 s47, s70, 3145728
 buffer_load_dwordx4 v56, s[16:19], s47 offen nt lds
 s_add_u32 m0, s72, 156672
 s_nop 0
 buffer_load_dwordx4 v57, s[16:19], s47 offen nt lds
 ds_read_b64_tr_b16 a[16:17], v17 offset:24576
 ds_read_b64_tr_b16 a[18:19], v17 offset:24832
 ds_read_b64_tr_b16 a[20:21], v17 offset:28672
 ds_read_b64_tr_b16 a[22:23], v17 offset:28928
 s_waitcnt vmcnt(14)
 s_waitcnt lgkmcnt(0)
 s_barrier
 s_add_u32 m0, s72, 24576
 s_add_u32 s47, s70, 3145856
 buffer_load_dwordx4 v56, s[16:19], s47 offen nt lds
 s_add_u32 m0, s72, 25600
 s_nop 0
 buffer_load_dwordx4 v57, s[16:19], s47 offen nt lds
 ds_read_b64_tr_b16 a[24:25], v17 offset:32768
 ds_read_b64_tr_b16 a[26:27], v17 offset:33024
 ds_read_b64_tr_b16 a[28:29], v17 offset:36864
 ds_read_b64_tr_b16 a[30:31], v17 offset:37120
 s_waitcnt vmcnt(14)
 s_waitcnt lgkmcnt(0)
 s_barrier
 s_add_u32 m0, s72, 32768
 s_add_u32 s47, s70, 3407872
 buffer_load_dwordx4 v56, s[8:11], s47 offen nt lds
 s_add_u32 m0, s72, 33792
 s_nop 0
 buffer_load_dwordx4 v57, s[8:11], s47 offen nt lds
 ds_read_b64_tr_b16 a[32:33], v17 offset:40960
 ds_read_b64_tr_b16 a[34:35], v17 offset:41216
 ds_read_b64_tr_b16 a[36:37], v17 offset:45056
 ds_read_b64_tr_b16 a[38:39], v17 offset:45312
 s_waitcnt vmcnt(14)
 s_waitcnt lgkmcnt(0)
 s_barrier
 s_add_u32 m0, s72, 40960
 s_add_u32 s47, s70, 3408000
 buffer_load_dwordx4 v56, s[8:11], s47 offen nt lds
 s_add_u32 m0, s72, 41984
 s_nop 0
 buffer_load_dwordx4 v57, s[8:11], s47 offen nt lds
 ds_read_b64_tr_b16 a[40:41], v17 offset:49152
 ds_read_b64_tr_b16 a[42:43], v17 offset:49408
 ds_read_b64_tr_b16 a[44:45], v17 offset:53248
 ds_read_b64_tr_b16 a[46:47], v17 offset:53504
 s_waitcnt vmcnt(14)
 s_waitcnt lgkmcnt(0)
 s_barrier
 s_add_u32 m0, s72, 49152
 s_add_u32 s47, s70, 3407872
 buffer_load_dwordx4 v56, s[12:15], s47 offen nt lds
 s_add_u32 m0, s72, 50176
 s_nop 0
 buffer_load_dwordx4 v57, s[12:15], s47 offen nt lds
 ds_read_b64_tr_b16 a[48:49], v17 offset:57344
 ds_read_b64_tr_b16 a[50:51], v17 offset:57600
 ds_read_b64_tr_b16 a[52:53], v17 offset:61440
 ds_read_b64_tr_b16 a[54:55], v17 offset:61696
 s_waitcnt vmcnt(14)
 s_waitcnt lgkmcnt(0)
 s_barrier
 s_add_u32 m0, s72, 57344
 s_add_u32 s47, s70, 3407872
 buffer_load_dwordx4 v56, s[16:19], s47 offen nt lds
 s_add_u32 m0, s72, 58368
 s_nop 0
 buffer_load_dwordx4 v57, s[16:19], s47 offen nt lds
 ds_read_b64_tr_b16 a[56:57], v18 offset:0
 ds_read_b64_tr_b16 a[58:59], v18 offset:256
 ds_read_b64_tr_b16 a[60:61], v18 offset:4096
 ds_read_b64_tr_b16 a[62:63], v18 offset:4352
 s_waitcnt vmcnt(14)
 s_waitcnt lgkmcnt(0)
 s_barrier
 s_add_u32 m0, s72, 65536
 s_add_u32 s47, s70, 3408000
 buffer_load_dwordx4 v56, s[16:19], s47 offen nt lds
 s_add_u32 m0, s72, 66560
 s_nop 0
 buffer_load_dwordx4 v57, s[16:19], s47 offen nt lds
 ds_read_b64_tr_b16 a[64:65], v18 offset:8192
 ds_read_b64_tr_b16 a[66:67], v18 offset:8448
 ds_read_b64_tr_b16 a[68:69], v18 offset:12288
 ds_read_b64_tr_b16 a[70:71], v18 offset:12544
 s_waitcnt vmcnt(14)
 s_waitcnt lgkmcnt(0)
 s_barrier
 s_add_u32 m0, s72, 73728
 s_add_u32 s47, s70, 4194304
 buffer_load_dwordx4 v12, s[8:11], s47 offen nt lds
 s_add_u32 m0, s72, 74752
 s_nop 0
 buffer_load_dwordx4 v13, s[8:11], s47 offen nt lds
 ds_read_b64_tr_b16 a[72:73], v18 offset:16384
 ds_read_b64_tr_b16 a[74:75], v18 offset:16640
 ds_read_b64_tr_b16 a[76:77], v18 offset:20480
 ds_read_b64_tr_b16 a[78:79], v18 offset:20736
 s_waitcnt vmcnt(14)
 s_waitcnt lgkmcnt(0)
 s_barrier
 s_add_u32 m0, s72, 81920
 s_add_u32 s47, s70, 4194432
 buffer_load_dwordx4 v12, s[8:11], s47 offen nt lds
 s_add_u32 m0, s72, 82944
 s_nop 0
 buffer_load_dwordx4 v13, s[8:11], s47 offen nt lds
 ds_read_b64_tr_b16 a[80:81], v18 offset:24576
 ds_read_b64_tr_b16 a[82:83], v18 offset:24832
 ds_read_b64_tr_b16 a[84:85], v18 offset:28672
 ds_read_b64_tr_b16 a[86:87], v18 offset:28928
 s_waitcnt vmcnt(14)
 s_waitcnt lgkmcnt(0)
 s_barrier
 s_add_u32 m0, s72, 90112
 s_add_u32 s47, s70, 4194304
 buffer_load_dwordx4 v12, s[12:15], s47 offen nt lds
 s_add_u32 m0, s72, 91136
 s_nop 0
 buffer_load_dwordx4 v13, s[12:15], s47 offen nt lds
 ds_read_b64_tr_b16 a[88:89], v16 offset:24576
 ds_read_b64_tr_b16 a[90:91], v16 offset:24832
 ds_read_b64_tr_b16 a[92:93], v16 offset:28672
 ds_read_b64_tr_b16 a[94:95], v16 offset:28928
 s_waitcnt vmcnt(14)
 s_waitcnt lgkmcnt(0)
 s_barrier
 s_add_u32 m0, s72, 98304
 s_add_u32 s47, s70, 4194304
 buffer_load_dwordx4 v12, s[16:19], s47 offen nt lds
 s_add_u32 m0, s72, 99328
 s_nop 0
 buffer_load_dwordx4 v13, s[16:19], s47 offen nt lds
 ds_read_b64_tr_b16 a[96:97], v16 offset:32768
 ds_read_b64_tr_b16 a[98:99], v16 offset:33024
 ds_read_b64_tr_b16 a[100:101], v16 offset:36864
 ds_read_b64_tr_b16 a[102:103], v16 offset:37120
 s_waitcnt vmcnt(14)
 s_waitcnt lgkmcnt(0)
 s_barrier
 s_add_u32 m0, s72, 106496
 s_add_u32 s47, s70, 4194432
 buffer_load_dwordx4 v12, s[16:19], s47 offen nt lds
 s_add_u32 m0, s72, 107520
 s_nop 0
 buffer_load_dwordx4 v13, s[16:19], s47 offen nt lds
 ds_read_b64_tr_b16 a[104:105], v16 offset:40960
 ds_read_b64_tr_b16 a[106:107], v16 offset:41216
 ds_read_b64_tr_b16 a[108:109], v16 offset:45056
 ds_read_b64_tr_b16 a[110:111], v16 offset:45312
 s_waitcnt vmcnt(14)
 s_waitcnt lgkmcnt(0)
 s_barrier
 s_add_u32 m0, s72, 114688
 s_add_u32 s47, s71, 0
 buffer_load_dwordx4 v14, s[24:27], s47 offen nt lds
 s_add_u32 m0, s72, 115712
 s_nop 0
 buffer_load_dwordx4 v15, s[24:27], s47 offen nt lds
 ds_read_b64_tr_b16 a[112:113], v16 offset:49152
 ds_read_b64_tr_b16 a[114:115], v16 offset:49408
 ds_read_b64_tr_b16 a[116:117], v16 offset:53248
 ds_read_b64_tr_b16 a[118:119], v16 offset:53504
 s_waitcnt vmcnt(14)
 s_waitcnt lgkmcnt(0)
 s_barrier
 s_add_u32 m0, s72, 122880
 s_add_u32 s47, s71, 128
 buffer_load_dwordx4 v14, s[24:27], s47 offen nt lds
 s_add_u32 m0, s72, 123904
 s_nop 0
 buffer_load_dwordx4 v15, s[24:27], s47 offen nt lds
 ds_read_b64_tr_b16 a[120:121], v16 offset:57344
 ds_read_b64_tr_b16 a[122:123], v16 offset:57600
 ds_read_b64_tr_b16 a[124:125], v16 offset:61440
 ds_read_b64_tr_b16 a[126:127], v16 offset:61696
 s_waitcnt vmcnt(14)
 s_waitcnt lgkmcnt(0)
 s_barrier
 s_add_u32 m0, s72, 131072
 s_add_u32 s47, s71, 256
 buffer_load_dwordx4 v14, s[24:27], s47 offen nt lds
 s_add_u32 m0, s72, 132096
 s_nop 0
 buffer_load_dwordx4 v15, s[24:27], s47 offen nt lds
 ds_read_b64_tr_b16 a[128:129], v17 offset:0
 ds_read_b64_tr_b16 a[130:131], v17 offset:256
 ds_read_b64_tr_b16 a[132:133], v17 offset:4096
 ds_read_b64_tr_b16 a[134:135], v17 offset:4352
 s_waitcnt vmcnt(14)
 s_waitcnt lgkmcnt(0)
 s_barrier
 s_add_u32 m0, s72, 139264
 s_add_u32 s47, s71, 384
 buffer_load_dwordx4 v14, s[24:27], s47 offen nt lds
 s_add_u32 m0, s72, 140288
 s_nop 0
 buffer_load_dwordx4 v15, s[24:27], s47 offen nt lds
 ds_read_b64_tr_b16 a[136:137], v17 offset:8192
 ds_read_b64_tr_b16 a[138:139], v17 offset:8448
 ds_read_b64_tr_b16 a[140:141], v17 offset:12288
 ds_read_b64_tr_b16 a[142:143], v17 offset:12544
 s_waitcnt vmcnt(14)
 s_waitcnt lgkmcnt(0)
 s_barrier
 s_add_u32 m0, s72, 147456
 s_add_u32 s47, s71, 512
 buffer_load_dwordx4 v14, s[24:27], s47 offen nt lds
 s_add_u32 m0, s72, 148480
 s_nop 0
 buffer_load_dwordx4 v15, s[24:27], s47 offen nt lds
 ds_read_b64_tr_b16 a[144:145], v17 offset:16384
 ds_read_b64_tr_b16 a[146:147], v17 offset:16640
 ds_read_b64_tr_b16 a[148:149], v17 offset:20480
 ds_read_b64_tr_b16 a[150:151], v17 offset:20736
 s_waitcnt vmcnt(14)
 s_waitcnt lgkmcnt(0)
 s_barrier
 s_add_u32 m0, s72, 155648
 s_add_u32 s47, s71, 640
 buffer_load_dwordx4 v14, s[24:27], s47 offen nt lds
 s_add_u32 m0, s72, 156672
 s_nop 0
 buffer_load_dwordx4 v15, s[24:27], s47 offen nt lds
 ds_read_b64_tr_b16 a[152:153], v17 offset:24576
 ds_read_b64_tr_b16 a[154:155], v17 offset:24832
 ds_read_b64_tr_b16 a[156:157], v17 offset:28672
 ds_read_b64_tr_b16 a[158:159], v17 offset:28928
 s_waitcnt vmcnt(14)
 s_waitcnt lgkmcnt(0)
 s_barrier
 s_add_u32 m0, s72, 24576
 s_add_u32 s47, s71, 768
 buffer_load_dwordx4 v14, s[24:27], s47 offen nt lds
 s_add_u32 m0, s72, 25600
 s_nop 0
 buffer_load_dwordx4 v15, s[24:27], s47 offen nt lds
 ds_read_b64_tr_b16 a[160:161], v17 offset:32768
 ds_read_b64_tr_b16 a[162:163], v17 offset:33024
 ds_read_b64_tr_b16 a[164:165], v17 offset:36864
 ds_read_b64_tr_b16 a[166:167], v17 offset:37120
 s_waitcnt vmcnt(14)
 s_waitcnt lgkmcnt(0)
 s_barrier
 s_add_u32 m0, s72, 32768
 s_add_u32 s47, s71, 896
 buffer_load_dwordx4 v14, s[24:27], s47 offen nt lds
 s_add_u32 m0, s72, 33792
 s_nop 0
 buffer_load_dwordx4 v15, s[24:27], s47 offen nt lds
 ds_read_b64_tr_b16 a[168:169], v17 offset:40960
 ds_read_b64_tr_b16 a[170:171], v17 offset:41216
 ds_read_b64_tr_b16 a[172:173], v17 offset:45056
 ds_read_b64_tr_b16 a[174:175], v17 offset:45312
 s_waitcnt vmcnt(14)
 s_waitcnt lgkmcnt(0)
 s_barrier
 s_add_u32 m0, s72, 40960
 s_add_u32 s47, s71, 37760
 buffer_load_dwordx4 v14, s[24:27], s47 offen nt lds
 s_add_u32 m0, s72, 41984
 s_nop 0
 buffer_load_dwordx4 v15, s[24:27], s47 offen nt lds
 ds_read_b64_tr_b16 a[176:177], v17 offset:49152
 ds_read_b64_tr_b16 a[178:179], v17 offset:49408
 ds_read_b64_tr_b16 a[180:181], v17 offset:53248
 ds_read_b64_tr_b16 a[182:183], v17 offset:53504
 s_waitcnt vmcnt(14)
 s_waitcnt lgkmcnt(0)
 s_barrier
 s_add_u32 m0, s72, 49152
 s_add_u32 s47, s71, 1024
 buffer_load_dwordx4 v14, s[24:27], s47 offen nt lds
 s_add_u32 m0, s72, 50176
 s_nop 0
 buffer_load_dwordx4 v15, s[24:27], s47 offen nt lds
 ds_read_b64_tr_b16 a[184:185], v17 offset:57344
 ds_read_b64_tr_b16 a[186:187], v17 offset:57600
 ds_read_b64_tr_b16 a[188:189], v17 offset:61440
 ds_read_b64_tr_b16 a[190:191], v17 offset:61696
 s_waitcnt vmcnt(14)
 s_waitcnt lgkmcnt(0)
 s_barrier
 s_add_u32 m0, s72, 57344
 s_add_u32 s47, s70, 2097280
 buffer_load_dwordx4 v56, s[12:15], s47 offen nt lds
 s_add_u32 m0, s72, 58368
 s_nop 0
 buffer_load_dwordx4 v57, s[12:15], s47 offen nt lds
 ds_read_b64_tr_b16 a[192:193], v18 offset:0
 ds_read_b64_tr_b16 a[194:195], v18 offset:256
 ds_read_b64_tr_b16 a[196:197], v18 offset:4096
 ds_read_b64_tr_b16 a[198:199], v18 offset:4352
 s_waitcnt vmcnt(14)
 s_waitcnt lgkmcnt(0)
 s_barrier
 s_add_u32 m0, s72, 65536
 s_add_u32 s47, s70, 2359424
 buffer_load_dwordx4 v56, s[12:15], s47 offen nt lds
 s_add_u32 m0, s72, 66560
 s_nop 0
 buffer_load_dwordx4 v57, s[12:15], s47 offen nt lds
 ds_read_b64_tr_b16 a[200:201], v18 offset:8192
 ds_read_b64_tr_b16 a[202:203], v18 offset:8448
 ds_read_b64_tr_b16 a[204:205], v18 offset:12288
 ds_read_b64_tr_b16 a[206:207], v18 offset:12544
 s_waitcnt vmcnt(14)
 s_waitcnt lgkmcnt(0)
 s_barrier
 s_add_u32 m0, s72, 73728
 s_add_u32 s47, s70, 3145856
 buffer_load_dwordx4 v56, s[12:15], s47 offen nt lds
 s_add_u32 m0, s72, 74752
 s_nop 0
 buffer_load_dwordx4 v57, s[12:15], s47 offen nt lds
 ds_read_b64_tr_b16 a[208:209], v18 offset:16384
 ds_read_b64_tr_b16 a[210:211], v18 offset:16640
 ds_read_b64_tr_b16 a[212:213], v18 offset:20480
 ds_read_b64_tr_b16 a[214:215], v18 offset:20736
 s_waitcnt vmcnt(14)
 s_waitcnt lgkmcnt(0)
 s_barrier
 s_add_u32 m0, s72, 81920
 s_add_u32 s47, s70, 3408000
 buffer_load_dwordx4 v56, s[12:15], s47 offen nt lds
 s_add_u32 m0, s72, 82944
 s_nop 0
 buffer_load_dwordx4 v57, s[12:15], s47 offen nt lds
 ds_read_b64_tr_b16 a[216:217], v18 offset:24576
 ds_read_b64_tr_b16 a[218:219], v18 offset:24832
 ds_read_b64_tr_b16 a[220:221], v18 offset:28672
 ds_read_b64_tr_b16 a[222:223], v18 offset:28928
 s_waitcnt vmcnt(14)
 s_waitcnt lgkmcnt(0)
 s_barrier
 s_add_u32 m0, s72, 90112
 s_add_u32 s47, s70, 4194432
 buffer_load_dwordx4 v12, s[12:15], s47 offen nt lds
 s_add_u32 m0, s72, 91136
 s_nop 0
 buffer_load_dwordx4 v13, s[12:15], s47 offen nt lds
 ds_read_b64_tr_b16 a[224:225], v16 offset:24576
 ds_read_b64_tr_b16 a[226:227], v16 offset:24832
 ds_read_b64_tr_b16 a[228:229], v16 offset:28672
 ds_read_b64_tr_b16 a[230:231], v16 offset:28928
 s_waitcnt vmcnt(14)
 s_waitcnt lgkmcnt(0)
 s_barrier
 s_add_u32 m0, s72, 98304
 s_add_u32 s47, s71, 37888
 buffer_load_dwordx4 v14, s[24:27], s47 offen nt lds
 s_add_u32 m0, s72, 99328
 s_nop 0
 buffer_load_dwordx4 v15, s[24:27], s47 offen nt lds
 ds_read_b64_tr_b16 a[232:233], v16 offset:32768
 ds_read_b64_tr_b16 a[234:235], v16 offset:33024
 ds_read_b64_tr_b16 a[236:237], v16 offset:36864
 ds_read_b64_tr_b16 a[238:239], v16 offset:37120
 s_waitcnt vmcnt(14)
 s_waitcnt lgkmcnt(0)
 s_barrier
 s_add_u32 m0, s72, 106496
 s_add_u32 s47, s71, 36864
 buffer_load_dwordx4 v14, s[24:27], s47 offen nt lds
 s_add_u32 m0, s72, 107520
 s_nop 0
 buffer_load_dwordx4 v15, s[24:27], s47 offen nt lds
 ds_read_b64_tr_b16 a[240:241], v16 offset:40960
 ds_read_b64_tr_b16 a[242:243], v16 offset:41216
 ds_read_b64_tr_b16 a[244:245], v16 offset:45056
 ds_read_b64_tr_b16 a[246:247], v16 offset:45312
 s_waitcnt vmcnt(14)
 s_waitcnt lgkmcnt(0)
 s_barrier
 s_add_u32 m0, s72, 114688
 s_add_u32 s47, s71, 36992
 buffer_load_dwordx4 v14, s[24:27], s47 offen nt lds
 s_add_u32 m0, s72, 115712
 s_nop 0
 buffer_load_dwordx4 v15, s[24:27], s47 offen nt lds
 ds_read_b64_tr_b16 a[248:249], v16 offset:49152
 ds_read_b64_tr_b16 a[250:251], v16 offset:49408
 ds_read_b64_tr_b16 a[252:253], v16 offset:53248
 ds_read_b64_tr_b16 a[254:255], v16 offset:53504
 s_waitcnt vmcnt(14)
 s_waitcnt lgkmcnt(0)
 s_barrier
 s_add_u32 m0, s72, 122880
 s_add_u32 s47, s71, 37120
 buffer_load_dwordx4 v14, s[24:27], s47 offen nt lds
 s_add_u32 m0, s72, 123904
 s_nop 0
 buffer_load_dwordx4 v15, s[24:27], s47 offen nt lds
 ds_read_b64_tr_b16 v[48:49], v16 offset:57344
 ds_read_b64_tr_b16 v[50:51], v16 offset:57600
 ds_read_b64_tr_b16 v[52:53], v16 offset:61440
 ds_read_b64_tr_b16 v[54:55], v16 offset:61696
 s_waitcnt vmcnt(14)
 s_waitcnt lgkmcnt(0)
 s_barrier
 s_add_u32 m0, s72, 131072
 s_add_u32 s47, s71, 37248
 buffer_load_dwordx4 v14, s[24:27], s47 offen nt lds
 s_add_u32 m0, s72, 132096
 s_nop 0
 buffer_load_dwordx4 v15, s[24:27], s47 offen nt lds
 ds_write_b128 v60, v[48:51] offset:57344
 ds_write_b128 v60, v[52:55] offset:61440
 ds_read_b64_tr_b16 v[40:41], v17 offset:0
 ds_read_b64_tr_b16 v[42:43], v17 offset:256
 ds_read_b64_tr_b16 v[44:45], v17 offset:4096
 ds_read_b64_tr_b16 v[46:47], v17 offset:4352
 s_waitcnt vmcnt(14)
 s_waitcnt lgkmcnt(0)
 s_barrier
 s_add_u32 m0, s72, 139264
 s_add_u32 s47, s71, 37376
 buffer_load_dwordx4 v14, s[24:27], s47 offen nt lds
 s_add_u32 m0, s72, 140288
 s_nop 0
 buffer_load_dwordx4 v15, s[24:27], s47 offen nt lds
 ds_write_b128 v61, v[40:43] offset:0
 ds_write_b128 v61, v[44:47] offset:4096
 ds_read_b64_tr_b16 v[48:49], v17 offset:8192
 ds_read_b64_tr_b16 v[50:51], v17 offset:8448
 ds_read_b64_tr_b16 v[52:53], v17 offset:12288
 ds_read_b64_tr_b16 v[54:55], v17 offset:12544
 s_waitcnt vmcnt(14)
 s_waitcnt lgkmcnt(0)
 s_barrier
 s_add_u32 m0, s72, 147456
 s_add_u32 s47, s71, 37504
 buffer_load_dwordx4 v14, s[24:27], s47 offen nt lds
 s_add_u32 m0, s72, 148480
 s_nop 0
 buffer_load_dwordx4 v15, s[24:27], s47 offen nt lds
 ds_write_b128 v61, v[48:51] offset:8192
 ds_write_b128 v61, v[52:55] offset:12288
 ds_read_b64_tr_b16 v[40:41], v17 offset:16384
 ds_read_b64_tr_b16 v[42:43], v17 offset:16640
 ds_read_b64_tr_b16 v[44:45], v17 offset:20480
 ds_read_b64_tr_b16 v[46:47], v17 offset:20736
 s_waitcnt vmcnt(14)
 s_waitcnt lgkmcnt(0)
 s_barrier
 s_add_u32 m0, s72, 155648
 s_add_u32 s47, s71, 37632
 buffer_load_dwordx4 v14, s[24:27], s47 offen nt lds
 s_add_u32 m0, s72, 156672
 s_nop 0
 buffer_load_dwordx4 v15, s[24:27], s47 offen nt lds
 ds_write_b128 v61, v[40:43] offset:16384
 ds_write_b128 v61, v[44:47] offset:20480
 ds_read_b64_tr_b16 v[48:49], v17 offset:24576
 ds_read_b64_tr_b16 v[50:51], v17 offset:24832
 ds_read_b64_tr_b16 v[52:53], v17 offset:28672
 ds_read_b64_tr_b16 v[54:55], v17 offset:28928
 s_waitcnt vmcnt(14)
 s_waitcnt lgkmcnt(0)
 s_barrier
 s_add_u32 m0, s72, 24576
 s_add_u32 s47, s70, 128
 buffer_load_dwordx4 v56, s[12:15], s47 offen nt lds
 s_add_u32 m0, s72, 25600
 s_nop 0
 buffer_load_dwordx4 v57, s[12:15], s47 offen nt lds
 ds_write_b128 v61, v[48:51] offset:24576
 ds_write_b128 v61, v[52:55] offset:28672
 ds_read_b64_tr_b16 v[40:41], v17 offset:32768
 ds_read_b64_tr_b16 v[42:43], v17 offset:33024
 ds_read_b64_tr_b16 v[44:45], v17 offset:36864
 ds_read_b64_tr_b16 v[46:47], v17 offset:37120
 s_waitcnt vmcnt(14)
 s_waitcnt lgkmcnt(0)
 s_barrier
 s_add_u32 m0, s72, 32768
 s_add_u32 s47, s70, 262272
 buffer_load_dwordx4 v56, s[12:15], s47 offen nt lds
 s_add_u32 m0, s72, 33792
 s_nop 0
 buffer_load_dwordx4 v57, s[12:15], s47 offen nt lds
 ds_write_b128 v61, v[40:43] offset:32768
 ds_write_b128 v61, v[44:47] offset:36864
 ds_read_b64_tr_b16 v[48:49], v17 offset:40960
 ds_read_b64_tr_b16 v[50:51], v17 offset:41216
 ds_read_b64_tr_b16 v[52:53], v17 offset:45056
 ds_read_b64_tr_b16 v[54:55], v17 offset:45312
 s_waitcnt vmcnt(14)
 s_waitcnt lgkmcnt(0)
 s_barrier
 s_add_u32 m0, s72, 40960
 s_add_u32 s47, s70, 1048704
 buffer_load_dwordx4 v56, s[12:15], s47 offen nt lds
 s_add_u32 m0, s72, 41984
 s_nop 0
 buffer_load_dwordx4 v57, s[12:15], s47 offen nt lds
 ds_write_b128 v61, v[48:51] offset:40960
 ds_write_b128 v61, v[52:55] offset:45056
 ds_read_b64_tr_b16 v[40:41], v17 offset:49152
 ds_read_b64_tr_b16 v[42:43], v17 offset:49408
 ds_read_b64_tr_b16 v[44:45], v17 offset:53248
 ds_read_b64_tr_b16 v[46:47], v17 offset:53504
 s_waitcnt vmcnt(14)
 s_waitcnt lgkmcnt(0)
 s_barrier
 s_add_u32 m0, s72, 49152
 s_add_u32 s47, s70, 1310848
 buffer_load_dwordx4 v56, s[12:15], s47 offen nt lds
 s_add_u32 m0, s72, 50176
 s_nop 0
 buffer_load_dwordx4 v57, s[12:15], s47 offen nt lds
 ds_write_b128 v61, v[40:43] offset:49152
 ds_write_b128 v61, v[44:47] offset:53248
 ds_read_b64_tr_b16 v[48:49], v17 offset:57344
 ds_read_b64_tr_b16 v[50:51], v17 offset:57600
 ds_read_b64_tr_b16 v[52:53], v17 offset:61440
 ds_read_b64_tr_b16 v[54:55], v17 offset:61696
 s_waitcnt vmcnt(14)
 s_waitcnt lgkmcnt(0)
 s_barrier
 ds_write_b128 v61, v[48:51] offset:57344
 ds_write_b128 v61, v[52:55] offset:61440
 ds_read_b64_tr_b16 v[40:41], v18 offset:0
 ds_read_b64_tr_b16 v[42:43], v18 offset:256
 ds_read_b64_tr_b16 v[44:45], v18 offset:4096
 ds_read_b64_tr_b16 v[46:47], v18 offset:4352
 s_waitcnt vmcnt(12)
 s_waitcnt lgkmcnt(0)
 s_barrier
 ds_write_b128 v62, v[40:43] offset:0
 ds_write_b128 v62, v[44:47] offset:4096
 ds_read_b64_tr_b16 v[48:49], v18 offset:8192
 ds_read_b64_tr_b16 v[50:51], v18 offset:8448
 ds_read_b64_tr_b16 v[52:53], v18 offset:12288
 ds_read_b64_tr_b16 v[54:55], v18 offset:12544
 s_waitcnt vmcnt(10)
 s_waitcnt lgkmcnt(0)
 s_barrier
 ds_write_b128 v62, v[48:51] offset:8192
 ds_write_b128 v62, v[52:55] offset:12288
 ds_read_b64_tr_b16 v[40:41], v18 offset:16384
 ds_read_b64_tr_b16 v[42:43], v18 offset:16640
 ds_read_b64_tr_b16 v[44:45], v18 offset:20480
 ds_read_b64_tr_b16 v[46:47], v18 offset:20736
 s_waitcnt vmcnt(8)
 s_waitcnt lgkmcnt(0)
 s_barrier
 ds_write_b128 v62, v[40:43] offset:16384
 ds_write_b128 v62, v[44:47] offset:20480
 ds_read_b64_tr_b16 v[48:49], v18 offset:24576
 ds_read_b64_tr_b16 v[50:51], v18 offset:24832
 ds_read_b64_tr_b16 v[52:53], v18 offset:28672
 ds_read_b64_tr_b16 v[54:55], v18 offset:28928
 s_waitcnt vmcnt(6)
 s_waitcnt lgkmcnt(0)
 s_barrier
 ds_write_b128 v62, v[48:51] offset:24576
 ds_write_b128 v62, v[52:55] offset:28672
 ds_read_b64_tr_b16 v[40:41], v16 offset:24576
 ds_read_b64_tr_b16 v[42:43], v16 offset:24832
 ds_read_b64_tr_b16 v[44:45], v16 offset:28672
 ds_read_b64_tr_b16 v[46:47], v16 offset:28928
 s_waitcnt vmcnt(4)
 s_waitcnt lgkmcnt(0)
 s_barrier
 ds_write_b128 v60, v[40:43] offset:24576
 ds_write_b128 v60, v[44:47] offset:28672
 ds_read_b64_tr_b16 v[48:49], v16 offset:32768
 ds_read_b64_tr_b16 v[50:51], v16 offset:33024
 ds_read_b64_tr_b16 v[52:53], v16 offset:36864
 ds_read_b64_tr_b16 v[54:55], v16 offset:37120
 s_waitcnt vmcnt(2)
 s_waitcnt lgkmcnt(0)
 s_barrier
 ds_write_b128 v60, v[48:51] offset:32768
 ds_write_b128 v60, v[52:55] offset:36864
 ds_read_b64_tr_b16 v[40:41], v16 offset:40960
 ds_read_b64_tr_b16 v[42:43], v16 offset:41216
 ds_read_b64_tr_b16 v[44:45], v16 offset:45056
 ds_read_b64_tr_b16 v[46:47], v16 offset:45312
 s_waitcnt vmcnt(0)
 s_waitcnt lgkmcnt(0)
 s_barrier
 ds_write_b128 v60, v[40:43] offset:40960
 ds_write_b128 v60, v[44:47] offset:45056
 ds_read_b64_tr_b16 v[48:49], v16 offset:49152
 ds_read_b64_tr_b16 v[50:51], v16 offset:49408
 ds_read_b64_tr_b16 v[52:53], v16 offset:53248
 ds_read_b64_tr_b16 v[54:55], v16 offset:53504
 s_waitcnt lgkmcnt(0)
 s_barrier
 ds_write_b128 v60, v[48:51] offset:49152
 ds_write_b128 v60, v[52:55] offset:53248
 v_lshlrev_b32 v0, 4, v0
 s_load_dwordx2 s[32:33], s[0:1], 56
 s_mov_b32 s34, 0x2400
 s_mov_b32 s35, 0x20000
 v_lshrrev_b32 v24, 4, v3
 v_bfe_u32 v25, v24, 2, 2
 v_and_b32 v26, 1, v24
 v_lshl_add_u32 v25, v25, 1, v26
 v_mul_u32_u24 v25, 1152, v25
 v_and_b32 v26, 48, v24
 v_and_b32 v27, 2, v24
 v_lshl_add_u32 v27, v27, 2, v26
 v_lshl_add_u32 v29, v27, 1, v25
 v_add_u32 v25, v26, v25
 s_lshr_b32 s47, s4, 1
 s_lshl_b32 s47, s47, 8
 s_and_b32 s58, s4, 1
 s_lshl_b32 s58, s58, 6
 s_add_u32 s47, s47, s58
 s_waitcnt lgkmcnt(0)
 buffer_load_dwordx4 v[36:39], v25, s[32:35], s47 offen offset:0
 buffer_load_dwordx4 v[40:43], v25, s[32:35], s47 offen offset:128
 buffer_load_dwordx4 v[44:47], v25, s[32:35], s47 offen offset:512
 buffer_load_dwordx4 v[48:51], v25, s[32:35], s47 offen offset:640
 buffer_load_dwordx4 v[64:67], v29, s[32:35], 0 offen offset:1024
Lhs_37:
 buffer_load_dwordx2 v[26:27], v7, s[28:31], 0 offen offset:8 sc1
 s_waitcnt vmcnt(0)
 v_sad_u8 v28, v26, 0, 0
 v_sad_u8 v28, v27, 0, v28
 v_cmp_eq_u32 vcc, 32, v28
 s_cbranch_vccnz Lhsok_38
 s_sub_u32 s54, s54, 1
 s_cbranch_scc0 Lhs_37
 s_endpgm
Lhsok_38:
 v_readfirstlane_b32 s74, v26
 v_readfirstlane_b32 s75, v27
 v_mov_b32 v30, 0x05040100
 v_mov_b32 v31, 0x07060302
 v_cndmask_b32 v32, v30, v31, s[48:49]
 v_perm_b32 v52, v40, v36, v32
 v_perm_b32 v53, v41, v37, v32
 v_perm_b32 v54, v42, v38, v32
 v_perm_b32 v55, v43, v39, v32
 v_perm_b32 v56, v48, v44, v32
 v_perm_b32 v57, v49, v45, v32
 v_perm_b32 v58, v50, v46, v32
 v_perm_b32 v59, v51, v47, v32
 v_perm_b32 v60, v65, v64, v30
 v_perm_b32 v61, v67, v66, v30
 v_perm_b32 v62, v65, v64, v31
 v_perm_b32 v63, v67, v66, v31
 ds_write_b128 v0, v[52:55]
 ds_write_b128 v0, v[56:59] offset:4096
 ds_write_b128 v3, v[60:63] offset:8192
 s_mov_b32 s95, 0x200000
 v_mov_b32 v31, 0
Lfr_39:
 buffer_load_dword v30, v31, s[28:31], 0 offen sc1
 s_waitcnt vmcnt(0)
 v_cmp_ne_u32 vcc, 0, v30
 s_cbranch_vccnz Lfrk_40
 s_sub_u32 s95, s95, 1
 s_cbranch_scc0 Lfr_39
 s_endpgm
Lfrk_40:
 s_mov_b32 s24, 0xf000f
 s_mov_b32 s25, 0xf000f
 s_mov_b32 s26, 0xf000f0
 s_mov_b32 s27, 0xf000f0
 s_mov_b32 s28, 0xf000f00
 s_mov_b32 s29, 0xf000f00
 s_mov_b32 s30, 0xf000f000
 s_mov_b32 s31, 0xf000f000
 s_mov_b32 s32, 0xaaaaaaaa
 s_mov_b32 s33, 0xaaaaaaaa
 s_mov_b32 s34, 0x3f803f80
 s_mov_b32 s35, 0x3f803f80
Lpb0_41:
 buffer_load_dword v1, v7, s[20:23], s56 offen sc1
 s_waitcnt vmcnt(0)
 v_cmp_le_u32 vcc, 3, v1
 s_cbranch_vccnz Lpb0ok_42
 s_sub_u32 s54, s54, 1
 s_cbranch_scc0 Lpb0_41
 s_endpgm
Lpb0ok_42:
 s_lshl_b32 s47, s4, 11
 s_add_u32 m0, s47, 9216
 v_lshlrev_b32 v24, 2, v0
 buffer_load_dwordx4 v3, s[20:23], s67 offen offset:0 sc1 lds
 buffer_load_dwordx4 v3, s[20:23], s67 offen offset:1024 sc1 lds
 buffer_load_dword v25, v24, s[20:23], s37 offen sc1
 s_add_u32 s68, s37, 0x80000
 buffer_load_dword v25, v24, s[20:23], s68 offen sc1
 s_add_u32 s68, s68, 0x80000
 buffer_load_dwordx4 v[64:67], v3, s[20:23], s39 offen offset:0 sc1
 buffer_load_dwordx4 v[64:67], v3, s[20:23], s39 offen offset:1024 sc1
 buffer_load_dwordx4 v[64:67], v3, s[20:23], s40 offen offset:0 sc1
 buffer_load_dwordx4 v[64:67], v3, s[20:23], s40 offen offset:1024 sc1
 s_mov_b32 s47, 0x160000
 buffer_load_dword v25, v24, s[20:23], s47 offen sc1
 s_mov_b32 s47, 0x1e0000
 buffer_load_dword v25, v24, s[20:23], s47 offen sc1
 s_mov_b32 s70, -1
 s_mov_b32 s71, 0
 s_lshl_b32 s47, s4, 12
 s_add_u32 s68, s68, s47
 v_mov_b32 v2, 0
 v_mov_b32 v4, 0
 s_waitcnt vmcnt(0)
 ds_read_b128 v[20:23], v0 offset:24576
 ds_read_b128 v[24:27], v0 offset:28672
 ds_read_b128 v[28:31], v0 offset:32768
 ds_read_b128 v[32:35], v0 offset:36864
 v_mov_b64 v[36:37], 0
 v_mov_b64 v[38:39], 0
 v_mov_b64 v[40:41], 0
 v_mov_b64 v[42:43], 0
 v_mov_b64 v[44:45], 0
 v_mov_b64 v[46:47], 0
 v_mov_b64 v[48:49], 0
 v_mov_b64 v[50:51], 0
 v_lshl_add_u32 v1, v3, 3, s68
 v_mov_b32 v6, s56
 v_cndmask_b32 v1, v6, v1, s[70:71]
 s_xor_b32 s44, s44, 0x80000
 s_xor_b32 s45, s45, 0x80000
 s_xor_b32 s65, s65, 0x80000
 s_xor_b32 s66, s66, 0x80000
 s_xor_b32 s41, s41, 0x80000
 s_xor_b32 s43, s43, 0x80000
 s_lshr_b64 s[74:75], s[74:75], s73
 s_and_b32 s74, s74, 0xff
 s_cmp_eq_u32 s74, 32
 s_cbranch_scc0 Lslow_43
 .p2align 3
Lstep_45:
 s_mov_b64 exec, -1
 s_waitcnt lgkmcnt(0)
 s_barrier
 ds_read_b128 v[52:55], v3 offset:0
 ds_read_b128 v[56:59], v3 offset:1024
 ds_read_b128 v[60:63], v3 offset:2048
 buffer_load_dwordx4 v[12:15], v3, s[20:23], s59 offen offset:0 sc1
 s_waitcnt lgkmcnt(2)
 v_smfmac_f32_16x16x64_bf16 v[36:39], v[52:55], v[72:79], v5
 v_smfmac_f32_16x16x64_bf16 v[40:43], v[52:55], v[80:87], v5
 buffer_load_dwordx4 v[16:19], v3, s[20:23], s59 offen offset:1024 sc1
 v_smfmac_f32_16x16x64_bf16 v[44:47], v[52:55], v[88:95], v5
 s_waitcnt lgkmcnt(1)
 v_smfmac_f32_16x16x64_bf16 v[48:51], v[52:55], v[20:27], v5
 v_smfmac_f32_16x16x64_bf16 v[36:39], v[56:59], v[112:119], v5
 ds_read_b128 v[20:23], v0 offset:40960
 v_smfmac_f32_16x16x64_bf16 v[40:43], v[56:59], v[120:127], v5
 ds_read_b128 v[24:27], v0 offset:45056
 v_smfmac_f32_16x16x64_bf16 v[44:47], v[56:59], v[128:135], v5
 ds_read_b128 v[52:55], v3 offset:3072
 s_waitcnt lgkmcnt(3)
 v_smfmac_f32_16x16x64_bf16 v[48:51], v[56:59], v[28:35], v5
 buffer_load_dword v1, v1, s[20:23], 0 offen sc1
 v_smfmac_f32_16x16x64_bf16 v[36:39], v[60:63], v[152:159], v5
 ds_read_b128 v[28:31], v0 offset:49152
 s_max_u32 s47, s36, 1
 v_smfmac_f32_16x16x64_bf16 v[40:43], v[60:63], v[160:167], v5
 ds_read_b128 v[32:35], v0 offset:53248
 s_sub_u32 s47, s47, 1
 v_smfmac_f32_16x16x64_bf16 v[44:47], v[60:63], v[168:175], v5
 ds_read_b128 v[56:59], v3 offset:4096
 s_waitcnt lgkmcnt(3)
 v_smfmac_f32_16x16x64_bf16 v[48:51], v[60:63], v[20:27], v5
 v_smfmac_f32_16x16x64_bf16 v[36:39], v[52:55], v[192:199], v5
 ds_read_b128 v[20:23], v0 offset:57344
 v_min_u32 v6, 16, v0
 v_smfmac_f32_16x16x64_bf16 v[40:43], v[52:55], v[200:207], v5
 ds_read_b128 v[24:27], v0 offset:61440
 v_lshlrev_b32 v6, 24, v6
 v_smfmac_f32_16x16x64_bf16 v[44:47], v[52:55], v[208:215], v5
 ds_read_b128 v[60:63], v3 offset:5120
 s_waitcnt lgkmcnt(3)
 v_add_u32 v0, 0x10000, v0
 v_smfmac_f32_16x16x64_bf16 v[48:51], v[52:55], v[28:35], v5
 buffer_store_dwordx4 v[64:67], v0, s[20:23], s38 offen sc1
 v_smfmac_f32_16x16x64_bf16 v[36:39], v[56:59], v[232:239], v5
 ds_read_b128 v[28:31], v0 offset:0
 v_smfmac_f32_16x16x64_bf16 v[40:43], v[56:59], v[240:247], v5
 ds_read_b128 v[32:35], v0 offset:4096
 v_smfmac_f32_16x16x64_bf16 v[44:47], v[56:59], v[248:255], v5
 ds_read_b128 v[52:55], v3 offset:6144
 s_waitcnt lgkmcnt(3)
 v_smfmac_f32_16x16x64_bf16 v[48:51], v[56:59], v[20:27], v5
 v_smfmac_f32_16x16x64_bf16 v[36:39], v[60:63], a[16:23], v5
 ds_read_b128 v[20:23], v0 offset:8192
 v_mov_b32 v64, s47
 v_smfmac_f32_16x16x64_bf16 v[40:43], v[60:63], a[24:31], v5
 ds_read_b128 v[24:27], v0 offset:12288
 v_smfmac_f32_16x16x64_bf16 v[44:47], v[60:63], a[32:39], v5
 ds_read_b128 v[56:59], v3 offset:7168
 s_waitcnt lgkmcnt(3)
 v_smfmac_f32_16x16x64_bf16 v[48:51], v[60:63], v[28:35], v5
 buffer_store_dword v64, v6, s[20:23], s57 offen sc1
 v_smfmac_f32_16x16x64_bf16 v[36:39], v[52:55], a[56:63], v5
 ds_read_b128 v[28:31], v0 offset:16384
 v_smfmac_f32_16x16x64_bf16 v[40:43], v[52:55], a[64:71], v5
 ds_read_b128 v[32:35], v0 offset:20480
 v_smfmac_f32_16x16x64_bf16 v[44:47], v[52:55], a[72:79], v5
 ds_read_b128 v[60:63], v3 offset:8192
 s_waitcnt lgkmcnt(3)
 v_smfmac_f32_16x16x64_bf16 v[48:51], v[52:55], v[20:27], v5
 s_waitcnt vmcnt(5)
 v_smfmac_f32_16x16x64_bf16 v[36:39], v[56:59], a[96:103], v5
 ds_read_b128 v[20:23], v0 offset:24576
 v_mov_b64 v[64:65], 0
 v_smfmac_f32_16x16x64_bf16 v[40:43], v[56:59], a[104:111], v5
 ds_read_b128 v[24:27], v0 offset:28672
 v_mov_b64 v[66:67], 0
 v_smfmac_f32_16x16x64_bf16 v[44:47], v[56:59], a[112:119], v5
 ds_read_b128 v[52:55], v3 offset:0
 s_waitcnt lgkmcnt(3)
 v_mov_b64 v[68:69], 0
 v_smfmac_f32_16x16x64_bf16 v[48:51], v[56:59], v[28:35], v5
 v_mov_b64 v[70:71], 0
 v_smfmac_f32_16x16x64_bf16 v[36:39], v[60:63], a[136:143], v5
 ds_read_b128 v[32:35], v3 offset:11264
 v_mov_b64 v[28:29], 0
 v_smfmac_f32_16x16x64_bf16 v[40:43], v[60:63], a[144:151], v5
 v_mov_b64 v[30:31], 0
 v_smfmac_f32_16x16x64_bf16 v[44:47], v[60:63], a[152:159], v5
 ds_read_b128 v[56:59], v3 offset:1024
 s_waitcnt lgkmcnt(2)
 v_add_f32 v36, v36, v38
 v_smfmac_f32_16x16x64_bf16 v[48:51], v[60:63], v[20:27], v5
 ds_read_b128 v[60:63], v3 offset:2048
 ds_read_b128 v[20:23], v3 offset:9216
 v_add_f32 v37, v37, v39
 v_cvt_pk_bf16_f32 v36, v36, v37
 v_smfmac_f32_16x16x64_bf16 v[64:67], v[52:55], v[96:103], v5
 ds_write_b16 v10, v36 offset:17408
 ds_write_b16_d16_hi v10, v36 offset:17472
 v_add_f32 v40, v40, v42
 v_add_f32 v41, v41, v43
 v_cvt_pk_bf16_f32 v40, v40, v41
 v_smfmac_f32_16x16x64_bf16 v[68:71], v[52:55], v[104:111], v5
 ds_write_b16 v10, v40 offset:17412
 ds_write_b16_d16_hi v10, v40 offset:17476
 v_add_f32 v44, v44, v46
 v_add_f32 v45, v45, v47
 v_add_f32 v48, v48, v50
 v_add_f32 v49, v49, v51
 v_cvt_pk_bf16_f32 v44, v44, v45
 v_cvt_pk_bf16_f32 v45, v48, v49
 ds_write_b64 v8, v[44:45] offset:19456
 s_waitcnt lgkmcnt(7)
 v_smfmac_f32_16x16x64_bf16 v[64:67], v[56:59], v[136:143], v5
 ds_read_b128 v[52:55], v3 offset:3072
 ds_read_b128 v[24:27], v3 offset:10240
 v_smfmac_f32_16x16x64_bf16 v[68:71], v[56:59], v[144:151], v5
 ds_read_b128 v[56:59], v3 offset:4096
 s_waitcnt lgkmcnt(9)
 v_smfmac_f32_16x16x64_bf16 v[64:67], v[60:63], v[176:183], v5
 v_smfmac_f32_16x16x64_bf16 v[68:71], v[60:63], v[184:191], v5
 s_waitcnt lgkmcnt(3)
 s_barrier
 ds_read_b128 v[36:39], v11 offset:17408
 ds_read_b128 v[40:43], v11 offset:17920
 s_waitcnt lgkmcnt(4)
 v_smfmac_f32_16x16x64_bf16 v[64:67], v[52:55], v[216:223], v5
 ds_read_b64_tr_b16 v[60:61], v9 offset:19456
 ds_read_b64_tr_b16 v[62:63], v9 offset:19488
 v_smfmac_f32_16x16x64_bf16 v[68:71], v[52:55], v[224:231], v5
 ds_read_b128 v[52:55], v3 offset:5120
 ds_read_b128 v[44:47], v11 offset:18432
 s_waitcnt lgkmcnt(6)
 v_smfmac_f32_16x16x64_bf16 v[64:67], v[56:59], a[0:7], v5
 ds_read_b128 v[48:51], v11 offset:18944
 v_smfmac_f32_16x16x64_bf16 v[68:71], v[56:59], a[8:15], v5
 ds_read_b128 v[56:59], v3 offset:6144
 s_waitcnt lgkmcnt(7)
 v_mfma_f32_16x16x32_bf16 v[20:23], v[20:23], v[36:39], 0
 v_mfma_f32_16x16x32_bf16 v[24:27], v[24:27], v[36:39], 0
 s_waitcnt lgkmcnt(6)
 v_mfma_f32_16x16x32_bf16 v[20:23], v[32:35], v[40:43], v[20:23]
 ds_read_b128 v[32:35], v3 offset:12288
 s_waitcnt lgkmcnt(5)
 v_smfmac_f32_16x16x64_bf16 v[28:31], v[60:63], v[36:43], v5
 ds_read_b64_tr_b16 v[60:61], v9 offset:20544
 ds_read_b64_tr_b16 v[62:63], v9 offset:20576
 ds_read_b128 v[36:39], v3 offset:13312
 s_waitcnt lgkmcnt(7)
 v_smfmac_f32_16x16x64_bf16 v[64:67], v[52:55], a[40:47], v5
 v_smfmac_f32_16x16x64_bf16 v[68:71], v[52:55], a[48:55], v5
 ds_read_b128 v[52:55], v3 offset:7168
 s_waitcnt lgkmcnt(4)
 v_mfma_f32_16x16x32_bf16 v[24:27], v[32:35], v[40:43], v[24:27]
 ds_read_b128 v[40:43], v3 offset:14336
 ds_read_b128 v[32:35], v3 offset:15360
 s_waitcnt lgkmcnt(4)
 v_smfmac_f32_16x16x64_bf16 v[28:31], v[60:63], v[44:51], v5
 ds_read_b128 v[60:63], v3 offset:16384
 s_waitcnt lgkmcnt(4)
 v_mfma_f32_16x16x32_bf16 v[20:23], v[36:39], v[44:47], v[20:23]
 v_smfmac_f32_16x16x64_bf16 v[64:67], v[56:59], a[80:87], v5
 v_smfmac_f32_16x16x64_bf16 v[68:71], v[56:59], a[88:95], v5
 ds_read_b128 v[56:59], v3 offset:8192
 v_add_f32 v28, v28, v30
 s_waitcnt lgkmcnt(3)
 v_mfma_f32_16x16x32_bf16 v[24:27], v[40:43], v[44:47], v[24:27]
 v_add_f32 v29, v29, v31
 v_max_f32 v30, v28, v29
 s_waitcnt lgkmcnt(2)
 v_mfma_f32_16x16x32_bf16 v[20:23], v[32:35], v[48:51], v[20:23]
 v_cndmask_b32 v28, v28, v29, s[48:49]
 s_waitcnt lgkmcnt(1)
 v_mfma_f32_16x16x32_bf16 v[24:27], v[60:63], v[48:51], v[24:27]
 v_mov_b64 v[32:33], s[34:35]
 v_mov_b64 v[34:35], s[34:35]
 v_smfmac_f32_16x16x64_bf16 v[64:67], v[52:55], a[120:127], v5
 ds_read_b128 v[36:39], v0 offset:32768
 ds_read_b128 v[40:43], v0 offset:36864
 v_max3_f32 v30, v30, v20, v21
 v_smfmac_f32_16x16x64_bf16 v[68:71], v[52:55], a[128:135], v5
 ds_read_b128 v[44:47], v0 offset:40960
 ds_read_b128 v[48:51], v0 offset:45056
 v_max3_f32 v30, v30, v22, v23
 v_max3_f32 v30, v30, v24, v25
 v_max3_f32 v31, v30, v26, v27
 v_max3_f32 v29, v30, v26, v27
 s_waitcnt lgkmcnt(4)
 v_smfmac_f32_16x16x64_bf16 v[64:67], v[56:59], a[160:167], v5
 v_cndmask_b32 v20, v20, v24, s[48:49]
 v_smfmac_f32_16x16x64_bf16 v[68:71], v[56:59], a[168:175], v5
 v_cndmask_b32 v21, v21, v25, s[48:49]
 v_permlane16_swap_b32 v31, v29
 v_max_f32 v30, v31, v29
 v_max_f32 v6, v31, v29
 v_cndmask_b32 v22, v22, v26, s[48:49]
 v_cndmask_b32 v23, v23, v27, s[48:49]
 v_permlane32_swap_b32 v30, v6
 v_max_f32 v30, v30, v6
 v_mul_f32 v30, -s55, v30
 v_fma_f32 v28, v28, s55, v30
 v_fma_f32 v20, v20, s55, v30
 v_fma_f32 v21, v21, s55, v30
 v_fma_f32 v22, v22, s55, v30
 v_fma_f32 v23, v23, s55, v30
 v_exp_f32 v28, v28
 v_add_f32 v64, v64, v66
 v_add_f32 v65, v65, v67
 v_cndmask_b32 v29, 0, v28, s[48:49]
 v_cndmask_b32 v28, v28, 0, s[48:49]
 v_cvt_pk_bf16_f32 v6, v28, v29
 v_add_f32 v68, v68, v70
 v_add_f32 v69, v69, v71
 v_mfma_f32_16x16x16_bf16 v[60:63], v[6:7], v[32:33], 0
 v_cvt_pk_bf16_f32 v2, v64, v65
 v_cvt_pk_bf16_f32 v4, v68, v69
 v_exp_f32 v20, v20
 v_exp_f32 v21, v21
 v_mfma_f32_16x16x16_bf16 v[52:55], v[6:7], v[2:3], 0
 s_waitcnt vmcnt(3)
 v_exp_f32 v22, v22
 v_mfma_f32_16x16x16_bf16 v[56:59], v[6:7], v[4:5], 0
 s_cmp_eq_u32 s36, 63
 v_exp_f32 v23, v23
 v_cvt_pk_bf16_f32 v30, v20, v21
 v_cvt_pk_bf16_f32 v31, v22, v23
 v_mov_b64 v[64:65], 0
 v_mov_b64 v[66:67], 0
 v_smfmac_f32_16x16x32_bf16 v[60:63], v[30:31], v[32:35], v5
 v_mov_b64 v[68:69], 0
 v_mov_b64 v[70:71], 0
 v_smfmac_f32_16x16x32_bf16 v[52:55], v[30:31], v[12:15], v5
 v_mov_b64 v[20:21], 0
 v_mov_b64 v[22:23], 0
 v_smfmac_f32_16x16x32_bf16 v[56:59], v[30:31], v[16:19], v5
 s_nop 0
 v_add_f32 v60, v60, v62
 v_add_f32 v61, v61, v63
 v_rcp_f32 v60, v60
 v_rcp_f32 v61, v61
 v_add_f32 v52, v52, v54
 v_add_f32 v53, v53, v55
 v_mul_f32 v52, v52, v60
 v_mul_f32 v53, v53, v61
 v_add_f32 v56, v56, v58
 v_add_f32 v57, v57, v59
 v_mul_f32 v56, v56, v60
 v_mul_f32 v57, v57, v61
 v_cvt_pk_bf16_f32 v52, v52, v53
 v_cvt_pk_bf16_f32 v53, v56, v57
 ds_write_b64 v8, v[52:53] offset:21632
 s_cbranch_scc1 Lchexit_44
 v_bfe_u32 v6, v0, 7, 5
 v_mul_u32_u24 v6, 10496, v6
 v_bfe_u32 v60, v3, 4, 3
 v_lshl_add_u32 v6, v60, 3, v6
 s_xor_b32 s46, s46, 0x1
 v_mov_b64 v[24:25], 0
 s_add_u32 s67, s67, 0x80000
 v_mov_b64 v[26:27], 0
 s_add_u32 s59, s59, 0x80000
 v_mov_b64 v[28:29], 0
 s_add_u32 s38, s38, 0x20000
 v_mov_b64 v[30:31], 0
 s_waitcnt lgkmcnt(0)
 s_barrier
 ds_read_b64_tr_b16 v[52:53], v9 offset:21632
 ds_read_b64_tr_b16 v[54:55], v9 offset:21664
 v_mov_b64 v[32:33], 0
 ds_read_b64_tr_b16 v[56:57], v9 offset:22720
 ds_read_b64_tr_b16 v[58:59], v9 offset:22752
 v_mov_b64 v[34:35], 0
 s_cmp_lt_u32 s36, 61
 v_mov_b64 v[12:13], 0
 s_cselect_b32 s47, 0x80000, 0
 v_mov_b64 v[14:15], 0
 s_add_u32 s68, s68, s47
 v_mov_b64 v[16:17], 0
 s_add_u32 s36, s36, 1
 v_mov_b64 v[18:19], 0
 s_waitcnt lgkmcnt(2)
 v_smfmac_f32_16x16x64_bf16 v[64:67], v[52:55], a[248:255], v5
 s_add_u32 s58, s36, 3
 s_min_u32 s58, s58, 64
 v_mov_b64 v[60:61], 0
 v_smfmac_f32_16x16x64_bf16 v[68:71], v[52:55], a[176:183], v5
 buffer_load_dwordx4 v3, s[20:23], s67 offen offset:0 sc1 lds
 v_mov_b64 v[62:63], 0
 s_waitcnt lgkmcnt(0)
 v_smfmac_f32_16x16x64_bf16 v[64:67], v[56:59], v[36:43], v5
 ds_read_b128 v[36:39], v0 offset:49152
 ds_read_b128 v[40:43], v0 offset:53248
 v_smfmac_f32_16x16x64_bf16 v[20:23], v[52:55], a[184:191], v5
 buffer_load_dwordx4 v3, s[20:23], s67 offen offset:1024 sc1 lds
 v_smfmac_f32_16x16x64_bf16 v[68:71], v[56:59], v[44:51], v5
 ds_read_b128 v[44:47], v0 offset:57344
 ds_read_b128 v[48:51], v0 offset:61440
 v_add_f32 v64, v64, v66
 v_add_f32 v65, v65, v67
 v_smfmac_f32_16x16x64_bf16 v[24:27], v[52:55], a[192:199], v5
 s_xor_b32 s44, s44, 0x80000
 s_xor_b32 s45, s45, 0x80000
 v_cvt_pk_bf16_f32 v65, v65, v65
 v_cvt_pk_bf16_f32 v64, v64, v64
 s_waitcnt lgkmcnt(2)
 v_add_u32 v0, 0x10000, v0
 v_smfmac_f32_16x16x64_bf16 v[20:23], v[56:59], v[36:43], v5
 ds_read_b128 v[36:39], v0 offset:0
 ds_read_b128 v[40:43], v0 offset:4096
 v_and_or_b32 v65, v65, -2, s46
 v_smfmac_f32_16x16x64_bf16 v[28:31], v[52:55], a[200:207], v5
 buffer_store_dwordx2 v[64:65], v6, s[20:23], s62 offen
 v_add_f32 v68, v68, v70
 v_add_f32 v69, v69, v71
 s_waitcnt lgkmcnt(2)
 v_smfmac_f32_16x16x64_bf16 v[24:27], v[56:59], v[44:51], v5
 ds_read_b128 v[44:47], v0 offset:8192
 ds_read_b128 v[48:51], v0 offset:12288
 v_add_f32 v20, v20, v22
 v_add_f32 v21, v21, v23
 v_smfmac_f32_16x16x64_bf16 v[32:35], v[52:55], a[208:215], v5
 s_xor_b32 s65, s65, 0x80000
 s_xor_b32 s66, s66, 0x80000
 v_cvt_pk_bf16_f32 v69, v69, v21
 v_cvt_pk_bf16_f32 v68, v68, v20
 s_waitcnt lgkmcnt(2)
 v_smfmac_f32_16x16x64_bf16 v[28:31], v[56:59], v[36:43], v5
 ds_read_b128 v[36:39], v0 offset:16384
 ds_read_b128 v[40:43], v0 offset:20480
 v_and_or_b32 v69, v69, -2, s46
 v_smfmac_f32_16x16x64_bf16 v[12:15], v[52:55], a[216:223], v5
 buffer_store_dwordx2 v[68:69], v6, s[20:23], s60 offen offset:0
 v_add_f32 v24, v24, v26
 v_add_f32 v25, v25, v27
 s_waitcnt lgkmcnt(2)
 v_smfmac_f32_16x16x64_bf16 v[32:35], v[56:59], v[44:51], v5
 ds_read_b128 v[44:47], v0 offset:24576
 ds_read_b128 v[48:51], v0 offset:28672
 v_add_f32 v28, v28, v30
 v_add_f32 v29, v29, v31
 v_smfmac_f32_16x16x64_bf16 v[16:19], v[52:55], a[224:231], v5
 s_xor_b32 s41, s41, 0x80000
 s_xor_b32 s43, s43, 0x80000
 v_cvt_pk_bf16_f32 v25, v25, v29
 v_cvt_pk_bf16_f32 v24, v24, v28
 s_waitcnt lgkmcnt(2)
 v_smfmac_f32_16x16x64_bf16 v[12:15], v[56:59], v[36:43], v5
 v_and_or_b32 v25, v25, -2, s46
 v_smfmac_f32_16x16x64_bf16 v[60:63], v[52:55], a[232:239], v5
 buffer_store_dwordx2 v[24:25], v6, s[20:23], s60 offen offset:2048
 v_add_f32 v32, v32, v34
 v_add_f32 v33, v33, v35
 s_waitcnt lgkmcnt(0)
 v_smfmac_f32_16x16x64_bf16 v[16:19], v[56:59], v[44:51], v5
 s_nop 0
 v_add_f32 v12, v12, v14
 v_add_f32 v13, v13, v15
 v_smfmac_f32_16x16x64_bf16 v[60:63], v[56:59], a[240:247], v5
 v_cvt_pk_bf16_f32 v33, v33, v13
 v_cvt_pk_bf16_f32 v32, v32, v12
 v_and_or_b32 v33, v33, -2, s46
 buffer_store_dwordx2 v[32:33], v6, s[20:23], s61 offen offset:0
 v_add_f32 v16, v16, v18
 v_add_f32 v17, v17, v19
 s_cmp_eq_u32 s4, 0
 s_nop 0
 v_add_f32 v60, v60, v62
 v_add_f32 v61, v61, v63
 v_cvt_pk_bf16_f32 v17, v17, v61
 v_cvt_pk_bf16_f32 v16, v16, v60
 v_and_or_b32 v17, v17, -2, s46
 buffer_store_dwordx2 v[16:17], v6, s[20:23], s61 offen offset:2048
 s_cbranch_scc1 LwH_47
 v_mov_b32 v47, 0x3f80
 v_cndmask_b32 v47, v47, 1.0, s[32:33]
 v_cndmask_b32 v44, 0, v47, s[24:25]
 v_cndmask_b32 v45, 0, v47, s[26:27]
 v_cndmask_b32 v46, 0, v47, s[28:29]
 v_cndmask_b32 v47, 0, v47, s[30:31]
 v_bfe_u32 v52, v3, 8, 2
 v_bfe_u32 v58, v3, 2, 4
 v_lshl_or_b32 v52, v52, 4, v58
 v_and_b32 v58, 0xc0, v3
 v_lshl_or_b32 v52, v58, 24, v52
 v_subrev_u32 v0, 0x20000, v0
 v_mov_b32 v59, -1
 v_add_u32 v54, s42, v3
 v_add_u32 v58, s69, v9
 ds_read_b64_tr_b16 v[64:65], v58 offset:19456
 v_mov_b32 v66, v2
 v_mov_b32 v67, v4
 ds_read_b128 v[20:23], v0 offset:24576
 ds_read_b128 v[24:27], v0 offset:28672
 ds_read_b128 v[28:31], v0 offset:32768
 ds_read_b128 v[32:35], v0 offset:36864
 s_cmp_eq_u32 s4, 1
 s_waitcnt vmcnt(2)
 s_cbranch_scc1 Lq1_48
 s_cmp_eq_u32 s4, 2
 s_waitcnt vmcnt(1)
 s_cbranch_scc1 Lq1_48
 s_waitcnt vmcnt(0)
Lq1_48:
 buffer_load_dwordx4 v[36:39], v3, s[20:23], s39 offen offset:0 sc1
 buffer_load_dwordx4 v[40:43], v3, s[20:23], s39 offen offset:1024 sc1
 s_nop 15
 s_nop 11
 buffer_load_dwordx4 v[12:15], v3, s[20:23], s39 offen offset:0 sc1
 buffer_load_dwordx4 v[16:19], v3, s[20:23], s39 offen offset:1024 sc1
 s_waitcnt vmcnt(3)
 v_mfma_f32_16x16x32_bf16 v[48:51], v[44:47], v[36:39], 0
 s_waitcnt vmcnt(2)
 v_mfma_f32_16x16x32_bf16 v[48:51], v[44:47], v[40:43], v[48:51]
 v_bitop3_b32 v55, v37, v39, s46 bitop3:0x7e
 v_bitop3_b32 v56, v41, v43, s46 bitop3:0x7e
 v_bitop3_b32 v55, v55, 1, v56 bitop3:0xc8
 v_cmp_ne_u32 vcc, 0, v55
 s_nop 3
 v_add_f32_dpp v48, v48, v48 row_ror:4 row_mask:0xf bank_mask:0xf
 v_add_f32_dpp v49, v49, v49 row_ror:4 row_mask:0xf bank_mask:0xf
 s_cbranch_vccnz Lr2_50
 v_add_f32_dpp v48, v48, v48 row_ror:8 row_mask:0xf bank_mask:0xf
 v_add_f32_dpp v49, v49, v49 row_ror:8 row_mask:0xf bank_mask:0xf
 v_cvt_pk_bf16_f32 v48, v48, v49
 buffer_store_dword v48, v52, s[20:23], s44 offen
Lb1_51:
 buffer_store_dword v59, v52, s[20:23], s45 offen
 v_cmp_gt_u32 vcc, s58, v1
 v_mov_b64 v[36:37], 0
 v_mov_b64 v[38:39], 0
 v_mov_b64 v[40:41], 0
 v_mov_b64 v[42:43], 0
 v_mov_b64 v[44:45], 0
 v_mov_b64 v[46:47], 0
 v_mov_b64 v[48:49], 0
 v_mov_b64 v[50:51], 0
 s_cmp_lg_u32 vcc_hi, 0
 s_cbranch_scc1 Lfw_53
Lfok_52:
 v_lshl_add_u32 v1, v3, 3, s68
 v_mov_b32 v6, s56
 v_cndmask_b32 v1, v6, v1, s[70:71]
 s_nop 15
 s_nop 3
 buffer_load_dwordx4 v[12:15], v3, s[20:23], s41 offen offset:0 sc1
 buffer_load_dwordx4 v[16:19], v3, s[20:23], s41 offen offset:1024 sc1
 s_nop 15
 s_nop 7
Lp2_54:
 buffer_load_dwordx4 v[12:15], v3, s[20:23], s41 offen offset:0 sc1
 buffer_load_dwordx4 v[16:19], v3, s[20:23], s41 offen offset:1024 sc1
 s_waitcnt vmcnt(2)
 v_max3_u32 v55, v12, v13, v14
 v_max3_u32 v55, v55, v15, v16
 v_max3_u32 v55, v55, v17, v18
 v_max_u32 v55, v55, v19
 ds_write_b128 v54, v[12:15] offset:0
 ds_write_b128 v54, v[16:19] offset:1024
 v_cmpx_eq_u32 vcc, -1, v55
 s_cbranch_execz Lstep_45
 buffer_load_dwordx4 v[12:15], v3, s[20:23], s41 offen offset:0 sc1
 buffer_load_dwordx4 v[16:19], v3, s[20:23], s41 offen offset:1024 sc1
 s_waitcnt vmcnt(2)
 v_max3_u32 v55, v12, v13, v14
 v_max3_u32 v55, v55, v15, v16
 v_max3_u32 v55, v55, v17, v18
 v_max_u32 v55, v55, v19
 ds_write_b128 v54, v[12:15] offset:0
 ds_write_b128 v54, v[16:19] offset:1024
 v_cmpx_eq_u32 vcc, -1, v55
 s_cbranch_execz Lstep_45
 buffer_load_dwordx4 v[12:15], v3, s[20:23], s41 offen offset:0 sc1
 buffer_load_dwordx4 v[16:19], v3, s[20:23], s41 offen offset:1024 sc1
 s_waitcnt vmcnt(2)
 v_max3_u32 v55, v12, v13, v14
 v_max3_u32 v55, v55, v15, v16
 v_max3_u32 v55, v55, v17, v18
 v_max_u32 v55, v55, v19
 ds_write_b128 v54, v[12:15] offset:0
 ds_write_b128 v54, v[16:19] offset:1024
 v_cmpx_eq_u32 vcc, -1, v55
 s_cbranch_execz Lstep_45
 s_sub_u32 s54, s54, 1
 s_cbranch_scc0 Lp2_54
 s_endpgm
LwH_47:
 v_bfe_u32 v53, v3, 8, 1
 v_bfe_u32 v58, v3, 9, 1
 v_lshl_or_b32 v53, v53, 1, v58
 v_bfe_u32 v58, v3, 5, 1
 v_lshl_or_b32 v53, v53, 1, v58
 v_and_b32 v58, 0xd0, v3
 v_lshlrev_b32 v58, 24, v58
 v_lshl_or_b32 v53, v53, 2, v58
 s_waitcnt vmcnt(2)
 buffer_load_dwordx4 v[20:23], v3, s[20:23], s40 offen offset:0 sc1
 buffer_load_dwordx4 v[24:27], v3, s[20:23], s40 offen offset:1024 sc1
 buffer_load_dwordx4 v[36:39], v3, s[20:23], s39 offen offset:0 sc1
 buffer_load_dwordx4 v[40:43], v3, s[20:23], s39 offen offset:1024 sc1
 v_mov_b32 v47, 0x3f80
 v_cndmask_b32 v47, v47, 1.0, s[32:33]
 v_cndmask_b32 v44, 0, v47, s[24:25]
 v_cndmask_b32 v45, 0, v47, s[26:27]
 v_cndmask_b32 v46, 0, v47, s[28:29]
 v_cndmask_b32 v47, 0, v47, s[30:31]
 v_bfe_u32 v52, v3, 8, 2
 v_bfe_u32 v58, v3, 2, 4
 v_lshl_or_b32 v52, v52, 4, v58
 v_and_b32 v58, 0xc0, v3
 v_lshl_or_b32 v52, v58, 24, v52
 v_subrev_u32 v0, 0x20000, v0
 v_mov_b32 v59, -1
 v_add_u32 v54, s42, v3
 v_add_u32 v58, s69, v9
 ds_read_b64_tr_b16 v[64:65], v58 offset:19456
 v_mov_b32 v66, v2
 v_mov_b32 v67, v4
 s_waitcnt vmcnt(2)
 v_mfma_f32_16x16x32_bf16 v[28:31], v[44:47], v[20:23], 0
 v_mfma_f32_16x16x32_bf16 v[28:31], v[44:47], v[24:27], v[28:31]
 s_waitcnt vmcnt(1)
 v_mfma_f32_16x16x32_bf16 v[48:51], v[44:47], v[36:39], 0
 s_waitcnt vmcnt(0)
 v_mfma_f32_16x16x32_bf16 v[48:51], v[44:47], v[40:43], v[48:51]
 v_bitop3_b32 v55, v37, v39, s46 bitop3:0x7e
 v_bitop3_b32 v56, v41, v43, s46 bitop3:0x7e
 v_bitop3_b32 v57, v21, v23, s46 bitop3:0x7e
 v_or3_b32 v55, v55, v56, v57
 v_bitop3_b32 v56, v25, v27, s46 bitop3:0x7e
 v_bitop3_b32 v55, v55, 1, v56 bitop3:0xc8
 v_cmp_ne_u32 vcc, 0, v55
 v_add_f32_dpp v29, v29, v29 row_ror:4 row_mask:0xf bank_mask:0xf
 v_add_f32_dpp v48, v48, v48 row_ror:4 row_mask:0xf bank_mask:0xf
 v_add_f32_dpp v49, v49, v49 row_ror:4 row_mask:0xf bank_mask:0xf
 v_add_f32_dpp v29, v29, v29 row_ror:8 row_mask:0xf bank_mask:0xf
 v_add_f32_dpp v48, v48, v48 row_ror:8 row_mask:0xf bank_mask:0xf
 v_add_f32_dpp v49, v49, v49 row_ror:8 row_mask:0xf bank_mask:0xf
 s_cbranch_vccnz Lr1_55
 v_cvt_pk_bf16_f32 v48, v48, v49
 buffer_store_dword v48, v52, s[20:23], s44 offen
 v_mov_b32_dpp v30, v29 quad_perm:[1,0,3,2] row_mask:0xf bank_mask:0xf
 v_cvt_pk_bf16_f32 v29, v29, v30
 buffer_store_dword v29, v53, s[20:23], s65 offen
Lb1_56:
 buffer_store_dword v59, v52, s[20:23], s45 offen
 buffer_store_dword v59, v53, s[20:23], s66 offen
 v_cmp_gt_u32 vcc, s58, v1
 ds_read_b128 v[20:23], v0 offset:24576
 ds_read_b128 v[24:27], v0 offset:28672
 ds_read_b128 v[28:31], v0 offset:32768
 ds_read_b128 v[32:35], v0 offset:36864
 v_mov_b64 v[36:37], 0
 v_mov_b64 v[38:39], 0
 v_mov_b64 v[40:41], 0
 v_mov_b64 v[42:43], 0
 v_mov_b64 v[44:45], 0
 v_mov_b64 v[46:47], 0
 v_mov_b64 v[48:49], 0
 v_mov_b64 v[50:51], 0
 s_cmp_lg_u32 vcc_hi, 0
 s_cbranch_scc1 Lfw_58
Lfok_57:
 v_lshl_add_u32 v1, v3, 3, s68
 v_mov_b32 v6, s56
 v_cndmask_b32 v1, v6, v1, s[70:71]
 s_nop 13
 buffer_load_dwordx4 v[12:15], v3, s[20:23], s41 offen offset:0 sc1
 buffer_load_dwordx4 v[16:19], v3, s[20:23], s41 offen offset:1024 sc1
 buffer_load_dwordx4 v[68:71], v3, s[20:23], s43 offen offset:0 sc1
 s_nop 15
 s_nop 7
Lp2_59:
 buffer_load_dwordx4 v[12:15], v3, s[20:23], s41 offen offset:0 sc1
 buffer_load_dwordx4 v[16:19], v3, s[20:23], s41 offen offset:1024 sc1
 buffer_load_dwordx4 v[68:71], v3, s[20:23], s43 offen offset:0 sc1
 s_waitcnt vmcnt(3)
 v_max3_u32 v55, v12, v13, v14
 v_max3_u32 v55, v55, v15, v16
 v_max3_u32 v55, v55, v17, v18
 v_max3_u32 v55, v55, v19, v68
 v_max3_u32 v55, v55, v69, v70
 v_max_u32 v55, v55, v71
 ds_write_b128 v54, v[12:15] offset:0
 ds_write_b128 v54, v[16:19] offset:1024
 ds_write_b128 v54, v[68:71] offset:8192
 v_cmpx_eq_u32 vcc, -1, v55
 s_cbranch_execz Lstep_45
 buffer_load_dwordx4 v[12:15], v3, s[20:23], s41 offen offset:0 sc1
 buffer_load_dwordx4 v[16:19], v3, s[20:23], s41 offen offset:1024 sc1
 buffer_load_dwordx4 v[68:71], v3, s[20:23], s43 offen offset:0 sc1
 s_waitcnt vmcnt(3)
 v_max3_u32 v55, v12, v13, v14
 v_max3_u32 v55, v55, v15, v16
 v_max3_u32 v55, v55, v17, v18
 v_max3_u32 v55, v55, v19, v68
 v_max3_u32 v55, v55, v69, v70
 v_max_u32 v55, v55, v71
 ds_write_b128 v54, v[12:15] offset:0
 ds_write_b128 v54, v[16:19] offset:1024
 ds_write_b128 v54, v[68:71] offset:8192
 v_cmpx_eq_u32 vcc, -1, v55
 s_cbranch_execz Lstep_45
 buffer_load_dwordx4 v[12:15], v3, s[20:23], s41 offen offset:0 sc1
 buffer_load_dwordx4 v[16:19], v3, s[20:23], s41 offen offset:1024 sc1
 buffer_load_dwordx4 v[68:71], v3, s[20:23], s43 offen offset:0 sc1
 s_waitcnt vmcnt(3)
 v_max3_u32 v55, v12, v13, v14
 v_max3_u32 v55, v55, v15, v16
 v_max3_u32 v55, v55, v17, v18
 v_max3_u32 v55, v55, v19, v68
 v_max3_u32 v55, v55, v69, v70
 v_max_u32 v55, v55, v71
 ds_write_b128 v54, v[12:15] offset:0
 ds_write_b128 v54, v[16:19] offset:1024
 ds_write_b128 v54, v[68:71] offset:8192
 v_cmpx_eq_u32 vcc, -1, v55
 s_cbranch_execz Lstep_45
 s_sub_u32 s54, s54, 1
 s_cbranch_scc0 Lp2_59
 s_endpgm
Lr1_55:
 s_mov_b64 exec, vcc
Lrt_60:
 buffer_load_dwordx4 v[20:23], v3, s[20:23], s40 offen offset:0 sc1
 buffer_load_dwordx4 v[24:27], v3, s[20:23], s40 offen offset:1024 sc1
 buffer_load_dwordx4 v[36:39], v3, s[20:23], s39 offen offset:0 sc1
 buffer_load_dwordx4 v[40:43], v3, s[20:23], s39 offen offset:1024 sc1
 s_waitcnt vmcnt(4)
 v_bitop3_b32 v55, v37, v39, s46 bitop3:0x7e
 v_bitop3_b32 v56, v41, v43, s46 bitop3:0x7e
 v_bitop3_b32 v57, v21, v23, s46 bitop3:0x7e
 v_or3_b32 v55, v55, v56, v57
 v_bitop3_b32 v56, v25, v27, s46 bitop3:0x7e
 v_bitop3_b32 v55, v55, 1, v56 bitop3:0xc8
 v_cmpx_ne_u32 vcc, 0, v55
 s_cbranch_execz Lrte_61
 buffer_load_dwordx4 v[20:23], v3, s[20:23], s40 offen offset:0 sc1
 buffer_load_dwordx4 v[24:27], v3, s[20:23], s40 offen offset:1024 sc1
 buffer_load_dwordx4 v[36:39], v3, s[20:23], s39 offen offset:0 sc1
 buffer_load_dwordx4 v[40:43], v3, s[20:23], s39 offen offset:1024 sc1
 s_waitcnt vmcnt(4)
 v_bitop3_b32 v55, v37, v39, s46 bitop3:0x7e
 v_bitop3_b32 v56, v41, v43, s46 bitop3:0x7e
 v_bitop3_b32 v57, v21, v23, s46 bitop3:0x7e
 v_or3_b32 v55, v55, v56, v57
 v_bitop3_b32 v56, v25, v27, s46 bitop3:0x7e
 v_bitop3_b32 v55, v55, 1, v56 bitop3:0xc8
 v_cmpx_ne_u32 vcc, 0, v55
 s_cbranch_execz Lrte_61
 buffer_load_dwordx4 v[20:23], v3, s[20:23], s40 offen offset:0 sc1
 buffer_load_dwordx4 v[24:27], v3, s[20:23], s40 offen offset:1024 sc1
 buffer_load_dwordx4 v[36:39], v3, s[20:23], s39 offen offset:0 sc1
 buffer_load_dwordx4 v[40:43], v3, s[20:23], s39 offen offset:1024 sc1
 s_waitcnt vmcnt(4)
 v_bitop3_b32 v55, v37, v39, s46 bitop3:0x7e
 v_bitop3_b32 v56, v41, v43, s46 bitop3:0x7e
 v_bitop3_b32 v57, v21, v23, s46 bitop3:0x7e
 v_or3_b32 v55, v55, v56, v57
 v_bitop3_b32 v56, v25, v27, s46 bitop3:0x7e
 v_bitop3_b32 v55, v55, 1, v56 bitop3:0xc8
 v_cmpx_ne_u32 vcc, 0, v55
 s_cbranch_execz Lrte_61
 s_sub_u32 s54, s54, 1
 s_cbranch_scc0 Lrt_60
 s_endpgm
Lrte_61:
 s_mov_b64 exec, -1
 s_nop 2
 v_mfma_f32_16x16x32_bf16 v[28:31], v[44:47], v[20:23], 0
 v_mfma_f32_16x16x32_bf16 v[28:31], v[44:47], v[24:27], v[28:31]
 v_mfma_f32_16x16x32_bf16 v[48:51], v[44:47], v[36:39], 0
 v_mfma_f32_16x16x32_bf16 v[48:51], v[44:47], v[40:43], v[48:51]
 s_nop 6
 v_add_f32_dpp v29, v29, v29 row_ror:4 row_mask:0xf bank_mask:0xf
 v_add_f32_dpp v48, v48, v48 row_ror:4 row_mask:0xf bank_mask:0xf
 v_add_f32_dpp v49, v49, v49 row_ror:4 row_mask:0xf bank_mask:0xf
 v_add_f32_dpp v29, v29, v29 row_ror:8 row_mask:0xf bank_mask:0xf
 v_add_f32_dpp v48, v48, v48 row_ror:8 row_mask:0xf bank_mask:0xf
 v_add_f32_dpp v49, v49, v49 row_ror:8 row_mask:0xf bank_mask:0xf
 v_cvt_pk_bf16_f32 v48, v48, v49
 buffer_store_dword v48, v52, s[20:23], s44 offen
 v_mov_b32_dpp v30, v29 quad_perm:[1,0,3,2] row_mask:0xf bank_mask:0xf
 v_cvt_pk_bf16_f32 v29, v29, v30
 buffer_store_dword v29, v53, s[20:23], s65 offen
 s_waitcnt vmcnt(2)
 s_branch Lb1_56
Lr2_50:
 s_waitcnt vmcnt(1)
 v_mfma_f32_16x16x32_bf16 v[48:51], v[44:47], v[12:15], 0
 s_waitcnt vmcnt(0)
 v_mfma_f32_16x16x32_bf16 v[48:51], v[44:47], v[16:19], v[48:51]
 v_bitop3_b32 v55, v13, v15, s46 bitop3:0x7e
 v_bitop3_b32 v56, v17, v19, s46 bitop3:0x7e
 v_bitop3_b32 v55, v55, 1, v56 bitop3:0xc8
 v_cmp_ne_u32 vcc, 0, v55
 s_nop 3
 v_add_f32_dpp v48, v48, v48 row_ror:4 row_mask:0xf bank_mask:0xf
 v_add_f32_dpp v49, v49, v49 row_ror:4 row_mask:0xf bank_mask:0xf
 s_cbranch_vccnz Lr1_49
 v_add_f32_dpp v48, v48, v48 row_ror:8 row_mask:0xf bank_mask:0xf
 v_add_f32_dpp v49, v49, v49 row_ror:8 row_mask:0xf bank_mask:0xf
 v_cvt_pk_bf16_f32 v48, v48, v49
 buffer_store_dword v48, v52, s[20:23], s44 offen
 s_branch Lb1_51
Lr1_49:
 s_mov_b64 exec, vcc
Lrt_62:
 buffer_load_dwordx4 v[12:15], v3, s[20:23], s39 offen offset:0 sc1
 buffer_load_dwordx4 v[16:19], v3, s[20:23], s39 offen offset:1024 sc1
 s_waitcnt vmcnt(2)
 v_bitop3_b32 v55, v13, v15, s46 bitop3:0x7e
 v_bitop3_b32 v56, v17, v19, s46 bitop3:0x7e
 v_bitop3_b32 v55, v55, 1, v56 bitop3:0xc8
 v_cmpx_ne_u32 vcc, 0, v55
 s_cbranch_execz Lrte_63
 buffer_load_dwordx4 v[12:15], v3, s[20:23], s39 offen offset:0 sc1
 buffer_load_dwordx4 v[16:19], v3, s[20:23], s39 offen offset:1024 sc1
 s_waitcnt vmcnt(2)
 v_bitop3_b32 v55, v13, v15, s46 bitop3:0x7e
 v_bitop3_b32 v56, v17, v19, s46 bitop3:0x7e
 v_bitop3_b32 v55, v55, 1, v56 bitop3:0xc8
 v_cmpx_ne_u32 vcc, 0, v55
 s_cbranch_execz Lrte_63
 buffer_load_dwordx4 v[12:15], v3, s[20:23], s39 offen offset:0 sc1
 buffer_load_dwordx4 v[16:19], v3, s[20:23], s39 offen offset:1024 sc1
 s_waitcnt vmcnt(2)
 v_bitop3_b32 v55, v13, v15, s46 bitop3:0x7e
 v_bitop3_b32 v56, v17, v19, s46 bitop3:0x7e
 v_bitop3_b32 v55, v55, 1, v56 bitop3:0xc8
 v_cmpx_ne_u32 vcc, 0, v55
 s_cbranch_execz Lrte_63
 s_sub_u32 s54, s54, 1
 s_cbranch_scc0 Lrt_62
 s_endpgm
Lrte_63:
 s_mov_b64 exec, -1
 s_nop 2
 v_mfma_f32_16x16x32_bf16 v[48:51], v[44:47], v[12:15], 0
 v_mfma_f32_16x16x32_bf16 v[48:51], v[44:47], v[16:19], v[48:51]
 s_nop 7
 v_add_f32_dpp v48, v48, v48 row_ror:4 row_mask:0xf bank_mask:0xf
 v_add_f32_dpp v49, v49, v49 row_ror:4 row_mask:0xf bank_mask:0xf
 s_nop 0
 v_add_f32_dpp v48, v48, v48 row_ror:8 row_mask:0xf bank_mask:0xf
 v_add_f32_dpp v49, v49, v49 row_ror:8 row_mask:0xf bank_mask:0xf
 v_cvt_pk_bf16_f32 v48, v48, v49
 buffer_store_dword v48, v52, s[20:23], s44 offen
 s_branch Lb1_51
Lfw_53:
Lpb_64:
 buffer_load_dword v1, v7, s[20:23], s56 offen sc1
 s_waitcnt vmcnt(0)
 v_cmp_le_u32 vcc, s58, v1
 s_cbranch_vccnz Lpbok_65
 s_sub_u32 s54, s54, 1
 s_cbranch_scc0 Lpb_64
 s_endpgm
Lpbok_65:
 s_branch Lfok_52
Lfw_58:
Lpb_66:
 buffer_load_dword v1, v7, s[20:23], s56 offen sc1
 s_waitcnt vmcnt(0)
 v_cmp_le_u32 vcc, s58, v1
 s_cbranch_vccnz Lpbok_67
 s_sub_u32 s54, s54, 1
 s_cbranch_scc0 Lpb_66
 s_endpgm
Lpbok_67:
 s_branch Lfok_57
Lfail_46:
 s_endpgm
Lslow_43:
 .p2align 3
Lstep_68:
 s_mov_b64 exec, -1
 s_waitcnt lgkmcnt(0)
 s_barrier
 ds_read_b128 v[52:55], v3 offset:0
 ds_read_b128 v[56:59], v3 offset:1024
 ds_read_b128 v[60:63], v3 offset:2048
 buffer_load_dwordx4 v[12:15], v3, s[20:23], s59 offen offset:0 sc1
 s_waitcnt lgkmcnt(2)
 v_smfmac_f32_16x16x64_bf16 v[36:39], v[52:55], v[72:79], v5
 v_smfmac_f32_16x16x64_bf16 v[40:43], v[52:55], v[80:87], v5
 buffer_load_dwordx4 v[16:19], v3, s[20:23], s59 offen offset:1024 sc1
 v_smfmac_f32_16x16x64_bf16 v[44:47], v[52:55], v[88:95], v5
 s_waitcnt lgkmcnt(1)
 v_smfmac_f32_16x16x64_bf16 v[48:51], v[52:55], v[20:27], v5
 v_smfmac_f32_16x16x64_bf16 v[36:39], v[56:59], v[112:119], v5
 ds_read_b128 v[20:23], v0 offset:40960
 v_smfmac_f32_16x16x64_bf16 v[40:43], v[56:59], v[120:127], v5
 ds_read_b128 v[24:27], v0 offset:45056
 v_smfmac_f32_16x16x64_bf16 v[44:47], v[56:59], v[128:135], v5
 ds_read_b128 v[52:55], v3 offset:3072
 s_waitcnt lgkmcnt(3)
 v_smfmac_f32_16x16x64_bf16 v[48:51], v[56:59], v[28:35], v5
 buffer_load_dword v1, v1, s[20:23], 0 offen sc1
 v_smfmac_f32_16x16x64_bf16 v[36:39], v[60:63], v[152:159], v5
 ds_read_b128 v[28:31], v0 offset:49152
 s_max_u32 s47, s36, 1
 v_smfmac_f32_16x16x64_bf16 v[40:43], v[60:63], v[160:167], v5
 ds_read_b128 v[32:35], v0 offset:53248
 s_sub_u32 s47, s47, 1
 v_smfmac_f32_16x16x64_bf16 v[44:47], v[60:63], v[168:175], v5
 ds_read_b128 v[56:59], v3 offset:4096
 s_waitcnt lgkmcnt(3)
 v_smfmac_f32_16x16x64_bf16 v[48:51], v[60:63], v[20:27], v5
 v_smfmac_f32_16x16x64_bf16 v[36:39], v[52:55], v[192:199], v5
 ds_read_b128 v[20:23], v0 offset:57344
 v_min_u32 v6, 16, v0
 v_smfmac_f32_16x16x64_bf16 v[40:43], v[52:55], v[200:207], v5
 ds_read_b128 v[24:27], v0 offset:61440
 v_lshlrev_b32 v6, 24, v6
 v_smfmac_f32_16x16x64_bf16 v[44:47], v[52:55], v[208:215], v5
 ds_read_b128 v[60:63], v3 offset:5120
 s_waitcnt lgkmcnt(3)
 v_add_u32 v0, 0x10000, v0
 v_smfmac_f32_16x16x64_bf16 v[48:51], v[52:55], v[28:35], v5
 buffer_store_dwordx4 v[64:67], v0, s[20:23], s38 offen sc1
 v_smfmac_f32_16x16x64_bf16 v[36:39], v[56:59], v[232:239], v5
 ds_read_b128 v[28:31], v0 offset:0
 v_smfmac_f32_16x16x64_bf16 v[40:43], v[56:59], v[240:247], v5
 ds_read_b128 v[32:35], v0 offset:4096
 v_smfmac_f32_16x16x64_bf16 v[44:47], v[56:59], v[248:255], v5
 ds_read_b128 v[52:55], v3 offset:6144
 s_waitcnt lgkmcnt(3)
 v_smfmac_f32_16x16x64_bf16 v[48:51], v[56:59], v[20:27], v5
 v_smfmac_f32_16x16x64_bf16 v[36:39], v[60:63], a[16:23], v5
 ds_read_b128 v[20:23], v0 offset:8192
 v_mov_b32 v64, s47
 v_smfmac_f32_16x16x64_bf16 v[40:43], v[60:63], a[24:31], v5
 ds_read_b128 v[24:27], v0 offset:12288
 v_smfmac_f32_16x16x64_bf16 v[44:47], v[60:63], a[32:39], v5
 ds_read_b128 v[56:59], v3 offset:7168
 s_waitcnt lgkmcnt(3)
 v_smfmac_f32_16x16x64_bf16 v[48:51], v[60:63], v[28:35], v5
 buffer_store_dword v64, v6, s[20:23], s57 offen sc1
 v_smfmac_f32_16x16x64_bf16 v[36:39], v[52:55], a[56:63], v5
 ds_read_b128 v[28:31], v0 offset:16384
 v_smfmac_f32_16x16x64_bf16 v[40:43], v[52:55], a[64:71], v5
 ds_read_b128 v[32:35], v0 offset:20480
 v_smfmac_f32_16x16x64_bf16 v[44:47], v[52:55], a[72:79], v5
 ds_read_b128 v[60:63], v3 offset:8192
 s_waitcnt lgkmcnt(3)
 v_smfmac_f32_16x16x64_bf16 v[48:51], v[52:55], v[20:27], v5
 s_waitcnt vmcnt(5)
 v_smfmac_f32_16x16x64_bf16 v[36:39], v[56:59], a[96:103], v5
 ds_read_b128 v[20:23], v0 offset:24576
 v_mov_b64 v[64:65], 0
 v_smfmac_f32_16x16x64_bf16 v[40:43], v[56:59], a[104:111], v5
 ds_read_b128 v[24:27], v0 offset:28672
 v_mov_b64 v[66:67], 0
 v_smfmac_f32_16x16x64_bf16 v[44:47], v[56:59], a[112:119], v5
 ds_read_b128 v[52:55], v3 offset:0
 s_waitcnt lgkmcnt(3)
 v_mov_b64 v[68:69], 0
 v_smfmac_f32_16x16x64_bf16 v[48:51], v[56:59], v[28:35], v5
 v_mov_b64 v[70:71], 0
 v_smfmac_f32_16x16x64_bf16 v[36:39], v[60:63], a[136:143], v5
 ds_read_b128 v[32:35], v3 offset:11264
 v_mov_b64 v[28:29], 0
 v_smfmac_f32_16x16x64_bf16 v[40:43], v[60:63], a[144:151], v5
 v_mov_b64 v[30:31], 0
 v_smfmac_f32_16x16x64_bf16 v[44:47], v[60:63], a[152:159], v5
 ds_read_b128 v[56:59], v3 offset:1024
 s_waitcnt lgkmcnt(2)
 v_add_f32 v36, v36, v38
 v_smfmac_f32_16x16x64_bf16 v[48:51], v[60:63], v[20:27], v5
 ds_read_b128 v[60:63], v3 offset:2048
 ds_read_b128 v[20:23], v3 offset:9216
 v_add_f32 v37, v37, v39
 v_cvt_pk_bf16_f32 v36, v36, v37
 v_smfmac_f32_16x16x64_bf16 v[64:67], v[52:55], v[96:103], v5
 ds_write_b16 v10, v36 offset:17408
 ds_write_b16_d16_hi v10, v36 offset:17472
 v_add_f32 v40, v40, v42
 v_add_f32 v41, v41, v43
 v_cvt_pk_bf16_f32 v40, v40, v41
 v_smfmac_f32_16x16x64_bf16 v[68:71], v[52:55], v[104:111], v5
 ds_write_b16 v10, v40 offset:17412
 ds_write_b16_d16_hi v10, v40 offset:17476
 v_add_f32 v44, v44, v46
 v_add_f32 v45, v45, v47
 v_add_f32 v48, v48, v50
 v_add_f32 v49, v49, v51
 v_cvt_pk_bf16_f32 v44, v44, v45
 v_cvt_pk_bf16_f32 v45, v48, v49
 ds_write_b64 v8, v[44:45] offset:19456
 s_waitcnt lgkmcnt(7)
 v_smfmac_f32_16x16x64_bf16 v[64:67], v[56:59], v[136:143], v5
 ds_read_b128 v[52:55], v3 offset:3072
 ds_read_b128 v[24:27], v3 offset:10240
 v_smfmac_f32_16x16x64_bf16 v[68:71], v[56:59], v[144:151], v5
 ds_read_b128 v[56:59], v3 offset:4096
 s_waitcnt lgkmcnt(9)
 v_smfmac_f32_16x16x64_bf16 v[64:67], v[60:63], v[176:183], v5
 v_smfmac_f32_16x16x64_bf16 v[68:71], v[60:63], v[184:191], v5
 s_waitcnt lgkmcnt(3)
 s_barrier
 ds_read_b128 v[36:39], v11 offset:17408
 ds_read_b128 v[40:43], v11 offset:17920
 s_waitcnt lgkmcnt(4)
 v_smfmac_f32_16x16x64_bf16 v[64:67], v[52:55], v[216:223], v5
 ds_read_b64_tr_b16 v[60:61], v9 offset:19456
 ds_read_b64_tr_b16 v[62:63], v9 offset:19488
 v_smfmac_f32_16x16x64_bf16 v[68:71], v[52:55], v[224:231], v5
 ds_read_b128 v[52:55], v3 offset:5120
 ds_read_b128 v[44:47], v11 offset:18432
 s_waitcnt lgkmcnt(6)
 v_smfmac_f32_16x16x64_bf16 v[64:67], v[56:59], a[0:7], v5
 ds_read_b128 v[48:51], v11 offset:18944
 v_smfmac_f32_16x16x64_bf16 v[68:71], v[56:59], a[8:15], v5
 ds_read_b128 v[56:59], v3 offset:6144
 s_waitcnt lgkmcnt(7)
 v_mfma_f32_16x16x32_bf16 v[20:23], v[20:23], v[36:39], 0
 v_mfma_f32_16x16x32_bf16 v[24:27], v[24:27], v[36:39], 0
 s_waitcnt lgkmcnt(6)
 v_mfma_f32_16x16x32_bf16 v[20:23], v[32:35], v[40:43], v[20:23]
 ds_read_b128 v[32:35], v3 offset:12288
 s_waitcnt lgkmcnt(5)
 v_smfmac_f32_16x16x64_bf16 v[28:31], v[60:63], v[36:43], v5
 ds_read_b64_tr_b16 v[60:61], v9 offset:20544
 ds_read_b64_tr_b16 v[62:63], v9 offset:20576
 ds_read_b128 v[36:39], v3 offset:13312
 s_waitcnt lgkmcnt(7)
 v_smfmac_f32_16x16x64_bf16 v[64:67], v[52:55], a[40:47], v5
 v_smfmac_f32_16x16x64_bf16 v[68:71], v[52:55], a[48:55], v5
 ds_read_b128 v[52:55], v3 offset:7168
 s_waitcnt lgkmcnt(4)
 v_mfma_f32_16x16x32_bf16 v[24:27], v[32:35], v[40:43], v[24:27]
 ds_read_b128 v[40:43], v3 offset:14336
 ds_read_b128 v[32:35], v3 offset:15360
 s_waitcnt lgkmcnt(4)
 v_smfmac_f32_16x16x64_bf16 v[28:31], v[60:63], v[44:51], v5
 ds_read_b128 v[60:63], v3 offset:16384
 s_waitcnt lgkmcnt(4)
 v_mfma_f32_16x16x32_bf16 v[20:23], v[36:39], v[44:47], v[20:23]
 v_smfmac_f32_16x16x64_bf16 v[64:67], v[56:59], a[80:87], v5
 v_smfmac_f32_16x16x64_bf16 v[68:71], v[56:59], a[88:95], v5
 ds_read_b128 v[56:59], v3 offset:8192
 v_add_f32 v28, v28, v30
 s_waitcnt lgkmcnt(3)
 v_mfma_f32_16x16x32_bf16 v[24:27], v[40:43], v[44:47], v[24:27]
 v_add_f32 v29, v29, v31
 v_max_f32 v30, v28, v29
 s_waitcnt lgkmcnt(2)
 v_mfma_f32_16x16x32_bf16 v[20:23], v[32:35], v[48:51], v[20:23]
 v_cndmask_b32 v28, v28, v29, s[48:49]
 s_waitcnt lgkmcnt(1)
 v_mfma_f32_16x16x32_bf16 v[24:27], v[60:63], v[48:51], v[24:27]
 v_mov_b64 v[32:33], s[34:35]
 v_mov_b64 v[34:35], s[34:35]
 v_smfmac_f32_16x16x64_bf16 v[64:67], v[52:55], a[120:127], v5
 ds_read_b128 v[36:39], v0 offset:32768
 ds_read_b128 v[40:43], v0 offset:36864
 v_max3_f32 v30, v30, v20, v21
 v_smfmac_f32_16x16x64_bf16 v[68:71], v[52:55], a[128:135], v5
 ds_read_b128 v[44:47], v0 offset:40960
 ds_read_b128 v[48:51], v0 offset:45056
 v_max3_f32 v30, v30, v22, v23
 v_max3_f32 v30, v30, v24, v25
 v_max3_f32 v31, v30, v26, v27
 v_max3_f32 v29, v30, v26, v27
 s_waitcnt lgkmcnt(4)
 v_smfmac_f32_16x16x64_bf16 v[64:67], v[56:59], a[160:167], v5
 v_cndmask_b32 v20, v20, v24, s[48:49]
 v_smfmac_f32_16x16x64_bf16 v[68:71], v[56:59], a[168:175], v5
 v_cndmask_b32 v21, v21, v25, s[48:49]
 v_permlane16_swap_b32 v31, v29
 v_max_f32 v30, v31, v29
 v_max_f32 v6, v31, v29
 v_cndmask_b32 v22, v22, v26, s[48:49]
 v_cndmask_b32 v23, v23, v27, s[48:49]
 v_permlane32_swap_b32 v30, v6
 v_max_f32 v30, v30, v6
 v_mul_f32 v30, -s55, v30
 v_fma_f32 v28, v28, s55, v30
 v_fma_f32 v20, v20, s55, v30
 v_fma_f32 v21, v21, s55, v30
 v_fma_f32 v22, v22, s55, v30
 v_fma_f32 v23, v23, s55, v30
 v_exp_f32 v28, v28
 v_add_f32 v64, v64, v66
 v_add_f32 v65, v65, v67
 v_cndmask_b32 v29, 0, v28, s[48:49]
 v_cndmask_b32 v28, v28, 0, s[48:49]
 v_cvt_pk_bf16_f32 v6, v28, v29
 v_add_f32 v68, v68, v70
 v_add_f32 v69, v69, v71
 v_mfma_f32_16x16x16_bf16 v[60:63], v[6:7], v[32:33], 0
 v_cvt_pk_bf16_f32 v2, v64, v65
 v_cvt_pk_bf16_f32 v4, v68, v69
 v_exp_f32 v20, v20
 v_exp_f32 v21, v21
 v_mfma_f32_16x16x16_bf16 v[52:55], v[6:7], v[2:3], 0
 s_waitcnt vmcnt(3)
 v_exp_f32 v22, v22
 v_mfma_f32_16x16x16_bf16 v[56:59], v[6:7], v[4:5], 0
 s_cmp_eq_u32 s36, 63
 v_exp_f32 v23, v23
 v_cvt_pk_bf16_f32 v30, v20, v21
 v_cvt_pk_bf16_f32 v31, v22, v23
 v_mov_b64 v[64:65], 0
 v_mov_b64 v[66:67], 0
 v_smfmac_f32_16x16x32_bf16 v[60:63], v[30:31], v[32:35], v5
 v_mov_b64 v[68:69], 0
 v_mov_b64 v[70:71], 0
 v_smfmac_f32_16x16x32_bf16 v[52:55], v[30:31], v[12:15], v5
 v_mov_b64 v[20:21], 0
 v_mov_b64 v[22:23], 0
 v_smfmac_f32_16x16x32_bf16 v[56:59], v[30:31], v[16:19], v5
 s_nop 0
 v_add_f32 v60, v60, v62
 v_add_f32 v61, v61, v63
 v_rcp_f32 v60, v60
 v_rcp_f32 v61, v61
 v_add_f32 v52, v52, v54
 v_add_f32 v53, v53, v55
 v_mul_f32 v52, v52, v60
 v_mul_f32 v53, v53, v61
 v_add_f32 v56, v56, v58
 v_add_f32 v57, v57, v59
 v_mul_f32 v56, v56, v60
 v_mul_f32 v57, v57, v61
 v_cvt_pk_bf16_f32 v52, v52, v53
 v_cvt_pk_bf16_f32 v53, v56, v57
 ds_write_b64 v8, v[52:53] offset:21632
 s_cbranch_scc1 Lchexit_44
 v_bfe_u32 v6, v0, 7, 5
 v_mul_u32_u24 v6, 10496, v6
 v_bfe_u32 v60, v3, 4, 3
 v_lshl_add_u32 v6, v60, 3, v6
 s_xor_b32 s46, s46, 0x1
 v_mov_b64 v[24:25], 0
 s_add_u32 s67, s67, 0x80000
 v_mov_b64 v[26:27], 0
 s_add_u32 s59, s59, 0x80000
 v_mov_b64 v[28:29], 0
 s_add_u32 s38, s38, 0x20000
 v_mov_b64 v[30:31], 0
 s_waitcnt lgkmcnt(0)
 s_barrier
 ds_read_b64_tr_b16 v[52:53], v9 offset:21632
 ds_read_b64_tr_b16 v[54:55], v9 offset:21664
 v_mov_b64 v[32:33], 0
 ds_read_b64_tr_b16 v[56:57], v9 offset:22720
 ds_read_b64_tr_b16 v[58:59], v9 offset:22752
 v_mov_b64 v[34:35], 0
 s_cmp_lt_u32 s36, 61
 v_mov_b64 v[12:13], 0
 s_cselect_b32 s47, 0x80000, 0
 v_mov_b64 v[14:15], 0
 s_add_u32 s68, s68, s47
 v_mov_b64 v[16:17], 0
 s_add_u32 s36, s36, 1
 v_mov_b64 v[18:19], 0
 s_waitcnt lgkmcnt(2)
 v_smfmac_f32_16x16x64_bf16 v[64:67], v[52:55], a[248:255], v5
 s_add_u32 s58, s36, 3
 s_min_u32 s58, s58, 64
 v_mov_b64 v[60:61], 0
 v_smfmac_f32_16x16x64_bf16 v[68:71], v[52:55], a[176:183], v5
 buffer_load_dwordx4 v3, s[20:23], s67 offen offset:0 sc1 lds
 v_mov_b64 v[62:63], 0
 s_waitcnt lgkmcnt(0)
 v_smfmac_f32_16x16x64_bf16 v[64:67], v[56:59], v[36:43], v5
 ds_read_b128 v[36:39], v0 offset:49152
 ds_read_b128 v[40:43], v0 offset:53248
 v_smfmac_f32_16x16x64_bf16 v[20:23], v[52:55], a[184:191], v5
 buffer_load_dwordx4 v3, s[20:23], s67 offen offset:1024 sc1 lds
 v_smfmac_f32_16x16x64_bf16 v[68:71], v[56:59], v[44:51], v5
 ds_read_b128 v[44:47], v0 offset:57344
 ds_read_b128 v[48:51], v0 offset:61440
 v_add_f32 v64, v64, v66
 v_add_f32 v65, v65, v67
 v_smfmac_f32_16x16x64_bf16 v[24:27], v[52:55], a[192:199], v5
 s_xor_b32 s44, s44, 0x80000
 s_xor_b32 s45, s45, 0x80000
 v_cvt_pk_bf16_f32 v65, v65, v65
 v_cvt_pk_bf16_f32 v64, v64, v64
 s_waitcnt lgkmcnt(2)
 v_add_u32 v0, 0x10000, v0
 v_smfmac_f32_16x16x64_bf16 v[20:23], v[56:59], v[36:43], v5
 ds_read_b128 v[36:39], v0 offset:0
 ds_read_b128 v[40:43], v0 offset:4096
 v_and_or_b32 v65, v65, -2, s46
 v_smfmac_f32_16x16x64_bf16 v[28:31], v[52:55], a[200:207], v5
 buffer_store_dwordx2 v[64:65], v6, s[20:23], s62 offen sc1
 v_add_f32 v68, v68, v70
 v_add_f32 v69, v69, v71
 s_waitcnt lgkmcnt(2)
 v_smfmac_f32_16x16x64_bf16 v[24:27], v[56:59], v[44:51], v5
 ds_read_b128 v[44:47], v0 offset:8192
 ds_read_b128 v[48:51], v0 offset:12288
 v_add_f32 v20, v20, v22
 v_add_f32 v21, v21, v23
 v_smfmac_f32_16x16x64_bf16 v[32:35], v[52:55], a[208:215], v5
 s_xor_b32 s65, s65, 0x80000
 s_xor_b32 s66, s66, 0x80000
 v_cvt_pk_bf16_f32 v69, v69, v21
 v_cvt_pk_bf16_f32 v68, v68, v20
 s_waitcnt lgkmcnt(2)
 v_smfmac_f32_16x16x64_bf16 v[28:31], v[56:59], v[36:43], v5
 ds_read_b128 v[36:39], v0 offset:16384
 ds_read_b128 v[40:43], v0 offset:20480
 v_and_or_b32 v69, v69, -2, s46
 v_smfmac_f32_16x16x64_bf16 v[12:15], v[52:55], a[216:223], v5
 buffer_store_dwordx2 v[68:69], v6, s[20:23], s60 offen offset:0 sc1
 v_add_f32 v24, v24, v26
 v_add_f32 v25, v25, v27
 s_waitcnt lgkmcnt(2)
 v_smfmac_f32_16x16x64_bf16 v[32:35], v[56:59], v[44:51], v5
 ds_read_b128 v[44:47], v0 offset:24576
 ds_read_b128 v[48:51], v0 offset:28672
 v_add_f32 v28, v28, v30
 v_add_f32 v29, v29, v31
 v_smfmac_f32_16x16x64_bf16 v[16:19], v[52:55], a[224:231], v5
 s_xor_b32 s41, s41, 0x80000
 s_xor_b32 s43, s43, 0x80000
 v_cvt_pk_bf16_f32 v25, v25, v29
 v_cvt_pk_bf16_f32 v24, v24, v28
 s_waitcnt lgkmcnt(2)
 v_smfmac_f32_16x16x64_bf16 v[12:15], v[56:59], v[36:43], v5
 v_and_or_b32 v25, v25, -2, s46
 v_smfmac_f32_16x16x64_bf16 v[60:63], v[52:55], a[232:239], v5
 buffer_store_dwordx2 v[24:25], v6, s[20:23], s60 offen offset:2048 sc1
 v_add_f32 v32, v32, v34
 v_add_f32 v33, v33, v35
 s_waitcnt lgkmcnt(0)
 v_smfmac_f32_16x16x64_bf16 v[16:19], v[56:59], v[44:51], v5
 s_nop 0
 v_add_f32 v12, v12, v14
 v_add_f32 v13, v13, v15
 v_smfmac_f32_16x16x64_bf16 v[60:63], v[56:59], a[240:247], v5
 v_cvt_pk_bf16_f32 v33, v33, v13
 v_cvt_pk_bf16_f32 v32, v32, v12
 v_and_or_b32 v33, v33, -2, s46
 buffer_store_dwordx2 v[32:33], v6, s[20:23], s61 offen offset:0 sc1
 v_add_f32 v16, v16, v18
 v_add_f32 v17, v17, v19
 s_cmp_eq_u32 s4, 0
 s_nop 0
 v_add_f32 v60, v60, v62
 v_add_f32 v61, v61, v63
 v_cvt_pk_bf16_f32 v17, v17, v61
 v_cvt_pk_bf16_f32 v16, v16, v60
 v_and_or_b32 v17, v17, -2, s46
 buffer_store_dwordx2 v[16:17], v6, s[20:23], s61 offen offset:2048 sc1
 s_cbranch_scc1 LwH_70
 v_mov_b32 v47, 0x3f80
 v_cndmask_b32 v47, v47, 1.0, s[32:33]
 v_cndmask_b32 v44, 0, v47, s[24:25]
 v_cndmask_b32 v45, 0, v47, s[26:27]
 v_cndmask_b32 v46, 0, v47, s[28:29]
 v_cndmask_b32 v47, 0, v47, s[30:31]
 v_bfe_u32 v52, v3, 8, 2
 v_bfe_u32 v58, v3, 2, 4
 v_lshl_or_b32 v52, v52, 4, v58
 v_and_b32 v58, 0xc0, v3
 v_lshl_or_b32 v52, v58, 24, v52
 v_subrev_u32 v0, 0x20000, v0
 v_mov_b32 v59, -1
 v_add_u32 v54, s42, v3
 v_add_u32 v58, s69, v9
 ds_read_b64_tr_b16 v[64:65], v58 offset:19456
 v_mov_b32 v66, v2
 v_mov_b32 v67, v4
 ds_read_b128 v[20:23], v0 offset:24576
 ds_read_b128 v[24:27], v0 offset:28672
 ds_read_b128 v[28:31], v0 offset:32768
 ds_read_b128 v[32:35], v0 offset:36864
 s_cmp_eq_u32 s4, 1
 s_waitcnt vmcnt(2)
 s_cbranch_scc1 Lq1_71
 s_cmp_eq_u32 s4, 2
 s_waitcnt vmcnt(1)
 s_cbranch_scc1 Lq1_71
 s_waitcnt vmcnt(0)
Lq1_71:
 buffer_load_dwordx4 v[36:39], v3, s[20:23], s39 offen offset:0 sc1
 buffer_load_dwordx4 v[40:43], v3, s[20:23], s39 offen offset:1024 sc1
 s_nop 15
 s_nop 11
 buffer_load_dwordx4 v[12:15], v3, s[20:23], s39 offen offset:0 sc1
 buffer_load_dwordx4 v[16:19], v3, s[20:23], s39 offen offset:1024 sc1
 s_waitcnt vmcnt(3)
 v_mfma_f32_16x16x32_bf16 v[48:51], v[44:47], v[36:39], 0
 s_waitcnt vmcnt(2)
 v_mfma_f32_16x16x32_bf16 v[48:51], v[44:47], v[40:43], v[48:51]
 v_bitop3_b32 v55, v37, v39, s46 bitop3:0x7e
 v_bitop3_b32 v56, v41, v43, s46 bitop3:0x7e
 v_bitop3_b32 v55, v55, 1, v56 bitop3:0xc8
 v_cmp_ne_u32 vcc, 0, v55
 s_nop 3
 v_add_f32_dpp v48, v48, v48 row_ror:4 row_mask:0xf bank_mask:0xf
 v_add_f32_dpp v49, v49, v49 row_ror:4 row_mask:0xf bank_mask:0xf
 s_cbranch_vccnz Lr2_73
 v_add_f32_dpp v48, v48, v48 row_ror:8 row_mask:0xf bank_mask:0xf
 v_add_f32_dpp v49, v49, v49 row_ror:8 row_mask:0xf bank_mask:0xf
 v_cvt_pk_bf16_f32 v48, v48, v49
 buffer_store_dword v48, v52, s[20:23], s44 offen sc1
Lb1_74:
 buffer_store_dword v59, v52, s[20:23], s45 offen sc1
 v_cmp_gt_u32 vcc, s58, v1
 v_mov_b64 v[36:37], 0
 v_mov_b64 v[38:39], 0
 v_mov_b64 v[40:41], 0
 v_mov_b64 v[42:43], 0
 v_mov_b64 v[44:45], 0
 v_mov_b64 v[46:47], 0
 v_mov_b64 v[48:49], 0
 v_mov_b64 v[50:51], 0
 s_cmp_lg_u32 vcc_hi, 0
 s_cbranch_scc1 Lfw_76
Lfok_75:
 v_lshl_add_u32 v1, v3, 3, s68
 v_mov_b32 v6, s56
 v_cndmask_b32 v1, v6, v1, s[70:71]
 s_nop 15
 s_nop 3
 buffer_load_dwordx4 v[12:15], v3, s[20:23], s41 offen offset:0 sc1
 buffer_load_dwordx4 v[16:19], v3, s[20:23], s41 offen offset:1024 sc1
 s_nop 15
 s_nop 7
Lp2_77:
 buffer_load_dwordx4 v[12:15], v3, s[20:23], s41 offen offset:0 sc1
 buffer_load_dwordx4 v[16:19], v3, s[20:23], s41 offen offset:1024 sc1
 s_waitcnt vmcnt(2)
 v_max3_u32 v55, v12, v13, v14
 v_max3_u32 v55, v55, v15, v16
 v_max3_u32 v55, v55, v17, v18
 v_max_u32 v55, v55, v19
 ds_write_b128 v54, v[12:15] offset:0
 ds_write_b128 v54, v[16:19] offset:1024
 v_cmpx_eq_u32 vcc, -1, v55
 s_cbranch_execz Lstep_68
 buffer_load_dwordx4 v[12:15], v3, s[20:23], s41 offen offset:0 sc1
 buffer_load_dwordx4 v[16:19], v3, s[20:23], s41 offen offset:1024 sc1
 s_waitcnt vmcnt(2)
 v_max3_u32 v55, v12, v13, v14
 v_max3_u32 v55, v55, v15, v16
 v_max3_u32 v55, v55, v17, v18
 v_max_u32 v55, v55, v19
 ds_write_b128 v54, v[12:15] offset:0
 ds_write_b128 v54, v[16:19] offset:1024
 v_cmpx_eq_u32 vcc, -1, v55
 s_cbranch_execz Lstep_68
 buffer_load_dwordx4 v[12:15], v3, s[20:23], s41 offen offset:0 sc1
 buffer_load_dwordx4 v[16:19], v3, s[20:23], s41 offen offset:1024 sc1
 s_waitcnt vmcnt(2)
 v_max3_u32 v55, v12, v13, v14
 v_max3_u32 v55, v55, v15, v16
 v_max3_u32 v55, v55, v17, v18
 v_max_u32 v55, v55, v19
 ds_write_b128 v54, v[12:15] offset:0
 ds_write_b128 v54, v[16:19] offset:1024
 v_cmpx_eq_u32 vcc, -1, v55
 s_cbranch_execz Lstep_68
 s_sub_u32 s54, s54, 1
 s_cbranch_scc0 Lp2_77
 s_endpgm
LwH_70:
 v_bfe_u32 v53, v3, 8, 1
 v_bfe_u32 v58, v3, 9, 1
 v_lshl_or_b32 v53, v53, 1, v58
 v_bfe_u32 v58, v3, 5, 1
 v_lshl_or_b32 v53, v53, 1, v58
 v_and_b32 v58, 0xd0, v3
 v_lshlrev_b32 v58, 24, v58
 v_lshl_or_b32 v53, v53, 2, v58
 s_waitcnt vmcnt(2)
 buffer_load_dwordx4 v[20:23], v3, s[20:23], s40 offen offset:0 sc1
 buffer_load_dwordx4 v[24:27], v3, s[20:23], s40 offen offset:1024 sc1
 buffer_load_dwordx4 v[36:39], v3, s[20:23], s39 offen offset:0 sc1
 buffer_load_dwordx4 v[40:43], v3, s[20:23], s39 offen offset:1024 sc1
 v_mov_b32 v47, 0x3f80
 v_cndmask_b32 v47, v47, 1.0, s[32:33]
 v_cndmask_b32 v44, 0, v47, s[24:25]
 v_cndmask_b32 v45, 0, v47, s[26:27]
 v_cndmask_b32 v46, 0, v47, s[28:29]
 v_cndmask_b32 v47, 0, v47, s[30:31]
 v_bfe_u32 v52, v3, 8, 2
 v_bfe_u32 v58, v3, 2, 4
 v_lshl_or_b32 v52, v52, 4, v58
 v_and_b32 v58, 0xc0, v3
 v_lshl_or_b32 v52, v58, 24, v52
 v_subrev_u32 v0, 0x20000, v0
 v_mov_b32 v59, -1
 v_add_u32 v54, s42, v3
 v_add_u32 v58, s69, v9
 ds_read_b64_tr_b16 v[64:65], v58 offset:19456
 v_mov_b32 v66, v2
 v_mov_b32 v67, v4
 s_waitcnt vmcnt(2)
 v_mfma_f32_16x16x32_bf16 v[28:31], v[44:47], v[20:23], 0
 v_mfma_f32_16x16x32_bf16 v[28:31], v[44:47], v[24:27], v[28:31]
 s_waitcnt vmcnt(1)
 v_mfma_f32_16x16x32_bf16 v[48:51], v[44:47], v[36:39], 0
 s_waitcnt vmcnt(0)
 v_mfma_f32_16x16x32_bf16 v[48:51], v[44:47], v[40:43], v[48:51]
 v_bitop3_b32 v55, v37, v39, s46 bitop3:0x7e
 v_bitop3_b32 v56, v41, v43, s46 bitop3:0x7e
 v_bitop3_b32 v57, v21, v23, s46 bitop3:0x7e
 v_or3_b32 v55, v55, v56, v57
 v_bitop3_b32 v56, v25, v27, s46 bitop3:0x7e
 v_bitop3_b32 v55, v55, 1, v56 bitop3:0xc8
 v_cmp_ne_u32 vcc, 0, v55
 v_add_f32_dpp v29, v29, v29 row_ror:4 row_mask:0xf bank_mask:0xf
 v_add_f32_dpp v48, v48, v48 row_ror:4 row_mask:0xf bank_mask:0xf
 v_add_f32_dpp v49, v49, v49 row_ror:4 row_mask:0xf bank_mask:0xf
 v_add_f32_dpp v29, v29, v29 row_ror:8 row_mask:0xf bank_mask:0xf
 v_add_f32_dpp v48, v48, v48 row_ror:8 row_mask:0xf bank_mask:0xf
 v_add_f32_dpp v49, v49, v49 row_ror:8 row_mask:0xf bank_mask:0xf
 s_cbranch_vccnz Lr1_78
 v_cvt_pk_bf16_f32 v48, v48, v49
 buffer_store_dword v48, v52, s[20:23], s44 offen sc1
 v_mov_b32_dpp v30, v29 quad_perm:[1,0,3,2] row_mask:0xf bank_mask:0xf
 v_cvt_pk_bf16_f32 v29, v29, v30
 buffer_store_dword v29, v53, s[20:23], s65 offen sc1
Lb1_79:
 buffer_store_dword v59, v52, s[20:23], s45 offen sc1
 buffer_store_dword v59, v53, s[20:23], s66 offen sc1
 v_cmp_gt_u32 vcc, s58, v1
 ds_read_b128 v[20:23], v0 offset:24576
 ds_read_b128 v[24:27], v0 offset:28672
 ds_read_b128 v[28:31], v0 offset:32768
 ds_read_b128 v[32:35], v0 offset:36864
 v_mov_b64 v[36:37], 0
 v_mov_b64 v[38:39], 0
 v_mov_b64 v[40:41], 0
 v_mov_b64 v[42:43], 0
 v_mov_b64 v[44:45], 0
 v_mov_b64 v[46:47], 0
 v_mov_b64 v[48:49], 0
 v_mov_b64 v[50:51], 0
 s_cmp_lg_u32 vcc_hi, 0
 s_cbranch_scc1 Lfw_81
Lfok_80:
 v_lshl_add_u32 v1, v3, 3, s68
 v_mov_b32 v6, s56
 v_cndmask_b32 v1, v6, v1, s[70:71]
 s_nop 13
 buffer_load_dwordx4 v[12:15], v3, s[20:23], s41 offen offset:0 sc1
 buffer_load_dwordx4 v[16:19], v3, s[20:23], s41 offen offset:1024 sc1
 buffer_load_dwordx4 v[68:71], v3, s[20:23], s43 offen offset:0 sc1
 s_nop 15
 s_nop 7
Lp2_82:
 buffer_load_dwordx4 v[12:15], v3, s[20:23], s41 offen offset:0 sc1
 buffer_load_dwordx4 v[16:19], v3, s[20:23], s41 offen offset:1024 sc1
 buffer_load_dwordx4 v[68:71], v3, s[20:23], s43 offen offset:0 sc1
 s_waitcnt vmcnt(3)
 v_max3_u32 v55, v12, v13, v14
 v_max3_u32 v55, v55, v15, v16
 v_max3_u32 v55, v55, v17, v18
 v_max3_u32 v55, v55, v19, v68
 v_max3_u32 v55, v55, v69, v70
 v_max_u32 v55, v55, v71
 ds_write_b128 v54, v[12:15] offset:0
 ds_write_b128 v54, v[16:19] offset:1024
 ds_write_b128 v54, v[68:71] offset:8192
 v_cmpx_eq_u32 vcc, -1, v55
 s_cbranch_execz Lstep_68
 buffer_load_dwordx4 v[12:15], v3, s[20:23], s41 offen offset:0 sc1
 buffer_load_dwordx4 v[16:19], v3, s[20:23], s41 offen offset:1024 sc1
 buffer_load_dwordx4 v[68:71], v3, s[20:23], s43 offen offset:0 sc1
 s_waitcnt vmcnt(3)
 v_max3_u32 v55, v12, v13, v14
 v_max3_u32 v55, v55, v15, v16
 v_max3_u32 v55, v55, v17, v18
 v_max3_u32 v55, v55, v19, v68
 v_max3_u32 v55, v55, v69, v70
 v_max_u32 v55, v55, v71
 ds_write_b128 v54, v[12:15] offset:0
 ds_write_b128 v54, v[16:19] offset:1024
 ds_write_b128 v54, v[68:71] offset:8192
 v_cmpx_eq_u32 vcc, -1, v55
 s_cbranch_execz Lstep_68
 buffer_load_dwordx4 v[12:15], v3, s[20:23], s41 offen offset:0 sc1
 buffer_load_dwordx4 v[16:19], v3, s[20:23], s41 offen offset:1024 sc1
 buffer_load_dwordx4 v[68:71], v3, s[20:23], s43 offen offset:0 sc1
 s_waitcnt vmcnt(3)
 v_max3_u32 v55, v12, v13, v14
 v_max3_u32 v55, v55, v15, v16
 v_max3_u32 v55, v55, v17, v18
 v_max3_u32 v55, v55, v19, v68
 v_max3_u32 v55, v55, v69, v70
 v_max_u32 v55, v55, v71
 ds_write_b128 v54, v[12:15] offset:0
 ds_write_b128 v54, v[16:19] offset:1024
 ds_write_b128 v54, v[68:71] offset:8192
 v_cmpx_eq_u32 vcc, -1, v55
 s_cbranch_execz Lstep_68
 s_sub_u32 s54, s54, 1
 s_cbranch_scc0 Lp2_82
 s_endpgm
Lr1_78:
 s_mov_b64 exec, vcc
Lrt_83:
 buffer_load_dwordx4 v[20:23], v3, s[20:23], s40 offen offset:0 sc1
 buffer_load_dwordx4 v[24:27], v3, s[20:23], s40 offen offset:1024 sc1
 buffer_load_dwordx4 v[36:39], v3, s[20:23], s39 offen offset:0 sc1
 buffer_load_dwordx4 v[40:43], v3, s[20:23], s39 offen offset:1024 sc1
 s_waitcnt vmcnt(4)
 v_bitop3_b32 v55, v37, v39, s46 bitop3:0x7e
 v_bitop3_b32 v56, v41, v43, s46 bitop3:0x7e
 v_bitop3_b32 v57, v21, v23, s46 bitop3:0x7e
 v_or3_b32 v55, v55, v56, v57
 v_bitop3_b32 v56, v25, v27, s46 bitop3:0x7e
 v_bitop3_b32 v55, v55, 1, v56 bitop3:0xc8
 v_cmpx_ne_u32 vcc, 0, v55
 s_cbranch_execz Lrte_84
 buffer_load_dwordx4 v[20:23], v3, s[20:23], s40 offen offset:0 sc1
 buffer_load_dwordx4 v[24:27], v3, s[20:23], s40 offen offset:1024 sc1
 buffer_load_dwordx4 v[36:39], v3, s[20:23], s39 offen offset:0 sc1
 buffer_load_dwordx4 v[40:43], v3, s[20:23], s39 offen offset:1024 sc1
 s_waitcnt vmcnt(4)
 v_bitop3_b32 v55, v37, v39, s46 bitop3:0x7e
 v_bitop3_b32 v56, v41, v43, s46 bitop3:0x7e
 v_bitop3_b32 v57, v21, v23, s46 bitop3:0x7e
 v_or3_b32 v55, v55, v56, v57
 v_bitop3_b32 v56, v25, v27, s46 bitop3:0x7e
 v_bitop3_b32 v55, v55, 1, v56 bitop3:0xc8
 v_cmpx_ne_u32 vcc, 0, v55
 s_cbranch_execz Lrte_84
 buffer_load_dwordx4 v[20:23], v3, s[20:23], s40 offen offset:0 sc1
 buffer_load_dwordx4 v[24:27], v3, s[20:23], s40 offen offset:1024 sc1
 buffer_load_dwordx4 v[36:39], v3, s[20:23], s39 offen offset:0 sc1
 buffer_load_dwordx4 v[40:43], v3, s[20:23], s39 offen offset:1024 sc1
 s_waitcnt vmcnt(4)
 v_bitop3_b32 v55, v37, v39, s46 bitop3:0x7e
 v_bitop3_b32 v56, v41, v43, s46 bitop3:0x7e
 v_bitop3_b32 v57, v21, v23, s46 bitop3:0x7e
 v_or3_b32 v55, v55, v56, v57
 v_bitop3_b32 v56, v25, v27, s46 bitop3:0x7e
 v_bitop3_b32 v55, v55, 1, v56 bitop3:0xc8
 v_cmpx_ne_u32 vcc, 0, v55
 s_cbranch_execz Lrte_84
 s_sub_u32 s54, s54, 1
 s_cbranch_scc0 Lrt_83
 s_endpgm
Lrte_84:
 s_mov_b64 exec, -1
 s_nop 2
 v_mfma_f32_16x16x32_bf16 v[28:31], v[44:47], v[20:23], 0
 v_mfma_f32_16x16x32_bf16 v[28:31], v[44:47], v[24:27], v[28:31]
 v_mfma_f32_16x16x32_bf16 v[48:51], v[44:47], v[36:39], 0
 v_mfma_f32_16x16x32_bf16 v[48:51], v[44:47], v[40:43], v[48:51]
 s_nop 6
 v_add_f32_dpp v29, v29, v29 row_ror:4 row_mask:0xf bank_mask:0xf
 v_add_f32_dpp v48, v48, v48 row_ror:4 row_mask:0xf bank_mask:0xf
 v_add_f32_dpp v49, v49, v49 row_ror:4 row_mask:0xf bank_mask:0xf
 v_add_f32_dpp v29, v29, v29 row_ror:8 row_mask:0xf bank_mask:0xf
 v_add_f32_dpp v48, v48, v48 row_ror:8 row_mask:0xf bank_mask:0xf
 v_add_f32_dpp v49, v49, v49 row_ror:8 row_mask:0xf bank_mask:0xf
 v_cvt_pk_bf16_f32 v48, v48, v49
 buffer_store_dword v48, v52, s[20:23], s44 offen sc1
 v_mov_b32_dpp v30, v29 quad_perm:[1,0,3,2] row_mask:0xf bank_mask:0xf
 v_cvt_pk_bf16_f32 v29, v29, v30
 buffer_store_dword v29, v53, s[20:23], s65 offen sc1
 s_waitcnt vmcnt(2)
 s_branch Lb1_79
Lr2_73:
 s_waitcnt vmcnt(1)
 v_mfma_f32_16x16x32_bf16 v[48:51], v[44:47], v[12:15], 0
 s_waitcnt vmcnt(0)
 v_mfma_f32_16x16x32_bf16 v[48:51], v[44:47], v[16:19], v[48:51]
 v_bitop3_b32 v55, v13, v15, s46 bitop3:0x7e
 v_bitop3_b32 v56, v17, v19, s46 bitop3:0x7e
 v_bitop3_b32 v55, v55, 1, v56 bitop3:0xc8
 v_cmp_ne_u32 vcc, 0, v55
 s_nop 3
 v_add_f32_dpp v48, v48, v48 row_ror:4 row_mask:0xf bank_mask:0xf
 v_add_f32_dpp v49, v49, v49 row_ror:4 row_mask:0xf bank_mask:0xf
 s_cbranch_vccnz Lr1_72
 v_add_f32_dpp v48, v48, v48 row_ror:8 row_mask:0xf bank_mask:0xf
 v_add_f32_dpp v49, v49, v49 row_ror:8 row_mask:0xf bank_mask:0xf
 v_cvt_pk_bf16_f32 v48, v48, v49
 buffer_store_dword v48, v52, s[20:23], s44 offen sc1
 s_branch Lb1_74
Lr1_72:
 s_mov_b64 exec, vcc
Lrt_85:
 buffer_load_dwordx4 v[12:15], v3, s[20:23], s39 offen offset:0 sc1
 buffer_load_dwordx4 v[16:19], v3, s[20:23], s39 offen offset:1024 sc1
 s_waitcnt vmcnt(2)
 v_bitop3_b32 v55, v13, v15, s46 bitop3:0x7e
 v_bitop3_b32 v56, v17, v19, s46 bitop3:0x7e
 v_bitop3_b32 v55, v55, 1, v56 bitop3:0xc8
 v_cmpx_ne_u32 vcc, 0, v55
 s_cbranch_execz Lrte_86
 buffer_load_dwordx4 v[12:15], v3, s[20:23], s39 offen offset:0 sc1
 buffer_load_dwordx4 v[16:19], v3, s[20:23], s39 offen offset:1024 sc1
 s_waitcnt vmcnt(2)
 v_bitop3_b32 v55, v13, v15, s46 bitop3:0x7e
 v_bitop3_b32 v56, v17, v19, s46 bitop3:0x7e
 v_bitop3_b32 v55, v55, 1, v56 bitop3:0xc8
 v_cmpx_ne_u32 vcc, 0, v55
 s_cbranch_execz Lrte_86
 buffer_load_dwordx4 v[12:15], v3, s[20:23], s39 offen offset:0 sc1
 buffer_load_dwordx4 v[16:19], v3, s[20:23], s39 offen offset:1024 sc1
 s_waitcnt vmcnt(2)
 v_bitop3_b32 v55, v13, v15, s46 bitop3:0x7e
 v_bitop3_b32 v56, v17, v19, s46 bitop3:0x7e
 v_bitop3_b32 v55, v55, 1, v56 bitop3:0xc8
 v_cmpx_ne_u32 vcc, 0, v55
 s_cbranch_execz Lrte_86
 s_sub_u32 s54, s54, 1
 s_cbranch_scc0 Lrt_85
 s_endpgm
Lrte_86:
 s_mov_b64 exec, -1
 s_nop 2
 v_mfma_f32_16x16x32_bf16 v[48:51], v[44:47], v[12:15], 0
 v_mfma_f32_16x16x32_bf16 v[48:51], v[44:47], v[16:19], v[48:51]
 s_nop 7
 v_add_f32_dpp v48, v48, v48 row_ror:4 row_mask:0xf bank_mask:0xf
 v_add_f32_dpp v49, v49, v49 row_ror:4 row_mask:0xf bank_mask:0xf
 s_nop 0
 v_add_f32_dpp v48, v48, v48 row_ror:8 row_mask:0xf bank_mask:0xf
 v_add_f32_dpp v49, v49, v49 row_ror:8 row_mask:0xf bank_mask:0xf
 v_cvt_pk_bf16_f32 v48, v48, v49
 buffer_store_dword v48, v52, s[20:23], s44 offen sc1
 s_branch Lb1_74
Lfw_76:
Lpb_87:
 buffer_load_dword v1, v7, s[20:23], s56 offen sc1
 s_waitcnt vmcnt(0)
 v_cmp_le_u32 vcc, s58, v1
 s_cbranch_vccnz Lpbok_88
 s_sub_u32 s54, s54, 1
 s_cbranch_scc0 Lpb_87
 s_endpgm
Lpbok_88:
 s_branch Lfok_75
Lfw_81:
Lpb_89:
 buffer_load_dword v1, v7, s[20:23], s56 offen sc1
 s_waitcnt vmcnt(0)
 v_cmp_le_u32 vcc, s58, v1
 s_cbranch_vccnz Lpbok_90
 s_sub_u32 s54, s54, 1
 s_cbranch_scc0 Lpb_89
 s_endpgm
Lpbok_90:
 s_branch Lfok_80
Lfail_69:
 s_endpgm
Lchexit_44:
 s_add_u32 s38, s38, 0x20000
 v_add_u32 v6, s69, v9
 ds_read_b64_tr_b16 v[64:65], v6 offset:19456
 v_mov_b32 v66, v2
 v_mov_b32 v67, v4
 s_waitcnt lgkmcnt(0)
 buffer_store_dwordx4 v[64:67], v0, s[20:23], s38 offen sc1
 s_waitcnt vmcnt(0) lgkmcnt(0)
 s_barrier
 v_subrev_u32 v0, 0x10000, v0
 v_min_u32 v0, 16, v0
 v_lshlrev_b32 v0, 24, v0
 v_mov_b32 v6, 64
 buffer_store_dword v6, v0, s[20:23], s57 offen sc1
Lfin:
Lend:
 s_endpgm
.section .rodata,"a"
.p2align 6
.amdhsa_kernel concat_heads__compressed_kv_cla__memory_aug_recurrent_mem_tr__prompt_kernel
  .amdhsa_next_free_vgpr 512
  .amdhsa_next_free_sgpr 102
  .amdhsa_accum_offset 256
  .amdhsa_group_segment_fixed_size 0
  .amdhsa_kernarg_size 128
  .amdhsa_user_sgpr_count 2
  .amdhsa_user_sgpr_kernarg_segment_ptr 1
  .amdhsa_system_sgpr_workgroup_id_x 1
  .amdhsa_float_denorm_mode_32 3
.end_amdhsa_kernel
```

```asm
; @launch grid=(256,1,1) block=(256,1,1) lds=163840
.amdgcn_target "amdgcn-amd-amdhsa--gfx950"
.text
.globl concat_heads__compressed_kv_cla__memory_aug_recurrent_mem_tr__prompt_kernel
.p2align 8
.type concat_heads__compressed_kv_cla__memory_aug_recurrent_mem_tr__prompt_kernel,@function
concat_heads__compressed_kv_cla__memory_aug_recurrent_mem_tr__prompt_kernel:
 s_cmp_ge_u32 s2, 256
 s_cbranch_scc1 Lend
 s_load_dwordx2 s[20:21], s[0:1], 120
 s_mov_b32 s22, 0x10000000
 s_mov_b32 s23, 0x20000
 s_load_dwordx2 s[28:29], s[0:1], 112
 s_mov_b32 s30, 0x100
 s_mov_b32 s31, 0x20000
 v_lshrrev_b32 v1, 6, v0
 s_and_b32 s5, s2, 7
 s_lshr_b32 s6, s2, 3
 v_readfirstlane_b32 s4, v1
 s_lshl_b32 s5, s5, 2
 s_lshr_b32 s5, 0x37654120, s5
 s_and_b32 s5, s5, 7
 s_waitcnt lgkmcnt(0)
 s_cmp_eq_u32 s5, 0
 s_cbranch_scc1 Lchain
 s_cmp_eq_u32 s5, 1
 s_cbranch_scc1 Lpb
 s_cmp_lt_u32 s5, 4
 s_cbranch_scc1 Lqa
 s_load_dwordx2 s[8:9], s[0:1], 8
 s_mov_b32 s10, 0x200000
 s_mov_b32 s11, 0x20000
 s_load_dwordx2 s[12:13], s[0:1], 24
 s_mov_b32 s14, 0x400000
 s_mov_b32 s15, 0x20000
 s_load_dwordx2 s[16:17], s[0:1], 32
 s_mov_b32 s18, 0x400000
 s_mov_b32 s19, 0x20000
 s_sub_u32 s3, s5, 4
 s_lshl_b32 s3, s3, 3
 s_lshr_b32 s7, s6, 2
 s_add_u32 s3, s3, s7
 s_lshl_b32 s32, s3, 8
 s_mov_b32 s33, s32
 s_lshl_b32 s34, s3, 14
 s_add_u32 s34, s34, 0x1000000
 s_add_u32 s35, s34, 8192
 s_mov_b32 s36, 16
 s_and_b32 s37, s6, 3
 s_lshl_b32 s7, s3, 5
 s_add_u32 s7, s7, s37
 s_lshl_b32 s7, s7, 2
 s_add_u32 s7, s7, 0x2000
 v_min_u32 v1, 1, v0
 v_lshlrev_b32 v1, 28, v1
 v_add_u32 v13, s7, v1
 s_waitcnt lgkmcnt(0)
 v_and_b32 v1, 63, v0
 v_lshrrev_b32 v2, 3, v0
 v_mul_u32_u24 v10, 1024, v2
 v_lshrrev_b32 v2, 4, v0
 v_xor_b32 v2, v2, v0
 v_and_b32 v2, 7, v2
 v_lshl_add_u32 v10, v2, 4, v10
 v_lshrrev_b32 v2, 4, v1
 v_bfe_u32 v3, v1, 1, 3
 v_xor_b32 v2, v2, v3
 v_and_b32 v3, 15, v1
 v_lshlrev_b32 v3, 7, v3
 v_lshl_add_u32 v4, v2, 4, v3
 v_xor_b32 v5, 64, v4
 v_lshrrev_b32 v2, 4, v0
 v_lshlrev_b32 v11, 13, v2
 v_lshrrev_b32 v2, 7, v0
 v_lshrrev_b32 v3, 4, v1
 v_lshl_add_u32 v3, v2, 2, v3
 v_bfe_u32 v2, v1, 1, 3
 v_xor_b32 v2, v2, v3
 v_lshl_add_u32 v11, v2, 5, v11
 v_and_b32 v2, 1, v1
 v_lshl_add_u32 v11, v2, 4, v11
 v_bfe_u32 v2, v1, 2, 3
 v_xor_b32 v3, s4, v2
 v_lshlrev_b32 v3, 5, v3
 v_and_b32 v2, 3, v2
 v_lshl_add_u32 v3, v2, 8, v3
 v_lshrrev_b32 v2, 4, v1
 v_lshl_add_u32 v3, v2, 11, v3
 v_and_b32 v2, 3, v1
 v_lshl_add_u32 v3, v2, 3, v3
 v_add_u32 v8, 65536, v3
 v_xor_b32 v3, 0x80, v3
 v_add_u32 v9, 65536, v3
 s_lshl_b32 s45, s4, 11
 v_lshl_add_u32 v12, v1, 4, s45
 s_mov_b32 s39, s37
 s_add_u32 s40, s39, 4
 s_lshl_b32 s49, s4, 10
 s_mul_i32 s46, s39, 32768
 s_add_u32 m0, s49, 0
 s_nop 0
 buffer_load_dwordx4 v10, s[8:11], s46 offen offset:0  lds
 s_add_u32 m0, s49, 3968
 s_nop 0
 buffer_load_dwordx4 v10, s[8:11], s46 offen offset:128  lds
 s_add_u32 m0, s49, 7936
 s_nop 0
 buffer_load_dwordx4 v10, s[8:11], s46 offen offset:256  lds
 s_add_u32 m0, s49, 11904
 s_nop 0
 buffer_load_dwordx4 v10, s[8:11], s46 offen offset:384  lds
 s_add_u32 m0, s49, 15872
 s_nop 0
 buffer_load_dwordx4 v10, s[8:11], s46 offen offset:512  lds
 s_add_u32 m0, s49, 19840
 s_nop 0
 buffer_load_dwordx4 v10, s[8:11], s46 offen offset:640  lds
 s_add_u32 m0, s49, 23808
 s_nop 0
 buffer_load_dwordx4 v10, s[8:11], s46 offen offset:768  lds
 s_add_u32 m0, s49, 27776
 s_nop 0
 buffer_load_dwordx4 v10, s[8:11], s46 offen offset:896  lds
 s_lshl_b32 s49, s4, 10
 s_add_u32 s49, s49, 32768
 s_mul_i32 s46, s40, 32768
 s_add_u32 m0, s49, 0
 s_nop 0
 buffer_load_dwordx4 v10, s[8:11], s46 offen offset:0  lds
 s_add_u32 m0, s49, 3968
 s_nop 0
 buffer_load_dwordx4 v10, s[8:11], s46 offen offset:128  lds
 s_add_u32 m0, s49, 7936
 s_nop 0
 buffer_load_dwordx4 v10, s[8:11], s46 offen offset:256  lds
 s_add_u32 m0, s49, 11904
 s_nop 0
 buffer_load_dwordx4 v10, s[8:11], s46 offen offset:384  lds
 s_add_u32 m0, s49, 15872
 s_nop 0
 buffer_load_dwordx4 v10, s[8:11], s46 offen offset:512  lds
 s_add_u32 m0, s49, 19840
 s_nop 0
 buffer_load_dwordx4 v10, s[8:11], s46 offen offset:640  lds
 s_add_u32 m0, s49, 23808
 s_nop 0
 buffer_load_dwordx4 v10, s[8:11], s46 offen offset:768  lds
 s_add_u32 m0, s49, 27776
 s_nop 0
 buffer_load_dwordx4 v10, s[8:11], s46 offen offset:896  lds
 s_lshl_b32 s49, s4, 10
 s_add_u32 m0, s49, 65536
 s_add_u32 s45, s32, 0
 buffer_load_dwordx4 v11, s[12:15], s45 offen nt lds
 s_add_u32 m0, s49, 69632
 s_add_u32 s45, s32, 131072
 buffer_load_dwordx4 v11, s[12:15], s45 offen nt lds
 s_add_u32 m0, s49, 73728
 s_add_u32 s45, s33, 0
 buffer_load_dwordx4 v11, s[16:19], s45 offen nt lds
 s_add_u32 m0, s49, 77824
 s_add_u32 s45, s33, 131072
 buffer_load_dwordx4 v11, s[16:19], s45 offen nt lds
 s_add_u32 m0, s49, 81920
 s_add_u32 s45, s32, 262144
 buffer_load_dwordx4 v11, s[12:15], s45 offen nt lds
 s_add_u32 m0, s49, 86016
 s_add_u32 s45, s32, 393216
 buffer_load_dwordx4 v11, s[12:15], s45 offen nt lds
 s_add_u32 m0, s49, 90112
 s_add_u32 s45, s33, 262144
 buffer_load_dwordx4 v11, s[16:19], s45 offen nt lds
 s_add_u32 m0, s49, 94208
 s_add_u32 s45, s33, 393216
 buffer_load_dwordx4 v11, s[16:19], s45 offen nt lds
 s_add_u32 m0, s49, 98304
 s_add_u32 s45, s32, 524288
 buffer_load_dwordx4 v11, s[12:15], s45 offen nt lds
 s_add_u32 m0, s49, 102400
 s_add_u32 s45, s32, 655360
 buffer_load_dwordx4 v11, s[12:15], s45 offen nt lds
 s_add_u32 m0, s49, 106496
 s_add_u32 s45, s33, 524288
 buffer_load_dwordx4 v11, s[16:19], s45 offen nt lds
 s_add_u32 m0, s49, 110592
 s_add_u32 s45, s33, 655360
 buffer_load_dwordx4 v11, s[16:19], s45 offen nt lds
 s_waitcnt vmcnt(8) lgkmcnt(0)
 s_barrier
 s_add_u32 m0, s49, 114688
 s_add_u32 s45, s32, 786432
 buffer_load_dwordx4 v11, s[12:15], s45 offen nt lds
 s_add_u32 m0, s49, 118784
 s_add_u32 s45, s32, 917504
 buffer_load_dwordx4 v11, s[12:15], s45 offen nt lds
 s_add_u32 m0, s49, 122880
 s_add_u32 s45, s33, 786432
 buffer_load_dwordx4 v11, s[16:19], s45 offen nt lds
 s_add_u32 m0, s49, 126976
 s_add_u32 s45, s33, 917504
 buffer_load_dwordx4 v11, s[16:19], s45 offen nt lds
 ds_read_b64_tr_b16 a[0:1], v8 offset:0
 ds_read_b64_tr_b16 a[2:3], v8 offset:1024
 ds_read_b64_tr_b16 a[64:65], v9 offset:0
 ds_read_b64_tr_b16 a[66:67], v9 offset:1024
 ds_read_b64_tr_b16 a[128:129], v8 offset:8192
 ds_read_b64_tr_b16 a[130:131], v8 offset:9216
 ds_read_b64_tr_b16 a[192:193], v9 offset:8192
 ds_read_b64_tr_b16 a[194:195], v9 offset:9216
 s_waitcnt vmcnt(8) lgkmcnt(0)
 s_barrier
 s_add_u32 m0, s49, 65536
 s_add_u32 s45, s32, 1048576
 buffer_load_dwordx4 v11, s[12:15], s45 offen nt lds
 s_add_u32 m0, s49, 69632
 s_add_u32 s45, s32, 1179648
 buffer_load_dwordx4 v11, s[12:15], s45 offen nt lds
 s_add_u32 m0, s49, 73728
 s_add_u32 s45, s33, 1048576
 buffer_load_dwordx4 v11, s[16:19], s45 offen nt lds
 s_add_u32 m0, s49, 77824
 s_add_u32 s45, s33, 1179648
 buffer_load_dwordx4 v11, s[16:19], s45 offen nt lds
 ds_read_b64_tr_b16 a[4:5], v8 offset:16384
 ds_read_b64_tr_b16 a[6:7], v8 offset:17408
 ds_read_b64_tr_b16 a[68:69], v9 offset:16384
 ds_read_b64_tr_b16 a[70:71], v9 offset:17408
 ds_read_b64_tr_b16 a[132:133], v8 offset:24576
 ds_read_b64_tr_b16 a[134:135], v8 offset:25600
 ds_read_b64_tr_b16 a[196:197], v9 offset:24576
 ds_read_b64_tr_b16 a[198:199], v9 offset:25600
 s_waitcnt vmcnt(8) lgkmcnt(0)
 s_barrier
 s_add_u32 m0, s49, 81920
 s_add_u32 s45, s32, 1310720
 buffer_load_dwordx4 v11, s[12:15], s45 offen nt lds
 s_add_u32 m0, s49, 86016
 s_add_u32 s45, s32, 1441792
 buffer_load_dwordx4 v11, s[12:15], s45 offen nt lds
 s_add_u32 m0, s49, 90112
 s_add_u32 s45, s33, 1310720
 buffer_load_dwordx4 v11, s[16:19], s45 offen nt lds
 s_add_u32 m0, s49, 94208
 s_add_u32 s45, s33, 1441792
 buffer_load_dwordx4 v11, s[16:19], s45 offen nt lds
 ds_read_b64_tr_b16 a[8:9], v8 offset:32768
 ds_read_b64_tr_b16 a[10:11], v8 offset:33792
 ds_read_b64_tr_b16 a[72:73], v9 offset:32768
 ds_read_b64_tr_b16 a[74:75], v9 offset:33792
 ds_read_b64_tr_b16 a[136:137], v8 offset:40960
 ds_read_b64_tr_b16 a[138:139], v8 offset:41984
 ds_read_b64_tr_b16 a[200:201], v9 offset:40960
 ds_read_b64_tr_b16 a[202:203], v9 offset:41984
 s_waitcnt vmcnt(8) lgkmcnt(0)
 s_barrier
 s_add_u32 m0, s49, 98304
 s_add_u32 s45, s32, 1572864
 buffer_load_dwordx4 v11, s[12:15], s45 offen nt lds
 s_add_u32 m0, s49, 102400
 s_add_u32 s45, s32, 1703936
 buffer_load_dwordx4 v11, s[12:15], s45 offen nt lds
 s_add_u32 m0, s49, 106496
 s_add_u32 s45, s33, 1572864
 buffer_load_dwordx4 v11, s[16:19], s45 offen nt lds
 s_add_u32 m0, s49, 110592
 s_add_u32 s45, s33, 1703936
 buffer_load_dwordx4 v11, s[16:19], s45 offen nt lds
 ds_read_b64_tr_b16 a[12:13], v8 offset:49152
 ds_read_b64_tr_b16 a[14:15], v8 offset:50176
 ds_read_b64_tr_b16 a[76:77], v9 offset:49152
 ds_read_b64_tr_b16 a[78:79], v9 offset:50176
 ds_read_b64_tr_b16 a[140:141], v8 offset:57344
 ds_read_b64_tr_b16 a[142:143], v8 offset:58368
 ds_read_b64_tr_b16 a[204:205], v9 offset:57344
 ds_read_b64_tr_b16 a[206:207], v9 offset:58368
 s_waitcnt vmcnt(8) lgkmcnt(0)
 s_barrier
 s_add_u32 m0, s49, 114688
 s_add_u32 s45, s32, 1835008
 buffer_load_dwordx4 v11, s[12:15], s45 offen nt lds
 s_add_u32 m0, s49, 118784
 s_add_u32 s45, s32, 1966080
 buffer_load_dwordx4 v11, s[12:15], s45 offen nt lds
 s_add_u32 m0, s49, 122880
 s_add_u32 s45, s33, 1835008
 buffer_load_dwordx4 v11, s[16:19], s45 offen nt lds
 s_add_u32 m0, s49, 126976
 s_add_u32 s45, s33, 1966080
 buffer_load_dwordx4 v11, s[16:19], s45 offen nt lds
 ds_read_b64_tr_b16 a[16:17], v8 offset:0
 ds_read_b64_tr_b16 a[18:19], v8 offset:1024
 ds_read_b64_tr_b16 a[80:81], v9 offset:0
 ds_read_b64_tr_b16 a[82:83], v9 offset:1024
 ds_read_b64_tr_b16 a[144:145], v8 offset:8192
 ds_read_b64_tr_b16 a[146:147], v8 offset:9216
 ds_read_b64_tr_b16 a[208:209], v9 offset:8192
 ds_read_b64_tr_b16 a[210:211], v9 offset:9216
 s_waitcnt vmcnt(8) lgkmcnt(0)
 s_barrier
 s_add_u32 m0, s49, 65536
 s_add_u32 s45, s32, 2097152
 buffer_load_dwordx4 v11, s[12:15], s45 offen nt lds
 s_add_u32 m0, s49, 69632
 s_add_u32 s45, s32, 2228224
 buffer_load_dwordx4 v11, s[12:15], s45 offen nt lds
 s_add_u32 m0, s49, 73728
 s_add_u32 s45, s33, 2097152
 buffer_load_dwordx4 v11, s[16:19], s45 offen nt lds
 s_add_u32 m0, s49, 77824
 s_add_u32 s45, s33, 2228224
 buffer_load_dwordx4 v11, s[16:19], s45 offen nt lds
 ds_read_b64_tr_b16 a[20:21], v8 offset:16384
 ds_read_b64_tr_b16 a[22:23], v8 offset:17408
 ds_read_b64_tr_b16 a[84:85], v9 offset:16384
 ds_read_b64_tr_b16 a[86:87], v9 offset:17408
 ds_read_b64_tr_b16 a[148:149], v8 offset:24576
 ds_read_b64_tr_b16 a[150:151], v8 offset:25600
 ds_read_b64_tr_b16 a[212:213], v9 offset:24576
 ds_read_b64_tr_b16 a[214:215], v9 offset:25600
 s_waitcnt vmcnt(8) lgkmcnt(0)
 s_barrier
 s_add_u32 m0, s49, 81920
 s_add_u32 s45, s32, 2359296
 buffer_load_dwordx4 v11, s[12:15], s45 offen nt lds
 s_add_u32 m0, s49, 86016
 s_add_u32 s45, s32, 2490368
 buffer_load_dwordx4 v11, s[12:15], s45 offen nt lds
 s_add_u32 m0, s49, 90112
 s_add_u32 s45, s33, 2359296
 buffer_load_dwordx4 v11, s[16:19], s45 offen nt lds
 s_add_u32 m0, s49, 94208
 s_add_u32 s45, s33, 2490368
 buffer_load_dwordx4 v11, s[16:19], s45 offen nt lds
 ds_read_b64_tr_b16 a[24:25], v8 offset:32768
 ds_read_b64_tr_b16 a[26:27], v8 offset:33792
 ds_read_b64_tr_b16 a[88:89], v9 offset:32768
 ds_read_b64_tr_b16 a[90:91], v9 offset:33792
 ds_read_b64_tr_b16 a[152:153], v8 offset:40960
 ds_read_b64_tr_b16 a[154:155], v8 offset:41984
 ds_read_b64_tr_b16 a[216:217], v9 offset:40960
 ds_read_b64_tr_b16 a[218:219], v9 offset:41984
 s_waitcnt vmcnt(8) lgkmcnt(0)
 s_barrier
 s_add_u32 m0, s49, 98304
 s_add_u32 s45, s32, 2621440
 buffer_load_dwordx4 v11, s[12:15], s45 offen nt lds
 s_add_u32 m0, s49, 102400
 s_add_u32 s45, s32, 2752512
 buffer_load_dwordx4 v11, s[12:15], s45 offen nt lds
 s_add_u32 m0, s49, 106496
 s_add_u32 s45, s33, 2621440
 buffer_load_dwordx4 v11, s[16:19], s45 offen nt lds
 s_add_u32 m0, s49, 110592
 s_add_u32 s45, s33, 2752512
 buffer_load_dwordx4 v11, s[16:19], s45 offen nt lds
 ds_read_b64_tr_b16 a[28:29], v8 offset:49152
 ds_read_b64_tr_b16 a[30:31], v8 offset:50176
 ds_read_b64_tr_b16 a[92:93], v9 offset:49152
 ds_read_b64_tr_b16 a[94:95], v9 offset:50176
 ds_read_b64_tr_b16 a[156:157], v8 offset:57344
 ds_read_b64_tr_b16 a[158:159], v8 offset:58368
 ds_read_b64_tr_b16 a[220:221], v9 offset:57344
 ds_read_b64_tr_b16 a[222:223], v9 offset:58368
 s_waitcnt vmcnt(8) lgkmcnt(0)
 s_barrier
 s_add_u32 m0, s49, 114688
 s_add_u32 s45, s32, 2883584
 buffer_load_dwordx4 v11, s[12:15], s45 offen nt lds
 s_add_u32 m0, s49, 118784
 s_add_u32 s45, s32, 3014656
 buffer_load_dwordx4 v11, s[12:15], s45 offen nt lds
 s_add_u32 m0, s49, 122880
 s_add_u32 s45, s33, 2883584
 buffer_load_dwordx4 v11, s[16:19], s45 offen nt lds
 s_add_u32 m0, s49, 126976
 s_add_u32 s45, s33, 3014656
 buffer_load_dwordx4 v11, s[16:19], s45 offen nt lds
 ds_read_b64_tr_b16 a[32:33], v8 offset:0
 ds_read_b64_tr_b16 a[34:35], v8 offset:1024
 ds_read_b64_tr_b16 a[96:97], v9 offset:0
 ds_read_b64_tr_b16 a[98:99], v9 offset:1024
 ds_read_b64_tr_b16 a[160:161], v8 offset:8192
 ds_read_b64_tr_b16 a[162:163], v8 offset:9216
 ds_read_b64_tr_b16 a[224:225], v9 offset:8192
 ds_read_b64_tr_b16 a[226:227], v9 offset:9216
 s_waitcnt vmcnt(8) lgkmcnt(0)
 s_barrier
 s_add_u32 m0, s49, 65536
 s_add_u32 s45, s32, 3145728
 buffer_load_dwordx4 v11, s[12:15], s45 offen nt lds
 s_add_u32 m0, s49, 69632
 s_add_u32 s45, s32, 3276800
 buffer_load_dwordx4 v11, s[12:15], s45 offen nt lds
 s_add_u32 m0, s49, 73728
 s_add_u32 s45, s33, 3145728
 buffer_load_dwordx4 v11, s[16:19], s45 offen nt lds
 s_add_u32 m0, s49, 77824
 s_add_u32 s45, s33, 3276800
 buffer_load_dwordx4 v11, s[16:19], s45 offen nt lds
 ds_read_b64_tr_b16 a[36:37], v8 offset:16384
 ds_read_b64_tr_b16 a[38:39], v8 offset:17408
 ds_read_b64_tr_b16 a[100:101], v9 offset:16384
 ds_read_b64_tr_b16 a[102:103], v9 offset:17408
 ds_read_b64_tr_b16 a[164:165], v8 offset:24576
 ds_read_b64_tr_b16 a[166:167], v8 offset:25600
 ds_read_b64_tr_b16 a[228:229], v9 offset:24576
 ds_read_b64_tr_b16 a[230:231], v9 offset:25600
 s_waitcnt vmcnt(8) lgkmcnt(0)
 s_barrier
 s_add_u32 m0, s49, 81920
 s_add_u32 s45, s32, 3407872
 buffer_load_dwordx4 v11, s[12:15], s45 offen nt lds
 s_add_u32 m0, s49, 86016
 s_add_u32 s45, s32, 3538944
 buffer_load_dwordx4 v11, s[12:15], s45 offen nt lds
 s_add_u32 m0, s49, 90112
 s_add_u32 s45, s33, 3407872
 buffer_load_dwordx4 v11, s[16:19], s45 offen nt lds
 s_add_u32 m0, s49, 94208
 s_add_u32 s45, s33, 3538944
 buffer_load_dwordx4 v11, s[16:19], s45 offen nt lds
 ds_read_b64_tr_b16 a[40:41], v8 offset:32768
 ds_read_b64_tr_b16 a[42:43], v8 offset:33792
 ds_read_b64_tr_b16 a[104:105], v9 offset:32768
 ds_read_b64_tr_b16 a[106:107], v9 offset:33792
 ds_read_b64_tr_b16 a[168:169], v8 offset:40960
 ds_read_b64_tr_b16 a[170:171], v8 offset:41984
 ds_read_b64_tr_b16 a[232:233], v9 offset:40960
 ds_read_b64_tr_b16 a[234:235], v9 offset:41984
 s_waitcnt vmcnt(8) lgkmcnt(0)
 s_barrier
 s_add_u32 m0, s49, 98304
 s_add_u32 s45, s32, 3670016
 buffer_load_dwordx4 v11, s[12:15], s45 offen nt lds
 s_add_u32 m0, s49, 102400
 s_add_u32 s45, s32, 3801088
 buffer_load_dwordx4 v11, s[12:15], s45 offen nt lds
 s_add_u32 m0, s49, 106496
 s_add_u32 s45, s33, 3670016
 buffer_load_dwordx4 v11, s[16:19], s45 offen nt lds
 s_add_u32 m0, s49, 110592
 s_add_u32 s45, s33, 3801088
 buffer_load_dwordx4 v11, s[16:19], s45 offen nt lds
 ds_read_b64_tr_b16 a[44:45], v8 offset:49152
 ds_read_b64_tr_b16 a[46:47], v8 offset:50176
 ds_read_b64_tr_b16 a[108:109], v9 offset:49152
 ds_read_b64_tr_b16 a[110:111], v9 offset:50176
 ds_read_b64_tr_b16 a[172:173], v8 offset:57344
 ds_read_b64_tr_b16 a[174:175], v8 offset:58368
 ds_read_b64_tr_b16 a[236:237], v9 offset:57344
 ds_read_b64_tr_b16 a[238:239], v9 offset:58368
 s_waitcnt vmcnt(8) lgkmcnt(0)
 s_barrier
 s_add_u32 m0, s49, 114688
 s_add_u32 s45, s32, 3932160
 buffer_load_dwordx4 v11, s[12:15], s45 offen nt lds
 s_add_u32 m0, s49, 118784
 s_add_u32 s45, s32, 4063232
 buffer_load_dwordx4 v11, s[12:15], s45 offen nt lds
 s_add_u32 m0, s49, 122880
 s_add_u32 s45, s33, 3932160
 buffer_load_dwordx4 v11, s[16:19], s45 offen nt lds
 s_add_u32 m0, s49, 126976
 s_add_u32 s45, s33, 4063232
 buffer_load_dwordx4 v11, s[16:19], s45 offen nt lds
 ds_read_b64_tr_b16 a[48:49], v8 offset:0
 ds_read_b64_tr_b16 a[50:51], v8 offset:1024
 ds_read_b64_tr_b16 a[112:113], v9 offset:0
 ds_read_b64_tr_b16 a[114:115], v9 offset:1024
 ds_read_b64_tr_b16 a[176:177], v8 offset:8192
 ds_read_b64_tr_b16 a[178:179], v8 offset:9216
 ds_read_b64_tr_b16 a[240:241], v9 offset:8192
 ds_read_b64_tr_b16 a[242:243], v9 offset:9216
 s_waitcnt vmcnt(8) lgkmcnt(0)
 s_barrier
 ds_read_b64_tr_b16 a[52:53], v8 offset:16384
 ds_read_b64_tr_b16 a[54:55], v8 offset:17408
 ds_read_b64_tr_b16 a[116:117], v9 offset:16384
 ds_read_b64_tr_b16 a[118:119], v9 offset:17408
 ds_read_b64_tr_b16 a[180:181], v8 offset:24576
 ds_read_b64_tr_b16 a[182:183], v8 offset:25600
 ds_read_b64_tr_b16 a[244:245], v9 offset:24576
 ds_read_b64_tr_b16 a[246:247], v9 offset:25600
 s_waitcnt vmcnt(4) lgkmcnt(0)
 s_barrier
 ds_read_b64_tr_b16 a[56:57], v8 offset:32768
 ds_read_b64_tr_b16 a[58:59], v8 offset:33792
 ds_read_b64_tr_b16 a[120:121], v9 offset:32768
 ds_read_b64_tr_b16 a[122:123], v9 offset:33792
 ds_read_b64_tr_b16 a[184:185], v8 offset:40960
 ds_read_b64_tr_b16 a[186:187], v8 offset:41984
 ds_read_b64_tr_b16 a[248:249], v9 offset:40960
 ds_read_b64_tr_b16 a[250:251], v9 offset:41984
 s_waitcnt vmcnt(0) lgkmcnt(0)
 s_barrier
 ds_read_b64_tr_b16 a[60:61], v8 offset:49152
 ds_read_b64_tr_b16 a[62:63], v8 offset:50176
 ds_read_b64_tr_b16 a[124:125], v9 offset:49152
 ds_read_b64_tr_b16 a[126:127], v9 offset:50176
 ds_read_b64_tr_b16 a[188:189], v8 offset:57344
 ds_read_b64_tr_b16 a[190:191], v8 offset:58368
 ds_read_b64_tr_b16 a[252:253], v9 offset:57344
 ds_read_b64_tr_b16 a[254:255], v9 offset:58368
 s_mov_b32 s50, 0x3e0293ee
 s_mov_b32 s42, 0
 s_mov_b32 s43, 0
 s_mov_b32 s44, 65536
 v_mov_b32 v6, v4
 v_mov_b32 v7, v5
 s_mov_b32 s95, 0x40000
 s_cmp_lg_u32 s4, 0
 s_cbranch_scc1 Lfrk_2
 v_min_u32 v21, 1, v0
 v_lshlrev_b32 v21, 28, v21
Lfr_1:
 buffer_load_dword v20, v21, s[28:31], 0 offen offset:128 sc1
 s_waitcnt vmcnt(0)
 v_cmp_eq_u32 vcc, 1, v20
 s_cbranch_vccnz Lfrk_2
 s_sleep 12
 s_sub_u32 s95, s95, 1
 s_cbranch_scc0 Lfr_1
 s_endpgm
Lfrk_2:
 s_lshl_b32 s47, s2, 13
 s_add_u32 s47, s47, 0x8000000
 s_mov_b32 s48, s47
 v_mov_b32 v14, 0
 s_waitcnt vmcnt(0) lgkmcnt(0)
 s_barrier
 ds_read_b128 v[32:35], v6 offset:0
 ds_read_b128 v[36:39], v6 offset:2048
 ds_read_b128 v[40:43], v7 offset:0
 ds_read_b128 v[44:47], v7 offset:2048
 v_lshlrev_b32 v1, 12, v0
 s_lshl_b32 s45, s6, 7
 buffer_load_dword v15, v1, s[8:11], s45 offen
 v_add_u32 v1, 0x100000, v1
 buffer_load_dword v15, v1, s[8:11], s45 offen
 v_add_u32 v1, 0x100000, v1
 s_waitcnt lgkmcnt(2)
Lps_loop_3:
 v_mfma_f32_16x16x32_bf16 v[64:67], a[0:3], v[32:35], 0
 ds_read_b128 v[48:51], v6 offset:4096
 v_mfma_f32_16x16x32_bf16 v[72:75], a[64:67], v[32:35], 0
 ds_read_b128 v[52:55], v6 offset:6144
 v_mfma_f32_16x16x32_bf16 v[80:83], v[32:35], a[128:131], 0
 s_add_u32 s41, s40, 4
 v_mfma_f32_16x16x32_bf16 v[88:91], v[32:35], a[192:195], 0
 s_add_u32 s45, s42, 2
 s_mul_i32 s46, s41, 32768
 v_mfma_f32_16x16x32_bf16 v[68:71], a[0:3], v[36:39], 0
 s_cmp_lt_u32 s45, s36
 s_cselect_b32 s46, s46, 0
 v_mfma_f32_16x16x32_bf16 v[76:79], a[64:67], v[36:39], 0
 s_lshl_b32 s49, s4, 10
 s_add_u32 s49, s49, s44
 v_mfma_f32_16x16x32_bf16 v[84:87], v[36:39], a[128:131], 0
 v_mfma_f32_16x16x32_bf16 v[92:95], v[36:39], a[192:195], 0
 s_waitcnt lgkmcnt(2)
 v_mfma_f32_16x16x32_bf16 v[64:67], a[4:7], v[40:43], v[64:67]
 ds_read_b128 v[56:59], v7 offset:4096
 v_mfma_f32_16x16x32_bf16 v[72:75], a[68:71], v[40:43], v[72:75]
 ds_read_b128 v[60:63], v7 offset:6144
 v_mfma_f32_16x16x32_bf16 v[80:83], v[40:43], a[132:135], v[80:83]
 s_add_u32 m0, s49, 0
 v_mfma_f32_16x16x32_bf16 v[88:91], v[40:43], a[196:199], v[88:91]
 buffer_load_dwordx4 v10, s[8:11], s46 offen offset:0  lds
 v_mfma_f32_16x16x32_bf16 v[68:71], a[4:7], v[44:47], v[68:71]
 s_add_u32 m0, s49, 3968
 v_mfma_f32_16x16x32_bf16 v[76:79], a[68:71], v[44:47], v[76:79]
 buffer_load_dwordx4 v10, s[8:11], s46 offen offset:128  lds
 v_mfma_f32_16x16x32_bf16 v[84:87], v[44:47], a[132:135], v[84:87]
 v_mfma_f32_16x16x32_bf16 v[92:95], v[44:47], a[196:199], v[92:95]
 s_waitcnt lgkmcnt(2)
 v_mfma_f32_16x16x32_bf16 v[64:67], a[8:11], v[48:51], v[64:67]
 ds_read_b128 v[32:35], v6 offset:8192
 v_mfma_f32_16x16x32_bf16 v[72:75], a[72:75], v[48:51], v[72:75]
 ds_read_b128 v[36:39], v6 offset:10240
 v_mfma_f32_16x16x32_bf16 v[80:83], v[48:51], a[136:139], v[80:83]
 s_add_u32 m0, s49, 7936
 v_mfma_f32_16x16x32_bf16 v[88:91], v[48:51], a[200:203], v[88:91]
 buffer_load_dwordx4 v10, s[8:11], s46 offen offset:256  lds
 v_mfma_f32_16x16x32_bf16 v[68:71], a[8:11], v[52:55], v[68:71]
 s_add_u32 m0, s49, 11904
 v_mfma_f32_16x16x32_bf16 v[76:79], a[72:75], v[52:55], v[76:79]
 buffer_load_dwordx4 v10, s[8:11], s46 offen offset:384  lds
 v_mfma_f32_16x16x32_bf16 v[84:87], v[52:55], a[136:139], v[84:87]
 v_mfma_f32_16x16x32_bf16 v[92:95], v[52:55], a[200:203], v[92:95]
 s_waitcnt lgkmcnt(2)
 v_mfma_f32_16x16x32_bf16 v[64:67], a[12:15], v[56:59], v[64:67]
 ds_read_b128 v[40:43], v7 offset:8192
 v_mfma_f32_16x16x32_bf16 v[72:75], a[76:79], v[56:59], v[72:75]
 ds_read_b128 v[44:47], v7 offset:10240
 v_mfma_f32_16x16x32_bf16 v[80:83], v[56:59], a[140:143], v[80:83]
 s_add_u32 m0, s49, 15872
 v_mfma_f32_16x16x32_bf16 v[88:91], v[56:59], a[204:207], v[88:91]
 buffer_load_dwordx4 v10, s[8:11], s46 offen offset:512  lds
 v_mfma_f32_16x16x32_bf16 v[68:71], a[12:15], v[60:63], v[68:71]
 s_add_u32 m0, s49, 19840
 v_mfma_f32_16x16x32_bf16 v[76:79], a[76:79], v[60:63], v[76:79]
 buffer_load_dwordx4 v10, s[8:11], s46 offen offset:640  lds
 v_mfma_f32_16x16x32_bf16 v[84:87], v[60:63], a[140:143], v[84:87]
 v_mfma_f32_16x16x32_bf16 v[92:95], v[60:63], a[204:207], v[92:95]
 s_waitcnt lgkmcnt(2)
 v_mfma_f32_16x16x32_bf16 v[64:67], a[16:19], v[32:35], v[64:67]
 ds_read_b128 v[48:51], v6 offset:12288
 v_mfma_f32_16x16x32_bf16 v[72:75], a[80:83], v[32:35], v[72:75]
 ds_read_b128 v[52:55], v6 offset:14336
 v_mfma_f32_16x16x32_bf16 v[80:83], v[32:35], a[144:147], v[80:83]
 s_add_u32 m0, s49, 23808
 v_mfma_f32_16x16x32_bf16 v[88:91], v[32:35], a[208:211], v[88:91]
 buffer_load_dwordx4 v10, s[8:11], s46 offen offset:768  lds
 v_mfma_f32_16x16x32_bf16 v[68:71], a[16:19], v[36:39], v[68:71]
 s_add_u32 m0, s49, 27776
 v_mfma_f32_16x16x32_bf16 v[76:79], a[80:83], v[36:39], v[76:79]
 buffer_load_dwordx4 v10, s[8:11], s46 offen offset:896  lds
 v_mfma_f32_16x16x32_bf16 v[84:87], v[36:39], a[144:147], v[84:87]
 v_mfma_f32_16x16x32_bf16 v[92:95], v[36:39], a[208:211], v[92:95]
 s_waitcnt lgkmcnt(2)
 v_mfma_f32_16x16x32_bf16 v[64:67], a[20:23], v[40:43], v[64:67]
 ds_read_b128 v[56:59], v7 offset:12288
 v_mfma_f32_16x16x32_bf16 v[72:75], a[84:87], v[40:43], v[72:75]
 ds_read_b128 v[60:63], v7 offset:14336
 v_mfma_f32_16x16x32_bf16 v[80:83], v[40:43], a[148:151], v[80:83]
 v_mfma_f32_16x16x32_bf16 v[88:91], v[40:43], a[212:215], v[88:91]
 v_mfma_f32_16x16x32_bf16 v[68:71], a[20:23], v[44:47], v[68:71]
 v_mfma_f32_16x16x32_bf16 v[76:79], a[84:87], v[44:47], v[76:79]
 v_mfma_f32_16x16x32_bf16 v[84:87], v[44:47], a[148:151], v[84:87]
 v_mfma_f32_16x16x32_bf16 v[92:95], v[44:47], a[212:215], v[92:95]
 s_waitcnt lgkmcnt(2)
 v_mfma_f32_16x16x32_bf16 v[64:67], a[24:27], v[48:51], v[64:67]
 ds_read_b128 v[32:35], v6 offset:16384
 v_mfma_f32_16x16x32_bf16 v[72:75], a[88:91], v[48:51], v[72:75]
 ds_read_b128 v[36:39], v6 offset:18432
 v_mfma_f32_16x16x32_bf16 v[80:83], v[48:51], a[152:155], v[80:83]
 v_cvt_pk_bf16_f32 v16, v96, v97
 v_mfma_f32_16x16x32_bf16 v[88:91], v[48:51], a[216:219], v[88:91]
 v_cvt_pk_bf16_f32 v17, v104, v105
 v_mfma_f32_16x16x32_bf16 v[68:71], a[24:27], v[52:55], v[68:71]
 v_mfma_f32_16x16x32_bf16 v[76:79], a[88:91], v[52:55], v[76:79]
 v_cvt_pk_bf16_f32 v18, v98, v99
 v_mfma_f32_16x16x32_bf16 v[84:87], v[52:55], a[152:155], v[84:87]
 v_mfma_f32_16x16x32_bf16 v[92:95], v[52:55], a[216:219], v[92:95]
 s_waitcnt lgkmcnt(2)
 v_mfma_f32_16x16x32_bf16 v[64:67], a[28:31], v[56:59], v[64:67]
 ds_read_b128 v[40:43], v7 offset:16384
 v_mfma_f32_16x16x32_bf16 v[72:75], a[92:95], v[56:59], v[72:75]
 ds_read_b128 v[44:47], v7 offset:18432
 v_mfma_f32_16x16x32_bf16 v[80:83], v[56:59], a[156:159], v[80:83]
 v_cvt_pk_bf16_f32 v19, v106, v107
 v_mfma_f32_16x16x32_bf16 v[88:91], v[56:59], a[220:223], v[88:91]
 v_mfma_f32_16x16x32_bf16 v[68:71], a[28:31], v[60:63], v[68:71]
 buffer_store_dwordx4 v[16:19], v12, s[20:23], s47 offen offset:0 sc1
 v_mfma_f32_16x16x32_bf16 v[76:79], a[92:95], v[60:63], v[76:79]
 v_cvt_pk_bf16_f32 v20, v100, v101
 v_mfma_f32_16x16x32_bf16 v[84:87], v[60:63], a[156:159], v[84:87]
 v_mfma_f32_16x16x32_bf16 v[92:95], v[60:63], a[220:223], v[92:95]
 s_waitcnt lgkmcnt(2)
 v_mfma_f32_16x16x32_bf16 v[64:67], a[32:35], v[32:35], v[64:67]
 ds_read_b128 v[48:51], v6 offset:20480
 v_mfma_f32_16x16x32_bf16 v[72:75], a[96:99], v[32:35], v[72:75]
 ds_read_b128 v[52:55], v6 offset:22528
 v_mfma_f32_16x16x32_bf16 v[80:83], v[32:35], a[160:163], v[80:83]
 v_cvt_pk_bf16_f32 v21, v108, v109
 v_mfma_f32_16x16x32_bf16 v[88:91], v[32:35], a[224:227], v[88:91]
 v_mfma_f32_16x16x32_bf16 v[68:71], a[32:35], v[36:39], v[68:71]
 v_cvt_pk_bf16_f32 v22, v102, v103
 v_mfma_f32_16x16x32_bf16 v[76:79], a[96:99], v[36:39], v[76:79]
 v_mfma_f32_16x16x32_bf16 v[84:87], v[36:39], a[160:163], v[84:87]
 v_cvt_pk_bf16_f32 v23, v110, v111
 v_mfma_f32_16x16x32_bf16 v[92:95], v[36:39], a[224:227], v[92:95]
 s_waitcnt lgkmcnt(2)
 v_mfma_f32_16x16x32_bf16 v[64:67], a[36:39], v[40:43], v[64:67]
 ds_read_b128 v[56:59], v7 offset:20480
 v_mfma_f32_16x16x32_bf16 v[72:75], a[100:103], v[40:43], v[72:75]
 ds_read_b128 v[60:63], v7 offset:22528
 v_mfma_f32_16x16x32_bf16 v[80:83], v[40:43], a[164:167], v[80:83]
 buffer_store_dwordx4 v[20:23], v12, s[20:23], s47 offen offset:1024 sc1
 v_mfma_f32_16x16x32_bf16 v[88:91], v[40:43], a[228:231], v[88:91]
 v_mfma_f32_16x16x32_bf16 v[68:71], a[36:39], v[44:47], v[68:71]
 v_cvt_pk_bf16_f32 v24, v112, v113
 v_mfma_f32_16x16x32_bf16 v[76:79], a[100:103], v[44:47], v[76:79]
 v_mfma_f32_16x16x32_bf16 v[84:87], v[44:47], a[164:167], v[84:87]
 v_cvt_pk_bf16_f32 v25, v116, v117
 v_mfma_f32_16x16x32_bf16 v[92:95], v[44:47], a[228:231], v[92:95]
 s_waitcnt lgkmcnt(2)
 v_mfma_f32_16x16x32_bf16 v[64:67], a[40:43], v[48:51], v[64:67]
 ds_read_b128 v[32:35], v6 offset:24576
 v_mfma_f32_16x16x32_bf16 v[72:75], a[104:107], v[48:51], v[72:75]
 ds_read_b128 v[36:39], v6 offset:26624
 v_mfma_f32_16x16x32_bf16 v[80:83], v[48:51], a[168:171], v[80:83]
 v_mfma_f32_16x16x32_bf16 v[88:91], v[48:51], a[232:235], v[88:91]
 v_cvt_pk_bf16_f32 v26, v114, v115
 v_mfma_f32_16x16x32_bf16 v[68:71], a[40:43], v[52:55], v[68:71]
 v_cvt_pk_bf16_f32 v27, v118, v119
 v_mfma_f32_16x16x32_bf16 v[76:79], a[104:107], v[52:55], v[76:79]
 v_mfma_f32_16x16x32_bf16 v[84:87], v[52:55], a[168:171], v[84:87]
 buffer_store_dwordx4 v[24:27], v12, s[20:23], s48 offen offset:0 sc1
 v_mfma_f32_16x16x32_bf16 v[92:95], v[52:55], a[232:235], v[92:95]
 s_waitcnt lgkmcnt(2)
 v_mfma_f32_16x16x32_bf16 v[64:67], a[44:47], v[56:59], v[64:67]
 ds_read_b128 v[40:43], v7 offset:24576
 v_mfma_f32_16x16x32_bf16 v[72:75], a[108:111], v[56:59], v[72:75]
 ds_read_b128 v[44:47], v7 offset:26624
 v_mfma_f32_16x16x32_bf16 v[80:83], v[56:59], a[172:175], v[80:83]
 s_add_u32 s43, s43, 32768
 s_cmp_eq_u32 s43, 131072
 v_mfma_f32_16x16x32_bf16 v[88:91], v[56:59], a[236:239], v[88:91]
 s_cselect_b32 s43, 0, s43
 s_add_u32 s44, s44, 32768
 v_mfma_f32_16x16x32_bf16 v[68:71], a[44:47], v[60:63], v[68:71]
 s_cmp_eq_u32 s44, 131072
 s_cselect_b32 s44, 0, s44
 v_mfma_f32_16x16x32_bf16 v[76:79], a[108:111], v[60:63], v[76:79]
 v_mfma_f32_16x16x32_bf16 v[84:87], v[60:63], a[172:175], v[84:87]
 v_cvt_pk_bf16_f32 v28, v120, v121
 v_mfma_f32_16x16x32_bf16 v[92:95], v[60:63], a[236:239], v[92:95]
 s_waitcnt lgkmcnt(2)
 v_mfma_f32_16x16x32_bf16 v[64:67], a[48:51], v[32:35], v[64:67]
 ds_read_b128 v[48:51], v6 offset:28672
 v_mfma_f32_16x16x32_bf16 v[72:75], a[112:115], v[32:35], v[72:75]
 ds_read_b128 v[52:55], v6 offset:30720
 v_mfma_f32_16x16x32_bf16 v[80:83], v[32:35], a[176:179], v[80:83]
 v_add_u32 v6, s43, v4
 v_mfma_f32_16x16x32_bf16 v[88:91], v[32:35], a[240:243], v[88:91]
 v_mfma_f32_16x16x32_bf16 v[68:71], a[48:51], v[36:39], v[68:71]
 v_cvt_pk_bf16_f32 v29, v124, v125
 v_mfma_f32_16x16x32_bf16 v[76:79], a[112:115], v[36:39], v[76:79]
 v_cvt_pk_bf16_f32 v30, v122, v123
 v_mfma_f32_16x16x32_bf16 v[84:87], v[36:39], a[176:179], v[84:87]
 v_mfma_f32_16x16x32_bf16 v[92:95], v[36:39], a[240:243], v[92:95]
 s_waitcnt lgkmcnt(2)
 v_mfma_f32_16x16x32_bf16 v[64:67], a[52:55], v[40:43], v[64:67]
 ds_read_b128 v[56:59], v7 offset:28672
 v_mfma_f32_16x16x32_bf16 v[72:75], a[116:119], v[40:43], v[72:75]
 ds_read_b128 v[60:63], v7 offset:30720
 v_mfma_f32_16x16x32_bf16 v[80:83], v[40:43], a[180:183], v[80:83]
 v_add_u32 v7, s43, v5
 v_mfma_f32_16x16x32_bf16 v[88:91], v[40:43], a[244:247], v[88:91]
 v_cvt_pk_bf16_f32 v31, v126, v127
 v_mfma_f32_16x16x32_bf16 v[68:71], a[52:55], v[44:47], v[68:71]
 v_mfma_f32_16x16x32_bf16 v[76:79], a[116:119], v[44:47], v[76:79]
 buffer_store_dwordx4 v[28:31], v12, s[20:23], s48 offen offset:1024 sc1
 v_mfma_f32_16x16x32_bf16 v[84:87], v[44:47], a[180:183], v[84:87]
 v_mfma_f32_16x16x32_bf16 v[92:95], v[44:47], a[244:247], v[92:95]
 s_waitcnt lgkmcnt(2)
 v_mfma_f32_16x16x32_bf16 v[64:67], a[56:59], v[48:51], v[64:67]
 s_waitcnt vmcnt(12)
 s_barrier
 ds_read_b128 v[32:35], v6 offset:0
 v_mfma_f32_16x16x32_bf16 v[72:75], a[120:123], v[48:51], v[72:75]
 ds_read_b128 v[36:39], v6 offset:2048
 v_mfma_f32_16x16x32_bf16 v[80:83], v[48:51], a[184:187], v[80:83]
 v_mfma_f32_16x16x32_bf16 v[88:91], v[48:51], a[248:251], v[88:91]
 v_mfma_f32_16x16x32_bf16 v[68:71], a[56:59], v[52:55], v[68:71]
 v_mfma_f32_16x16x32_bf16 v[76:79], a[120:123], v[52:55], v[76:79]
 v_mfma_f32_16x16x32_bf16 v[84:87], v[52:55], a[184:187], v[84:87]
 v_mfma_f32_16x16x32_bf16 v[92:95], v[52:55], a[248:251], v[92:95]
 s_waitcnt lgkmcnt(2)
 v_mfma_f32_16x16x32_bf16 v[64:67], a[60:63], v[56:59], v[64:67]
 ds_read_b128 v[40:43], v7 offset:0
 v_mfma_f32_16x16x32_bf16 v[72:75], a[124:127], v[56:59], v[72:75]
 ds_read_b128 v[44:47], v7 offset:2048
 v_mfma_f32_16x16x32_bf16 v[80:83], v[56:59], a[188:191], v[80:83]
 s_mul_i32 s45, s39, 524288
 s_add_u32 s47, s34, s45
 v_mfma_f32_16x16x32_bf16 v[88:91], v[56:59], a[252:255], v[88:91]
 s_add_u32 s48, s35, s45
 v_mov_b32 v14, s42
 v_mfma_f32_16x16x32_bf16 v[68:71], a[60:63], v[60:63], v[68:71]
 s_mov_b32 s39, s40
 s_mov_b32 s40, s41
 v_mfma_f32_16x16x32_bf16 v[76:79], a[124:127], v[60:63], v[76:79]
 s_add_u32 s42, s42, 1
 v_mfma_f32_16x16x32_bf16 v[84:87], v[60:63], a[188:191], v[84:87]
 v_mfma_f32_16x16x32_bf16 v[92:95], v[60:63], a[252:255], v[92:95]
 s_waitcnt lgkmcnt(2)
 v_mfma_f32_16x16x32_bf16 v[96:99], a[0:3], v[32:35], 0
 ds_read_b128 v[48:51], v6 offset:4096
 v_mfma_f32_16x16x32_bf16 v[104:107], a[64:67], v[32:35], 0
 ds_read_b128 v[52:55], v6 offset:6144
 v_mfma_f32_16x16x32_bf16 v[112:115], v[32:35], a[128:131], 0
 s_add_u32 s41, s40, 4
 v_mfma_f32_16x16x32_bf16 v[120:123], v[32:35], a[192:195], 0
 s_add_u32 s45, s42, 2
 s_mul_i32 s46, s41, 32768
 v_mfma_f32_16x16x32_bf16 v[100:103], a[0:3], v[36:39], 0
 s_cmp_lt_u32 s45, s36
 s_cselect_b32 s46, s46, 0
 v_mfma_f32_16x16x32_bf16 v[108:111], a[64:67], v[36:39], 0
 s_lshl_b32 s49, s4, 10
 s_add_u32 s49, s49, s44
 v_mfma_f32_16x16x32_bf16 v[116:119], v[36:39], a[128:131], 0
 v_mfma_f32_16x16x32_bf16 v[124:127], v[36:39], a[192:195], 0
 s_waitcnt lgkmcnt(2)
 v_mfma_f32_16x16x32_bf16 v[96:99], a[4:7], v[40:43], v[96:99]
 ds_read_b128 v[56:59], v7 offset:4096
 v_mfma_f32_16x16x32_bf16 v[104:107], a[68:71], v[40:43], v[104:107]
 ds_read_b128 v[60:63], v7 offset:6144
 v_mfma_f32_16x16x32_bf16 v[112:115], v[40:43], a[132:135], v[112:115]
 s_add_u32 m0, s49, 0
 v_mfma_f32_16x16x32_bf16 v[120:123], v[40:43], a[196:199], v[120:123]
 buffer_load_dwordx4 v10, s[8:11], s46 offen offset:0  lds
 v_mfma_f32_16x16x32_bf16 v[100:103], a[4:7], v[44:47], v[100:103]
 s_add_u32 m0, s49, 3968
 v_mfma_f32_16x16x32_bf16 v[108:111], a[68:71], v[44:47], v[108:111]
 buffer_load_dwordx4 v10, s[8:11], s46 offen offset:128  lds
 v_mfma_f32_16x16x32_bf16 v[116:119], v[44:47], a[132:135], v[116:119]
 v_mfma_f32_16x16x32_bf16 v[124:127], v[44:47], a[196:199], v[124:127]
 s_waitcnt lgkmcnt(2)
 v_mfma_f32_16x16x32_bf16 v[96:99], a[8:11], v[48:51], v[96:99]
 ds_read_b128 v[32:35], v6 offset:8192
 v_mfma_f32_16x16x32_bf16 v[104:107], a[72:75], v[48:51], v[104:107]
 ds_read_b128 v[36:39], v6 offset:10240
 v_mfma_f32_16x16x32_bf16 v[112:115], v[48:51], a[136:139], v[112:115]
 s_add_u32 m0, s49, 7936
 v_mfma_f32_16x16x32_bf16 v[120:123], v[48:51], a[200:203], v[120:123]
 buffer_load_dwordx4 v10, s[8:11], s46 offen offset:256  lds
 v_mfma_f32_16x16x32_bf16 v[100:103], a[8:11], v[52:55], v[100:103]
 s_add_u32 m0, s49, 11904
 v_mfma_f32_16x16x32_bf16 v[108:111], a[72:75], v[52:55], v[108:111]
 buffer_load_dwordx4 v10, s[8:11], s46 offen offset:384  lds
 v_mfma_f32_16x16x32_bf16 v[116:119], v[52:55], a[136:139], v[116:119]
 v_mfma_f32_16x16x32_bf16 v[124:127], v[52:55], a[200:203], v[124:127]
 s_waitcnt lgkmcnt(2)
 v_mfma_f32_16x16x32_bf16 v[96:99], a[12:15], v[56:59], v[96:99]
 ds_read_b128 v[40:43], v7 offset:8192
 v_mfma_f32_16x16x32_bf16 v[104:107], a[76:79], v[56:59], v[104:107]
 ds_read_b128 v[44:47], v7 offset:10240
 v_mfma_f32_16x16x32_bf16 v[112:115], v[56:59], a[140:143], v[112:115]
 s_add_u32 m0, s49, 15872
 v_mfma_f32_16x16x32_bf16 v[120:123], v[56:59], a[204:207], v[120:123]
 buffer_load_dwordx4 v10, s[8:11], s46 offen offset:512  lds
 v_mfma_f32_16x16x32_bf16 v[100:103], a[12:15], v[60:63], v[100:103]
 s_add_u32 m0, s49, 19840
 v_mfma_f32_16x16x32_bf16 v[108:111], a[76:79], v[60:63], v[108:111]
 buffer_load_dwordx4 v10, s[8:11], s46 offen offset:640  lds
 v_mfma_f32_16x16x32_bf16 v[116:119], v[60:63], a[140:143], v[116:119]
 v_mfma_f32_16x16x32_bf16 v[124:127], v[60:63], a[204:207], v[124:127]
 s_waitcnt lgkmcnt(2)
 v_mfma_f32_16x16x32_bf16 v[96:99], a[16:19], v[32:35], v[96:99]
 ds_read_b128 v[48:51], v6 offset:12288
 v_mfma_f32_16x16x32_bf16 v[104:107], a[80:83], v[32:35], v[104:107]
 ds_read_b128 v[52:55], v6 offset:14336
 v_mfma_f32_16x16x32_bf16 v[112:115], v[32:35], a[144:147], v[112:115]
 s_add_u32 m0, s49, 23808
 v_mfma_f32_16x16x32_bf16 v[120:123], v[32:35], a[208:211], v[120:123]
 buffer_load_dwordx4 v10, s[8:11], s46 offen offset:768  lds
 v_mfma_f32_16x16x32_bf16 v[100:103], a[16:19], v[36:39], v[100:103]
 s_add_u32 m0, s49, 27776
 v_mfma_f32_16x16x32_bf16 v[108:111], a[80:83], v[36:39], v[108:111]
 buffer_load_dwordx4 v10, s[8:11], s46 offen offset:896  lds
 v_mfma_f32_16x16x32_bf16 v[116:119], v[36:39], a[144:147], v[116:119]
 v_mfma_f32_16x16x32_bf16 v[124:127], v[36:39], a[208:211], v[124:127]
 s_waitcnt lgkmcnt(2)
 v_mfma_f32_16x16x32_bf16 v[96:99], a[20:23], v[40:43], v[96:99]
 ds_read_b128 v[56:59], v7 offset:12288
 v_mfma_f32_16x16x32_bf16 v[104:107], a[84:87], v[40:43], v[104:107]
 ds_read_b128 v[60:63], v7 offset:14336
 v_mfma_f32_16x16x32_bf16 v[112:115], v[40:43], a[148:151], v[112:115]
 v_mfma_f32_16x16x32_bf16 v[120:123], v[40:43], a[212:215], v[120:123]
 v_mfma_f32_16x16x32_bf16 v[100:103], a[20:23], v[44:47], v[100:103]
 v_mfma_f32_16x16x32_bf16 v[108:111], a[84:87], v[44:47], v[108:111]
 v_mfma_f32_16x16x32_bf16 v[116:119], v[44:47], a[148:151], v[116:119]
 v_mfma_f32_16x16x32_bf16 v[124:127], v[44:47], a[212:215], v[124:127]
 s_waitcnt lgkmcnt(2)
 v_mfma_f32_16x16x32_bf16 v[96:99], a[24:27], v[48:51], v[96:99]
 ds_read_b128 v[32:35], v6 offset:16384
 v_mfma_f32_16x16x32_bf16 v[104:107], a[88:91], v[48:51], v[104:107]
 ds_read_b128 v[36:39], v6 offset:18432
 v_mfma_f32_16x16x32_bf16 v[112:115], v[48:51], a[152:155], v[112:115]
 v_cvt_pk_bf16_f32 v16, v64, v65
 v_mfma_f32_16x16x32_bf16 v[120:123], v[48:51], a[216:219], v[120:123]
 v_cvt_pk_bf16_f32 v17, v72, v73
 v_mfma_f32_16x16x32_bf16 v[100:103], a[24:27], v[52:55], v[100:103]
 v_mfma_f32_16x16x32_bf16 v[108:111], a[88:91], v[52:55], v[108:111]
 v_cvt_pk_bf16_f32 v18, v66, v67
 v_mfma_f32_16x16x32_bf16 v[116:119], v[52:55], a[152:155], v[116:119]
 v_mfma_f32_16x16x32_bf16 v[124:127], v[52:55], a[216:219], v[124:127]
 s_waitcnt lgkmcnt(2)
 v_mfma_f32_16x16x32_bf16 v[96:99], a[28:31], v[56:59], v[96:99]
 ds_read_b128 v[40:43], v7 offset:16384
 v_mfma_f32_16x16x32_bf16 v[104:107], a[92:95], v[56:59], v[104:107]
 ds_read_b128 v[44:47], v7 offset:18432
 v_mfma_f32_16x16x32_bf16 v[112:115], v[56:59], a[156:159], v[112:115]
 v_cvt_pk_bf16_f32 v19, v74, v75
 v_mfma_f32_16x16x32_bf16 v[120:123], v[56:59], a[220:223], v[120:123]
 v_mfma_f32_16x16x32_bf16 v[100:103], a[28:31], v[60:63], v[100:103]
 buffer_store_dwordx4 v[16:19], v12, s[20:23], s47 offen offset:0 sc1
 v_mfma_f32_16x16x32_bf16 v[108:111], a[92:95], v[60:63], v[108:111]
 v_cvt_pk_bf16_f32 v20, v68, v69
 v_mfma_f32_16x16x32_bf16 v[116:119], v[60:63], a[156:159], v[116:119]
 v_mfma_f32_16x16x32_bf16 v[124:127], v[60:63], a[220:223], v[124:127]
 s_waitcnt lgkmcnt(2)
 v_mfma_f32_16x16x32_bf16 v[96:99], a[32:35], v[32:35], v[96:99]
 ds_read_b128 v[48:51], v6 offset:20480
 v_mfma_f32_16x16x32_bf16 v[104:107], a[96:99], v[32:35], v[104:107]
 ds_read_b128 v[52:55], v6 offset:22528
 v_mfma_f32_16x16x32_bf16 v[112:115], v[32:35], a[160:163], v[112:115]
 v_cvt_pk_bf16_f32 v21, v76, v77
 v_mfma_f32_16x16x32_bf16 v[120:123], v[32:35], a[224:227], v[120:123]
 v_mfma_f32_16x16x32_bf16 v[100:103], a[32:35], v[36:39], v[100:103]
 v_cvt_pk_bf16_f32 v22, v70, v71
 v_mfma_f32_16x16x32_bf16 v[108:111], a[96:99], v[36:39], v[108:111]
 v_mfma_f32_16x16x32_bf16 v[116:119], v[36:39], a[160:163], v[116:119]
 v_cvt_pk_bf16_f32 v23, v78, v79
 v_mfma_f32_16x16x32_bf16 v[124:127], v[36:39], a[224:227], v[124:127]
 s_waitcnt lgkmcnt(2)
 v_mfma_f32_16x16x32_bf16 v[96:99], a[36:39], v[40:43], v[96:99]
 ds_read_b128 v[56:59], v7 offset:20480
 v_mfma_f32_16x16x32_bf16 v[104:107], a[100:103], v[40:43], v[104:107]
 ds_read_b128 v[60:63], v7 offset:22528
 v_mfma_f32_16x16x32_bf16 v[112:115], v[40:43], a[164:167], v[112:115]
 buffer_store_dwordx4 v[20:23], v12, s[20:23], s47 offen offset:1024 sc1
 v_mfma_f32_16x16x32_bf16 v[120:123], v[40:43], a[228:231], v[120:123]
 v_mfma_f32_16x16x32_bf16 v[100:103], a[36:39], v[44:47], v[100:103]
 v_cvt_pk_bf16_f32 v24, v80, v81
 v_mfma_f32_16x16x32_bf16 v[108:111], a[100:103], v[44:47], v[108:111]
 v_mfma_f32_16x16x32_bf16 v[116:119], v[44:47], a[164:167], v[116:119]
 v_cvt_pk_bf16_f32 v25, v84, v85
 v_mfma_f32_16x16x32_bf16 v[124:127], v[44:47], a[228:231], v[124:127]
 s_waitcnt lgkmcnt(2)
 v_mfma_f32_16x16x32_bf16 v[96:99], a[40:43], v[48:51], v[96:99]
 ds_read_b128 v[32:35], v6 offset:24576
 v_mfma_f32_16x16x32_bf16 v[104:107], a[104:107], v[48:51], v[104:107]
 ds_read_b128 v[36:39], v6 offset:26624
 v_mfma_f32_16x16x32_bf16 v[112:115], v[48:51], a[168:171], v[112:115]
 v_mfma_f32_16x16x32_bf16 v[120:123], v[48:51], a[232:235], v[120:123]
 v_cvt_pk_bf16_f32 v26, v82, v83
 v_mfma_f32_16x16x32_bf16 v[100:103], a[40:43], v[52:55], v[100:103]
 v_cvt_pk_bf16_f32 v27, v86, v87
 v_mfma_f32_16x16x32_bf16 v[108:111], a[104:107], v[52:55], v[108:111]
 v_mfma_f32_16x16x32_bf16 v[116:119], v[52:55], a[168:171], v[116:119]
 buffer_store_dwordx4 v[24:27], v12, s[20:23], s48 offen offset:0 sc1
 v_mfma_f32_16x16x32_bf16 v[124:127], v[52:55], a[232:235], v[124:127]
 s_waitcnt lgkmcnt(2)
 v_mfma_f32_16x16x32_bf16 v[96:99], a[44:47], v[56:59], v[96:99]
 ds_read_b128 v[40:43], v7 offset:24576
 v_mfma_f32_16x16x32_bf16 v[104:107], a[108:111], v[56:59], v[104:107]
 ds_read_b128 v[44:47], v7 offset:26624
 v_mfma_f32_16x16x32_bf16 v[112:115], v[56:59], a[172:175], v[112:115]
 s_add_u32 s43, s43, 32768
 s_cmp_eq_u32 s43, 131072
 v_mfma_f32_16x16x32_bf16 v[120:123], v[56:59], a[236:239], v[120:123]
 s_cselect_b32 s43, 0, s43
 s_add_u32 s44, s44, 32768
 v_mfma_f32_16x16x32_bf16 v[100:103], a[44:47], v[60:63], v[100:103]
 s_cmp_eq_u32 s44, 131072
 s_cselect_b32 s44, 0, s44
 v_mfma_f32_16x16x32_bf16 v[108:111], a[108:111], v[60:63], v[108:111]
 v_mfma_f32_16x16x32_bf16 v[116:119], v[60:63], a[172:175], v[116:119]
 v_cvt_pk_bf16_f32 v28, v88, v89
 v_mfma_f32_16x16x32_bf16 v[124:127], v[60:63], a[236:239], v[124:127]
 s_waitcnt lgkmcnt(2)
 v_mfma_f32_16x16x32_bf16 v[96:99], a[48:51], v[32:35], v[96:99]
 ds_read_b128 v[48:51], v6 offset:28672
 v_mfma_f32_16x16x32_bf16 v[104:107], a[112:115], v[32:35], v[104:107]
 ds_read_b128 v[52:55], v6 offset:30720
 v_mfma_f32_16x16x32_bf16 v[112:115], v[32:35], a[176:179], v[112:115]
 v_add_u32 v6, s43, v4
 v_mfma_f32_16x16x32_bf16 v[120:123], v[32:35], a[240:243], v[120:123]
 v_mfma_f32_16x16x32_bf16 v[100:103], a[48:51], v[36:39], v[100:103]
 v_cvt_pk_bf16_f32 v29, v92, v93
 v_mfma_f32_16x16x32_bf16 v[108:111], a[112:115], v[36:39], v[108:111]
 v_cvt_pk_bf16_f32 v30, v90, v91
 v_mfma_f32_16x16x32_bf16 v[116:119], v[36:39], a[176:179], v[116:119]
 v_mfma_f32_16x16x32_bf16 v[124:127], v[36:39], a[240:243], v[124:127]
 s_waitcnt lgkmcnt(2)
 v_mfma_f32_16x16x32_bf16 v[96:99], a[52:55], v[40:43], v[96:99]
 ds_read_b128 v[56:59], v7 offset:28672
 v_mfma_f32_16x16x32_bf16 v[104:107], a[116:119], v[40:43], v[104:107]
 ds_read_b128 v[60:63], v7 offset:30720
 v_mfma_f32_16x16x32_bf16 v[112:115], v[40:43], a[180:183], v[112:115]
 v_add_u32 v7, s43, v5
 v_mfma_f32_16x16x32_bf16 v[120:123], v[40:43], a[244:247], v[120:123]
 v_cvt_pk_bf16_f32 v31, v94, v95
 v_mfma_f32_16x16x32_bf16 v[100:103], a[52:55], v[44:47], v[100:103]
 v_mfma_f32_16x16x32_bf16 v[108:111], a[116:119], v[44:47], v[108:111]
 buffer_store_dwordx4 v[28:31], v12, s[20:23], s48 offen offset:1024 sc1
 v_mfma_f32_16x16x32_bf16 v[116:119], v[44:47], a[180:183], v[116:119]
 v_mfma_f32_16x16x32_bf16 v[124:127], v[44:47], a[244:247], v[124:127]
 s_waitcnt lgkmcnt(2)
 v_mfma_f32_16x16x32_bf16 v[96:99], a[56:59], v[48:51], v[96:99]
 s_waitcnt vmcnt(12)
 s_barrier
 ds_read_b128 v[32:35], v6 offset:0
 v_mfma_f32_16x16x32_bf16 v[104:107], a[120:123], v[48:51], v[104:107]
 ds_read_b128 v[36:39], v6 offset:2048
 v_mfma_f32_16x16x32_bf16 v[112:115], v[48:51], a[184:187], v[112:115]
 v_mfma_f32_16x16x32_bf16 v[120:123], v[48:51], a[248:251], v[120:123]
 v_mfma_f32_16x16x32_bf16 v[100:103], a[56:59], v[52:55], v[100:103]
 v_mfma_f32_16x16x32_bf16 v[108:111], a[120:123], v[52:55], v[108:111]
 v_mfma_f32_16x16x32_bf16 v[116:119], v[52:55], a[184:187], v[116:119]
 v_mfma_f32_16x16x32_bf16 v[124:127], v[52:55], a[248:251], v[124:127]
 s_waitcnt lgkmcnt(2)
 v_mfma_f32_16x16x32_bf16 v[96:99], a[60:63], v[56:59], v[96:99]
 ds_read_b128 v[40:43], v7 offset:0
 v_mfma_f32_16x16x32_bf16 v[104:107], a[124:127], v[56:59], v[104:107]
 ds_read_b128 v[44:47], v7 offset:2048
 v_mfma_f32_16x16x32_bf16 v[112:115], v[56:59], a[188:191], v[112:115]
 s_mul_i32 s45, s39, 524288
 s_add_u32 s47, s34, s45
 v_mfma_f32_16x16x32_bf16 v[120:123], v[56:59], a[252:255], v[120:123]
 s_add_u32 s48, s35, s45
 v_mov_b32 v14, s42
 v_mfma_f32_16x16x32_bf16 v[100:103], a[60:63], v[60:63], v[100:103]
 s_mov_b32 s39, s40
 s_mov_b32 s40, s41
 v_mfma_f32_16x16x32_bf16 v[108:111], a[124:127], v[60:63], v[108:111]
 s_add_u32 s42, s42, 1
 s_cmp_lt_u32 s42, s36
 v_mfma_f32_16x16x32_bf16 v[116:119], v[60:63], a[188:191], v[116:119]
 v_mfma_f32_16x16x32_bf16 v[124:127], v[60:63], a[252:255], v[124:127]
 s_waitcnt lgkmcnt(2)
 s_cbranch_scc1 Lps_loop_3
 s_nop 7
 v_cvt_pk_bf16_f32 v16, v96, v97
 v_cvt_pk_bf16_f32 v17, v104, v105
 v_cvt_pk_bf16_f32 v18, v98, v99
 v_cvt_pk_bf16_f32 v19, v106, v107
 buffer_store_dwordx4 v[16:19], v12, s[20:23], s47 offen offset:0 sc1
 v_cvt_pk_bf16_f32 v20, v100, v101
 v_cvt_pk_bf16_f32 v21, v108, v109
 v_cvt_pk_bf16_f32 v22, v102, v103
 v_cvt_pk_bf16_f32 v23, v110, v111
 buffer_store_dwordx4 v[20:23], v12, s[20:23], s47 offen offset:1024 sc1
 v_cvt_pk_bf16_f32 v24, v112, v113
 v_cvt_pk_bf16_f32 v25, v116, v117
 v_cvt_pk_bf16_f32 v26, v114, v115
 v_cvt_pk_bf16_f32 v27, v118, v119
 buffer_store_dwordx4 v[24:27], v12, s[20:23], s48 offen offset:0 sc1
 v_cvt_pk_bf16_f32 v28, v120, v121
 v_cvt_pk_bf16_f32 v29, v124, v125
 v_cvt_pk_bf16_f32 v30, v122, v123
 v_cvt_pk_bf16_f32 v31, v126, v127
 buffer_store_dwordx4 v[28:31], v12, s[20:23], s48 offen offset:1024 sc1
 s_waitcnt vmcnt(0) lgkmcnt(0)
 s_barrier
 v_mov_b32 v14, s36
 buffer_store_dword v14, v13, s[20:23], 0 offen sc1
 s_mov_b32 s32, s3
 s_and_b32 s33, s6, 3
 s_sub_u32 s34, 7, s33
 v_and_b32 v1, 63, v0
 v_lshlrev_b32 v1, 4, v1
 v_mov_b32 v4, 0xff800000
 v_min_u32 v5, 1, v0
 v_lshlrev_b32 v5, 28, v5
 v_mov_b32 v6, 0x3f803f80
 v_accvgpr_write_b32 a192, v6
 v_accvgpr_write_b32 a193, v6
 v_accvgpr_write_b32 a194, v6
 v_accvgpr_write_b32 a195, v6
 s_mov_b32 s52, 0xfff0ffff
 s_mov_b32 s53, 0xf000ff00
 s_mov_b32 s54, 0xffe0fffe
 s_mov_b32 s55, 0xe000fe00
 s_mov_b32 s56, 0xffc0fffc
 s_mov_b32 s57, 0xc000fc00
 s_mov_b32 s58, 0xff80fff8
 s_mov_b32 s59, 0x8000f800
 s_mov_b32 s73, 0x53800000
 s_mov_b32 s74, 0x21800000
 s_lshl_b32 s50, s4, 12
 s_lshl_b32 s45, s32, 14
 s_add_u32 s45, s45, s50
 s_add_u32 s45, s45, 0x1000000
 s_lshl_b32 s36, s33, 3
 s_add_u32 s36, s36, 8
 s_lshl_b32 s47, s34, 3
 s_add_u32 s47, s47, 8
 s_mov_b32 s35, 0
 s_mov_b32 s38, 0
 s_mov_b32 s46, 0
 s_lshl_b32 s7, s3, 7
 s_add_u32 s7, s7, 0x2000
 s_lshr_b32 s94, s3, 1
 s_lshl_b32 s94, s94, 7
 s_add_u32 s94, s94, 0x3000
 v_mov_b32 v8, 0
Law_4:
 buffer_load_dwordx4 v[16:19], v8, s[20:23], s7 offen sc1
 buffer_load_dwordx4 v[20:23], v8, s[20:23], s94 offen sc1
 s_waitcnt vmcnt(0)
 v_min3_u32 v16, v16, v17, v18
 v_min3_u32 v16, v16, v19, v20
 v_min3_u32 v16, v16, v21, v22
 v_min_u32 v16, v16, v23
 v_cmp_le_u32 vcc, 16, v16
 s_cbranch_vccnz Lawk_5
 s_sleep 2
 s_sub_u32 s95, s95, 1
 s_cbranch_scc0 Law_4
 s_endpgm
Lawk_5:
 s_lshl_b32 s37, s35, 19
 s_add_u32 m0, s38, s50
 s_add_u32 s37, s37, s45
 buffer_load_dwordx4 v1, s[20:23], s37 offen offset:0 sc1 lds
 buffer_load_dwordx4 v1, s[20:23], s37 offen offset:1024 sc1 lds
 buffer_load_dwordx4 v1, s[20:23], s37 offen offset:2048 sc1 lds
 buffer_load_dwordx4 v1, s[20:23], s37 offen offset:3072 sc1 lds
 s_add_u32 s38, s38, 0x4000
 s_and_b32 s38, s38, 0x1ffff
 s_add_u32 s35, s35, 1
 s_cmp_eq_u32 s35, s36
 s_cselect_b32 s36, s47, s36
 s_cselect_b32 s35, 0, s35
 s_lshl_b32 s44, s33, 3
 s_add_u32 s44, s44, s4
 s_lshl_b32 s44, s44, 5
 s_add_u32 s44, s44, s32
 s_lshl_b32 s44, s44, 13
 s_add_u32 s44, s44, 0x5000000
 buffer_load_dwordx4 a[0:3], v1, s[20:23], s44 offen offset:0 sc1
 buffer_load_dwordx4 a[16:19], v1, s[20:23], s44 offen offset:1024 sc1
 buffer_load_dwordx4 a[4:7], v1, s[20:23], s44 offen offset:2048 sc1
 buffer_load_dwordx4 a[20:23], v1, s[20:23], s44 offen offset:3072 sc1
 s_add_u32 s44, s44, 4096
 buffer_load_dwordx4 a[8:11], v1, s[20:23], s44 offen offset:0 sc1
 buffer_load_dwordx4 a[24:27], v1, s[20:23], s44 offen offset:1024 sc1
 buffer_load_dwordx4 a[12:15], v1, s[20:23], s44 offen offset:2048 sc1
 buffer_load_dwordx4 a[28:31], v1, s[20:23], s44 offen offset:3072 sc1
 s_lshl_b32 s44, s33, 3
 s_add_u32 s44, s44, 7
 s_sub_u32 s44, s44, s4
 s_lshl_b32 s44, s44, 5
 s_add_u32 s44, s44, s32
 s_lshl_b32 s44, s44, 13
 s_add_u32 s44, s44, 0x5000000
 buffer_load_dwordx4 a[32:35], v1, s[20:23], s44 offen offset:0 sc1
 buffer_load_dwordx4 a[48:51], v1, s[20:23], s44 offen offset:1024 sc1
 buffer_load_dwordx4 a[36:39], v1, s[20:23], s44 offen offset:2048 sc1
 buffer_load_dwordx4 a[52:55], v1, s[20:23], s44 offen offset:3072 sc1
 s_add_u32 s44, s44, 4096
 buffer_load_dwordx4 a[40:43], v1, s[20:23], s44 offen offset:0 sc1
 buffer_load_dwordx4 a[56:59], v1, s[20:23], s44 offen offset:1024 sc1
 buffer_load_dwordx4 a[44:47], v1, s[20:23], s44 offen offset:2048 sc1
 buffer_load_dwordx4 a[60:63], v1, s[20:23], s44 offen offset:3072 sc1
 s_lshl_b32 s37, s35, 19
 s_add_u32 m0, s38, s50
 s_add_u32 s37, s37, s45
 buffer_load_dwordx4 v1, s[20:23], s37 offen offset:0 sc1 lds
 buffer_load_dwordx4 v1, s[20:23], s37 offen offset:1024 sc1 lds
 buffer_load_dwordx4 v1, s[20:23], s37 offen offset:2048 sc1 lds
 buffer_load_dwordx4 v1, s[20:23], s37 offen offset:3072 sc1 lds
 s_add_u32 s38, s38, 0x4000
 s_and_b32 s38, s38, 0x1ffff
 s_add_u32 s35, s35, 1
 s_cmp_eq_u32 s35, s36
 s_cselect_b32 s36, s47, s36
 s_cselect_b32 s35, 0, s35
 s_lshl_b32 s37, s35, 19
 s_add_u32 m0, s38, s50
 s_add_u32 s37, s37, s45
 buffer_load_dwordx4 v1, s[20:23], s37 offen offset:0 sc1 lds
 buffer_load_dwordx4 v1, s[20:23], s37 offen offset:1024 sc1 lds
 buffer_load_dwordx4 v1, s[20:23], s37 offen offset:2048 sc1 lds
 buffer_load_dwordx4 v1, s[20:23], s37 offen offset:3072 sc1 lds
 s_add_u32 s38, s38, 0x4000
 s_and_b32 s38, s38, 0x1ffff
 s_add_u32 s35, s35, 1
 s_cmp_eq_u32 s35, s36
 s_cselect_b32 s36, s47, s36
 s_cselect_b32 s35, 0, s35
 s_lshl_b32 s37, s35, 19
 s_add_u32 m0, s38, s50
 s_add_u32 s37, s37, s45
 buffer_load_dwordx4 v1, s[20:23], s37 offen offset:0 sc1 lds
 buffer_load_dwordx4 v1, s[20:23], s37 offen offset:1024 sc1 lds
 buffer_load_dwordx4 v1, s[20:23], s37 offen offset:2048 sc1 lds
 buffer_load_dwordx4 v1, s[20:23], s37 offen offset:3072 sc1 lds
 s_add_u32 s38, s38, 0x4000
 s_and_b32 s38, s38, 0x1ffff
 s_add_u32 s35, s35, 1
 s_cmp_eq_u32 s35, s36
 s_cselect_b32 s36, s47, s36
 s_cselect_b32 s35, 0, s35
 s_lshl_b32 s37, s35, 19
 s_add_u32 m0, s38, s50
 s_add_u32 s37, s37, s45
 buffer_load_dwordx4 v1, s[20:23], s37 offen offset:0 sc1 lds
 buffer_load_dwordx4 v1, s[20:23], s37 offen offset:1024 sc1 lds
 buffer_load_dwordx4 v1, s[20:23], s37 offen offset:2048 sc1 lds
 buffer_load_dwordx4 v1, s[20:23], s37 offen offset:3072 sc1 lds
 s_add_u32 s38, s38, 0x4000
 s_and_b32 s38, s38, 0x1ffff
 s_add_u32 s35, s35, 1
 s_cmp_eq_u32 s35, s36
 s_cselect_b32 s36, s47, s36
 s_cselect_b32 s35, 0, s35
 s_lshl_b32 s37, s35, 19
 s_add_u32 m0, s38, s50
 s_add_u32 s37, s37, s45
 buffer_load_dwordx4 v1, s[20:23], s37 offen offset:0 sc1 lds
 buffer_load_dwordx4 v1, s[20:23], s37 offen offset:1024 sc1 lds
 buffer_load_dwordx4 v1, s[20:23], s37 offen offset:2048 sc1 lds
 buffer_load_dwordx4 v1, s[20:23], s37 offen offset:3072 sc1 lds
 s_add_u32 s38, s38, 0x4000
 s_and_b32 s38, s38, 0x1ffff
 s_add_u32 s35, s35, 1
 s_cmp_eq_u32 s35, s36
 s_cselect_b32 s36, s47, s36
 s_cselect_b32 s35, 0, s35
 s_lshl_b32 s37, s35, 19
 s_add_u32 m0, s38, s50
 s_add_u32 s37, s37, s45
 buffer_load_dwordx4 v1, s[20:23], s37 offen offset:0 sc1 lds
 buffer_load_dwordx4 v1, s[20:23], s37 offen offset:1024 sc1 lds
 buffer_load_dwordx4 v1, s[20:23], s37 offen offset:2048 sc1 lds
 buffer_load_dwordx4 v1, s[20:23], s37 offen offset:3072 sc1 lds
 s_add_u32 s38, s38, 0x4000
 s_and_b32 s38, s38, 0x1ffff
 s_add_u32 s35, s35, 1
 s_cmp_eq_u32 s35, s36
 s_cselect_b32 s36, s47, s36
 s_cselect_b32 s35, 0, s35
 s_lshl_b32 s44, s34, 3
 s_add_u32 s44, s44, s4
 s_lshl_b32 s44, s44, 5
 s_add_u32 s44, s44, s32
 s_lshl_b32 s44, s44, 13
 s_add_u32 s44, s44, 0x5000000
 buffer_load_dwordx4 a[64:67], v1, s[20:23], s44 offen offset:0 sc1
 buffer_load_dwordx4 a[80:83], v1, s[20:23], s44 offen offset:1024 sc1
 buffer_load_dwordx4 a[68:71], v1, s[20:23], s44 offen offset:2048 sc1
 buffer_load_dwordx4 a[84:87], v1, s[20:23], s44 offen offset:3072 sc1
 s_add_u32 s44, s44, 4096
 buffer_load_dwordx4 a[72:75], v1, s[20:23], s44 offen offset:0 sc1
 buffer_load_dwordx4 a[88:91], v1, s[20:23], s44 offen offset:1024 sc1
 buffer_load_dwordx4 a[76:79], v1, s[20:23], s44 offen offset:2048 sc1
 buffer_load_dwordx4 a[92:95], v1, s[20:23], s44 offen offset:3072 sc1
 s_lshl_b32 s44, s34, 3
 s_add_u32 s44, s44, 7
 s_sub_u32 s44, s44, s4
 s_lshl_b32 s44, s44, 5
 s_add_u32 s44, s44, s32
 s_lshl_b32 s44, s44, 13
 s_add_u32 s44, s44, 0x5000000
 buffer_load_dwordx4 a[96:99], v1, s[20:23], s44 offen offset:0 sc1
 buffer_load_dwordx4 a[112:115], v1, s[20:23], s44 offen offset:1024 sc1
 buffer_load_dwordx4 a[100:103], v1, s[20:23], s44 offen offset:2048 sc1
 buffer_load_dwordx4 a[116:119], v1, s[20:23], s44 offen offset:3072 sc1
 s_add_u32 s44, s44, 4096
 buffer_load_dwordx4 a[104:107], v1, s[20:23], s44 offen offset:0 sc1
 buffer_load_dwordx4 a[120:123], v1, s[20:23], s44 offen offset:1024 sc1
 buffer_load_dwordx4 a[108:111], v1, s[20:23], s44 offen offset:2048 sc1
 buffer_load_dwordx4 a[124:127], v1, s[20:23], s44 offen offset:3072 sc1
 s_waitcnt vmcnt(40)
 s_barrier
 v_mov_b32 v2, v1
 ds_read_b128 a[128:131], v2 offset:0
 ds_read_b128 a[132:135], v2 offset:1024
 ds_read_b128 a[136:139], v2 offset:2048
 ds_read_b128 a[140:143], v2 offset:3072
 ds_read_b128 a[144:147], v2 offset:4096
 ds_read_b128 a[148:151], v2 offset:5120
 ds_read_b128 a[152:155], v2 offset:6144
 ds_read_b128 a[156:159], v2 offset:7168
 s_mov_b32 s39, 0
 s_add_u32 s39, s39, 0x4000
 s_and_b32 s39, s39, 0x1ffff
 v_mov_b32 v3, v2
 v_add_u32 v2, s39, v1
 s_mov_b32 s72, 0x8000000
Lablk_6:
 s_lshl_b32 s43, s33, 3
 s_add_u32 s41, s43, s4
 s_add_u32 s42, s43, 7
 s_sub_u32 s42, s42, s4
 s_mov_b32 s49, 0
 s_waitcnt lgkmcnt(0)
 v_mfma_f32_16x16x32_bf16 v[48:51], a[128:131], a[0:3], 0
 s_cmp_lt_u32 s49, s41
 v_mov_b64 v[176:177], 0
 v_mov_b64 v[178:179], 0
 v_mfma_f32_16x16x32_bf16 v[56:59], a[128:131], a[16:19], 0
 s_cselect_b64 s[68:69], -1, 0
 v_mov_b64 v[180:181], 0
 v_mov_b64 v[182:183], 0
 v_mfma_f32_16x16x32_bf16 v[64:67], a[128:131], a[32:35], 0
 v_mfma_f32_16x16x32_bf16 v[72:75], a[128:131], a[48:51], 0
 s_cmp_le_u32 s49, s41
 v_mov_b64 v[184:185], 0
 v_mov_b64 v[186:187], 0
 v_mfma_f32_16x16x32_bf16 v[48:51], a[136:139], a[4:7], v[48:51]
 v_mfma_f32_16x16x32_bf16 v[56:59], a[136:139], a[20:23], v[56:59]
 s_cselect_b64 s[70:71], -1, 0
 v_mov_b64 v[188:189], 0
 v_mov_b64 v[190:191], 0
 v_mfma_f32_16x16x32_bf16 v[64:67], a[136:139], a[36:39], v[64:67]
 v_mfma_f32_16x16x32_bf16 v[72:75], a[136:139], a[52:55], v[72:75]
 s_cmp_eq_u32 s49, s41
 v_mov_b64 v[192:193], 0
 v_mov_b64 v[194:195], 0
 v_mfma_f32_16x16x32_bf16 v[48:51], a[144:147], a[8:11], v[48:51]
 s_cselect_b64 s[60:61], s[52:53], s[68:69]
 v_mfma_f32_16x16x32_bf16 v[56:59], a[144:147], a[24:27], v[56:59]
 v_mov_b64 v[196:197], 0
 v_mov_b64 v[198:199], 0
 v_mfma_f32_16x16x32_bf16 v[64:67], a[144:147], a[40:43], v[64:67]
 s_cselect_b64 s[62:63], s[54:55], s[68:69]
 v_mfma_f32_16x16x32_bf16 v[72:75], a[144:147], a[56:59], v[72:75]
 v_mov_b64 v[200:201], 0
 v_mov_b64 v[202:203], 0
 v_mfma_f32_16x16x32_bf16 v[48:51], a[152:155], a[12:15], v[48:51]
 s_cselect_b64 s[64:65], s[56:57], s[68:69]
 v_mfma_f32_16x16x32_bf16 v[56:59], a[152:155], a[28:31], v[56:59]
 v_mov_b64 v[204:205], 0
 v_mov_b64 v[206:207], 0
 v_mfma_f32_16x16x32_bf16 v[64:67], a[152:155], a[44:47], v[64:67]
 s_cselect_b64 s[66:67], s[58:59], s[68:69]
 v_mfma_f32_16x16x32_bf16 v[72:75], a[152:155], a[60:63], v[72:75]
 s_nop 4
 v_max3_f32 v12, v48, v49, v50
 v_max3_f32 v13, v56, v57, v58
 v_max3_f32 v14, v64, v65, v66
 v_max3_f32 v15, v72, v73, v74
 v_max_f32 v12, v12, v51
 v_max_f32 v13, v13, v59
 v_max_f32 v14, v14, v67
 v_max_f32 v15, v15, v75
 v_mov_b32 v6, v12
 v_mov_b32 v7, v13
 v_mov_b32 v8, v14
 v_mov_b32 v9, v15
 v_permlane16_swap_b32 v12, v6
 v_permlane16_swap_b32 v13, v7
 v_permlane16_swap_b32 v14, v8
 v_permlane16_swap_b32 v15, v9
 v_max_f32 v12, v12, v6
 v_max_f32 v13, v13, v7
 v_max_f32 v14, v14, v8
 v_max_f32 v15, v15, v9
 v_mov_b32 v6, v12
 v_mov_b32 v7, v13
 v_mov_b32 v8, v14
 v_mov_b32 v9, v15
 v_permlane32_swap_b32 v12, v6
 v_permlane32_swap_b32 v13, v7
 v_permlane32_swap_b32 v14, v8
 v_permlane32_swap_b32 v15, v9
 v_max_f32 v12, v12, v6
 v_max_f32 v13, v13, v7
 v_max_f32 v14, v14, v8
 v_max_f32 v15, v15, v9
 v_sub_f32 v12, 0, v12
 v_sub_f32 v13, 0, v13
 v_sub_f32 v14, 0, v14
 v_sub_f32 v15, 0, v15
 v_cndmask_b32 v80, v4, v12, s[60:61]
 v_cndmask_b32 v81, v4, v12, s[62:63]
 v_cndmask_b32 v82, v4, v12, s[64:65]
 v_cndmask_b32 v83, v4, v12, s[66:67]
 v_cndmask_b32 v84, v4, v12, s[68:69]
 v_cndmask_b32 v85, v4, v12, s[68:69]
 v_cndmask_b32 v86, v4, v12, s[68:69]
 v_cndmask_b32 v87, v4, v12, s[68:69]
 v_cndmask_b32 v88, v4, v13, s[70:71]
 v_cndmask_b32 v89, v4, v13, s[70:71]
 v_cndmask_b32 v90, v4, v13, s[70:71]
 v_cndmask_b32 v91, v4, v13, s[70:71]
 v_cndmask_b32 v92, v4, v13, s[60:61]
 v_cndmask_b32 v93, v4, v13, s[62:63]
 v_cndmask_b32 v94, v4, v13, s[64:65]
 v_cndmask_b32 v95, v4, v13, s[66:67]
 v_mov_b32 v96, v14
 v_mov_b32 v97, v14
 v_mov_b32 v98, v14
 v_mov_b32 v99, v14
 v_mov_b32 v100, v14
 v_mov_b32 v101, v14
 v_mov_b32 v102, v14
 v_mov_b32 v103, v14
 v_mov_b32 v104, v15
 v_mov_b32 v105, v15
 v_mov_b32 v106, v15
 v_mov_b32 v107, v15
 v_mov_b32 v108, v15
 v_mov_b32 v109, v15
 v_mov_b32 v110, v15
 v_mov_b32 v111, v15
 v_mov_b32 v6, 1
 s_waitcnt lgkmcnt(0)
 v_mfma_f32_16x16x32_bf16 v[48:51], a[128:131], a[0:3], v[80:83]
 ds_read_b128 a[160:163], v3 offset:8192
 v_mov_b64 v[208:209], 0
 v_mov_b64 v[210:211], 0
 v_mfma_f32_16x16x32_bf16 v[56:59], a[128:131], a[16:19], v[88:91]
 v_mov_b64 v[212:213], 0
 v_mov_b64 v[214:215], 0
 v_mfma_f32_16x16x32_bf16 v[52:55], a[132:135], a[0:3], v[84:87]
 ds_read_b128 a[164:167], v3 offset:9216
 v_mfma_f32_16x16x32_bf16 v[60:63], a[132:135], a[16:19], v[92:95]
 v_mov_b64 v[216:217], 0
 v_mov_b64 v[218:219], 0
 v_mfma_f32_16x16x32_bf16 v[48:51], a[136:139], a[4:7], v[48:51]
 ds_read_b128 a[168:171], v3 offset:10240
 v_mov_b64 v[220:221], 0
 v_mov_b64 v[222:223], 0
 v_mfma_f32_16x16x32_bf16 v[56:59], a[136:139], a[20:23], v[56:59]
 v_mfma_f32_16x16x32_bf16 v[52:55], a[140:143], a[4:7], v[52:55]
 ds_read_b128 a[172:175], v3 offset:11264
 v_mov_b64 v[224:225], 0
 v_mov_b64 v[226:227], 0
 v_mfma_f32_16x16x32_bf16 v[60:63], a[140:143], a[20:23], v[60:63]
 v_mov_b64 v[228:229], 0
 v_mov_b64 v[230:231], 0
 v_mfma_f32_16x16x32_bf16 v[48:51], a[144:147], a[8:11], v[48:51]
 ds_read_b128 a[176:179], v3 offset:12288
 v_mfma_f32_16x16x32_bf16 v[56:59], a[144:147], a[24:27], v[56:59]
 v_mov_b64 v[232:233], 0
 v_mov_b64 v[234:235], 0
 v_mfma_f32_16x16x32_bf16 v[52:55], a[148:151], a[8:11], v[52:55]
 ds_read_b128 a[180:183], v3 offset:13312
 v_mov_b64 v[236:237], 0
 v_mov_b64 v[238:239], 0
 v_mfma_f32_16x16x32_bf16 v[60:63], a[148:151], a[24:27], v[60:63]
 v_mfma_f32_16x16x32_bf16 v[48:51], a[152:155], a[12:15], v[48:51]
 ds_read_b128 a[184:187], v3 offset:14336
 v_mov_b64 v[40:41], 0
 v_mov_b64 v[42:43], 0
 v_mfma_f32_16x16x32_bf16 v[56:59], a[152:155], a[28:31], v[56:59]
 v_mov_b64 v[44:45], 0
 v_mov_b64 v[46:47], 0
 v_mfma_f32_16x16x32_bf16 v[52:55], a[156:159], a[12:15], v[52:55]
 ds_read_b128 a[188:191], v3 offset:15360
 v_mfma_f32_16x16x32_bf16 v[60:63], a[156:159], a[28:31], v[60:63]
 v_mfma_f32_16x16x32_bf16 v[64:67], a[128:131], a[32:35], v[96:99]
 s_waitcnt vmcnt(0)
 s_barrier
 buffer_store_dword v6, v5, s[20:23], s72 offen sc1
 v_mfma_f32_16x16x32_bf16 v[72:75], a[128:131], a[48:51], v[104:107]
 ds_read_b128 a[128:131], v2 offset:0
 v_mfma_f32_16x16x32_bf16 v[68:71], a[132:135], a[32:35], v[100:103]
 s_add_u32 s49, s49, 1
 v_mfma_f32_16x16x32_bf16 v[76:79], a[132:135], a[48:51], v[108:111]
 ds_read_b128 a[132:135], v2 offset:1024
 v_exp_f32 v48, v48
 v_exp_f32 v49, v49
 v_mfma_f32_16x16x32_bf16 v[64:67], a[136:139], a[36:39], v[64:67]
 s_cmp_lt_u32 s49, s41
 v_exp_f32 v52, v52
 v_exp_f32 v53, v53
 v_mfma_f32_16x16x32_bf16 v[72:75], a[136:139], a[52:55], v[72:75]
 ds_read_b128 a[136:139], v2 offset:2048
 v_exp_f32 v50, v50
 v_mfma_f32_16x16x32_bf16 v[68:71], a[140:143], a[36:39], v[68:71]
 s_cselect_b64 s[68:69], -1, 0
 v_cvt_pk_bf16_f32 v16, v48, v49
 v_cvt_pk_bf16_f32 v17, v52, v53
 v_exp_f32 v51, v51
 v_mfma_f32_16x16x32_bf16 v[76:79], a[140:143], a[52:55], v[76:79]
 ds_read_b128 a[140:143], v2 offset:3072
 v_exp_f32 v54, v54
 v_exp_f32 v55, v55
 v_mfma_f32_16x16x32_bf16 v[64:67], a[144:147], a[40:43], v[64:67]
 v_cvt_pk_bf16_f32 v18, v50, v51
 v_cvt_pk_bf16_f32 v19, v54, v55
 v_mfma_f32_16x16x32_bf16 v[72:75], a[144:147], a[56:59], v[72:75]
 ds_read_b128 a[144:147], v2 offset:4096
 v_exp_f32 v56, v56
 v_exp_f32 v57, v57
 v_mfma_f32_16x16x32_bf16 v[68:71], a[148:151], a[40:43], v[68:71]
 s_cmp_le_u32 s49, s41
 v_exp_f32 v60, v60
 v_exp_f32 v61, v61
 v_mfma_f32_16x16x32_bf16 v[76:79], a[148:151], a[56:59], v[76:79]
 ds_read_b128 a[148:151], v2 offset:5120
 v_exp_f32 v58, v58
 v_mfma_f32_16x16x32_bf16 v[64:67], a[152:155], a[44:47], v[64:67]
 s_cselect_b64 s[70:71], -1, 0
 v_cvt_pk_bf16_f32 v20, v56, v57
 v_cvt_pk_bf16_f32 v21, v60, v61
 v_exp_f32 v59, v59
 v_mfma_f32_16x16x32_bf16 v[72:75], a[152:155], a[60:63], v[72:75]
 ds_read_b128 a[152:155], v2 offset:6144
 v_exp_f32 v62, v62
 v_exp_f32 v63, v63
 v_mfma_f32_16x16x32_bf16 v[68:71], a[156:159], a[44:47], v[68:71]
 v_cvt_pk_bf16_f32 v22, v58, v59
 v_cvt_pk_bf16_f32 v23, v62, v63
 v_mfma_f32_16x16x32_bf16 v[76:79], a[156:159], a[60:63], v[76:79]
 ds_read_b128 a[156:159], v2 offset:7168
 s_waitcnt lgkmcnt(8)
 v_mfma_f32_16x16x32_bf16 v[112:115], a[160:163], v[16:19], 0
 s_add_u32 s39, s39, 0x4000
 s_and_b32 s39, s39, 0x1ffff
 v_mfma_f32_16x16x32_bf16 v[144:147], a[160:163], v[20:23], 0
 s_cmp_eq_u32 s49, s41
 v_mfma_f32_16x16x32_bf16 v[116:119], a[164:167], v[16:19], 0
 s_cselect_b64 s[60:61], s[52:53], s[68:69]
 v_mfma_f32_16x16x32_bf16 v[148:151], a[164:167], v[20:23], 0
 s_cselect_b64 s[62:63], s[54:55], s[68:69]
 v_mov_b32 v3, v2
 v_add_u32 v2, s39, v1
 v_exp_f32 v64, v64
 v_mfma_f32_16x16x32_bf16 v[120:123], a[168:171], v[16:19], 0
 s_cselect_b64 s[64:65], s[56:57], s[68:69]
 v_exp_f32 v65, v65
 v_mfma_f32_16x16x32_bf16 v[152:155], a[168:171], v[20:23], 0
 s_cselect_b64 s[66:67], s[58:59], s[68:69]
 v_exp_f32 v68, v68
 v_mfma_f32_16x16x32_bf16 v[124:127], a[172:175], v[16:19], 0
 s_lshl_b32 s37, s35, 19
 v_exp_f32 v69, v69
 v_exp_f32 v66, v66
 v_mfma_f32_16x16x32_bf16 v[156:159], a[172:175], v[20:23], 0
 s_add_u32 m0, s38, s50
 v_cvt_pk_bf16_f32 v24, v64, v65
 v_cvt_pk_bf16_f32 v25, v68, v69
 v_mfma_f32_16x16x32_bf16 v[128:131], a[176:179], v[16:19], 0
 s_add_u32 s37, s37, s45
 v_exp_f32 v67, v67
 v_mfma_f32_16x16x32_bf16 v[160:163], a[176:179], v[20:23], 0
 buffer_load_dwordx4 v1, s[20:23], s37 offen offset:0 sc1 lds
 buffer_load_dwordx4 v1, s[20:23], s37 offen offset:1024 sc1 lds
 v_exp_f32 v70, v70
 v_mfma_f32_16x16x32_bf16 v[132:135], a[180:183], v[16:19], 0
 buffer_load_dwordx4 v1, s[20:23], s37 offen offset:2048 sc1 lds
 v_exp_f32 v71, v71
 v_cvt_pk_bf16_f32 v26, v66, v67
 v_cvt_pk_bf16_f32 v27, v70, v71
 v_mfma_f32_16x16x32_bf16 v[164:167], a[180:183], v[20:23], 0
 buffer_load_dwordx4 v1, s[20:23], s37 offen offset:3072 sc1 lds
 v_cndmask_b32 v80, v4, v12, s[60:61]
 v_cndmask_b32 v81, v4, v12, s[62:63]
 v_mfma_f32_16x16x32_bf16 v[136:139], a[184:187], v[16:19], 0
 s_add_u32 s38, s38, 0x4000
 v_cndmask_b32 v82, v4, v12, s[64:65]
 v_cndmask_b32 v83, v4, v12, s[66:67]
 v_mfma_f32_16x16x32_bf16 v[168:171], a[184:187], v[20:23], 0
 s_and_b32 s38, s38, 0x1ffff
 v_cndmask_b32 v84, v4, v12, s[68:69]
 v_cndmask_b32 v85, v4, v12, s[68:69]
 v_mfma_f32_16x16x32_bf16 v[140:143], a[188:191], v[16:19], 0
 s_add_u32 s35, s35, 1
 v_cndmask_b32 v86, v4, v12, s[68:69]
 v_cndmask_b32 v87, v4, v12, s[68:69]
 v_cndmask_b32 v88, v4, v13, s[70:71]
 v_cndmask_b32 v89, v4, v13, s[70:71]
 v_mfma_f32_16x16x32_bf16 v[172:175], a[188:191], v[20:23], 0
 s_cmp_eq_u32 s35, s36
 v_cndmask_b32 v90, v4, v13, s[70:71]
 v_cndmask_b32 v91, v4, v13, s[70:71]
 v_mfma_f32_16x16x32_bf16 v[32:35], a[192:195], v[16:19], 0
 s_cselect_b32 s36, s47, s36
 v_cndmask_b32 v92, v4, v13, s[60:61]
 v_cndmask_b32 v93, v4, v13, s[62:63]
 v_mfma_f32_16x16x32_bf16 v[36:39], a[192:195], v[20:23], 0
 s_cselect_b32 s35, 0, s35
 v_cndmask_b32 v94, v4, v13, s[64:65]
 v_cndmask_b32 v95, v4, v13, s[66:67]
 s_cmp_eq_u32 s43, 0
 s_cbranch_scc1 Lamk_11
 s_sub_u32 s40, s43, 1
 .p2align 3
Lapl_10:
 s_waitcnt lgkmcnt(0)
 v_mfma_f32_16x16x32_bf16 v[48:51], a[128:131], a[0:3], v[80:83]
 v_exp_f32 v72, v72
 v_mfma_f32_16x16x32_bf16 v[56:59], a[128:131], a[16:19], v[88:91]
 v_exp_f32 v73, v73
 v_mfma_f32_16x16x32_bf16 v[52:55], a[132:135], a[0:3], v[84:87]
 v_mfma_f32_16x16x32_bf16 v[60:63], a[132:135], a[16:19], v[92:95]
 v_exp_f32 v76, v76
 v_mfma_f32_16x16x32_bf16 v[48:51], a[136:139], a[4:7], v[48:51]
 v_exp_f32 v77, v77
 v_mfma_f32_16x16x32_bf16 v[56:59], a[136:139], a[20:23], v[56:59]
 v_mfma_f32_16x16x32_bf16 v[52:55], a[140:143], a[4:7], v[52:55]
 v_exp_f32 v74, v74
 v_mfma_f32_16x16x32_bf16 v[60:63], a[140:143], a[20:23], v[60:63]
 v_cvt_pk_bf16_f32 v28, v72, v73
 v_cvt_pk_bf16_f32 v29, v76, v77
 v_mfma_f32_16x16x32_bf16 v[48:51], a[144:147], a[8:11], v[48:51]
 v_mfma_f32_16x16x32_bf16 v[56:59], a[144:147], a[24:27], v[56:59]
 v_exp_f32 v75, v75
 v_mfma_f32_16x16x32_bf16 v[52:55], a[148:151], a[8:11], v[52:55]
 v_exp_f32 v78, v78
 v_mfma_f32_16x16x32_bf16 v[60:63], a[148:151], a[24:27], v[60:63]
 v_mfma_f32_16x16x32_bf16 v[48:51], a[152:155], a[12:15], v[48:51]
 v_exp_f32 v79, v79
 v_mfma_f32_16x16x32_bf16 v[56:59], a[152:155], a[28:31], v[56:59]
 v_cvt_pk_bf16_f32 v30, v74, v75
 v_cvt_pk_bf16_f32 v31, v78, v79
 v_mfma_f32_16x16x32_bf16 v[52:55], a[156:159], a[12:15], v[52:55]
 v_mfma_f32_16x16x32_bf16 v[60:63], a[156:159], a[28:31], v[60:63]
 v_mfma_f32_16x16x32_bf16 v[176:179], a[160:163], v[24:27], v[176:179]
 v_mfma_f32_16x16x32_bf16 v[208:211], a[160:163], v[28:31], v[208:211]
 ds_read_b128 a[160:163], v3 offset:8192
 v_mfma_f32_16x16x32_bf16 v[180:183], a[164:167], v[24:27], v[180:183]
 v_mfma_f32_16x16x32_bf16 v[212:215], a[164:167], v[28:31], v[212:215]
 ds_read_b128 a[164:167], v3 offset:9216
 v_exp_f32 v48, v48
 v_mfma_f32_16x16x32_bf16 v[184:187], a[168:171], v[24:27], v[184:187]
 v_exp_f32 v49, v49
 v_mfma_f32_16x16x32_bf16 v[216:219], a[168:171], v[28:31], v[216:219]
 ds_read_b128 a[168:171], v3 offset:10240
 v_exp_f32 v52, v52
 v_mfma_f32_16x16x32_bf16 v[188:191], a[172:175], v[24:27], v[188:191]
 v_mfma_f32_16x16x32_bf16 v[220:223], a[172:175], v[28:31], v[220:223]
 ds_read_b128 a[172:175], v3 offset:11264
 v_exp_f32 v53, v53
 v_mfma_f32_16x16x32_bf16 v[192:195], a[176:179], v[24:27], v[192:195]
 v_exp_f32 v50, v50
 v_mfma_f32_16x16x32_bf16 v[224:227], a[176:179], v[28:31], v[224:227]
 ds_read_b128 a[176:179], v3 offset:12288
 v_mfma_f32_16x16x32_bf16 v[196:199], a[180:183], v[24:27], v[196:199]
 v_cvt_pk_bf16_f32 v16, v48, v49
 v_cvt_pk_bf16_f32 v17, v52, v53
 v_mfma_f32_16x16x32_bf16 v[228:231], a[180:183], v[28:31], v[228:231]
 ds_read_b128 a[180:183], v3 offset:13312
 v_exp_f32 v51, v51
 v_mfma_f32_16x16x32_bf16 v[200:203], a[184:187], v[24:27], v[200:203]
 v_exp_f32 v54, v54
 v_mfma_f32_16x16x32_bf16 v[232:235], a[184:187], v[28:31], v[232:235]
 ds_read_b128 a[184:187], v3 offset:14336
 v_mfma_f32_16x16x32_bf16 v[204:207], a[188:191], v[24:27], v[204:207]
 v_exp_f32 v55, v55
 v_mfma_f32_16x16x32_bf16 v[236:239], a[188:191], v[28:31], v[236:239]
 ds_read_b128 a[188:191], v3 offset:15360
 v_cvt_pk_bf16_f32 v18, v50, v51
 v_cvt_pk_bf16_f32 v19, v54, v55
 v_mfma_f32_16x16x32_bf16 v[40:43], a[192:195], v[24:27], v[40:43]
 v_mfma_f32_16x16x32_bf16 v[44:47], a[192:195], v[28:31], v[44:47]
 v_mfma_f32_16x16x32_bf16 v[64:67], a[128:131], a[32:35], v[96:99]
 s_waitcnt vmcnt(20)
 s_barrier
 v_exp_f32 v56, v56
 v_mfma_f32_16x16x32_bf16 v[72:75], a[128:131], a[48:51], v[104:107]
 ds_read_b128 a[128:131], v2 offset:0
 v_exp_f32 v57, v57
 v_mfma_f32_16x16x32_bf16 v[68:71], a[132:135], a[32:35], v[100:103]
 s_add_u32 s39, s39, 0x4000
 v_mfma_f32_16x16x32_bf16 v[76:79], a[132:135], a[48:51], v[108:111]
 ds_read_b128 a[132:135], v2 offset:1024
 v_exp_f32 v60, v60
 v_mfma_f32_16x16x32_bf16 v[64:67], a[136:139], a[36:39], v[64:67]
 v_exp_f32 v61, v61
 v_mfma_f32_16x16x32_bf16 v[72:75], a[136:139], a[52:55], v[72:75]
 ds_read_b128 a[136:139], v2 offset:2048
 v_mfma_f32_16x16x32_bf16 v[68:71], a[140:143], a[36:39], v[68:71]
 v_exp_f32 v58, v58
 v_mfma_f32_16x16x32_bf16 v[76:79], a[140:143], a[52:55], v[76:79]
 ds_read_b128 a[140:143], v2 offset:3072
 v_cvt_pk_bf16_f32 v20, v56, v57
 v_cvt_pk_bf16_f32 v21, v60, v61
 v_mfma_f32_16x16x32_bf16 v[64:67], a[144:147], a[40:43], v[64:67]
 s_and_b32 s39, s39, 0x1ffff
 v_mfma_f32_16x16x32_bf16 v[72:75], a[144:147], a[56:59], v[72:75]
 ds_read_b128 a[144:147], v2 offset:4096
 v_exp_f32 v59, v59
 v_mfma_f32_16x16x32_bf16 v[68:71], a[148:151], a[40:43], v[68:71]
 v_exp_f32 v62, v62
 v_mfma_f32_16x16x32_bf16 v[76:79], a[148:151], a[56:59], v[76:79]
 ds_read_b128 a[148:151], v2 offset:5120
 v_mfma_f32_16x16x32_bf16 v[64:67], a[152:155], a[44:47], v[64:67]
 v_exp_f32 v63, v63
 v_mfma_f32_16x16x32_bf16 v[72:75], a[152:155], a[60:63], v[72:75]
 ds_read_b128 a[152:155], v2 offset:6144
 v_cvt_pk_bf16_f32 v22, v58, v59
 v_cvt_pk_bf16_f32 v23, v62, v63
 v_mfma_f32_16x16x32_bf16 v[68:71], a[156:159], a[44:47], v[68:71]
 v_mfma_f32_16x16x32_bf16 v[76:79], a[156:159], a[60:63], v[76:79]
 ds_read_b128 a[156:159], v2 offset:7168
 s_waitcnt lgkmcnt(8)
 v_mfma_f32_16x16x32_bf16 v[112:115], a[160:163], v[16:19], v[112:115]
 s_lshl_b32 s37, s35, 19
 v_mov_b32 v3, v2
 v_add_u32 v2, s39, v1
 v_mfma_f32_16x16x32_bf16 v[144:147], a[160:163], v[20:23], v[144:147]
 s_add_u32 m0, s38, s50
 v_mfma_f32_16x16x32_bf16 v[116:119], a[164:167], v[16:19], v[116:119]
 s_add_u32 s37, s37, s45
 v_mfma_f32_16x16x32_bf16 v[148:151], a[164:167], v[20:23], v[148:151]
 buffer_load_dwordx4 v1, s[20:23], s37 offen offset:0 sc1 lds
 v_exp_f32 v64, v64
 v_mfma_f32_16x16x32_bf16 v[120:123], a[168:171], v[16:19], v[120:123]
 buffer_load_dwordx4 v1, s[20:23], s37 offen offset:1024 sc1 lds
 v_mfma_f32_16x16x32_bf16 v[152:155], a[168:171], v[20:23], v[152:155]
 v_exp_f32 v65, v65
 v_mfma_f32_16x16x32_bf16 v[124:127], a[172:175], v[16:19], v[124:127]
 buffer_load_dwordx4 v1, s[20:23], s37 offen offset:2048 sc1 lds
 v_exp_f32 v68, v68
 v_mfma_f32_16x16x32_bf16 v[156:159], a[172:175], v[20:23], v[156:159]
 buffer_load_dwordx4 v1, s[20:23], s37 offen offset:3072 sc1 lds
 v_exp_f32 v69, v69
 v_mfma_f32_16x16x32_bf16 v[128:131], a[176:179], v[16:19], v[128:131]
 s_add_u32 s38, s38, 0x4000
 v_mfma_f32_16x16x32_bf16 v[160:163], a[176:179], v[20:23], v[160:163]
 s_and_b32 s38, s38, 0x1ffff
 v_exp_f32 v66, v66
 v_mfma_f32_16x16x32_bf16 v[132:135], a[180:183], v[16:19], v[132:135]
 s_add_u32 s35, s35, 1
 v_cvt_pk_bf16_f32 v24, v64, v65
 v_cvt_pk_bf16_f32 v25, v68, v69
 v_mfma_f32_16x16x32_bf16 v[164:167], a[180:183], v[20:23], v[164:167]
 v_exp_f32 v67, v67
 v_mfma_f32_16x16x32_bf16 v[136:139], a[184:187], v[16:19], v[136:139]
 s_cmp_eq_u32 s35, s36
 v_mfma_f32_16x16x32_bf16 v[168:171], a[184:187], v[20:23], v[168:171]
 s_cselect_b32 s36, s47, s36
 v_exp_f32 v70, v70
 v_mfma_f32_16x16x32_bf16 v[140:143], a[188:191], v[16:19], v[140:143]
 s_cselect_b32 s35, 0, s35
 v_exp_f32 v71, v71
 v_mfma_f32_16x16x32_bf16 v[172:175], a[188:191], v[20:23], v[172:175]
 s_add_u32 s49, s49, 1
 v_cvt_pk_bf16_f32 v26, v66, v67
 v_cvt_pk_bf16_f32 v27, v70, v71
 v_mfma_f32_16x16x32_bf16 v[32:35], a[192:195], v[16:19], v[32:35]
 s_cmp_lt_u32 s49, s40
 v_mfma_f32_16x16x32_bf16 v[36:39], a[192:195], v[20:23], v[36:39]
 s_cbranch_scc1 Lapl_10
Lamk_11:
 s_add_u32 s40, s43, 4
 .p2align 3
Lamk_13:
 s_waitcnt lgkmcnt(0)
 v_mfma_f32_16x16x32_bf16 v[48:51], a[128:131], a[0:3], v[80:83]
 s_add_u32 s49, s49, 1
 v_exp_f32 v72, v72
 v_mfma_f32_16x16x32_bf16 v[56:59], a[128:131], a[16:19], v[88:91]
 s_cmp_lt_u32 s49, s41
 v_exp_f32 v73, v73
 v_mfma_f32_16x16x32_bf16 v[52:55], a[132:135], a[0:3], v[84:87]
 v_mfma_f32_16x16x32_bf16 v[60:63], a[132:135], a[16:19], v[92:95]
 s_cselect_b64 s[68:69], -1, 0
 v_exp_f32 v76, v76
 v_mfma_f32_16x16x32_bf16 v[48:51], a[136:139], a[4:7], v[48:51]
 s_cmp_le_u32 s49, s41
 v_exp_f32 v77, v77
 v_mfma_f32_16x16x32_bf16 v[56:59], a[136:139], a[20:23], v[56:59]
 v_mfma_f32_16x16x32_bf16 v[52:55], a[140:143], a[4:7], v[52:55]
 s_cselect_b64 s[70:71], -1, 0
 v_exp_f32 v74, v74
 v_mfma_f32_16x16x32_bf16 v[60:63], a[140:143], a[20:23], v[60:63]
 v_cvt_pk_bf16_f32 v28, v72, v73
 v_cvt_pk_bf16_f32 v29, v76, v77
 v_mfma_f32_16x16x32_bf16 v[48:51], a[144:147], a[8:11], v[48:51]
 s_cmp_eq_u32 s49, s41
 v_mfma_f32_16x16x32_bf16 v[56:59], a[144:147], a[24:27], v[56:59]
 s_cselect_b64 s[60:61], s[52:53], s[68:69]
 v_exp_f32 v75, v75
 v_mfma_f32_16x16x32_bf16 v[52:55], a[148:151], a[8:11], v[52:55]
 v_exp_f32 v78, v78
 v_mfma_f32_16x16x32_bf16 v[60:63], a[148:151], a[24:27], v[60:63]
 s_cselect_b64 s[62:63], s[54:55], s[68:69]
 v_mfma_f32_16x16x32_bf16 v[48:51], a[152:155], a[12:15], v[48:51]
 s_cselect_b64 s[64:65], s[56:57], s[68:69]
 v_exp_f32 v79, v79
 v_mfma_f32_16x16x32_bf16 v[56:59], a[152:155], a[28:31], v[56:59]
 v_cvt_pk_bf16_f32 v30, v74, v75
 v_cvt_pk_bf16_f32 v31, v78, v79
 v_mfma_f32_16x16x32_bf16 v[52:55], a[156:159], a[12:15], v[52:55]
 s_cselect_b64 s[66:67], s[58:59], s[68:69]
 v_mfma_f32_16x16x32_bf16 v[60:63], a[156:159], a[28:31], v[60:63]
 v_mfma_f32_16x16x32_bf16 v[176:179], a[160:163], v[24:27], v[176:179]
 v_mfma_f32_16x16x32_bf16 v[208:211], a[160:163], v[28:31], v[208:211]
 ds_read_b128 a[160:163], v3 offset:8192
 v_mfma_f32_16x16x32_bf16 v[180:183], a[164:167], v[24:27], v[180:183]
 v_mfma_f32_16x16x32_bf16 v[212:215], a[164:167], v[28:31], v[212:215]
 ds_read_b128 a[164:167], v3 offset:9216
 v_exp_f32 v48, v48
 v_mfma_f32_16x16x32_bf16 v[184:187], a[168:171], v[24:27], v[184:187]
 v_exp_f32 v49, v49
 v_mfma_f32_16x16x32_bf16 v[216:219], a[168:171], v[28:31], v[216:219]
 ds_read_b128 a[168:171], v3 offset:10240
 v_exp_f32 v52, v52
 v_mfma_f32_16x16x32_bf16 v[188:191], a[172:175], v[24:27], v[188:191]
 v_exp_f32 v53, v53
 v_mfma_f32_16x16x32_bf16 v[220:223], a[172:175], v[28:31], v[220:223]
 ds_read_b128 a[172:175], v3 offset:11264
 v_exp_f32 v50, v50
 v_mfma_f32_16x16x32_bf16 v[192:195], a[176:179], v[24:27], v[192:195]
 v_cvt_pk_bf16_f32 v16, v48, v49
 v_cvt_pk_bf16_f32 v17, v52, v53
 v_mfma_f32_16x16x32_bf16 v[224:227], a[176:179], v[28:31], v[224:227]
 ds_read_b128 a[176:179], v3 offset:12288
 v_exp_f32 v51, v51
 v_mfma_f32_16x16x32_bf16 v[196:199], a[180:183], v[24:27], v[196:199]
 v_exp_f32 v54, v54
 v_mfma_f32_16x16x32_bf16 v[228:231], a[180:183], v[28:31], v[228:231]
 ds_read_b128 a[180:183], v3 offset:13312
 v_exp_f32 v55, v55
 v_mfma_f32_16x16x32_bf16 v[200:203], a[184:187], v[24:27], v[200:203]
 v_cvt_pk_bf16_f32 v18, v50, v51
 v_cvt_pk_bf16_f32 v19, v54, v55
 v_mfma_f32_16x16x32_bf16 v[232:235], a[184:187], v[28:31], v[232:235]
 ds_read_b128 a[184:187], v3 offset:14336
 v_cndmask_b32 v80, v4, v12, s[60:61]
 v_cndmask_b32 v81, v4, v12, s[62:63]
 v_mfma_f32_16x16x32_bf16 v[204:207], a[188:191], v[24:27], v[204:207]
 v_cndmask_b32 v82, v4, v12, s[64:65]
 v_cndmask_b32 v83, v4, v12, s[66:67]
 v_mfma_f32_16x16x32_bf16 v[236:239], a[188:191], v[28:31], v[236:239]
 ds_read_b128 a[188:191], v3 offset:15360
 v_cndmask_b32 v84, v4, v12, s[68:69]
 v_cndmask_b32 v85, v4, v12, s[68:69]
 v_mfma_f32_16x16x32_bf16 v[40:43], a[192:195], v[24:27], v[40:43]
 v_cndmask_b32 v86, v4, v12, s[68:69]
 v_cndmask_b32 v87, v4, v12, s[68:69]
 v_mfma_f32_16x16x32_bf16 v[44:47], a[192:195], v[28:31], v[44:47]
 v_mfma_f32_16x16x32_bf16 v[64:67], a[128:131], a[32:35], v[96:99]
 s_waitcnt vmcnt(20)
 s_barrier
 v_exp_f32 v56, v56
 v_mfma_f32_16x16x32_bf16 v[72:75], a[128:131], a[48:51], v[104:107]
 ds_read_b128 a[128:131], v2 offset:0
 v_exp_f32 v57, v57
 v_mfma_f32_16x16x32_bf16 v[68:71], a[132:135], a[32:35], v[100:103]
 s_add_u32 s39, s39, 0x4000
 v_exp_f32 v60, v60
 v_mfma_f32_16x16x32_bf16 v[76:79], a[132:135], a[48:51], v[108:111]
 ds_read_b128 a[132:135], v2 offset:1024
 v_exp_f32 v61, v61
 v_mfma_f32_16x16x32_bf16 v[64:67], a[136:139], a[36:39], v[64:67]
 v_exp_f32 v58, v58
 v_mfma_f32_16x16x32_bf16 v[72:75], a[136:139], a[52:55], v[72:75]
 ds_read_b128 a[136:139], v2 offset:2048
 v_cvt_pk_bf16_f32 v20, v56, v57
 v_cvt_pk_bf16_f32 v21, v60, v61
 v_mfma_f32_16x16x32_bf16 v[68:71], a[140:143], a[36:39], v[68:71]
 v_exp_f32 v59, v59
 v_mfma_f32_16x16x32_bf16 v[76:79], a[140:143], a[52:55], v[76:79]
 ds_read_b128 a[140:143], v2 offset:3072
 v_exp_f32 v62, v62
 v_mfma_f32_16x16x32_bf16 v[64:67], a[144:147], a[40:43], v[64:67]
 s_and_b32 s39, s39, 0x1ffff
 v_exp_f32 v63, v63
 v_mfma_f32_16x16x32_bf16 v[72:75], a[144:147], a[56:59], v[72:75]
 ds_read_b128 a[144:147], v2 offset:4096
 v_cvt_pk_bf16_f32 v22, v58, v59
 v_cvt_pk_bf16_f32 v23, v62, v63
 v_mfma_f32_16x16x32_bf16 v[68:71], a[148:151], a[40:43], v[68:71]
 v_cndmask_b32 v88, v4, v13, s[70:71]
 v_cndmask_b32 v89, v4, v13, s[70:71]
 v_mfma_f32_16x16x32_bf16 v[76:79], a[148:151], a[56:59], v[76:79]
 ds_read_b128 a[148:151], v2 offset:5120
 v_cndmask_b32 v90, v4, v13, s[70:71]
 v_cndmask_b32 v91, v4, v13, s[70:71]
 v_mfma_f32_16x16x32_bf16 v[64:67], a[152:155], a[44:47], v[64:67]
 v_cndmask_b32 v92, v4, v13, s[60:61]
 v_cndmask_b32 v93, v4, v13, s[62:63]
 v_mfma_f32_16x16x32_bf16 v[72:75], a[152:155], a[60:63], v[72:75]
 ds_read_b128 a[152:155], v2 offset:6144
 v_cndmask_b32 v94, v4, v13, s[64:65]
 v_cndmask_b32 v95, v4, v13, s[66:67]
 v_mfma_f32_16x16x32_bf16 v[68:71], a[156:159], a[44:47], v[68:71]
 v_mfma_f32_16x16x32_bf16 v[76:79], a[156:159], a[60:63], v[76:79]
 ds_read_b128 a[156:159], v2 offset:7168
 s_waitcnt lgkmcnt(8)
 v_mfma_f32_16x16x32_bf16 v[112:115], a[160:163], v[16:19], v[112:115]
 s_lshl_b32 s37, s35, 19
 v_mov_b32 v3, v2
 v_add_u32 v2, s39, v1
 v_mfma_f32_16x16x32_bf16 v[144:147], a[160:163], v[20:23], v[144:147]
 s_add_u32 m0, s38, s50
 v_mfma_f32_16x16x32_bf16 v[116:119], a[164:167], v[16:19], v[116:119]
 s_add_u32 s37, s37, s45
 v_mfma_f32_16x16x32_bf16 v[148:151], a[164:167], v[20:23], v[148:151]
 buffer_load_dwordx4 v1, s[20:23], s37 offen offset:0 sc1 lds
 v_exp_f32 v64, v64
 v_mfma_f32_16x16x32_bf16 v[120:123], a[168:171], v[16:19], v[120:123]
 v_mfma_f32_16x16x32_bf16 v[152:155], a[168:171], v[20:23], v[152:155]
 buffer_load_dwordx4 v1, s[20:23], s37 offen offset:1024 sc1 lds
 v_exp_f32 v65, v65
 v_mfma_f32_16x16x32_bf16 v[124:127], a[172:175], v[16:19], v[124:127]
 buffer_load_dwordx4 v1, s[20:23], s37 offen offset:2048 sc1 lds
 v_exp_f32 v68, v68
 v_mfma_f32_16x16x32_bf16 v[156:159], a[172:175], v[20:23], v[156:159]
 buffer_load_dwordx4 v1, s[20:23], s37 offen offset:3072 sc1 lds
 v_exp_f32 v69, v69
 v_mfma_f32_16x16x32_bf16 v[128:131], a[176:179], v[16:19], v[128:131]
 v_mfma_f32_16x16x32_bf16 v[160:163], a[176:179], v[20:23], v[160:163]
 s_add_u32 s38, s38, 0x4000
 v_exp_f32 v66, v66
 v_mfma_f32_16x16x32_bf16 v[132:135], a[180:183], v[16:19], v[132:135]
 s_and_b32 s38, s38, 0x1ffff
 v_cvt_pk_bf16_f32 v24, v64, v65
 v_cvt_pk_bf16_f32 v25, v68, v69
 v_mfma_f32_16x16x32_bf16 v[164:167], a[180:183], v[20:23], v[164:167]
 s_add_u32 s35, s35, 1
 v_exp_f32 v67, v67
 v_mfma_f32_16x16x32_bf16 v[136:139], a[184:187], v[16:19], v[136:139]
 s_cmp_eq_u32 s35, s36
 v_mfma_f32_16x16x32_bf16 v[168:171], a[184:187], v[20:23], v[168:171]
 v_exp_f32 v70, v70
 v_mfma_f32_16x16x32_bf16 v[140:143], a[188:191], v[16:19], v[140:143]
 s_cselect_b32 s36, s47, s36
 v_exp_f32 v71, v71
 v_mfma_f32_16x16x32_bf16 v[172:175], a[188:191], v[20:23], v[172:175]
 s_cselect_b32 s35, 0, s35
 v_cvt_pk_bf16_f32 v26, v66, v67
 v_cvt_pk_bf16_f32 v27, v70, v71
 v_mfma_f32_16x16x32_bf16 v[32:35], a[192:195], v[16:19], v[32:35]
 s_cmp_lt_u32 s49, s40
 v_mfma_f32_16x16x32_bf16 v[36:39], a[192:195], v[20:23], v[36:39]
 s_cbranch_scc1 Lamk_13
 s_add_u32 s40, s43, 8
 s_cmp_lt_u32 s49, s42
 s_cselect_b64 s[68:69], -1, 0
 s_cmp_le_u32 s49, s42
 s_cselect_b64 s[70:71], -1, 0
 s_cmp_eq_u32 s49, s42
 s_cselect_b64 s[60:61], s[52:53], s[68:69]
 s_cselect_b64 s[62:63], s[54:55], s[68:69]
 s_cselect_b64 s[64:65], s[56:57], s[68:69]
 s_cselect_b64 s[66:67], s[58:59], s[68:69]
 v_mfma_f32_16x16x32_bf16 v[176:179], a[160:163], v[24:27], v[176:179]
 v_cndmask_b32 v96, v4, v14, s[60:61]
 v_cndmask_b32 v97, v4, v14, s[62:63]
 v_mfma_f32_16x16x32_bf16 v[180:183], a[164:167], v[24:27], v[180:183]
 v_cndmask_b32 v98, v4, v14, s[64:65]
 v_cndmask_b32 v99, v4, v14, s[66:67]
 v_mfma_f32_16x16x32_bf16 v[184:187], a[168:171], v[24:27], v[184:187]
 v_cndmask_b32 v100, v4, v14, s[68:69]
 v_cndmask_b32 v101, v4, v14, s[68:69]
 v_mfma_f32_16x16x32_bf16 v[188:191], a[172:175], v[24:27], v[188:191]
 v_exp_f32 v72, v72
 v_mfma_f32_16x16x32_bf16 v[192:195], a[176:179], v[24:27], v[192:195]
 v_exp_f32 v73, v73
 v_mfma_f32_16x16x32_bf16 v[196:199], a[180:183], v[24:27], v[196:199]
 v_exp_f32 v76, v76
 v_mfma_f32_16x16x32_bf16 v[200:203], a[184:187], v[24:27], v[200:203]
 v_exp_f32 v77, v77
 v_mfma_f32_16x16x32_bf16 v[204:207], a[188:191], v[24:27], v[204:207]
 v_exp_f32 v74, v74
 v_mfma_f32_16x16x32_bf16 v[40:43], a[192:195], v[24:27], v[40:43]
 v_cndmask_b32 v102, v4, v14, s[68:69]
 v_cndmask_b32 v103, v4, v14, s[68:69]
 s_nop 0
 .p2align 3
Lam1_12:
 s_waitcnt lgkmcnt(0)
 v_mfma_f32_16x16x32_bf16 v[64:67], a[128:131], a[32:35], v[96:99]
 v_cvt_pk_bf16_f32 v28, v72, v73
 v_cvt_pk_bf16_f32 v29, v76, v77
 v_mfma_f32_16x16x32_bf16 v[68:71], a[132:135], a[32:35], v[100:103]
 v_exp_f32 v75, v75
 v_mfma_f32_16x16x32_bf16 v[64:67], a[136:139], a[36:39], v[64:67]
 v_exp_f32 v78, v78
 v_mfma_f32_16x16x32_bf16 v[68:71], a[140:143], a[36:39], v[68:71]
 v_exp_f32 v79, v79
 v_mfma_f32_16x16x32_bf16 v[64:67], a[144:147], a[40:43], v[64:67]
 v_cvt_pk_bf16_f32 v30, v74, v75
 v_cvt_pk_bf16_f32 v31, v78, v79
 v_mfma_f32_16x16x32_bf16 v[68:71], a[148:151], a[40:43], v[68:71]
 v_cndmask_b32 v104, v4, v15, s[70:71]
 v_cndmask_b32 v105, v4, v15, s[70:71]
 v_mfma_f32_16x16x32_bf16 v[64:67], a[152:155], a[44:47], v[64:67]
 v_mfma_f32_16x16x32_bf16 v[68:71], a[156:159], a[44:47], v[68:71]
 v_mfma_f32_16x16x32_bf16 v[208:211], a[160:163], v[28:31], v[208:211]
 ds_read_b128 a[160:163], v3 offset:8192
 v_cndmask_b32 v106, v4, v15, s[70:71]
 v_cndmask_b32 v107, v4, v15, s[70:71]
 v_mfma_f32_16x16x32_bf16 v[212:215], a[164:167], v[28:31], v[212:215]
 ds_read_b128 a[164:167], v3 offset:9216
 v_cndmask_b32 v108, v4, v15, s[60:61]
 v_cndmask_b32 v109, v4, v15, s[62:63]
 v_mfma_f32_16x16x32_bf16 v[216:219], a[168:171], v[28:31], v[216:219]
 ds_read_b128 a[168:171], v3 offset:10240
 v_cndmask_b32 v110, v4, v15, s[64:65]
 v_cndmask_b32 v111, v4, v15, s[66:67]
 v_mfma_f32_16x16x32_bf16 v[220:223], a[172:175], v[28:31], v[220:223]
 ds_read_b128 a[172:175], v3 offset:11264
 v_exp_f32 v64, v64
 v_mfma_f32_16x16x32_bf16 v[224:227], a[176:179], v[28:31], v[224:227]
 ds_read_b128 a[176:179], v3 offset:12288
 v_exp_f32 v65, v65
 v_mfma_f32_16x16x32_bf16 v[228:231], a[180:183], v[28:31], v[228:231]
 ds_read_b128 a[180:183], v3 offset:13312
 v_exp_f32 v68, v68
 v_mfma_f32_16x16x32_bf16 v[232:235], a[184:187], v[28:31], v[232:235]
 ds_read_b128 a[184:187], v3 offset:14336
 v_exp_f32 v69, v69
 v_mfma_f32_16x16x32_bf16 v[236:239], a[188:191], v[28:31], v[236:239]
 ds_read_b128 a[188:191], v3 offset:15360
 v_exp_f32 v66, v66
 v_mfma_f32_16x16x32_bf16 v[44:47], a[192:195], v[28:31], v[44:47]
 v_mfma_f32_16x16x32_bf16 v[72:75], a[128:131], a[48:51], v[104:107]
 s_waitcnt vmcnt(20)
 s_barrier
 ds_read_b128 a[128:131], v2 offset:0
 s_add_u32 s39, s39, 0x4000
 v_cvt_pk_bf16_f32 v24, v64, v65
 v_cvt_pk_bf16_f32 v25, v68, v69
 v_mfma_f32_16x16x32_bf16 v[76:79], a[132:135], a[48:51], v[108:111]
 ds_read_b128 a[132:135], v2 offset:1024
 v_exp_f32 v67, v67
 v_mfma_f32_16x16x32_bf16 v[72:75], a[136:139], a[52:55], v[72:75]
 ds_read_b128 a[136:139], v2 offset:2048
 v_exp_f32 v70, v70
 v_mfma_f32_16x16x32_bf16 v[76:79], a[140:143], a[52:55], v[76:79]
 ds_read_b128 a[140:143], v2 offset:3072
 v_mfma_f32_16x16x32_bf16 v[72:75], a[144:147], a[56:59], v[72:75]
 ds_read_b128 a[144:147], v2 offset:4096
 s_and_b32 s39, s39, 0x1ffff
 v_exp_f32 v71, v71
 v_mfma_f32_16x16x32_bf16 v[76:79], a[148:151], a[56:59], v[76:79]
 ds_read_b128 a[148:151], v2 offset:5120
 v_cvt_pk_bf16_f32 v26, v66, v67
 v_cvt_pk_bf16_f32 v27, v70, v71
 v_mfma_f32_16x16x32_bf16 v[72:75], a[152:155], a[60:63], v[72:75]
 ds_read_b128 a[152:155], v2 offset:6144
 v_mfma_f32_16x16x32_bf16 v[76:79], a[156:159], a[60:63], v[76:79]
 ds_read_b128 a[156:159], v2 offset:7168
 s_waitcnt lgkmcnt(8)
 s_add_u32 s49, s49, 1
 s_cmp_lt_u32 s49, s42
 s_cselect_b64 s[68:69], -1, 0
 s_cmp_le_u32 s49, s42
 s_cselect_b64 s[70:71], -1, 0
 s_cmp_eq_u32 s49, s42
 s_cselect_b64 s[60:61], s[52:53], s[68:69]
 s_cselect_b64 s[62:63], s[54:55], s[68:69]
 s_cselect_b64 s[64:65], s[56:57], s[68:69]
 s_cselect_b64 s[66:67], s[58:59], s[68:69]
 v_mfma_f32_16x16x32_bf16 v[176:179], a[160:163], v[24:27], v[176:179]
 s_lshl_b32 s37, s35, 19
 s_add_u32 m0, s38, s50
 v_mov_b32 v3, v2
 v_add_u32 v2, s39, v1
 v_cndmask_b32 v96, v4, v14, s[60:61]
 v_cndmask_b32 v97, v4, v14, s[62:63]
 v_mfma_f32_16x16x32_bf16 v[180:183], a[164:167], v[24:27], v[180:183]
 s_add_u32 s37, s37, s45
 buffer_load_dwordx4 v1, s[20:23], s37 offen offset:0 sc1 lds
 v_cndmask_b32 v98, v4, v14, s[64:65]
 v_cndmask_b32 v99, v4, v14, s[66:67]
 v_mfma_f32_16x16x32_bf16 v[184:187], a[168:171], v[24:27], v[184:187]
 buffer_load_dwordx4 v1, s[20:23], s37 offen offset:1024 sc1 lds
 v_exp_f32 v72, v72
 v_mfma_f32_16x16x32_bf16 v[188:191], a[172:175], v[24:27], v[188:191]
 buffer_load_dwordx4 v1, s[20:23], s37 offen offset:2048 sc1 lds
 buffer_load_dwordx4 v1, s[20:23], s37 offen offset:3072 sc1 lds
 v_exp_f32 v73, v73
 v_mfma_f32_16x16x32_bf16 v[192:195], a[176:179], v[24:27], v[192:195]
 s_add_u32 s38, s38, 0x4000
 v_exp_f32 v76, v76
 v_mfma_f32_16x16x32_bf16 v[196:199], a[180:183], v[24:27], v[196:199]
 s_and_b32 s38, s38, 0x1ffff
 s_add_u32 s35, s35, 1
 v_exp_f32 v77, v77
 v_mfma_f32_16x16x32_bf16 v[200:203], a[184:187], v[24:27], v[200:203]
 s_cmp_eq_u32 s35, s36
 v_exp_f32 v74, v74
 v_mfma_f32_16x16x32_bf16 v[204:207], a[188:191], v[24:27], v[204:207]
 s_cselect_b32 s36, s47, s36
 s_cselect_b32 s35, 0, s35
 v_cndmask_b32 v100, v4, v14, s[68:69]
 v_cndmask_b32 v101, v4, v14, s[68:69]
 v_mfma_f32_16x16x32_bf16 v[40:43], a[192:195], v[24:27], v[40:43]
 s_cmp_lt_u32 s49, s40
 v_cndmask_b32 v102, v4, v14, s[68:69]
 v_cndmask_b32 v103, v4, v14, s[68:69]
 s_cbranch_scc1 Lam1_12
 v_cvt_pk_bf16_f32 v28, v72, v73
 v_cvt_pk_bf16_f32 v29, v76, v77
 v_exp_f32 v75, v75
 v_exp_f32 v78, v78
 v_exp_f32 v79, v79
 v_cvt_pk_bf16_f32 v30, v74, v75
 v_cvt_pk_bf16_f32 v31, v78, v79
 s_nop 1
 v_mfma_f32_16x16x32_bf16 v[44:47], a[192:195], v[28:31], v[44:47]
 v_mfma_f32_16x16x32_bf16 v[208:211], a[160:163], v[28:31], v[208:211]
 v_mfma_f32_16x16x32_bf16 v[212:215], a[164:167], v[28:31], v[212:215]
 v_mfma_f32_16x16x32_bf16 v[216:219], a[168:171], v[28:31], v[216:219]
 v_mfma_f32_16x16x32_bf16 v[220:223], a[172:175], v[28:31], v[220:223]
 v_mfma_f32_16x16x32_bf16 v[224:227], a[176:179], v[28:31], v[224:227]
 v_mfma_f32_16x16x32_bf16 v[228:231], a[180:183], v[28:31], v[228:231]
 v_mfma_f32_16x16x32_bf16 v[232:235], a[184:187], v[28:31], v[232:235]
 v_mfma_f32_16x16x32_bf16 v[236:239], a[188:191], v[28:31], v[236:239]
 v_cmp_ngt_f32 s[60:61], s73, v32
 v_cmp_nlt_f32 vcc, s74, v32
 s_or_b64 s[60:61], s[60:61], vcc
 v_cmp_ngt_f32 s[62:63], s73, v36
 v_cmp_nlt_f32 vcc, s74, v36
 s_or_b64 s[62:63], s[62:63], vcc
 v_cmp_ngt_f32 s[64:65], s73, v40
 v_cmp_nlt_f32 vcc, s74, v40
 s_or_b64 s[64:65], s[64:65], vcc
 v_cmp_ngt_f32 s[66:67], s73, v44
 v_cmp_nlt_f32 vcc, s74, v44
 s_or_b64 s[66:67], s[66:67], vcc
 s_or_b64 s[60:61], s[60:61], s[62:63]
 s_or_b64 s[64:65], s[64:65], s[66:67]
 s_or_b64 s[60:61], s[60:61], s[64:65]
 s_cbranch_scc1 Laslow_7
Laback_8:
 v_rcp_f32 v32, v32
 v_rcp_f32 v36, v36
 v_rcp_f32 v40, v40
 v_rcp_f32 v44, v44
 s_lshl_b32 s40, s41, 5
 s_add_u32 s40, s40, s32
 s_lshl_b32 s40, s40, 13
 s_add_u32 s40, s40, 0x6000000
 s_add_u32 s44, s40, 4096
 v_pk_mul_f32 v[112:113], v[112:113], v[32:33] op_sel_hi:[1,0]
 v_pk_mul_f32 v[114:115], v[114:115], v[32:33] op_sel_hi:[1,0]
 v_pk_mul_f32 v[116:117], v[116:117], v[32:33] op_sel_hi:[1,0]
 v_pk_mul_f32 v[118:119], v[118:119], v[32:33] op_sel_hi:[1,0]
 v_cvt_pk_bf16_f32 v240, v112, v113
 v_cvt_pk_bf16_f32 v241, v116, v117
 v_cvt_pk_bf16_f32 v242, v114, v115
 v_cvt_pk_bf16_f32 v243, v118, v119
 buffer_store_dwordx4 v[240:243], v1, s[20:23], s40 offen offset:0 sc1
 v_pk_mul_f32 v[120:121], v[120:121], v[32:33] op_sel_hi:[1,0]
 v_pk_mul_f32 v[122:123], v[122:123], v[32:33] op_sel_hi:[1,0]
 v_pk_mul_f32 v[124:125], v[124:125], v[32:33] op_sel_hi:[1,0]
 v_pk_mul_f32 v[126:127], v[126:127], v[32:33] op_sel_hi:[1,0]
 v_cvt_pk_bf16_f32 v244, v120, v121
 v_cvt_pk_bf16_f32 v245, v124, v125
 v_cvt_pk_bf16_f32 v246, v122, v123
 v_cvt_pk_bf16_f32 v247, v126, v127
 buffer_store_dwordx4 v[244:247], v1, s[20:23], s40 offen offset:2048 sc1
 v_pk_mul_f32 v[128:129], v[128:129], v[32:33] op_sel_hi:[1,0]
 v_pk_mul_f32 v[130:131], v[130:131], v[32:33] op_sel_hi:[1,0]
 v_pk_mul_f32 v[132:133], v[132:133], v[32:33] op_sel_hi:[1,0]
 v_pk_mul_f32 v[134:135], v[134:135], v[32:33] op_sel_hi:[1,0]
 v_cvt_pk_bf16_f32 v248, v128, v129
 v_cvt_pk_bf16_f32 v249, v132, v133
 v_cvt_pk_bf16_f32 v250, v130, v131
 v_cvt_pk_bf16_f32 v251, v134, v135
 buffer_store_dwordx4 v[248:251], v1, s[20:23], s44 offen offset:0 sc1
 v_pk_mul_f32 v[136:137], v[136:137], v[32:33] op_sel_hi:[1,0]
 v_pk_mul_f32 v[138:139], v[138:139], v[32:33] op_sel_hi:[1,0]
 v_pk_mul_f32 v[140:141], v[140:141], v[32:33] op_sel_hi:[1,0]
 v_pk_mul_f32 v[142:143], v[142:143], v[32:33] op_sel_hi:[1,0]
 v_cvt_pk_bf16_f32 v252, v136, v137
 v_cvt_pk_bf16_f32 v253, v140, v141
 v_cvt_pk_bf16_f32 v254, v138, v139
 v_cvt_pk_bf16_f32 v255, v142, v143
 buffer_store_dwordx4 v[252:255], v1, s[20:23], s44 offen offset:2048 sc1
 v_pk_mul_f32 v[144:145], v[144:145], v[36:37] op_sel_hi:[1,0]
 v_pk_mul_f32 v[146:147], v[146:147], v[36:37] op_sel_hi:[1,0]
 v_pk_mul_f32 v[148:149], v[148:149], v[36:37] op_sel_hi:[1,0]
 v_pk_mul_f32 v[150:151], v[150:151], v[36:37] op_sel_hi:[1,0]
 v_cvt_pk_bf16_f32 v240, v144, v145
 v_cvt_pk_bf16_f32 v241, v148, v149
 v_cvt_pk_bf16_f32 v242, v146, v147
 v_cvt_pk_bf16_f32 v243, v150, v151
 buffer_store_dwordx4 v[240:243], v1, s[20:23], s40 offen offset:1024 sc1
 v_pk_mul_f32 v[152:153], v[152:153], v[36:37] op_sel_hi:[1,0]
 v_pk_mul_f32 v[154:155], v[154:155], v[36:37] op_sel_hi:[1,0]
 v_pk_mul_f32 v[156:157], v[156:157], v[36:37] op_sel_hi:[1,0]
 v_pk_mul_f32 v[158:159], v[158:159], v[36:37] op_sel_hi:[1,0]
 v_cvt_pk_bf16_f32 v244, v152, v153
 v_cvt_pk_bf16_f32 v245, v156, v157
 v_cvt_pk_bf16_f32 v246, v154, v155
 v_cvt_pk_bf16_f32 v247, v158, v159
 buffer_store_dwordx4 v[244:247], v1, s[20:23], s40 offen offset:3072 sc1
 v_pk_mul_f32 v[160:161], v[160:161], v[36:37] op_sel_hi:[1,0]
 v_pk_mul_f32 v[162:163], v[162:163], v[36:37] op_sel_hi:[1,0]
 v_pk_mul_f32 v[164:165], v[164:165], v[36:37] op_sel_hi:[1,0]
 v_pk_mul_f32 v[166:167], v[166:167], v[36:37] op_sel_hi:[1,0]
 v_cvt_pk_bf16_f32 v248, v160, v161
 v_cvt_pk_bf16_f32 v249, v164, v165
 v_cvt_pk_bf16_f32 v250, v162, v163
 v_cvt_pk_bf16_f32 v251, v166, v167
 buffer_store_dwordx4 v[248:251], v1, s[20:23], s44 offen offset:1024 sc1
 v_pk_mul_f32 v[168:169], v[168:169], v[36:37] op_sel_hi:[1,0]
 v_pk_mul_f32 v[170:171], v[170:171], v[36:37] op_sel_hi:[1,0]
 v_pk_mul_f32 v[172:173], v[172:173], v[36:37] op_sel_hi:[1,0]
 v_pk_mul_f32 v[174:175], v[174:175], v[36:37] op_sel_hi:[1,0]
 v_cvt_pk_bf16_f32 v252, v168, v169
 v_cvt_pk_bf16_f32 v253, v172, v173
 v_cvt_pk_bf16_f32 v254, v170, v171
 v_cvt_pk_bf16_f32 v255, v174, v175
 buffer_store_dwordx4 v[252:255], v1, s[20:23], s44 offen offset:3072 sc1
 s_lshl_b32 s40, s42, 5
 s_add_u32 s40, s40, s32
 s_lshl_b32 s40, s40, 13
 s_add_u32 s40, s40, 0x6000000
 s_add_u32 s44, s40, 4096
 v_pk_mul_f32 v[176:177], v[176:177], v[40:41] op_sel_hi:[1,0]
 v_pk_mul_f32 v[178:179], v[178:179], v[40:41] op_sel_hi:[1,0]
 v_pk_mul_f32 v[180:181], v[180:181], v[40:41] op_sel_hi:[1,0]
 v_pk_mul_f32 v[182:183], v[182:183], v[40:41] op_sel_hi:[1,0]
 v_cvt_pk_bf16_f32 v240, v176, v177
 v_cvt_pk_bf16_f32 v241, v180, v181
 v_cvt_pk_bf16_f32 v242, v178, v179
 v_cvt_pk_bf16_f32 v243, v182, v183
 buffer_store_dwordx4 v[240:243], v1, s[20:23], s40 offen offset:0 sc1
 v_pk_mul_f32 v[184:185], v[184:185], v[40:41] op_sel_hi:[1,0]
 v_pk_mul_f32 v[186:187], v[186:187], v[40:41] op_sel_hi:[1,0]
 v_pk_mul_f32 v[188:189], v[188:189], v[40:41] op_sel_hi:[1,0]
 v_pk_mul_f32 v[190:191], v[190:191], v[40:41] op_sel_hi:[1,0]
 v_cvt_pk_bf16_f32 v244, v184, v185
 v_cvt_pk_bf16_f32 v245, v188, v189
 v_cvt_pk_bf16_f32 v246, v186, v187
 v_cvt_pk_bf16_f32 v247, v190, v191
 buffer_store_dwordx4 v[244:247], v1, s[20:23], s40 offen offset:2048 sc1
 v_pk_mul_f32 v[192:193], v[192:193], v[40:41] op_sel_hi:[1,0]
 v_pk_mul_f32 v[194:195], v[194:195], v[40:41] op_sel_hi:[1,0]
 v_pk_mul_f32 v[196:197], v[196:197], v[40:41] op_sel_hi:[1,0]
 v_pk_mul_f32 v[198:199], v[198:199], v[40:41] op_sel_hi:[1,0]
 v_cvt_pk_bf16_f32 v248, v192, v193
 v_cvt_pk_bf16_f32 v249, v196, v197
 v_cvt_pk_bf16_f32 v250, v194, v195
 v_cvt_pk_bf16_f32 v251, v198, v199
 buffer_store_dwordx4 v[248:251], v1, s[20:23], s44 offen offset:0 sc1
 v_pk_mul_f32 v[200:201], v[200:201], v[40:41] op_sel_hi:[1,0]
 v_pk_mul_f32 v[202:203], v[202:203], v[40:41] op_sel_hi:[1,0]
 v_pk_mul_f32 v[204:205], v[204:205], v[40:41] op_sel_hi:[1,0]
 v_pk_mul_f32 v[206:207], v[206:207], v[40:41] op_sel_hi:[1,0]
 v_cvt_pk_bf16_f32 v252, v200, v201
 v_cvt_pk_bf16_f32 v253, v204, v205
 v_cvt_pk_bf16_f32 v254, v202, v203
 v_cvt_pk_bf16_f32 v255, v206, v207
 buffer_store_dwordx4 v[252:255], v1, s[20:23], s44 offen offset:2048 sc1
 v_pk_mul_f32 v[208:209], v[208:209], v[44:45] op_sel_hi:[1,0]
 v_pk_mul_f32 v[210:211], v[210:211], v[44:45] op_sel_hi:[1,0]
 v_pk_mul_f32 v[212:213], v[212:213], v[44:45] op_sel_hi:[1,0]
 v_pk_mul_f32 v[214:215], v[214:215], v[44:45] op_sel_hi:[1,0]
 v_cvt_pk_bf16_f32 v240, v208, v209
 v_cvt_pk_bf16_f32 v241, v212, v213
 v_cvt_pk_bf16_f32 v242, v210, v211
 v_cvt_pk_bf16_f32 v243, v214, v215
 buffer_store_dwordx4 v[240:243], v1, s[20:23], s40 offen offset:1024 sc1
 v_pk_mul_f32 v[216:217], v[216:217], v[44:45] op_sel_hi:[1,0]
 v_pk_mul_f32 v[218:219], v[218:219], v[44:45] op_sel_hi:[1,0]
 v_pk_mul_f32 v[220:221], v[220:221], v[44:45] op_sel_hi:[1,0]
 v_pk_mul_f32 v[222:223], v[222:223], v[44:45] op_sel_hi:[1,0]
 v_cvt_pk_bf16_f32 v244, v216, v217
 v_cvt_pk_bf16_f32 v245, v220, v221
 v_cvt_pk_bf16_f32 v246, v218, v219
 v_cvt_pk_bf16_f32 v247, v222, v223
 buffer_store_dwordx4 v[244:247], v1, s[20:23], s40 offen offset:3072 sc1
 v_pk_mul_f32 v[224:225], v[224:225], v[44:45] op_sel_hi:[1,0]
 v_pk_mul_f32 v[226:227], v[226:227], v[44:45] op_sel_hi:[1,0]
 v_pk_mul_f32 v[228:229], v[228:229], v[44:45] op_sel_hi:[1,0]
 v_pk_mul_f32 v[230:231], v[230:231], v[44:45] op_sel_hi:[1,0]
 v_cvt_pk_bf16_f32 v248, v224, v225
 v_cvt_pk_bf16_f32 v249, v228, v229
 v_cvt_pk_bf16_f32 v250, v226, v227
 v_cvt_pk_bf16_f32 v251, v230, v231
 buffer_store_dwordx4 v[248:251], v1, s[20:23], s44 offen offset:1024 sc1
 v_pk_mul_f32 v[232:233], v[232:233], v[44:45] op_sel_hi:[1,0]
 v_pk_mul_f32 v[234:235], v[234:235], v[44:45] op_sel_hi:[1,0]
 v_pk_mul_f32 v[236:237], v[236:237], v[44:45] op_sel_hi:[1,0]
 v_pk_mul_f32 v[238:239], v[238:239], v[44:45] op_sel_hi:[1,0]
 v_cvt_pk_bf16_f32 v252, v232, v233
 v_cvt_pk_bf16_f32 v253, v236, v237
 v_cvt_pk_bf16_f32 v254, v234, v235
 v_cvt_pk_bf16_f32 v255, v238, v239
 buffer_store_dwordx4 v[252:255], v1, s[20:23], s44 offen offset:3072 sc1
 s_lshl_b32 s72, s33, 5
 s_add_u32 s72, s72, s32
 s_lshl_b32 s72, s72, 2
 s_add_u32 s72, s72, 0x3c00
 s_cmp_eq_u32 s46, 1
 s_cbranch_scc1 Ladone_9
 s_mov_b32 s46, 1
 s_mov_b32 s33, s34
 v_accvgpr_mov_b32 a0, a64
 v_accvgpr_mov_b32 a1, a65
 v_accvgpr_mov_b32 a2, a66
 v_accvgpr_mov_b32 a3, a67
 v_accvgpr_mov_b32 a4, a68
 v_accvgpr_mov_b32 a5, a69
 v_accvgpr_mov_b32 a6, a70
 v_accvgpr_mov_b32 a7, a71
 v_accvgpr_mov_b32 a8, a72
 v_accvgpr_mov_b32 a9, a73
 v_accvgpr_mov_b32 a10, a74
 v_accvgpr_mov_b32 a11, a75
 v_accvgpr_mov_b32 a12, a76
 v_accvgpr_mov_b32 a13, a77
 v_accvgpr_mov_b32 a14, a78
 v_accvgpr_mov_b32 a15, a79
 v_accvgpr_mov_b32 a16, a80
 v_accvgpr_mov_b32 a17, a81
 v_accvgpr_mov_b32 a18, a82
 v_accvgpr_mov_b32 a19, a83
 v_accvgpr_mov_b32 a20, a84
 v_accvgpr_mov_b32 a21, a85
 v_accvgpr_mov_b32 a22, a86
 v_accvgpr_mov_b32 a23, a87
 v_accvgpr_mov_b32 a24, a88
 v_accvgpr_mov_b32 a25, a89
 v_accvgpr_mov_b32 a26, a90
 v_accvgpr_mov_b32 a27, a91
 v_accvgpr_mov_b32 a28, a92
 v_accvgpr_mov_b32 a29, a93
 v_accvgpr_mov_b32 a30, a94
 v_accvgpr_mov_b32 a31, a95
 v_accvgpr_mov_b32 a32, a96
 v_accvgpr_mov_b32 a33, a97
 v_accvgpr_mov_b32 a34, a98
 v_accvgpr_mov_b32 a35, a99
 v_accvgpr_mov_b32 a36, a100
 v_accvgpr_mov_b32 a37, a101
 v_accvgpr_mov_b32 a38, a102
 v_accvgpr_mov_b32 a39, a103
 v_accvgpr_mov_b32 a40, a104
 v_accvgpr_mov_b32 a41, a105
 v_accvgpr_mov_b32 a42, a106
 v_accvgpr_mov_b32 a43, a107
 v_accvgpr_mov_b32 a44, a108
 v_accvgpr_mov_b32 a45, a109
 v_accvgpr_mov_b32 a46, a110
 v_accvgpr_mov_b32 a47, a111
 v_accvgpr_mov_b32 a48, a112
 v_accvgpr_mov_b32 a49, a113
 v_accvgpr_mov_b32 a50, a114
 v_accvgpr_mov_b32 a51, a115
 v_accvgpr_mov_b32 a52, a116
 v_accvgpr_mov_b32 a53, a117
 v_accvgpr_mov_b32 a54, a118
 v_accvgpr_mov_b32 a55, a119
 v_accvgpr_mov_b32 a56, a120
 v_accvgpr_mov_b32 a57, a121
 v_accvgpr_mov_b32 a58, a122
 v_accvgpr_mov_b32 a59, a123
 v_accvgpr_mov_b32 a60, a124
 v_accvgpr_mov_b32 a61, a125
 v_accvgpr_mov_b32 a62, a126
 v_accvgpr_mov_b32 a63, a127
 s_branch Lablk_6
Laslow_7:
 s_waitcnt vmcnt(0) lgkmcnt(0)
 v_mov_b32 v12, 0
 v_mov_b32 v240, v4
 v_mov_b32 v13, 0
 v_mov_b32 v241, v4
 v_mov_b32 v14, 0
 v_mov_b32 v242, v4
 v_mov_b32 v15, 0
 v_mov_b32 v243, v4
 s_mov_b32 s49, 0
Lsl_14:
 s_lshl_b32 s37, s49, 19
 s_add_u32 s37, s37, s45
 s_sub_u32 s37, s37, s50
 s_add_u32 s44, s37, 0
 buffer_load_dwordx4 a[128:131], v1, s[20:23], s44 offen offset:0 sc1
 buffer_load_dwordx4 a[132:135], v1, s[20:23], s44 offen offset:1024 sc1
 buffer_load_dwordx4 a[136:139], v1, s[20:23], s44 offen offset:2048 sc1
 buffer_load_dwordx4 a[140:143], v1, s[20:23], s44 offen offset:3072 sc1
 s_add_u32 s44, s37, 4096
 buffer_load_dwordx4 a[144:147], v1, s[20:23], s44 offen offset:0 sc1
 buffer_load_dwordx4 a[148:151], v1, s[20:23], s44 offen offset:1024 sc1
 buffer_load_dwordx4 a[152:155], v1, s[20:23], s44 offen offset:2048 sc1
 buffer_load_dwordx4 a[156:159], v1, s[20:23], s44 offen offset:3072 sc1
 s_cmp_lt_u32 s49, s41
 s_cselect_b64 s[68:69], -1, 0
 s_cmp_le_u32 s49, s41
 s_cselect_b64 s[70:71], -1, 0
 s_cmp_eq_u32 s49, s41
 s_cselect_b64 s[60:61], s[52:53], s[68:69]
 s_cselect_b64 s[62:63], s[54:55], s[68:69]
 s_cselect_b64 s[64:65], s[56:57], s[68:69]
 s_cselect_b64 s[66:67], s[58:59], s[68:69]
 v_cndmask_b32 v80, v4, v12, s[60:61]
 v_cndmask_b32 v81, v4, v12, s[62:63]
 v_cndmask_b32 v82, v4, v12, s[64:65]
 v_cndmask_b32 v83, v4, v12, s[66:67]
 v_cndmask_b32 v84, v4, v12, s[68:69]
 v_cndmask_b32 v85, v4, v12, s[68:69]
 v_cndmask_b32 v86, v4, v12, s[68:69]
 v_cndmask_b32 v87, v4, v12, s[68:69]
 v_cndmask_b32 v88, v4, v13, s[70:71]
 v_cndmask_b32 v89, v4, v13, s[70:71]
 v_cndmask_b32 v90, v4, v13, s[70:71]
 v_cndmask_b32 v91, v4, v13, s[70:71]
 v_cndmask_b32 v92, v4, v13, s[60:61]
 v_cndmask_b32 v93, v4, v13, s[62:63]
 v_cndmask_b32 v94, v4, v13, s[64:65]
 v_cndmask_b32 v95, v4, v13, s[66:67]
 s_cmp_lt_u32 s49, s42
 s_cselect_b64 s[68:69], -1, 0
 s_cmp_le_u32 s49, s42
 s_cselect_b64 s[70:71], -1, 0
 s_cmp_eq_u32 s49, s42
 s_cselect_b64 s[60:61], s[52:53], s[68:69]
 s_cselect_b64 s[62:63], s[54:55], s[68:69]
 s_cselect_b64 s[64:65], s[56:57], s[68:69]
 s_cselect_b64 s[66:67], s[58:59], s[68:69]
 v_cndmask_b32 v96, v4, v14, s[60:61]
 v_cndmask_b32 v97, v4, v14, s[62:63]
 v_cndmask_b32 v98, v4, v14, s[64:65]
 v_cndmask_b32 v99, v4, v14, s[66:67]
 v_cndmask_b32 v100, v4, v14, s[68:69]
 v_cndmask_b32 v101, v4, v14, s[68:69]
 v_cndmask_b32 v102, v4, v14, s[68:69]
 v_cndmask_b32 v103, v4, v14, s[68:69]
 v_cndmask_b32 v104, v4, v15, s[70:71]
 v_cndmask_b32 v105, v4, v15, s[70:71]
 v_cndmask_b32 v106, v4, v15, s[70:71]
 v_cndmask_b32 v107, v4, v15, s[70:71]
 v_cndmask_b32 v108, v4, v15, s[60:61]
 v_cndmask_b32 v109, v4, v15, s[62:63]
 v_cndmask_b32 v110, v4, v15, s[64:65]
 v_cndmask_b32 v111, v4, v15, s[66:67]
 s_waitcnt vmcnt(0)
 s_nop 0
 v_mfma_f32_16x16x32_bf16 v[48:51], a[128:131], a[0:3], v[80:83]
 v_mfma_f32_16x16x32_bf16 v[56:59], a[128:131], a[16:19], v[88:91]
 v_mfma_f32_16x16x32_bf16 v[64:67], a[128:131], a[32:35], v[96:99]
 v_mfma_f32_16x16x32_bf16 v[72:75], a[128:131], a[48:51], v[104:107]
 v_mfma_f32_16x16x32_bf16 v[52:55], a[132:135], a[0:3], v[84:87]
 v_mfma_f32_16x16x32_bf16 v[60:63], a[132:135], a[16:19], v[92:95]
 v_mfma_f32_16x16x32_bf16 v[68:71], a[132:135], a[32:35], v[100:103]
 v_mfma_f32_16x16x32_bf16 v[76:79], a[132:135], a[48:51], v[108:111]
 v_mfma_f32_16x16x32_bf16 v[48:51], a[136:139], a[4:7], v[48:51]
 v_mfma_f32_16x16x32_bf16 v[56:59], a[136:139], a[20:23], v[56:59]
 v_mfma_f32_16x16x32_bf16 v[64:67], a[136:139], a[36:39], v[64:67]
 v_mfma_f32_16x16x32_bf16 v[72:75], a[136:139], a[52:55], v[72:75]
 v_mfma_f32_16x16x32_bf16 v[52:55], a[140:143], a[4:7], v[52:55]
 v_mfma_f32_16x16x32_bf16 v[60:63], a[140:143], a[20:23], v[60:63]
 v_mfma_f32_16x16x32_bf16 v[68:71], a[140:143], a[36:39], v[68:71]
 v_mfma_f32_16x16x32_bf16 v[76:79], a[140:143], a[52:55], v[76:79]
 v_mfma_f32_16x16x32_bf16 v[48:51], a[144:147], a[8:11], v[48:51]
 v_mfma_f32_16x16x32_bf16 v[56:59], a[144:147], a[24:27], v[56:59]
 v_mfma_f32_16x16x32_bf16 v[64:67], a[144:147], a[40:43], v[64:67]
 v_mfma_f32_16x16x32_bf16 v[72:75], a[144:147], a[56:59], v[72:75]
 v_mfma_f32_16x16x32_bf16 v[52:55], a[148:151], a[8:11], v[52:55]
 v_mfma_f32_16x16x32_bf16 v[60:63], a[148:151], a[24:27], v[60:63]
 v_mfma_f32_16x16x32_bf16 v[68:71], a[148:151], a[40:43], v[68:71]
 v_mfma_f32_16x16x32_bf16 v[76:79], a[148:151], a[56:59], v[76:79]
 v_mfma_f32_16x16x32_bf16 v[48:51], a[152:155], a[12:15], v[48:51]
 v_mfma_f32_16x16x32_bf16 v[56:59], a[152:155], a[28:31], v[56:59]
 v_mfma_f32_16x16x32_bf16 v[64:67], a[152:155], a[44:47], v[64:67]
 v_mfma_f32_16x16x32_bf16 v[72:75], a[152:155], a[60:63], v[72:75]
 v_mfma_f32_16x16x32_bf16 v[52:55], a[156:159], a[12:15], v[52:55]
 v_mfma_f32_16x16x32_bf16 v[60:63], a[156:159], a[28:31], v[60:63]
 v_mfma_f32_16x16x32_bf16 v[68:71], a[156:159], a[44:47], v[68:71]
 v_mfma_f32_16x16x32_bf16 v[76:79], a[156:159], a[60:63], v[76:79]
 s_nop 7
 v_max3_f32 v240, v240, v48, v49
 v_max3_f32 v240, v240, v50, v51
 v_max3_f32 v240, v240, v52, v53
 v_max3_f32 v240, v240, v54, v55
 v_max3_f32 v241, v241, v56, v57
 v_max3_f32 v241, v241, v58, v59
 v_max3_f32 v241, v241, v60, v61
 v_max3_f32 v241, v241, v62, v63
 v_max3_f32 v242, v242, v64, v65
 v_max3_f32 v242, v242, v66, v67
 v_max3_f32 v242, v242, v68, v69
 v_max3_f32 v242, v242, v70, v71
 v_max3_f32 v243, v243, v72, v73
 v_max3_f32 v243, v243, v74, v75
 v_max3_f32 v243, v243, v76, v77
 v_max3_f32 v243, v243, v78, v79
 s_add_u32 s49, s49, 1
 s_cmp_le_u32 s49, s42
 s_cbranch_scc1 Lsl_14
 v_mov_b32 v244, v240
 v_mov_b32 v245, v241
 v_mov_b32 v246, v242
 v_mov_b32 v247, v243
 v_permlane16_swap_b32 v240, v244
 v_permlane16_swap_b32 v241, v245
 v_permlane16_swap_b32 v242, v246
 v_permlane16_swap_b32 v243, v247
 v_max_f32 v240, v240, v244
 v_max_f32 v241, v241, v245
 v_max_f32 v242, v242, v246
 v_max_f32 v243, v243, v247
 v_mov_b32 v244, v240
 v_mov_b32 v245, v241
 v_mov_b32 v246, v242
 v_mov_b32 v247, v243
 v_permlane32_swap_b32 v240, v244
 v_permlane32_swap_b32 v241, v245
 v_permlane32_swap_b32 v242, v246
 v_permlane32_swap_b32 v243, v247
 v_max_f32 v240, v240, v244
 v_max_f32 v241, v241, v245
 v_max_f32 v242, v242, v246
 v_max_f32 v243, v243, v247
 v_sub_f32 v12, 0, v240
 v_sub_f32 v13, 0, v241
 v_sub_f32 v14, 0, v242
 v_sub_f32 v15, 0, v243
 v_mov_b64 v[112:113], 0
 v_mov_b64 v[114:115], 0
 v_mov_b64 v[116:117], 0
 v_mov_b64 v[118:119], 0
 v_mov_b64 v[120:121], 0
 v_mov_b64 v[122:123], 0
 v_mov_b64 v[124:125], 0
 v_mov_b64 v[126:127], 0
 v_mov_b64 v[128:129], 0
 v_mov_b64 v[130:131], 0
 v_mov_b64 v[132:133], 0
 v_mov_b64 v[134:135], 0
 v_mov_b64 v[136:137], 0
 v_mov_b64 v[138:139], 0
 v_mov_b64 v[140:141], 0
 v_mov_b64 v[142:143], 0
 v_mov_b64 v[144:145], 0
 v_mov_b64 v[146:147], 0
 v_mov_b64 v[148:149], 0
 v_mov_b64 v[150:151], 0
 v_mov_b64 v[152:153], 0
 v_mov_b64 v[154:155], 0
 v_mov_b64 v[156:157], 0
 v_mov_b64 v[158:159], 0
 v_mov_b64 v[160:161], 0
 v_mov_b64 v[162:163], 0
 v_mov_b64 v[164:165], 0
 v_mov_b64 v[166:167], 0
 v_mov_b64 v[168:169], 0
 v_mov_b64 v[170:171], 0
 v_mov_b64 v[172:173], 0
 v_mov_b64 v[174:175], 0
 v_mov_b64 v[176:177], 0
 v_mov_b64 v[178:179], 0
 v_mov_b64 v[180:181], 0
 v_mov_b64 v[182:183], 0
 v_mov_b64 v[184:185], 0
 v_mov_b64 v[186:187], 0
 v_mov_b64 v[188:189], 0
 v_mov_b64 v[190:191], 0
 v_mov_b64 v[192:193], 0
 v_mov_b64 v[194:195], 0
 v_mov_b64 v[196:197], 0
 v_mov_b64 v[198:199], 0
 v_mov_b64 v[200:201], 0
 v_mov_b64 v[202:203], 0
 v_mov_b64 v[204:205], 0
 v_mov_b64 v[206:207], 0
 v_mov_b64 v[208:209], 0
 v_mov_b64 v[210:211], 0
 v_mov_b64 v[212:213], 0
 v_mov_b64 v[214:215], 0
 v_mov_b64 v[216:217], 0
 v_mov_b64 v[218:219], 0
 v_mov_b64 v[220:221], 0
 v_mov_b64 v[222:223], 0
 v_mov_b64 v[224:225], 0
 v_mov_b64 v[226:227], 0
 v_mov_b64 v[228:229], 0
 v_mov_b64 v[230:231], 0
 v_mov_b64 v[232:233], 0
 v_mov_b64 v[234:235], 0
 v_mov_b64 v[236:237], 0
 v_mov_b64 v[238:239], 0
 v_mov_b64 v[32:33], 0
 v_mov_b64 v[34:35], 0
 v_mov_b64 v[36:37], 0
 v_mov_b64 v[38:39], 0
 v_mov_b64 v[40:41], 0
 v_mov_b64 v[42:43], 0
 v_mov_b64 v[44:45], 0
 v_mov_b64 v[46:47], 0
 s_mov_b32 s49, 0
Lsl_15:
 s_lshl_b32 s37, s49, 19
 s_add_u32 s37, s37, s45
 s_sub_u32 s37, s37, s50
 s_add_u32 s44, s37, 0
 buffer_load_dwordx4 a[128:131], v1, s[20:23], s44 offen offset:0 sc1
 buffer_load_dwordx4 a[132:135], v1, s[20:23], s44 offen offset:1024 sc1
 buffer_load_dwordx4 a[136:139], v1, s[20:23], s44 offen offset:2048 sc1
 buffer_load_dwordx4 a[140:143], v1, s[20:23], s44 offen offset:3072 sc1
 s_add_u32 s44, s37, 4096
 buffer_load_dwordx4 a[144:147], v1, s[20:23], s44 offen offset:0 sc1
 buffer_load_dwordx4 a[148:151], v1, s[20:23], s44 offen offset:1024 sc1
 buffer_load_dwordx4 a[152:155], v1, s[20:23], s44 offen offset:2048 sc1
 buffer_load_dwordx4 a[156:159], v1, s[20:23], s44 offen offset:3072 sc1
 s_add_u32 s44, s37, 8192
 buffer_load_dwordx4 a[160:163], v1, s[20:23], s44 offen offset:0 sc1
 buffer_load_dwordx4 a[164:167], v1, s[20:23], s44 offen offset:1024 sc1
 buffer_load_dwordx4 a[168:171], v1, s[20:23], s44 offen offset:2048 sc1
 buffer_load_dwordx4 a[172:175], v1, s[20:23], s44 offen offset:3072 sc1
 s_add_u32 s44, s37, 12288
 buffer_load_dwordx4 a[176:179], v1, s[20:23], s44 offen offset:0 sc1
 buffer_load_dwordx4 a[180:183], v1, s[20:23], s44 offen offset:1024 sc1
 buffer_load_dwordx4 a[184:187], v1, s[20:23], s44 offen offset:2048 sc1
 buffer_load_dwordx4 a[188:191], v1, s[20:23], s44 offen offset:3072 sc1
 s_cmp_lt_u32 s49, s41
 s_cselect_b64 s[68:69], -1, 0
 s_cmp_le_u32 s49, s41
 s_cselect_b64 s[70:71], -1, 0
 s_cmp_eq_u32 s49, s41
 s_cselect_b64 s[60:61], s[52:53], s[68:69]
 s_cselect_b64 s[62:63], s[54:55], s[68:69]
 s_cselect_b64 s[64:65], s[56:57], s[68:69]
 s_cselect_b64 s[66:67], s[58:59], s[68:69]
 v_cndmask_b32 v80, v4, v12, s[60:61]
 v_cndmask_b32 v81, v4, v12, s[62:63]
 v_cndmask_b32 v82, v4, v12, s[64:65]
 v_cndmask_b32 v83, v4, v12, s[66:67]
 v_cndmask_b32 v84, v4, v12, s[68:69]
 v_cndmask_b32 v85, v4, v12, s[68:69]
 v_cndmask_b32 v86, v4, v12, s[68:69]
 v_cndmask_b32 v87, v4, v12, s[68:69]
 v_cndmask_b32 v88, v4, v13, s[70:71]
 v_cndmask_b32 v89, v4, v13, s[70:71]
 v_cndmask_b32 v90, v4, v13, s[70:71]
 v_cndmask_b32 v91, v4, v13, s[70:71]
 v_cndmask_b32 v92, v4, v13, s[60:61]
 v_cndmask_b32 v93, v4, v13, s[62:63]
 v_cndmask_b32 v94, v4, v13, s[64:65]
 v_cndmask_b32 v95, v4, v13, s[66:67]
 s_cmp_lt_u32 s49, s42
 s_cselect_b64 s[68:69], -1, 0
 s_cmp_le_u32 s49, s42
 s_cselect_b64 s[70:71], -1, 0
 s_cmp_eq_u32 s49, s42
 s_cselect_b64 s[60:61], s[52:53], s[68:69]
 s_cselect_b64 s[62:63], s[54:55], s[68:69]
 s_cselect_b64 s[64:65], s[56:57], s[68:69]
 s_cselect_b64 s[66:67], s[58:59], s[68:69]
 v_cndmask_b32 v96, v4, v14, s[60:61]
 v_cndmask_b32 v97, v4, v14, s[62:63]
 v_cndmask_b32 v98, v4, v14, s[64:65]
 v_cndmask_b32 v99, v4, v14, s[66:67]
 v_cndmask_b32 v100, v4, v14, s[68:69]
 v_cndmask_b32 v101, v4, v14, s[68:69]
 v_cndmask_b32 v102, v4, v14, s[68:69]
 v_cndmask_b32 v103, v4, v14, s[68:69]
 v_cndmask_b32 v104, v4, v15, s[70:71]
 v_cndmask_b32 v105, v4, v15, s[70:71]
 v_cndmask_b32 v106, v4, v15, s[70:71]
 v_cndmask_b32 v107, v4, v15, s[70:71]
 v_cndmask_b32 v108, v4, v15, s[60:61]
 v_cndmask_b32 v109, v4, v15, s[62:63]
 v_cndmask_b32 v110, v4, v15, s[64:65]
 v_cndmask_b32 v111, v4, v15, s[66:67]
 s_waitcnt vmcnt(0)
 s_nop 0
 v_mfma_f32_16x16x32_bf16 v[48:51], a[128:131], a[0:3], v[80:83]
 v_mfma_f32_16x16x32_bf16 v[56:59], a[128:131], a[16:19], v[88:91]
 v_mfma_f32_16x16x32_bf16 v[64:67], a[128:131], a[32:35], v[96:99]
 v_mfma_f32_16x16x32_bf16 v[72:75], a[128:131], a[48:51], v[104:107]
 v_mfma_f32_16x16x32_bf16 v[52:55], a[132:135], a[0:3], v[84:87]
 v_mfma_f32_16x16x32_bf16 v[60:63], a[132:135], a[16:19], v[92:95]
 v_mfma_f32_16x16x32_bf16 v[68:71], a[132:135], a[32:35], v[100:103]
 v_mfma_f32_16x16x32_bf16 v[76:79], a[132:135], a[48:51], v[108:111]
 v_mfma_f32_16x16x32_bf16 v[48:51], a[136:139], a[4:7], v[48:51]
 v_mfma_f32_16x16x32_bf16 v[56:59], a[136:139], a[20:23], v[56:59]
 v_mfma_f32_16x16x32_bf16 v[64:67], a[136:139], a[36:39], v[64:67]
 v_mfma_f32_16x16x32_bf16 v[72:75], a[136:139], a[52:55], v[72:75]
 v_mfma_f32_16x16x32_bf16 v[52:55], a[140:143], a[4:7], v[52:55]
 v_mfma_f32_16x16x32_bf16 v[60:63], a[140:143], a[20:23], v[60:63]
 v_mfma_f32_16x16x32_bf16 v[68:71], a[140:143], a[36:39], v[68:71]
 v_mfma_f32_16x16x32_bf16 v[76:79], a[140:143], a[52:55], v[76:79]
 v_mfma_f32_16x16x32_bf16 v[48:51], a[144:147], a[8:11], v[48:51]
 v_mfma_f32_16x16x32_bf16 v[56:59], a[144:147], a[24:27], v[56:59]
 v_mfma_f32_16x16x32_bf16 v[64:67], a[144:147], a[40:43], v[64:67]
 v_mfma_f32_16x16x32_bf16 v[72:75], a[144:147], a[56:59], v[72:75]
 v_mfma_f32_16x16x32_bf16 v[52:55], a[148:151], a[8:11], v[52:55]
 v_mfma_f32_16x16x32_bf16 v[60:63], a[148:151], a[24:27], v[60:63]
 v_mfma_f32_16x16x32_bf16 v[68:71], a[148:151], a[40:43], v[68:71]
 v_mfma_f32_16x16x32_bf16 v[76:79], a[148:151], a[56:59], v[76:79]
 v_mfma_f32_16x16x32_bf16 v[48:51], a[152:155], a[12:15], v[48:51]
 v_mfma_f32_16x16x32_bf16 v[56:59], a[152:155], a[28:31], v[56:59]
 v_mfma_f32_16x16x32_bf16 v[64:67], a[152:155], a[44:47], v[64:67]
 v_mfma_f32_16x16x32_bf16 v[72:75], a[152:155], a[60:63], v[72:75]
 v_mfma_f32_16x16x32_bf16 v[52:55], a[156:159], a[12:15], v[52:55]
 v_mfma_f32_16x16x32_bf16 v[60:63], a[156:159], a[28:31], v[60:63]
 v_mfma_f32_16x16x32_bf16 v[68:71], a[156:159], a[44:47], v[68:71]
 v_mfma_f32_16x16x32_bf16 v[76:79], a[156:159], a[60:63], v[76:79]
 s_nop 7
 v_exp_f32 v48, v48
 v_exp_f32 v49, v49
 v_exp_f32 v52, v52
 v_exp_f32 v53, v53
 v_exp_f32 v50, v50
 v_cvt_pk_bf16_f32 v16, v48, v49
 v_cvt_pk_bf16_f32 v17, v52, v53
 v_exp_f32 v51, v51
 v_exp_f32 v54, v54
 v_exp_f32 v55, v55
 v_cvt_pk_bf16_f32 v18, v50, v51
 v_cvt_pk_bf16_f32 v19, v54, v55
 v_exp_f32 v56, v56
 v_exp_f32 v57, v57
 v_exp_f32 v60, v60
 v_exp_f32 v61, v61
 v_exp_f32 v58, v58
 v_cvt_pk_bf16_f32 v20, v56, v57
 v_cvt_pk_bf16_f32 v21, v60, v61
 v_exp_f32 v59, v59
 v_exp_f32 v62, v62
 v_exp_f32 v63, v63
 v_cvt_pk_bf16_f32 v22, v58, v59
 v_cvt_pk_bf16_f32 v23, v62, v63
 v_exp_f32 v64, v64
 v_exp_f32 v65, v65
 v_exp_f32 v68, v68
 v_exp_f32 v69, v69
 v_exp_f32 v66, v66
 v_cvt_pk_bf16_f32 v24, v64, v65
 v_cvt_pk_bf16_f32 v25, v68, v69
 v_exp_f32 v67, v67
 v_exp_f32 v70, v70
 v_exp_f32 v71, v71
 v_cvt_pk_bf16_f32 v26, v66, v67
 v_cvt_pk_bf16_f32 v27, v70, v71
 v_exp_f32 v72, v72
 v_exp_f32 v73, v73
 v_exp_f32 v76, v76
 v_exp_f32 v77, v77
 v_exp_f32 v74, v74
 v_cvt_pk_bf16_f32 v28, v72, v73
 v_cvt_pk_bf16_f32 v29, v76, v77
 v_exp_f32 v75, v75
 v_exp_f32 v78, v78
 v_exp_f32 v79, v79
 v_cvt_pk_bf16_f32 v30, v74, v75
 v_cvt_pk_bf16_f32 v31, v78, v79
 s_nop 1
 v_mfma_f32_16x16x32_bf16 v[112:115], a[160:163], v[16:19], v[112:115]
 v_mfma_f32_16x16x32_bf16 v[144:147], a[160:163], v[20:23], v[144:147]
 v_mfma_f32_16x16x32_bf16 v[176:179], a[160:163], v[24:27], v[176:179]
 v_mfma_f32_16x16x32_bf16 v[208:211], a[160:163], v[28:31], v[208:211]
 v_mfma_f32_16x16x32_bf16 v[116:119], a[164:167], v[16:19], v[116:119]
 v_mfma_f32_16x16x32_bf16 v[148:151], a[164:167], v[20:23], v[148:151]
 v_mfma_f32_16x16x32_bf16 v[180:183], a[164:167], v[24:27], v[180:183]
 v_mfma_f32_16x16x32_bf16 v[212:215], a[164:167], v[28:31], v[212:215]
 v_mfma_f32_16x16x32_bf16 v[120:123], a[168:171], v[16:19], v[120:123]
 v_mfma_f32_16x16x32_bf16 v[152:155], a[168:171], v[20:23], v[152:155]
 v_mfma_f32_16x16x32_bf16 v[184:187], a[168:171], v[24:27], v[184:187]
 v_mfma_f32_16x16x32_bf16 v[216:219], a[168:171], v[28:31], v[216:219]
 v_mfma_f32_16x16x32_bf16 v[124:127], a[172:175], v[16:19], v[124:127]
 v_mfma_f32_16x16x32_bf16 v[156:159], a[172:175], v[20:23], v[156:159]
 v_mfma_f32_16x16x32_bf16 v[188:191], a[172:175], v[24:27], v[188:191]
 v_mfma_f32_16x16x32_bf16 v[220:223], a[172:175], v[28:31], v[220:223]
 v_mfma_f32_16x16x32_bf16 v[128:131], a[176:179], v[16:19], v[128:131]
 v_mfma_f32_16x16x32_bf16 v[160:163], a[176:179], v[20:23], v[160:163]
 v_mfma_f32_16x16x32_bf16 v[192:195], a[176:179], v[24:27], v[192:195]
 v_mfma_f32_16x16x32_bf16 v[224:227], a[176:179], v[28:31], v[224:227]
 v_mfma_f32_16x16x32_bf16 v[132:135], a[180:183], v[16:19], v[132:135]
 v_mfma_f32_16x16x32_bf16 v[164:167], a[180:183], v[20:23], v[164:167]
 v_mfma_f32_16x16x32_bf16 v[196:199], a[180:183], v[24:27], v[196:199]
 v_mfma_f32_16x16x32_bf16 v[228:231], a[180:183], v[28:31], v[228:231]
 v_mfma_f32_16x16x32_bf16 v[136:139], a[184:187], v[16:19], v[136:139]
 v_mfma_f32_16x16x32_bf16 v[168:171], a[184:187], v[20:23], v[168:171]
 v_mfma_f32_16x16x32_bf16 v[200:203], a[184:187], v[24:27], v[200:203]
 v_mfma_f32_16x16x32_bf16 v[232:235], a[184:187], v[28:31], v[232:235]
 v_mfma_f32_16x16x32_bf16 v[140:143], a[188:191], v[16:19], v[140:143]
 v_mfma_f32_16x16x32_bf16 v[172:175], a[188:191], v[20:23], v[172:175]
 v_mfma_f32_16x16x32_bf16 v[204:207], a[188:191], v[24:27], v[204:207]
 v_mfma_f32_16x16x32_bf16 v[236:239], a[188:191], v[28:31], v[236:239]
 v_mfma_f32_16x16x32_bf16 v[32:35], a[192:195], v[16:19], v[32:35]
 v_mfma_f32_16x16x32_bf16 v[36:39], a[192:195], v[20:23], v[36:39]
 v_mfma_f32_16x16x32_bf16 v[40:43], a[192:195], v[24:27], v[40:43]
 v_mfma_f32_16x16x32_bf16 v[44:47], a[192:195], v[28:31], v[44:47]
 s_add_u32 s49, s49, 1
 s_cmp_le_u32 s49, s42
 s_cbranch_scc1 Lsl_15
 ds_read_b128 a[128:131], v3 offset:0
 ds_read_b128 a[132:135], v3 offset:1024
 ds_read_b128 a[136:139], v3 offset:2048
 ds_read_b128 a[140:143], v3 offset:3072
 ds_read_b128 a[144:147], v3 offset:4096
 ds_read_b128 a[148:151], v3 offset:5120
 ds_read_b128 a[152:155], v3 offset:6144
 ds_read_b128 a[156:159], v3 offset:7168
 s_branch Laback_8
Ladone_9:
 s_waitcnt vmcnt(0) lgkmcnt(0)
 s_barrier
 v_mov_b32 v6, 1
 buffer_store_dword v6, v5, s[20:23], s72 offen sc1
 s_cmp_ge_u32 s6, 27
 s_cbranch_scc1 Lfin
 s_load_dwordx2 s[8:9], s[0:1], 40
 s_mov_b32 s10, 0x480000
 s_mov_b32 s11, 0x20000
 s_mul_i32 s7, s6, 29
 s_lshr_b32 s7, s7, 8
 s_mul_i32 s94, s7, 9
 s_sub_u32 s32, s6, s94
 s_mul_i32 s40, s7, 3
 s_lshl_b32 s7, s7, 2
 s_add_u32 s7, s7, s5
 s_sub_u32 s33, s7, 4
 s_mov_b32 s34, 12
 s_cmp_lt_u32 s33, 4
 s_cselect_b32 s35, 6, 5
 s_mov_b32 s36, 0x6000000
 s_mov_b32 s37, 0
 s_lshl_b32 s38, s4, 5
 s_add_u32 s38, s38, 0x3c00
 s_mov_b32 s39, 0
 s_mov_b32 s93, 0x38
 s_mov_b32 s92, 7
 s_mov_b32 s91, 4
 s_mov_b32 s90, 31
 s_branch Los
Lpb:
 s_load_dwordx2 s[8:9], s[0:1], 48
 s_mov_b32 s10, 0x240000
 s_mov_b32 s11, 0x20000
 s_load_dwordx2 s[12:13], s[0:1], 72
 s_mov_b32 s14, 0x480000
 s_mov_b32 s15, 0x20000
 s_load_dwordx2 s[16:17], s[0:1], 80
 s_mov_b32 s18, 0x480000
 s_mov_b32 s19, 0x20000
 s_lshl_b32 s32, s6, 8
 s_mov_b32 s33, s32
 s_lshl_b32 s34, s6, 14
 s_add_u32 s34, s34, 0x3000000
 s_add_u32 s35, s34, 8192
 s_mov_b32 s36, 64
 s_mov_b32 s37, 0
 s_lshl_b32 s7, s6, 7
 s_add_u32 s7, s7, 0x0
 v_min_u32 v1, 1, v0
 v_lshlrev_b32 v1, 28, v1
 v_add_u32 v13, s7, v1
 s_waitcnt lgkmcnt(0)
 v_and_b32 v1, 63, v0
 v_lshrrev_b32 v2, 3, v0
 v_mul_u32_u24 v10, 1152, v2
 v_lshrrev_b32 v2, 4, v0
 v_xor_b32 v2, v2, v0
 v_and_b32 v2, 7, v2
 v_lshl_add_u32 v10, v2, 4, v10
 v_lshrrev_b32 v2, 4, v1
 v_bfe_u32 v3, v1, 1, 3
 v_xor_b32 v2, v2, v3
 v_and_b32 v3, 15, v1
 v_lshlrev_b32 v3, 7, v3
 v_lshl_add_u32 v4, v2, 4, v3
 v_xor_b32 v5, 64, v4
 v_lshrrev_b32 v2, 4, v0
 v_lshlrev_b32 v11, 13, v2
 v_lshrrev_b32 v2, 7, v0
 v_lshrrev_b32 v3, 4, v1
 v_lshl_add_u32 v3, v2, 2, v3
 v_bfe_u32 v2, v1, 1, 3
 v_xor_b32 v2, v2, v3
 v_lshl_add_u32 v11, v2, 5, v11
 v_and_b32 v2, 1, v1
 v_lshl_add_u32 v11, v2, 4, v11
 v_bfe_u32 v2, v1, 2, 3
 v_xor_b32 v3, s4, v2
 v_lshlrev_b32 v3, 5, v3
 v_and_b32 v2, 3, v2
 v_lshl_add_u32 v3, v2, 8, v3
 v_lshrrev_b32 v2, 4, v1
 v_lshl_add_u32 v3, v2, 11, v3
 v_and_b32 v2, 3, v1
 v_lshl_add_u32 v3, v2, 3, v3
 v_add_u32 v8, 73728, v3
 v_xor_b32 v3, 0x80, v3
 v_add_u32 v9, 73728, v3
 s_lshl_b32 s45, s4, 11
 v_lshl_add_u32 v12, v1, 4, s45
 s_mov_b32 s39, s37
 s_add_u32 s40, s39, 1
 s_lshl_b32 s49, s4, 10
 s_mul_i32 s46, s39, 36864
 s_add_u32 m0, s49, 0
 s_nop 0
 buffer_load_dwordx4 v10, s[8:11], s46 offen offset:0  lds
 s_add_u32 m0, s49, 3968
 s_nop 0
 buffer_load_dwordx4 v10, s[8:11], s46 offen offset:128  lds
 s_add_u32 m0, s49, 7936
 s_nop 0
 buffer_load_dwordx4 v10, s[8:11], s46 offen offset:256  lds
 s_add_u32 m0, s49, 11904
 s_nop 0
 buffer_load_dwordx4 v10, s[8:11], s46 offen offset:384  lds
 s_add_u32 m0, s49, 15872
 s_nop 0
 buffer_load_dwordx4 v10, s[8:11], s46 offen offset:512  lds
 s_add_u32 m0, s49, 19840
 s_nop 0
 buffer_load_dwordx4 v10, s[8:11], s46 offen offset:640  lds
 s_add_u32 m0, s49, 23808
 s_nop 0
 buffer_load_dwordx4 v10, s[8:11], s46 offen offset:768  lds
 s_add_u32 m0, s49, 27776
 s_nop 0
 buffer_load_dwordx4 v10, s[8:11], s46 offen offset:896  lds
 s_add_u32 m0, s49, 31744
 s_nop 0
 buffer_load_dwordx4 v10, s[8:11], s46 offen offset:1024  lds
 s_lshl_b32 s49, s4, 10
 s_add_u32 s49, s49, 36864
 s_mul_i32 s46, s40, 36864
 s_add_u32 m0, s49, 0
 s_nop 0
 buffer_load_dwordx4 v10, s[8:11], s46 offen offset:0  lds
 s_add_u32 m0, s49, 3968
 s_nop 0
 buffer_load_dwordx4 v10, s[8:11], s46 offen offset:128  lds
 s_add_u32 m0, s49, 7936
 s_nop 0
 buffer_load_dwordx4 v10, s[8:11], s46 offen offset:256  lds
 s_add_u32 m0, s49, 11904
 s_nop 0
 buffer_load_dwordx4 v10, s[8:11], s46 offen offset:384  lds
 s_add_u32 m0, s49, 15872
 s_nop 0
 buffer_load_dwordx4 v10, s[8:11], s46 offen offset:512  lds
 s_add_u32 m0, s49, 19840
 s_nop 0
 buffer_load_dwordx4 v10, s[8:11], s46 offen offset:640  lds
 s_add_u32 m0, s49, 23808
 s_nop 0
 buffer_load_dwordx4 v10, s[8:11], s46 offen offset:768  lds
 s_add_u32 m0, s49, 27776
 s_nop 0
 buffer_load_dwordx4 v10, s[8:11], s46 offen offset:896  lds
 s_add_u32 m0, s49, 31744
 s_nop 0
 buffer_load_dwordx4 v10, s[8:11], s46 offen offset:1024  lds
 s_lshl_b32 s49, s4, 10
 s_add_u32 m0, s49, 73728
 s_add_u32 s45, s32, 0
 buffer_load_dwordx4 v11, s[12:15], s45 offen nt lds
 s_add_u32 m0, s49, 77824
 s_add_u32 s45, s32, 131072
 buffer_load_dwordx4 v11, s[12:15], s45 offen nt lds
 s_add_u32 m0, s49, 81920
 s_add_u32 s45, s33, 0
 buffer_load_dwordx4 v11, s[16:19], s45 offen nt lds
 s_add_u32 m0, s49, 86016
 s_add_u32 s45, s33, 131072
 buffer_load_dwordx4 v11, s[16:19], s45 offen nt lds
 s_add_u32 m0, s49, 90112
 s_add_u32 s45, s32, 262144
 buffer_load_dwordx4 v11, s[12:15], s45 offen nt lds
 s_add_u32 m0, s49, 94208
 s_add_u32 s45, s32, 393216
 buffer_load_dwordx4 v11, s[12:15], s45 offen nt lds
 s_add_u32 m0, s49, 98304
 s_add_u32 s45, s33, 262144
 buffer_load_dwordx4 v11, s[16:19], s45 offen nt lds
 s_add_u32 m0, s49, 102400
 s_add_u32 s45, s33, 393216
 buffer_load_dwordx4 v11, s[16:19], s45 offen nt lds
 s_add_u32 m0, s49, 106496
 s_add_u32 s45, s32, 524288
 buffer_load_dwordx4 v11, s[12:15], s45 offen nt lds
 s_add_u32 m0, s49, 110592
 s_add_u32 s45, s32, 655360
 buffer_load_dwordx4 v11, s[12:15], s45 offen nt lds
 s_add_u32 m0, s49, 114688
 s_add_u32 s45, s33, 524288
 buffer_load_dwordx4 v11, s[16:19], s45 offen nt lds
 s_add_u32 m0, s49, 118784
 s_add_u32 s45, s33, 655360
 buffer_load_dwordx4 v11, s[16:19], s45 offen nt lds
 s_waitcnt vmcnt(8) lgkmcnt(0)
 s_barrier
 s_add_u32 m0, s49, 122880
 s_add_u32 s45, s32, 786432
 buffer_load_dwordx4 v11, s[12:15], s45 offen nt lds
 s_add_u32 m0, s49, 126976
 s_add_u32 s45, s32, 917504
 buffer_load_dwordx4 v11, s[12:15], s45 offen nt lds
 s_add_u32 m0, s49, 131072
 s_add_u32 s45, s33, 786432
 buffer_load_dwordx4 v11, s[16:19], s45 offen nt lds
 s_add_u32 m0, s49, 135168
 s_add_u32 s45, s33, 917504
 buffer_load_dwordx4 v11, s[16:19], s45 offen nt lds
 ds_read_b64_tr_b16 a[0:1], v8 offset:0
 ds_read_b64_tr_b16 a[2:3], v8 offset:1024
 ds_read_b64_tr_b16 a[72:73], v9 offset:0
 ds_read_b64_tr_b16 a[74:75], v9 offset:1024
 ds_read_b64_tr_b16 a[144:145], v8 offset:8192
 ds_read_b64_tr_b16 a[146:147], v8 offset:9216
 ds_read_b64_tr_b16 a[216:217], v9 offset:8192
 ds_read_b64_tr_b16 a[218:219], v9 offset:9216
 s_waitcnt vmcnt(8) lgkmcnt(0)
 s_barrier
 s_add_u32 m0, s49, 73728
 s_add_u32 s45, s32, 1048576
 buffer_load_dwordx4 v11, s[12:15], s45 offen nt lds
 s_add_u32 m0, s49, 77824
 s_add_u32 s45, s32, 1179648
 buffer_load_dwordx4 v11, s[12:15], s45 offen nt lds
 s_add_u32 m0, s49, 81920
 s_add_u32 s45, s33, 1048576
 buffer_load_dwordx4 v11, s[16:19], s45 offen nt lds
 s_add_u32 m0, s49, 86016
 s_add_u32 s45, s33, 1179648
 buffer_load_dwordx4 v11, s[16:19], s45 offen nt lds
 ds_read_b64_tr_b16 a[4:5], v8 offset:16384
 ds_read_b64_tr_b16 a[6:7], v8 offset:17408
 ds_read_b64_tr_b16 a[76:77], v9 offset:16384
 ds_read_b64_tr_b16 a[78:79], v9 offset:17408
 ds_read_b64_tr_b16 a[148:149], v8 offset:24576
 ds_read_b64_tr_b16 a[150:151], v8 offset:25600
 ds_read_b64_tr_b16 a[220:221], v9 offset:24576
 ds_read_b64_tr_b16 a[222:223], v9 offset:25600
 s_waitcnt vmcnt(8) lgkmcnt(0)
 s_barrier
 s_add_u32 m0, s49, 90112
 s_add_u32 s45, s32, 1310720
 buffer_load_dwordx4 v11, s[12:15], s45 offen nt lds
 s_add_u32 m0, s49, 94208
 s_add_u32 s45, s32, 1441792
 buffer_load_dwordx4 v11, s[12:15], s45 offen nt lds
 s_add_u32 m0, s49, 98304
 s_add_u32 s45, s33, 1310720
 buffer_load_dwordx4 v11, s[16:19], s45 offen nt lds
 s_add_u32 m0, s49, 102400
 s_add_u32 s45, s33, 1441792
 buffer_load_dwordx4 v11, s[16:19], s45 offen nt lds
 ds_read_b64_tr_b16 a[8:9], v8 offset:32768
 ds_read_b64_tr_b16 a[10:11], v8 offset:33792
 ds_read_b64_tr_b16 a[80:81], v9 offset:32768
 ds_read_b64_tr_b16 a[82:83], v9 offset:33792
 ds_read_b64_tr_b16 a[152:153], v8 offset:40960
 ds_read_b64_tr_b16 a[154:155], v8 offset:41984
 ds_read_b64_tr_b16 a[224:225], v9 offset:40960
 ds_read_b64_tr_b16 a[226:227], v9 offset:41984
 s_waitcnt vmcnt(8) lgkmcnt(0)
 s_barrier
 s_add_u32 m0, s49, 106496
 s_add_u32 s45, s32, 1572864
 buffer_load_dwordx4 v11, s[12:15], s45 offen nt lds
 s_add_u32 m0, s49, 110592
 s_add_u32 s45, s32, 1703936
 buffer_load_dwordx4 v11, s[12:15], s45 offen nt lds
 s_add_u32 m0, s49, 114688
 s_add_u32 s45, s33, 1572864
 buffer_load_dwordx4 v11, s[16:19], s45 offen nt lds
 s_add_u32 m0, s49, 118784
 s_add_u32 s45, s33, 1703936
 buffer_load_dwordx4 v11, s[16:19], s45 offen nt lds
 ds_read_b64_tr_b16 a[12:13], v8 offset:49152
 ds_read_b64_tr_b16 a[14:15], v8 offset:50176
 ds_read_b64_tr_b16 a[84:85], v9 offset:49152
 ds_read_b64_tr_b16 a[86:87], v9 offset:50176
 ds_read_b64_tr_b16 a[156:157], v8 offset:57344
 ds_read_b64_tr_b16 a[158:159], v8 offset:58368
 ds_read_b64_tr_b16 a[228:229], v9 offset:57344
 ds_read_b64_tr_b16 a[230:231], v9 offset:58368
 s_waitcnt vmcnt(8) lgkmcnt(0)
 s_barrier
 s_add_u32 m0, s49, 122880
 s_add_u32 s45, s32, 1835008
 buffer_load_dwordx4 v11, s[12:15], s45 offen nt lds
 s_add_u32 m0, s49, 126976
 s_add_u32 s45, s32, 1966080
 buffer_load_dwordx4 v11, s[12:15], s45 offen nt lds
 s_add_u32 m0, s49, 131072
 s_add_u32 s45, s33, 1835008
 buffer_load_dwordx4 v11, s[16:19], s45 offen nt lds
 s_add_u32 m0, s49, 135168
 s_add_u32 s45, s33, 1966080
 buffer_load_dwordx4 v11, s[16:19], s45 offen nt lds
 ds_read_b64_tr_b16 a[16:17], v8 offset:0
 ds_read_b64_tr_b16 a[18:19], v8 offset:1024
 ds_read_b64_tr_b16 a[88:89], v9 offset:0
 ds_read_b64_tr_b16 a[90:91], v9 offset:1024
 ds_read_b64_tr_b16 a[160:161], v8 offset:8192
 ds_read_b64_tr_b16 a[162:163], v8 offset:9216
 ds_read_b64_tr_b16 a[232:233], v9 offset:8192
 ds_read_b64_tr_b16 a[234:235], v9 offset:9216
 s_waitcnt vmcnt(8) lgkmcnt(0)
 s_barrier
 s_add_u32 m0, s49, 73728
 s_add_u32 s45, s32, 2097152
 buffer_load_dwordx4 v11, s[12:15], s45 offen nt lds
 s_add_u32 m0, s49, 77824
 s_add_u32 s45, s32, 2228224
 buffer_load_dwordx4 v11, s[12:15], s45 offen nt lds
 s_add_u32 m0, s49, 81920
 s_add_u32 s45, s33, 2097152
 buffer_load_dwordx4 v11, s[16:19], s45 offen nt lds
 s_add_u32 m0, s49, 86016
 s_add_u32 s45, s33, 2228224
 buffer_load_dwordx4 v11, s[16:19], s45 offen nt lds
 ds_read_b64_tr_b16 a[20:21], v8 offset:16384
 ds_read_b64_tr_b16 a[22:23], v8 offset:17408
 ds_read_b64_tr_b16 a[92:93], v9 offset:16384
 ds_read_b64_tr_b16 a[94:95], v9 offset:17408
 ds_read_b64_tr_b16 a[164:165], v8 offset:24576
 ds_read_b64_tr_b16 a[166:167], v8 offset:25600
 ds_read_b64_tr_b16 a[236:237], v9 offset:24576
 ds_read_b64_tr_b16 a[238:239], v9 offset:25600
 s_waitcnt vmcnt(8) lgkmcnt(0)
 s_barrier
 s_add_u32 m0, s49, 90112
 s_add_u32 s45, s32, 2359296
 buffer_load_dwordx4 v11, s[12:15], s45 offen nt lds
 s_add_u32 m0, s49, 94208
 s_add_u32 s45, s32, 2490368
 buffer_load_dwordx4 v11, s[12:15], s45 offen nt lds
 s_add_u32 m0, s49, 98304
 s_add_u32 s45, s33, 2359296
 buffer_load_dwordx4 v11, s[16:19], s45 offen nt lds
 s_add_u32 m0, s49, 102400
 s_add_u32 s45, s33, 2490368
 buffer_load_dwordx4 v11, s[16:19], s45 offen nt lds
 ds_read_b64_tr_b16 a[24:25], v8 offset:32768
 ds_read_b64_tr_b16 a[26:27], v8 offset:33792
 ds_read_b64_tr_b16 a[96:97], v9 offset:32768
 ds_read_b64_tr_b16 a[98:99], v9 offset:33792
 ds_read_b64_tr_b16 a[168:169], v8 offset:40960
 ds_read_b64_tr_b16 a[170:171], v8 offset:41984
 ds_read_b64_tr_b16 a[240:241], v9 offset:40960
 ds_read_b64_tr_b16 a[242:243], v9 offset:41984
 s_waitcnt vmcnt(8) lgkmcnt(0)
 s_barrier
 s_add_u32 m0, s49, 106496
 s_add_u32 s45, s32, 2621440
 buffer_load_dwordx4 v11, s[12:15], s45 offen nt lds
 s_add_u32 m0, s49, 110592
 s_add_u32 s45, s32, 2752512
 buffer_load_dwordx4 v11, s[12:15], s45 offen nt lds
 s_add_u32 m0, s49, 114688
 s_add_u32 s45, s33, 2621440
 buffer_load_dwordx4 v11, s[16:19], s45 offen nt lds
 s_add_u32 m0, s49, 118784
 s_add_u32 s45, s33, 2752512
 buffer_load_dwordx4 v11, s[16:19], s45 offen nt lds
 ds_read_b64_tr_b16 a[28:29], v8 offset:49152
 ds_read_b64_tr_b16 a[30:31], v8 offset:50176
 ds_read_b64_tr_b16 a[100:101], v9 offset:49152
 ds_read_b64_tr_b16 a[102:103], v9 offset:50176
 ds_read_b64_tr_b16 a[172:173], v8 offset:57344
 ds_read_b64_tr_b16 a[174:175], v8 offset:58368
 ds_read_b64_tr_b16 a[244:245], v9 offset:57344
 ds_read_b64_tr_b16 a[246:247], v9 offset:58368
 s_waitcnt vmcnt(8) lgkmcnt(0)
 s_barrier
 s_add_u32 m0, s49, 122880
 s_add_u32 s45, s32, 2883584
 buffer_load_dwordx4 v11, s[12:15], s45 offen nt lds
 s_add_u32 m0, s49, 126976
 s_add_u32 s45, s32, 3014656
 buffer_load_dwordx4 v11, s[12:15], s45 offen nt lds
 s_add_u32 m0, s49, 131072
 s_add_u32 s45, s33, 2883584
 buffer_load_dwordx4 v11, s[16:19], s45 offen nt lds
 s_add_u32 m0, s49, 135168
 s_add_u32 s45, s33, 3014656
 buffer_load_dwordx4 v11, s[16:19], s45 offen nt lds
 ds_read_b64_tr_b16 a[32:33], v8 offset:0
 ds_read_b64_tr_b16 a[34:35], v8 offset:1024
 ds_read_b64_tr_b16 a[104:105], v9 offset:0
 ds_read_b64_tr_b16 a[106:107], v9 offset:1024
 ds_read_b64_tr_b16 a[176:177], v8 offset:8192
 ds_read_b64_tr_b16 a[178:179], v8 offset:9216
 ds_read_b64_tr_b16 a[248:249], v9 offset:8192
 ds_read_b64_tr_b16 a[250:251], v9 offset:9216
 s_waitcnt vmcnt(8) lgkmcnt(0)
 s_barrier
 s_add_u32 m0, s49, 73728
 s_add_u32 s45, s32, 3145728
 buffer_load_dwordx4 v11, s[12:15], s45 offen nt lds
 s_add_u32 m0, s49, 77824
 s_add_u32 s45, s32, 3276800
 buffer_load_dwordx4 v11, s[12:15], s45 offen nt lds
 s_add_u32 m0, s49, 81920
 s_add_u32 s45, s33, 3145728
 buffer_load_dwordx4 v11, s[16:19], s45 offen nt lds
 s_add_u32 m0, s49, 86016
 s_add_u32 s45, s33, 3276800
 buffer_load_dwordx4 v11, s[16:19], s45 offen nt lds
 ds_read_b64_tr_b16 a[36:37], v8 offset:16384
 ds_read_b64_tr_b16 a[38:39], v8 offset:17408
 ds_read_b64_tr_b16 a[108:109], v9 offset:16384
 ds_read_b64_tr_b16 a[110:111], v9 offset:17408
 ds_read_b64_tr_b16 a[180:181], v8 offset:24576
 ds_read_b64_tr_b16 a[182:183], v8 offset:25600
 ds_read_b64_tr_b16 a[252:253], v9 offset:24576
 ds_read_b64_tr_b16 a[254:255], v9 offset:25600
 s_waitcnt vmcnt(8) lgkmcnt(0)
 s_barrier
 s_add_u32 m0, s49, 90112
 s_add_u32 s45, s32, 3407872
 buffer_load_dwordx4 v11, s[12:15], s45 offen nt lds
 s_add_u32 m0, s49, 94208
 s_add_u32 s45, s32, 3538944
 buffer_load_dwordx4 v11, s[12:15], s45 offen nt lds
 s_add_u32 m0, s49, 98304
 s_add_u32 s45, s33, 3407872
 buffer_load_dwordx4 v11, s[16:19], s45 offen nt lds
 s_add_u32 m0, s49, 102400
 s_add_u32 s45, s33, 3538944
 buffer_load_dwordx4 v11, s[16:19], s45 offen nt lds
 ds_read_b64_tr_b16 a[40:41], v8 offset:32768
 ds_read_b64_tr_b16 a[42:43], v8 offset:33792
 ds_read_b64_tr_b16 a[112:113], v9 offset:32768
 ds_read_b64_tr_b16 a[114:115], v9 offset:33792
 ds_read_b64_tr_b16 a[184:185], v8 offset:40960
 ds_read_b64_tr_b16 a[186:187], v8 offset:41984
 ds_read_b64_tr_b16 v[224:225], v9 offset:40960
 ds_read_b64_tr_b16 v[226:227], v9 offset:41984
 s_waitcnt vmcnt(8) lgkmcnt(0)
 s_barrier
 s_add_u32 m0, s49, 106496
 s_add_u32 s45, s32, 3670016
 buffer_load_dwordx4 v11, s[12:15], s45 offen nt lds
 s_add_u32 m0, s49, 110592
 s_add_u32 s45, s32, 3801088
 buffer_load_dwordx4 v11, s[12:15], s45 offen nt lds
 s_add_u32 m0, s49, 114688
 s_add_u32 s45, s33, 3670016
 buffer_load_dwordx4 v11, s[16:19], s45 offen nt lds
 s_add_u32 m0, s49, 118784
 s_add_u32 s45, s33, 3801088
 buffer_load_dwordx4 v11, s[16:19], s45 offen nt lds
 ds_read_b64_tr_b16 a[44:45], v8 offset:49152
 ds_read_b64_tr_b16 a[46:47], v8 offset:50176
 ds_read_b64_tr_b16 a[116:117], v9 offset:49152
 ds_read_b64_tr_b16 a[118:119], v9 offset:50176
 ds_read_b64_tr_b16 a[188:189], v8 offset:57344
 ds_read_b64_tr_b16 a[190:191], v8 offset:58368
 ds_read_b64_tr_b16 v[228:229], v9 offset:57344
 ds_read_b64_tr_b16 v[230:231], v9 offset:58368
 s_waitcnt vmcnt(8) lgkmcnt(0)
 s_barrier
 s_add_u32 m0, s49, 122880
 s_add_u32 s45, s32, 3932160
 buffer_load_dwordx4 v11, s[12:15], s45 offen nt lds
 s_add_u32 m0, s49, 126976
 s_add_u32 s45, s32, 4063232
 buffer_load_dwordx4 v11, s[12:15], s45 offen nt lds
 s_add_u32 m0, s49, 131072
 s_add_u32 s45, s33, 3932160
 buffer_load_dwordx4 v11, s[16:19], s45 offen nt lds
 s_add_u32 m0, s49, 135168
 s_add_u32 s45, s33, 4063232
 buffer_load_dwordx4 v11, s[16:19], s45 offen nt lds
 ds_read_b64_tr_b16 a[48:49], v8 offset:0
 ds_read_b64_tr_b16 a[50:51], v8 offset:1024
 ds_read_b64_tr_b16 a[120:121], v9 offset:0
 ds_read_b64_tr_b16 a[122:123], v9 offset:1024
 ds_read_b64_tr_b16 a[192:193], v8 offset:8192
 ds_read_b64_tr_b16 a[194:195], v8 offset:9216
 ds_read_b64_tr_b16 v[232:233], v9 offset:8192
 ds_read_b64_tr_b16 v[234:235], v9 offset:9216
 s_waitcnt vmcnt(8) lgkmcnt(0)
 s_barrier
 s_add_u32 m0, s49, 73728
 s_add_u32 s45, s32, 4194304
 buffer_load_dwordx4 v11, s[12:15], s45 offen nt lds
 s_add_u32 m0, s49, 77824
 s_add_u32 s45, s32, 4325376
 buffer_load_dwordx4 v11, s[12:15], s45 offen nt lds
 s_add_u32 m0, s49, 81920
 s_add_u32 s45, s33, 4194304
 buffer_load_dwordx4 v11, s[16:19], s45 offen nt lds
 s_add_u32 m0, s49, 86016
 s_add_u32 s45, s33, 4325376
 buffer_load_dwordx4 v11, s[16:19], s45 offen nt lds
 ds_read_b64_tr_b16 a[52:53], v8 offset:16384
 ds_read_b64_tr_b16 a[54:55], v8 offset:17408
 ds_read_b64_tr_b16 a[124:125], v9 offset:16384
 ds_read_b64_tr_b16 a[126:127], v9 offset:17408
 ds_read_b64_tr_b16 a[196:197], v8 offset:24576
 ds_read_b64_tr_b16 a[198:199], v8 offset:25600
 ds_read_b64_tr_b16 v[236:237], v9 offset:24576
 ds_read_b64_tr_b16 v[238:239], v9 offset:25600
 s_waitcnt vmcnt(8) lgkmcnt(0)
 s_barrier
 s_add_u32 m0, s49, 90112
 s_add_u32 s45, s32, 4456448
 buffer_load_dwordx4 v11, s[12:15], s45 offen nt lds
 s_add_u32 m0, s49, 94208
 s_add_u32 s45, s32, 4587520
 buffer_load_dwordx4 v11, s[12:15], s45 offen nt lds
 s_add_u32 m0, s49, 98304
 s_add_u32 s45, s33, 4456448
 buffer_load_dwordx4 v11, s[16:19], s45 offen nt lds
 s_add_u32 m0, s49, 102400
 s_add_u32 s45, s33, 4587520
 buffer_load_dwordx4 v11, s[16:19], s45 offen nt lds
 ds_read_b64_tr_b16 a[56:57], v8 offset:32768
 ds_read_b64_tr_b16 a[58:59], v8 offset:33792
 ds_read_b64_tr_b16 a[128:129], v9 offset:32768
 ds_read_b64_tr_b16 a[130:131], v9 offset:33792
 ds_read_b64_tr_b16 a[200:201], v8 offset:40960
 ds_read_b64_tr_b16 a[202:203], v8 offset:41984
 ds_read_b64_tr_b16 v[240:241], v9 offset:40960
 ds_read_b64_tr_b16 v[242:243], v9 offset:41984
 s_waitcnt vmcnt(8) lgkmcnt(0)
 s_barrier
 ds_read_b64_tr_b16 a[60:61], v8 offset:49152
 ds_read_b64_tr_b16 a[62:63], v8 offset:50176
 ds_read_b64_tr_b16 a[132:133], v9 offset:49152
 ds_read_b64_tr_b16 a[134:135], v9 offset:50176
 ds_read_b64_tr_b16 a[204:205], v8 offset:57344
 ds_read_b64_tr_b16 a[206:207], v8 offset:58368
 ds_read_b64_tr_b16 v[244:245], v9 offset:57344
 ds_read_b64_tr_b16 v[246:247], v9 offset:58368
 s_waitcnt vmcnt(4) lgkmcnt(0)
 s_barrier
 ds_read_b64_tr_b16 a[64:65], v8 offset:0
 ds_read_b64_tr_b16 a[66:67], v8 offset:1024
 ds_read_b64_tr_b16 a[136:137], v9 offset:0
 ds_read_b64_tr_b16 a[138:139], v9 offset:1024
 ds_read_b64_tr_b16 a[208:209], v8 offset:8192
 ds_read_b64_tr_b16 a[210:211], v8 offset:9216
 ds_read_b64_tr_b16 v[248:249], v9 offset:8192
 ds_read_b64_tr_b16 v[250:251], v9 offset:9216
 s_waitcnt vmcnt(0) lgkmcnt(0)
 s_barrier
 ds_read_b64_tr_b16 a[68:69], v8 offset:16384
 ds_read_b64_tr_b16 a[70:71], v8 offset:17408
 ds_read_b64_tr_b16 a[140:141], v9 offset:16384
 ds_read_b64_tr_b16 a[142:143], v9 offset:17408
 ds_read_b64_tr_b16 a[212:213], v8 offset:24576
 ds_read_b64_tr_b16 a[214:215], v8 offset:25600
 ds_read_b64_tr_b16 v[252:253], v9 offset:24576
 ds_read_b64_tr_b16 v[254:255], v9 offset:25600
 s_mov_b32 s50, 0x3e0293ee
 s_mov_b32 s42, 0
 s_mov_b32 s43, 0
 s_mov_b32 s44, 73728
 v_mov_b32 v6, v4
 v_mov_b32 v7, v5
 s_mov_b32 s95, 0x40000
 s_cmp_lg_u32 s4, 0
 s_cbranch_scc1 Lfrk_17
 v_min_u32 v21, 1, v0
 v_lshlrev_b32 v21, 28, v21
Lfr_16:
 buffer_load_dword v20, v21, s[28:31], 0 offen offset:0 sc1
 s_waitcnt vmcnt(0)
 v_cmp_eq_u32 vcc, 1, v20
 s_cbranch_vccnz Lfrk_17
 s_sub_u32 s95, s95, 1
 s_cbranch_scc0 Lfr_16
 s_endpgm
Lfrk_17:
 s_lshl_b32 s47, s2, 13
 s_add_u32 s47, s47, 0x8000000
 s_mov_b32 s48, s47
 v_mov_b32 v14, 0
 s_waitcnt vmcnt(0) lgkmcnt(0)
 s_barrier
 ds_read_b128 v[32:35], v6 offset:0
 ds_read_b128 v[36:39], v6 offset:2048
 ds_read_b128 v[40:43], v7 offset:0
 ds_read_b128 v[44:47], v7 offset:2048
 v_lshlrev_b32 v1, 12, v0
 s_lshl_b32 s45, s6, 7
 buffer_load_dword v15, v1, s[8:11], s45 offen
 v_add_u32 v1, 0x100000, v1
 buffer_load_dword v15, v1, s[8:11], s45 offen
 v_add_u32 v1, 0x100000, v1
 buffer_load_dword v15, v1, s[8:11], s45 offen
 v_add_u32 v1, 0x100000, v1
 s_waitcnt lgkmcnt(2)
Lps_loop_18:
 v_mfma_f32_16x16x32_bf16 v[64:67], a[0:3], v[32:35], 0
 ds_read_b128 v[48:51], v6 offset:4096
 v_mfma_f32_16x16x32_bf16 v[72:75], a[72:75], v[32:35], 0
 ds_read_b128 v[52:55], v6 offset:6144
 v_mfma_f32_16x16x32_bf16 v[80:83], v[32:35], a[144:147], 0
 s_add_u32 s41, s40, 1
 v_mfma_f32_16x16x32_bf16 v[88:91], v[32:35], a[216:219], 0
 s_add_u32 s45, s42, 2
 s_mul_i32 s46, s41, 36864
 v_mfma_f32_16x16x32_bf16 v[68:71], a[0:3], v[36:39], 0
 s_cmp_lt_u32 s45, s36
 s_cselect_b32 s46, s46, 0
 v_mfma_f32_16x16x32_bf16 v[76:79], a[72:75], v[36:39], 0
 s_lshl_b32 s49, s4, 10
 s_add_u32 s49, s49, s44
 v_mfma_f32_16x16x32_bf16 v[84:87], v[36:39], a[144:147], 0
 v_cvt_pk_bf16_f32 v16, v96, v97
 v_mfma_f32_16x16x32_bf16 v[92:95], v[36:39], a[216:219], 0
 s_waitcnt lgkmcnt(2)
 v_mfma_f32_16x16x32_bf16 v[64:67], a[4:7], v[40:43], v[64:67]
 ds_read_b128 v[56:59], v7 offset:4096
 v_mfma_f32_16x16x32_bf16 v[72:75], a[76:79], v[40:43], v[72:75]
 ds_read_b128 v[60:63], v7 offset:6144
 v_mfma_f32_16x16x32_bf16 v[80:83], v[40:43], a[148:151], v[80:83]
 v_cvt_pk_bf16_f32 v17, v104, v105
 v_mfma_f32_16x16x32_bf16 v[88:91], v[40:43], a[220:223], v[88:91]
 v_cvt_pk_bf16_f32 v18, v98, v99
 v_mfma_f32_16x16x32_bf16 v[68:71], a[4:7], v[44:47], v[68:71]
 v_cvt_pk_bf16_f32 v19, v106, v107
 v_mfma_f32_16x16x32_bf16 v[76:79], a[76:79], v[44:47], v[76:79]
 buffer_store_dwordx4 v[16:19], v12, s[20:23], s47 offen offset:0 sc1
 v_mfma_f32_16x16x32_bf16 v[84:87], v[44:47], a[148:151], v[84:87]
 v_cvt_pk_bf16_f32 v20, v100, v101
 v_mfma_f32_16x16x32_bf16 v[92:95], v[44:47], a[220:223], v[92:95]
 s_waitcnt lgkmcnt(2)
 v_mfma_f32_16x16x32_bf16 v[64:67], a[8:11], v[48:51], v[64:67]
 ds_read_b128 v[32:35], v6 offset:8192
 v_mfma_f32_16x16x32_bf16 v[72:75], a[80:83], v[48:51], v[72:75]
 ds_read_b128 v[36:39], v6 offset:10240
 v_mfma_f32_16x16x32_bf16 v[80:83], v[48:51], a[152:155], v[80:83]
 v_cvt_pk_bf16_f32 v21, v108, v109
 v_mfma_f32_16x16x32_bf16 v[88:91], v[48:51], a[224:227], v[88:91]
 v_cvt_pk_bf16_f32 v22, v102, v103
 v_mfma_f32_16x16x32_bf16 v[68:71], a[8:11], v[52:55], v[68:71]
 v_cvt_pk_bf16_f32 v23, v110, v111
 v_mfma_f32_16x16x32_bf16 v[76:79], a[80:83], v[52:55], v[76:79]
 buffer_store_dwordx4 v[20:23], v12, s[20:23], s47 offen offset:1024 sc1
 v_mfma_f32_16x16x32_bf16 v[84:87], v[52:55], a[152:155], v[84:87]
 v_cvt_pk_bf16_f32 v24, v112, v113
 v_mfma_f32_16x16x32_bf16 v[92:95], v[52:55], a[224:227], v[92:95]
 s_waitcnt lgkmcnt(2)
 v_mfma_f32_16x16x32_bf16 v[64:67], a[12:15], v[56:59], v[64:67]
 ds_read_b128 v[40:43], v7 offset:8192
 v_mfma_f32_16x16x32_bf16 v[72:75], a[84:87], v[56:59], v[72:75]
 ds_read_b128 v[44:47], v7 offset:10240
 v_mfma_f32_16x16x32_bf16 v[80:83], v[56:59], a[156:159], v[80:83]
 v_cvt_pk_bf16_f32 v25, v116, v117
 v_mfma_f32_16x16x32_bf16 v[88:91], v[56:59], a[228:231], v[88:91]
 v_cvt_pk_bf16_f32 v26, v114, v115
 v_mfma_f32_16x16x32_bf16 v[68:71], a[12:15], v[60:63], v[68:71]
 v_cvt_pk_bf16_f32 v27, v118, v119
 v_mfma_f32_16x16x32_bf16 v[76:79], a[84:87], v[60:63], v[76:79]
 buffer_store_dwordx4 v[24:27], v12, s[20:23], s48 offen offset:0 sc1
 v_mfma_f32_16x16x32_bf16 v[84:87], v[60:63], a[156:159], v[84:87]
 v_cvt_pk_bf16_f32 v28, v120, v121
 v_mfma_f32_16x16x32_bf16 v[92:95], v[60:63], a[228:231], v[92:95]
 s_waitcnt lgkmcnt(2)
 v_mfma_f32_16x16x32_bf16 v[64:67], a[16:19], v[32:35], v[64:67]
 ds_read_b128 v[48:51], v6 offset:12288
 v_mfma_f32_16x16x32_bf16 v[72:75], a[88:91], v[32:35], v[72:75]
 ds_read_b128 v[52:55], v6 offset:14336
 v_mfma_f32_16x16x32_bf16 v[80:83], v[32:35], a[160:163], v[80:83]
 v_cvt_pk_bf16_f32 v29, v124, v125
 v_mfma_f32_16x16x32_bf16 v[88:91], v[32:35], a[232:235], v[88:91]
 v_cvt_pk_bf16_f32 v30, v122, v123
 v_mfma_f32_16x16x32_bf16 v[68:71], a[16:19], v[36:39], v[68:71]
 v_cvt_pk_bf16_f32 v31, v126, v127
 v_mfma_f32_16x16x32_bf16 v[76:79], a[88:91], v[36:39], v[76:79]
 buffer_store_dwordx4 v[28:31], v12, s[20:23], s48 offen offset:1024 sc1
 v_mfma_f32_16x16x32_bf16 v[84:87], v[36:39], a[160:163], v[84:87]
 v_mfma_f32_16x16x32_bf16 v[92:95], v[36:39], a[232:235], v[92:95]
 s_waitcnt lgkmcnt(2)
 v_mfma_f32_16x16x32_bf16 v[64:67], a[20:23], v[40:43], v[64:67]
 ds_read_b128 v[56:59], v7 offset:12288
 v_mfma_f32_16x16x32_bf16 v[72:75], a[92:95], v[40:43], v[72:75]
 ds_read_b128 v[60:63], v7 offset:14336
 v_mfma_f32_16x16x32_bf16 v[80:83], v[40:43], a[164:167], v[80:83]
 s_add_u32 m0, s49, 0
 v_mfma_f32_16x16x32_bf16 v[88:91], v[40:43], a[236:239], v[88:91]
 buffer_load_dwordx4 v10, s[8:11], s46 offen offset:0  lds
 v_mfma_f32_16x16x32_bf16 v[68:71], a[20:23], v[44:47], v[68:71]
 s_add_u32 m0, s49, 3968
 v_mfma_f32_16x16x32_bf16 v[76:79], a[92:95], v[44:47], v[76:79]
 buffer_load_dwordx4 v10, s[8:11], s46 offen offset:128  lds
 v_mfma_f32_16x16x32_bf16 v[84:87], v[44:47], a[164:167], v[84:87]
 v_mfma_f32_16x16x32_bf16 v[92:95], v[44:47], a[236:239], v[92:95]
 s_waitcnt lgkmcnt(2)
 v_mfma_f32_16x16x32_bf16 v[64:67], a[24:27], v[48:51], v[64:67]
 ds_read_b128 v[32:35], v6 offset:16384
 v_mfma_f32_16x16x32_bf16 v[72:75], a[96:99], v[48:51], v[72:75]
 ds_read_b128 v[36:39], v6 offset:18432
 v_mfma_f32_16x16x32_bf16 v[80:83], v[48:51], a[168:171], v[80:83]
 s_add_u32 m0, s49, 7936
 v_mfma_f32_16x16x32_bf16 v[88:91], v[48:51], a[240:243], v[88:91]
 buffer_load_dwordx4 v10, s[8:11], s46 offen offset:256  lds
 v_mfma_f32_16x16x32_bf16 v[68:71], a[24:27], v[52:55], v[68:71]
 s_add_u32 m0, s49, 11904
 v_mfma_f32_16x16x32_bf16 v[76:79], a[96:99], v[52:55], v[76:79]
 buffer_load_dwordx4 v10, s[8:11], s46 offen offset:384  lds
 v_mfma_f32_16x16x32_bf16 v[84:87], v[52:55], a[168:171], v[84:87]
 v_mfma_f32_16x16x32_bf16 v[92:95], v[52:55], a[240:243], v[92:95]
 s_waitcnt lgkmcnt(2)
 v_mfma_f32_16x16x32_bf16 v[64:67], a[28:31], v[56:59], v[64:67]
 ds_read_b128 v[40:43], v7 offset:16384
 v_mfma_f32_16x16x32_bf16 v[72:75], a[100:103], v[56:59], v[72:75]
 ds_read_b128 v[44:47], v7 offset:18432
 v_mfma_f32_16x16x32_bf16 v[80:83], v[56:59], a[172:175], v[80:83]
 s_add_u32 m0, s49, 15872
 v_mfma_f32_16x16x32_bf16 v[88:91], v[56:59], a[244:247], v[88:91]
 buffer_load_dwordx4 v10, s[8:11], s46 offen offset:512  lds
 v_mfma_f32_16x16x32_bf16 v[68:71], a[28:31], v[60:63], v[68:71]
 s_add_u32 m0, s49, 19840
 v_mfma_f32_16x16x32_bf16 v[76:79], a[100:103], v[60:63], v[76:79]
 buffer_load_dwordx4 v10, s[8:11], s46 offen offset:640  lds
 v_mfma_f32_16x16x32_bf16 v[84:87], v[60:63], a[172:175], v[84:87]
 v_mfma_f32_16x16x32_bf16 v[92:95], v[60:63], a[244:247], v[92:95]
 s_waitcnt lgkmcnt(2)
 v_mfma_f32_16x16x32_bf16 v[64:67], a[32:35], v[32:35], v[64:67]
 ds_read_b128 v[48:51], v6 offset:20480
 v_mfma_f32_16x16x32_bf16 v[72:75], a[104:107], v[32:35], v[72:75]
 ds_read_b128 v[52:55], v6 offset:22528
 v_mfma_f32_16x16x32_bf16 v[80:83], v[32:35], a[176:179], v[80:83]
 s_add_u32 m0, s49, 23808
 v_mfma_f32_16x16x32_bf16 v[88:91], v[32:35], a[248:251], v[88:91]
 buffer_load_dwordx4 v10, s[8:11], s46 offen offset:768  lds
 v_mfma_f32_16x16x32_bf16 v[68:71], a[32:35], v[36:39], v[68:71]
 s_add_u32 m0, s49, 27776
 v_mfma_f32_16x16x32_bf16 v[76:79], a[104:107], v[36:39], v[76:79]
 buffer_load_dwordx4 v10, s[8:11], s46 offen offset:896  lds
 v_mfma_f32_16x16x32_bf16 v[84:87], v[36:39], a[176:179], v[84:87]
 v_mfma_f32_16x16x32_bf16 v[92:95], v[36:39], a[248:251], v[92:95]
 s_waitcnt lgkmcnt(2)
 v_mfma_f32_16x16x32_bf16 v[64:67], a[36:39], v[40:43], v[64:67]
 ds_read_b128 v[56:59], v7 offset:20480
 v_mfma_f32_16x16x32_bf16 v[72:75], a[108:111], v[40:43], v[72:75]
 ds_read_b128 v[60:63], v7 offset:22528
 v_mfma_f32_16x16x32_bf16 v[80:83], v[40:43], a[180:183], v[80:83]
 s_add_u32 m0, s49, 31744
 v_mfma_f32_16x16x32_bf16 v[88:91], v[40:43], a[252:255], v[88:91]
 buffer_load_dwordx4 v10, s[8:11], s46 offen offset:1024  lds
 v_mfma_f32_16x16x32_bf16 v[68:71], a[36:39], v[44:47], v[68:71]
 v_mfma_f32_16x16x32_bf16 v[76:79], a[108:111], v[44:47], v[76:79]
 v_mfma_f32_16x16x32_bf16 v[84:87], v[44:47], a[180:183], v[84:87]
 v_mfma_f32_16x16x32_bf16 v[92:95], v[44:47], a[252:255], v[92:95]
 s_waitcnt lgkmcnt(2)
 v_mfma_f32_16x16x32_bf16 v[64:67], a[40:43], v[48:51], v[64:67]
 ds_read_b128 v[32:35], v6 offset:24576
 v_mfma_f32_16x16x32_bf16 v[72:75], a[112:115], v[48:51], v[72:75]
 ds_read_b128 v[36:39], v6 offset:26624
 v_mfma_f32_16x16x32_bf16 v[80:83], v[48:51], a[184:187], v[80:83]
 v_mfma_f32_16x16x32_bf16 v[88:91], v[48:51], v[224:227], v[88:91]
 v_mfma_f32_16x16x32_bf16 v[68:71], a[40:43], v[52:55], v[68:71]
 v_mfma_f32_16x16x32_bf16 v[76:79], a[112:115], v[52:55], v[76:79]
 v_mfma_f32_16x16x32_bf16 v[84:87], v[52:55], a[184:187], v[84:87]
 v_mfma_f32_16x16x32_bf16 v[92:95], v[52:55], v[224:227], v[92:95]
 s_waitcnt lgkmcnt(2)
 v_mfma_f32_16x16x32_bf16 v[64:67], a[44:47], v[56:59], v[64:67]
 ds_read_b128 v[40:43], v7 offset:24576
 v_mfma_f32_16x16x32_bf16 v[72:75], a[116:119], v[56:59], v[72:75]
 ds_read_b128 v[44:47], v7 offset:26624
 v_mfma_f32_16x16x32_bf16 v[80:83], v[56:59], a[188:191], v[80:83]
 v_mfma_f32_16x16x32_bf16 v[88:91], v[56:59], v[228:231], v[88:91]
 v_mfma_f32_16x16x32_bf16 v[68:71], a[44:47], v[60:63], v[68:71]
 v_mfma_f32_16x16x32_bf16 v[76:79], a[116:119], v[60:63], v[76:79]
 v_mfma_f32_16x16x32_bf16 v[84:87], v[60:63], a[188:191], v[84:87]
 v_mfma_f32_16x16x32_bf16 v[92:95], v[60:63], v[228:231], v[92:95]
 s_waitcnt lgkmcnt(2)
 v_mfma_f32_16x16x32_bf16 v[64:67], a[48:51], v[32:35], v[64:67]
 ds_read_b128 v[48:51], v6 offset:28672
 v_mfma_f32_16x16x32_bf16 v[72:75], a[120:123], v[32:35], v[72:75]
 ds_read_b128 v[52:55], v6 offset:30720
 v_mfma_f32_16x16x32_bf16 v[80:83], v[32:35], a[192:195], v[80:83]
 v_mfma_f32_16x16x32_bf16 v[88:91], v[32:35], v[232:235], v[88:91]
 v_mfma_f32_16x16x32_bf16 v[68:71], a[48:51], v[36:39], v[68:71]
 v_mfma_f32_16x16x32_bf16 v[76:79], a[120:123], v[36:39], v[76:79]
 v_mfma_f32_16x16x32_bf16 v[84:87], v[36:39], a[192:195], v[84:87]
 v_mfma_f32_16x16x32_bf16 v[92:95], v[36:39], v[232:235], v[92:95]
 s_waitcnt lgkmcnt(2)
 v_mfma_f32_16x16x32_bf16 v[64:67], a[52:55], v[40:43], v[64:67]
 ds_read_b128 v[56:59], v7 offset:28672
 v_mfma_f32_16x16x32_bf16 v[72:75], a[124:127], v[40:43], v[72:75]
 ds_read_b128 v[60:63], v7 offset:30720
 v_mfma_f32_16x16x32_bf16 v[80:83], v[40:43], a[196:199], v[80:83]
 s_add_u32 s43, s43, 36864
 s_cmp_eq_u32 s43, 147456
 v_mfma_f32_16x16x32_bf16 v[88:91], v[40:43], v[236:239], v[88:91]
 s_cselect_b32 s43, 0, s43
 s_add_u32 s44, s44, 36864
 v_mfma_f32_16x16x32_bf16 v[68:71], a[52:55], v[44:47], v[68:71]
 s_cmp_eq_u32 s44, 147456
 s_cselect_b32 s44, 0, s44
 v_mfma_f32_16x16x32_bf16 v[76:79], a[124:127], v[44:47], v[76:79]
 v_mfma_f32_16x16x32_bf16 v[84:87], v[44:47], a[196:199], v[84:87]
 v_mfma_f32_16x16x32_bf16 v[92:95], v[44:47], v[236:239], v[92:95]
 s_waitcnt lgkmcnt(2)
 v_mfma_f32_16x16x32_bf16 v[64:67], a[56:59], v[48:51], v[64:67]
 ds_read_b128 v[32:35], v6 offset:32768
 v_mfma_f32_16x16x32_bf16 v[72:75], a[128:131], v[48:51], v[72:75]
 ds_read_b128 v[36:39], v6 offset:34816
 v_mfma_f32_16x16x32_bf16 v[80:83], v[48:51], a[200:203], v[80:83]
 v_add_u32 v6, s43, v4
 v_mfma_f32_16x16x32_bf16 v[88:91], v[48:51], v[240:243], v[88:91]
 v_mfma_f32_16x16x32_bf16 v[68:71], a[56:59], v[52:55], v[68:71]
 v_mfma_f32_16x16x32_bf16 v[76:79], a[128:131], v[52:55], v[76:79]
 v_mfma_f32_16x16x32_bf16 v[84:87], v[52:55], a[200:203], v[84:87]
 v_mfma_f32_16x16x32_bf16 v[92:95], v[52:55], v[240:243], v[92:95]
 s_waitcnt lgkmcnt(2)
 v_mfma_f32_16x16x32_bf16 v[64:67], a[60:63], v[56:59], v[64:67]
 ds_read_b128 v[40:43], v7 offset:32768
 v_mfma_f32_16x16x32_bf16 v[72:75], a[132:135], v[56:59], v[72:75]
 ds_read_b128 v[44:47], v7 offset:34816
 v_mfma_f32_16x16x32_bf16 v[80:83], v[56:59], a[204:207], v[80:83]
 v_add_u32 v7, s43, v5
 v_mfma_f32_16x16x32_bf16 v[88:91], v[56:59], v[244:247], v[88:91]
 v_mfma_f32_16x16x32_bf16 v[68:71], a[60:63], v[60:63], v[68:71]
 v_mfma_f32_16x16x32_bf16 v[76:79], a[132:135], v[60:63], v[76:79]
 v_mfma_f32_16x16x32_bf16 v[84:87], v[60:63], a[204:207], v[84:87]
 v_mfma_f32_16x16x32_bf16 v[92:95], v[60:63], v[244:247], v[92:95]
 s_waitcnt lgkmcnt(2)
 v_mfma_f32_16x16x32_bf16 v[64:67], a[64:67], v[32:35], v[64:67]
 s_waitcnt vmcnt(9)
 s_barrier
 ds_read_b128 v[48:51], v6 offset:0
 v_mfma_f32_16x16x32_bf16 v[72:75], a[136:139], v[32:35], v[72:75]
 ds_read_b128 v[52:55], v6 offset:2048
 v_mfma_f32_16x16x32_bf16 v[80:83], v[32:35], a[208:211], v[80:83]
 buffer_store_dword v14, v13, s[20:23], 0 offen sc1
 v_mfma_f32_16x16x32_bf16 v[88:91], v[32:35], v[248:251], v[88:91]
 v_mfma_f32_16x16x32_bf16 v[68:71], a[64:67], v[36:39], v[68:71]
 v_mfma_f32_16x16x32_bf16 v[76:79], a[136:139], v[36:39], v[76:79]
 v_mfma_f32_16x16x32_bf16 v[84:87], v[36:39], a[208:211], v[84:87]
 v_mfma_f32_16x16x32_bf16 v[92:95], v[36:39], v[248:251], v[92:95]
 s_waitcnt lgkmcnt(2)
 v_mfma_f32_16x16x32_bf16 v[64:67], a[68:71], v[40:43], v[64:67]
 ds_read_b128 v[56:59], v7 offset:0
 v_mfma_f32_16x16x32_bf16 v[72:75], a[140:143], v[40:43], v[72:75]
 ds_read_b128 v[60:63], v7 offset:2048
 v_mfma_f32_16x16x32_bf16 v[80:83], v[40:43], a[212:215], v[80:83]
 s_mul_i32 s45, s39, 524288
 s_add_u32 s47, s34, s45
 v_mfma_f32_16x16x32_bf16 v[88:91], v[40:43], v[252:255], v[88:91]
 s_add_u32 s48, s35, s45
 v_add_u32 v14, 1, v14
 v_mfma_f32_16x16x32_bf16 v[68:71], a[68:71], v[44:47], v[68:71]
 s_mov_b32 s39, s40
 s_mov_b32 s40, s41
 v_mfma_f32_16x16x32_bf16 v[76:79], a[140:143], v[44:47], v[76:79]
 s_add_u32 s42, s42, 1
 v_mfma_f32_16x16x32_bf16 v[84:87], v[44:47], a[212:215], v[84:87]
 v_mfma_f32_16x16x32_bf16 v[92:95], v[44:47], v[252:255], v[92:95]
 s_waitcnt lgkmcnt(2)
 v_mfma_f32_16x16x32_bf16 v[96:99], a[0:3], v[48:51], 0
 ds_read_b128 v[32:35], v6 offset:4096
 v_mfma_f32_16x16x32_bf16 v[104:107], a[72:75], v[48:51], 0
 ds_read_b128 v[36:39], v6 offset:6144
 v_mfma_f32_16x16x32_bf16 v[112:115], v[48:51], a[144:147], 0
 s_add_u32 s41, s40, 1
 v_mfma_f32_16x16x32_bf16 v[120:123], v[48:51], a[216:219], 0
 s_add_u32 s45, s42, 2
 s_mul_i32 s46, s41, 36864
 v_mfma_f32_16x16x32_bf16 v[100:103], a[0:3], v[52:55], 0
 s_cmp_lt_u32 s45, s36
 s_cselect_b32 s46, s46, 0
 v_mfma_f32_16x16x32_bf16 v[108:111], a[72:75], v[52:55], 0
 s_lshl_b32 s49, s4, 10
 s_add_u32 s49, s49, s44
 v_mfma_f32_16x16x32_bf16 v[116:119], v[52:55], a[144:147], 0
 v_cvt_pk_bf16_f32 v16, v64, v65
 v_mfma_f32_16x16x32_bf16 v[124:127], v[52:55], a[216:219], 0
 s_waitcnt lgkmcnt(2)
 v_mfma_f32_16x16x32_bf16 v[96:99], a[4:7], v[56:59], v[96:99]
 ds_read_b128 v[40:43], v7 offset:4096
 v_mfma_f32_16x16x32_bf16 v[104:107], a[76:79], v[56:59], v[104:107]
 ds_read_b128 v[44:47], v7 offset:6144
 v_mfma_f32_16x16x32_bf16 v[112:115], v[56:59], a[148:151], v[112:115]
 v_cvt_pk_bf16_f32 v17, v72, v73
 v_mfma_f32_16x16x32_bf16 v[120:123], v[56:59], a[220:223], v[120:123]
 v_cvt_pk_bf16_f32 v18, v66, v67
 v_mfma_f32_16x16x32_bf16 v[100:103], a[4:7], v[60:63], v[100:103]
 v_cvt_pk_bf16_f32 v19, v74, v75
 v_mfma_f32_16x16x32_bf16 v[108:111], a[76:79], v[60:63], v[108:111]
 buffer_store_dwordx4 v[16:19], v12, s[20:23], s47 offen offset:0 sc1
 v_mfma_f32_16x16x32_bf16 v[116:119], v[60:63], a[148:151], v[116:119]
 v_cvt_pk_bf16_f32 v20, v68, v69
 v_mfma_f32_16x16x32_bf16 v[124:127], v[60:63], a[220:223], v[124:127]
 s_waitcnt lgkmcnt(2)
 v_mfma_f32_16x16x32_bf16 v[96:99], a[8:11], v[32:35], v[96:99]
 ds_read_b128 v[48:51], v6 offset:8192
 v_mfma_f32_16x16x32_bf16 v[104:107], a[80:83], v[32:35], v[104:107]
 ds_read_b128 v[52:55], v6 offset:10240
 v_mfma_f32_16x16x32_bf16 v[112:115], v[32:35], a[152:155], v[112:115]
 v_cvt_pk_bf16_f32 v21, v76, v77
 v_mfma_f32_16x16x32_bf16 v[120:123], v[32:35], a[224:227], v[120:123]
 v_cvt_pk_bf16_f32 v22, v70, v71
 v_mfma_f32_16x16x32_bf16 v[100:103], a[8:11], v[36:39], v[100:103]
 v_cvt_pk_bf16_f32 v23, v78, v79
 v_mfma_f32_16x16x32_bf16 v[108:111], a[80:83], v[36:39], v[108:111]
 buffer_store_dwordx4 v[20:23], v12, s[20:23], s47 offen offset:1024 sc1
 v_mfma_f32_16x16x32_bf16 v[116:119], v[36:39], a[152:155], v[116:119]
 v_cvt_pk_bf16_f32 v24, v80, v81
 v_mfma_f32_16x16x32_bf16 v[124:127], v[36:39], a[224:227], v[124:127]
 s_waitcnt lgkmcnt(2)
 v_mfma_f32_16x16x32_bf16 v[96:99], a[12:15], v[40:43], v[96:99]
 ds_read_b128 v[56:59], v7 offset:8192
 v_mfma_f32_16x16x32_bf16 v[104:107], a[84:87], v[40:43], v[104:107]
 ds_read_b128 v[60:63], v7 offset:10240
 v_mfma_f32_16x16x32_bf16 v[112:115], v[40:43], a[156:159], v[112:115]
 v_cvt_pk_bf16_f32 v25, v84, v85
 v_mfma_f32_16x16x32_bf16 v[120:123], v[40:43], a[228:231], v[120:123]
 v_cvt_pk_bf16_f32 v26, v82, v83
 v_mfma_f32_16x16x32_bf16 v[100:103], a[12:15], v[44:47], v[100:103]
 v_cvt_pk_bf16_f32 v27, v86, v87
 v_mfma_f32_16x16x32_bf16 v[108:111], a[84:87], v[44:47], v[108:111]
 buffer_store_dwordx4 v[24:27], v12, s[20:23], s48 offen offset:0 sc1
 v_mfma_f32_16x16x32_bf16 v[116:119], v[44:47], a[156:159], v[116:119]
 v_cvt_pk_bf16_f32 v28, v88, v89
 v_mfma_f32_16x16x32_bf16 v[124:127], v[44:47], a[228:231], v[124:127]
 s_waitcnt lgkmcnt(2)
 v_mfma_f32_16x16x32_bf16 v[96:99], a[16:19], v[48:51], v[96:99]
 ds_read_b128 v[32:35], v6 offset:12288
 v_mfma_f32_16x16x32_bf16 v[104:107], a[88:91], v[48:51], v[104:107]
 ds_read_b128 v[36:39], v6 offset:14336
 v_mfma_f32_16x16x32_bf16 v[112:115], v[48:51], a[160:163], v[112:115]
 v_cvt_pk_bf16_f32 v29, v92, v93
 v_mfma_f32_16x16x32_bf16 v[120:123], v[48:51], a[232:235], v[120:123]
 v_cvt_pk_bf16_f32 v30, v90, v91
 v_mfma_f32_16x16x32_bf16 v[100:103], a[16:19], v[52:55], v[100:103]
 v_cvt_pk_bf16_f32 v31, v94, v95
 v_mfma_f32_16x16x32_bf16 v[108:111], a[88:91], v[52:55], v[108:111]
 buffer_store_dwordx4 v[28:31], v12, s[20:23], s48 offen offset:1024 sc1
 v_mfma_f32_16x16x32_bf16 v[116:119], v[52:55], a[160:163], v[116:119]
 v_mfma_f32_16x16x32_bf16 v[124:127], v[52:55], a[232:235], v[124:127]
 s_waitcnt lgkmcnt(2)
 v_mfma_f32_16x16x32_bf16 v[96:99], a[20:23], v[56:59], v[96:99]
 ds_read_b128 v[40:43], v7 offset:12288
 v_mfma_f32_16x16x32_bf16 v[104:107], a[92:95], v[56:59], v[104:107]
 ds_read_b128 v[44:47], v7 offset:14336
 v_mfma_f32_16x16x32_bf16 v[112:115], v[56:59], a[164:167], v[112:115]
 s_add_u32 m0, s49, 0
 v_mfma_f32_16x16x32_bf16 v[120:123], v[56:59], a[236:239], v[120:123]
 buffer_load_dwordx4 v10, s[8:11], s46 offen offset:0  lds
 v_mfma_f32_16x16x32_bf16 v[100:103], a[20:23], v[60:63], v[100:103]
 s_add_u32 m0, s49, 3968
 v_mfma_f32_16x16x32_bf16 v[108:111], a[92:95], v[60:63], v[108:111]
 buffer_load_dwordx4 v10, s[8:11], s46 offen offset:128  lds
 v_mfma_f32_16x16x32_bf16 v[116:119], v[60:63], a[164:167], v[116:119]
 v_mfma_f32_16x16x32_bf16 v[124:127], v[60:63], a[236:239], v[124:127]
 s_waitcnt lgkmcnt(2)
 v_mfma_f32_16x16x32_bf16 v[96:99], a[24:27], v[32:35], v[96:99]
 ds_read_b128 v[48:51], v6 offset:16384
 v_mfma_f32_16x16x32_bf16 v[104:107], a[96:99], v[32:35], v[104:107]
 ds_read_b128 v[52:55], v6 offset:18432
 v_mfma_f32_16x16x32_bf16 v[112:115], v[32:35], a[168:171], v[112:115]
 s_add_u32 m0, s49, 7936
 v_mfma_f32_16x16x32_bf16 v[120:123], v[32:35], a[240:243], v[120:123]
 buffer_load_dwordx4 v10, s[8:11], s46 offen offset:256  lds
 v_mfma_f32_16x16x32_bf16 v[100:103], a[24:27], v[36:39], v[100:103]
 s_add_u32 m0, s49, 11904
 v_mfma_f32_16x16x32_bf16 v[108:111], a[96:99], v[36:39], v[108:111]
 buffer_load_dwordx4 v10, s[8:11], s46 offen offset:384  lds
 v_mfma_f32_16x16x32_bf16 v[116:119], v[36:39], a[168:171], v[116:119]
 v_mfma_f32_16x16x32_bf16 v[124:127], v[36:39], a[240:243], v[124:127]
 s_waitcnt lgkmcnt(2)
 v_mfma_f32_16x16x32_bf16 v[96:99], a[28:31], v[40:43], v[96:99]
 ds_read_b128 v[56:59], v7 offset:16384
 v_mfma_f32_16x16x32_bf16 v[104:107], a[100:103], v[40:43], v[104:107]
 ds_read_b128 v[60:63], v7 offset:18432
 v_mfma_f32_16x16x32_bf16 v[112:115], v[40:43], a[172:175], v[112:115]
 s_add_u32 m0, s49, 15872
 v_mfma_f32_16x16x32_bf16 v[120:123], v[40:43], a[244:247], v[120:123]
 buffer_load_dwordx4 v10, s[8:11], s46 offen offset:512  lds
 v_mfma_f32_16x16x32_bf16 v[100:103], a[28:31], v[44:47], v[100:103]
 s_add_u32 m0, s49, 19840
 v_mfma_f32_16x16x32_bf16 v[108:111], a[100:103], v[44:47], v[108:111]
 buffer_load_dwordx4 v10, s[8:11], s46 offen offset:640  lds
 v_mfma_f32_16x16x32_bf16 v[116:119], v[44:47], a[172:175], v[116:119]
 v_mfma_f32_16x16x32_bf16 v[124:127], v[44:47], a[244:247], v[124:127]
 s_waitcnt lgkmcnt(2)
 v_mfma_f32_16x16x32_bf16 v[96:99], a[32:35], v[48:51], v[96:99]
 ds_read_b128 v[32:35], v6 offset:20480
 v_mfma_f32_16x16x32_bf16 v[104:107], a[104:107], v[48:51], v[104:107]
 ds_read_b128 v[36:39], v6 offset:22528
 v_mfma_f32_16x16x32_bf16 v[112:115], v[48:51], a[176:179], v[112:115]
 s_add_u32 m0, s49, 23808
 v_mfma_f32_16x16x32_bf16 v[120:123], v[48:51], a[248:251], v[120:123]
 buffer_load_dwordx4 v10, s[8:11], s46 offen offset:768  lds
 v_mfma_f32_16x16x32_bf16 v[100:103], a[32:35], v[52:55], v[100:103]
 s_add_u32 m0, s49, 27776
 v_mfma_f32_16x16x32_bf16 v[108:111], a[104:107], v[52:55], v[108:111]
 buffer_load_dwordx4 v10, s[8:11], s46 offen offset:896  lds
 v_mfma_f32_16x16x32_bf16 v[116:119], v[52:55], a[176:179], v[116:119]
 v_mfma_f32_16x16x32_bf16 v[124:127], v[52:55], a[248:251], v[124:127]
 s_waitcnt lgkmcnt(2)
 v_mfma_f32_16x16x32_bf16 v[96:99], a[36:39], v[56:59], v[96:99]
 ds_read_b128 v[40:43], v7 offset:20480
 v_mfma_f32_16x16x32_bf16 v[104:107], a[108:111], v[56:59], v[104:107]
 ds_read_b128 v[44:47], v7 offset:22528
 v_mfma_f32_16x16x32_bf16 v[112:115], v[56:59], a[180:183], v[112:115]
 s_add_u32 m0, s49, 31744
 v_mfma_f32_16x16x32_bf16 v[120:123], v[56:59], a[252:255], v[120:123]
 buffer_load_dwordx4 v10, s[8:11], s46 offen offset:1024  lds
 v_mfma_f32_16x16x32_bf16 v[100:103], a[36:39], v[60:63], v[100:103]
 v_mfma_f32_16x16x32_bf16 v[108:111], a[108:111], v[60:63], v[108:111]
 v_mfma_f32_16x16x32_bf16 v[116:119], v[60:63], a[180:183], v[116:119]
 v_mfma_f32_16x16x32_bf16 v[124:127], v[60:63], a[252:255], v[124:127]
 s_waitcnt lgkmcnt(2)
 v_mfma_f32_16x16x32_bf16 v[96:99], a[40:43], v[32:35], v[96:99]
 ds_read_b128 v[48:51], v6 offset:24576
 v_mfma_f32_16x16x32_bf16 v[104:107], a[112:115], v[32:35], v[104:107]
 ds_read_b128 v[52:55], v6 offset:26624
 v_mfma_f32_16x16x32_bf16 v[112:115], v[32:35], a[184:187], v[112:115]
 v_mfma_f32_16x16x32_bf16 v[120:123], v[32:35], v[224:227], v[120:123]
 v_mfma_f32_16x16x32_bf16 v[100:103], a[40:43], v[36:39], v[100:103]
 v_mfma_f32_16x16x32_bf16 v[108:111], a[112:115], v[36:39], v[108:111]
 v_mfma_f32_16x16x32_bf16 v[116:119], v[36:39], a[184:187], v[116:119]
 v_mfma_f32_16x16x32_bf16 v[124:127], v[36:39], v[224:227], v[124:127]
 s_waitcnt lgkmcnt(2)
 v_mfma_f32_16x16x32_bf16 v[96:99], a[44:47], v[40:43], v[96:99]
 ds_read_b128 v[56:59], v7 offset:24576
 v_mfma_f32_16x16x32_bf16 v[104:107], a[116:119], v[40:43], v[104:107]
 ds_read_b128 v[60:63], v7 offset:26624
 v_mfma_f32_16x16x32_bf16 v[112:115], v[40:43], a[188:191], v[112:115]
 v_mfma_f32_16x16x32_bf16 v[120:123], v[40:43], v[228:231], v[120:123]
 v_mfma_f32_16x16x32_bf16 v[100:103], a[44:47], v[44:47], v[100:103]
 v_mfma_f32_16x16x32_bf16 v[108:111], a[116:119], v[44:47], v[108:111]
 v_mfma_f32_16x16x32_bf16 v[116:119], v[44:47], a[188:191], v[116:119]
 v_mfma_f32_16x16x32_bf16 v[124:127], v[44:47], v[228:231], v[124:127]
 s_waitcnt lgkmcnt(2)
 v_mfma_f32_16x16x32_bf16 v[96:99], a[48:51], v[48:51], v[96:99]
 ds_read_b128 v[32:35], v6 offset:28672
 v_mfma_f32_16x16x32_bf16 v[104:107], a[120:123], v[48:51], v[104:107]
 ds_read_b128 v[36:39], v6 offset:30720
 v_mfma_f32_16x16x32_bf16 v[112:115], v[48:51], a[192:195], v[112:115]
 v_mfma_f32_16x16x32_bf16 v[120:123], v[48:51], v[232:235], v[120:123]
 v_mfma_f32_16x16x32_bf16 v[100:103], a[48:51], v[52:55], v[100:103]
 v_mfma_f32_16x16x32_bf16 v[108:111], a[120:123], v[52:55], v[108:111]
 v_mfma_f32_16x16x32_bf16 v[116:119], v[52:55], a[192:195], v[116:119]
 v_mfma_f32_16x16x32_bf16 v[124:127], v[52:55], v[232:235], v[124:127]
 s_waitcnt lgkmcnt(2)
 v_mfma_f32_16x16x32_bf16 v[96:99], a[52:55], v[56:59], v[96:99]
 ds_read_b128 v[40:43], v7 offset:28672
 v_mfma_f32_16x16x32_bf16 v[104:107], a[124:127], v[56:59], v[104:107]
 ds_read_b128 v[44:47], v7 offset:30720
 v_mfma_f32_16x16x32_bf16 v[112:115], v[56:59], a[196:199], v[112:115]
 s_add_u32 s43, s43, 36864
 s_cmp_eq_u32 s43, 147456
 v_mfma_f32_16x16x32_bf16 v[120:123], v[56:59], v[236:239], v[120:123]
 s_cselect_b32 s43, 0, s43
 s_add_u32 s44, s44, 36864
 v_mfma_f32_16x16x32_bf16 v[100:103], a[52:55], v[60:63], v[100:103]
 s_cmp_eq_u32 s44, 147456
 s_cselect_b32 s44, 0, s44
 v_mfma_f32_16x16x32_bf16 v[108:111], a[124:127], v[60:63], v[108:111]
 v_mfma_f32_16x16x32_bf16 v[116:119], v[60:63], a[196:199], v[116:119]
 v_mfma_f32_16x16x32_bf16 v[124:127], v[60:63], v[236:239], v[124:127]
 s_waitcnt lgkmcnt(2)
 v_mfma_f32_16x16x32_bf16 v[96:99], a[56:59], v[32:35], v[96:99]
 ds_read_b128 v[48:51], v6 offset:32768
 v_mfma_f32_16x16x32_bf16 v[104:107], a[128:131], v[32:35], v[104:107]
 ds_read_b128 v[52:55], v6 offset:34816
 v_mfma_f32_16x16x32_bf16 v[112:115], v[32:35], a[200:203], v[112:115]
 v_add_u32 v6, s43, v4
 v_mfma_f32_16x16x32_bf16 v[120:123], v[32:35], v[240:243], v[120:123]
 v_mfma_f32_16x16x32_bf16 v[100:103], a[56:59], v[36:39], v[100:103]
 v_mfma_f32_16x16x32_bf16 v[108:111], a[128:131], v[36:39], v[108:111]
 v_mfma_f32_16x16x32_bf16 v[116:119], v[36:39], a[200:203], v[116:119]
 v_mfma_f32_16x16x32_bf16 v[124:127], v[36:39], v[240:243], v[124:127]
 s_waitcnt lgkmcnt(2)
 v_mfma_f32_16x16x32_bf16 v[96:99], a[60:63], v[40:43], v[96:99]
 ds_read_b128 v[56:59], v7 offset:32768
 v_mfma_f32_16x16x32_bf16 v[104:107], a[132:135], v[40:43], v[104:107]
 ds_read_b128 v[60:63], v7 offset:34816
 v_mfma_f32_16x16x32_bf16 v[112:115], v[40:43], a[204:207], v[112:115]
 v_add_u32 v7, s43, v5
 v_mfma_f32_16x16x32_bf16 v[120:123], v[40:43], v[244:247], v[120:123]
 v_mfma_f32_16x16x32_bf16 v[100:103], a[60:63], v[44:47], v[100:103]
 v_mfma_f32_16x16x32_bf16 v[108:111], a[132:135], v[44:47], v[108:111]
 v_mfma_f32_16x16x32_bf16 v[116:119], v[44:47], a[204:207], v[116:119]
 v_mfma_f32_16x16x32_bf16 v[124:127], v[44:47], v[244:247], v[124:127]
 s_waitcnt lgkmcnt(2)
 v_mfma_f32_16x16x32_bf16 v[96:99], a[64:67], v[48:51], v[96:99]
 s_waitcnt vmcnt(9)
 s_barrier
 ds_read_b128 v[32:35], v6 offset:0
 v_mfma_f32_16x16x32_bf16 v[104:107], a[136:139], v[48:51], v[104:107]
 ds_read_b128 v[36:39], v6 offset:2048
 v_mfma_f32_16x16x32_bf16 v[112:115], v[48:51], a[208:211], v[112:115]
 buffer_store_dword v14, v13, s[20:23], 0 offen sc1
 v_mfma_f32_16x16x32_bf16 v[120:123], v[48:51], v[248:251], v[120:123]
 v_mfma_f32_16x16x32_bf16 v[100:103], a[64:67], v[52:55], v[100:103]
 v_mfma_f32_16x16x32_bf16 v[108:111], a[136:139], v[52:55], v[108:111]
 v_mfma_f32_16x16x32_bf16 v[116:119], v[52:55], a[208:211], v[116:119]
 v_mfma_f32_16x16x32_bf16 v[124:127], v[52:55], v[248:251], v[124:127]
 s_waitcnt lgkmcnt(2)
 v_mfma_f32_16x16x32_bf16 v[96:99], a[68:71], v[56:59], v[96:99]
 ds_read_b128 v[40:43], v7 offset:0
 v_mfma_f32_16x16x32_bf16 v[104:107], a[140:143], v[56:59], v[104:107]
 ds_read_b128 v[44:47], v7 offset:2048
 v_mfma_f32_16x16x32_bf16 v[112:115], v[56:59], a[212:215], v[112:115]
 s_mul_i32 s45, s39, 524288
 s_add_u32 s47, s34, s45
 v_mfma_f32_16x16x32_bf16 v[120:123], v[56:59], v[252:255], v[120:123]
 s_add_u32 s48, s35, s45
 v_add_u32 v14, 1, v14
 v_mfma_f32_16x16x32_bf16 v[100:103], a[68:71], v[60:63], v[100:103]
 s_mov_b32 s39, s40
 s_mov_b32 s40, s41
 v_mfma_f32_16x16x32_bf16 v[108:111], a[140:143], v[60:63], v[108:111]
 s_add_u32 s42, s42, 1
 s_cmp_lt_u32 s42, s36
 v_mfma_f32_16x16x32_bf16 v[116:119], v[60:63], a[212:215], v[116:119]
 v_mfma_f32_16x16x32_bf16 v[124:127], v[60:63], v[252:255], v[124:127]
 s_waitcnt lgkmcnt(2)
 s_cbranch_scc1 Lps_loop_18
 s_nop 7
 v_cvt_pk_bf16_f32 v16, v96, v97
 v_cvt_pk_bf16_f32 v17, v104, v105
 v_cvt_pk_bf16_f32 v18, v98, v99
 v_cvt_pk_bf16_f32 v19, v106, v107
 buffer_store_dwordx4 v[16:19], v12, s[20:23], s47 offen offset:0 sc1
 v_cvt_pk_bf16_f32 v20, v100, v101
 v_cvt_pk_bf16_f32 v21, v108, v109
 v_cvt_pk_bf16_f32 v22, v102, v103
 v_cvt_pk_bf16_f32 v23, v110, v111
 buffer_store_dwordx4 v[20:23], v12, s[20:23], s47 offen offset:1024 sc1
 v_cvt_pk_bf16_f32 v24, v112, v113
 v_cvt_pk_bf16_f32 v25, v116, v117
 v_cvt_pk_bf16_f32 v26, v114, v115
 v_cvt_pk_bf16_f32 v27, v118, v119
 buffer_store_dwordx4 v[24:27], v12, s[20:23], s48 offen offset:0 sc1
 v_cvt_pk_bf16_f32 v28, v120, v121
 v_cvt_pk_bf16_f32 v29, v124, v125
 v_cvt_pk_bf16_f32 v30, v122, v123
 v_cvt_pk_bf16_f32 v31, v126, v127
 buffer_store_dwordx4 v[28:31], v12, s[20:23], s48 offen offset:1024 sc1
 s_waitcnt vmcnt(0) lgkmcnt(0)
 s_barrier
 v_mov_b32 v14, s36
 buffer_store_dword v14, v13, s[20:23], 0 offen sc1
 s_branch Lfin
Lqa:
 s_load_dwordx2 s[8:9], s[0:1], 0
 s_mov_b32 s10, 0x240000
 s_mov_b32 s11, 0x20000
 s_load_dwordx2 s[12:13], s[0:1], 16
 s_mov_b32 s14, 0x480000
 s_mov_b32 s15, 0x20000
 s_load_dwordx2 s[16:17], s[0:1], 16
 s_mov_b32 s18, 0x480000
 s_mov_b32 s19, 0x20000
 s_cmp_eq_u32 s2, 255
 s_cbranch_scc0 Lqa1
 v_mov_b32 v4, 0
 v_mov_b32 v5, 0
 v_mov_b32 v6, 0
 v_mov_b32 v7, 0
 v_lshlrev_b32 v1, 4, v0
 s_mov_b32 s7, 0
 buffer_store_dwordx4 v[4:7], v1, s[20:23], s7 offen sc1
 s_mov_b32 s7, 4096
 buffer_store_dwordx4 v[4:7], v1, s[20:23], s7 offen sc1
 s_mov_b32 s7, 8192
 buffer_store_dwordx4 v[4:7], v1, s[20:23], s7 offen sc1
 s_mov_b32 s7, 12288
 buffer_store_dwordx4 v[4:7], v1, s[20:23], s7 offen sc1
 s_mov_b32 s7, 16384
 buffer_store_dwordx4 v[4:7], v1, s[20:23], s7 offen sc1
 v_min_u32 v1, 1, v0
 v_lshlrev_b32 v1, 28, v1
 v_mov_b32 v2, 1
 s_waitcnt vmcnt(0)
 s_barrier
 buffer_store_dword v2, v1, s[28:31], 0 offen sc1
Lqa1:
 s_sub_u32 s3, s5, 2
 s_lshl_b32 s3, s3, 3
 s_lshr_b32 s7, s6, 2
 s_add_u32 s3, s3, s7
 s_lshl_b32 s32, s3, 9
 s_add_u32 s33, s32, 256
 s_lshl_b32 s34, s3, 14
 s_add_u32 s34, s34, 0x5000000
 s_add_u32 s35, s34, 8192
 s_mov_b32 s36, 16
 s_and_b32 s37, s6, 3
 s_lshl_b32 s7, s3, 5
 s_add_u32 s7, s7, s37
 s_lshl_b32 s7, s7, 2
 s_add_u32 s7, s7, 0x3000
 v_min_u32 v1, 1, v0
 v_lshlrev_b32 v1, 28, v1
 v_add_u32 v13, s7, v1
 s_waitcnt lgkmcnt(0)
 v_and_b32 v1, 63, v0
 v_lshrrev_b32 v2, 3, v0
 v_mul_u32_u24 v10, 1152, v2
 v_lshrrev_b32 v2, 4, v0
 v_xor_b32 v2, v2, v0
 v_and_b32 v2, 7, v2
 v_lshl_add_u32 v10, v2, 4, v10
 v_lshrrev_b32 v2, 4, v1
 v_bfe_u32 v3, v1, 1, 3
 v_xor_b32 v2, v2, v3
 v_and_b32 v3, 15, v1
 v_lshlrev_b32 v3, 7, v3
 v_lshl_add_u32 v4, v2, 4, v3
 v_xor_b32 v5, 64, v4
 v_lshrrev_b32 v2, 4, v0
 v_lshlrev_b32 v11, 13, v2
 v_lshrrev_b32 v2, 7, v0
 v_lshrrev_b32 v3, 4, v1
 v_lshl_add_u32 v3, v2, 2, v3
 v_bfe_u32 v2, v1, 1, 3
 v_xor_b32 v2, v2, v3
 v_lshl_add_u32 v11, v2, 5, v11
 v_and_b32 v2, 1, v1
 v_lshl_add_u32 v11, v2, 4, v11
 v_bfe_u32 v2, v1, 2, 3
 v_xor_b32 v3, s4, v2
 v_lshlrev_b32 v3, 5, v3
 v_and_b32 v2, 3, v2
 v_lshl_add_u32 v3, v2, 8, v3
 v_lshrrev_b32 v2, 4, v1
 v_lshl_add_u32 v3, v2, 11, v3
 v_and_b32 v2, 3, v1
 v_lshl_add_u32 v3, v2, 3, v3
 v_add_u32 v8, 73728, v3
 v_xor_b32 v3, 0x80, v3
 v_add_u32 v9, 73728, v3
 s_lshl_b32 s45, s4, 11
 v_lshl_add_u32 v12, v1, 4, s45
 s_mov_b32 s39, s37
 s_add_u32 s40, s39, 4
 s_lshl_b32 s49, s4, 10
 s_mul_i32 s46, s39, 36864
 s_add_u32 m0, s49, 0
 s_nop 0
 buffer_load_dwordx4 v10, s[8:11], s46 offen offset:0  lds
 s_add_u32 m0, s49, 3968
 s_nop 0
 buffer_load_dwordx4 v10, s[8:11], s46 offen offset:128  lds
 s_add_u32 m0, s49, 7936
 s_nop 0
 buffer_load_dwordx4 v10, s[8:11], s46 offen offset:256  lds
 s_add_u32 m0, s49, 11904
 s_nop 0
 buffer_load_dwordx4 v10, s[8:11], s46 offen offset:384  lds
 s_add_u32 m0, s49, 15872
 s_nop 0
 buffer_load_dwordx4 v10, s[8:11], s46 offen offset:512  lds
 s_add_u32 m0, s49, 19840
 s_nop 0
 buffer_load_dwordx4 v10, s[8:11], s46 offen offset:640  lds
 s_add_u32 m0, s49, 23808
 s_nop 0
 buffer_load_dwordx4 v10, s[8:11], s46 offen offset:768  lds
 s_add_u32 m0, s49, 27776
 s_nop 0
 buffer_load_dwordx4 v10, s[8:11], s46 offen offset:896  lds
 s_add_u32 m0, s49, 31744
 s_nop 0
 buffer_load_dwordx4 v10, s[8:11], s46 offen offset:1024  lds
 s_lshl_b32 s49, s4, 10
 s_add_u32 s49, s49, 36864
 s_mul_i32 s46, s40, 36864
 s_add_u32 m0, s49, 0
 s_nop 0
 buffer_load_dwordx4 v10, s[8:11], s46 offen offset:0  lds
 s_add_u32 m0, s49, 3968
 s_nop 0
 buffer_load_dwordx4 v10, s[8:11], s46 offen offset:128  lds
 s_add_u32 m0, s49, 7936
 s_nop 0
 buffer_load_dwordx4 v10, s[8:11], s46 offen offset:256  lds
 s_add_u32 m0, s49, 11904
 s_nop 0
 buffer_load_dwordx4 v10, s[8:11], s46 offen offset:384  lds
 s_add_u32 m0, s49, 15872
 s_nop 0
 buffer_load_dwordx4 v10, s[8:11], s46 offen offset:512  lds
 s_add_u32 m0, s49, 19840
 s_nop 0
 buffer_load_dwordx4 v10, s[8:11], s46 offen offset:640  lds
 s_add_u32 m0, s49, 23808
 s_nop 0
 buffer_load_dwordx4 v10, s[8:11], s46 offen offset:768  lds
 s_add_u32 m0, s49, 27776
 s_nop 0
 buffer_load_dwordx4 v10, s[8:11], s46 offen offset:896  lds
 s_add_u32 m0, s49, 31744
 s_nop 0
 buffer_load_dwordx4 v10, s[8:11], s46 offen offset:1024  lds
 s_lshl_b32 s49, s4, 10
 s_add_u32 m0, s49, 73728
 s_add_u32 s45, s32, 0
 buffer_load_dwordx4 v11, s[12:15], s45 offen nt lds
 s_add_u32 m0, s49, 77824
 s_add_u32 s45, s32, 131072
 buffer_load_dwordx4 v11, s[12:15], s45 offen nt lds
 s_add_u32 m0, s49, 81920
 s_add_u32 s45, s33, 0
 buffer_load_dwordx4 v11, s[16:19], s45 offen nt lds
 s_add_u32 m0, s49, 86016
 s_add_u32 s45, s33, 131072
 buffer_load_dwordx4 v11, s[16:19], s45 offen nt lds
 s_add_u32 m0, s49, 90112
 s_add_u32 s45, s32, 262144
 buffer_load_dwordx4 v11, s[12:15], s45 offen nt lds
 s_add_u32 m0, s49, 94208
 s_add_u32 s45, s32, 393216
 buffer_load_dwordx4 v11, s[12:15], s45 offen nt lds
 s_add_u32 m0, s49, 98304
 s_add_u32 s45, s33, 262144
 buffer_load_dwordx4 v11, s[16:19], s45 offen nt lds
 s_add_u32 m0, s49, 102400
 s_add_u32 s45, s33, 393216
 buffer_load_dwordx4 v11, s[16:19], s45 offen nt lds
 s_add_u32 m0, s49, 106496
 s_add_u32 s45, s32, 524288
 buffer_load_dwordx4 v11, s[12:15], s45 offen nt lds
 s_add_u32 m0, s49, 110592
 s_add_u32 s45, s32, 655360
 buffer_load_dwordx4 v11, s[12:15], s45 offen nt lds
 s_add_u32 m0, s49, 114688
 s_add_u32 s45, s33, 524288
 buffer_load_dwordx4 v11, s[16:19], s45 offen nt lds
 s_add_u32 m0, s49, 118784
 s_add_u32 s45, s33, 655360
 buffer_load_dwordx4 v11, s[16:19], s45 offen nt lds
 s_waitcnt vmcnt(8) lgkmcnt(0)
 s_barrier
 s_add_u32 m0, s49, 122880
 s_add_u32 s45, s32, 786432
 buffer_load_dwordx4 v11, s[12:15], s45 offen nt lds
 s_add_u32 m0, s49, 126976
 s_add_u32 s45, s32, 917504
 buffer_load_dwordx4 v11, s[12:15], s45 offen nt lds
 s_add_u32 m0, s49, 131072
 s_add_u32 s45, s33, 786432
 buffer_load_dwordx4 v11, s[16:19], s45 offen nt lds
 s_add_u32 m0, s49, 135168
 s_add_u32 s45, s33, 917504
 buffer_load_dwordx4 v11, s[16:19], s45 offen nt lds
 ds_read_b64_tr_b16 a[0:1], v8 offset:0
 ds_read_b64_tr_b16 a[2:3], v8 offset:1024
 ds_read_b64_tr_b16 a[72:73], v9 offset:0
 ds_read_b64_tr_b16 a[74:75], v9 offset:1024
 ds_read_b64_tr_b16 a[144:145], v8 offset:8192
 ds_read_b64_tr_b16 a[146:147], v8 offset:9216
 ds_read_b64_tr_b16 a[216:217], v9 offset:8192
 ds_read_b64_tr_b16 a[218:219], v9 offset:9216
 s_waitcnt vmcnt(8) lgkmcnt(0)
 s_barrier
 s_add_u32 m0, s49, 73728
 s_add_u32 s45, s32, 1048576
 buffer_load_dwordx4 v11, s[12:15], s45 offen nt lds
 s_add_u32 m0, s49, 77824
 s_add_u32 s45, s32, 1179648
 buffer_load_dwordx4 v11, s[12:15], s45 offen nt lds
 s_add_u32 m0, s49, 81920
 s_add_u32 s45, s33, 1048576
 buffer_load_dwordx4 v11, s[16:19], s45 offen nt lds
 s_add_u32 m0, s49, 86016
 s_add_u32 s45, s33, 1179648
 buffer_load_dwordx4 v11, s[16:19], s45 offen nt lds
 ds_read_b64_tr_b16 a[4:5], v8 offset:16384
 ds_read_b64_tr_b16 a[6:7], v8 offset:17408
 ds_read_b64_tr_b16 a[76:77], v9 offset:16384
 ds_read_b64_tr_b16 a[78:79], v9 offset:17408
 ds_read_b64_tr_b16 a[148:149], v8 offset:24576
 ds_read_b64_tr_b16 a[150:151], v8 offset:25600
 ds_read_b64_tr_b16 a[220:221], v9 offset:24576
 ds_read_b64_tr_b16 a[222:223], v9 offset:25600
 s_waitcnt vmcnt(8) lgkmcnt(0)
 s_barrier
 s_add_u32 m0, s49, 90112
 s_add_u32 s45, s32, 1310720
 buffer_load_dwordx4 v11, s[12:15], s45 offen nt lds
 s_add_u32 m0, s49, 94208
 s_add_u32 s45, s32, 1441792
 buffer_load_dwordx4 v11, s[12:15], s45 offen nt lds
 s_add_u32 m0, s49, 98304
 s_add_u32 s45, s33, 1310720
 buffer_load_dwordx4 v11, s[16:19], s45 offen nt lds
 s_add_u32 m0, s49, 102400
 s_add_u32 s45, s33, 1441792
 buffer_load_dwordx4 v11, s[16:19], s45 offen nt lds
 ds_read_b64_tr_b16 a[8:9], v8 offset:32768
 ds_read_b64_tr_b16 a[10:11], v8 offset:33792
 ds_read_b64_tr_b16 a[80:81], v9 offset:32768
 ds_read_b64_tr_b16 a[82:83], v9 offset:33792
 ds_read_b64_tr_b16 a[152:153], v8 offset:40960
 ds_read_b64_tr_b16 a[154:155], v8 offset:41984
 ds_read_b64_tr_b16 a[224:225], v9 offset:40960
 ds_read_b64_tr_b16 a[226:227], v9 offset:41984
 s_waitcnt vmcnt(8) lgkmcnt(0)
 s_barrier
 s_add_u32 m0, s49, 106496
 s_add_u32 s45, s32, 1572864
 buffer_load_dwordx4 v11, s[12:15], s45 offen nt lds
 s_add_u32 m0, s49, 110592
 s_add_u32 s45, s32, 1703936
 buffer_load_dwordx4 v11, s[12:15], s45 offen nt lds
 s_add_u32 m0, s49, 114688
 s_add_u32 s45, s33, 1572864
 buffer_load_dwordx4 v11, s[16:19], s45 offen nt lds
 s_add_u32 m0, s49, 118784
 s_add_u32 s45, s33, 1703936
 buffer_load_dwordx4 v11, s[16:19], s45 offen nt lds
 ds_read_b64_tr_b16 a[12:13], v8 offset:49152
 ds_read_b64_tr_b16 a[14:15], v8 offset:50176
 ds_read_b64_tr_b16 a[84:85], v9 offset:49152
 ds_read_b64_tr_b16 a[86:87], v9 offset:50176
 ds_read_b64_tr_b16 a[156:157], v8 offset:57344
 ds_read_b64_tr_b16 a[158:159], v8 offset:58368
 ds_read_b64_tr_b16 a[228:229], v9 offset:57344
 ds_read_b64_tr_b16 a[230:231], v9 offset:58368
 s_waitcnt vmcnt(8) lgkmcnt(0)
 s_barrier
 s_add_u32 m0, s49, 122880
 s_add_u32 s45, s32, 1835008
 buffer_load_dwordx4 v11, s[12:15], s45 offen nt lds
 s_add_u32 m0, s49, 126976
 s_add_u32 s45, s32, 1966080
 buffer_load_dwordx4 v11, s[12:15], s45 offen nt lds
 s_add_u32 m0, s49, 131072
 s_add_u32 s45, s33, 1835008
 buffer_load_dwordx4 v11, s[16:19], s45 offen nt lds
 s_add_u32 m0, s49, 135168
 s_add_u32 s45, s33, 1966080
 buffer_load_dwordx4 v11, s[16:19], s45 offen nt lds
 ds_read_b64_tr_b16 a[16:17], v8 offset:0
 ds_read_b64_tr_b16 a[18:19], v8 offset:1024
 ds_read_b64_tr_b16 a[88:89], v9 offset:0
 ds_read_b64_tr_b16 a[90:91], v9 offset:1024
 ds_read_b64_tr_b16 a[160:161], v8 offset:8192
 ds_read_b64_tr_b16 a[162:163], v8 offset:9216
 ds_read_b64_tr_b16 a[232:233], v9 offset:8192
 ds_read_b64_tr_b16 a[234:235], v9 offset:9216
 s_waitcnt vmcnt(8) lgkmcnt(0)
 s_barrier
 s_add_u32 m0, s49, 73728
 s_add_u32 s45, s32, 2097152
 buffer_load_dwordx4 v11, s[12:15], s45 offen nt lds
 s_add_u32 m0, s49, 77824
 s_add_u32 s45, s32, 2228224
 buffer_load_dwordx4 v11, s[12:15], s45 offen nt lds
 s_add_u32 m0, s49, 81920
 s_add_u32 s45, s33, 2097152
 buffer_load_dwordx4 v11, s[16:19], s45 offen nt lds
 s_add_u32 m0, s49, 86016
 s_add_u32 s45, s33, 2228224
 buffer_load_dwordx4 v11, s[16:19], s45 offen nt lds
 ds_read_b64_tr_b16 a[20:21], v8 offset:16384
 ds_read_b64_tr_b16 a[22:23], v8 offset:17408
 ds_read_b64_tr_b16 a[92:93], v9 offset:16384
 ds_read_b64_tr_b16 a[94:95], v9 offset:17408
 ds_read_b64_tr_b16 a[164:165], v8 offset:24576
 ds_read_b64_tr_b16 a[166:167], v8 offset:25600
 ds_read_b64_tr_b16 a[236:237], v9 offset:24576
 ds_read_b64_tr_b16 a[238:239], v9 offset:25600
 s_waitcnt vmcnt(8) lgkmcnt(0)
 s_barrier
 s_add_u32 m0, s49, 90112
 s_add_u32 s45, s32, 2359296
 buffer_load_dwordx4 v11, s[12:15], s45 offen nt lds
 s_add_u32 m0, s49, 94208
 s_add_u32 s45, s32, 2490368
 buffer_load_dwordx4 v11, s[12:15], s45 offen nt lds
 s_add_u32 m0, s49, 98304
 s_add_u32 s45, s33, 2359296
 buffer_load_dwordx4 v11, s[16:19], s45 offen nt lds
 s_add_u32 m0, s49, 102400
 s_add_u32 s45, s33, 2490368
 buffer_load_dwordx4 v11, s[16:19], s45 offen nt lds
 ds_read_b64_tr_b16 a[24:25], v8 offset:32768
 ds_read_b64_tr_b16 a[26:27], v8 offset:33792
 ds_read_b64_tr_b16 a[96:97], v9 offset:32768
 ds_read_b64_tr_b16 a[98:99], v9 offset:33792
 ds_read_b64_tr_b16 a[168:169], v8 offset:40960
 ds_read_b64_tr_b16 a[170:171], v8 offset:41984
 ds_read_b64_tr_b16 a[240:241], v9 offset:40960
 ds_read_b64_tr_b16 a[242:243], v9 offset:41984
 s_waitcnt vmcnt(8) lgkmcnt(0)
 s_barrier
 s_add_u32 m0, s49, 106496
 s_add_u32 s45, s32, 2621440
 buffer_load_dwordx4 v11, s[12:15], s45 offen nt lds
 s_add_u32 m0, s49, 110592
 s_add_u32 s45, s32, 2752512
 buffer_load_dwordx4 v11, s[12:15], s45 offen nt lds
 s_add_u32 m0, s49, 114688
 s_add_u32 s45, s33, 2621440
 buffer_load_dwordx4 v11, s[16:19], s45 offen nt lds
 s_add_u32 m0, s49, 118784
 s_add_u32 s45, s33, 2752512
 buffer_load_dwordx4 v11, s[16:19], s45 offen nt lds
 ds_read_b64_tr_b16 a[28:29], v8 offset:49152
 ds_read_b64_tr_b16 a[30:31], v8 offset:50176
 ds_read_b64_tr_b16 a[100:101], v9 offset:49152
 ds_read_b64_tr_b16 a[102:103], v9 offset:50176
 ds_read_b64_tr_b16 a[172:173], v8 offset:57344
 ds_read_b64_tr_b16 a[174:175], v8 offset:58368
 ds_read_b64_tr_b16 a[244:245], v9 offset:57344
 ds_read_b64_tr_b16 a[246:247], v9 offset:58368
 s_waitcnt vmcnt(8) lgkmcnt(0)
 s_barrier
 s_add_u32 m0, s49, 122880
 s_add_u32 s45, s32, 2883584
 buffer_load_dwordx4 v11, s[12:15], s45 offen nt lds
 s_add_u32 m0, s49, 126976
 s_add_u32 s45, s32, 3014656
 buffer_load_dwordx4 v11, s[12:15], s45 offen nt lds
 s_add_u32 m0, s49, 131072
 s_add_u32 s45, s33, 2883584
 buffer_load_dwordx4 v11, s[16:19], s45 offen nt lds
 s_add_u32 m0, s49, 135168
 s_add_u32 s45, s33, 3014656
 buffer_load_dwordx4 v11, s[16:19], s45 offen nt lds
 ds_read_b64_tr_b16 a[32:33], v8 offset:0
 ds_read_b64_tr_b16 a[34:35], v8 offset:1024
 ds_read_b64_tr_b16 a[104:105], v9 offset:0
 ds_read_b64_tr_b16 a[106:107], v9 offset:1024
 ds_read_b64_tr_b16 a[176:177], v8 offset:8192
 ds_read_b64_tr_b16 a[178:179], v8 offset:9216
 ds_read_b64_tr_b16 a[248:249], v9 offset:8192
 ds_read_b64_tr_b16 a[250:251], v9 offset:9216
 s_waitcnt vmcnt(8) lgkmcnt(0)
 s_barrier
 s_add_u32 m0, s49, 73728
 s_add_u32 s45, s32, 3145728
 buffer_load_dwordx4 v11, s[12:15], s45 offen nt lds
 s_add_u32 m0, s49, 77824
 s_add_u32 s45, s32, 3276800
 buffer_load_dwordx4 v11, s[12:15], s45 offen nt lds
 s_add_u32 m0, s49, 81920
 s_add_u32 s45, s33, 3145728
 buffer_load_dwordx4 v11, s[16:19], s45 offen nt lds
 s_add_u32 m0, s49, 86016
 s_add_u32 s45, s33, 3276800
 buffer_load_dwordx4 v11, s[16:19], s45 offen nt lds
 ds_read_b64_tr_b16 a[36:37], v8 offset:16384
 ds_read_b64_tr_b16 a[38:39], v8 offset:17408
 ds_read_b64_tr_b16 a[108:109], v9 offset:16384
 ds_read_b64_tr_b16 a[110:111], v9 offset:17408
 ds_read_b64_tr_b16 a[180:181], v8 offset:24576
 ds_read_b64_tr_b16 a[182:183], v8 offset:25600
 ds_read_b64_tr_b16 a[252:253], v9 offset:24576
 ds_read_b64_tr_b16 a[254:255], v9 offset:25600
 s_waitcnt vmcnt(8) lgkmcnt(0)
 s_barrier
 s_add_u32 m0, s49, 90112
 s_add_u32 s45, s32, 3407872
 buffer_load_dwordx4 v11, s[12:15], s45 offen nt lds
 s_add_u32 m0, s49, 94208
 s_add_u32 s45, s32, 3538944
 buffer_load_dwordx4 v11, s[12:15], s45 offen nt lds
 s_add_u32 m0, s49, 98304
 s_add_u32 s45, s33, 3407872
 buffer_load_dwordx4 v11, s[16:19], s45 offen nt lds
 s_add_u32 m0, s49, 102400
 s_add_u32 s45, s33, 3538944
 buffer_load_dwordx4 v11, s[16:19], s45 offen nt lds
 ds_read_b64_tr_b16 a[40:41], v8 offset:32768
 ds_read_b64_tr_b16 a[42:43], v8 offset:33792
 ds_read_b64_tr_b16 a[112:113], v9 offset:32768
 ds_read_b64_tr_b16 a[114:115], v9 offset:33792
 ds_read_b64_tr_b16 a[184:185], v8 offset:40960
 ds_read_b64_tr_b16 a[186:187], v8 offset:41984
 ds_read_b64_tr_b16 v[224:225], v9 offset:40960
 ds_read_b64_tr_b16 v[226:227], v9 offset:41984
 s_waitcnt vmcnt(8) lgkmcnt(0)
 s_barrier
 s_add_u32 m0, s49, 106496
 s_add_u32 s45, s32, 3670016
 buffer_load_dwordx4 v11, s[12:15], s45 offen nt lds
 s_add_u32 m0, s49, 110592
 s_add_u32 s45, s32, 3801088
 buffer_load_dwordx4 v11, s[12:15], s45 offen nt lds
 s_add_u32 m0, s49, 114688
 s_add_u32 s45, s33, 3670016
 buffer_load_dwordx4 v11, s[16:19], s45 offen nt lds
 s_add_u32 m0, s49, 118784
 s_add_u32 s45, s33, 3801088
 buffer_load_dwordx4 v11, s[16:19], s45 offen nt lds
 ds_read_b64_tr_b16 a[44:45], v8 offset:49152
 ds_read_b64_tr_b16 a[46:47], v8 offset:50176
 ds_read_b64_tr_b16 a[116:117], v9 offset:49152
 ds_read_b64_tr_b16 a[118:119], v9 offset:50176
 ds_read_b64_tr_b16 a[188:189], v8 offset:57344
 ds_read_b64_tr_b16 a[190:191], v8 offset:58368
 ds_read_b64_tr_b16 v[228:229], v9 offset:57344
 ds_read_b64_tr_b16 v[230:231], v9 offset:58368
 s_waitcnt vmcnt(8) lgkmcnt(0)
 s_barrier
 s_add_u32 m0, s49, 122880
 s_add_u32 s45, s32, 3932160
 buffer_load_dwordx4 v11, s[12:15], s45 offen nt lds
 s_add_u32 m0, s49, 126976
 s_add_u32 s45, s32, 4063232
 buffer_load_dwordx4 v11, s[12:15], s45 offen nt lds
 s_add_u32 m0, s49, 131072
 s_add_u32 s45, s33, 3932160
 buffer_load_dwordx4 v11, s[16:19], s45 offen nt lds
 s_add_u32 m0, s49, 135168
 s_add_u32 s45, s33, 4063232
 buffer_load_dwordx4 v11, s[16:19], s45 offen nt lds
 ds_read_b64_tr_b16 a[48:49], v8 offset:0
 ds_read_b64_tr_b16 a[50:51], v8 offset:1024
 ds_read_b64_tr_b16 a[120:121], v9 offset:0
 ds_read_b64_tr_b16 a[122:123], v9 offset:1024
 ds_read_b64_tr_b16 a[192:193], v8 offset:8192
 ds_read_b64_tr_b16 a[194:195], v8 offset:9216
 ds_read_b64_tr_b16 v[232:233], v9 offset:8192
 ds_read_b64_tr_b16 v[234:235], v9 offset:9216
 s_waitcnt vmcnt(8) lgkmcnt(0)
 s_barrier
 s_add_u32 m0, s49, 73728
 s_add_u32 s45, s32, 4194304
 buffer_load_dwordx4 v11, s[12:15], s45 offen nt lds
 s_add_u32 m0, s49, 77824
 s_add_u32 s45, s32, 4325376
 buffer_load_dwordx4 v11, s[12:15], s45 offen nt lds
 s_add_u32 m0, s49, 81920
 s_add_u32 s45, s33, 4194304
 buffer_load_dwordx4 v11, s[16:19], s45 offen nt lds
 s_add_u32 m0, s49, 86016
 s_add_u32 s45, s33, 4325376
 buffer_load_dwordx4 v11, s[16:19], s45 offen nt lds
 ds_read_b64_tr_b16 a[52:53], v8 offset:16384
 ds_read_b64_tr_b16 a[54:55], v8 offset:17408
 ds_read_b64_tr_b16 a[124:125], v9 offset:16384
 ds_read_b64_tr_b16 a[126:127], v9 offset:17408
 ds_read_b64_tr_b16 a[196:197], v8 offset:24576
 ds_read_b64_tr_b16 a[198:199], v8 offset:25600
 ds_read_b64_tr_b16 v[236:237], v9 offset:24576
 ds_read_b64_tr_b16 v[238:239], v9 offset:25600
 s_waitcnt vmcnt(8) lgkmcnt(0)
 s_barrier
 s_add_u32 m0, s49, 90112
 s_add_u32 s45, s32, 4456448
 buffer_load_dwordx4 v11, s[12:15], s45 offen nt lds
 s_add_u32 m0, s49, 94208
 s_add_u32 s45, s32, 4587520
 buffer_load_dwordx4 v11, s[12:15], s45 offen nt lds
 s_add_u32 m0, s49, 98304
 s_add_u32 s45, s33, 4456448
 buffer_load_dwordx4 v11, s[16:19], s45 offen nt lds
 s_add_u32 m0, s49, 102400
 s_add_u32 s45, s33, 4587520
 buffer_load_dwordx4 v11, s[16:19], s45 offen nt lds
 ds_read_b64_tr_b16 a[56:57], v8 offset:32768
 ds_read_b64_tr_b16 a[58:59], v8 offset:33792
 ds_read_b64_tr_b16 a[128:129], v9 offset:32768
 ds_read_b64_tr_b16 a[130:131], v9 offset:33792
 ds_read_b64_tr_b16 a[200:201], v8 offset:40960
 ds_read_b64_tr_b16 a[202:203], v8 offset:41984
 ds_read_b64_tr_b16 v[240:241], v9 offset:40960
 ds_read_b64_tr_b16 v[242:243], v9 offset:41984
 s_waitcnt vmcnt(8) lgkmcnt(0)
 s_barrier
 ds_read_b64_tr_b16 a[60:61], v8 offset:49152
 ds_read_b64_tr_b16 a[62:63], v8 offset:50176
 ds_read_b64_tr_b16 a[132:133], v9 offset:49152
 ds_read_b64_tr_b16 a[134:135], v9 offset:50176
 ds_read_b64_tr_b16 a[204:205], v8 offset:57344
 ds_read_b64_tr_b16 a[206:207], v8 offset:58368
 ds_read_b64_tr_b16 v[244:245], v9 offset:57344
 ds_read_b64_tr_b16 v[246:247], v9 offset:58368
 s_waitcnt vmcnt(4) lgkmcnt(0)
 s_barrier
 ds_read_b64_tr_b16 a[64:65], v8 offset:0
 ds_read_b64_tr_b16 a[66:67], v8 offset:1024
 ds_read_b64_tr_b16 a[136:137], v9 offset:0
 ds_read_b64_tr_b16 a[138:139], v9 offset:1024
 ds_read_b64_tr_b16 a[208:209], v8 offset:8192
 ds_read_b64_tr_b16 a[210:211], v8 offset:9216
 ds_read_b64_tr_b16 v[248:249], v9 offset:8192
 ds_read_b64_tr_b16 v[250:251], v9 offset:9216
 s_waitcnt vmcnt(0) lgkmcnt(0)
 s_barrier
 ds_read_b64_tr_b16 a[68:69], v8 offset:16384
 ds_read_b64_tr_b16 a[70:71], v8 offset:17408
 ds_read_b64_tr_b16 a[140:141], v9 offset:16384
 ds_read_b64_tr_b16 a[142:143], v9 offset:17408
 ds_read_b64_tr_b16 a[212:213], v8 offset:24576
 ds_read_b64_tr_b16 a[214:215], v8 offset:25600
 ds_read_b64_tr_b16 v[252:253], v9 offset:24576
 ds_read_b64_tr_b16 v[254:255], v9 offset:25600
 s_mov_b32 s50, 0x3e0293ee
 s_mov_b32 s42, 0
 s_mov_b32 s43, 0
 s_mov_b32 s44, 73728
 v_mov_b32 v6, v4
 v_mov_b32 v7, v5
 s_mov_b32 s95, 0x40000
 s_cmp_lg_u32 s4, 0
 s_cbranch_scc1 Lfrk_20
 v_min_u32 v21, 1, v0
 v_lshlrev_b32 v21, 28, v21
Lfr_19:
 buffer_load_dword v20, v21, s[28:31], 0 offen offset:128 sc1
 s_waitcnt vmcnt(0)
 v_cmp_eq_u32 vcc, 1, v20
 s_cbranch_vccnz Lfrk_20
 s_sleep 12
 s_sub_u32 s95, s95, 1
 s_cbranch_scc0 Lfr_19
 s_endpgm
Lfrk_20:
 s_lshl_b32 s47, s2, 13
 s_add_u32 s47, s47, 0x8000000
 s_mov_b32 s48, s47
 v_mov_b32 v14, 0
 s_waitcnt vmcnt(0) lgkmcnt(0)
 s_barrier
 ds_read_b128 v[32:35], v6 offset:0
 ds_read_b128 v[36:39], v6 offset:2048
 ds_read_b128 v[40:43], v7 offset:0
 ds_read_b128 v[44:47], v7 offset:2048
 v_lshlrev_b32 v1, 12, v0
 s_lshl_b32 s45, s6, 7
 buffer_load_dword v15, v1, s[8:11], s45 offen
 v_add_u32 v1, 0x100000, v1
 buffer_load_dword v15, v1, s[8:11], s45 offen
 v_add_u32 v1, 0x100000, v1
 buffer_load_dword v15, v1, s[8:11], s45 offen
 v_add_u32 v1, 0x100000, v1
 s_waitcnt lgkmcnt(2)
Lps_loop_21:
 v_mfma_f32_16x16x32_bf16 v[64:67], a[0:3], v[32:35], 0
 ds_read_b128 v[48:51], v6 offset:4096
 v_mfma_f32_16x16x32_bf16 v[72:75], a[72:75], v[32:35], 0
 ds_read_b128 v[52:55], v6 offset:6144
 v_mfma_f32_16x16x32_bf16 v[80:83], a[144:147], v[32:35], 0
 s_add_u32 s41, s40, 4
 v_mfma_f32_16x16x32_bf16 v[88:91], a[216:219], v[32:35], 0
 s_add_u32 s45, s42, 2
 s_mul_i32 s46, s41, 36864
 v_mfma_f32_16x16x32_bf16 v[68:71], a[0:3], v[36:39], 0
 s_cmp_lt_u32 s45, s36
 s_cselect_b32 s46, s46, 0
 v_mfma_f32_16x16x32_bf16 v[76:79], a[72:75], v[36:39], 0
 s_lshl_b32 s49, s4, 10
 s_add_u32 s49, s49, s44
 v_mfma_f32_16x16x32_bf16 v[84:87], a[144:147], v[36:39], 0
 v_mfma_f32_16x16x32_bf16 v[92:95], a[216:219], v[36:39], 0
 s_waitcnt lgkmcnt(2)
 v_mfma_f32_16x16x32_bf16 v[64:67], a[4:7], v[40:43], v[64:67]
 ds_read_b128 v[56:59], v7 offset:4096
 v_mfma_f32_16x16x32_bf16 v[72:75], a[76:79], v[40:43], v[72:75]
 ds_read_b128 v[60:63], v7 offset:6144
 v_mfma_f32_16x16x32_bf16 v[80:83], a[148:151], v[40:43], v[80:83]
 s_add_u32 m0, s49, 0
 v_mfma_f32_16x16x32_bf16 v[88:91], a[220:223], v[40:43], v[88:91]
 buffer_load_dwordx4 v10, s[8:11], s46 offen offset:0  lds
 v_mfma_f32_16x16x32_bf16 v[68:71], a[4:7], v[44:47], v[68:71]
 s_add_u32 m0, s49, 3968
 v_mfma_f32_16x16x32_bf16 v[76:79], a[76:79], v[44:47], v[76:79]
 buffer_load_dwordx4 v10, s[8:11], s46 offen offset:128  lds
 v_mfma_f32_16x16x32_bf16 v[84:87], a[148:151], v[44:47], v[84:87]
 v_mfma_f32_16x16x32_bf16 v[92:95], a[220:223], v[44:47], v[92:95]
 s_waitcnt lgkmcnt(2)
 v_mfma_f32_16x16x32_bf16 v[64:67], a[8:11], v[48:51], v[64:67]
 ds_read_b128 v[32:35], v6 offset:8192
 v_mfma_f32_16x16x32_bf16 v[72:75], a[80:83], v[48:51], v[72:75]
 ds_read_b128 v[36:39], v6 offset:10240
 v_mfma_f32_16x16x32_bf16 v[80:83], a[152:155], v[48:51], v[80:83]
 s_add_u32 m0, s49, 7936
 v_mfma_f32_16x16x32_bf16 v[88:91], a[224:227], v[48:51], v[88:91]
 buffer_load_dwordx4 v10, s[8:11], s46 offen offset:256  lds
 v_mfma_f32_16x16x32_bf16 v[68:71], a[8:11], v[52:55], v[68:71]
 s_add_u32 m0, s49, 11904
 v_mfma_f32_16x16x32_bf16 v[76:79], a[80:83], v[52:55], v[76:79]
 buffer_load_dwordx4 v10, s[8:11], s46 offen offset:384  lds
 v_mfma_f32_16x16x32_bf16 v[84:87], a[152:155], v[52:55], v[84:87]
 v_mfma_f32_16x16x32_bf16 v[92:95], a[224:227], v[52:55], v[92:95]
 s_waitcnt lgkmcnt(2)
 v_mfma_f32_16x16x32_bf16 v[64:67], a[12:15], v[56:59], v[64:67]
 ds_read_b128 v[40:43], v7 offset:8192
 v_mfma_f32_16x16x32_bf16 v[72:75], a[84:87], v[56:59], v[72:75]
 ds_read_b128 v[44:47], v7 offset:10240
 v_mfma_f32_16x16x32_bf16 v[80:83], a[156:159], v[56:59], v[80:83]
 s_add_u32 m0, s49, 15872
 v_mfma_f32_16x16x32_bf16 v[88:91], a[228:231], v[56:59], v[88:91]
 buffer_load_dwordx4 v10, s[8:11], s46 offen offset:512  lds
 v_mfma_f32_16x16x32_bf16 v[68:71], a[12:15], v[60:63], v[68:71]
 s_add_u32 m0, s49, 19840
 v_mfma_f32_16x16x32_bf16 v[76:79], a[84:87], v[60:63], v[76:79]
 buffer_load_dwordx4 v10, s[8:11], s46 offen offset:640  lds
 v_mfma_f32_16x16x32_bf16 v[84:87], a[156:159], v[60:63], v[84:87]
 v_mfma_f32_16x16x32_bf16 v[92:95], a[228:231], v[60:63], v[92:95]
 s_waitcnt lgkmcnt(2)
 v_mfma_f32_16x16x32_bf16 v[64:67], a[16:19], v[32:35], v[64:67]
 ds_read_b128 v[48:51], v6 offset:12288
 v_mfma_f32_16x16x32_bf16 v[72:75], a[88:91], v[32:35], v[72:75]
 ds_read_b128 v[52:55], v6 offset:14336
 v_mfma_f32_16x16x32_bf16 v[80:83], a[160:163], v[32:35], v[80:83]
 s_add_u32 m0, s49, 23808
 v_mfma_f32_16x16x32_bf16 v[88:91], a[232:235], v[32:35], v[88:91]
 buffer_load_dwordx4 v10, s[8:11], s46 offen offset:768  lds
 v_mfma_f32_16x16x32_bf16 v[68:71], a[16:19], v[36:39], v[68:71]
 s_add_u32 m0, s49, 27776
 v_mfma_f32_16x16x32_bf16 v[76:79], a[88:91], v[36:39], v[76:79]
 buffer_load_dwordx4 v10, s[8:11], s46 offen offset:896  lds
 v_mfma_f32_16x16x32_bf16 v[84:87], a[160:163], v[36:39], v[84:87]
 v_mfma_f32_16x16x32_bf16 v[92:95], a[232:235], v[36:39], v[92:95]
 s_waitcnt lgkmcnt(2)
 v_mfma_f32_16x16x32_bf16 v[64:67], a[20:23], v[40:43], v[64:67]
 ds_read_b128 v[56:59], v7 offset:12288
 v_mfma_f32_16x16x32_bf16 v[72:75], a[92:95], v[40:43], v[72:75]
 ds_read_b128 v[60:63], v7 offset:14336
 v_mfma_f32_16x16x32_bf16 v[80:83], a[164:167], v[40:43], v[80:83]
 s_add_u32 m0, s49, 31744
 v_mfma_f32_16x16x32_bf16 v[88:91], a[236:239], v[40:43], v[88:91]
 buffer_load_dwordx4 v10, s[8:11], s46 offen offset:1024  lds
 v_mfma_f32_16x16x32_bf16 v[68:71], a[20:23], v[44:47], v[68:71]
 v_mfma_f32_16x16x32_bf16 v[76:79], a[92:95], v[44:47], v[76:79]
 v_mfma_f32_16x16x32_bf16 v[84:87], a[164:167], v[44:47], v[84:87]
 v_mfma_f32_16x16x32_bf16 v[92:95], a[236:239], v[44:47], v[92:95]
 s_waitcnt lgkmcnt(2)
 v_mfma_f32_16x16x32_bf16 v[64:67], a[24:27], v[48:51], v[64:67]
 ds_read_b128 v[32:35], v6 offset:16384
 v_mul_f32 v96, s50, v96
 v_mfma_f32_16x16x32_bf16 v[72:75], a[96:99], v[48:51], v[72:75]
 ds_read_b128 v[36:39], v6 offset:18432
 v_mfma_f32_16x16x32_bf16 v[80:83], a[168:171], v[48:51], v[80:83]
 v_mul_f32 v97, s50, v97
 v_mfma_f32_16x16x32_bf16 v[88:91], a[240:243], v[48:51], v[88:91]
 v_mul_f32 v98, s50, v98
 v_mfma_f32_16x16x32_bf16 v[68:71], a[24:27], v[52:55], v[68:71]
 v_mul_f32 v99, s50, v99
 v_mfma_f32_16x16x32_bf16 v[76:79], a[96:99], v[52:55], v[76:79]
 v_mul_f32 v104, s50, v104
 v_mfma_f32_16x16x32_bf16 v[84:87], a[168:171], v[52:55], v[84:87]
 v_mul_f32 v105, s50, v105
 v_mfma_f32_16x16x32_bf16 v[92:95], a[240:243], v[52:55], v[92:95]
 s_waitcnt lgkmcnt(2)
 v_mfma_f32_16x16x32_bf16 v[64:67], a[28:31], v[56:59], v[64:67]
 ds_read_b128 v[40:43], v7 offset:16384
 v_mfma_f32_16x16x32_bf16 v[72:75], a[100:103], v[56:59], v[72:75]
 ds_read_b128 v[44:47], v7 offset:18432
 v_mul_f32 v106, s50, v106
 v_mfma_f32_16x16x32_bf16 v[80:83], a[172:175], v[56:59], v[80:83]
 v_mul_f32 v107, s50, v107
 v_mfma_f32_16x16x32_bf16 v[88:91], a[244:247], v[56:59], v[88:91]
 v_cvt_pk_bf16_f32 v16, v96, v97
 v_mfma_f32_16x16x32_bf16 v[68:71], a[28:31], v[60:63], v[68:71]
 v_mfma_f32_16x16x32_bf16 v[76:79], a[100:103], v[60:63], v[76:79]
 v_cvt_pk_bf16_f32 v17, v104, v105
 v_mfma_f32_16x16x32_bf16 v[84:87], a[172:175], v[60:63], v[84:87]
 v_cvt_pk_bf16_f32 v18, v98, v99
 v_mfma_f32_16x16x32_bf16 v[92:95], a[244:247], v[60:63], v[92:95]
 s_waitcnt lgkmcnt(2)
 v_cvt_pk_bf16_f32 v19, v106, v107
 v_mfma_f32_16x16x32_bf16 v[64:67], a[32:35], v[32:35], v[64:67]
 ds_read_b128 v[48:51], v6 offset:20480
 v_mfma_f32_16x16x32_bf16 v[72:75], a[104:107], v[32:35], v[72:75]
 ds_read_b128 v[52:55], v6 offset:22528
 v_mfma_f32_16x16x32_bf16 v[80:83], a[176:179], v[32:35], v[80:83]
 buffer_store_dwordx4 v[16:19], v12, s[20:23], s47 offen offset:0 sc1
 v_mfma_f32_16x16x32_bf16 v[88:91], a[248:251], v[32:35], v[88:91]
 v_mul_f32 v100, s50, v100
 v_mfma_f32_16x16x32_bf16 v[68:71], a[32:35], v[36:39], v[68:71]
 v_mul_f32 v101, s50, v101
 v_mfma_f32_16x16x32_bf16 v[76:79], a[104:107], v[36:39], v[76:79]
 v_mul_f32 v102, s50, v102
 v_mfma_f32_16x16x32_bf16 v[84:87], a[176:179], v[36:39], v[84:87]
 v_mul_f32 v103, s50, v103
 v_mfma_f32_16x16x32_bf16 v[92:95], a[248:251], v[36:39], v[92:95]
 s_waitcnt lgkmcnt(2)
 v_mfma_f32_16x16x32_bf16 v[64:67], a[36:39], v[40:43], v[64:67]
 ds_read_b128 v[56:59], v7 offset:20480
 v_mul_f32 v108, s50, v108
 v_mfma_f32_16x16x32_bf16 v[72:75], a[108:111], v[40:43], v[72:75]
 ds_read_b128 v[60:63], v7 offset:22528
 v_mfma_f32_16x16x32_bf16 v[80:83], a[180:183], v[40:43], v[80:83]
 v_mul_f32 v109, s50, v109
 v_mfma_f32_16x16x32_bf16 v[88:91], a[252:255], v[40:43], v[88:91]
 v_mul_f32 v110, s50, v110
 v_mfma_f32_16x16x32_bf16 v[68:71], a[36:39], v[44:47], v[68:71]
 v_mul_f32 v111, s50, v111
 v_mfma_f32_16x16x32_bf16 v[76:79], a[108:111], v[44:47], v[76:79]
 v_mfma_f32_16x16x32_bf16 v[84:87], a[180:183], v[44:47], v[84:87]
 v_cvt_pk_bf16_f32 v20, v100, v101
 v_mfma_f32_16x16x32_bf16 v[92:95], a[252:255], v[44:47], v[92:95]
 s_waitcnt lgkmcnt(2)
 v_cvt_pk_bf16_f32 v21, v108, v109
 v_mfma_f32_16x16x32_bf16 v[64:67], a[40:43], v[48:51], v[64:67]
 ds_read_b128 v[32:35], v6 offset:24576
 v_mfma_f32_16x16x32_bf16 v[72:75], a[112:115], v[48:51], v[72:75]
 ds_read_b128 v[36:39], v6 offset:26624
 v_cvt_pk_bf16_f32 v22, v102, v103
 v_mfma_f32_16x16x32_bf16 v[80:83], a[184:187], v[48:51], v[80:83]
 v_mfma_f32_16x16x32_bf16 v[88:91], v[224:227], v[48:51], v[88:91]
 v_cvt_pk_bf16_f32 v23, v110, v111
 v_mfma_f32_16x16x32_bf16 v[68:71], a[40:43], v[52:55], v[68:71]
 buffer_store_dwordx4 v[20:23], v12, s[20:23], s47 offen offset:1024 sc1
 v_mfma_f32_16x16x32_bf16 v[76:79], a[112:115], v[52:55], v[76:79]
 v_mul_f32 v112, s50, v112
 v_mfma_f32_16x16x32_bf16 v[84:87], a[184:187], v[52:55], v[84:87]
 v_mul_f32 v113, s50, v113
 v_mfma_f32_16x16x32_bf16 v[92:95], v[224:227], v[52:55], v[92:95]
 s_waitcnt lgkmcnt(2)
 v_mfma_f32_16x16x32_bf16 v[64:67], a[44:47], v[56:59], v[64:67]
 ds_read_b128 v[40:43], v7 offset:24576
 v_mul_f32 v114, s50, v114
 v_mfma_f32_16x16x32_bf16 v[72:75], a[116:119], v[56:59], v[72:75]
 ds_read_b128 v[44:47], v7 offset:26624
 v_mfma_f32_16x16x32_bf16 v[80:83], a[188:191], v[56:59], v[80:83]
 v_mul_f32 v115, s50, v115
 v_mfma_f32_16x16x32_bf16 v[88:91], v[228:231], v[56:59], v[88:91]
 v_mul_f32 v120, s50, v120
 v_mfma_f32_16x16x32_bf16 v[68:71], a[44:47], v[60:63], v[68:71]
 v_mul_f32 v121, s50, v121
 v_mfma_f32_16x16x32_bf16 v[76:79], a[116:119], v[60:63], v[76:79]
 v_mfma_f32_16x16x32_bf16 v[84:87], a[188:191], v[60:63], v[84:87]
 v_mul_f32 v122, s50, v122
 v_mfma_f32_16x16x32_bf16 v[92:95], v[228:231], v[60:63], v[92:95]
 s_waitcnt lgkmcnt(2)
 v_mul_f32 v123, s50, v123
 v_mfma_f32_16x16x32_bf16 v[64:67], a[48:51], v[32:35], v[64:67]
 ds_read_b128 v[48:51], v6 offset:28672
 v_mfma_f32_16x16x32_bf16 v[72:75], a[120:123], v[32:35], v[72:75]
 ds_read_b128 v[52:55], v6 offset:30720
 v_cvt_pk_bf16_f32 v24, v112, v113
 v_mfma_f32_16x16x32_bf16 v[80:83], a[192:195], v[32:35], v[80:83]
 v_mfma_f32_16x16x32_bf16 v[88:91], v[232:235], v[32:35], v[88:91]
 v_cvt_pk_bf16_f32 v25, v120, v121
 v_mfma_f32_16x16x32_bf16 v[68:71], a[48:51], v[36:39], v[68:71]
 v_cvt_pk_bf16_f32 v26, v114, v115
 v_mfma_f32_16x16x32_bf16 v[76:79], a[120:123], v[36:39], v[76:79]
 v_cvt_pk_bf16_f32 v27, v122, v123
 v_mfma_f32_16x16x32_bf16 v[84:87], a[192:195], v[36:39], v[84:87]
 buffer_store_dwordx4 v[24:27], v12, s[20:23], s48 offen offset:0 sc1
 v_mfma_f32_16x16x32_bf16 v[92:95], v[232:235], v[36:39], v[92:95]
 s_waitcnt lgkmcnt(2)
 v_mfma_f32_16x16x32_bf16 v[64:67], a[52:55], v[40:43], v[64:67]
 ds_read_b128 v[56:59], v7 offset:28672
 v_mul_f32 v116, s50, v116
 v_mfma_f32_16x16x32_bf16 v[72:75], a[124:127], v[40:43], v[72:75]
 ds_read_b128 v[60:63], v7 offset:30720
 v_mfma_f32_16x16x32_bf16 v[80:83], a[196:199], v[40:43], v[80:83]
 s_add_u32 s43, s43, 36864
 s_cmp_eq_u32 s43, 147456
 v_mfma_f32_16x16x32_bf16 v[88:91], v[236:239], v[40:43], v[88:91]
 s_cselect_b32 s43, 0, s43
 s_add_u32 s44, s44, 36864
 v_mfma_f32_16x16x32_bf16 v[68:71], a[52:55], v[44:47], v[68:71]
 s_cmp_eq_u32 s44, 147456
 s_cselect_b32 s44, 0, s44
 v_mfma_f32_16x16x32_bf16 v[76:79], a[124:127], v[44:47], v[76:79]
 v_mul_f32 v117, s50, v117
 v_mfma_f32_16x16x32_bf16 v[84:87], a[196:199], v[44:47], v[84:87]
 v_mul_f32 v118, s50, v118
 v_mfma_f32_16x16x32_bf16 v[92:95], v[236:239], v[44:47], v[92:95]
 s_waitcnt lgkmcnt(2)
 v_mfma_f32_16x16x32_bf16 v[64:67], a[56:59], v[48:51], v[64:67]
 ds_read_b128 v[32:35], v6 offset:32768
 v_mul_f32 v119, s50, v119
 v_mfma_f32_16x16x32_bf16 v[72:75], a[128:131], v[48:51], v[72:75]
 ds_read_b128 v[36:39], v6 offset:34816
 v_mfma_f32_16x16x32_bf16 v[80:83], a[200:203], v[48:51], v[80:83]
 v_add_u32 v6, s43, v4
 v_mul_f32 v124, s50, v124
 v_mfma_f32_16x16x32_bf16 v[88:91], v[240:243], v[48:51], v[88:91]
 v_mfma_f32_16x16x32_bf16 v[68:71], a[56:59], v[52:55], v[68:71]
 v_mul_f32 v125, s50, v125
 v_mfma_f32_16x16x32_bf16 v[76:79], a[128:131], v[52:55], v[76:79]
 v_mul_f32 v126, s50, v126
 v_mfma_f32_16x16x32_bf16 v[84:87], a[200:203], v[52:55], v[84:87]
 v_mul_f32 v127, s50, v127
 v_mfma_f32_16x16x32_bf16 v[92:95], v[240:243], v[52:55], v[92:95]
 s_waitcnt lgkmcnt(2)
 v_mfma_f32_16x16x32_bf16 v[64:67], a[60:63], v[56:59], v[64:67]
 ds_read_b128 v[40:43], v7 offset:32768
 v_cvt_pk_bf16_f32 v28, v116, v117
 v_mfma_f32_16x16x32_bf16 v[72:75], a[132:135], v[56:59], v[72:75]
 ds_read_b128 v[44:47], v7 offset:34816
 v_mfma_f32_16x16x32_bf16 v[80:83], a[204:207], v[56:59], v[80:83]
 v_add_u32 v7, s43, v5
 v_cvt_pk_bf16_f32 v29, v124, v125
 v_mfma_f32_16x16x32_bf16 v[88:91], v[244:247], v[56:59], v[88:91]
 v_cvt_pk_bf16_f32 v30, v118, v119
 v_mfma_f32_16x16x32_bf16 v[68:71], a[60:63], v[60:63], v[68:71]
 v_mfma_f32_16x16x32_bf16 v[76:79], a[132:135], v[60:63], v[76:79]
 v_cvt_pk_bf16_f32 v31, v126, v127
 v_mfma_f32_16x16x32_bf16 v[84:87], a[204:207], v[60:63], v[84:87]
 buffer_store_dwordx4 v[28:31], v12, s[20:23], s48 offen offset:1024 sc1
 v_mfma_f32_16x16x32_bf16 v[92:95], v[244:247], v[60:63], v[92:95]
 s_waitcnt lgkmcnt(2)
 v_mfma_f32_16x16x32_bf16 v[64:67], a[64:67], v[32:35], v[64:67]
 s_waitcnt vmcnt(13)
 s_barrier
 ds_read_b128 v[48:51], v6 offset:0
 v_mfma_f32_16x16x32_bf16 v[72:75], a[136:139], v[32:35], v[72:75]
 ds_read_b128 v[52:55], v6 offset:2048
 v_mfma_f32_16x16x32_bf16 v[80:83], a[208:211], v[32:35], v[80:83]
 v_mfma_f32_16x16x32_bf16 v[88:91], v[248:251], v[32:35], v[88:91]
 v_mfma_f32_16x16x32_bf16 v[68:71], a[64:67], v[36:39], v[68:71]
 v_mfma_f32_16x16x32_bf16 v[76:79], a[136:139], v[36:39], v[76:79]
 v_mfma_f32_16x16x32_bf16 v[84:87], a[208:211], v[36:39], v[84:87]
 v_mfma_f32_16x16x32_bf16 v[92:95], v[248:251], v[36:39], v[92:95]
 s_waitcnt lgkmcnt(2)
 v_mfma_f32_16x16x32_bf16 v[64:67], a[68:71], v[40:43], v[64:67]
 ds_read_b128 v[56:59], v7 offset:0
 v_mfma_f32_16x16x32_bf16 v[72:75], a[140:143], v[40:43], v[72:75]
 ds_read_b128 v[60:63], v7 offset:2048
 v_mfma_f32_16x16x32_bf16 v[80:83], a[212:215], v[40:43], v[80:83]
 s_mul_i32 s45, s39, 262144
 s_add_u32 s47, s34, s45
 v_mfma_f32_16x16x32_bf16 v[88:91], v[252:255], v[40:43], v[88:91]
 s_add_u32 s48, s35, s45
 v_mov_b32 v14, s42
 v_mfma_f32_16x16x32_bf16 v[68:71], a[68:71], v[44:47], v[68:71]
 s_mov_b32 s39, s40
 s_mov_b32 s40, s41
 v_mfma_f32_16x16x32_bf16 v[76:79], a[140:143], v[44:47], v[76:79]
 s_add_u32 s42, s42, 1
 v_mfma_f32_16x16x32_bf16 v[84:87], a[212:215], v[44:47], v[84:87]
 v_mfma_f32_16x16x32_bf16 v[92:95], v[252:255], v[44:47], v[92:95]
 s_waitcnt lgkmcnt(2)
 v_mfma_f32_16x16x32_bf16 v[96:99], a[0:3], v[48:51], 0
 ds_read_b128 v[32:35], v6 offset:4096
 v_mfma_f32_16x16x32_bf16 v[104:107], a[72:75], v[48:51], 0
 ds_read_b128 v[36:39], v6 offset:6144
 v_mfma_f32_16x16x32_bf16 v[112:115], a[144:147], v[48:51], 0
 s_add_u32 s41, s40, 4
 v_mfma_f32_16x16x32_bf16 v[120:123], a[216:219], v[48:51], 0
 s_add_u32 s45, s42, 2
 s_mul_i32 s46, s41, 36864
 v_mfma_f32_16x16x32_bf16 v[100:103], a[0:3], v[52:55], 0
 s_cmp_lt_u32 s45, s36
 s_cselect_b32 s46, s46, 0
 v_mfma_f32_16x16x32_bf16 v[108:111], a[72:75], v[52:55], 0
 s_lshl_b32 s49, s4, 10
 s_add_u32 s49, s49, s44
 v_mfma_f32_16x16x32_bf16 v[116:119], a[144:147], v[52:55], 0
 v_mfma_f32_16x16x32_bf16 v[124:127], a[216:219], v[52:55], 0
 s_waitcnt lgkmcnt(2)
 v_mfma_f32_16x16x32_bf16 v[96:99], a[4:7], v[56:59], v[96:99]
 ds_read_b128 v[40:43], v7 offset:4096
 v_mfma_f32_16x16x32_bf16 v[104:107], a[76:79], v[56:59], v[104:107]
 ds_read_b128 v[44:47], v7 offset:6144
 v_mfma_f32_16x16x32_bf16 v[112:115], a[148:151], v[56:59], v[112:115]
 s_add_u32 m0, s49, 0
 v_mfma_f32_16x16x32_bf16 v[120:123], a[220:223], v[56:59], v[120:123]
 buffer_load_dwordx4 v10, s[8:11], s46 offen offset:0  lds
 v_mfma_f32_16x16x32_bf16 v[100:103], a[4:7], v[60:63], v[100:103]
 s_add_u32 m0, s49, 3968
 v_mfma_f32_16x16x32_bf16 v[108:111], a[76:79], v[60:63], v[108:111]
 buffer_load_dwordx4 v10, s[8:11], s46 offen offset:128  lds
 v_mfma_f32_16x16x32_bf16 v[116:119], a[148:151], v[60:63], v[116:119]
 v_mfma_f32_16x16x32_bf16 v[124:127], a[220:223], v[60:63], v[124:127]
 s_waitcnt lgkmcnt(2)
 v_mfma_f32_16x16x32_bf16 v[96:99], a[8:11], v[32:35], v[96:99]
 ds_read_b128 v[48:51], v6 offset:8192
 v_mfma_f32_16x16x32_bf16 v[104:107], a[80:83], v[32:35], v[104:107]
 ds_read_b128 v[52:55], v6 offset:10240
 v_mfma_f32_16x16x32_bf16 v[112:115], a[152:155], v[32:35], v[112:115]
 s_add_u32 m0, s49, 7936
 v_mfma_f32_16x16x32_bf16 v[120:123], a[224:227], v[32:35], v[120:123]
 buffer_load_dwordx4 v10, s[8:11], s46 offen offset:256  lds
 v_mfma_f32_16x16x32_bf16 v[100:103], a[8:11], v[36:39], v[100:103]
 s_add_u32 m0, s49, 11904
 v_mfma_f32_16x16x32_bf16 v[108:111], a[80:83], v[36:39], v[108:111]
 buffer_load_dwordx4 v10, s[8:11], s46 offen offset:384  lds
 v_mfma_f32_16x16x32_bf16 v[116:119], a[152:155], v[36:39], v[116:119]
 v_mfma_f32_16x16x32_bf16 v[124:127], a[224:227], v[36:39], v[124:127]
 s_waitcnt lgkmcnt(2)
 v_mfma_f32_16x16x32_bf16 v[96:99], a[12:15], v[40:43], v[96:99]
 ds_read_b128 v[56:59], v7 offset:8192
 v_mfma_f32_16x16x32_bf16 v[104:107], a[84:87], v[40:43], v[104:107]
 ds_read_b128 v[60:63], v7 offset:10240
 v_mfma_f32_16x16x32_bf16 v[112:115], a[156:159], v[40:43], v[112:115]
 s_add_u32 m0, s49, 15872
 v_mfma_f32_16x16x32_bf16 v[120:123], a[228:231], v[40:43], v[120:123]
 buffer_load_dwordx4 v10, s[8:11], s46 offen offset:512  lds
 v_mfma_f32_16x16x32_bf16 v[100:103], a[12:15], v[44:47], v[100:103]
 s_add_u32 m0, s49, 19840
 v_mfma_f32_16x16x32_bf16 v[108:111], a[84:87], v[44:47], v[108:111]
 buffer_load_dwordx4 v10, s[8:11], s46 offen offset:640  lds
 v_mfma_f32_16x16x32_bf16 v[116:119], a[156:159], v[44:47], v[116:119]
 v_mfma_f32_16x16x32_bf16 v[124:127], a[228:231], v[44:47], v[124:127]
 s_waitcnt lgkmcnt(2)
 v_mfma_f32_16x16x32_bf16 v[96:99], a[16:19], v[48:51], v[96:99]
 ds_read_b128 v[32:35], v6 offset:12288
 v_mfma_f32_16x16x32_bf16 v[104:107], a[88:91], v[48:51], v[104:107]
 ds_read_b128 v[36:39], v6 offset:14336
 v_mfma_f32_16x16x32_bf16 v[112:115], a[160:163], v[48:51], v[112:115]
 s_add_u32 m0, s49, 23808
 v_mfma_f32_16x16x32_bf16 v[120:123], a[232:235], v[48:51], v[120:123]
 buffer_load_dwordx4 v10, s[8:11], s46 offen offset:768  lds
 v_mfma_f32_16x16x32_bf16 v[100:103], a[16:19], v[52:55], v[100:103]
 s_add_u32 m0, s49, 27776
 v_mfma_f32_16x16x32_bf16 v[108:111], a[88:91], v[52:55], v[108:111]
 buffer_load_dwordx4 v10, s[8:11], s46 offen offset:896  lds
 v_mfma_f32_16x16x32_bf16 v[116:119], a[160:163], v[52:55], v[116:119]
 v_mfma_f32_16x16x32_bf16 v[124:127], a[232:235], v[52:55], v[124:127]
 s_waitcnt lgkmcnt(2)
 v_mfma_f32_16x16x32_bf16 v[96:99], a[20:23], v[56:59], v[96:99]
 ds_read_b128 v[40:43], v7 offset:12288
 v_mfma_f32_16x16x32_bf16 v[104:107], a[92:95], v[56:59], v[104:107]
 ds_read_b128 v[44:47], v7 offset:14336
 v_mfma_f32_16x16x32_bf16 v[112:115], a[164:167], v[56:59], v[112:115]
 s_add_u32 m0, s49, 31744
 v_mfma_f32_16x16x32_bf16 v[120:123], a[236:239], v[56:59], v[120:123]
 buffer_load_dwordx4 v10, s[8:11], s46 offen offset:1024  lds
 v_mfma_f32_16x16x32_bf16 v[100:103], a[20:23], v[60:63], v[100:103]
 v_mfma_f32_16x16x32_bf16 v[108:111], a[92:95], v[60:63], v[108:111]
 v_mfma_f32_16x16x32_bf16 v[116:119], a[164:167], v[60:63], v[116:119]
 v_mfma_f32_16x16x32_bf16 v[124:127], a[236:239], v[60:63], v[124:127]
 s_waitcnt lgkmcnt(2)
 v_mfma_f32_16x16x32_bf16 v[96:99], a[24:27], v[32:35], v[96:99]
 ds_read_b128 v[48:51], v6 offset:16384
 v_mul_f32 v64, s50, v64
 v_mfma_f32_16x16x32_bf16 v[104:107], a[96:99], v[32:35], v[104:107]
 ds_read_b128 v[52:55], v6 offset:18432
 v_mfma_f32_16x16x32_bf16 v[112:115], a[168:171], v[32:35], v[112:115]
 v_mul_f32 v65, s50, v65
 v_mfma_f32_16x16x32_bf16 v[120:123], a[240:243], v[32:35], v[120:123]
 v_mul_f32 v66, s50, v66
 v_mfma_f32_16x16x32_bf16 v[100:103], a[24:27], v[36:39], v[100:103]
 v_mul_f32 v67, s50, v67
 v_mfma_f32_16x16x32_bf16 v[108:111], a[96:99], v[36:39], v[108:111]
 v_mul_f32 v72, s50, v72
 v_mfma_f32_16x16x32_bf16 v[116:119], a[168:171], v[36:39], v[116:119]
 v_mul_f32 v73, s50, v73
 v_mfma_f32_16x16x32_bf16 v[124:127], a[240:243], v[36:39], v[124:127]
 s_waitcnt lgkmcnt(2)
 v_mfma_f32_16x16x32_bf16 v[96:99], a[28:31], v[40:43], v[96:99]
 ds_read_b128 v[56:59], v7 offset:16384
 v_mfma_f32_16x16x32_bf16 v[104:107], a[100:103], v[40:43], v[104:107]
 ds_read_b128 v[60:63], v7 offset:18432
 v_mul_f32 v74, s50, v74
 v_mfma_f32_16x16x32_bf16 v[112:115], a[172:175], v[40:43], v[112:115]
 v_mul_f32 v75, s50, v75
 v_mfma_f32_16x16x32_bf16 v[120:123], a[244:247], v[40:43], v[120:123]
 v_cvt_pk_bf16_f32 v16, v64, v65
 v_mfma_f32_16x16x32_bf16 v[100:103], a[28:31], v[44:47], v[100:103]
 v_mfma_f32_16x16x32_bf16 v[108:111], a[100:103], v[44:47], v[108:111]
 v_cvt_pk_bf16_f32 v17, v72, v73
 v_mfma_f32_16x16x32_bf16 v[116:119], a[172:175], v[44:47], v[116:119]
 v_cvt_pk_bf16_f32 v18, v66, v67
 v_mfma_f32_16x16x32_bf16 v[124:127], a[244:247], v[44:47], v[124:127]
 s_waitcnt lgkmcnt(2)
 v_cvt_pk_bf16_f32 v19, v74, v75
 v_mfma_f32_16x16x32_bf16 v[96:99], a[32:35], v[48:51], v[96:99]
 ds_read_b128 v[32:35], v6 offset:20480
 v_mfma_f32_16x16x32_bf16 v[104:107], a[104:107], v[48:51], v[104:107]
 ds_read_b128 v[36:39], v6 offset:22528
 v_mfma_f32_16x16x32_bf16 v[112:115], a[176:179], v[48:51], v[112:115]
 buffer_store_dwordx4 v[16:19], v12, s[20:23], s47 offen offset:0 sc1
 v_mfma_f32_16x16x32_bf16 v[120:123], a[248:251], v[48:51], v[120:123]
 v_mul_f32 v68, s50, v68
 v_mfma_f32_16x16x32_bf16 v[100:103], a[32:35], v[52:55], v[100:103]
 v_mul_f32 v69, s50, v69
 v_mfma_f32_16x16x32_bf16 v[108:111], a[104:107], v[52:55], v[108:111]
 v_mul_f32 v70, s50, v70
 v_mfma_f32_16x16x32_bf16 v[116:119], a[176:179], v[52:55], v[116:119]
 v_mul_f32 v71, s50, v71
 v_mfma_f32_16x16x32_bf16 v[124:127], a[248:251], v[52:55], v[124:127]
 s_waitcnt lgkmcnt(2)
 v_mfma_f32_16x16x32_bf16 v[96:99], a[36:39], v[56:59], v[96:99]
 ds_read_b128 v[40:43], v7 offset:20480
 v_mul_f32 v76, s50, v76
 v_mfma_f32_16x16x32_bf16 v[104:107], a[108:111], v[56:59], v[104:107]
 ds_read_b128 v[44:47], v7 offset:22528
 v_mfma_f32_16x16x32_bf16 v[112:115], a[180:183], v[56:59], v[112:115]
 v_mul_f32 v77, s50, v77
 v_mfma_f32_16x16x32_bf16 v[120:123], a[252:255], v[56:59], v[120:123]
 v_mul_f32 v78, s50, v78
 v_mfma_f32_16x16x32_bf16 v[100:103], a[36:39], v[60:63], v[100:103]
 v_mul_f32 v79, s50, v79
 v_mfma_f32_16x16x32_bf16 v[108:111], a[108:111], v[60:63], v[108:111]
 v_mfma_f32_16x16x32_bf16 v[116:119], a[180:183], v[60:63], v[116:119]
 v_cvt_pk_bf16_f32 v20, v68, v69
 v_mfma_f32_16x16x32_bf16 v[124:127], a[252:255], v[60:63], v[124:127]
 s_waitcnt lgkmcnt(2)
 v_cvt_pk_bf16_f32 v21, v76, v77
 v_mfma_f32_16x16x32_bf16 v[96:99], a[40:43], v[32:35], v[96:99]
 ds_read_b128 v[48:51], v6 offset:24576
 v_mfma_f32_16x16x32_bf16 v[104:107], a[112:115], v[32:35], v[104:107]
 ds_read_b128 v[52:55], v6 offset:26624
 v_cvt_pk_bf16_f32 v22, v70, v71
 v_mfma_f32_16x16x32_bf16 v[112:115], a[184:187], v[32:35], v[112:115]
 v_mfma_f32_16x16x32_bf16 v[120:123], v[224:227], v[32:35], v[120:123]
 v_cvt_pk_bf16_f32 v23, v78, v79
 v_mfma_f32_16x16x32_bf16 v[100:103], a[40:43], v[36:39], v[100:103]
 buffer_store_dwordx4 v[20:23], v12, s[20:23], s47 offen offset:1024 sc1
 v_mfma_f32_16x16x32_bf16 v[108:111], a[112:115], v[36:39], v[108:111]
 v_mul_f32 v80, s50, v80
 v_mfma_f32_16x16x32_bf16 v[116:119], a[184:187], v[36:39], v[116:119]
 v_mul_f32 v81, s50, v81
 v_mfma_f32_16x16x32_bf16 v[124:127], v[224:227], v[36:39], v[124:127]
 s_waitcnt lgkmcnt(2)
 v_mfma_f32_16x16x32_bf16 v[96:99], a[44:47], v[40:43], v[96:99]
 ds_read_b128 v[56:59], v7 offset:24576
 v_mul_f32 v82, s50, v82
 v_mfma_f32_16x16x32_bf16 v[104:107], a[116:119], v[40:43], v[104:107]
 ds_read_b128 v[60:63], v7 offset:26624
 v_mfma_f32_16x16x32_bf16 v[112:115], a[188:191], v[40:43], v[112:115]
 v_mul_f32 v83, s50, v83
 v_mfma_f32_16x16x32_bf16 v[120:123], v[228:231], v[40:43], v[120:123]
 v_mul_f32 v88, s50, v88
 v_mfma_f32_16x16x32_bf16 v[100:103], a[44:47], v[44:47], v[100:103]
 v_mul_f32 v89, s50, v89
 v_mfma_f32_16x16x32_bf16 v[108:111], a[116:119], v[44:47], v[108:111]
 v_mfma_f32_16x16x32_bf16 v[116:119], a[188:191], v[44:47], v[116:119]
 v_mul_f32 v90, s50, v90
 v_mfma_f32_16x16x32_bf16 v[124:127], v[228:231], v[44:47], v[124:127]
 s_waitcnt lgkmcnt(2)
 v_mul_f32 v91, s50, v91
 v_mfma_f32_16x16x32_bf16 v[96:99], a[48:51], v[48:51], v[96:99]
 ds_read_b128 v[32:35], v6 offset:28672
 v_mfma_f32_16x16x32_bf16 v[104:107], a[120:123], v[48:51], v[104:107]
 ds_read_b128 v[36:39], v6 offset:30720
 v_cvt_pk_bf16_f32 v24, v80, v81
 v_mfma_f32_16x16x32_bf16 v[112:115], a[192:195], v[48:51], v[112:115]
 v_mfma_f32_16x16x32_bf16 v[120:123], v[232:235], v[48:51], v[120:123]
 v_cvt_pk_bf16_f32 v25, v88, v89
 v_mfma_f32_16x16x32_bf16 v[100:103], a[48:51], v[52:55], v[100:103]
 v_cvt_pk_bf16_f32 v26, v82, v83
 v_mfma_f32_16x16x32_bf16 v[108:111], a[120:123], v[52:55], v[108:111]
 v_cvt_pk_bf16_f32 v27, v90, v91
 v_mfma_f32_16x16x32_bf16 v[116:119], a[192:195], v[52:55], v[116:119]
 buffer_store_dwordx4 v[24:27], v12, s[20:23], s48 offen offset:0 sc1
 v_mfma_f32_16x16x32_bf16 v[124:127], v[232:235], v[52:55], v[124:127]
 s_waitcnt lgkmcnt(2)
 v_mfma_f32_16x16x32_bf16 v[96:99], a[52:55], v[56:59], v[96:99]
 ds_read_b128 v[40:43], v7 offset:28672
 v_mul_f32 v84, s50, v84
 v_mfma_f32_16x16x32_bf16 v[104:107], a[124:127], v[56:59], v[104:107]
 ds_read_b128 v[44:47], v7 offset:30720
 v_mfma_f32_16x16x32_bf16 v[112:115], a[196:199], v[56:59], v[112:115]
 s_add_u32 s43, s43, 36864
 s_cmp_eq_u32 s43, 147456
 v_mfma_f32_16x16x32_bf16 v[120:123], v[236:239], v[56:59], v[120:123]
 s_cselect_b32 s43, 0, s43
 s_add_u32 s44, s44, 36864
 v_mfma_f32_16x16x32_bf16 v[100:103], a[52:55], v[60:63], v[100:103]
 s_cmp_eq_u32 s44, 147456
 s_cselect_b32 s44, 0, s44
 v_mfma_f32_16x16x32_bf16 v[108:111], a[124:127], v[60:63], v[108:111]
 v_mul_f32 v85, s50, v85
 v_mfma_f32_16x16x32_bf16 v[116:119], a[196:199], v[60:63], v[116:119]
 v_mul_f32 v86, s50, v86
 v_mfma_f32_16x16x32_bf16 v[124:127], v[236:239], v[60:63], v[124:127]
 s_waitcnt lgkmcnt(2)
 v_mfma_f32_16x16x32_bf16 v[96:99], a[56:59], v[32:35], v[96:99]
 ds_read_b128 v[48:51], v6 offset:32768
 v_mul_f32 v87, s50, v87
 v_mfma_f32_16x16x32_bf16 v[104:107], a[128:131], v[32:35], v[104:107]
 ds_read_b128 v[52:55], v6 offset:34816
 v_mfma_f32_16x16x32_bf16 v[112:115], a[200:203], v[32:35], v[112:115]
 v_add_u32 v6, s43, v4
 v_mul_f32 v92, s50, v92
 v_mfma_f32_16x16x32_bf16 v[120:123], v[240:243], v[32:35], v[120:123]
 v_mfma_f32_16x16x32_bf16 v[100:103], a[56:59], v[36:39], v[100:103]
 v_mul_f32 v93, s50, v93
 v_mfma_f32_16x16x32_bf16 v[108:111], a[128:131], v[36:39], v[108:111]
 v_mul_f32 v94, s50, v94
 v_mfma_f32_16x16x32_bf16 v[116:119], a[200:203], v[36:39], v[116:119]
 v_mul_f32 v95, s50, v95
 v_mfma_f32_16x16x32_bf16 v[124:127], v[240:243], v[36:39], v[124:127]
 s_waitcnt lgkmcnt(2)
 v_mfma_f32_16x16x32_bf16 v[96:99], a[60:63], v[40:43], v[96:99]
 ds_read_b128 v[56:59], v7 offset:32768
 v_cvt_pk_bf16_f32 v28, v84, v85
 v_mfma_f32_16x16x32_bf16 v[104:107], a[132:135], v[40:43], v[104:107]
 ds_read_b128 v[60:63], v7 offset:34816
 v_mfma_f32_16x16x32_bf16 v[112:115], a[204:207], v[40:43], v[112:115]
 v_add_u32 v7, s43, v5
 v_cvt_pk_bf16_f32 v29, v92, v93
 v_mfma_f32_16x16x32_bf16 v[120:123], v[244:247], v[40:43], v[120:123]
 v_cvt_pk_bf16_f32 v30, v86, v87
 v_mfma_f32_16x16x32_bf16 v[100:103], a[60:63], v[44:47], v[100:103]
 v_mfma_f32_16x16x32_bf16 v[108:111], a[132:135], v[44:47], v[108:111]
 v_cvt_pk_bf16_f32 v31, v94, v95
 v_mfma_f32_16x16x32_bf16 v[116:119], a[204:207], v[44:47], v[116:119]
 buffer_store_dwordx4 v[28:31], v12, s[20:23], s48 offen offset:1024 sc1
 v_mfma_f32_16x16x32_bf16 v[124:127], v[244:247], v[44:47], v[124:127]
 s_waitcnt lgkmcnt(2)
 v_mfma_f32_16x16x32_bf16 v[96:99], a[64:67], v[48:51], v[96:99]
 s_waitcnt vmcnt(13)
 s_barrier
 ds_read_b128 v[32:35], v6 offset:0
 v_mfma_f32_16x16x32_bf16 v[104:107], a[136:139], v[48:51], v[104:107]
 ds_read_b128 v[36:39], v6 offset:2048
 v_mfma_f32_16x16x32_bf16 v[112:115], a[208:211], v[48:51], v[112:115]
 v_mfma_f32_16x16x32_bf16 v[120:123], v[248:251], v[48:51], v[120:123]
 v_mfma_f32_16x16x32_bf16 v[100:103], a[64:67], v[52:55], v[100:103]
 v_mfma_f32_16x16x32_bf16 v[108:111], a[136:139], v[52:55], v[108:111]
 v_mfma_f32_16x16x32_bf16 v[116:119], a[208:211], v[52:55], v[116:119]
 v_mfma_f32_16x16x32_bf16 v[124:127], v[248:251], v[52:55], v[124:127]
 s_waitcnt lgkmcnt(2)
 v_mfma_f32_16x16x32_bf16 v[96:99], a[68:71], v[56:59], v[96:99]
 ds_read_b128 v[40:43], v7 offset:0
 v_mfma_f32_16x16x32_bf16 v[104:107], a[140:143], v[56:59], v[104:107]
 ds_read_b128 v[44:47], v7 offset:2048
 v_mfma_f32_16x16x32_bf16 v[112:115], a[212:215], v[56:59], v[112:115]
 s_mul_i32 s45, s39, 262144
 s_add_u32 s47, s34, s45
 v_mfma_f32_16x16x32_bf16 v[120:123], v[252:255], v[56:59], v[120:123]
 s_add_u32 s48, s35, s45
 v_mov_b32 v14, s42
 v_mfma_f32_16x16x32_bf16 v[100:103], a[68:71], v[60:63], v[100:103]
 s_mov_b32 s39, s40
 s_mov_b32 s40, s41
 v_mfma_f32_16x16x32_bf16 v[108:111], a[140:143], v[60:63], v[108:111]
 s_add_u32 s42, s42, 1
 s_cmp_lt_u32 s42, s36
 v_mfma_f32_16x16x32_bf16 v[116:119], a[212:215], v[60:63], v[116:119]
 v_mfma_f32_16x16x32_bf16 v[124:127], v[252:255], v[60:63], v[124:127]
 s_waitcnt lgkmcnt(2)
 s_cbranch_scc1 Lps_loop_21
 s_nop 7
 v_mul_f32 v96, s50, v96
 v_mul_f32 v97, s50, v97
 v_mul_f32 v98, s50, v98
 v_mul_f32 v99, s50, v99
 v_mul_f32 v104, s50, v104
 v_mul_f32 v105, s50, v105
 v_mul_f32 v106, s50, v106
 v_mul_f32 v107, s50, v107
 v_cvt_pk_bf16_f32 v16, v96, v97
 v_cvt_pk_bf16_f32 v17, v104, v105
 v_cvt_pk_bf16_f32 v18, v98, v99
 v_cvt_pk_bf16_f32 v19, v106, v107
 buffer_store_dwordx4 v[16:19], v12, s[20:23], s47 offen offset:0 sc1
 v_mul_f32 v100, s50, v100
 v_mul_f32 v101, s50, v101
 v_mul_f32 v102, s50, v102
 v_mul_f32 v103, s50, v103
 v_mul_f32 v108, s50, v108
 v_mul_f32 v109, s50, v109
 v_mul_f32 v110, s50, v110
 v_mul_f32 v111, s50, v111
 v_cvt_pk_bf16_f32 v20, v100, v101
 v_cvt_pk_bf16_f32 v21, v108, v109
 v_cvt_pk_bf16_f32 v22, v102, v103
 v_cvt_pk_bf16_f32 v23, v110, v111
 buffer_store_dwordx4 v[20:23], v12, s[20:23], s47 offen offset:1024 sc1
 v_mul_f32 v112, s50, v112
 v_mul_f32 v113, s50, v113
 v_mul_f32 v114, s50, v114
 v_mul_f32 v115, s50, v115
 v_mul_f32 v120, s50, v120
 v_mul_f32 v121, s50, v121
 v_mul_f32 v122, s50, v122
 v_mul_f32 v123, s50, v123
 v_cvt_pk_bf16_f32 v24, v112, v113
 v_cvt_pk_bf16_f32 v25, v120, v121
 v_cvt_pk_bf16_f32 v26, v114, v115
 v_cvt_pk_bf16_f32 v27, v122, v123
 buffer_store_dwordx4 v[24:27], v12, s[20:23], s48 offen offset:0 sc1
 v_mul_f32 v116, s50, v116
 v_mul_f32 v117, s50, v117
 v_mul_f32 v118, s50, v118
 v_mul_f32 v119, s50, v119
 v_mul_f32 v124, s50, v124
 v_mul_f32 v125, s50, v125
 v_mul_f32 v126, s50, v126
 v_mul_f32 v127, s50, v127
 v_cvt_pk_bf16_f32 v28, v116, v117
 v_cvt_pk_bf16_f32 v29, v124, v125
 v_cvt_pk_bf16_f32 v30, v118, v119
 v_cvt_pk_bf16_f32 v31, v126, v127
 buffer_store_dwordx4 v[28:31], v12, s[20:23], s48 offen offset:1024 sc1
 s_waitcnt vmcnt(0) lgkmcnt(0)
 s_barrier
 v_mov_b32 v14, s36
 buffer_store_dword v14, v13, s[20:23], 0 offen sc1
 s_sub_u32 s3, s5, 2
 s_add_u32 s7, s6, s3
 s_cmp_ge_u32 s7, 30
 s_cbranch_scc1 Lfin
 s_cmp_ge_u32 s6, 16
 s_cbranch_scc1 Lob
 s_load_dwordx2 s[8:9], s[0:1], 48
 s_mov_b32 s10, 0x240000
 s_mov_b32 s11, 0x20000
 s_load_dwordx2 s[12:13], s[0:1], 64
 s_mov_b32 s14, 0x480000
 s_mov_b32 s15, 0x20000
 s_load_dwordx2 s[16:17], s[0:1], 64
 s_mov_b32 s18, 0x480000
 s_mov_b32 s19, 0x20000
 s_lshl_b32 s32, s6, 9
 s_add_u32 s33, s32, 256
 s_mov_b32 s36, 32
 s_mov_b32 s37, s3
 s_lshl_b32 s52, s6, 1
 s_lshl_b32 s7, s3, 4
 s_add_u32 s7, s7, s6
 s_and_b32 s94, s7, 3
 s_lshr_b32 s7, s7, 2
 s_lshl_b32 s7, s7, 5
 s_add_u32 s7, s7, s94
 s_lshl_b32 s7, s7, 2
 s_add_u32 s59, s7, 0x3800
 s_waitcnt lgkmcnt(0)
 v_and_b32 v1, 63, v0
 v_lshrrev_b32 v2, 3, v0
 v_mul_u32_u24 v10, 1152, v2
 v_lshrrev_b32 v2, 4, v0
 v_xor_b32 v2, v2, v0
 v_and_b32 v2, 7, v2
 v_lshl_add_u32 v10, v2, 4, v10
 v_lshrrev_b32 v2, 4, v1
 v_bfe_u32 v3, v1, 1, 3
 v_xor_b32 v2, v2, v3
 v_and_b32 v3, 15, v1
 v_lshlrev_b32 v3, 7, v3
 v_lshl_add_u32 v4, v2, 4, v3
 v_xor_b32 v5, 64, v4
 v_lshrrev_b32 v2, 4, v0
 v_lshlrev_b32 v11, 13, v2
 v_lshrrev_b32 v2, 7, v0
 v_lshrrev_b32 v3, 4, v1
 v_lshl_add_u32 v3, v2, 2, v3
 v_bfe_u32 v2, v1, 1, 3
 v_xor_b32 v2, v2, v3
 v_lshl_add_u32 v11, v2, 5, v11
 v_and_b32 v2, 1, v1
 v_lshl_add_u32 v11, v2, 4, v11
 v_bfe_u32 v2, v1, 2, 3
 v_xor_b32 v3, s4, v2
 v_lshlrev_b32 v3, 5, v3
 v_and_b32 v2, 3, v2
 v_lshl_add_u32 v3, v2, 8, v3
 v_lshrrev_b32 v2, 4, v1
 v_lshl_add_u32 v3, v2, 11, v3
 v_and_b32 v2, 3, v1
 v_lshl_add_u32 v3, v2, 3, v3
 v_add_u32 v8, 73728, v3
 v_xor_b32 v3, 0x80, v3
 v_add_u32 v9, 73728, v3
 s_lshl_b32 s45, s4, 11
 v_lshl_add_u32 v12, v1, 4, s45
 s_mov_b32 s39, s37
 s_add_u32 s40, s39, 2
 s_lshl_b32 s49, s4, 10
 s_mul_i32 s46, s39, 36864
 s_add_u32 m0, s49, 0
 s_nop 0
 buffer_load_dwordx4 v10, s[8:11], s46 offen offset:0  lds
 s_add_u32 m0, s49, 3968
 s_nop 0
 buffer_load_dwordx4 v10, s[8:11], s46 offen offset:128  lds
 s_add_u32 m0, s49, 7936
 s_nop 0
 buffer_load_dwordx4 v10, s[8:11], s46 offen offset:256  lds
 s_add_u32 m0, s49, 11904
 s_nop 0
 buffer_load_dwordx4 v10, s[8:11], s46 offen offset:384  lds
 s_add_u32 m0, s49, 15872
 s_nop 0
 buffer_load_dwordx4 v10, s[8:11], s46 offen offset:512  lds
 s_add_u32 m0, s49, 19840
 s_nop 0
 buffer_load_dwordx4 v10, s[8:11], s46 offen offset:640  lds
 s_add_u32 m0, s49, 23808
 s_nop 0
 buffer_load_dwordx4 v10, s[8:11], s46 offen offset:768  lds
 s_add_u32 m0, s49, 27776
 s_nop 0
 buffer_load_dwordx4 v10, s[8:11], s46 offen offset:896  lds
 s_add_u32 m0, s49, 31744
 s_nop 0
 buffer_load_dwordx4 v10, s[8:11], s46 offen offset:1024  lds
 s_lshl_b32 s49, s4, 10
 s_add_u32 s49, s49, 36864
 s_mul_i32 s46, s40, 36864
 s_add_u32 m0, s49, 0
 s_nop 0
 buffer_load_dwordx4 v10, s[8:11], s46 offen offset:0  lds
 s_add_u32 m0, s49, 3968
 s_nop 0
 buffer_load_dwordx4 v10, s[8:11], s46 offen offset:128  lds
 s_add_u32 m0, s49, 7936
 s_nop 0
 buffer_load_dwordx4 v10, s[8:11], s46 offen offset:256  lds
 s_add_u32 m0, s49, 11904
 s_nop 0
 buffer_load_dwordx4 v10, s[8:11], s46 offen offset:384  lds
 s_add_u32 m0, s49, 15872
 s_nop 0
 buffer_load_dwordx4 v10, s[8:11], s46 offen offset:512  lds
 s_add_u32 m0, s49, 19840
 s_nop 0
 buffer_load_dwordx4 v10, s[8:11], s46 offen offset:640  lds
 s_add_u32 m0, s49, 23808
 s_nop 0
 buffer_load_dwordx4 v10, s[8:11], s46 offen offset:768  lds
 s_add_u32 m0, s49, 27776
 s_nop 0
 buffer_load_dwordx4 v10, s[8:11], s46 offen offset:896  lds
 s_add_u32 m0, s49, 31744
 s_nop 0
 buffer_load_dwordx4 v10, s[8:11], s46 offen offset:1024  lds
 s_lshl_b32 s49, s4, 10
 s_add_u32 m0, s49, 73728
 s_add_u32 s45, s32, 0
 buffer_load_dwordx4 v11, s[12:15], s45 offen  lds
 s_add_u32 m0, s49, 77824
 s_add_u32 s45, s32, 131072
 buffer_load_dwordx4 v11, s[12:15], s45 offen  lds
 s_add_u32 m0, s49, 81920
 s_add_u32 s45, s33, 0
 buffer_load_dwordx4 v11, s[16:19], s45 offen  lds
 s_add_u32 m0, s49, 86016
 s_add_u32 s45, s33, 131072
 buffer_load_dwordx4 v11, s[16:19], s45 offen  lds
 s_add_u32 m0, s49, 90112
 s_add_u32 s45, s32, 262144
 buffer_load_dwordx4 v11, s[12:15], s45 offen  lds
 s_add_u32 m0, s49, 94208
 s_add_u32 s45, s32, 393216
 buffer_load_dwordx4 v11, s[12:15], s45 offen  lds
 s_add_u32 m0, s49, 98304
 s_add_u32 s45, s33, 262144
 buffer_load_dwordx4 v11, s[16:19], s45 offen  lds
 s_add_u32 m0, s49, 102400
 s_add_u32 s45, s33, 393216
 buffer_load_dwordx4 v11, s[16:19], s45 offen  lds
 s_add_u32 m0, s49, 106496
 s_add_u32 s45, s32, 524288
 buffer_load_dwordx4 v11, s[12:15], s45 offen  lds
 s_add_u32 m0, s49, 110592
 s_add_u32 s45, s32, 655360
 buffer_load_dwordx4 v11, s[12:15], s45 offen  lds
 s_add_u32 m0, s49, 114688
 s_add_u32 s45, s33, 524288
 buffer_load_dwordx4 v11, s[16:19], s45 offen  lds
 s_add_u32 m0, s49, 118784
 s_add_u32 s45, s33, 655360
 buffer_load_dwordx4 v11, s[16:19], s45 offen  lds
 s_waitcnt vmcnt(8) lgkmcnt(0)
 s_barrier
 s_add_u32 m0, s49, 122880
 s_add_u32 s45, s32, 786432
 buffer_load_dwordx4 v11, s[12:15], s45 offen  lds
 s_add_u32 m0, s49, 126976
 s_add_u32 s45, s32, 917504
 buffer_load_dwordx4 v11, s[12:15], s45 offen  lds
 s_add_u32 m0, s49, 131072
 s_add_u32 s45, s33, 786432
 buffer_load_dwordx4 v11, s[16:19], s45 offen  lds
 s_add_u32 m0, s49, 135168
 s_add_u32 s45, s33, 917504
 buffer_load_dwordx4 v11, s[16:19], s45 offen  lds
 ds_read_b64_tr_b16 a[0:1], v8 offset:0
 ds_read_b64_tr_b16 a[2:3], v8 offset:1024
 ds_read_b64_tr_b16 a[72:73], v9 offset:0
 ds_read_b64_tr_b16 a[74:75], v9 offset:1024
 ds_read_b64_tr_b16 a[144:145], v8 offset:8192
 ds_read_b64_tr_b16 a[146:147], v8 offset:9216
 ds_read_b64_tr_b16 a[216:217], v9 offset:8192
 ds_read_b64_tr_b16 a[218:219], v9 offset:9216
 s_waitcnt vmcnt(8) lgkmcnt(0)
 s_barrier
 s_add_u32 m0, s49, 73728
 s_add_u32 s45, s32, 1048576
 buffer_load_dwordx4 v11, s[12:15], s45 offen  lds
 s_add_u32 m0, s49, 77824
 s_add_u32 s45, s32, 1179648
 buffer_load_dwordx4 v11, s[12:15], s45 offen  lds
 s_add_u32 m0, s49, 81920
 s_add_u32 s45, s33, 1048576
 buffer_load_dwordx4 v11, s[16:19], s45 offen  lds
 s_add_u32 m0, s49, 86016
 s_add_u32 s45, s33, 1179648
 buffer_load_dwordx4 v11, s[16:19], s45 offen  lds
 ds_read_b64_tr_b16 a[4:5], v8 offset:16384
 ds_read_b64_tr_b16 a[6:7], v8 offset:17408
 ds_read_b64_tr_b16 a[76:77], v9 offset:16384
 ds_read_b64_tr_b16 a[78:79], v9 offset:17408
 ds_read_b64_tr_b16 a[148:149], v8 offset:24576
 ds_read_b64_tr_b16 a[150:151], v8 offset:25600
 ds_read_b64_tr_b16 a[220:221], v9 offset:24576
 ds_read_b64_tr_b16 a[222:223], v9 offset:25600
 s_waitcnt vmcnt(8) lgkmcnt(0)
 s_barrier
 s_add_u32 m0, s49, 90112
 s_add_u32 s45, s32, 1310720
 buffer_load_dwordx4 v11, s[12:15], s45 offen  lds
 s_add_u32 m0, s49, 94208
 s_add_u32 s45, s32, 1441792
 buffer_load_dwordx4 v11, s[12:15], s45 offen  lds
 s_add_u32 m0, s49, 98304
 s_add_u32 s45, s33, 1310720
 buffer_load_dwordx4 v11, s[16:19], s45 offen  lds
 s_add_u32 m0, s49, 102400
 s_add_u32 s45, s33, 1441792
 buffer_load_dwordx4 v11, s[16:19], s45 offen  lds
 ds_read_b64_tr_b16 a[8:9], v8 offset:32768
 ds_read_b64_tr_b16 a[10:11], v8 offset:33792
 ds_read_b64_tr_b16 a[80:81], v9 offset:32768
 ds_read_b64_tr_b16 a[82:83], v9 offset:33792
 ds_read_b64_tr_b16 a[152:153], v8 offset:40960
 ds_read_b64_tr_b16 a[154:155], v8 offset:41984
 ds_read_b64_tr_b16 a[224:225], v9 offset:40960
 ds_read_b64_tr_b16 a[226:227], v9 offset:41984
 s_waitcnt vmcnt(8) lgkmcnt(0)
 s_barrier
 s_add_u32 m0, s49, 106496
 s_add_u32 s45, s32, 1572864
 buffer_load_dwordx4 v11, s[12:15], s45 offen  lds
 s_add_u32 m0, s49, 110592
 s_add_u32 s45, s32, 1703936
 buffer_load_dwordx4 v11, s[12:15], s45 offen  lds
 s_add_u32 m0, s49, 114688
 s_add_u32 s45, s33, 1572864
 buffer_load_dwordx4 v11, s[16:19], s45 offen  lds
 s_add_u32 m0, s49, 118784
 s_add_u32 s45, s33, 1703936
 buffer_load_dwordx4 v11, s[16:19], s45 offen  lds
 ds_read_b64_tr_b16 a[12:13], v8 offset:49152
 ds_read_b64_tr_b16 a[14:15], v8 offset:50176
 ds_read_b64_tr_b16 a[84:85], v9 offset:49152
 ds_read_b64_tr_b16 a[86:87], v9 offset:50176
 ds_read_b64_tr_b16 a[156:157], v8 offset:57344
 ds_read_b64_tr_b16 a[158:159], v8 offset:58368
 ds_read_b64_tr_b16 a[228:229], v9 offset:57344
 ds_read_b64_tr_b16 a[230:231], v9 offset:58368
 s_waitcnt vmcnt(8) lgkmcnt(0)
 s_barrier
 s_add_u32 m0, s49, 122880
 s_add_u32 s45, s32, 1835008
 buffer_load_dwordx4 v11, s[12:15], s45 offen  lds
 s_add_u32 m0, s49, 126976
 s_add_u32 s45, s32, 1966080
 buffer_load_dwordx4 v11, s[12:15], s45 offen  lds
 s_add_u32 m0, s49, 131072
 s_add_u32 s45, s33, 1835008
 buffer_load_dwordx4 v11, s[16:19], s45 offen  lds
 s_add_u32 m0, s49, 135168
 s_add_u32 s45, s33, 1966080
 buffer_load_dwordx4 v11, s[16:19], s45 offen  lds
 ds_read_b64_tr_b16 a[16:17], v8 offset:0
 ds_read_b64_tr_b16 a[18:19], v8 offset:1024
 ds_read_b64_tr_b16 a[88:89], v9 offset:0
 ds_read_b64_tr_b16 a[90:91], v9 offset:1024
 ds_read_b64_tr_b16 a[160:161], v8 offset:8192
 ds_read_b64_tr_b16 a[162:163], v8 offset:9216
 ds_read_b64_tr_b16 a[232:233], v9 offset:8192
 ds_read_b64_tr_b16 a[234:235], v9 offset:9216
 s_waitcnt vmcnt(8) lgkmcnt(0)
 s_barrier
 s_add_u32 m0, s49, 73728
 s_add_u32 s45, s32, 2097152
 buffer_load_dwordx4 v11, s[12:15], s45 offen  lds
 s_add_u32 m0, s49, 77824
 s_add_u32 s45, s32, 2228224
 buffer_load_dwordx4 v11, s[12:15], s45 offen  lds
 s_add_u32 m0, s49, 81920
 s_add_u32 s45, s33, 2097152
 buffer_load_dwordx4 v11, s[16:19], s45 offen  lds
 s_add_u32 m0, s49, 86016
 s_add_u32 s45, s33, 2228224
 buffer_load_dwordx4 v11, s[16:19], s45 offen  lds
 ds_read_b64_tr_b16 a[20:21], v8 offset:16384
 ds_read_b64_tr_b16 a[22:23], v8 offset:17408
 ds_read_b64_tr_b16 a[92:93], v9 offset:16384
 ds_read_b64_tr_b16 a[94:95], v9 offset:17408
 ds_read_b64_tr_b16 a[164:165], v8 offset:24576
 ds_read_b64_tr_b16 a[166:167], v8 offset:25600
 ds_read_b64_tr_b16 a[236:237], v9 offset:24576
 ds_read_b64_tr_b16 a[238:239], v9 offset:25600
 s_waitcnt vmcnt(8) lgkmcnt(0)
 s_barrier
 s_add_u32 m0, s49, 90112
 s_add_u32 s45, s32, 2359296
 buffer_load_dwordx4 v11, s[12:15], s45 offen  lds
 s_add_u32 m0, s49, 94208
 s_add_u32 s45, s32, 2490368
 buffer_load_dwordx4 v11, s[12:15], s45 offen  lds
 s_add_u32 m0, s49, 98304
 s_add_u32 s45, s33, 2359296
 buffer_load_dwordx4 v11, s[16:19], s45 offen  lds
 s_add_u32 m0, s49, 102400
 s_add_u32 s45, s33, 2490368
 buffer_load_dwordx4 v11, s[16:19], s45 offen  lds
 ds_read_b64_tr_b16 a[24:25], v8 offset:32768
 ds_read_b64_tr_b16 a[26:27], v8 offset:33792
 ds_read_b64_tr_b16 a[96:97], v9 offset:32768
 ds_read_b64_tr_b16 a[98:99], v9 offset:33792
 ds_read_b64_tr_b16 a[168:169], v8 offset:40960
 ds_read_b64_tr_b16 a[170:171], v8 offset:41984
 ds_read_b64_tr_b16 a[240:241], v9 offset:40960
 ds_read_b64_tr_b16 a[242:243], v9 offset:41984
 s_waitcnt vmcnt(8) lgkmcnt(0)
 s_barrier
 s_add_u32 m0, s49, 106496
 s_add_u32 s45, s32, 2621440
 buffer_load_dwordx4 v11, s[12:15], s45 offen  lds
 s_add_u32 m0, s49, 110592
 s_add_u32 s45, s32, 2752512
 buffer_load_dwordx4 v11, s[12:15], s45 offen  lds
 s_add_u32 m0, s49, 114688
 s_add_u32 s45, s33, 2621440
 buffer_load_dwordx4 v11, s[16:19], s45 offen  lds
 s_add_u32 m0, s49, 118784
 s_add_u32 s45, s33, 2752512
 buffer_load_dwordx4 v11, s[16:19], s45 offen  lds
 ds_read_b64_tr_b16 a[28:29], v8 offset:49152
 ds_read_b64_tr_b16 a[30:31], v8 offset:50176
 ds_read_b64_tr_b16 a[100:101], v9 offset:49152
 ds_read_b64_tr_b16 a[102:103], v9 offset:50176
 ds_read_b64_tr_b16 a[172:173], v8 offset:57344
 ds_read_b64_tr_b16 a[174:175], v8 offset:58368
 ds_read_b64_tr_b16 a[244:245], v9 offset:57344
 ds_read_b64_tr_b16 a[246:247], v9 offset:58368
 s_waitcnt vmcnt(8) lgkmcnt(0)
 s_barrier
 s_add_u32 m0, s49, 122880
 s_add_u32 s45, s32, 2883584
 buffer_load_dwordx4 v11, s[12:15], s45 offen  lds
 s_add_u32 m0, s49, 126976
 s_add_u32 s45, s32, 3014656
 buffer_load_dwordx4 v11, s[12:15], s45 offen  lds
 s_add_u32 m0, s49, 131072
 s_add_u32 s45, s33, 2883584
 buffer_load_dwordx4 v11, s[16:19], s45 offen  lds
 s_add_u32 m0, s49, 135168
 s_add_u32 s45, s33, 3014656
 buffer_load_dwordx4 v11, s[16:19], s45 offen  lds
 ds_read_b64_tr_b16 a[32:33], v8 offset:0
 ds_read_b64_tr_b16 a[34:35], v8 offset:1024
 ds_read_b64_tr_b16 a[104:105], v9 offset:0
 ds_read_b64_tr_b16 a[106:107], v9 offset:1024
 ds_read_b64_tr_b16 a[176:177], v8 offset:8192
 ds_read_b64_tr_b16 a[178:179], v8 offset:9216
 ds_read_b64_tr_b16 a[248:249], v9 offset:8192
 ds_read_b64_tr_b16 a[250:251], v9 offset:9216
 s_waitcnt vmcnt(8) lgkmcnt(0)
 s_barrier
 s_add_u32 m0, s49, 73728
 s_add_u32 s45, s32, 3145728
 buffer_load_dwordx4 v11, s[12:15], s45 offen  lds
 s_add_u32 m0, s49, 77824
 s_add_u32 s45, s32, 3276800
 buffer_load_dwordx4 v11, s[12:15], s45 offen  lds
 s_add_u32 m0, s49, 81920
 s_add_u32 s45, s33, 3145728
 buffer_load_dwordx4 v11, s[16:19], s45 offen  lds
 s_add_u32 m0, s49, 86016
 s_add_u32 s45, s33, 3276800
 buffer_load_dwordx4 v11, s[16:19], s45 offen  lds
 ds_read_b64_tr_b16 a[36:37], v8 offset:16384
 ds_read_b64_tr_b16 a[38:39], v8 offset:17408
 ds_read_b64_tr_b16 a[108:109], v9 offset:16384
 ds_read_b64_tr_b16 a[110:111], v9 offset:17408
 ds_read_b64_tr_b16 a[180:181], v8 offset:24576
 ds_read_b64_tr_b16 a[182:183], v8 offset:25600
 ds_read_b64_tr_b16 a[252:253], v9 offset:24576
 ds_read_b64_tr_b16 a[254:255], v9 offset:25600
 s_waitcnt vmcnt(8) lgkmcnt(0)
 s_barrier
 s_add_u32 m0, s49, 90112
 s_add_u32 s45, s32, 3407872
 buffer_load_dwordx4 v11, s[12:15], s45 offen  lds
 s_add_u32 m0, s49, 94208
 s_add_u32 s45, s32, 3538944
 buffer_load_dwordx4 v11, s[12:15], s45 offen  lds
 s_add_u32 m0, s49, 98304
 s_add_u32 s45, s33, 3407872
 buffer_load_dwordx4 v11, s[16:19], s45 offen  lds
 s_add_u32 m0, s49, 102400
 s_add_u32 s45, s33, 3538944
 buffer_load_dwordx4 v11, s[16:19], s45 offen  lds
 ds_read_b64_tr_b16 a[40:41], v8 offset:32768
 ds_read_b64_tr_b16 a[42:43], v8 offset:33792
 ds_read_b64_tr_b16 a[112:113], v9 offset:32768
 ds_read_b64_tr_b16 a[114:115], v9 offset:33792
 ds_read_b64_tr_b16 a[184:185], v8 offset:40960
 ds_read_b64_tr_b16 a[186:187], v8 offset:41984
 ds_read_b64_tr_b16 v[224:225], v9 offset:40960
 ds_read_b64_tr_b16 v[226:227], v9 offset:41984
 s_waitcnt vmcnt(8) lgkmcnt(0)
 s_barrier
 s_add_u32 m0, s49, 106496
 s_add_u32 s45, s32, 3670016
 buffer_load_dwordx4 v11, s[12:15], s45 offen  lds
 s_add_u32 m0, s49, 110592
 s_add_u32 s45, s32, 3801088
 buffer_load_dwordx4 v11, s[12:15], s45 offen  lds
 s_add_u32 m0, s49, 114688
 s_add_u32 s45, s33, 3670016
 buffer_load_dwordx4 v11, s[16:19], s45 offen  lds
 s_add_u32 m0, s49, 118784
 s_add_u32 s45, s33, 3801088
 buffer_load_dwordx4 v11, s[16:19], s45 offen  lds
 ds_read_b64_tr_b16 a[44:45], v8 offset:49152
 ds_read_b64_tr_b16 a[46:47], v8 offset:50176
 ds_read_b64_tr_b16 a[116:117], v9 offset:49152
 ds_read_b64_tr_b16 a[118:119], v9 offset:50176
 ds_read_b64_tr_b16 a[188:189], v8 offset:57344
 ds_read_b64_tr_b16 a[190:191], v8 offset:58368
 ds_read_b64_tr_b16 v[228:229], v9 offset:57344
 ds_read_b64_tr_b16 v[230:231], v9 offset:58368
 s_waitcnt vmcnt(8) lgkmcnt(0)
 s_barrier
 s_add_u32 m0, s49, 122880
 s_add_u32 s45, s32, 3932160
 buffer_load_dwordx4 v11, s[12:15], s45 offen  lds
 s_add_u32 m0, s49, 126976
 s_add_u32 s45, s32, 4063232
 buffer_load_dwordx4 v11, s[12:15], s45 offen  lds
 s_add_u32 m0, s49, 131072
 s_add_u32 s45, s33, 3932160
 buffer_load_dwordx4 v11, s[16:19], s45 offen  lds
 s_add_u32 m0, s49, 135168
 s_add_u32 s45, s33, 4063232
 buffer_load_dwordx4 v11, s[16:19], s45 offen  lds
 ds_read_b64_tr_b16 a[48:49], v8 offset:0
 ds_read_b64_tr_b16 a[50:51], v8 offset:1024
 ds_read_b64_tr_b16 a[120:121], v9 offset:0
 ds_read_b64_tr_b16 a[122:123], v9 offset:1024
 ds_read_b64_tr_b16 a[192:193], v8 offset:8192
 ds_read_b64_tr_b16 a[194:195], v8 offset:9216
 ds_read_b64_tr_b16 v[232:233], v9 offset:8192
 ds_read_b64_tr_b16 v[234:235], v9 offset:9216
 s_waitcnt vmcnt(8) lgkmcnt(0)
 s_barrier
 s_add_u32 m0, s49, 73728
 s_add_u32 s45, s32, 4194304
 buffer_load_dwordx4 v11, s[12:15], s45 offen  lds
 s_add_u32 m0, s49, 77824
 s_add_u32 s45, s32, 4325376
 buffer_load_dwordx4 v11, s[12:15], s45 offen  lds
 s_add_u32 m0, s49, 81920
 s_add_u32 s45, s33, 4194304
 buffer_load_dwordx4 v11, s[16:19], s45 offen  lds
 s_add_u32 m0, s49, 86016
 s_add_u32 s45, s33, 4325376
 buffer_load_dwordx4 v11, s[16:19], s45 offen  lds
 ds_read_b64_tr_b16 a[52:53], v8 offset:16384
 ds_read_b64_tr_b16 a[54:55], v8 offset:17408
 ds_read_b64_tr_b16 a[124:125], v9 offset:16384
 ds_read_b64_tr_b16 a[126:127], v9 offset:17408
 ds_read_b64_tr_b16 a[196:197], v8 offset:24576
 ds_read_b64_tr_b16 a[198:199], v8 offset:25600
 ds_read_b64_tr_b16 v[236:237], v9 offset:24576
 ds_read_b64_tr_b16 v[238:239], v9 offset:25600
 s_waitcnt vmcnt(8) lgkmcnt(0)
 s_barrier
 s_add_u32 m0, s49, 90112
 s_add_u32 s45, s32, 4456448
 buffer_load_dwordx4 v11, s[12:15], s45 offen  lds
 s_add_u32 m0, s49, 94208
 s_add_u32 s45, s32, 4587520
 buffer_load_dwordx4 v11, s[12:15], s45 offen  lds
 s_add_u32 m0, s49, 98304
 s_add_u32 s45, s33, 4456448
 buffer_load_dwordx4 v11, s[16:19], s45 offen  lds
 s_add_u32 m0, s49, 102400
 s_add_u32 s45, s33, 4587520
 buffer_load_dwordx4 v11, s[16:19], s45 offen  lds
 ds_read_b64_tr_b16 a[56:57], v8 offset:32768
 ds_read_b64_tr_b16 a[58:59], v8 offset:33792
 ds_read_b64_tr_b16 a[128:129], v9 offset:32768
 ds_read_b64_tr_b16 a[130:131], v9 offset:33792
 ds_read_b64_tr_b16 a[200:201], v8 offset:40960
 ds_read_b64_tr_b16 a[202:203], v8 offset:41984
 ds_read_b64_tr_b16 v[240:241], v9 offset:40960
 ds_read_b64_tr_b16 v[242:243], v9 offset:41984
 s_waitcnt vmcnt(8) lgkmcnt(0)
 s_barrier
 ds_read_b64_tr_b16 a[60:61], v8 offset:49152
 ds_read_b64_tr_b16 a[62:63], v8 offset:50176
 ds_read_b64_tr_b16 a[132:133], v9 offset:49152
 ds_read_b64_tr_b16 a[134:135], v9 offset:50176
 ds_read_b64_tr_b16 a[204:205], v8 offset:57344
 ds_read_b64_tr_b16 a[206:207], v8 offset:58368
 ds_read_b64_tr_b16 v[244:245], v9 offset:57344
 ds_read_b64_tr_b16 v[246:247], v9 offset:58368
 s_waitcnt vmcnt(4) lgkmcnt(0)
 s_barrier
 ds_read_b64_tr_b16 a[64:65], v8 offset:0
 ds_read_b64_tr_b16 a[66:67], v8 offset:1024
 ds_read_b64_tr_b16 a[136:137], v9 offset:0
 ds_read_b64_tr_b16 a[138:139], v9 offset:1024
 ds_read_b64_tr_b16 a[208:209], v8 offset:8192
 ds_read_b64_tr_b16 a[210:211], v8 offset:9216
 ds_read_b64_tr_b16 v[248:249], v9 offset:8192
 ds_read_b64_tr_b16 v[250:251], v9 offset:9216
 s_waitcnt vmcnt(0) lgkmcnt(0)
 s_barrier
 ds_read_b64_tr_b16 a[68:69], v8 offset:16384
 ds_read_b64_tr_b16 a[70:71], v8 offset:17408
 ds_read_b64_tr_b16 a[140:141], v9 offset:16384
 ds_read_b64_tr_b16 a[142:143], v9 offset:17408
 ds_read_b64_tr_b16 a[212:213], v8 offset:24576
 ds_read_b64_tr_b16 a[214:215], v8 offset:25600
 ds_read_b64_tr_b16 v[252:253], v9 offset:24576
 ds_read_b64_tr_b16 v[254:255], v9 offset:25600
 s_mov_b32 s50, 0x3e0293ee
 s_mov_b32 s42, 0
 s_mov_b32 s43, 0
 s_mov_b32 s44, 73728
 v_mov_b32 v6, v4
 v_mov_b32 v7, v5
 v_and_b32 v17, 63, v0
 v_lshlrev_b32 v1, 4, v17
 s_lshl_b32 s45, s4, 11
 s_add_u32 s45, s45, 147456
 v_add_u32 v2, s45, v1
 s_lshr_b32 s53, s4, 1
 s_and_b32 s54, s4, 1
 s_add_u32 s52, s52, s53
 s_lshl_b32 s53, s53, 13
 s_lshl_b32 s54, s54, 10
 s_add_u32 s45, s53, s54
 s_add_u32 s45, s45, 147456
 v_add_u32 v3, s45, v1
 s_lshl_b32 s63, s52, 13
 s_add_u32 s63, s63, s54
 s_add_u32 s63, s63, 0x7000000
 s_lshl_b32 s61, s52, 14
 s_add_u32 s61, s61, 0x3000000
 s_lshl_b32 s62, s52, 12
 s_add_u32 s62, s62, 0x400000
 s_lshl_b32 s57, s52, 7
 s_add_u32 s57, s57, 0x1000
 s_waitcnt lgkmcnt(0)
 v_min_u32 v8, 1, v0
 v_lshlrev_b32 v8, 28, v8
 s_mov_b32 s58, 0x40000
 v_mov_b32 v13, 0
 v_mov_b32 v14, 0
 v_min_u32 v15, 1, v17
 v_lshlrev_b32 v15, 28, v15
 v_bfe_u32 v18, v17, 3, 2
 v_and_b32 v19, 7, v17
 v_lshlrev_b32 v19, 7, v19
 v_lshl_add_u32 v18, v18, 11, v19
 v_lshrrev_b32 v19, 5, v17
 v_lshl_or_b32 v11, v19, 28, v18
 s_mov_b32 s56, s61
 v_mov_b32 v18, 0x44444444
 v_mov_b32 v19, 0xeeeeeeee
 v_and_b32 v20, 2, v17
 v_cmp_eq_u32 vcc, 0, v20
 s_nop 1
 v_cndmask_b32 v12, v19, v18, vcc
 v_mov_b32 v217, 0
 v_mov_b32 v218, 0
 v_mov_b32 v220, 0x3f803f80
 v_mov_b32 v221, 0x3f803f80
 v_mov_b32 v222, 0x3f803f80
 v_mov_b32 v223, 0x3f803f80
 v_and_b32 v18, 15, v17
 v_lshrrev_b32 v19, 4, v17
 v_lshlrev_b32 v19, 2, v19
 v_sub_u32 v18, v18, v19
 s_lshr_b32 s45, s54, 6
 v_add_u32 v18, s45, v18
 v_mov_b32 v19, 0xff800000
 v_cmp_le_i32 vcc, 0, v18
 s_nop 1
 v_cndmask_b32 v208, v19, v13, vcc
 v_cmp_le_i32 vcc, 1, v18
 s_nop 1
 v_cndmask_b32 v209, v19, v13, vcc
 v_cmp_le_i32 vcc, 2, v18
 s_nop 1
 v_cndmask_b32 v210, v19, v13, vcc
 v_cmp_le_i32 vcc, 3, v18
 s_nop 1
 v_cndmask_b32 v211, v19, v13, vcc
 v_cmp_le_i32 vcc, 16, v18
 s_nop 1
 v_cndmask_b32 v212, v19, v13, vcc
 v_cmp_le_i32 vcc, 17, v18
 s_nop 1
 v_cndmask_b32 v213, v19, v13, vcc
 v_cmp_le_i32 vcc, 18, v18
 s_nop 1
 v_cndmask_b32 v214, v19, v13, vcc
 v_cmp_le_i32 vcc, 19, v18
 s_nop 1
 v_cndmask_b32 v215, v19, v13, vcc
Lqs_22:
 buffer_load_dword v16, v15, s[20:23], s57 offen sc1
 s_waitcnt vmcnt(0)
 v_cmp_le_u32 vcc, 1, v16
 s_cbranch_vccnz Lqsk_23
 s_sleep 2
 s_sub_u32 s58, s58, 1
 s_cbranch_scc0 Lqs_22
 s_endpgm
Lqsk_23:
 s_waitcnt vmcnt(0) lgkmcnt(0)
 s_barrier
 ds_read_b128 v[32:35], v6 offset:0
 ds_read_b128 v[36:39], v6 offset:2048
 ds_read_b128 v[40:43], v7 offset:0
 ds_read_b128 v[44:47], v7 offset:2048
 s_waitcnt lgkmcnt(2)
Lqb_loop_24:
 v_mfma_f32_16x16x32_bf16 v[64:67], a[0:3], v[32:35], 0
 ds_read_b128 v[48:51], v6 offset:4096
 v_mfma_f32_16x16x32_bf16 v[72:75], a[72:75], v[32:35], 0
 ds_read_b128 v[52:55], v6 offset:6144
 v_mfma_f32_16x16x32_bf16 v[80:83], a[144:147], v[32:35], 0
 s_add_u32 s41, s40, 2
 v_mfma_f32_16x16x32_bf16 v[88:91], a[216:219], v[32:35], 0
 s_add_u32 s45, s42, 2
 s_mul_i32 s46, s41, 36864
 v_mfma_f32_16x16x32_bf16 v[68:71], a[0:3], v[36:39], 0
 s_cmp_lt_u32 s45, s36
 s_cselect_b32 s46, s46, 0
 v_mfma_f32_16x16x32_bf16 v[76:79], a[72:75], v[36:39], 0
 s_lshl_b32 s49, s4, 10
 s_add_u32 s49, s49, s44
 v_mfma_f32_16x16x32_bf16 v[84:87], a[144:147], v[36:39], 0
 s_lshl_b32 s53, s39, 19
 s_add_u32 s53, s53, s61
 v_mfma_f32_16x16x32_bf16 v[92:95], a[216:219], v[36:39], 0
 s_waitcnt lgkmcnt(2)
 v_mfma_f32_16x16x32_bf16 v[64:67], a[4:7], v[40:43], v[64:67]
 ds_read_b128 v[56:59], v7 offset:4096
 v_mfma_f32_16x16x32_bf16 v[72:75], a[76:79], v[40:43], v[72:75]
 ds_read_b128 v[60:63], v7 offset:6144
 v_mfma_f32_16x16x32_bf16 v[80:83], a[148:151], v[40:43], v[80:83]
 s_add_u32 m0, s49, 0
 v_mfma_f32_16x16x32_bf16 v[88:91], a[220:223], v[40:43], v[88:91]
 buffer_load_dwordx4 v10, s[8:11], s46 offen offset:0  lds
 v_mfma_f32_16x16x32_bf16 v[68:71], a[4:7], v[44:47], v[68:71]
 s_add_u32 m0, s49, 3968
 v_mfma_f32_16x16x32_bf16 v[76:79], a[76:79], v[44:47], v[76:79]
 buffer_load_dwordx4 v10, s[8:11], s46 offen offset:128  lds
 v_mfma_f32_16x16x32_bf16 v[84:87], a[148:151], v[44:47], v[84:87]
 s_lshl_b32 s55, s39, 17
 s_add_u32 s55, s55, s62
 v_mfma_f32_16x16x32_bf16 v[92:95], a[220:223], v[44:47], v[92:95]
 s_waitcnt lgkmcnt(2)
 v_mfma_f32_16x16x32_bf16 v[64:67], a[8:11], v[48:51], v[64:67]
 ds_read_b128 v[32:35], v6 offset:8192
 v_mfma_f32_16x16x32_bf16 v[72:75], a[80:83], v[48:51], v[72:75]
 ds_read_b128 v[36:39], v6 offset:10240
 v_mfma_f32_16x16x32_bf16 v[80:83], a[152:155], v[48:51], v[80:83]
 s_add_u32 m0, s49, 7936
 v_mfma_f32_16x16x32_bf16 v[88:91], a[224:227], v[48:51], v[88:91]
 buffer_load_dwordx4 v10, s[8:11], s46 offen offset:256  lds
 v_mfma_f32_16x16x32_bf16 v[68:71], a[8:11], v[52:55], v[68:71]
 s_add_u32 m0, s49, 11904
 v_mfma_f32_16x16x32_bf16 v[76:79], a[80:83], v[52:55], v[76:79]
 buffer_load_dwordx4 v10, s[8:11], s46 offen offset:384  lds
 v_mfma_f32_16x16x32_bf16 v[84:87], a[152:155], v[52:55], v[84:87]
 v_mfma_f32_16x16x32_bf16 v[92:95], a[224:227], v[52:55], v[92:95]
 s_waitcnt lgkmcnt(2)
 v_mfma_f32_16x16x32_bf16 v[64:67], a[12:15], v[56:59], v[64:67]
 ds_read_b128 v[40:43], v7 offset:8192
 v_mfma_f32_16x16x32_bf16 v[72:75], a[84:87], v[56:59], v[72:75]
 ds_read_b128 v[44:47], v7 offset:10240
 v_mfma_f32_16x16x32_bf16 v[80:83], a[156:159], v[56:59], v[80:83]
 s_add_u32 m0, s49, 15872
 v_mfma_f32_16x16x32_bf16 v[88:91], a[228:231], v[56:59], v[88:91]
 buffer_load_dwordx4 v10, s[8:11], s46 offen offset:512  lds
 v_mfma_f32_16x16x32_bf16 v[68:71], a[12:15], v[60:63], v[68:71]
 s_add_u32 m0, s49, 19840
 v_mfma_f32_16x16x32_bf16 v[76:79], a[84:87], v[60:63], v[76:79]
 buffer_load_dwordx4 v10, s[8:11], s46 offen offset:640  lds
 v_mfma_f32_16x16x32_bf16 v[84:87], a[156:159], v[60:63], v[84:87]
 s_add_u32 s60, s39, 1
 v_mfma_f32_16x16x32_bf16 v[92:95], a[228:231], v[60:63], v[92:95]
 s_waitcnt lgkmcnt(2)
 v_mfma_f32_16x16x32_bf16 v[64:67], a[16:19], v[32:35], v[64:67]
 ds_read_b128 v[48:51], v6 offset:12288
 v_mfma_f32_16x16x32_bf16 v[72:75], a[88:91], v[32:35], v[72:75]
 ds_read_b128 v[52:55], v6 offset:14336
 v_mfma_f32_16x16x32_bf16 v[80:83], a[160:163], v[32:35], v[80:83]
 s_add_u32 m0, s49, 23808
 v_mfma_f32_16x16x32_bf16 v[88:91], a[232:235], v[32:35], v[88:91]
 buffer_load_dwordx4 v10, s[8:11], s46 offen offset:768  lds
 v_mfma_f32_16x16x32_bf16 v[68:71], a[16:19], v[36:39], v[68:71]
 s_add_u32 m0, s49, 27776
 v_mfma_f32_16x16x32_bf16 v[76:79], a[88:91], v[36:39], v[76:79]
 buffer_load_dwordx4 v10, s[8:11], s46 offen offset:896  lds
 v_mfma_f32_16x16x32_bf16 v[84:87], a[160:163], v[36:39], v[84:87]
 v_mfma_f32_16x16x32_bf16 v[92:95], a[232:235], v[36:39], v[92:95]
 s_waitcnt lgkmcnt(2)
 v_mfma_f32_16x16x32_bf16 v[64:67], a[20:23], v[40:43], v[64:67]
 ds_read_b128 v[56:59], v7 offset:12288
 v_mfma_f32_16x16x32_bf16 v[72:75], a[92:95], v[40:43], v[72:75]
 ds_read_b128 v[60:63], v7 offset:14336
 v_mfma_f32_16x16x32_bf16 v[80:83], a[164:167], v[40:43], v[80:83]
 s_add_u32 m0, s49, 31744
 v_mfma_f32_16x16x32_bf16 v[88:91], a[236:239], v[40:43], v[88:91]
 buffer_load_dwordx4 v10, s[8:11], s46 offen offset:1024  lds
 v_mfma_f32_16x16x32_bf16 v[68:71], a[20:23], v[44:47], v[68:71]
 v_mfma_f32_16x16x32_bf16 v[76:79], a[92:95], v[44:47], v[76:79]
 v_mfma_f32_16x16x32_bf16 v[84:87], a[164:167], v[44:47], v[84:87]
 v_mfma_f32_16x16x32_bf16 v[92:95], a[236:239], v[44:47], v[92:95]
 s_waitcnt lgkmcnt(2)
 v_mfma_f32_16x16x32_bf16 v[64:67], a[24:27], v[48:51], v[64:67]
 ds_read_b128 v[32:35], v6 offset:16384
 v_mfma_f32_16x16x32_bf16 v[72:75], a[96:99], v[48:51], v[72:75]
 ds_read_b128 v[36:39], v6 offset:18432
 v_mfma_f32_16x16x32_bf16 v[80:83], a[168:171], v[48:51], v[80:83]
 s_waitcnt vmcnt(9)
 buffer_load_dword v17, v11, s[20:23], s56 offen sc1
 v_mfma_f32_16x16x32_bf16 v[88:91], a[240:243], v[48:51], v[88:91]
 s_barrier
 buffer_store_dword v14, v8, s[20:23], s59 offen sc1
 v_mfma_f32_16x16x32_bf16 v[68:71], a[24:27], v[52:55], v[68:71]
 buffer_load_dword v16, v15, s[20:23], s57 offen sc1
 v_mfma_f32_16x16x32_bf16 v[76:79], a[96:99], v[52:55], v[76:79]
 v_mfma_f32_16x16x32_bf16 v[84:87], a[168:171], v[52:55], v[84:87]
 s_lshl_b32 s56, s39, 18
 s_add_u32 s56, s56, s63
 v_mfma_f32_16x16x32_bf16 v[92:95], a[240:243], v[52:55], v[92:95]
 s_waitcnt lgkmcnt(2)
 v_mfma_f32_16x16x32_bf16 v[64:67], a[28:31], v[56:59], v[64:67]
 ds_read_b128 v[40:43], v7 offset:16384
 v_mfma_f32_16x16x32_bf16 v[72:75], a[100:103], v[56:59], v[72:75]
 ds_read_b128 v[44:47], v7 offset:18432
 v_mfma_f32_16x16x32_bf16 v[80:83], a[172:175], v[56:59], v[80:83]
 buffer_load_dwordx4 v[128:131], v1, s[20:23], s53 offen offset:0 sc1
 v_mfma_f32_16x16x32_bf16 v[88:91], a[244:247], v[56:59], v[88:91]
 v_mfma_f32_16x16x32_bf16 v[68:71], a[28:31], v[60:63], v[68:71]
 buffer_load_dwordx4 v[132:135], v1, s[20:23], s53 offen offset:1024 sc1
 v_mfma_f32_16x16x32_bf16 v[76:79], a[100:103], v[60:63], v[76:79]
 v_mfma_f32_16x16x32_bf16 v[84:87], a[172:175], v[60:63], v[84:87]
 v_mfma_f32_16x16x32_bf16 v[92:95], a[244:247], v[60:63], v[92:95]
 s_waitcnt lgkmcnt(2)
 v_mfma_f32_16x16x32_bf16 v[64:67], a[32:35], v[32:35], v[64:67]
 ds_read_b128 v[48:51], v6 offset:20480
 v_mfma_f32_16x16x32_bf16 v[72:75], a[104:107], v[32:35], v[72:75]
 ds_read_b128 v[52:55], v6 offset:22528
 v_mfma_f32_16x16x32_bf16 v[80:83], a[176:179], v[32:35], v[80:83]
 buffer_load_dwordx4 v[136:139], v1, s[20:23], s53 offen offset:2048 sc1
 v_mfma_f32_16x16x32_bf16 v[88:91], a[248:251], v[32:35], v[88:91]
 v_mfma_f32_16x16x32_bf16 v[68:71], a[32:35], v[36:39], v[68:71]
 buffer_load_dwordx4 v[140:143], v1, s[20:23], s53 offen offset:3072 sc1
 v_mfma_f32_16x16x32_bf16 v[76:79], a[104:107], v[36:39], v[76:79]
 v_mfma_f32_16x16x32_bf16 v[84:87], a[176:179], v[36:39], v[84:87]
 s_add_u32 s53, s53, 4096
 v_mfma_f32_16x16x32_bf16 v[92:95], a[248:251], v[36:39], v[92:95]
 s_waitcnt lgkmcnt(2)
 v_mfma_f32_16x16x32_bf16 v[64:67], a[36:39], v[40:43], v[64:67]
 ds_read_b128 v[56:59], v7 offset:20480
 v_mfma_f32_16x16x32_bf16 v[72:75], a[108:111], v[40:43], v[72:75]
 ds_read_b128 v[60:63], v7 offset:22528
 v_mfma_f32_16x16x32_bf16 v[80:83], a[180:183], v[40:43], v[80:83]
 buffer_load_dwordx4 v[144:147], v1, s[20:23], s53 offen offset:0 sc1
 v_mfma_f32_16x16x32_bf16 v[88:91], a[252:255], v[40:43], v[88:91]
 v_mfma_f32_16x16x32_bf16 v[68:71], a[36:39], v[44:47], v[68:71]
 buffer_load_dwordx4 v[148:151], v1, s[20:23], s53 offen offset:1024 sc1
 v_mfma_f32_16x16x32_bf16 v[76:79], a[108:111], v[44:47], v[76:79]
 v_mfma_f32_16x16x32_bf16 v[84:87], a[180:183], v[44:47], v[84:87]
 v_mfma_f32_16x16x32_bf16 v[92:95], a[252:255], v[44:47], v[92:95]
 s_waitcnt lgkmcnt(2)
 v_mfma_f32_16x16x32_bf16 v[64:67], a[40:43], v[48:51], v[64:67]
 ds_read_b128 v[32:35], v6 offset:24576
 v_mfma_f32_16x16x32_bf16 v[72:75], a[112:115], v[48:51], v[72:75]
 ds_read_b128 v[36:39], v6 offset:26624
 v_mfma_f32_16x16x32_bf16 v[80:83], a[184:187], v[48:51], v[80:83]
 buffer_load_dwordx4 v[152:155], v1, s[20:23], s53 offen offset:2048 sc1
 v_mfma_f32_16x16x32_bf16 v[88:91], v[224:227], v[48:51], v[88:91]
 v_mfma_f32_16x16x32_bf16 v[68:71], a[40:43], v[52:55], v[68:71]
 buffer_load_dwordx4 v[156:159], v1, s[20:23], s53 offen offset:3072 sc1
 v_mfma_f32_16x16x32_bf16 v[76:79], a[112:115], v[52:55], v[76:79]
 v_mfma_f32_16x16x32_bf16 v[84:87], a[184:187], v[52:55], v[84:87]
 s_add_u32 s53, s53, 4096
 v_mfma_f32_16x16x32_bf16 v[92:95], v[224:227], v[52:55], v[92:95]
 s_waitcnt lgkmcnt(2)
 v_mfma_f32_16x16x32_bf16 v[64:67], a[44:47], v[56:59], v[64:67]
 ds_read_b128 v[40:43], v7 offset:24576
 v_mfma_f32_16x16x32_bf16 v[72:75], a[116:119], v[56:59], v[72:75]
 ds_read_b128 v[44:47], v7 offset:26624
 v_mfma_f32_16x16x32_bf16 v[80:83], a[188:191], v[56:59], v[80:83]
 buffer_load_dwordx4 v[160:163], v1, s[20:23], s53 offen offset:0 sc1
 v_mfma_f32_16x16x32_bf16 v[88:91], v[228:231], v[56:59], v[88:91]
 v_mfma_f32_16x16x32_bf16 v[68:71], a[44:47], v[60:63], v[68:71]
 buffer_load_dwordx4 v[164:167], v1, s[20:23], s53 offen offset:1024 sc1
 v_mfma_f32_16x16x32_bf16 v[76:79], a[116:119], v[60:63], v[76:79]
 v_mfma_f32_16x16x32_bf16 v[84:87], a[188:191], v[60:63], v[84:87]
 v_mfma_f32_16x16x32_bf16 v[92:95], v[228:231], v[60:63], v[92:95]
 s_waitcnt lgkmcnt(2)
 v_mfma_f32_16x16x32_bf16 v[64:67], a[48:51], v[32:35], v[64:67]
 ds_read_b128 v[48:51], v6 offset:28672
 v_mfma_f32_16x16x32_bf16 v[72:75], a[120:123], v[32:35], v[72:75]
 ds_read_b128 v[52:55], v6 offset:30720
 v_mfma_f32_16x16x32_bf16 v[80:83], a[192:195], v[32:35], v[80:83]
 buffer_load_dwordx4 v[168:171], v1, s[20:23], s53 offen offset:2048 sc1
 v_mfma_f32_16x16x32_bf16 v[88:91], v[232:235], v[32:35], v[88:91]
 v_mfma_f32_16x16x32_bf16 v[68:71], a[48:51], v[36:39], v[68:71]
 buffer_load_dwordx4 v[172:175], v1, s[20:23], s53 offen offset:3072 sc1
 v_mfma_f32_16x16x32_bf16 v[76:79], a[120:123], v[36:39], v[76:79]
 v_mfma_f32_16x16x32_bf16 v[84:87], a[192:195], v[36:39], v[84:87]
 s_add_u32 s53, s53, 4096
 v_mfma_f32_16x16x32_bf16 v[92:95], v[232:235], v[36:39], v[92:95]
 s_waitcnt lgkmcnt(2)
 v_mfma_f32_16x16x32_bf16 v[64:67], a[52:55], v[40:43], v[64:67]
 ds_read_b128 v[56:59], v7 offset:28672
 v_mfma_f32_16x16x32_bf16 v[72:75], a[124:127], v[40:43], v[72:75]
 ds_read_b128 v[60:63], v7 offset:30720
 v_mfma_f32_16x16x32_bf16 v[80:83], a[196:199], v[40:43], v[80:83]
 s_add_u32 s43, s43, 36864
 s_cmp_eq_u32 s43, 147456
 buffer_load_dwordx4 v[176:179], v1, s[20:23], s53 offen offset:0 sc1
 v_mfma_f32_16x16x32_bf16 v[88:91], v[236:239], v[40:43], v[88:91]
 s_cselect_b32 s43, 0, s43
 s_add_u32 s44, s44, 36864
 v_mfma_f32_16x16x32_bf16 v[68:71], a[52:55], v[44:47], v[68:71]
 s_cmp_eq_u32 s44, 147456
 s_cselect_b32 s44, 0, s44
 buffer_load_dwordx4 v[180:183], v1, s[20:23], s53 offen offset:1024 sc1
 v_mfma_f32_16x16x32_bf16 v[76:79], a[124:127], v[44:47], v[76:79]
 v_mfma_f32_16x16x32_bf16 v[84:87], a[196:199], v[44:47], v[84:87]
 v_mfma_f32_16x16x32_bf16 v[92:95], v[236:239], v[44:47], v[92:95]
 s_waitcnt lgkmcnt(2)
 v_mfma_f32_16x16x32_bf16 v[64:67], a[56:59], v[48:51], v[64:67]
 ds_read_b128 v[32:35], v6 offset:32768
 v_mfma_f32_16x16x32_bf16 v[72:75], a[128:131], v[48:51], v[72:75]
 ds_read_b128 v[36:39], v6 offset:34816
 v_mfma_f32_16x16x32_bf16 v[80:83], a[200:203], v[48:51], v[80:83]
 v_add_u32 v6, s43, v4
 buffer_load_dwordx4 v[184:187], v1, s[20:23], s53 offen offset:2048 sc1
 v_mfma_f32_16x16x32_bf16 v[88:91], v[240:243], v[48:51], v[88:91]
 v_mfma_f32_16x16x32_bf16 v[68:71], a[56:59], v[52:55], v[68:71]
 buffer_load_dwordx4 v[188:191], v1, s[20:23], s53 offen offset:3072 sc1
 v_mfma_f32_16x16x32_bf16 v[76:79], a[128:131], v[52:55], v[76:79]
 v_mfma_f32_16x16x32_bf16 v[84:87], a[200:203], v[52:55], v[84:87]
 v_mfma_f32_16x16x32_bf16 v[92:95], v[240:243], v[52:55], v[92:95]
 s_waitcnt lgkmcnt(2)
 v_mfma_f32_16x16x32_bf16 v[64:67], a[60:63], v[56:59], v[64:67]
 ds_read_b128 v[40:43], v7 offset:32768
 v_mfma_f32_16x16x32_bf16 v[72:75], a[132:135], v[56:59], v[72:75]
 ds_read_b128 v[44:47], v7 offset:34816
 v_mfma_f32_16x16x32_bf16 v[80:83], a[204:207], v[56:59], v[80:83]
 v_add_u32 v7, s43, v5
 v_mfma_f32_16x16x32_bf16 v[88:91], v[244:247], v[56:59], v[88:91]
 v_mfma_f32_16x16x32_bf16 v[68:71], a[60:63], v[60:63], v[68:71]
 v_mfma_f32_16x16x32_bf16 v[76:79], a[132:135], v[60:63], v[76:79]
 v_mfma_f32_16x16x32_bf16 v[84:87], a[204:207], v[60:63], v[84:87]
 v_mfma_f32_16x16x32_bf16 v[92:95], v[244:247], v[60:63], v[92:95]
 s_waitcnt lgkmcnt(2)
 v_mfma_f32_16x16x32_bf16 v[64:67], a[64:67], v[32:35], v[64:67]
 s_waitcnt vmcnt(28)
 s_barrier
 ds_read_b128 v[48:51], v6 offset:0
 v_mfma_f32_16x16x32_bf16 v[72:75], a[136:139], v[32:35], v[72:75]
 ds_read_b128 v[52:55], v6 offset:2048
 v_mfma_f32_16x16x32_bf16 v[80:83], a[208:211], v[32:35], v[80:83]
 v_mfma_f32_16x16x32_bf16 v[88:91], v[248:251], v[32:35], v[88:91]
 s_waitcnt vmcnt(16)
 v_cmp_le_u32 vcc, s60, v16
 v_mfma_f32_16x16x32_bf16 v[68:71], a[64:67], v[36:39], v[68:71]
 v_mfma_f32_16x16x32_bf16 v[76:79], a[136:139], v[36:39], v[76:79]
 s_and_b32 s64, vcc_lo, 1
 s_cbranch_scc0 Lqsk_25
 buffer_load_dwordx4 v[192:195], v1, s[20:23], s55 offen offset:0 sc1
 buffer_load_dwordx4 v[196:199], v1, s[20:23], s55 offen offset:1024 sc1
 buffer_load_dwordx4 v[200:203], v1, s[20:23], s55 offen offset:2048 sc1
 buffer_load_dwordx4 v[204:207], v1, s[20:23], s55 offen offset:3072 sc1
Lqsk_25:
 v_mfma_f32_16x16x32_bf16 v[84:87], a[208:211], v[36:39], v[84:87]
 v_mfma_f32_16x16x32_bf16 v[92:95], v[248:251], v[36:39], v[92:95]
 s_waitcnt lgkmcnt(2)
 v_mfma_f32_16x16x32_bf16 v[64:67], a[68:71], v[40:43], v[64:67]
 ds_read_b128 v[56:59], v7 offset:0
 v_mfma_f32_16x16x32_bf16 v[72:75], a[140:143], v[40:43], v[72:75]
 ds_read_b128 v[60:63], v7 offset:2048
 v_mfma_f32_16x16x32_bf16 v[80:83], a[212:215], v[40:43], v[80:83]
 v_mfma_f32_16x16x32_bf16 v[88:91], v[252:255], v[40:43], v[88:91]
 s_mov_b32 s39, s40
 s_mov_b32 s40, s41
 v_mfma_f32_16x16x32_bf16 v[68:71], a[68:71], v[44:47], v[68:71]
 s_add_u32 s42, s42, 1
 v_mov_b32 v14, s42
 v_mfma_f32_16x16x32_bf16 v[76:79], a[140:143], v[44:47], v[76:79]
 v_mfma_f32_16x16x32_bf16 v[84:87], a[212:215], v[44:47], v[84:87]
 v_mfma_f32_16x16x32_bf16 v[92:95], v[252:255], v[44:47], v[92:95]
 s_waitcnt lgkmcnt(2)
 s_nop 3
 v_mul_f32 v64, s50, v64
 v_mul_f32 v65, s50, v65
 v_mul_f32 v66, s50, v66
 v_mul_f32 v67, s50, v67
 v_mul_f32 v72, s50, v72
 v_mul_f32 v73, s50, v73
 v_mul_f32 v74, s50, v74
 v_mul_f32 v75, s50, v75
 v_cvt_pk_bf16_f32 v16, v64, v65
 v_cvt_pk_bf16_f32 v17, v72, v73
 v_cvt_pk_bf16_f32 v18, v66, v67
 v_cvt_pk_bf16_f32 v19, v74, v75
 ds_write_b128 v2, v[16:19] offset:0
 v_mul_f32 v68, s50, v68
 v_mul_f32 v69, s50, v69
 v_mul_f32 v70, s50, v70
 v_mul_f32 v71, s50, v71
 v_mul_f32 v76, s50, v76
 v_mul_f32 v77, s50, v77
 v_mul_f32 v78, s50, v78
 v_mul_f32 v79, s50, v79
 v_cvt_pk_bf16_f32 v20, v68, v69
 v_cvt_pk_bf16_f32 v21, v76, v77
 v_cvt_pk_bf16_f32 v22, v70, v71
 v_cvt_pk_bf16_f32 v23, v78, v79
 ds_write_b128 v2, v[20:23] offset:1024
 v_mul_f32 v80, s50, v80
 v_mul_f32 v81, s50, v81
 v_mul_f32 v82, s50, v82
 v_mul_f32 v83, s50, v83
 v_mul_f32 v88, s50, v88
 v_mul_f32 v89, s50, v89
 v_mul_f32 v90, s50, v90
 v_mul_f32 v91, s50, v91
 v_cvt_pk_bf16_f32 v24, v80, v81
 v_cvt_pk_bf16_f32 v25, v88, v89
 v_cvt_pk_bf16_f32 v26, v82, v83
 v_cvt_pk_bf16_f32 v27, v90, v91
 ds_write_b128 v2, v[24:27] offset:8192
 v_mul_f32 v84, s50, v84
 v_mul_f32 v85, s50, v85
 v_mul_f32 v86, s50, v86
 v_mul_f32 v87, s50, v87
 v_mul_f32 v92, s50, v92
 v_mul_f32 v93, s50, v93
 v_mul_f32 v94, s50, v94
 v_mul_f32 v95, s50, v95
 v_cvt_pk_bf16_f32 v28, v84, v85
 v_cvt_pk_bf16_f32 v29, v92, v93
 v_cvt_pk_bf16_f32 v30, v86, v87
 v_cvt_pk_bf16_f32 v31, v94, v95
 ds_write_b128 v2, v[28:31] offset:9216
 v_mov_b64 v[120:121], 0
 v_mov_b64 v[122:123], 0
 s_waitcnt lgkmcnt(0)
 s_barrier
 ds_read_b128 v[96:99], v3 offset:0
 ds_read_b128 v[100:103], v3 offset:2048
 ds_read_b128 v[104:107], v3 offset:4096
 ds_read_b128 v[108:111], v3 offset:6144
 s_cmp_lg_u32 s64, 0
 s_cbranch_scc1 Lqpre_26
Lqs_27:
 buffer_load_dword v16, v15, s[20:23], s57 offen sc1
 s_waitcnt vmcnt(0)
 v_cmp_le_u32 vcc, s60, v16
 s_cbranch_vccnz Lqsk_28
 s_sleep 2
 s_sub_u32 s58, s58, 1
 s_cbranch_scc0 Lqs_27
 s_endpgm
Lqsk_28:
 buffer_load_dwordx4 v[192:195], v1, s[20:23], s55 offen offset:0 sc1
 buffer_load_dwordx4 v[196:199], v1, s[20:23], s55 offen offset:1024 sc1
 buffer_load_dwordx4 v[200:203], v1, s[20:23], s55 offen offset:2048 sc1
 buffer_load_dwordx4 v[204:207], v1, s[20:23], s55 offen offset:3072 sc1
Lqpre_26:
 s_waitcnt vmcnt(4) lgkmcnt(0)
 v_mfma_f32_16x16x32_bf16 v[112:115], v[128:131], v[96:99], v[208:211]
 v_mfma_f32_16x16x32_bf16 v[116:119], v[132:135], v[96:99], v[212:215]
 v_mfma_f32_16x16x32_bf16 v[112:115], v[136:139], v[100:103], v[112:115]
 v_mfma_f32_16x16x32_bf16 v[116:119], v[140:143], v[100:103], v[116:119]
 v_mfma_f32_16x16x32_bf16 v[112:115], v[144:147], v[104:107], v[112:115]
 v_mfma_f32_16x16x32_bf16 v[116:119], v[148:151], v[104:107], v[116:119]
 v_mfma_f32_16x16x32_bf16 v[112:115], v[152:155], v[108:111], v[112:115]
 v_mfma_f32_16x16x32_bf16 v[116:119], v[156:159], v[108:111], v[116:119]
 s_nop 7
 v_max3_f32 v24, v112, v113, v114
 v_max3_f32 v24, v24, v115, v116
 v_max3_f32 v24, v24, v117, v118
 v_max_f32 v24, v24, v119
 s_waitcnt vmcnt(2)
 v_mov_b64 v[16:17], v[192:193]
 v_mov_b64 v[18:19], v[196:197]
 s_nop 1
 v_smfmac_f32_16x16x64_bf16 v[120:123], v[16:19], v[96:103], v12
 s_waitcnt vmcnt(0)
 v_mov_b64 v[20:21], v[200:201]
 v_mov_b64 v[22:23], v[204:205]
 s_nop 1
 v_smfmac_f32_16x16x64_bf16 v[120:123], v[20:23], v[104:111], v12
 s_nop 7
 v_add_f32 v120, v120, v122
 v_add_f32 v121, v121, v123
 v_max3_f32 v24, v24, v120, v121
 v_mov_b32 v25, v24
 s_nop 1
 v_permlane16_swap_b32 v24, v25
 v_max_f32 v24, v24, v25
 v_mov_b32 v25, v24
 s_nop 1
 v_permlane32_swap_b32 v24, v25
 v_max_f32 v24, v24, v25
 v_sub_f32 v112, v112, v24
 v_sub_f32 v113, v113, v24
 v_sub_f32 v114, v114, v24
 v_sub_f32 v115, v115, v24
 v_sub_f32 v116, v116, v24
 v_sub_f32 v117, v117, v24
 v_sub_f32 v118, v118, v24
 v_sub_f32 v119, v119, v24
 v_sub_f32 v120, v120, v24
 v_sub_f32 v121, v121, v24
 v_exp_f32 v120, v120
 v_exp_f32 v121, v121
 v_exp_f32 v112, v112
 v_exp_f32 v113, v113
 v_exp_f32 v114, v114
 v_exp_f32 v115, v115
 v_exp_f32 v116, v116
 v_exp_f32 v117, v117
 v_exp_f32 v118, v118
 v_exp_f32 v119, v119
 v_cvt_pk_bf16_f32 v216, v120, v121
 v_cvt_pk_bf16_f32 v219, v120, v121
 v_cvt_pk_bf16_f32 v28, v112, v113
 v_cvt_pk_bf16_f32 v29, v116, v117
 v_cvt_pk_bf16_f32 v30, v114, v115
 v_cvt_pk_bf16_f32 v31, v118, v119
 v_mfma_f32_16x16x16_bf16 v[124:127], v[220:221], v[216:217], 0
 v_mfma_f32_16x16x16_bf16 v[64:67], v[194:195], v[216:217], 0
 v_mfma_f32_16x16x16_bf16 v[68:71], v[194:195], v[218:219], 0
 v_mfma_f32_16x16x16_bf16 v[72:75], v[198:199], v[216:217], 0
 v_mfma_f32_16x16x16_bf16 v[76:79], v[198:199], v[218:219], 0
 v_mfma_f32_16x16x16_bf16 v[80:83], v[202:203], v[216:217], 0
 v_mfma_f32_16x16x16_bf16 v[84:87], v[202:203], v[218:219], 0
 v_mfma_f32_16x16x16_bf16 v[88:91], v[206:207], v[216:217], 0
 v_mfma_f32_16x16x16_bf16 v[92:95], v[206:207], v[218:219], 0
 v_mfma_f32_16x16x32_bf16 v[124:127], v[220:223], v[28:31], v[124:127]
 v_mfma_f32_16x16x32_bf16 v[64:67], v[160:163], v[28:31], v[64:67]
 v_mfma_f32_16x16x32_bf16 v[68:71], v[164:167], v[28:31], v[68:71]
 v_mfma_f32_16x16x32_bf16 v[72:75], v[168:171], v[28:31], v[72:75]
 v_mfma_f32_16x16x32_bf16 v[76:79], v[172:175], v[28:31], v[76:79]
 v_mfma_f32_16x16x32_bf16 v[80:83], v[176:179], v[28:31], v[80:83]
 v_mfma_f32_16x16x32_bf16 v[84:87], v[180:183], v[28:31], v[84:87]
 v_mfma_f32_16x16x32_bf16 v[88:91], v[184:187], v[28:31], v[88:91]
 v_mfma_f32_16x16x32_bf16 v[92:95], v[188:191], v[28:31], v[92:95]
 v_rcp_f32 v124, v124
 s_add_u32 s45, s56, 4096
 v_mul_f32 v64, v64, v124
 v_mul_f32 v65, v65, v124
 v_mul_f32 v66, v66, v124
 v_mul_f32 v67, v67, v124
 v_mul_f32 v68, v68, v124
 v_mul_f32 v69, v69, v124
 v_mul_f32 v70, v70, v124
 v_mul_f32 v71, v71, v124
 v_cvt_pk_bf16_f32 v96, v64, v65
 v_cvt_pk_bf16_f32 v97, v68, v69
 v_cvt_pk_bf16_f32 v98, v66, v67
 v_cvt_pk_bf16_f32 v99, v70, v71
 buffer_store_dwordx4 v[96:99], v1, s[20:23], s56 offen offset:0 sc1
 v_mul_f32 v72, v72, v124
 v_mul_f32 v73, v73, v124
 v_mul_f32 v74, v74, v124
 v_mul_f32 v75, v75, v124
 v_mul_f32 v76, v76, v124
 v_mul_f32 v77, v77, v124
 v_mul_f32 v78, v78, v124
 v_mul_f32 v79, v79, v124
 v_cvt_pk_bf16_f32 v100, v72, v73
 v_cvt_pk_bf16_f32 v101, v76, v77
 v_cvt_pk_bf16_f32 v102, v74, v75
 v_cvt_pk_bf16_f32 v103, v78, v79
 buffer_store_dwordx4 v[100:103], v1, s[20:23], s56 offen offset:2048 sc1
 v_mul_f32 v80, v80, v124
 v_mul_f32 v81, v81, v124
 v_mul_f32 v82, v82, v124
 v_mul_f32 v83, v83, v124
 v_mul_f32 v84, v84, v124
 v_mul_f32 v85, v85, v124
 v_mul_f32 v86, v86, v124
 v_mul_f32 v87, v87, v124
 v_cvt_pk_bf16_f32 v104, v80, v81
 v_cvt_pk_bf16_f32 v105, v84, v85
 v_cvt_pk_bf16_f32 v106, v82, v83
 v_cvt_pk_bf16_f32 v107, v86, v87
 buffer_store_dwordx4 v[104:107], v1, s[20:23], s45 offen offset:0 sc1
 v_mul_f32 v88, v88, v124
 v_mul_f32 v89, v89, v124
 v_mul_f32 v90, v90, v124
 v_mul_f32 v91, v91, v124
 v_mul_f32 v92, v92, v124
 v_mul_f32 v93, v93, v124
 v_mul_f32 v94, v94, v124
 v_mul_f32 v95, v95, v124
 v_cvt_pk_bf16_f32 v108, v88, v89
 v_cvt_pk_bf16_f32 v109, v92, v93
 v_cvt_pk_bf16_f32 v110, v90, v91
 v_cvt_pk_bf16_f32 v111, v94, v95
 buffer_store_dwordx4 v[108:111], v1, s[20:23], s45 offen offset:2048 sc1
 v_mfma_f32_16x16x32_bf16 v[64:67], a[0:3], v[48:51], 0
 ds_read_b128 v[32:35], v6 offset:4096
 v_mfma_f32_16x16x32_bf16 v[72:75], a[72:75], v[48:51], 0
 ds_read_b128 v[36:39], v6 offset:6144
 v_mfma_f32_16x16x32_bf16 v[80:83], a[144:147], v[48:51], 0
 s_add_u32 s41, s40, 2
 v_mfma_f32_16x16x32_bf16 v[88:91], a[216:219], v[48:51], 0
 s_add_u32 s45, s42, 2
 s_mul_i32 s46, s41, 36864
 v_mfma_f32_16x16x32_bf16 v[68:71], a[0:3], v[52:55], 0
 s_cmp_lt_u32 s45, s36
 s_cselect_b32 s46, s46, 0
 v_mfma_f32_16x16x32_bf16 v[76:79], a[72:75], v[52:55], 0
 s_lshl_b32 s49, s4, 10
 s_add_u32 s49, s49, s44
 v_mfma_f32_16x16x32_bf16 v[84:87], a[144:147], v[52:55], 0
 s_lshl_b32 s53, s39, 19
 s_add_u32 s53, s53, s61
 v_mfma_f32_16x16x32_bf16 v[92:95], a[216:219], v[52:55], 0
 s_waitcnt lgkmcnt(2)
 v_mfma_f32_16x16x32_bf16 v[64:67], a[4:7], v[56:59], v[64:67]
 ds_read_b128 v[40:43], v7 offset:4096
 v_mfma_f32_16x16x32_bf16 v[72:75], a[76:79], v[56:59], v[72:75]
 ds_read_b128 v[44:47], v7 offset:6144
 v_mfma_f32_16x16x32_bf16 v[80:83], a[148:151], v[56:59], v[80:83]
 s_add_u32 m0, s49, 0
 v_mfma_f32_16x16x32_bf16 v[88:91], a[220:223], v[56:59], v[88:91]
 buffer_load_dwordx4 v10, s[8:11], s46 offen offset:0  lds
 v_mfma_f32_16x16x32_bf16 v[68:71], a[4:7], v[60:63], v[68:71]
 s_add_u32 m0, s49, 3968
 v_mfma_f32_16x16x32_bf16 v[76:79], a[76:79], v[60:63], v[76:79]
 buffer_load_dwordx4 v10, s[8:11], s46 offen offset:128  lds
 v_mfma_f32_16x16x32_bf16 v[84:87], a[148:151], v[60:63], v[84:87]
 s_lshl_b32 s55, s39, 17
 s_add_u32 s55, s55, s62
 v_mfma_f32_16x16x32_bf16 v[92:95], a[220:223], v[60:63], v[92:95]
 s_waitcnt lgkmcnt(2)
 v_mfma_f32_16x16x32_bf16 v[64:67], a[8:11], v[32:35], v[64:67]
 ds_read_b128 v[48:51], v6 offset:8192
 v_mfma_f32_16x16x32_bf16 v[72:75], a[80:83], v[32:35], v[72:75]
 ds_read_b128 v[52:55], v6 offset:10240
 v_mfma_f32_16x16x32_bf16 v[80:83], a[152:155], v[32:35], v[80:83]
 s_add_u32 m0, s49, 7936
 v_mfma_f32_16x16x32_bf16 v[88:91], a[224:227], v[32:35], v[88:91]
 buffer_load_dwordx4 v10, s[8:11], s46 offen offset:256  lds
 v_mfma_f32_16x16x32_bf16 v[68:71], a[8:11], v[36:39], v[68:71]
 s_add_u32 m0, s49, 11904
 v_mfma_f32_16x16x32_bf16 v[76:79], a[80:83], v[36:39], v[76:79]
 buffer_load_dwordx4 v10, s[8:11], s46 offen offset:384  lds
 v_mfma_f32_16x16x32_bf16 v[84:87], a[152:155], v[36:39], v[84:87]
 v_mfma_f32_16x16x32_bf16 v[92:95], a[224:227], v[36:39], v[92:95]
 s_waitcnt lgkmcnt(2)
 v_mfma_f32_16x16x32_bf16 v[64:67], a[12:15], v[40:43], v[64:67]
 ds_read_b128 v[56:59], v7 offset:8192
 v_mfma_f32_16x16x32_bf16 v[72:75], a[84:87], v[40:43], v[72:75]
 ds_read_b128 v[60:63], v7 offset:10240
 v_mfma_f32_16x16x32_bf16 v[80:83], a[156:159], v[40:43], v[80:83]
 s_add_u32 m0, s49, 15872
 v_mfma_f32_16x16x32_bf16 v[88:91], a[228:231], v[40:43], v[88:91]
 buffer_load_dwordx4 v10, s[8:11], s46 offen offset:512  lds
 v_mfma_f32_16x16x32_bf16 v[68:71], a[12:15], v[44:47], v[68:71]
 s_add_u32 m0, s49, 19840
 v_mfma_f32_16x16x32_bf16 v[76:79], a[84:87], v[44:47], v[76:79]
 buffer_load_dwordx4 v10, s[8:11], s46 offen offset:640  lds
 v_mfma_f32_16x16x32_bf16 v[84:87], a[156:159], v[44:47], v[84:87]
 s_add_u32 s60, s39, 1
 v_mfma_f32_16x16x32_bf16 v[92:95], a[228:231], v[44:47], v[92:95]
 s_waitcnt lgkmcnt(2)
 v_mfma_f32_16x16x32_bf16 v[64:67], a[16:19], v[48:51], v[64:67]
 ds_read_b128 v[32:35], v6 offset:12288
 v_mfma_f32_16x16x32_bf16 v[72:75], a[88:91], v[48:51], v[72:75]
 ds_read_b128 v[36:39], v6 offset:14336
 v_mfma_f32_16x16x32_bf16 v[80:83], a[160:163], v[48:51], v[80:83]
 s_add_u32 m0, s49, 23808
 v_mfma_f32_16x16x32_bf16 v[88:91], a[232:235], v[48:51], v[88:91]
 buffer_load_dwordx4 v10, s[8:11], s46 offen offset:768  lds
 v_mfma_f32_16x16x32_bf16 v[68:71], a[16:19], v[52:55], v[68:71]
 s_add_u32 m0, s49, 27776
 v_mfma_f32_16x16x32_bf16 v[76:79], a[88:91], v[52:55], v[76:79]
 buffer_load_dwordx4 v10, s[8:11], s46 offen offset:896  lds
 v_mfma_f32_16x16x32_bf16 v[84:87], a[160:163], v[52:55], v[84:87]
 v_mfma_f32_16x16x32_bf16 v[92:95], a[232:235], v[52:55], v[92:95]
 s_waitcnt lgkmcnt(2)
 v_mfma_f32_16x16x32_bf16 v[64:67], a[20:23], v[56:59], v[64:67]
 ds_read_b128 v[40:43], v7 offset:12288
 v_mfma_f32_16x16x32_bf16 v[72:75], a[92:95], v[56:59], v[72:75]
 ds_read_b128 v[44:47], v7 offset:14336
 v_mfma_f32_16x16x32_bf16 v[80:83], a[164:167], v[56:59], v[80:83]
 s_add_u32 m0, s49, 31744
 v_mfma_f32_16x16x32_bf16 v[88:91], a[236:239], v[56:59], v[88:91]
 buffer_load_dwordx4 v10, s[8:11], s46 offen offset:1024  lds
 v_mfma_f32_16x16x32_bf16 v[68:71], a[20:23], v[60:63], v[68:71]
 v_mfma_f32_16x16x32_bf16 v[76:79], a[92:95], v[60:63], v[76:79]
 v_mfma_f32_16x16x32_bf16 v[84:87], a[164:167], v[60:63], v[84:87]
 v_mfma_f32_16x16x32_bf16 v[92:95], a[236:239], v[60:63], v[92:95]
 s_waitcnt lgkmcnt(2)
 v_mfma_f32_16x16x32_bf16 v[64:67], a[24:27], v[32:35], v[64:67]
 ds_read_b128 v[48:51], v6 offset:16384
 v_mfma_f32_16x16x32_bf16 v[72:75], a[96:99], v[32:35], v[72:75]
 ds_read_b128 v[52:55], v6 offset:18432
 v_mfma_f32_16x16x32_bf16 v[80:83], a[168:171], v[32:35], v[80:83]
 s_waitcnt vmcnt(9)
 buffer_load_dword v17, v11, s[20:23], s56 offen sc1
 v_mfma_f32_16x16x32_bf16 v[88:91], a[240:243], v[32:35], v[88:91]
 s_barrier
 buffer_store_dword v14, v8, s[20:23], s59 offen sc1
 v_mfma_f32_16x16x32_bf16 v[68:71], a[24:27], v[36:39], v[68:71]
 buffer_load_dword v16, v15, s[20:23], s57 offen sc1
 v_mfma_f32_16x16x32_bf16 v[76:79], a[96:99], v[36:39], v[76:79]
 v_mfma_f32_16x16x32_bf16 v[84:87], a[168:171], v[36:39], v[84:87]
 s_lshl_b32 s56, s39, 18
 s_add_u32 s56, s56, s63
 v_mfma_f32_16x16x32_bf16 v[92:95], a[240:243], v[36:39], v[92:95]
 s_waitcnt lgkmcnt(2)
 v_mfma_f32_16x16x32_bf16 v[64:67], a[28:31], v[40:43], v[64:67]
 ds_read_b128 v[56:59], v7 offset:16384
 v_mfma_f32_16x16x32_bf16 v[72:75], a[100:103], v[40:43], v[72:75]
 ds_read_b128 v[60:63], v7 offset:18432
 v_mfma_f32_16x16x32_bf16 v[80:83], a[172:175], v[40:43], v[80:83]
 buffer_load_dwordx4 v[128:131], v1, s[20:23], s53 offen offset:0 sc1
 v_mfma_f32_16x16x32_bf16 v[88:91], a[244:247], v[40:43], v[88:91]
 v_mfma_f32_16x16x32_bf16 v[68:71], a[28:31], v[44:47], v[68:71]
 buffer_load_dwordx4 v[132:135], v1, s[20:23], s53 offen offset:1024 sc1
 v_mfma_f32_16x16x32_bf16 v[76:79], a[100:103], v[44:47], v[76:79]
 v_mfma_f32_16x16x32_bf16 v[84:87], a[172:175], v[44:47], v[84:87]
 v_mfma_f32_16x16x32_bf16 v[92:95], a[244:247], v[44:47], v[92:95]
 s_waitcnt lgkmcnt(2)
 v_mfma_f32_16x16x32_bf16 v[64:67], a[32:35], v[48:51], v[64:67]
 ds_read_b128 v[32:35], v6 offset:20480
 v_mfma_f32_16x16x32_bf16 v[72:75], a[104:107], v[48:51], v[72:75]
 ds_read_b128 v[36:39], v6 offset:22528
 v_mfma_f32_16x16x32_bf16 v[80:83], a[176:179], v[48:51], v[80:83]
 buffer_load_dwordx4 v[136:139], v1, s[20:23], s53 offen offset:2048 sc1
 v_mfma_f32_16x16x32_bf16 v[88:91], a[248:251], v[48:51], v[88:91]
 v_mfma_f32_16x16x32_bf16 v[68:71], a[32:35], v[52:55], v[68:71]
 buffer_load_dwordx4 v[140:143], v1, s[20:23], s53 offen offset:3072 sc1
 v_mfma_f32_16x16x32_bf16 v[76:79], a[104:107], v[52:55], v[76:79]
 v_mfma_f32_16x16x32_bf16 v[84:87], a[176:179], v[52:55], v[84:87]
 s_add_u32 s53, s53, 4096
 v_mfma_f32_16x16x32_bf16 v[92:95], a[248:251], v[52:55], v[92:95]
 s_waitcnt lgkmcnt(2)
 v_mfma_f32_16x16x32_bf16 v[64:67], a[36:39], v[56:59], v[64:67]
 ds_read_b128 v[40:43], v7 offset:20480
 v_mfma_f32_16x16x32_bf16 v[72:75], a[108:111], v[56:59], v[72:75]
 ds_read_b128 v[44:47], v7 offset:22528
 v_mfma_f32_16x16x32_bf16 v[80:83], a[180:183], v[56:59], v[80:83]
 buffer_load_dwordx4 v[144:147], v1, s[20:23], s53 offen offset:0 sc1
 v_mfma_f32_16x16x32_bf16 v[88:91], a[252:255], v[56:59], v[88:91]
 v_mfma_f32_16x16x32_bf16 v[68:71], a[36:39], v[60:63], v[68:71]
 buffer_load_dwordx4 v[148:151], v1, s[20:23], s53 offen offset:1024 sc1
 v_mfma_f32_16x16x32_bf16 v[76:79], a[108:111], v[60:63], v[76:79]
 v_mfma_f32_16x16x32_bf16 v[84:87], a[180:183], v[60:63], v[84:87]
 v_mfma_f32_16x16x32_bf16 v[92:95], a[252:255], v[60:63], v[92:95]
 s_waitcnt lgkmcnt(2)
 v_mfma_f32_16x16x32_bf16 v[64:67], a[40:43], v[32:35], v[64:67]
 ds_read_b128 v[48:51], v6 offset:24576
 v_mfma_f32_16x16x32_bf16 v[72:75], a[112:115], v[32:35], v[72:75]
 ds_read_b128 v[52:55], v6 offset:26624
 v_mfma_f32_16x16x32_bf16 v[80:83], a[184:187], v[32:35], v[80:83]
 buffer_load_dwordx4 v[152:155], v1, s[20:23], s53 offen offset:2048 sc1
 v_mfma_f32_16x16x32_bf16 v[88:91], v[224:227], v[32:35], v[88:91]
 v_mfma_f32_16x16x32_bf16 v[68:71], a[40:43], v[36:39], v[68:71]
 buffer_load_dwordx4 v[156:159], v1, s[20:23], s53 offen offset:3072 sc1
 v_mfma_f32_16x16x32_bf16 v[76:79], a[112:115], v[36:39], v[76:79]
 v_mfma_f32_16x16x32_bf16 v[84:87], a[184:187], v[36:39], v[84:87]
 s_add_u32 s53, s53, 4096
 v_mfma_f32_16x16x32_bf16 v[92:95], v[224:227], v[36:39], v[92:95]
 s_waitcnt lgkmcnt(2)
 v_mfma_f32_16x16x32_bf16 v[64:67], a[44:47], v[40:43], v[64:67]
 ds_read_b128 v[56:59], v7 offset:24576
 v_mfma_f32_16x16x32_bf16 v[72:75], a[116:119], v[40:43], v[72:75]
 ds_read_b128 v[60:63], v7 offset:26624
 v_mfma_f32_16x16x32_bf16 v[80:83], a[188:191], v[40:43], v[80:83]
 buffer_load_dwordx4 v[160:163], v1, s[20:23], s53 offen offset:0 sc1
 v_mfma_f32_16x16x32_bf16 v[88:91], v[228:231], v[40:43], v[88:91]
 v_mfma_f32_16x16x32_bf16 v[68:71], a[44:47], v[44:47], v[68:71]
 buffer_load_dwordx4 v[164:167], v1, s[20:23], s53 offen offset:1024 sc1
 v_mfma_f32_16x16x32_bf16 v[76:79], a[116:119], v[44:47], v[76:79]
 v_mfma_f32_16x16x32_bf16 v[84:87], a[188:191], v[44:47], v[84:87]
 v_mfma_f32_16x16x32_bf16 v[92:95], v[228:231], v[44:47], v[92:95]
 s_waitcnt lgkmcnt(2)
 v_mfma_f32_16x16x32_bf16 v[64:67], a[48:51], v[48:51], v[64:67]
 ds_read_b128 v[32:35], v6 offset:28672
 v_mfma_f32_16x16x32_bf16 v[72:75], a[120:123], v[48:51], v[72:75]
 ds_read_b128 v[36:39], v6 offset:30720
 v_mfma_f32_16x16x32_bf16 v[80:83], a[192:195], v[48:51], v[80:83]
 buffer_load_dwordx4 v[168:171], v1, s[20:23], s53 offen offset:2048 sc1
 v_mfma_f32_16x16x32_bf16 v[88:91], v[232:235], v[48:51], v[88:91]
 v_mfma_f32_16x16x32_bf16 v[68:71], a[48:51], v[52:55], v[68:71]
 buffer_load_dwordx4 v[172:175], v1, s[20:23], s53 offen offset:3072 sc1
 v_mfma_f32_16x16x32_bf16 v[76:79], a[120:123], v[52:55], v[76:79]
 v_mfma_f32_16x16x32_bf16 v[84:87], a[192:195], v[52:55], v[84:87]
 s_add_u32 s53, s53, 4096
 v_mfma_f32_16x16x32_bf16 v[92:95], v[232:235], v[52:55], v[92:95]
 s_waitcnt lgkmcnt(2)
 v_mfma_f32_16x16x32_bf16 v[64:67], a[52:55], v[56:59], v[64:67]
 ds_read_b128 v[40:43], v7 offset:28672
 v_mfma_f32_16x16x32_bf16 v[72:75], a[124:127], v[56:59], v[72:75]
 ds_read_b128 v[44:47], v7 offset:30720
 v_mfma_f32_16x16x32_bf16 v[80:83], a[196:199], v[56:59], v[80:83]
 s_add_u32 s43, s43, 36864
 s_cmp_eq_u32 s43, 147456
 buffer_load_dwordx4 v[176:179], v1, s[20:23], s53 offen offset:0 sc1
 v_mfma_f32_16x16x32_bf16 v[88:91], v[236:239], v[56:59], v[88:91]
 s_cselect_b32 s43, 0, s43
 s_add_u32 s44, s44, 36864
 v_mfma_f32_16x16x32_bf16 v[68:71], a[52:55], v[60:63], v[68:71]
 s_cmp_eq_u32 s44, 147456
 s_cselect_b32 s44, 0, s44
 buffer_load_dwordx4 v[180:183], v1, s[20:23], s53 offen offset:1024 sc1
 v_mfma_f32_16x16x32_bf16 v[76:79], a[124:127], v[60:63], v[76:79]
 v_mfma_f32_16x16x32_bf16 v[84:87], a[196:199], v[60:63], v[84:87]
 v_mfma_f32_16x16x32_bf16 v[92:95], v[236:239], v[60:63], v[92:95]
 s_waitcnt lgkmcnt(2)
 v_mfma_f32_16x16x32_bf16 v[64:67], a[56:59], v[32:35], v[64:67]
 ds_read_b128 v[48:51], v6 offset:32768
 v_mfma_f32_16x16x32_bf16 v[72:75], a[128:131], v[32:35], v[72:75]
 ds_read_b128 v[52:55], v6 offset:34816
 v_mfma_f32_16x16x32_bf16 v[80:83], a[200:203], v[32:35], v[80:83]
 v_add_u32 v6, s43, v4
 buffer_load_dwordx4 v[184:187], v1, s[20:23], s53 offen offset:2048 sc1
 v_mfma_f32_16x16x32_bf16 v[88:91], v[240:243], v[32:35], v[88:91]
 v_mfma_f32_16x16x32_bf16 v[68:71], a[56:59], v[36:39], v[68:71]
 buffer_load_dwordx4 v[188:191], v1, s[20:23], s53 offen offset:3072 sc1
 v_mfma_f32_16x16x32_bf16 v[76:79], a[128:131], v[36:39], v[76:79]
 v_mfma_f32_16x16x32_bf16 v[84:87], a[200:203], v[36:39], v[84:87]
 v_mfma_f32_16x16x32_bf16 v[92:95], v[240:243], v[36:39], v[92:95]
 s_waitcnt lgkmcnt(2)
 v_mfma_f32_16x16x32_bf16 v[64:67], a[60:63], v[40:43], v[64:67]
 ds_read_b128 v[56:59], v7 offset:32768
 v_mfma_f32_16x16x32_bf16 v[72:75], a[132:135], v[40:43], v[72:75]
 ds_read_b128 v[60:63], v7 offset:34816
 v_mfma_f32_16x16x32_bf16 v[80:83], a[204:207], v[40:43], v[80:83]
 v_add_u32 v7, s43, v5
 v_mfma_f32_16x16x32_bf16 v[88:91], v[244:247], v[40:43], v[88:91]
 v_mfma_f32_16x16x32_bf16 v[68:71], a[60:63], v[44:47], v[68:71]
 v_mfma_f32_16x16x32_bf16 v[76:79], a[132:135], v[44:47], v[76:79]
 v_mfma_f32_16x16x32_bf16 v[84:87], a[204:207], v[44:47], v[84:87]
 v_mfma_f32_16x16x32_bf16 v[92:95], v[244:247], v[44:47], v[92:95]
 s_waitcnt lgkmcnt(2)
 v_mfma_f32_16x16x32_bf16 v[64:67], a[64:67], v[48:51], v[64:67]
 s_waitcnt vmcnt(28)
 s_barrier
 ds_read_b128 v[32:35], v6 offset:0
 v_mfma_f32_16x16x32_bf16 v[72:75], a[136:139], v[48:51], v[72:75]
 ds_read_b128 v[36:39], v6 offset:2048
 v_mfma_f32_16x16x32_bf16 v[80:83], a[208:211], v[48:51], v[80:83]
 v_mfma_f32_16x16x32_bf16 v[88:91], v[248:251], v[48:51], v[88:91]
 s_waitcnt vmcnt(16)
 v_cmp_le_u32 vcc, s60, v16
 v_mfma_f32_16x16x32_bf16 v[68:71], a[64:67], v[52:55], v[68:71]
 v_mfma_f32_16x16x32_bf16 v[76:79], a[136:139], v[52:55], v[76:79]
 s_and_b32 s64, vcc_lo, 1
 s_cbranch_scc0 Lqsk_29
 buffer_load_dwordx4 v[192:195], v1, s[20:23], s55 offen offset:0 sc1
 buffer_load_dwordx4 v[196:199], v1, s[20:23], s55 offen offset:1024 sc1
 buffer_load_dwordx4 v[200:203], v1, s[20:23], s55 offen offset:2048 sc1
 buffer_load_dwordx4 v[204:207], v1, s[20:23], s55 offen offset:3072 sc1
Lqsk_29:
 v_mfma_f32_16x16x32_bf16 v[84:87], a[208:211], v[52:55], v[84:87]
 v_mfma_f32_16x16x32_bf16 v[92:95], v[248:251], v[52:55], v[92:95]
 s_waitcnt lgkmcnt(2)
 v_mfma_f32_16x16x32_bf16 v[64:67], a[68:71], v[56:59], v[64:67]
 ds_read_b128 v[40:43], v7 offset:0
 v_mfma_f32_16x16x32_bf16 v[72:75], a[140:143], v[56:59], v[72:75]
 ds_read_b128 v[44:47], v7 offset:2048
 v_mfma_f32_16x16x32_bf16 v[80:83], a[212:215], v[56:59], v[80:83]
 v_mfma_f32_16x16x32_bf16 v[88:91], v[252:255], v[56:59], v[88:91]
 s_mov_b32 s39, s40
 s_mov_b32 s40, s41
 v_mfma_f32_16x16x32_bf16 v[68:71], a[68:71], v[60:63], v[68:71]
 s_add_u32 s42, s42, 1
 v_mov_b32 v14, s42
 v_mfma_f32_16x16x32_bf16 v[76:79], a[140:143], v[60:63], v[76:79]
 v_mfma_f32_16x16x32_bf16 v[84:87], a[212:215], v[60:63], v[84:87]
 v_mfma_f32_16x16x32_bf16 v[92:95], v[252:255], v[60:63], v[92:95]
 s_waitcnt lgkmcnt(2)
 s_nop 3
 v_mul_f32 v64, s50, v64
 v_mul_f32 v65, s50, v65
 v_mul_f32 v66, s50, v66
 v_mul_f32 v67, s50, v67
 v_mul_f32 v72, s50, v72
 v_mul_f32 v73, s50, v73
 v_mul_f32 v74, s50, v74
 v_mul_f32 v75, s50, v75
 v_cvt_pk_bf16_f32 v16, v64, v65
 v_cvt_pk_bf16_f32 v17, v72, v73
 v_cvt_pk_bf16_f32 v18, v66, v67
 v_cvt_pk_bf16_f32 v19, v74, v75
 ds_write_b128 v2, v[16:19] offset:0
 v_mul_f32 v68, s50, v68
 v_mul_f32 v69, s50, v69
 v_mul_f32 v70, s50, v70
 v_mul_f32 v71, s50, v71
 v_mul_f32 v76, s50, v76
 v_mul_f32 v77, s50, v77
 v_mul_f32 v78, s50, v78
 v_mul_f32 v79, s50, v79
 v_cvt_pk_bf16_f32 v20, v68, v69
 v_cvt_pk_bf16_f32 v21, v76, v77
 v_cvt_pk_bf16_f32 v22, v70, v71
 v_cvt_pk_bf16_f32 v23, v78, v79
 ds_write_b128 v2, v[20:23] offset:1024
 v_mul_f32 v80, s50, v80
 v_mul_f32 v81, s50, v81
 v_mul_f32 v82, s50, v82
 v_mul_f32 v83, s50, v83
 v_mul_f32 v88, s50, v88
 v_mul_f32 v89, s50, v89
 v_mul_f32 v90, s50, v90
 v_mul_f32 v91, s50, v91
 v_cvt_pk_bf16_f32 v24, v80, v81
 v_cvt_pk_bf16_f32 v25, v88, v89
 v_cvt_pk_bf16_f32 v26, v82, v83
 v_cvt_pk_bf16_f32 v27, v90, v91
 ds_write_b128 v2, v[24:27] offset:8192
 v_mul_f32 v84, s50, v84
 v_mul_f32 v85, s50, v85
 v_mul_f32 v86, s50, v86
 v_mul_f32 v87, s50, v87
 v_mul_f32 v92, s50, v92
 v_mul_f32 v93, s50, v93
 v_mul_f32 v94, s50, v94
 v_mul_f32 v95, s50, v95
 v_cvt_pk_bf16_f32 v28, v84, v85
 v_cvt_pk_bf16_f32 v29, v92, v93
 v_cvt_pk_bf16_f32 v30, v86, v87
 v_cvt_pk_bf16_f32 v31, v94, v95
 ds_write_b128 v2, v[28:31] offset:9216
 v_mov_b64 v[120:121], 0
 v_mov_b64 v[122:123], 0
 s_waitcnt lgkmcnt(0)
 s_barrier
 ds_read_b128 v[96:99], v3 offset:0
 ds_read_b128 v[100:103], v3 offset:2048
 ds_read_b128 v[104:107], v3 offset:4096
 ds_read_b128 v[108:111], v3 offset:6144
 s_cmp_lg_u32 s64, 0
 s_cbranch_scc1 Lqpre_30
Lqs_31:
 buffer_load_dword v16, v15, s[20:23], s57 offen sc1
 s_waitcnt vmcnt(0)
 v_cmp_le_u32 vcc, s60, v16
 s_cbranch_vccnz Lqsk_32
 s_sleep 2
 s_sub_u32 s58, s58, 1
 s_cbranch_scc0 Lqs_31
 s_endpgm
Lqsk_32:
 buffer_load_dwordx4 v[192:195], v1, s[20:23], s55 offen offset:0 sc1
 buffer_load_dwordx4 v[196:199], v1, s[20:23], s55 offen offset:1024 sc1
 buffer_load_dwordx4 v[200:203], v1, s[20:23], s55 offen offset:2048 sc1
 buffer_load_dwordx4 v[204:207], v1, s[20:23], s55 offen offset:3072 sc1
Lqpre_30:
 s_waitcnt vmcnt(4) lgkmcnt(0)
 v_mfma_f32_16x16x32_bf16 v[112:115], v[128:131], v[96:99], v[208:211]
 v_mfma_f32_16x16x32_bf16 v[116:119], v[132:135], v[96:99], v[212:215]
 v_mfma_f32_16x16x32_bf16 v[112:115], v[136:139], v[100:103], v[112:115]
 v_mfma_f32_16x16x32_bf16 v[116:119], v[140:143], v[100:103], v[116:119]
 v_mfma_f32_16x16x32_bf16 v[112:115], v[144:147], v[104:107], v[112:115]
 v_mfma_f32_16x16x32_bf16 v[116:119], v[148:151], v[104:107], v[116:119]
 v_mfma_f32_16x16x32_bf16 v[112:115], v[152:155], v[108:111], v[112:115]
 v_mfma_f32_16x16x32_bf16 v[116:119], v[156:159], v[108:111], v[116:119]
 s_nop 7
 v_max3_f32 v24, v112, v113, v114
 v_max3_f32 v24, v24, v115, v116
 v_max3_f32 v24, v24, v117, v118
 v_max_f32 v24, v24, v119
 s_waitcnt vmcnt(2)
 v_mov_b64 v[16:17], v[192:193]
 v_mov_b64 v[18:19], v[196:197]
 s_nop 1
 v_smfmac_f32_16x16x64_bf16 v[120:123], v[16:19], v[96:103], v12
 s_waitcnt vmcnt(0)
 v_mov_b64 v[20:21], v[200:201]
 v_mov_b64 v[22:23], v[204:205]
 s_nop 1
 v_smfmac_f32_16x16x64_bf16 v[120:123], v[20:23], v[104:111], v12
 s_nop 7
 v_add_f32 v120, v120, v122
 v_add_f32 v121, v121, v123
 v_max3_f32 v24, v24, v120, v121
 v_mov_b32 v25, v24
 s_nop 1
 v_permlane16_swap_b32 v24, v25
 v_max_f32 v24, v24, v25
 v_mov_b32 v25, v24
 s_nop 1
 v_permlane32_swap_b32 v24, v25
 v_max_f32 v24, v24, v25
 v_sub_f32 v112, v112, v24
 v_sub_f32 v113, v113, v24
 v_sub_f32 v114, v114, v24
 v_sub_f32 v115, v115, v24
 v_sub_f32 v116, v116, v24
 v_sub_f32 v117, v117, v24
 v_sub_f32 v118, v118, v24
 v_sub_f32 v119, v119, v24
 v_sub_f32 v120, v120, v24
 v_sub_f32 v121, v121, v24
 v_exp_f32 v120, v120
 v_exp_f32 v121, v121
 v_exp_f32 v112, v112
 v_exp_f32 v113, v113
 v_exp_f32 v114, v114
 v_exp_f32 v115, v115
 v_exp_f32 v116, v116
 v_exp_f32 v117, v117
 v_exp_f32 v118, v118
 v_exp_f32 v119, v119
 v_cvt_pk_bf16_f32 v216, v120, v121
 v_cvt_pk_bf16_f32 v219, v120, v121
 v_cvt_pk_bf16_f32 v28, v112, v113
 v_cvt_pk_bf16_f32 v29, v116, v117
 v_cvt_pk_bf16_f32 v30, v114, v115
 v_cvt_pk_bf16_f32 v31, v118, v119
 v_mfma_f32_16x16x16_bf16 v[124:127], v[220:221], v[216:217], 0
 v_mfma_f32_16x16x16_bf16 v[64:67], v[194:195], v[216:217], 0
 v_mfma_f32_16x16x16_bf16 v[68:71], v[194:195], v[218:219], 0
 v_mfma_f32_16x16x16_bf16 v[72:75], v[198:199], v[216:217], 0
 v_mfma_f32_16x16x16_bf16 v[76:79], v[198:199], v[218:219], 0
 v_mfma_f32_16x16x16_bf16 v[80:83], v[202:203], v[216:217], 0
 v_mfma_f32_16x16x16_bf16 v[84:87], v[202:203], v[218:219], 0
 v_mfma_f32_16x16x16_bf16 v[88:91], v[206:207], v[216:217], 0
 v_mfma_f32_16x16x16_bf16 v[92:95], v[206:207], v[218:219], 0
 v_mfma_f32_16x16x32_bf16 v[124:127], v[220:223], v[28:31], v[124:127]
 v_mfma_f32_16x16x32_bf16 v[64:67], v[160:163], v[28:31], v[64:67]
 v_mfma_f32_16x16x32_bf16 v[68:71], v[164:167], v[28:31], v[68:71]
 v_mfma_f32_16x16x32_bf16 v[72:75], v[168:171], v[28:31], v[72:75]
 v_mfma_f32_16x16x32_bf16 v[76:79], v[172:175], v[28:31], v[76:79]
 v_mfma_f32_16x16x32_bf16 v[80:83], v[176:179], v[28:31], v[80:83]
 v_mfma_f32_16x16x32_bf16 v[84:87], v[180:183], v[28:31], v[84:87]
 v_mfma_f32_16x16x32_bf16 v[88:91], v[184:187], v[28:31], v[88:91]
 v_mfma_f32_16x16x32_bf16 v[92:95], v[188:191], v[28:31], v[92:95]
 v_rcp_f32 v124, v124
 s_add_u32 s45, s56, 4096
 v_mul_f32 v64, v64, v124
 v_mul_f32 v65, v65, v124
 v_mul_f32 v66, v66, v124
 v_mul_f32 v67, v67, v124
 v_mul_f32 v68, v68, v124
 v_mul_f32 v69, v69, v124
 v_mul_f32 v70, v70, v124
 v_mul_f32 v71, v71, v124
 v_cvt_pk_bf16_f32 v96, v64, v65
 v_cvt_pk_bf16_f32 v97, v68, v69
 v_cvt_pk_bf16_f32 v98, v66, v67
 v_cvt_pk_bf16_f32 v99, v70, v71
 buffer_store_dwordx4 v[96:99], v1, s[20:23], s56 offen offset:0 sc1
 v_mul_f32 v72, v72, v124
 v_mul_f32 v73, v73, v124
 v_mul_f32 v74, v74, v124
 v_mul_f32 v75, v75, v124
 v_mul_f32 v76, v76, v124
 v_mul_f32 v77, v77, v124
 v_mul_f32 v78, v78, v124
 v_mul_f32 v79, v79, v124
 v_cvt_pk_bf16_f32 v100, v72, v73
 v_cvt_pk_bf16_f32 v101, v76, v77
 v_cvt_pk_bf16_f32 v102, v74, v75
 v_cvt_pk_bf16_f32 v103, v78, v79
 buffer_store_dwordx4 v[100:103], v1, s[20:23], s56 offen offset:2048 sc1
 v_mul_f32 v80, v80, v124
 v_mul_f32 v81, v81, v124
 v_mul_f32 v82, v82, v124
 v_mul_f32 v83, v83, v124
 v_mul_f32 v84, v84, v124
 v_mul_f32 v85, v85, v124
 v_mul_f32 v86, v86, v124
 v_mul_f32 v87, v87, v124
 v_cvt_pk_bf16_f32 v104, v80, v81
 v_cvt_pk_bf16_f32 v105, v84, v85
 v_cvt_pk_bf16_f32 v106, v82, v83
 v_cvt_pk_bf16_f32 v107, v86, v87
 buffer_store_dwordx4 v[104:107], v1, s[20:23], s45 offen offset:0 sc1
 v_mul_f32 v88, v88, v124
 v_mul_f32 v89, v89, v124
 v_mul_f32 v90, v90, v124
 v_mul_f32 v91, v91, v124
 v_mul_f32 v92, v92, v124
 v_mul_f32 v93, v93, v124
 v_mul_f32 v94, v94, v124
 v_mul_f32 v95, v95, v124
 v_cvt_pk_bf16_f32 v108, v88, v89
 v_cvt_pk_bf16_f32 v109, v92, v93
 v_cvt_pk_bf16_f32 v110, v90, v91
 v_cvt_pk_bf16_f32 v111, v94, v95
 buffer_store_dwordx4 v[108:111], v1, s[20:23], s45 offen offset:2048 sc1
 s_cmp_lt_u32 s42, s36
 s_cbranch_scc1 Lqb_loop_24
 s_waitcnt vmcnt(0)
 buffer_load_dword v17, v11, s[20:23], s56 offen sc1
 s_barrier
 buffer_store_dword v14, v8, s[20:23], s59 offen sc1
 s_branch Lfin
Lob:
 s_load_dwordx2 s[8:9], s[0:1], 88
 s_mov_b32 s10, 0x480000
 s_mov_b32 s11, 0x20000
 s_sub_u32 s32, s6, 16
 s_mul_i32 s7, s3, 5
 s_add_u32 s7, s7, s6
 s_sub_u32 s7, s7, 25
 s_cmp_lt_u32 s6, 25
 s_cselect_b32 s32, s32, s7
 s_cselect_b32 s33, s3, 4
 s_cselect_b32 s34, 2, 1
 s_cselect_b32 s39, 6, 4
 s_cselect_b32 s35, 22, 20
 s_cselect_b32 s40, 0, 4
 s_mov_b32 s36, 0x7000000
 s_mov_b32 s37, 1152
 s_lshl_b32 s7, s4, 7
 s_add_u32 s38, s7, 0x3800
 s_mov_b32 s93, 1
 s_mov_b32 s92, 3
 s_mov_b32 s91, 9
 s_mov_b32 s90, 1
Los:
 s_load_dwordx2 s[24:25], s[0:1], 104
 s_mov_b32 s26, 0x480000
 s_mov_b32 s27, 0x20000
 s_waitcnt lgkmcnt(0)
 v_and_b32 v15, 63, v0
 v_lshlrev_b32 v1, 4, v15
 v_and_b32 v3, s92, v15
 v_lshlrev_b32 v3, 2, v3
 v_lshrrev_b32 v14, 4, v15
 v_min_u32 v14, 1, v14
 v_lshl_or_b32 v3, v14, 28, v3
 s_add_u32 s44, s32, s40
 s_and_b32 s44, s44, 7
 s_mov_b32 s50, 0x40000
 s_mul_i32 s49, s4, 40960
 v_add_u32 v5, s49, v1
 v_bfe_u32 v14, v15, 5, 1
 v_bfe_u32 v16, v15, 3, 1
 v_lshl_add_u32 v14, v14, 1, v16
 v_bfe_u32 v16, v15, 4, 1
 v_lshl_add_u32 v14, v16, 6, v14
 v_mul_u32_u24 v14, 1152, v14
 v_bfe_u32 v17, v15, 1, 2
 v_xor_b32 v17, v17, v16
 v_lshlrev_b32 v17, 5, v17
 v_and_b32 v16, 1, v15
 v_lshl_add_u32 v17, v16, 4, v17
 v_add_u32 v8, v14, v17
 v_xor_b32 v17, 64, v17
 v_add_u32 v9, v14, v17
 v_lshrrev_b32 v14, 4, v15
 v_bfe_u32 v16, v15, 2, 2
 v_lshl_add_u32 v14, v14, 3, v16
 v_lshlrev_b32 v14, 7, v14
 v_bfe_u32 v16, v15, 3, 2
 v_lshl_add_u32 v14, v16, 5, v14
 v_and_b32 v16, 3, v15
 v_lshl_add_u32 v14, v16, 3, v14
 v_xor_b32 v16, 0, v14
 v_add_u32 v10, s49, v16
 v_xor_b32 v16, 32, v14
 v_add_u32 v11, s49, v16
 v_xor_b32 v16, 64, v14
 v_add_u32 v12, s49, v16
 v_xor_b32 v16, 96, v14
 v_add_u32 v13, s49, v16
 s_lshl_b32 s47, s32, 7
 s_add_u32 s46, s44, 0
 s_and_b32 s46, s46, 7
 s_lshl_b32 s45, s4, 3
 s_add_u32 s46, s46, s45
 s_mul_i32 s46, s46, 147456
 s_add_u32 s46, s46, s47
 s_add_u32 m0, s49, 8192
 s_add_u32 s45, s46, 0
 buffer_load_dwordx4 v8, s[8:11], s45 offen  lds
 s_add_u32 m0, s49, 9216
 s_add_u32 s45, s46, 4608
 buffer_load_dwordx4 v9, s[8:11], s45 offen  lds
 s_add_u32 m0, s49, 10240
 s_add_u32 s45, s46, 9216
 buffer_load_dwordx4 v8, s[8:11], s45 offen  lds
 s_add_u32 m0, s49, 11264
 s_add_u32 s45, s46, 13824
 buffer_load_dwordx4 v9, s[8:11], s45 offen  lds
 s_add_u32 m0, s49, 12288
 s_add_u32 s45, s46, 18432
 buffer_load_dwordx4 v8, s[8:11], s45 offen  lds
 s_add_u32 m0, s49, 13312
 s_add_u32 s45, s46, 23040
 buffer_load_dwordx4 v9, s[8:11], s45 offen  lds
 s_add_u32 m0, s49, 14336
 s_add_u32 s45, s46, 27648
 buffer_load_dwordx4 v8, s[8:11], s45 offen  lds
 s_add_u32 m0, s49, 15360
 s_add_u32 s45, s46, 32256
 buffer_load_dwordx4 v9, s[8:11], s45 offen  lds
 s_add_u32 m0, s49, 16384
 s_add_u32 s45, s46, 36864
 buffer_load_dwordx4 v8, s[8:11], s45 offen  lds
 s_add_u32 m0, s49, 17408
 s_add_u32 s45, s46, 41472
 buffer_load_dwordx4 v9, s[8:11], s45 offen  lds
 s_add_u32 m0, s49, 18432
 s_add_u32 s45, s46, 46080
 buffer_load_dwordx4 v8, s[8:11], s45 offen  lds
 s_add_u32 m0, s49, 19456
 s_add_u32 s45, s46, 50688
 buffer_load_dwordx4 v9, s[8:11], s45 offen  lds
 s_add_u32 m0, s49, 20480
 s_add_u32 s45, s46, 55296
 buffer_load_dwordx4 v8, s[8:11], s45 offen  lds
 s_add_u32 m0, s49, 21504
 s_add_u32 s45, s46, 59904
 buffer_load_dwordx4 v9, s[8:11], s45 offen  lds
 s_add_u32 m0, s49, 22528
 s_add_u32 s45, s46, 64512
 buffer_load_dwordx4 v8, s[8:11], s45 offen  lds
 s_add_u32 m0, s49, 23552
 s_add_u32 s45, s46, 69120
 buffer_load_dwordx4 v9, s[8:11], s45 offen  lds
 s_add_u32 s46, s44, 1
 s_and_b32 s46, s46, 7
 s_lshl_b32 s45, s4, 3
 s_add_u32 s46, s46, s45
 s_mul_i32 s46, s46, 147456
 s_add_u32 s46, s46, s47
 s_add_u32 m0, s49, 24576
 s_add_u32 s45, s46, 0
 buffer_load_dwordx4 v8, s[8:11], s45 offen  lds
 s_add_u32 m0, s49, 25600
 s_add_u32 s45, s46, 4608
 buffer_load_dwordx4 v9, s[8:11], s45 offen  lds
 s_add_u32 m0, s49, 26624
 s_add_u32 s45, s46, 9216
 buffer_load_dwordx4 v8, s[8:11], s45 offen  lds
 s_add_u32 m0, s49, 27648
 s_add_u32 s45, s46, 13824
 buffer_load_dwordx4 v9, s[8:11], s45 offen  lds
 s_add_u32 m0, s49, 28672
 s_add_u32 s45, s46, 18432
 buffer_load_dwordx4 v8, s[8:11], s45 offen  lds
 s_add_u32 m0, s49, 29696
 s_add_u32 s45, s46, 23040
 buffer_load_dwordx4 v9, s[8:11], s45 offen  lds
 s_add_u32 m0, s49, 30720
 s_add_u32 s45, s46, 27648
 buffer_load_dwordx4 v8, s[8:11], s45 offen  lds
 s_add_u32 m0, s49, 31744
 s_add_u32 s45, s46, 32256
 buffer_load_dwordx4 v9, s[8:11], s45 offen  lds
 s_waitcnt vmcnt(20) lgkmcnt(0)
 s_add_u32 m0, s49, 32768
 s_add_u32 s45, s46, 36864
 buffer_load_dwordx4 v8, s[8:11], s45 offen  lds
 s_add_u32 m0, s49, 33792
 s_add_u32 s45, s46, 41472
 buffer_load_dwordx4 v9, s[8:11], s45 offen  lds
 s_add_u32 m0, s49, 34816
 s_add_u32 s45, s46, 46080
 buffer_load_dwordx4 v8, s[8:11], s45 offen  lds
 s_add_u32 m0, s49, 35840
 s_add_u32 s45, s46, 50688
 buffer_load_dwordx4 v9, s[8:11], s45 offen  lds
 ds_read_b64_tr_b16 a[0:1], v10 offset:8192
 ds_read_b64_tr_b16 a[2:3], v10 offset:8704
 ds_read_b64_tr_b16 a[4:5], v11 offset:8192
 ds_read_b64_tr_b16 a[6:7], v11 offset:8704
 ds_read_b64_tr_b16 a[8:9], v12 offset:8192
 ds_read_b64_tr_b16 a[10:11], v12 offset:8704
 ds_read_b64_tr_b16 v[16:17], v13 offset:8192
 ds_read_b64_tr_b16 v[18:19], v13 offset:8704
 s_waitcnt vmcnt(20) lgkmcnt(0)
 s_add_u32 m0, s49, 36864
 s_add_u32 s45, s46, 55296
 buffer_load_dwordx4 v8, s[8:11], s45 offen  lds
 s_add_u32 m0, s49, 37888
 s_add_u32 s45, s46, 59904
 buffer_load_dwordx4 v9, s[8:11], s45 offen  lds
 s_add_u32 m0, s49, 38912
 s_add_u32 s45, s46, 64512
 buffer_load_dwordx4 v8, s[8:11], s45 offen  lds
 s_add_u32 m0, s49, 39936
 s_add_u32 s45, s46, 69120
 buffer_load_dwordx4 v9, s[8:11], s45 offen  lds
 ds_write_b128 v5, v[16:19] offset:0
 ds_read_b64_tr_b16 a[12:13], v10 offset:12288
 ds_read_b64_tr_b16 a[14:15], v10 offset:12800
 ds_read_b64_tr_b16 a[16:17], v11 offset:12288
 ds_read_b64_tr_b16 a[18:19], v11 offset:12800
 ds_read_b64_tr_b16 a[20:21], v12 offset:12288
 ds_read_b64_tr_b16 a[22:23], v12 offset:12800
 ds_read_b64_tr_b16 v[20:21], v13 offset:12288
 ds_read_b64_tr_b16 v[22:23], v13 offset:12800
 s_waitcnt vmcnt(20) lgkmcnt(0)
 s_add_u32 s46, s44, 2
 s_and_b32 s46, s46, 7
 s_lshl_b32 s45, s4, 3
 s_add_u32 s46, s46, s45
 s_mul_i32 s46, s46, 147456
 s_add_u32 s46, s46, s47
 s_add_u32 m0, s49, 8192
 s_add_u32 s45, s46, 0
 buffer_load_dwordx4 v8, s[8:11], s45 offen  lds
 s_add_u32 m0, s49, 9216
 s_add_u32 s45, s46, 4608
 buffer_load_dwordx4 v9, s[8:11], s45 offen  lds
 s_add_u32 m0, s49, 10240
 s_add_u32 s45, s46, 9216
 buffer_load_dwordx4 v8, s[8:11], s45 offen  lds
 s_add_u32 m0, s49, 11264
 s_add_u32 s45, s46, 13824
 buffer_load_dwordx4 v9, s[8:11], s45 offen  lds
 ds_write_b128 v5, v[20:23] offset:1024
 ds_read_b64_tr_b16 a[24:25], v10 offset:16384
 ds_read_b64_tr_b16 a[26:27], v10 offset:16896
 ds_read_b64_tr_b16 a[28:29], v11 offset:16384
 ds_read_b64_tr_b16 a[30:31], v11 offset:16896
 ds_read_b64_tr_b16 a[32:33], v12 offset:16384
 ds_read_b64_tr_b16 a[34:35], v12 offset:16896
 ds_read_b64_tr_b16 v[16:17], v13 offset:16384
 ds_read_b64_tr_b16 v[18:19], v13 offset:16896
 s_waitcnt vmcnt(20) lgkmcnt(0)
 s_add_u32 m0, s49, 12288
 s_add_u32 s45, s46, 18432
 buffer_load_dwordx4 v8, s[8:11], s45 offen  lds
 s_add_u32 m0, s49, 13312
 s_add_u32 s45, s46, 23040
 buffer_load_dwordx4 v9, s[8:11], s45 offen  lds
 s_add_u32 m0, s49, 14336
 s_add_u32 s45, s46, 27648
 buffer_load_dwordx4 v8, s[8:11], s45 offen  lds
 s_add_u32 m0, s49, 15360
 s_add_u32 s45, s46, 32256
 buffer_load_dwordx4 v9, s[8:11], s45 offen  lds
 ds_write_b128 v5, v[16:19] offset:2048
 ds_read_b64_tr_b16 a[36:37], v10 offset:20480
 ds_read_b64_tr_b16 a[38:39], v10 offset:20992
 ds_read_b64_tr_b16 a[40:41], v11 offset:20480
 ds_read_b64_tr_b16 a[42:43], v11 offset:20992
 ds_read_b64_tr_b16 a[44:45], v12 offset:20480
 ds_read_b64_tr_b16 a[46:47], v12 offset:20992
 ds_read_b64_tr_b16 v[20:21], v13 offset:20480
 ds_read_b64_tr_b16 v[22:23], v13 offset:20992
 s_waitcnt vmcnt(20) lgkmcnt(0)
 s_add_u32 m0, s49, 16384
 s_add_u32 s45, s46, 36864
 buffer_load_dwordx4 v8, s[8:11], s45 offen  lds
 s_add_u32 m0, s49, 17408
 s_add_u32 s45, s46, 41472
 buffer_load_dwordx4 v9, s[8:11], s45 offen  lds
 s_add_u32 m0, s49, 18432
 s_add_u32 s45, s46, 46080
 buffer_load_dwordx4 v8, s[8:11], s45 offen  lds
 s_add_u32 m0, s49, 19456
 s_add_u32 s45, s46, 50688
 buffer_load_dwordx4 v9, s[8:11], s45 offen  lds
 ds_write_b128 v5, v[20:23] offset:3072
 ds_read_b64_tr_b16 a[48:49], v10 offset:24576
 ds_read_b64_tr_b16 a[50:51], v10 offset:25088
 ds_read_b64_tr_b16 a[52:53], v11 offset:24576
 ds_read_b64_tr_b16 a[54:55], v11 offset:25088
 ds_read_b64_tr_b16 a[56:57], v12 offset:24576
 ds_read_b64_tr_b16 a[58:59], v12 offset:25088
 ds_read_b64_tr_b16 v[16:17], v13 offset:24576
 ds_read_b64_tr_b16 v[18:19], v13 offset:25088
 s_waitcnt vmcnt(20) lgkmcnt(0)
 s_add_u32 m0, s49, 20480
 s_add_u32 s45, s46, 55296
 buffer_load_dwordx4 v8, s[8:11], s45 offen  lds
 s_add_u32 m0, s49, 21504
 s_add_u32 s45, s46, 59904
 buffer_load_dwordx4 v9, s[8:11], s45 offen  lds
 s_add_u32 m0, s49, 22528
 s_add_u32 s45, s46, 64512
 buffer_load_dwordx4 v8, s[8:11], s45 offen  lds
 s_add_u32 m0, s49, 23552
 s_add_u32 s45, s46, 69120
 buffer_load_dwordx4 v9, s[8:11], s45 offen  lds
 ds_write_b128 v5, v[16:19] offset:4096
 ds_read_b64_tr_b16 a[60:61], v10 offset:28672
 ds_read_b64_tr_b16 a[62:63], v10 offset:29184
 ds_read_b64_tr_b16 a[64:65], v11 offset:28672
 ds_read_b64_tr_b16 a[66:67], v11 offset:29184
 ds_read_b64_tr_b16 a[68:69], v12 offset:28672
 ds_read_b64_tr_b16 a[70:71], v12 offset:29184
 ds_read_b64_tr_b16 v[20:21], v13 offset:28672
 ds_read_b64_tr_b16 v[22:23], v13 offset:29184
 s_waitcnt vmcnt(20) lgkmcnt(0)
 s_add_u32 s46, s44, 3
 s_and_b32 s46, s46, 7
 s_lshl_b32 s45, s4, 3
 s_add_u32 s46, s46, s45
 s_mul_i32 s46, s46, 147456
 s_add_u32 s46, s46, s47
 s_add_u32 m0, s49, 24576
 s_add_u32 s45, s46, 0
 buffer_load_dwordx4 v8, s[8:11], s45 offen  lds
 s_add_u32 m0, s49, 25600
 s_add_u32 s45, s46, 4608
 buffer_load_dwordx4 v9, s[8:11], s45 offen  lds
 s_add_u32 m0, s49, 26624
 s_add_u32 s45, s46, 9216
 buffer_load_dwordx4 v8, s[8:11], s45 offen  lds
 s_add_u32 m0, s49, 27648
 s_add_u32 s45, s46, 13824
 buffer_load_dwordx4 v9, s[8:11], s45 offen  lds
 ds_write_b128 v5, v[20:23] offset:5120
 ds_read_b64_tr_b16 a[72:73], v10 offset:32768
 ds_read_b64_tr_b16 a[74:75], v10 offset:33280
 ds_read_b64_tr_b16 a[76:77], v11 offset:32768
 ds_read_b64_tr_b16 a[78:79], v11 offset:33280
 ds_read_b64_tr_b16 a[80:81], v12 offset:32768
 ds_read_b64_tr_b16 a[82:83], v12 offset:33280
 ds_read_b64_tr_b16 v[16:17], v13 offset:32768
 ds_read_b64_tr_b16 v[18:19], v13 offset:33280
 s_waitcnt vmcnt(20) lgkmcnt(0)
 s_add_u32 m0, s49, 28672
 s_add_u32 s45, s46, 18432
 buffer_load_dwordx4 v8, s[8:11], s45 offen  lds
 s_add_u32 m0, s49, 29696
 s_add_u32 s45, s46, 23040
 buffer_load_dwordx4 v9, s[8:11], s45 offen  lds
 s_add_u32 m0, s49, 30720
 s_add_u32 s45, s46, 27648
 buffer_load_dwordx4 v8, s[8:11], s45 offen  lds
 s_add_u32 m0, s49, 31744
 s_add_u32 s45, s46, 32256
 buffer_load_dwordx4 v9, s[8:11], s45 offen  lds
 ds_write_b128 v5, v[16:19] offset:6144
 ds_read_b64_tr_b16 a[84:85], v10 offset:36864
 ds_read_b64_tr_b16 a[86:87], v10 offset:37376
 ds_read_b64_tr_b16 a[88:89], v11 offset:36864
 ds_read_b64_tr_b16 a[90:91], v11 offset:37376
 ds_read_b64_tr_b16 a[92:93], v12 offset:36864
 ds_read_b64_tr_b16 a[94:95], v12 offset:37376
 ds_read_b64_tr_b16 v[20:21], v13 offset:36864
 ds_read_b64_tr_b16 v[22:23], v13 offset:37376
 s_waitcnt vmcnt(20) lgkmcnt(0)
 s_add_u32 m0, s49, 32768
 s_add_u32 s45, s46, 36864
 buffer_load_dwordx4 v8, s[8:11], s45 offen  lds
 s_add_u32 m0, s49, 33792
 s_add_u32 s45, s46, 41472
 buffer_load_dwordx4 v9, s[8:11], s45 offen  lds
 s_add_u32 m0, s49, 34816
 s_add_u32 s45, s46, 46080
 buffer_load_dwordx4 v8, s[8:11], s45 offen  lds
 s_add_u32 m0, s49, 35840
 s_add_u32 s45, s46, 50688
 buffer_load_dwordx4 v9, s[8:11], s45 offen  lds
 ds_write_b128 v5, v[20:23] offset:7168
 ds_read_b64_tr_b16 a[96:97], v10 offset:8192
 ds_read_b64_tr_b16 a[98:99], v10 offset:8704
 ds_read_b64_tr_b16 a[100:101], v11 offset:8192
 ds_read_b64_tr_b16 a[102:103], v11 offset:8704
 ds_read_b64_tr_b16 a[104:105], v12 offset:8192
 ds_read_b64_tr_b16 a[106:107], v12 offset:8704
 ds_read_b64_tr_b16 v[32:33], v13 offset:8192
 ds_read_b64_tr_b16 v[34:35], v13 offset:8704
 s_waitcnt vmcnt(20) lgkmcnt(0)
 s_add_u32 m0, s49, 36864
 s_add_u32 s45, s46, 55296
 buffer_load_dwordx4 v8, s[8:11], s45 offen  lds
 s_add_u32 m0, s49, 37888
 s_add_u32 s45, s46, 59904
 buffer_load_dwordx4 v9, s[8:11], s45 offen  lds
 s_add_u32 m0, s49, 38912
 s_add_u32 s45, s46, 64512
 buffer_load_dwordx4 v8, s[8:11], s45 offen  lds
 s_add_u32 m0, s49, 39936
 s_add_u32 s45, s46, 69120
 buffer_load_dwordx4 v9, s[8:11], s45 offen  lds
 ds_read_b64_tr_b16 a[108:109], v10 offset:12288
 ds_read_b64_tr_b16 a[110:111], v10 offset:12800
 ds_read_b64_tr_b16 a[112:113], v11 offset:12288
 ds_read_b64_tr_b16 a[114:115], v11 offset:12800
 ds_read_b64_tr_b16 a[116:117], v12 offset:12288
 ds_read_b64_tr_b16 a[118:119], v12 offset:12800
 ds_read_b64_tr_b16 v[36:37], v13 offset:12288
 ds_read_b64_tr_b16 v[38:39], v13 offset:12800
 s_waitcnt vmcnt(20) lgkmcnt(0)
 s_add_u32 s46, s44, 4
 s_and_b32 s46, s46, 7
 s_lshl_b32 s45, s4, 3
 s_add_u32 s46, s46, s45
 s_mul_i32 s46, s46, 147456
 s_add_u32 s46, s46, s47
 s_add_u32 m0, s49, 8192
 s_add_u32 s45, s46, 0
 buffer_load_dwordx4 v8, s[8:11], s45 offen  lds
 s_add_u32 m0, s49, 9216
 s_add_u32 s45, s46, 4608
 buffer_load_dwordx4 v9, s[8:11], s45 offen  lds
 s_add_u32 m0, s49, 10240
 s_add_u32 s45, s46, 9216
 buffer_load_dwordx4 v8, s[8:11], s45 offen  lds
 s_add_u32 m0, s49, 11264
 s_add_u32 s45, s46, 13824
 buffer_load_dwordx4 v9, s[8:11], s45 offen  lds
 ds_read_b64_tr_b16 a[120:121], v10 offset:16384
 ds_read_b64_tr_b16 a[122:123], v10 offset:16896
 ds_read_b64_tr_b16 a[124:125], v11 offset:16384
 ds_read_b64_tr_b16 a[126:127], v11 offset:16896
 ds_read_b64_tr_b16 a[128:129], v12 offset:16384
 ds_read_b64_tr_b16 a[130:131], v12 offset:16896
 ds_read_b64_tr_b16 v[40:41], v13 offset:16384
 ds_read_b64_tr_b16 v[42:43], v13 offset:16896
 s_waitcnt vmcnt(20) lgkmcnt(0)
 s_add_u32 m0, s49, 12288
 s_add_u32 s45, s46, 18432
 buffer_load_dwordx4 v8, s[8:11], s45 offen  lds
 s_add_u32 m0, s49, 13312
 s_add_u32 s45, s46, 23040
 buffer_load_dwordx4 v9, s[8:11], s45 offen  lds
 s_add_u32 m0, s49, 14336
 s_add_u32 s45, s46, 27648
 buffer_load_dwordx4 v8, s[8:11], s45 offen  lds
 s_add_u32 m0, s49, 15360
 s_add_u32 s45, s46, 32256
 buffer_load_dwordx4 v9, s[8:11], s45 offen  lds
 ds_read_b64_tr_b16 a[132:133], v10 offset:20480
 ds_read_b64_tr_b16 a[134:135], v10 offset:20992
 ds_read_b64_tr_b16 a[136:137], v11 offset:20480
 ds_read_b64_tr_b16 a[138:139], v11 offset:20992
 ds_read_b64_tr_b16 a[140:141], v12 offset:20480
 ds_read_b64_tr_b16 a[142:143], v12 offset:20992
 ds_read_b64_tr_b16 v[44:45], v13 offset:20480
 ds_read_b64_tr_b16 v[46:47], v13 offset:20992
 s_waitcnt vmcnt(20) lgkmcnt(0)
 s_add_u32 m0, s49, 16384
 s_add_u32 s45, s46, 36864
 buffer_load_dwordx4 v8, s[8:11], s45 offen  lds
 s_add_u32 m0, s49, 17408
 s_add_u32 s45, s46, 41472
 buffer_load_dwordx4 v9, s[8:11], s45 offen  lds
 s_add_u32 m0, s49, 18432
 s_add_u32 s45, s46, 46080
 buffer_load_dwordx4 v8, s[8:11], s45 offen  lds
 s_add_u32 m0, s49, 19456
 s_add_u32 s45, s46, 50688
 buffer_load_dwordx4 v9, s[8:11], s45 offen  lds
 ds_read_b64_tr_b16 a[144:145], v10 offset:24576
 ds_read_b64_tr_b16 a[146:147], v10 offset:25088
 ds_read_b64_tr_b16 a[148:149], v11 offset:24576
 ds_read_b64_tr_b16 a[150:151], v11 offset:25088
 ds_read_b64_tr_b16 a[152:153], v12 offset:24576
 ds_read_b64_tr_b16 a[154:155], v12 offset:25088
 ds_read_b64_tr_b16 v[48:49], v13 offset:24576
 ds_read_b64_tr_b16 v[50:51], v13 offset:25088
 s_waitcnt vmcnt(20) lgkmcnt(0)
 s_add_u32 m0, s49, 20480
 s_add_u32 s45, s46, 55296
 buffer_load_dwordx4 v8, s[8:11], s45 offen  lds
 s_add_u32 m0, s49, 21504
 s_add_u32 s45, s46, 59904
 buffer_load_dwordx4 v9, s[8:11], s45 offen  lds
 s_add_u32 m0, s49, 22528
 s_add_u32 s45, s46, 64512
 buffer_load_dwordx4 v8, s[8:11], s45 offen  lds
 s_add_u32 m0, s49, 23552
 s_add_u32 s45, s46, 69120
 buffer_load_dwordx4 v9, s[8:11], s45 offen  lds
 ds_read_b64_tr_b16 a[156:157], v10 offset:28672
 ds_read_b64_tr_b16 a[158:159], v10 offset:29184
 ds_read_b64_tr_b16 a[160:161], v11 offset:28672
 ds_read_b64_tr_b16 a[162:163], v11 offset:29184
 ds_read_b64_tr_b16 a[164:165], v12 offset:28672
 ds_read_b64_tr_b16 a[166:167], v12 offset:29184
 ds_read_b64_tr_b16 v[52:53], v13 offset:28672
 ds_read_b64_tr_b16 v[54:55], v13 offset:29184
 s_waitcnt vmcnt(20) lgkmcnt(0)
 s_add_u32 s46, s44, 5
 s_and_b32 s46, s46, 7
 s_lshl_b32 s45, s4, 3
 s_add_u32 s46, s46, s45
 s_mul_i32 s46, s46, 147456
 s_add_u32 s46, s46, s47
 s_add_u32 m0, s49, 24576
 s_add_u32 s45, s46, 0
 buffer_load_dwordx4 v8, s[8:11], s45 offen  lds
 s_add_u32 m0, s49, 25600
 s_add_u32 s45, s46, 4608
 buffer_load_dwordx4 v9, s[8:11], s45 offen  lds
 s_add_u32 m0, s49, 26624
 s_add_u32 s45, s46, 9216
 buffer_load_dwordx4 v8, s[8:11], s45 offen  lds
 s_add_u32 m0, s49, 27648
 s_add_u32 s45, s46, 13824
 buffer_load_dwordx4 v9, s[8:11], s45 offen  lds
 ds_read_b64_tr_b16 a[168:169], v10 offset:32768
 ds_read_b64_tr_b16 a[170:171], v10 offset:33280
 ds_read_b64_tr_b16 a[172:173], v11 offset:32768
 ds_read_b64_tr_b16 a[174:175], v11 offset:33280
 ds_read_b64_tr_b16 a[176:177], v12 offset:32768
 ds_read_b64_tr_b16 a[178:179], v12 offset:33280
 ds_read_b64_tr_b16 v[56:57], v13 offset:32768
 ds_read_b64_tr_b16 v[58:59], v13 offset:33280
 s_waitcnt vmcnt(20) lgkmcnt(0)
 s_add_u32 m0, s49, 28672
 s_add_u32 s45, s46, 18432
 buffer_load_dwordx4 v8, s[8:11], s45 offen  lds
 s_add_u32 m0, s49, 29696
 s_add_u32 s45, s46, 23040
 buffer_load_dwordx4 v9, s[8:11], s45 offen  lds
 s_add_u32 m0, s49, 30720
 s_add_u32 s45, s46, 27648
 buffer_load_dwordx4 v8, s[8:11], s45 offen  lds
 s_add_u32 m0, s49, 31744
 s_add_u32 s45, s46, 32256
 buffer_load_dwordx4 v9, s[8:11], s45 offen  lds
 ds_read_b64_tr_b16 a[180:181], v10 offset:36864
 ds_read_b64_tr_b16 a[182:183], v10 offset:37376
 ds_read_b64_tr_b16 a[184:185], v11 offset:36864
 ds_read_b64_tr_b16 a[186:187], v11 offset:37376
 ds_read_b64_tr_b16 a[188:189], v12 offset:36864
 ds_read_b64_tr_b16 a[190:191], v12 offset:37376
 ds_read_b64_tr_b16 v[60:61], v13 offset:36864
 ds_read_b64_tr_b16 v[62:63], v13 offset:37376
 s_waitcnt vmcnt(20) lgkmcnt(0)
 s_add_u32 m0, s49, 32768
 s_add_u32 s45, s46, 36864
 buffer_load_dwordx4 v8, s[8:11], s45 offen  lds
 s_add_u32 m0, s49, 33792
 s_add_u32 s45, s46, 41472
 buffer_load_dwordx4 v9, s[8:11], s45 offen  lds
 s_add_u32 m0, s49, 34816
 s_add_u32 s45, s46, 46080
 buffer_load_dwordx4 v8, s[8:11], s45 offen  lds
 s_add_u32 m0, s49, 35840
 s_add_u32 s45, s46, 50688
 buffer_load_dwordx4 v9, s[8:11], s45 offen  lds
 ds_read_b64_tr_b16 a[192:193], v10 offset:8192
 ds_read_b64_tr_b16 a[194:195], v10 offset:8704
 ds_read_b64_tr_b16 a[196:197], v11 offset:8192
 ds_read_b64_tr_b16 a[198:199], v11 offset:8704
 ds_read_b64_tr_b16 a[200:201], v12 offset:8192
 ds_read_b64_tr_b16 a[202:203], v12 offset:8704
 ds_read_b64_tr_b16 v[64:65], v13 offset:8192
 ds_read_b64_tr_b16 v[66:67], v13 offset:8704
 s_waitcnt vmcnt(20) lgkmcnt(0)
 s_add_u32 m0, s49, 36864
 s_add_u32 s45, s46, 55296
 buffer_load_dwordx4 v8, s[8:11], s45 offen  lds
 s_add_u32 m0, s49, 37888
 s_add_u32 s45, s46, 59904
 buffer_load_dwordx4 v9, s[8:11], s45 offen  lds
 s_add_u32 m0, s49, 38912
 s_add_u32 s45, s46, 64512
 buffer_load_dwordx4 v8, s[8:11], s45 offen  lds
 s_add_u32 m0, s49, 39936
 s_add_u32 s45, s46, 69120
 buffer_load_dwordx4 v9, s[8:11], s45 offen  lds
 ds_read_b64_tr_b16 a[204:205], v10 offset:12288
 ds_read_b64_tr_b16 a[206:207], v10 offset:12800
 ds_read_b64_tr_b16 a[208:209], v11 offset:12288
 ds_read_b64_tr_b16 a[210:211], v11 offset:12800
 ds_read_b64_tr_b16 a[212:213], v12 offset:12288
 ds_read_b64_tr_b16 a[214:215], v12 offset:12800
 ds_read_b64_tr_b16 v[68:69], v13 offset:12288
 ds_read_b64_tr_b16 v[70:71], v13 offset:12800
 s_waitcnt vmcnt(20) lgkmcnt(0)
 s_add_u32 s46, s44, 6
 s_and_b32 s46, s46, 7
 s_lshl_b32 s45, s4, 3
 s_add_u32 s46, s46, s45
 s_mul_i32 s46, s46, 147456
 s_add_u32 s46, s46, s47
 s_add_u32 m0, s49, 8192
 s_add_u32 s45, s46, 0
 buffer_load_dwordx4 v8, s[8:11], s45 offen  lds
 s_add_u32 m0, s49, 9216
 s_add_u32 s45, s46, 4608
 buffer_load_dwordx4 v9, s[8:11], s45 offen  lds
 s_add_u32 m0, s49, 10240
 s_add_u32 s45, s46, 9216
 buffer_load_dwordx4 v8, s[8:11], s45 offen  lds
 s_add_u32 m0, s49, 11264
 s_add_u32 s45, s46, 13824
 buffer_load_dwordx4 v9, s[8:11], s45 offen  lds
 ds_read_b64_tr_b16 a[216:217], v10 offset:16384
 ds_read_b64_tr_b16 a[218:219], v10 offset:16896
 ds_read_b64_tr_b16 a[220:221], v11 offset:16384
 ds_read_b64_tr_b16 a[222:223], v11 offset:16896
 ds_read_b64_tr_b16 a[224:225], v12 offset:16384
 ds_read_b64_tr_b16 a[226:227], v12 offset:16896
 ds_read_b64_tr_b16 v[72:73], v13 offset:16384
 ds_read_b64_tr_b16 v[74:75], v13 offset:16896
 s_waitcnt vmcnt(20) lgkmcnt(0)
 s_add_u32 m0, s49, 12288
 s_add_u32 s45, s46, 18432
 buffer_load_dwordx4 v8, s[8:11], s45 offen  lds
 s_add_u32 m0, s49, 13312
 s_add_u32 s45, s46, 23040
 buffer_load_dwordx4 v9, s[8:11], s45 offen  lds
 s_add_u32 m0, s49, 14336
 s_add_u32 s45, s46, 27648
 buffer_load_dwordx4 v8, s[8:11], s45 offen  lds
 s_add_u32 m0, s49, 15360
 s_add_u32 s45, s46, 32256
 buffer_load_dwordx4 v9, s[8:11], s45 offen  lds
 ds_read_b64_tr_b16 a[228:229], v10 offset:20480
 ds_read_b64_tr_b16 a[230:231], v10 offset:20992
 ds_read_b64_tr_b16 a[232:233], v11 offset:20480
 ds_read_b64_tr_b16 a[234:235], v11 offset:20992
 ds_read_b64_tr_b16 a[236:237], v12 offset:20480
 ds_read_b64_tr_b16 a[238:239], v12 offset:20992
 ds_read_b64_tr_b16 v[76:77], v13 offset:20480
 ds_read_b64_tr_b16 v[78:79], v13 offset:20992
 s_waitcnt vmcnt(20) lgkmcnt(0)
 s_add_u32 m0, s49, 16384
 s_add_u32 s45, s46, 36864
 buffer_load_dwordx4 v8, s[8:11], s45 offen  lds
 s_add_u32 m0, s49, 17408
 s_add_u32 s45, s46, 41472
 buffer_load_dwordx4 v9, s[8:11], s45 offen  lds
 s_add_u32 m0, s49, 18432
 s_add_u32 s45, s46, 46080
 buffer_load_dwordx4 v8, s[8:11], s45 offen  lds
 s_add_u32 m0, s49, 19456
 s_add_u32 s45, s46, 50688
 buffer_load_dwordx4 v9, s[8:11], s45 offen  lds
 ds_read_b64_tr_b16 a[240:241], v10 offset:24576
 ds_read_b64_tr_b16 a[242:243], v10 offset:25088
 ds_read_b64_tr_b16 a[244:245], v11 offset:24576
 ds_read_b64_tr_b16 a[246:247], v11 offset:25088
 ds_read_b64_tr_b16 a[248:249], v12 offset:24576
 ds_read_b64_tr_b16 a[250:251], v12 offset:25088
 ds_read_b64_tr_b16 v[80:81], v13 offset:24576
 ds_read_b64_tr_b16 v[82:83], v13 offset:25088
 s_waitcnt vmcnt(20) lgkmcnt(0)
 s_add_u32 m0, s49, 20480
 s_add_u32 s45, s46, 55296
 buffer_load_dwordx4 v8, s[8:11], s45 offen  lds
 s_add_u32 m0, s49, 21504
 s_add_u32 s45, s46, 59904
 buffer_load_dwordx4 v9, s[8:11], s45 offen  lds
 s_add_u32 m0, s49, 22528
 s_add_u32 s45, s46, 64512
 buffer_load_dwordx4 v8, s[8:11], s45 offen  lds
 s_add_u32 m0, s49, 23552
 s_add_u32 s45, s46, 69120
 buffer_load_dwordx4 v9, s[8:11], s45 offen  lds
 ds_read_b64_tr_b16 a[252:253], v10 offset:28672
 ds_read_b64_tr_b16 a[254:255], v10 offset:29184
 ds_read_b64_tr_b16 v[128:129], v11 offset:28672
 ds_read_b64_tr_b16 v[130:131], v11 offset:29184
 ds_read_b64_tr_b16 v[132:133], v12 offset:28672
 ds_read_b64_tr_b16 v[134:135], v12 offset:29184
 ds_read_b64_tr_b16 v[84:85], v13 offset:28672
 ds_read_b64_tr_b16 v[86:87], v13 offset:29184
 s_waitcnt vmcnt(20) lgkmcnt(0)
 s_add_u32 s46, s44, 7
 s_and_b32 s46, s46, 7
 s_lshl_b32 s45, s4, 3
 s_add_u32 s46, s46, s45
 s_mul_i32 s46, s46, 147456
 s_add_u32 s46, s46, s47
 s_add_u32 m0, s49, 24576
 s_add_u32 s45, s46, 0
 buffer_load_dwordx4 v8, s[8:11], s45 offen  lds
 s_add_u32 m0, s49, 25600
 s_add_u32 s45, s46, 4608
 buffer_load_dwordx4 v9, s[8:11], s45 offen  lds
 s_add_u32 m0, s49, 26624
 s_add_u32 s45, s46, 9216
 buffer_load_dwordx4 v8, s[8:11], s45 offen  lds
 s_add_u32 m0, s49, 27648
 s_add_u32 s45, s46, 13824
 buffer_load_dwordx4 v9, s[8:11], s45 offen  lds
 ds_read_b64_tr_b16 v[136:137], v10 offset:32768
 ds_read_b64_tr_b16 v[138:139], v10 offset:33280
 ds_read_b64_tr_b16 v[140:141], v11 offset:32768
 ds_read_b64_tr_b16 v[142:143], v11 offset:33280
 ds_read_b64_tr_b16 v[144:145], v12 offset:32768
 ds_read_b64_tr_b16 v[146:147], v12 offset:33280
 ds_read_b64_tr_b16 v[88:89], v13 offset:32768
 ds_read_b64_tr_b16 v[90:91], v13 offset:33280
 s_waitcnt vmcnt(20) lgkmcnt(0)
 s_add_u32 m0, s49, 28672
 s_add_u32 s45, s46, 18432
 buffer_load_dwordx4 v8, s[8:11], s45 offen  lds
 s_add_u32 m0, s49, 29696
 s_add_u32 s45, s46, 23040
 buffer_load_dwordx4 v9, s[8:11], s45 offen  lds
 s_add_u32 m0, s49, 30720
 s_add_u32 s45, s46, 27648
 buffer_load_dwordx4 v8, s[8:11], s45 offen  lds
 s_add_u32 m0, s49, 31744
 s_add_u32 s45, s46, 32256
 buffer_load_dwordx4 v9, s[8:11], s45 offen  lds
 ds_read_b64_tr_b16 v[148:149], v10 offset:36864
 ds_read_b64_tr_b16 v[150:151], v10 offset:37376
 ds_read_b64_tr_b16 v[152:153], v11 offset:36864
 ds_read_b64_tr_b16 v[154:155], v11 offset:37376
 ds_read_b64_tr_b16 v[156:157], v12 offset:36864
 ds_read_b64_tr_b16 v[158:159], v12 offset:37376
 ds_read_b64_tr_b16 v[92:93], v13 offset:36864
 ds_read_b64_tr_b16 v[94:95], v13 offset:37376
 s_waitcnt vmcnt(20) lgkmcnt(0)
 s_add_u32 m0, s49, 32768
 s_add_u32 s45, s46, 36864
 buffer_load_dwordx4 v8, s[8:11], s45 offen  lds
 s_add_u32 m0, s49, 33792
 s_add_u32 s45, s46, 41472
 buffer_load_dwordx4 v9, s[8:11], s45 offen  lds
 s_add_u32 m0, s49, 34816
 s_add_u32 s45, s46, 46080
 buffer_load_dwordx4 v8, s[8:11], s45 offen  lds
 s_add_u32 m0, s49, 35840
 s_add_u32 s45, s46, 50688
 buffer_load_dwordx4 v9, s[8:11], s45 offen  lds
 ds_read_b64_tr_b16 v[160:161], v10 offset:8192
 ds_read_b64_tr_b16 v[162:163], v10 offset:8704
 ds_read_b64_tr_b16 v[164:165], v11 offset:8192
 ds_read_b64_tr_b16 v[166:167], v11 offset:8704
 ds_read_b64_tr_b16 v[168:169], v12 offset:8192
 ds_read_b64_tr_b16 v[170:171], v12 offset:8704
 ds_read_b64_tr_b16 v[96:97], v13 offset:8192
 ds_read_b64_tr_b16 v[98:99], v13 offset:8704
 s_waitcnt vmcnt(20) lgkmcnt(0)
 s_add_u32 m0, s49, 36864
 s_add_u32 s45, s46, 55296
 buffer_load_dwordx4 v8, s[8:11], s45 offen  lds
 s_add_u32 m0, s49, 37888
 s_add_u32 s45, s46, 59904
 buffer_load_dwordx4 v9, s[8:11], s45 offen  lds
 s_add_u32 m0, s49, 38912
 s_add_u32 s45, s46, 64512
 buffer_load_dwordx4 v8, s[8:11], s45 offen  lds
 s_add_u32 m0, s49, 39936
 s_add_u32 s45, s46, 69120
 buffer_load_dwordx4 v9, s[8:11], s45 offen  lds
 ds_read_b64_tr_b16 v[172:173], v10 offset:12288
 ds_read_b64_tr_b16 v[174:175], v10 offset:12800
 ds_read_b64_tr_b16 v[176:177], v11 offset:12288
 ds_read_b64_tr_b16 v[178:179], v11 offset:12800
 ds_read_b64_tr_b16 v[180:181], v12 offset:12288
 ds_read_b64_tr_b16 v[182:183], v12 offset:12800
 ds_read_b64_tr_b16 v[100:101], v13 offset:12288
 ds_read_b64_tr_b16 v[102:103], v13 offset:12800
 s_waitcnt vmcnt(20) lgkmcnt(0)
 ds_read_b64_tr_b16 v[184:185], v10 offset:16384
 ds_read_b64_tr_b16 v[186:187], v10 offset:16896
 ds_read_b64_tr_b16 v[188:189], v11 offset:16384
 ds_read_b64_tr_b16 v[190:191], v11 offset:16896
 ds_read_b64_tr_b16 v[192:193], v12 offset:16384
 ds_read_b64_tr_b16 v[194:195], v12 offset:16896
 ds_read_b64_tr_b16 v[104:105], v13 offset:16384
 ds_read_b64_tr_b16 v[106:107], v13 offset:16896
 s_waitcnt vmcnt(16) lgkmcnt(0)
 ds_read_b64_tr_b16 v[196:197], v10 offset:20480
 ds_read_b64_tr_b16 v[198:199], v10 offset:20992
 ds_read_b64_tr_b16 v[200:201], v11 offset:20480
 ds_read_b64_tr_b16 v[202:203], v11 offset:20992
 ds_read_b64_tr_b16 v[204:205], v12 offset:20480
 ds_read_b64_tr_b16 v[206:207], v12 offset:20992
 ds_read_b64_tr_b16 v[108:109], v13 offset:20480
 ds_read_b64_tr_b16 v[110:111], v13 offset:20992
 s_waitcnt vmcnt(12) lgkmcnt(0)
 ds_read_b64_tr_b16 v[208:209], v10 offset:24576
 ds_read_b64_tr_b16 v[210:211], v10 offset:25088
 ds_read_b64_tr_b16 v[212:213], v11 offset:24576
 ds_read_b64_tr_b16 v[214:215], v11 offset:25088
 ds_read_b64_tr_b16 v[216:217], v12 offset:24576
 ds_read_b64_tr_b16 v[218:219], v12 offset:25088
 ds_read_b64_tr_b16 v[112:113], v13 offset:24576
 ds_read_b64_tr_b16 v[114:115], v13 offset:25088
 s_waitcnt vmcnt(8) lgkmcnt(0)
 ds_read_b64_tr_b16 v[220:221], v10 offset:28672
 ds_read_b64_tr_b16 v[222:223], v10 offset:29184
 ds_read_b64_tr_b16 v[224:225], v11 offset:28672
 ds_read_b64_tr_b16 v[226:227], v11 offset:29184
 ds_read_b64_tr_b16 v[228:229], v12 offset:28672
 ds_read_b64_tr_b16 v[230:231], v12 offset:29184
 ds_read_b64_tr_b16 v[116:117], v13 offset:28672
 ds_read_b64_tr_b16 v[118:119], v13 offset:29184
 s_waitcnt vmcnt(4) lgkmcnt(0)
 ds_read_b64_tr_b16 v[232:233], v10 offset:32768
 ds_read_b64_tr_b16 v[234:235], v10 offset:33280
 ds_read_b64_tr_b16 v[236:237], v11 offset:32768
 ds_read_b64_tr_b16 v[238:239], v11 offset:33280
 ds_read_b64_tr_b16 v[240:241], v12 offset:32768
 ds_read_b64_tr_b16 v[242:243], v12 offset:33280
 ds_read_b64_tr_b16 v[120:121], v13 offset:32768
 ds_read_b64_tr_b16 v[122:123], v13 offset:33280
 s_waitcnt vmcnt(0) lgkmcnt(0)
 ds_read_b64_tr_b16 v[244:245], v10 offset:36864
 ds_read_b64_tr_b16 v[246:247], v10 offset:37376
 ds_read_b64_tr_b16 v[248:249], v11 offset:36864
 ds_read_b64_tr_b16 v[250:251], v11 offset:37376
 ds_read_b64_tr_b16 v[252:253], v12 offset:36864
 ds_read_b64_tr_b16 v[254:255], v12 offset:37376
 ds_read_b64_tr_b16 v[124:125], v13 offset:36864
 ds_read_b64_tr_b16 v[126:127], v13 offset:37376
 s_waitcnt lgkmcnt(0)
 ds_write_b128 v5, v[32:35] offset:8192
 ds_write_b128 v5, v[36:39] offset:9216
 ds_write_b128 v5, v[40:43] offset:10240
 ds_write_b128 v5, v[44:47] offset:11264
 ds_write_b128 v5, v[48:51] offset:12288
 ds_write_b128 v5, v[52:55] offset:13312
 ds_write_b128 v5, v[56:59] offset:14336
 ds_write_b128 v5, v[60:63] offset:15360
 ds_write_b128 v5, v[64:67] offset:16384
 ds_write_b128 v5, v[68:71] offset:17408
 ds_write_b128 v5, v[72:75] offset:18432
 ds_write_b128 v5, v[76:79] offset:19456
 ds_write_b128 v5, v[80:83] offset:20480
 ds_write_b128 v5, v[84:87] offset:21504
 ds_write_b128 v5, v[88:91] offset:22528
 ds_write_b128 v5, v[92:95] offset:23552
 ds_write_b128 v5, v[96:99] offset:24576
 ds_write_b128 v5, v[100:103] offset:25600
 ds_write_b128 v5, v[104:107] offset:26624
 ds_write_b128 v5, v[108:111] offset:27648
 ds_write_b128 v5, v[112:115] offset:28672
 ds_write_b128 v5, v[116:119] offset:29696
 ds_write_b128 v5, v[120:123] offset:30720
 ds_write_b128 v5, v[124:127] offset:31744
 s_waitcnt lgkmcnt(0)
 v_lshrrev_b32 v13, 2, v15
 v_and_b32 v14, 3, v15
 s_lshr_b32 s45, s4, 1
 s_mul_i32 s45, s45, 36864
 s_and_b32 s46, s4, 1
 s_lshl_b32 s46, s46, 6
 s_add_u32 s45, s45, s46
 s_add_u32 s37, s37, s45
 v_mul_u32_u24 v6, 2304, v13
 v_lshl_add_u32 v6, v14, 4, v6
 v_lshl_add_u32 v13, v14, 2, v13
 v_and_b32 v13, 15, v13
 v_lshlrev_b32 v13, 4, v13
 s_lshl_b32 s45, s4, 11
 v_lshl_add_u32 v12, v14, 9, v13
 v_add_u32 v12, s45, v12
 v_lshrrev_b32 v13, 5, v15
 v_lshl_add_u32 v13, v13, 2, v15
 v_and_b32 v13, 15, v13
 v_and_or_b32 v13, v15, 48, v13
 v_lshlrev_b32 v13, 4, v13
 v_xor_b32 v14, 0x80, v13
 v_add_u32 v15, s49, v14
 v_add_u32 v14, s49, v13
 v_add_u32 v4, 32768, v12
 v_add_u32 v7, 114688, v12
 s_lshl_b32 s45, s32, 7
 s_add_u32 s37, s37, s45
 s_lshl_b32 s45, s4, 16
 s_add_u32 s36, s36, s45
 s_mov_b32 s42, s33
 s_mov_b32 s43, 0
 s_and_b32 s53, s42, s93
 s_lshl_b32 s53, s53, s91
 s_add_u32 s53, s53, s38
 s_lshr_b32 s51, s42, s90
 s_add_u32 s51, s51, 1
 ds_read_b128 v[16:19], v5 offset:0
 ds_read_b128 v[20:23], v5 offset:1024
Los0_33:
 buffer_load_dword v2, v3, s[20:23], s53 offen sc1
 s_waitcnt vmcnt(0)
 v_cmp_gt_u32 vcc, s51, v2
 s_and_b32 s52, vcc_lo, 0xffff
 s_cbranch_scc0 Los0k_34
 s_sleep 4
 s_sub_u32 s50, s50, 1
 s_cbranch_scc0 Los0_33
 s_endpgm
Los0k_34:
 s_lshl_b32 s48, s42, 18
 s_add_u32 s48, s48, s36
 s_add_u32 s52, s44, 0
 s_and_b32 s52, s52, 7
 s_lshl_b32 s52, s52, 13
 s_add_u32 s46, s48, s52
 s_add_u32 s47, s46, 4096
 buffer_load_dwordx4 v[32:35], v1, s[20:23], s46 offen offset:0 sc1
 buffer_load_dwordx4 v[36:39], v1, s[20:23], s46 offen offset:1024 sc1
 buffer_load_dwordx4 v[40:43], v1, s[20:23], s46 offen offset:2048 sc1
 buffer_load_dwordx4 v[44:47], v1, s[20:23], s46 offen offset:3072 sc1
 buffer_load_dwordx4 v[48:51], v1, s[20:23], s47 offen offset:0 sc1
 buffer_load_dwordx4 v[52:55], v1, s[20:23], s47 offen offset:1024 sc1
 buffer_load_dwordx4 v[56:59], v1, s[20:23], s47 offen offset:2048 sc1
 buffer_load_dwordx4 v[60:63], v1, s[20:23], s47 offen offset:3072 sc1
 s_add_u32 s52, s44, 1
 s_and_b32 s52, s52, 7
 s_lshl_b32 s52, s52, 13
 s_add_u32 s46, s48, s52
 s_add_u32 s47, s46, 4096
 buffer_load_dwordx4 v[64:67], v1, s[20:23], s46 offen offset:0 sc1
 buffer_load_dwordx4 v[68:71], v1, s[20:23], s46 offen offset:1024 sc1
 buffer_load_dwordx4 v[72:75], v1, s[20:23], s46 offen offset:2048 sc1
 buffer_load_dwordx4 v[76:79], v1, s[20:23], s46 offen offset:3072 sc1
 buffer_load_dwordx4 v[80:83], v1, s[20:23], s47 offen offset:0 sc1
 buffer_load_dwordx4 v[84:87], v1, s[20:23], s47 offen offset:1024 sc1
 buffer_load_dwordx4 v[88:91], v1, s[20:23], s47 offen offset:2048 sc1
 buffer_load_dwordx4 v[92:95], v1, s[20:23], s47 offen offset:3072 sc1
 .p2align 3
Losl_35:
 s_waitcnt vmcnt(14) lgkmcnt(1)
 v_mfma_f32_16x16x32_bf16 v[96:99], a[0:3], v[32:35], 0
 s_add_u32 s52, s44, 2
 s_and_b32 s52, s52, 7
 v_mfma_f32_16x16x32_bf16 v[100:103], a[4:7], v[32:35], 0
 s_lshl_b32 s52, s52, 13
 s_add_u32 s46, s48, s52
 v_mfma_f32_16x16x32_bf16 v[104:107], a[8:11], v[32:35], 0
 s_add_u32 s47, s46, 4096
 v_mfma_f32_16x16x32_bf16 v[108:111], v[16:19], v[32:35], 0
 buffer_load_dwordx4 v[32:35], v1, s[20:23], s46 offen offset:0 sc1
 v_mfma_f32_16x16x32_bf16 v[112:115], a[0:3], v[36:39], 0
 ds_read_b128 v[24:27], v5 offset:2048
 v_mfma_f32_16x16x32_bf16 v[116:119], a[4:7], v[36:39], 0
 v_mfma_f32_16x16x32_bf16 v[120:123], a[8:11], v[36:39], 0
 v_mfma_f32_16x16x32_bf16 v[124:127], v[16:19], v[36:39], 0
 buffer_load_dwordx4 v[36:39], v1, s[20:23], s46 offen offset:1024 sc1
 s_waitcnt vmcnt(14) lgkmcnt(1)
 v_mfma_f32_16x16x32_bf16 v[96:99], a[12:15], v[40:43], v[96:99]
 s_mov_b32 s41, s42
 s_add_u32 s43, s43, 1
 v_mfma_f32_16x16x32_bf16 v[100:103], a[16:19], v[40:43], v[100:103]
 s_cmp_lt_u32 s43, s35
 s_cselect_b32 s45, s34, 0
 v_mfma_f32_16x16x32_bf16 v[104:107], a[20:23], v[40:43], v[104:107]
 s_xor_b32 s34, s34, s39
 s_add_u32 s42, s42, s45
 v_mfma_f32_16x16x32_bf16 v[108:111], v[20:23], v[40:43], v[108:111]
 buffer_load_dwordx4 v[40:43], v1, s[20:23], s46 offen offset:2048 sc1
 v_mfma_f32_16x16x32_bf16 v[112:115], a[12:15], v[44:47], v[112:115]
 ds_read_b128 v[28:31], v5 offset:3072
 v_mfma_f32_16x16x32_bf16 v[116:119], a[16:19], v[44:47], v[116:119]
 v_mfma_f32_16x16x32_bf16 v[120:123], a[20:23], v[44:47], v[120:123]
 v_mfma_f32_16x16x32_bf16 v[124:127], v[20:23], v[44:47], v[124:127]
 buffer_load_dwordx4 v[44:47], v1, s[20:23], s46 offen offset:3072 sc1
 s_waitcnt vmcnt(14) lgkmcnt(1)
 v_mfma_f32_16x16x32_bf16 v[96:99], a[24:27], v[48:51], v[96:99]
 s_and_b32 s53, s42, s93
 s_lshl_b32 s53, s53, s91
 v_mfma_f32_16x16x32_bf16 v[100:103], a[28:31], v[48:51], v[100:103]
 s_add_u32 s53, s53, s38
 s_lshr_b32 s51, s42, s90
 v_mfma_f32_16x16x32_bf16 v[104:107], a[32:35], v[48:51], v[104:107]
 s_add_u32 s51, s51, 1
 v_mfma_f32_16x16x32_bf16 v[108:111], v[24:27], v[48:51], v[108:111]
 buffer_load_dwordx4 v[48:51], v1, s[20:23], s47 offen offset:0 sc1
 v_mfma_f32_16x16x32_bf16 v[112:115], a[24:27], v[52:55], v[112:115]
 ds_read_b128 v[16:19], v5 offset:4096
 v_mfma_f32_16x16x32_bf16 v[116:119], a[28:31], v[52:55], v[116:119]
 v_mfma_f32_16x16x32_bf16 v[120:123], a[32:35], v[52:55], v[120:123]
 v_mfma_f32_16x16x32_bf16 v[124:127], v[24:27], v[52:55], v[124:127]
 buffer_load_dwordx4 v[52:55], v1, s[20:23], s47 offen offset:1024 sc1
 s_waitcnt vmcnt(14) lgkmcnt(1)
 v_mfma_f32_16x16x32_bf16 v[96:99], a[36:39], v[56:59], v[96:99]
 s_mul_i32 s54, s41, 73728
 s_add_u32 s54, s54, s37
 v_mfma_f32_16x16x32_bf16 v[100:103], a[40:43], v[56:59], v[100:103]
 v_mfma_f32_16x16x32_bf16 v[104:107], a[44:47], v[56:59], v[104:107]
 v_mfma_f32_16x16x32_bf16 v[108:111], v[28:31], v[56:59], v[108:111]
 buffer_load_dwordx4 v[56:59], v1, s[20:23], s47 offen offset:2048 sc1
 v_mfma_f32_16x16x32_bf16 v[112:115], a[36:39], v[60:63], v[112:115]
 ds_read_b128 v[20:23], v5 offset:5120
 v_mfma_f32_16x16x32_bf16 v[116:119], a[40:43], v[60:63], v[116:119]
 v_mfma_f32_16x16x32_bf16 v[120:123], a[44:47], v[60:63], v[120:123]
 v_mfma_f32_16x16x32_bf16 v[124:127], v[28:31], v[60:63], v[124:127]
 buffer_load_dwordx4 v[60:63], v1, s[20:23], s47 offen offset:3072 sc1
 s_waitcnt vmcnt(14) lgkmcnt(1)
 v_mfma_f32_16x16x32_bf16 v[96:99], a[48:51], v[64:67], v[96:99]
 s_add_u32 s52, s44, 3
 s_and_b32 s52, s52, 7
 v_mfma_f32_16x16x32_bf16 v[100:103], a[52:55], v[64:67], v[100:103]
 s_lshl_b32 s52, s52, 13
 s_add_u32 s46, s48, s52
 v_mfma_f32_16x16x32_bf16 v[104:107], a[56:59], v[64:67], v[104:107]
 s_add_u32 s47, s46, 4096
 v_mfma_f32_16x16x32_bf16 v[108:111], v[16:19], v[64:67], v[108:111]
 buffer_load_dwordx4 v[64:67], v1, s[20:23], s46 offen offset:0 sc1
 v_mfma_f32_16x16x32_bf16 v[112:115], a[48:51], v[68:71], v[112:115]
 ds_read_b128 v[24:27], v5 offset:6144
 v_mfma_f32_16x16x32_bf16 v[116:119], a[52:55], v[68:71], v[116:119]
 v_mfma_f32_16x16x32_bf16 v[120:123], a[56:59], v[68:71], v[120:123]
 v_mfma_f32_16x16x32_bf16 v[124:127], v[16:19], v[68:71], v[124:127]
 buffer_load_dwordx4 v[68:71], v1, s[20:23], s46 offen offset:1024 sc1
 s_waitcnt vmcnt(14) lgkmcnt(1)
 v_mfma_f32_16x16x32_bf16 v[96:99], a[60:63], v[72:75], v[96:99]
 v_mfma_f32_16x16x32_bf16 v[100:103], a[64:67], v[72:75], v[100:103]
 v_mfma_f32_16x16x32_bf16 v[104:107], a[68:71], v[72:75], v[104:107]
 v_mfma_f32_16x16x32_bf16 v[108:111], v[20:23], v[72:75], v[108:111]
 buffer_load_dwordx4 v[72:75], v1, s[20:23], s46 offen offset:2048 sc1
 v_mfma_f32_16x16x32_bf16 v[112:115], a[60:63], v[76:79], v[112:115]
 ds_read_b128 v[28:31], v5 offset:7168
 v_mfma_f32_16x16x32_bf16 v[116:119], a[64:67], v[76:79], v[116:119]
 v_mfma_f32_16x16x32_bf16 v[120:123], a[68:71], v[76:79], v[120:123]
 v_mfma_f32_16x16x32_bf16 v[124:127], v[20:23], v[76:79], v[124:127]
 buffer_load_dwordx4 v[76:79], v1, s[20:23], s46 offen offset:3072 sc1
 s_waitcnt vmcnt(14) lgkmcnt(1)
 v_mfma_f32_16x16x32_bf16 v[96:99], a[72:75], v[80:83], v[96:99]
 v_mfma_f32_16x16x32_bf16 v[100:103], a[76:79], v[80:83], v[100:103]
 v_mfma_f32_16x16x32_bf16 v[104:107], a[80:83], v[80:83], v[104:107]
 v_mfma_f32_16x16x32_bf16 v[108:111], v[24:27], v[80:83], v[108:111]
 buffer_load_dwordx4 v[80:83], v1, s[20:23], s47 offen offset:0 sc1
 v_mfma_f32_16x16x32_bf16 v[112:115], a[72:75], v[84:87], v[112:115]
 ds_read_b128 v[16:19], v5 offset:8192
 v_mfma_f32_16x16x32_bf16 v[116:119], a[76:79], v[84:87], v[116:119]
 v_mfma_f32_16x16x32_bf16 v[120:123], a[80:83], v[84:87], v[120:123]
 v_mfma_f32_16x16x32_bf16 v[124:127], v[24:27], v[84:87], v[124:127]
 buffer_load_dwordx4 v[84:87], v1, s[20:23], s47 offen offset:1024 sc1
 s_waitcnt vmcnt(14) lgkmcnt(1)
 v_mfma_f32_16x16x32_bf16 v[96:99], a[84:87], v[88:91], v[96:99]
 v_mfma_f32_16x16x32_bf16 v[100:103], a[88:91], v[88:91], v[100:103]
 v_mfma_f32_16x16x32_bf16 v[104:107], a[92:95], v[88:91], v[104:107]
 v_mfma_f32_16x16x32_bf16 v[108:111], v[28:31], v[88:91], v[108:111]
 buffer_load_dwordx4 v[88:91], v1, s[20:23], s47 offen offset:2048 sc1
 v_mfma_f32_16x16x32_bf16 v[112:115], a[84:87], v[92:95], v[112:115]
 ds_read_b128 v[20:23], v5 offset:9216
 v_mfma_f32_16x16x32_bf16 v[116:119], a[88:91], v[92:95], v[116:119]
 v_mfma_f32_16x16x32_bf16 v[120:123], a[92:95], v[92:95], v[120:123]
 v_mfma_f32_16x16x32_bf16 v[124:127], v[28:31], v[92:95], v[124:127]
 buffer_load_dwordx4 v[92:95], v1, s[20:23], s47 offen offset:3072 sc1
 s_waitcnt vmcnt(14) lgkmcnt(1)
 v_mfma_f32_16x16x32_bf16 v[96:99], a[96:99], v[32:35], v[96:99]
 s_add_u32 s52, s44, 4
 s_and_b32 s52, s52, 7
 v_mfma_f32_16x16x32_bf16 v[100:103], a[100:103], v[32:35], v[100:103]
 s_lshl_b32 s52, s52, 13
 s_add_u32 s46, s48, s52
 v_mfma_f32_16x16x32_bf16 v[104:107], a[104:107], v[32:35], v[104:107]
 s_add_u32 s47, s46, 4096
 v_mfma_f32_16x16x32_bf16 v[108:111], v[16:19], v[32:35], v[108:111]
 buffer_load_dwordx4 v[32:35], v1, s[20:23], s46 offen offset:0 sc1
 v_mfma_f32_16x16x32_bf16 v[112:115], a[96:99], v[36:39], v[112:115]
 ds_read_b128 v[24:27], v5 offset:10240
 v_mfma_f32_16x16x32_bf16 v[116:119], a[100:103], v[36:39], v[116:119]
 v_mfma_f32_16x16x32_bf16 v[120:123], a[104:107], v[36:39], v[120:123]
 v_mfma_f32_16x16x32_bf16 v[124:127], v[16:19], v[36:39], v[124:127]
 buffer_load_dwordx4 v[36:39], v1, s[20:23], s46 offen offset:1024 sc1
 s_waitcnt vmcnt(14) lgkmcnt(1)
 v_mfma_f32_16x16x32_bf16 v[96:99], a[108:111], v[40:43], v[96:99]
 v_mfma_f32_16x16x32_bf16 v[100:103], a[112:115], v[40:43], v[100:103]
 v_mfma_f32_16x16x32_bf16 v[104:107], a[116:119], v[40:43], v[104:107]
 v_mfma_f32_16x16x32_bf16 v[108:111], v[20:23], v[40:43], v[108:111]
 buffer_load_dwordx4 v[40:43], v1, s[20:23], s46 offen offset:2048 sc1
 v_mfma_f32_16x16x32_bf16 v[112:115], a[108:111], v[44:47], v[112:115]
 ds_read_b128 v[28:31], v5 offset:11264
 v_mfma_f32_16x16x32_bf16 v[116:119], a[112:115], v[44:47], v[116:119]
 v_mfma_f32_16x16x32_bf16 v[120:123], a[116:119], v[44:47], v[120:123]
 v_mfma_f32_16x16x32_bf16 v[124:127], v[20:23], v[44:47], v[124:127]
 buffer_load_dwordx4 v[44:47], v1, s[20:23], s46 offen offset:3072 sc1
 s_waitcnt vmcnt(14) lgkmcnt(1)
 v_mfma_f32_16x16x32_bf16 v[96:99], a[120:123], v[48:51], v[96:99]
 s_barrier
 v_mfma_f32_16x16x32_bf16 v[100:103], a[124:127], v[48:51], v[100:103]
 v_mfma_f32_16x16x32_bf16 v[104:107], a[128:131], v[48:51], v[104:107]
 v_mfma_f32_16x16x32_bf16 v[108:111], v[24:27], v[48:51], v[108:111]
 buffer_load_dwordx4 v[48:51], v1, s[20:23], s47 offen offset:0 sc1
 v_mfma_f32_16x16x32_bf16 v[112:115], a[120:123], v[52:55], v[112:115]
 ds_read_b128 v[16:19], v5 offset:12288
 v_mfma_f32_16x16x32_bf16 v[116:119], a[124:127], v[52:55], v[116:119]
 v_mfma_f32_16x16x32_bf16 v[120:123], a[128:131], v[52:55], v[120:123]
 v_mfma_f32_16x16x32_bf16 v[124:127], v[24:27], v[52:55], v[124:127]
 buffer_load_dwordx4 v[52:55], v1, s[20:23], s47 offen offset:1024 sc1
 s_waitcnt vmcnt(14) lgkmcnt(1)
 v_mfma_f32_16x16x32_bf16 v[96:99], a[132:135], v[56:59], v[96:99]
 v_mfma_f32_16x16x32_bf16 v[100:103], a[136:139], v[56:59], v[100:103]
 v_mfma_f32_16x16x32_bf16 v[104:107], a[140:143], v[56:59], v[104:107]
 v_mfma_f32_16x16x32_bf16 v[108:111], v[28:31], v[56:59], v[108:111]
 buffer_load_dwordx4 v[56:59], v1, s[20:23], s47 offen offset:2048 sc1
 v_mfma_f32_16x16x32_bf16 v[112:115], a[132:135], v[60:63], v[112:115]
 ds_read_b128 v[20:23], v5 offset:13312
 v_mfma_f32_16x16x32_bf16 v[116:119], a[136:139], v[60:63], v[116:119]
 v_mfma_f32_16x16x32_bf16 v[120:123], a[140:143], v[60:63], v[120:123]
 v_mfma_f32_16x16x32_bf16 v[124:127], v[28:31], v[60:63], v[124:127]
 buffer_load_dwordx4 v[60:63], v1, s[20:23], s47 offen offset:3072 sc1
 s_waitcnt vmcnt(14) lgkmcnt(1)
 v_mfma_f32_16x16x32_bf16 v[96:99], a[144:147], v[64:67], v[96:99]
 s_add_u32 s52, s44, 5
 s_and_b32 s52, s52, 7
 v_mfma_f32_16x16x32_bf16 v[100:103], a[148:151], v[64:67], v[100:103]
 s_lshl_b32 s52, s52, 13
 s_add_u32 s46, s48, s52
 v_mfma_f32_16x16x32_bf16 v[104:107], a[152:155], v[64:67], v[104:107]
 s_add_u32 s47, s46, 4096
 v_mfma_f32_16x16x32_bf16 v[108:111], v[16:19], v[64:67], v[108:111]
 buffer_load_dwordx4 v[64:67], v1, s[20:23], s46 offen offset:0 sc1
 v_mfma_f32_16x16x32_bf16 v[112:115], a[144:147], v[68:71], v[112:115]
 ds_read_b128 v[24:27], v5 offset:14336
 v_mfma_f32_16x16x32_bf16 v[116:119], a[148:151], v[68:71], v[116:119]
 v_mfma_f32_16x16x32_bf16 v[120:123], a[152:155], v[68:71], v[120:123]
 v_mfma_f32_16x16x32_bf16 v[124:127], v[16:19], v[68:71], v[124:127]
 buffer_load_dwordx4 v[68:71], v1, s[20:23], s46 offen offset:1024 sc1
 s_waitcnt vmcnt(14) lgkmcnt(1)
 v_mfma_f32_16x16x32_bf16 v[96:99], a[156:159], v[72:75], v[96:99]
 buffer_load_dword v2, v3, s[20:23], s53 offen sc1
 v_mfma_f32_16x16x32_bf16 v[100:103], a[160:163], v[72:75], v[100:103]
 v_mfma_f32_16x16x32_bf16 v[104:107], a[164:167], v[72:75], v[104:107]
 v_mfma_f32_16x16x32_bf16 v[108:111], v[20:23], v[72:75], v[108:111]
 buffer_load_dwordx4 v[72:75], v1, s[20:23], s46 offen offset:2048 sc1
 v_mfma_f32_16x16x32_bf16 v[112:115], a[156:159], v[76:79], v[112:115]
 ds_read_b128 v[28:31], v5 offset:15360
 v_mfma_f32_16x16x32_bf16 v[116:119], a[160:163], v[76:79], v[116:119]
 v_mfma_f32_16x16x32_bf16 v[120:123], a[164:167], v[76:79], v[120:123]
 v_mfma_f32_16x16x32_bf16 v[124:127], v[20:23], v[76:79], v[124:127]
 buffer_load_dwordx4 v[76:79], v1, s[20:23], s46 offen offset:3072 sc1
 s_waitcnt vmcnt(14) lgkmcnt(1)
 v_mfma_f32_16x16x32_bf16 v[96:99], a[168:171], v[80:83], v[96:99]
 v_mfma_f32_16x16x32_bf16 v[100:103], a[172:175], v[80:83], v[100:103]
 v_mfma_f32_16x16x32_bf16 v[104:107], a[176:179], v[80:83], v[104:107]
 v_mfma_f32_16x16x32_bf16 v[108:111], v[24:27], v[80:83], v[108:111]
 buffer_load_dwordx4 v[80:83], v1, s[20:23], s47 offen offset:0 sc1
 v_mfma_f32_16x16x32_bf16 v[112:115], a[168:171], v[84:87], v[112:115]
 ds_read_b128 v[16:19], v5 offset:16384
 v_mfma_f32_16x16x32_bf16 v[116:119], a[172:175], v[84:87], v[116:119]
 v_mfma_f32_16x16x32_bf16 v[120:123], a[176:179], v[84:87], v[120:123]
 v_mfma_f32_16x16x32_bf16 v[124:127], v[24:27], v[84:87], v[124:127]
 buffer_load_dwordx4 v[84:87], v1, s[20:23], s47 offen offset:1024 sc1
 s_waitcnt vmcnt(14) lgkmcnt(1)
 v_mfma_f32_16x16x32_bf16 v[96:99], a[180:183], v[88:91], v[96:99]
 v_mfma_f32_16x16x32_bf16 v[100:103], a[184:187], v[88:91], v[100:103]
 v_mfma_f32_16x16x32_bf16 v[104:107], a[188:191], v[88:91], v[104:107]
 v_mfma_f32_16x16x32_bf16 v[108:111], v[28:31], v[88:91], v[108:111]
 buffer_load_dwordx4 v[88:91], v1, s[20:23], s47 offen offset:2048 sc1
 v_mfma_f32_16x16x32_bf16 v[112:115], a[180:183], v[92:95], v[112:115]
 ds_read_b128 v[20:23], v5 offset:17408
 v_mfma_f32_16x16x32_bf16 v[116:119], a[184:187], v[92:95], v[116:119]
 v_mfma_f32_16x16x32_bf16 v[120:123], a[188:191], v[92:95], v[120:123]
 v_mfma_f32_16x16x32_bf16 v[124:127], v[28:31], v[92:95], v[124:127]
 buffer_load_dwordx4 v[92:95], v1, s[20:23], s47 offen offset:3072 sc1
 s_waitcnt vmcnt(14) lgkmcnt(1)
 v_mfma_f32_16x16x32_bf16 v[96:99], a[192:195], v[32:35], v[96:99]
 s_add_u32 s52, s44, 6
 s_and_b32 s52, s52, 7
 v_mfma_f32_16x16x32_bf16 v[100:103], a[196:199], v[32:35], v[100:103]
 s_lshl_b32 s52, s52, 13
 s_add_u32 s46, s48, s52
 v_mfma_f32_16x16x32_bf16 v[104:107], a[200:203], v[32:35], v[104:107]
 s_add_u32 s47, s46, 4096
 v_mfma_f32_16x16x32_bf16 v[108:111], v[16:19], v[32:35], v[108:111]
 buffer_load_dwordx4 v[32:35], v1, s[20:23], s46 offen offset:0 sc1
 v_mfma_f32_16x16x32_bf16 v[112:115], a[192:195], v[36:39], v[112:115]
 ds_read_b128 v[24:27], v5 offset:18432
 v_mfma_f32_16x16x32_bf16 v[116:119], a[196:199], v[36:39], v[116:119]
 v_mfma_f32_16x16x32_bf16 v[120:123], a[200:203], v[36:39], v[120:123]
 v_mfma_f32_16x16x32_bf16 v[124:127], v[16:19], v[36:39], v[124:127]
 buffer_load_dwordx4 v[36:39], v1, s[20:23], s46 offen offset:1024 sc1
 s_waitcnt vmcnt(14) lgkmcnt(1)
 v_mfma_f32_16x16x32_bf16 v[96:99], a[204:207], v[40:43], v[96:99]
 v_mfma_f32_16x16x32_bf16 v[100:103], a[208:211], v[40:43], v[100:103]
 v_mfma_f32_16x16x32_bf16 v[104:107], a[212:215], v[40:43], v[104:107]
 v_mfma_f32_16x16x32_bf16 v[108:111], v[20:23], v[40:43], v[108:111]
 buffer_load_dwordx4 v[40:43], v1, s[20:23], s46 offen offset:2048 sc1
 v_mfma_f32_16x16x32_bf16 v[112:115], a[204:207], v[44:47], v[112:115]
 ds_read_b128 v[28:31], v5 offset:19456
 v_mfma_f32_16x16x32_bf16 v[116:119], a[208:211], v[44:47], v[116:119]
 v_mfma_f32_16x16x32_bf16 v[120:123], a[212:215], v[44:47], v[120:123]
 v_mfma_f32_16x16x32_bf16 v[124:127], v[20:23], v[44:47], v[124:127]
 buffer_load_dwordx4 v[44:47], v1, s[20:23], s46 offen offset:3072 sc1
 s_waitcnt vmcnt(14) lgkmcnt(1)
 v_mfma_f32_16x16x32_bf16 v[96:99], a[216:219], v[48:51], v[96:99]
 v_mfma_f32_16x16x32_bf16 v[100:103], a[220:223], v[48:51], v[100:103]
 v_mfma_f32_16x16x32_bf16 v[104:107], a[224:227], v[48:51], v[104:107]
 v_mfma_f32_16x16x32_bf16 v[108:111], v[24:27], v[48:51], v[108:111]
 buffer_load_dwordx4 v[48:51], v1, s[20:23], s47 offen offset:0 sc1
 v_mfma_f32_16x16x32_bf16 v[112:115], a[216:219], v[52:55], v[112:115]
 ds_read_b128 v[16:19], v5 offset:20480
 v_mfma_f32_16x16x32_bf16 v[116:119], a[220:223], v[52:55], v[116:119]
 v_mfma_f32_16x16x32_bf16 v[120:123], a[224:227], v[52:55], v[120:123]
 v_mfma_f32_16x16x32_bf16 v[124:127], v[24:27], v[52:55], v[124:127]
 buffer_load_dwordx4 v[52:55], v1, s[20:23], s47 offen offset:1024 sc1
 s_waitcnt vmcnt(14) lgkmcnt(1)
 v_mfma_f32_16x16x32_bf16 v[96:99], a[228:231], v[56:59], v[96:99]
 v_mfma_f32_16x16x32_bf16 v[100:103], a[232:235], v[56:59], v[100:103]
 v_mfma_f32_16x16x32_bf16 v[104:107], a[236:239], v[56:59], v[104:107]
 v_mfma_f32_16x16x32_bf16 v[108:111], v[28:31], v[56:59], v[108:111]
 buffer_load_dwordx4 v[56:59], v1, s[20:23], s47 offen offset:2048 sc1
 v_mfma_f32_16x16x32_bf16 v[112:115], a[228:231], v[60:63], v[112:115]
 ds_read_b128 v[20:23], v5 offset:21504
 v_mfma_f32_16x16x32_bf16 v[116:119], a[232:235], v[60:63], v[116:119]
 v_mfma_f32_16x16x32_bf16 v[120:123], a[236:239], v[60:63], v[120:123]
 v_mfma_f32_16x16x32_bf16 v[124:127], v[28:31], v[60:63], v[124:127]
 buffer_load_dwordx4 v[60:63], v1, s[20:23], s47 offen offset:3072 sc1
 s_waitcnt vmcnt(14) lgkmcnt(1)
 v_mfma_f32_16x16x32_bf16 v[96:99], a[240:243], v[64:67], v[96:99]
 s_add_u32 s52, s44, 7
 s_and_b32 s52, s52, 7
 v_mfma_f32_16x16x32_bf16 v[100:103], a[244:247], v[64:67], v[100:103]
 s_lshl_b32 s52, s52, 13
 s_add_u32 s46, s48, s52
 v_mfma_f32_16x16x32_bf16 v[104:107], a[248:251], v[64:67], v[104:107]
 s_add_u32 s47, s46, 4096
 v_mfma_f32_16x16x32_bf16 v[108:111], v[16:19], v[64:67], v[108:111]
 buffer_load_dwordx4 v[64:67], v1, s[20:23], s46 offen offset:0 sc1
 v_mfma_f32_16x16x32_bf16 v[112:115], a[240:243], v[68:71], v[112:115]
 ds_read_b128 v[24:27], v5 offset:22528
 v_mfma_f32_16x16x32_bf16 v[116:119], a[244:247], v[68:71], v[116:119]
 v_mfma_f32_16x16x32_bf16 v[120:123], a[248:251], v[68:71], v[120:123]
 v_mfma_f32_16x16x32_bf16 v[124:127], v[16:19], v[68:71], v[124:127]
 buffer_load_dwordx4 v[68:71], v1, s[20:23], s46 offen offset:1024 sc1
 s_waitcnt vmcnt(14) lgkmcnt(1)
 v_mfma_f32_16x16x32_bf16 v[96:99], a[252:255], v[72:75], v[96:99]
 v_mfma_f32_16x16x32_bf16 v[100:103], v[128:131], v[72:75], v[100:103]
 v_mfma_f32_16x16x32_bf16 v[104:107], v[132:135], v[72:75], v[104:107]
 v_mfma_f32_16x16x32_bf16 v[108:111], v[20:23], v[72:75], v[108:111]
 buffer_load_dwordx4 v[72:75], v1, s[20:23], s46 offen offset:2048 sc1
 v_mfma_f32_16x16x32_bf16 v[112:115], a[252:255], v[76:79], v[112:115]
 ds_read_b128 v[28:31], v5 offset:23552
 v_mfma_f32_16x16x32_bf16 v[116:119], v[128:131], v[76:79], v[116:119]
 v_mfma_f32_16x16x32_bf16 v[120:123], v[132:135], v[76:79], v[120:123]
 v_mfma_f32_16x16x32_bf16 v[124:127], v[20:23], v[76:79], v[124:127]
 buffer_load_dwordx4 v[76:79], v1, s[20:23], s46 offen offset:3072 sc1
 s_waitcnt vmcnt(14) lgkmcnt(1)
 v_mfma_f32_16x16x32_bf16 v[96:99], v[136:139], v[80:83], v[96:99]
 v_cmp_gt_u32 vcc, s51, v2
 v_mfma_f32_16x16x32_bf16 v[100:103], v[140:143], v[80:83], v[100:103]
 v_mfma_f32_16x16x32_bf16 v[104:107], v[144:147], v[80:83], v[104:107]
 v_mfma_f32_16x16x32_bf16 v[108:111], v[24:27], v[80:83], v[108:111]
 buffer_load_dwordx4 v[80:83], v1, s[20:23], s47 offen offset:0 sc1
 v_mfma_f32_16x16x32_bf16 v[112:115], v[136:139], v[84:87], v[112:115]
 ds_read_b128 v[16:19], v5 offset:24576
 v_mfma_f32_16x16x32_bf16 v[116:119], v[140:143], v[84:87], v[116:119]
 v_mfma_f32_16x16x32_bf16 v[120:123], v[144:147], v[84:87], v[120:123]
 v_mfma_f32_16x16x32_bf16 v[124:127], v[24:27], v[84:87], v[124:127]
 buffer_load_dwordx4 v[84:87], v1, s[20:23], s47 offen offset:1024 sc1
 s_waitcnt vmcnt(14) lgkmcnt(1)
 v_mfma_f32_16x16x32_bf16 v[96:99], v[148:151], v[88:91], v[96:99]
 s_and_b32 s52, vcc_lo, 0xffff
 s_cbranch_scc1 Losw_36
Loswk_37:
 v_mfma_f32_16x16x32_bf16 v[100:103], v[152:155], v[88:91], v[100:103]
 s_lshl_b32 s48, s42, 18
 s_add_u32 s48, s48, s36
 v_mfma_f32_16x16x32_bf16 v[104:107], v[156:159], v[88:91], v[104:107]
 v_mfma_f32_16x16x32_bf16 v[108:111], v[28:31], v[88:91], v[108:111]
 buffer_load_dwordx4 v[88:91], v1, s[20:23], s47 offen offset:2048 sc1
 v_mfma_f32_16x16x32_bf16 v[112:115], v[148:151], v[92:95], v[112:115]
 ds_read_b128 v[20:23], v5 offset:25600
 v_mfma_f32_16x16x32_bf16 v[116:119], v[152:155], v[92:95], v[116:119]
 v_mfma_f32_16x16x32_bf16 v[120:123], v[156:159], v[92:95], v[120:123]
 v_mfma_f32_16x16x32_bf16 v[124:127], v[28:31], v[92:95], v[124:127]
 buffer_load_dwordx4 v[92:95], v1, s[20:23], s47 offen offset:3072 sc1
 s_waitcnt vmcnt(14) lgkmcnt(1)
 v_mfma_f32_16x16x32_bf16 v[96:99], v[160:163], v[32:35], v[96:99]
 s_add_u32 s52, s44, 0
 s_and_b32 s52, s52, 7
 v_mfma_f32_16x16x32_bf16 v[100:103], v[164:167], v[32:35], v[100:103]
 s_lshl_b32 s52, s52, 13
 s_add_u32 s46, s48, s52
 v_mfma_f32_16x16x32_bf16 v[104:107], v[168:171], v[32:35], v[104:107]
 s_add_u32 s47, s46, 4096
 v_mfma_f32_16x16x32_bf16 v[108:111], v[16:19], v[32:35], v[108:111]
 buffer_load_dwordx4 v[32:35], v1, s[20:23], s46 offen offset:0 sc1
 v_mfma_f32_16x16x32_bf16 v[112:115], v[160:163], v[36:39], v[112:115]
 ds_read_b128 v[24:27], v5 offset:26624
 v_mfma_f32_16x16x32_bf16 v[116:119], v[164:167], v[36:39], v[116:119]
 v_mfma_f32_16x16x32_bf16 v[120:123], v[168:171], v[36:39], v[120:123]
 v_mfma_f32_16x16x32_bf16 v[124:127], v[16:19], v[36:39], v[124:127]
 buffer_load_dwordx4 v[36:39], v1, s[20:23], s46 offen offset:1024 sc1
 s_waitcnt vmcnt(14) lgkmcnt(1)
 v_mfma_f32_16x16x32_bf16 v[96:99], v[172:175], v[40:43], v[96:99]
 v_mfma_f32_16x16x32_bf16 v[100:103], v[176:179], v[40:43], v[100:103]
 v_mfma_f32_16x16x32_bf16 v[104:107], v[180:183], v[40:43], v[104:107]
 v_mfma_f32_16x16x32_bf16 v[108:111], v[20:23], v[40:43], v[108:111]
 buffer_load_dwordx4 v[40:43], v1, s[20:23], s46 offen offset:2048 sc1
 v_mfma_f32_16x16x32_bf16 v[112:115], v[172:175], v[44:47], v[112:115]
 ds_read_b128 v[28:31], v5 offset:27648
 v_mfma_f32_16x16x32_bf16 v[116:119], v[176:179], v[44:47], v[116:119]
 v_mfma_f32_16x16x32_bf16 v[120:123], v[180:183], v[44:47], v[120:123]
 v_mfma_f32_16x16x32_bf16 v[124:127], v[20:23], v[44:47], v[124:127]
 buffer_load_dwordx4 v[44:47], v1, s[20:23], s46 offen offset:3072 sc1
 s_waitcnt vmcnt(14) lgkmcnt(1)
 v_mfma_f32_16x16x32_bf16 v[96:99], v[184:187], v[48:51], v[96:99]
 v_mfma_f32_16x16x32_bf16 v[100:103], v[188:191], v[48:51], v[100:103]
 v_mfma_f32_16x16x32_bf16 v[104:107], v[192:195], v[48:51], v[104:107]
 v_mfma_f32_16x16x32_bf16 v[108:111], v[24:27], v[48:51], v[108:111]
 buffer_load_dwordx4 v[48:51], v1, s[20:23], s47 offen offset:0 sc1
 v_mfma_f32_16x16x32_bf16 v[112:115], v[184:187], v[52:55], v[112:115]
 ds_read_b128 v[16:19], v5 offset:28672
 v_mfma_f32_16x16x32_bf16 v[116:119], v[188:191], v[52:55], v[116:119]
 v_mfma_f32_16x16x32_bf16 v[120:123], v[192:195], v[52:55], v[120:123]
 v_mfma_f32_16x16x32_bf16 v[124:127], v[24:27], v[52:55], v[124:127]
 buffer_load_dwordx4 v[52:55], v1, s[20:23], s47 offen offset:1024 sc1
 s_waitcnt vmcnt(14) lgkmcnt(1)
 v_mfma_f32_16x16x32_bf16 v[96:99], v[196:199], v[56:59], v[96:99]
 v_mfma_f32_16x16x32_bf16 v[100:103], v[200:203], v[56:59], v[100:103]
 v_mfma_f32_16x16x32_bf16 v[104:107], v[204:207], v[56:59], v[104:107]
 v_mfma_f32_16x16x32_bf16 v[108:111], v[28:31], v[56:59], v[108:111]
 buffer_load_dwordx4 v[56:59], v1, s[20:23], s47 offen offset:2048 sc1
 v_mfma_f32_16x16x32_bf16 v[112:115], v[196:199], v[60:63], v[112:115]
 ds_read_b128 v[20:23], v5 offset:29696
 v_mfma_f32_16x16x32_bf16 v[116:119], v[200:203], v[60:63], v[116:119]
 v_mfma_f32_16x16x32_bf16 v[120:123], v[204:207], v[60:63], v[120:123]
 v_mfma_f32_16x16x32_bf16 v[124:127], v[28:31], v[60:63], v[124:127]
 buffer_load_dwordx4 v[60:63], v1, s[20:23], s47 offen offset:3072 sc1
 s_waitcnt vmcnt(14) lgkmcnt(1)
 v_mfma_f32_16x16x32_bf16 v[96:99], v[208:211], v[64:67], v[96:99]
 s_add_u32 s52, s44, 1
 s_and_b32 s52, s52, 7
 v_mfma_f32_16x16x32_bf16 v[100:103], v[212:215], v[64:67], v[100:103]
 s_lshl_b32 s52, s52, 13
 s_add_u32 s46, s48, s52
 v_mfma_f32_16x16x32_bf16 v[104:107], v[216:219], v[64:67], v[104:107]
 s_add_u32 s47, s46, 4096
 v_mfma_f32_16x16x32_bf16 v[108:111], v[16:19], v[64:67], v[108:111]
 buffer_load_dwordx4 v[64:67], v1, s[20:23], s46 offen offset:0 sc1
 v_mfma_f32_16x16x32_bf16 v[112:115], v[208:211], v[68:71], v[112:115]
 ds_read_b128 v[24:27], v5 offset:30720
 v_mfma_f32_16x16x32_bf16 v[116:119], v[212:215], v[68:71], v[116:119]
 v_mfma_f32_16x16x32_bf16 v[120:123], v[216:219], v[68:71], v[120:123]
 v_mfma_f32_16x16x32_bf16 v[124:127], v[16:19], v[68:71], v[124:127]
 buffer_load_dwordx4 v[68:71], v1, s[20:23], s46 offen offset:1024 sc1
 s_waitcnt vmcnt(14) lgkmcnt(1)
 v_mfma_f32_16x16x32_bf16 v[96:99], v[220:223], v[72:75], v[96:99]
 v_mfma_f32_16x16x32_bf16 v[100:103], v[224:227], v[72:75], v[100:103]
 v_mfma_f32_16x16x32_bf16 v[104:107], v[228:231], v[72:75], v[104:107]
 v_mfma_f32_16x16x32_bf16 v[108:111], v[20:23], v[72:75], v[108:111]
 buffer_load_dwordx4 v[72:75], v1, s[20:23], s46 offen offset:2048 sc1
 v_mfma_f32_16x16x32_bf16 v[112:115], v[220:223], v[76:79], v[112:115]
 ds_read_b128 v[28:31], v5 offset:31744
 v_mfma_f32_16x16x32_bf16 v[116:119], v[224:227], v[76:79], v[116:119]
 v_mfma_f32_16x16x32_bf16 v[120:123], v[228:231], v[76:79], v[120:123]
 v_mfma_f32_16x16x32_bf16 v[124:127], v[20:23], v[76:79], v[124:127]
 buffer_load_dwordx4 v[76:79], v1, s[20:23], s46 offen offset:3072 sc1
 s_waitcnt vmcnt(14) lgkmcnt(1)
 v_mfma_f32_16x16x32_bf16 v[96:99], v[232:235], v[80:83], v[96:99]
 v_mfma_f32_16x16x32_bf16 v[100:103], v[236:239], v[80:83], v[100:103]
 v_mfma_f32_16x16x32_bf16 v[104:107], v[240:243], v[80:83], v[104:107]
 v_mfma_f32_16x16x32_bf16 v[108:111], v[24:27], v[80:83], v[108:111]
 buffer_load_dwordx4 v[80:83], v1, s[20:23], s47 offen offset:0 sc1
 v_mfma_f32_16x16x32_bf16 v[112:115], v[232:235], v[84:87], v[112:115]
 ds_read_b128 v[16:19], v5 offset:0
 v_mfma_f32_16x16x32_bf16 v[116:119], v[236:239], v[84:87], v[116:119]
 v_mfma_f32_16x16x32_bf16 v[120:123], v[240:243], v[84:87], v[120:123]
 v_mfma_f32_16x16x32_bf16 v[124:127], v[24:27], v[84:87], v[124:127]
 buffer_load_dwordx4 v[84:87], v1, s[20:23], s47 offen offset:1024 sc1
 s_waitcnt vmcnt(14) lgkmcnt(1)
 v_mfma_f32_16x16x32_bf16 v[96:99], v[244:247], v[88:91], v[96:99]
 v_mfma_f32_16x16x32_bf16 v[100:103], v[248:251], v[88:91], v[100:103]
 v_mfma_f32_16x16x32_bf16 v[104:107], v[252:255], v[88:91], v[104:107]
 v_mfma_f32_16x16x32_bf16 v[108:111], v[28:31], v[88:91], v[108:111]
 buffer_load_dwordx4 v[88:91], v1, s[20:23], s47 offen offset:2048 sc1
 v_mfma_f32_16x16x32_bf16 v[112:115], v[244:247], v[92:95], v[112:115]
 ds_read_b128 v[20:23], v5 offset:1024
 v_mfma_f32_16x16x32_bf16 v[116:119], v[248:251], v[92:95], v[116:119]
 v_mfma_f32_16x16x32_bf16 v[120:123], v[252:255], v[92:95], v[120:123]
 v_mfma_f32_16x16x32_bf16 v[124:127], v[28:31], v[92:95], v[124:127]
 buffer_load_dwordx4 v[92:95], v1, s[20:23], s47 offen offset:3072 sc1
 s_cmp_lt_u32 s43, s35
 ds_write_b128 v14, v[96:99] offset:32768
 ds_write_b128 v15, v[100:103] offset:33792
 ds_write_b128 v14, v[104:107] offset:34816
 ds_write_b128 v15, v[108:111] offset:35840
 ds_write_b128 v14, v[112:115] offset:36864
 ds_write_b128 v15, v[116:119] offset:37888
 ds_write_b128 v14, v[120:123] offset:38912
 ds_write_b128 v15, v[124:127] offset:39936
 s_waitcnt lgkmcnt(0)
 s_barrier
 ds_read_b128 v[96:99], v4 offset:0
 ds_read_b128 v[100:103], v4 offset:256
 ds_read_b128 v[104:107], v4 offset:40960
 ds_read_b128 v[108:111], v4 offset:41216
 ds_read_b128 v[112:115], v7 offset:0
 ds_read_b128 v[116:119], v7 offset:256
 ds_read_b128 v[120:123], v7 offset:40960
 ds_read_b128 v[124:127], v7 offset:41216
 s_waitcnt lgkmcnt(4)
 v_pk_add_f32 v[96:97], v[96:97], v[104:105]
 v_pk_add_f32 v[98:99], v[98:99], v[106:107]
 v_pk_add_f32 v[100:101], v[100:101], v[108:109]
 v_pk_add_f32 v[102:103], v[102:103], v[110:111]
 s_waitcnt lgkmcnt(2)
 v_pk_add_f32 v[96:97], v[96:97], v[112:113]
 v_pk_add_f32 v[98:99], v[98:99], v[114:115]
 v_pk_add_f32 v[100:101], v[100:101], v[116:117]
 v_pk_add_f32 v[102:103], v[102:103], v[118:119]
 s_waitcnt lgkmcnt(0)
 v_pk_add_f32 v[96:97], v[96:97], v[120:121]
 v_pk_add_f32 v[98:99], v[98:99], v[122:123]
 v_pk_add_f32 v[100:101], v[100:101], v[124:125]
 v_pk_add_f32 v[102:103], v[102:103], v[126:127]
 v_cvt_pk_bf16_f32 v8, v96, v97
 v_cvt_pk_bf16_f32 v9, v98, v99
 v_cvt_pk_bf16_f32 v10, v100, v101
 v_cvt_pk_bf16_f32 v11, v102, v103
 buffer_store_dwordx4 v[8:11], v6, s[24:27], s54 offen
 s_cbranch_scc1 Losl_35
 s_branch Lose_38
Losw_36:
 buffer_load_dword v2, v3, s[20:23], s53 offen sc1
 s_waitcnt vmcnt(0)
 v_cmp_gt_u32 vcc, s51, v2
 s_and_b32 s52, vcc_lo, 0xffff
 s_cbranch_scc0 Loswk_37
 s_sleep 4
 s_sub_u32 s50, s50, 1
 s_cbranch_scc0 Losw_36
 s_endpgm
Lose_38:
 s_waitcnt vmcnt(0)
 s_branch Lfin
Lchain:
 s_load_dwordx2 s[8:9], s[0:1], 64
 s_mov_b32 s10, 0x480000
 s_mov_b32 s11, 0x20000
 s_load_dwordx2 s[12:13], s[0:1], 72
 s_mov_b32 s14, 0x480000
 s_mov_b32 s15, 0x20000
 s_load_dwordx2 s[16:17], s[0:1], 80
 s_mov_b32 s18, 0x480000
 s_mov_b32 s19, 0x20000
 s_load_dwordx2 s[24:25], s[0:1], 88
 s_mov_b32 s26, 0x480000
 s_mov_b32 s27, 0x20000
 s_load_dwordx2 s[28:29], s[0:1], 112
 s_mov_b32 s30, 0x100
 s_mov_b32 s31, 0x20000
 s_load_dwordx2 s[32:33], s[0:1], 56
 s_mov_b32 s34, 0x2400
 s_mov_b32 s35, 0x20000
 v_and_b32 v20, 63, v0
 v_lshlrev_b32 v3, 4, v20
 v_mov_b32 v7, 0
 s_mov_b32 s48, 0xcccccccc
 s_mov_b32 s49, 0xcccccccc
 v_mov_b32 v21, 0x44444444
 v_mov_b32 v22, 0xeeeeeeee
 v_cndmask_b32 v5, v21, v22, s[48:49]
 s_mul_i32 s47, s4, 544
 v_lshrrev_b32 v21, 4, v20
 v_lshlrev_b32 v21, 7, v21
 v_and_b32 v22, 32, v20
 v_add3_u32 v21, v21, v22, s47
 v_and_b32 v22, 15, v20
 v_lshl_add_u32 v8, v22, 3, v21
 v_lshrrev_b32 v21, 5, v20
 v_mul_u32_u24 v21, 544, v21
 v_and_b32 v22, 3, v20
 v_lshl_add_u32 v21, v22, 7, v21
 v_and_b32 v22, 2, v20
 v_lshl_add_u32 v21, v22, 4, v21
 v_and_b32 v22, 16, v20
 v_lshl_add_u32 v21, v22, 2, v21
 v_and_b32 v22, 12, v20
 v_lshl_add_u32 v9, v22, 1, v21
 v_lshrrev_b32 v21, 4, v0
 v_lshlrev_b32 v21, 7, v21
 v_and_b32 v22, 14, v20
 v_lshl_add_u32 v21, v22, 2, v21
 v_and_b32 v22, 1, v20
 v_lshl_add_u32 v10, v22, 1, v21
 v_and_b32 v21, 12, v20
 v_lshlrev_b32 v21, 5, v21
 v_lshl_add_u32 v21, v22, 6, v21
 v_and_b32 v22, 48, v20
 v_add_u32 v11, v21, v22
 s_mov_b32 s55, 0x3e0293ee
 s_mov_b32 s54, 0x40000
 s_lshl_b32 s47, s6, 6
 s_add_u32 s60, s47, 0x100000
 s_add_u32 s61, s47, 0x101000
 s_add_u32 s62, s47, 0x102000
 s_lshl_b32 s47, s6, 7
 s_add_u32 s56, s47, 0x0
 s_add_u32 s57, s47, 0x1000
 s_mul_i32 s47, s6, 10496
 s_add_u32 s40, s47, 0x102000
 s_lshl_b32 s58, s4, 11
 s_add_u32 s47, s47, s58
 s_add_u32 s39, s47, 0x100000
 s_lshl_b32 s42, s4, 11
 s_add_u32 s41, s42, 0x1e0000
 s_mov_b32 s43, 0x1e2000
 s_lshr_b32 s69, s4, 1
 s_mul_i32 s69, s69, 1088
 s_and_b32 s47, s4, 1
 s_lshl_b32 s47, s47, 5
 s_add_u32 s69, s69, s47
 s_lshl_b32 s47, s6, 5
 s_add_u32 s65, s47, 0x1e2000
 s_add_u32 s66, s47, 0x162000
 s_lshr_b32 s47, s6, 3
 s_lshl_b32 s47, s47, 9
 s_and_b32 s58, s6, 1
 s_lshl_b32 s58, s58, 8
 s_add_u32 s47, s47, s58
 s_and_b32 s58, s6, 6
 s_lshl_b32 s58, s58, 5
 s_add_u32 s47, s47, s58
 s_lshl_b32 s58, s4, 11
 s_add_u32 s47, s47, s58
 s_add_u32 s44, s47, 0x1e0000
 s_add_u32 s45, s47, 0x160000
 s_lshl_b32 s47, s6, 14
 s_add_u32 s37, s47, 0x3000000
 s_add_u32 s67, s37, s58
 s_add_u32 s59, s67, 8192
 s_lshl_b32 s47, s6, 12
 s_add_u32 s38, s47, 0x3d0000
 s_mov_b32 s36, 0
 s_mov_b32 s46, 0
 s_waitcnt lgkmcnt(0)
 v_mov_b32 v20, 0
 v_mov_b32 v21, 0
 v_mov_b32 v22, 0
 v_mov_b32 v23, 0
 v_mov_b32 v27, -1
 v_bfe_u32 v24, v3, 8, 1
 v_bfe_u32 v25, v3, 9, 1
 v_lshl_or_b32 v24, v24, 1, v25
 v_bfe_u32 v25, v3, 5, 1
 v_lshl_or_b32 v24, v24, 1, v25
 v_and_b32 v25, 0xd0, v3
 v_lshlrev_b32 v25, 24, v25
 v_lshl_or_b32 v24, v24, 2, v25
 v_bfe_u32 v26, v3, 8, 2
 v_bfe_u32 v25, v3, 2, 4
 v_lshl_or_b32 v26, v26, 4, v25
 v_and_b32 v25, 0xc0, v3
 v_lshl_or_b32 v26, v25, 24, v26
 buffer_store_dwordx4 v[20:23], v3, s[20:23], s39 offen offset:0 sc1
 buffer_store_dwordx4 v[20:23], v3, s[20:23], s39 offen offset:1024 sc1
 buffer_store_dwordx4 v[20:23], v3, s[20:23], s40 offen offset:0 sc1
 buffer_store_dwordx4 v[20:23], v3, s[20:23], s40 offen offset:1024 sc1
 buffer_store_dword v27, v26, s[20:23], s44 offen sc1
 buffer_store_dword v27, v26, s[20:23], s45 offen sc1
 buffer_store_dword v27, v24, s[20:23], s65 offen sc1
 buffer_store_dword v27, v24, s[20:23], s66 offen sc1
 v_and_b32 v30, 63, v0
 v_bfe_u32 v31, v30, 1, 2
 v_lshrrev_b32 v32, 5, v30
 v_xor_b32 v31, v31, v32
 v_lshlrev_b32 v31, 5, v31
 v_and_b32 v32, 1, v30
 v_lshl_add_u32 v31, v32, 4, v31
 v_xor_b32 v33, 64, v31
 v_lshrrev_b32 v32, 3, v30
 s_lshl_b32 s47, s4, 4
 v_and_b32 v34, 3, v32
 v_lshrrev_b32 v35, 2, v32
 v_lshl_add_u32 v34, v34, 1, v35
 v_add_u32 v34, s47, v34
 v_lshl_add_u32 v12, v34, 13, v31
 v_add_u32 v34, 8, v34
 v_lshl_add_u32 v13, v34, 13, v33
 v_and_b32 v34, 1, v32
 v_lshlrev_b32 v34, 6, v34
 v_and_b32 v35, 6, v32
 s_lshl_b32 s47, s4, 3
 v_add3_u32 v34, v34, v35, s47
 v_lshl_add_u32 v56, v34, 13, v31
 v_add_u32 v34, 1, v34
 v_lshl_add_u32 v57, v34, 13, v33
 v_lshrrev_b32 v34, 3, v0
 v_mul_u32_u24 v34, 1152, v34
 v_add_u32 v14, v34, v31
 v_add_u32 v34, 73728, v34
 v_add_u32 v15, v34, v33
 v_bfe_u32 v31, v30, 4, 1
 v_bfe_u32 v32, v30, 3, 1
 v_lshl_add_u32 v33, v32, 1, v31
 v_xor_b32 v33, s4, v33
 v_lshlrev_b32 v33, 5, v33
 v_lshl_add_u32 v33, v31, 9, v33
 v_lshl_add_u32 v33, v32, 10, v33
 v_bfe_u32 v31, v30, 2, 1
 v_lshl_add_u32 v33, v31, 7, v33
 v_lshrrev_b32 v31, 5, v30
 v_lshl_add_u32 v33, v31, 11, v33
 v_and_b32 v31, 3, v30
 v_lshl_add_u32 v16, v31, 3, v33
 v_add_u32 v17, 0x10000, v16
 v_add_u32 v18, 0x20000, v16
 v_lshlrev_b32 v60, 4, v0
 v_add_u32 v61, 0x10000, v60
 v_add_u32 v62, 0x20000, v60
 s_lshl_b32 s70, s6, 8
 s_mul_i32 s71, s6, 147456
 s_lshl_b32 s72, s4, 11
 s_lshl_b32 s47, s4, 4
 v_add_u32 v31, s47, v30
 s_lshr_b32 s47, s4, 1
 s_lshl_b32 s47, s47, 5
 v_add_u32 v32, s47, v31
 v_lshrrev_b32 v33, 4, v30
 v_lshlrev_b32 v33, 28, v33
 v_lshl_or_b32 v58, v31, 13, v33
 v_lshl_or_b32 v19, v32, 13, v33
 v_mul_u32_u24 v32, 1152, v32
 v_or_b32 v59, v32, v33
 s_add_u32 m0, s72, 24576
 s_add_u32 s47, s70, 0
 buffer_load_dwordx4 v56, s[8:11], s47 offen nt lds
 s_add_u32 m0, s72, 25600
 s_nop 0
 buffer_load_dwordx4 v57, s[8:11], s47 offen nt lds
 s_add_u32 m0, s72, 32768
 s_add_u32 s47, s70, 128
 buffer_load_dwordx4 v56, s[8:11], s47 offen nt lds
 s_add_u32 m0, s72, 33792
 s_nop 0
 buffer_load_dwordx4 v57, s[8:11], s47 offen nt lds
 s_add_u32 m0, s72, 40960
 s_add_u32 s47, s70, 0
 buffer_load_dwordx4 v56, s[12:15], s47 offen nt lds
 s_add_u32 m0, s72, 41984
 s_nop 0
 buffer_load_dwordx4 v57, s[12:15], s47 offen nt lds
 s_add_u32 m0, s72, 49152
 s_add_u32 s47, s70, 0
 buffer_load_dwordx4 v56, s[16:19], s47 offen nt lds
 s_add_u32 m0, s72, 50176
 s_nop 0
 buffer_load_dwordx4 v57, s[16:19], s47 offen nt lds
 s_add_u32 m0, s72, 57344
 s_add_u32 s47, s70, 128
 buffer_load_dwordx4 v56, s[16:19], s47 offen nt lds
 s_add_u32 m0, s72, 58368
 s_nop 0
 buffer_load_dwordx4 v57, s[16:19], s47 offen nt lds
 s_add_u32 m0, s72, 65536
 s_add_u32 s47, s70, 262144
 buffer_load_dwordx4 v56, s[8:11], s47 offen nt lds
 s_add_u32 m0, s72, 66560
 s_nop 0
 buffer_load_dwordx4 v57, s[8:11], s47 offen nt lds
 s_add_u32 m0, s72, 73728
 s_add_u32 s47, s70, 262272
 buffer_load_dwordx4 v56, s[8:11], s47 offen nt lds
 s_add_u32 m0, s72, 74752
 s_nop 0
 buffer_load_dwordx4 v57, s[8:11], s47 offen nt lds
 s_add_u32 m0, s72, 81920
 s_add_u32 s47, s70, 262144
 buffer_load_dwordx4 v56, s[12:15], s47 offen nt lds
 s_add_u32 m0, s72, 82944
 s_nop 0
 buffer_load_dwordx4 v57, s[12:15], s47 offen nt lds
 s_waitcnt vmcnt(14)
 s_waitcnt lgkmcnt(0)
 s_barrier
 s_getreg_b32 s73, hwreg(HW_REG_XCC_ID, 0, 3)
 s_lshl_b32 s73, s73, 3
 s_lshl_b64 s[74:75], 1, s73
 v_mov_b32 v64, s74
 v_mov_b32 v65, s75
 v_mov_b32 v66, 0x7ff00000
 v_cmp_eq_u32 vcc, 0, v0
 s_nop 1
 v_cndmask_b32 v66, v66, v7, vcc
 buffer_atomic_add_x2 v[64:65], v66, s[28:31], 0 offen offset:8
 s_add_u32 m0, s72, 90112
 s_add_u32 s47, s70, 262144
 buffer_load_dwordx4 v56, s[16:19], s47 offen nt lds
 s_add_u32 m0, s72, 91136
 s_nop 0
 buffer_load_dwordx4 v57, s[16:19], s47 offen nt lds
 ds_read_b64_tr_b16 v[72:73], v16 offset:24576
 ds_read_b64_tr_b16 v[74:75], v16 offset:24832
 ds_read_b64_tr_b16 v[76:77], v16 offset:28672
 ds_read_b64_tr_b16 v[78:79], v16 offset:28928
 s_waitcnt vmcnt(15)
 s_waitcnt lgkmcnt(0)
 s_barrier
 s_add_u32 m0, s72, 98304
 s_add_u32 s47, s70, 262272
 buffer_load_dwordx4 v56, s[16:19], s47 offen nt lds
 s_add_u32 m0, s72, 99328
 s_nop 0
 buffer_load_dwordx4 v57, s[16:19], s47 offen nt lds
 ds_read_b64_tr_b16 v[80:81], v16 offset:32768
 ds_read_b64_tr_b16 v[82:83], v16 offset:33024
 ds_read_b64_tr_b16 v[84:85], v16 offset:36864
 ds_read_b64_tr_b16 v[86:87], v16 offset:37120
 s_waitcnt vmcnt(15)
 s_waitcnt lgkmcnt(0)
 s_barrier
 s_add_u32 m0, s72, 106496
 s_add_u32 s47, s70, 1048576
 buffer_load_dwordx4 v56, s[8:11], s47 offen nt lds
 s_add_u32 m0, s72, 107520
 s_nop 0
 buffer_load_dwordx4 v57, s[8:11], s47 offen nt lds
 ds_read_b64_tr_b16 v[88:89], v16 offset:40960
 ds_read_b64_tr_b16 v[90:91], v16 offset:41216
 ds_read_b64_tr_b16 v[92:93], v16 offset:45056
 ds_read_b64_tr_b16 v[94:95], v16 offset:45312
 s_waitcnt vmcnt(15)
 s_waitcnt lgkmcnt(0)
 s_barrier
 s_add_u32 m0, s72, 114688
 s_add_u32 s47, s70, 1048704
 buffer_load_dwordx4 v56, s[8:11], s47 offen nt lds
 s_add_u32 m0, s72, 115712
 s_nop 0
 buffer_load_dwordx4 v57, s[8:11], s47 offen nt lds
 ds_read_b64_tr_b16 v[96:97], v16 offset:49152
 ds_read_b64_tr_b16 v[98:99], v16 offset:49408
 ds_read_b64_tr_b16 v[100:101], v16 offset:53248
 ds_read_b64_tr_b16 v[102:103], v16 offset:53504
 s_waitcnt vmcnt(15)
 s_waitcnt lgkmcnt(0)
 s_barrier
 s_add_u32 m0, s72, 122880
 s_add_u32 s47, s70, 1048576
 buffer_load_dwordx4 v56, s[12:15], s47 offen nt lds
 s_add_u32 m0, s72, 123904
 s_nop 0
 buffer_load_dwordx4 v57, s[12:15], s47 offen nt lds
 v_lshrrev_b32 v68, 4, v3
 v_bfe_u32 v69, v68, 2, 2
 v_and_b32 v70, 1, v68
 v_lshl_add_u32 v69, v69, 1, v70
 v_mul_u32_u24 v69, 1152, v69
 v_and_b32 v70, 48, v68
 v_and_b32 v71, 2, v68
 v_lshl_add_u32 v71, v71, 2, v70
 v_lshl_add_u32 v71, v71, 1, v69
 v_add_u32 v69, v70, v69
 s_lshr_b32 s47, s4, 1
 s_lshl_b32 s47, s47, 8
 s_and_b32 s58, s4, 1
 s_lshl_b32 s58, s58, 6
 s_add_u32 s47, s47, s58
 buffer_load_dwordx4 v[20:23], v69, s[32:35], s47 offen offset:0
 buffer_load_dwordx4 v[24:27], v69, s[32:35], s47 offen offset:128
 buffer_load_dwordx4 v[28:31], v69, s[32:35], s47 offen offset:512
 buffer_load_dwordx4 v[32:35], v69, s[32:35], s47 offen offset:640
 buffer_load_dwordx4 v[36:39], v71, s[32:35], 0 offen offset:1024
 ds_read_b64_tr_b16 v[104:105], v16 offset:57344
 ds_read_b64_tr_b16 v[106:107], v16 offset:57600
 ds_read_b64_tr_b16 v[108:109], v16 offset:61440
 ds_read_b64_tr_b16 v[110:111], v16 offset:61696
 s_waitcnt vmcnt(20)
 s_waitcnt lgkmcnt(0)
 s_barrier
 s_add_u32 m0, s72, 131072
 s_add_u32 s47, s70, 1048576
 buffer_load_dwordx4 v56, s[16:19], s47 offen nt lds
 s_add_u32 m0, s72, 132096
 s_nop 0
 buffer_load_dwordx4 v57, s[16:19], s47 offen nt lds
 ds_read_b64_tr_b16 v[112:113], v17 offset:0
 ds_read_b64_tr_b16 v[114:115], v17 offset:256
 ds_read_b64_tr_b16 v[116:117], v17 offset:4096
 ds_read_b64_tr_b16 v[118:119], v17 offset:4352
 s_waitcnt vmcnt(20)
 s_waitcnt lgkmcnt(0)
 s_barrier
 s_add_u32 m0, s72, 139264
 s_add_u32 s47, s70, 1048704
 buffer_load_dwordx4 v56, s[16:19], s47 offen nt lds
 s_add_u32 m0, s72, 140288
 s_nop 0
 buffer_load_dwordx4 v57, s[16:19], s47 offen nt lds
 ds_read_b64_tr_b16 v[120:121], v17 offset:8192
 ds_read_b64_tr_b16 v[122:123], v17 offset:8448
 ds_read_b64_tr_b16 v[124:125], v17 offset:12288
 ds_read_b64_tr_b16 v[126:127], v17 offset:12544
 s_waitcnt vmcnt(20)
 s_waitcnt lgkmcnt(0)
 s_barrier
 s_add_u32 m0, s72, 147456
 s_add_u32 s47, s70, 1310720
 buffer_load_dwordx4 v56, s[8:11], s47 offen nt lds
 s_add_u32 m0, s72, 148480
 s_nop 0
 buffer_load_dwordx4 v57, s[8:11], s47 offen nt lds
 ds_read_b64_tr_b16 v[128:129], v17 offset:16384
 ds_read_b64_tr_b16 v[130:131], v17 offset:16640
 ds_read_b64_tr_b16 v[132:133], v17 offset:20480
 ds_read_b64_tr_b16 v[134:135], v17 offset:20736
 s_waitcnt vmcnt(19)
 s_waitcnt lgkmcnt(0)
 s_barrier
 s_add_u32 m0, s72, 155648
 s_add_u32 s47, s70, 1310848
 buffer_load_dwordx4 v56, s[8:11], s47 offen nt lds
 s_add_u32 m0, s72, 156672
 s_nop 0
 buffer_load_dwordx4 v57, s[8:11], s47 offen nt lds
 ds_read_b64_tr_b16 v[136:137], v17 offset:24576
 ds_read_b64_tr_b16 v[138:139], v17 offset:24832
 ds_read_b64_tr_b16 v[140:141], v17 offset:28672
 ds_read_b64_tr_b16 v[142:143], v17 offset:28928
 s_waitcnt vmcnt(19)
 s_waitcnt lgkmcnt(0)
 s_barrier
 s_add_u32 m0, s72, 24576
 s_add_u32 s47, s70, 1310720
 buffer_load_dwordx4 v56, s[12:15], s47 offen nt lds
 s_add_u32 m0, s72, 25600
 s_nop 0
 buffer_load_dwordx4 v57, s[12:15], s47 offen nt lds
 ds_read_b64_tr_b16 v[144:145], v17 offset:32768
 ds_read_b64_tr_b16 v[146:147], v17 offset:33024
 ds_read_b64_tr_b16 v[148:149], v17 offset:36864
 ds_read_b64_tr_b16 v[150:151], v17 offset:37120
 s_waitcnt vmcnt(19)
 s_waitcnt lgkmcnt(0)
 s_barrier
 s_add_u32 m0, s72, 32768
 s_add_u32 s47, s70, 1310720
 buffer_load_dwordx4 v56, s[16:19], s47 offen nt lds
 s_add_u32 m0, s72, 33792
 s_nop 0
 buffer_load_dwordx4 v57, s[16:19], s47 offen nt lds
 ds_read_b64_tr_b16 v[152:153], v17 offset:40960
 ds_read_b64_tr_b16 v[154:155], v17 offset:41216
 ds_read_b64_tr_b16 v[156:157], v17 offset:45056
 ds_read_b64_tr_b16 v[158:159], v17 offset:45312
 s_waitcnt vmcnt(19)
 s_waitcnt lgkmcnt(0)
 s_barrier
 s_add_u32 m0, s72, 40960
 s_add_u32 s47, s70, 1310848
 buffer_load_dwordx4 v56, s[16:19], s47 offen nt lds
 s_add_u32 m0, s72, 41984
 s_nop 0
 buffer_load_dwordx4 v57, s[16:19], s47 offen nt lds
 ds_read_b64_tr_b16 v[160:161], v17 offset:49152
 ds_read_b64_tr_b16 v[162:163], v17 offset:49408
 ds_read_b64_tr_b16 v[164:165], v17 offset:53248
 ds_read_b64_tr_b16 v[166:167], v17 offset:53504
 s_waitcnt vmcnt(19)
 s_waitcnt lgkmcnt(0)
 s_barrier
 s_add_u32 m0, s72, 49152
 s_add_u32 s47, s70, 2097152
 buffer_load_dwordx4 v56, s[8:11], s47 offen nt lds
 s_add_u32 m0, s72, 50176
 s_nop 0
 buffer_load_dwordx4 v57, s[8:11], s47 offen nt lds
 ds_read_b64_tr_b16 v[168:169], v17 offset:57344
 ds_read_b64_tr_b16 v[170:171], v17 offset:57600
 ds_read_b64_tr_b16 v[172:173], v17 offset:61440
 ds_read_b64_tr_b16 v[174:175], v17 offset:61696
 s_waitcnt vmcnt(14)
 s_waitcnt lgkmcnt(0)
 s_barrier
 s_add_u32 m0, s72, 57344
 s_add_u32 s47, s70, 2097280
 buffer_load_dwordx4 v56, s[8:11], s47 offen nt lds
 s_add_u32 m0, s72, 58368
 s_nop 0
 buffer_load_dwordx4 v57, s[8:11], s47 offen nt lds
 ds_read_b64_tr_b16 v[176:177], v18 offset:0
 ds_read_b64_tr_b16 v[178:179], v18 offset:256
 ds_read_b64_tr_b16 v[180:181], v18 offset:4096
 ds_read_b64_tr_b16 v[182:183], v18 offset:4352
 s_waitcnt vmcnt(14)
 s_waitcnt lgkmcnt(0)
 s_barrier
 s_add_u32 m0, s72, 65536
 s_add_u32 s47, s70, 2097152
 buffer_load_dwordx4 v56, s[12:15], s47 offen nt lds
 s_add_u32 m0, s72, 66560
 s_nop 0
 buffer_load_dwordx4 v57, s[12:15], s47 offen nt lds
 v_mov_b32 v68, 0x05040100
 v_mov_b32 v69, 0x07060302
 v_cndmask_b32 v70, v68, v69, s[48:49]
 v_perm_b32 v20, v24, v20, v70
 v_perm_b32 v21, v25, v21, v70
 v_perm_b32 v22, v26, v22, v70
 v_perm_b32 v23, v27, v23, v70
 v_perm_b32 v28, v32, v28, v70
 v_perm_b32 v29, v33, v29, v70
 v_perm_b32 v30, v34, v30, v70
 v_perm_b32 v31, v35, v31, v70
 v_perm_b32 v24, v37, v36, v68
 v_perm_b32 v25, v39, v38, v68
 v_perm_b32 v26, v37, v36, v69
 v_perm_b32 v27, v39, v38, v69
 ds_write_b128 v60, v[20:23]
 ds_write_b128 v60, v[28:31] offset:4096
 ds_write_b128 v3, v[24:27] offset:8192
 ds_read_b64_tr_b16 v[184:185], v18 offset:8192
 ds_read_b64_tr_b16 v[186:187], v18 offset:8448
 ds_read_b64_tr_b16 v[188:189], v18 offset:12288
 ds_read_b64_tr_b16 v[190:191], v18 offset:12544
 s_waitcnt vmcnt(14)
 s_waitcnt lgkmcnt(0)
 s_barrier
 s_add_u32 m0, s72, 73728
 s_add_u32 s47, s70, 2097152
 buffer_load_dwordx4 v56, s[16:19], s47 offen nt lds
 s_add_u32 m0, s72, 74752
 s_nop 0
 buffer_load_dwordx4 v57, s[16:19], s47 offen nt lds
 ds_read_b64_tr_b16 v[192:193], v18 offset:16384
 ds_read_b64_tr_b16 v[194:195], v18 offset:16640
 ds_read_b64_tr_b16 v[196:197], v18 offset:20480
 ds_read_b64_tr_b16 v[198:199], v18 offset:20736
 s_waitcnt vmcnt(14)
 s_waitcnt lgkmcnt(0)
 s_barrier
 s_add_u32 m0, s72, 81920
 s_add_u32 s47, s70, 2097280
 buffer_load_dwordx4 v56, s[16:19], s47 offen nt lds
 s_add_u32 m0, s72, 82944
 s_nop 0
 buffer_load_dwordx4 v57, s[16:19], s47 offen nt lds
 ds_read_b64_tr_b16 v[200:201], v18 offset:24576
 ds_read_b64_tr_b16 v[202:203], v18 offset:24832
 ds_read_b64_tr_b16 v[204:205], v18 offset:28672
 ds_read_b64_tr_b16 v[206:207], v18 offset:28928
 s_waitcnt vmcnt(14)
 s_waitcnt lgkmcnt(0)
 s_barrier
 s_add_u32 m0, s72, 90112
 s_add_u32 s47, s70, 2359296
 buffer_load_dwordx4 v56, s[8:11], s47 offen nt lds
 s_add_u32 m0, s72, 91136
 s_nop 0
 buffer_load_dwordx4 v57, s[8:11], s47 offen nt lds
 ds_read_b64_tr_b16 v[208:209], v16 offset:24576
 ds_read_b64_tr_b16 v[210:211], v16 offset:24832
 ds_read_b64_tr_b16 v[212:213], v16 offset:28672
 ds_read_b64_tr_b16 v[214:215], v16 offset:28928
 s_waitcnt vmcnt(14)
 s_waitcnt lgkmcnt(0)
 s_barrier
 s_add_u32 m0, s72, 98304
 s_add_u32 s47, s70, 2359424
 buffer_load_dwordx4 v56, s[8:11], s47 offen nt lds
 s_add_u32 m0, s72, 99328
 s_nop 0
 buffer_load_dwordx4 v57, s[8:11], s47 offen nt lds
 ds_read_b64_tr_b16 v[216:217], v16 offset:32768
 ds_read_b64_tr_b16 v[218:219], v16 offset:33024
 ds_read_b64_tr_b16 v[220:221], v16 offset:36864
 ds_read_b64_tr_b16 v[222:223], v16 offset:37120
 s_waitcnt vmcnt(14)
 s_waitcnt lgkmcnt(0)
 s_barrier
 s_add_u32 m0, s72, 106496
 s_add_u32 s47, s70, 2359296
 buffer_load_dwordx4 v56, s[12:15], s47 offen nt lds
 s_add_u32 m0, s72, 107520
 s_nop 0
 buffer_load_dwordx4 v57, s[12:15], s47 offen nt lds
 ds_read_b64_tr_b16 v[224:225], v16 offset:40960
 ds_read_b64_tr_b16 v[226:227], v16 offset:41216
 ds_read_b64_tr_b16 v[228:229], v16 offset:45056
 ds_read_b64_tr_b16 v[230:231], v16 offset:45312
 s_waitcnt vmcnt(14)
 s_waitcnt lgkmcnt(0)
 s_barrier
 s_add_u32 m0, s72, 114688
 s_add_u32 s47, s70, 2359296
 buffer_load_dwordx4 v56, s[16:19], s47 offen nt lds
 s_add_u32 m0, s72, 115712
 s_nop 0
 buffer_load_dwordx4 v57, s[16:19], s47 offen nt lds
 ds_read_b64_tr_b16 v[232:233], v16 offset:49152
 ds_read_b64_tr_b16 v[234:235], v16 offset:49408
 ds_read_b64_tr_b16 v[236:237], v16 offset:53248
 ds_read_b64_tr_b16 v[238:239], v16 offset:53504
 s_waitcnt vmcnt(14)
 s_waitcnt lgkmcnt(0)
 s_barrier
 s_add_u32 m0, s72, 122880
 s_add_u32 s47, s70, 2359424
 buffer_load_dwordx4 v56, s[16:19], s47 offen nt lds
 s_add_u32 m0, s72, 123904
 s_nop 0
 buffer_load_dwordx4 v57, s[16:19], s47 offen nt lds
 ds_read_b64_tr_b16 v[240:241], v16 offset:57344
 ds_read_b64_tr_b16 v[242:243], v16 offset:57600
 ds_read_b64_tr_b16 v[244:245], v16 offset:61440
 ds_read_b64_tr_b16 v[246:247], v16 offset:61696
 s_waitcnt vmcnt(14)
 s_waitcnt lgkmcnt(0)
 s_barrier
 s_add_u32 m0, s72, 131072
 s_add_u32 s47, s70, 3145728
 buffer_load_dwordx4 v56, s[8:11], s47 offen nt lds
 s_add_u32 m0, s72, 132096
 s_nop 0
 buffer_load_dwordx4 v57, s[8:11], s47 offen nt lds
 ds_read_b64_tr_b16 v[248:249], v17 offset:0
 ds_read_b64_tr_b16 v[250:251], v17 offset:256
 ds_read_b64_tr_b16 v[252:253], v17 offset:4096
 ds_read_b64_tr_b16 v[254:255], v17 offset:4352
 s_waitcnt vmcnt(14)
 s_waitcnt lgkmcnt(0)
 s_barrier
 s_add_u32 m0, s72, 139264
 s_add_u32 s47, s70, 3145856
 buffer_load_dwordx4 v56, s[8:11], s47 offen nt lds
 s_add_u32 m0, s72, 140288
 s_nop 0
 buffer_load_dwordx4 v57, s[8:11], s47 offen nt lds
 ds_read_b64_tr_b16 a[0:1], v17 offset:8192
 ds_read_b64_tr_b16 a[2:3], v17 offset:8448
 ds_read_b64_tr_b16 a[4:5], v17 offset:12288
 ds_read_b64_tr_b16 a[6:7], v17 offset:12544
 s_waitcnt vmcnt(14)
 s_waitcnt lgkmcnt(0)
 s_barrier
 s_add_u32 m0, s72, 147456
 s_add_u32 s47, s70, 3145728
 buffer_load_dwordx4 v56, s[12:15], s47 offen nt lds
 s_add_u32 m0, s72, 148480
 s_nop 0
 buffer_load_dwordx4 v57, s[12:15], s47 offen nt lds
 ds_read_b64_tr_b16 a[8:9], v17 offset:16384
 ds_read_b64_tr_b16 a[10:11], v17 offset:16640
 ds_read_b64_tr_b16 a[12:13], v17 offset:20480
 ds_read_b64_tr_b16 a[14:15], v17 offset:20736
 s_waitcnt vmcnt(14)
 s_waitcnt lgkmcnt(0)
 s_barrier
 s_add_u32 m0, s72, 155648
 s_add_u32 s47, s70, 3145728
 buffer_load_dwordx4 v56, s[16:19], s47 offen nt lds
 s_add_u32 m0, s72, 156672
 s_nop 0
 buffer_load_dwordx4 v57, s[16:19], s47 offen nt lds
 ds_read_b64_tr_b16 a[16:17], v17 offset:24576
 ds_read_b64_tr_b16 a[18:19], v17 offset:24832
 ds_read_b64_tr_b16 a[20:21], v17 offset:28672
 ds_read_b64_tr_b16 a[22:23], v17 offset:28928
 s_waitcnt vmcnt(14)
 s_waitcnt lgkmcnt(0)
 s_barrier
 s_add_u32 m0, s72, 24576
 s_add_u32 s47, s70, 3145856
 buffer_load_dwordx4 v56, s[16:19], s47 offen nt lds
 s_add_u32 m0, s72, 25600
 s_nop 0
 buffer_load_dwordx4 v57, s[16:19], s47 offen nt lds
 ds_read_b64_tr_b16 a[24:25], v17 offset:32768
 ds_read_b64_tr_b16 a[26:27], v17 offset:33024
 ds_read_b64_tr_b16 a[28:29], v17 offset:36864
 ds_read_b64_tr_b16 a[30:31], v17 offset:37120
 s_waitcnt vmcnt(14)
 s_waitcnt lgkmcnt(0)
 s_barrier
 s_add_u32 m0, s72, 32768
 s_add_u32 s47, s70, 3407872
 buffer_load_dwordx4 v56, s[8:11], s47 offen nt lds
 s_add_u32 m0, s72, 33792
 s_nop 0
 buffer_load_dwordx4 v57, s[8:11], s47 offen nt lds
 ds_read_b64_tr_b16 a[32:33], v17 offset:40960
 ds_read_b64_tr_b16 a[34:35], v17 offset:41216
 ds_read_b64_tr_b16 a[36:37], v17 offset:45056
 ds_read_b64_tr_b16 a[38:39], v17 offset:45312
 s_waitcnt vmcnt(14)
 s_waitcnt lgkmcnt(0)
 s_barrier
 s_add_u32 m0, s72, 40960
 s_add_u32 s47, s70, 3408000
 buffer_load_dwordx4 v56, s[8:11], s47 offen nt lds
 s_add_u32 m0, s72, 41984
 s_nop 0
 buffer_load_dwordx4 v57, s[8:11], s47 offen nt lds
 ds_read_b64_tr_b16 a[40:41], v17 offset:49152
 ds_read_b64_tr_b16 a[42:43], v17 offset:49408
 ds_read_b64_tr_b16 a[44:45], v17 offset:53248
 ds_read_b64_tr_b16 a[46:47], v17 offset:53504
 s_waitcnt vmcnt(14)
 s_waitcnt lgkmcnt(0)
 s_barrier
 s_add_u32 m0, s72, 49152
 s_add_u32 s47, s70, 3407872
 buffer_load_dwordx4 v56, s[12:15], s47 offen nt lds
 s_add_u32 m0, s72, 50176
 s_nop 0
 buffer_load_dwordx4 v57, s[12:15], s47 offen nt lds
 ds_read_b64_tr_b16 a[48:49], v17 offset:57344
 ds_read_b64_tr_b16 a[50:51], v17 offset:57600
 ds_read_b64_tr_b16 a[52:53], v17 offset:61440
 ds_read_b64_tr_b16 a[54:55], v17 offset:61696
 s_waitcnt vmcnt(14)
 s_waitcnt lgkmcnt(0)
 s_barrier
 s_add_u32 m0, s72, 57344
 s_add_u32 s47, s70, 3407872
 buffer_load_dwordx4 v56, s[16:19], s47 offen nt lds
 s_add_u32 m0, s72, 58368
 s_nop 0
 buffer_load_dwordx4 v57, s[16:19], s47 offen nt lds
 v_min_u32 v65, 16, v3
 v_lshlrev_b32 v65, 24, v65
 buffer_load_dwordx4 v[68:71], v65, s[28:31], 0 offen sc1
 ds_read_b64_tr_b16 a[56:57], v18 offset:0
 ds_read_b64_tr_b16 a[58:59], v18 offset:256
 ds_read_b64_tr_b16 a[60:61], v18 offset:4096
 ds_read_b64_tr_b16 a[62:63], v18 offset:4352
 s_waitcnt vmcnt(15)
 s_waitcnt lgkmcnt(0)
 s_barrier
 s_add_u32 m0, s72, 65536
 s_add_u32 s47, s70, 3408000
 buffer_load_dwordx4 v56, s[16:19], s47 offen nt lds
 s_add_u32 m0, s72, 66560
 s_nop 0
 buffer_load_dwordx4 v57, s[16:19], s47 offen nt lds
 ds_read_b64_tr_b16 a[64:65], v18 offset:8192
 ds_read_b64_tr_b16 a[66:67], v18 offset:8448
 ds_read_b64_tr_b16 a[68:69], v18 offset:12288
 ds_read_b64_tr_b16 a[70:71], v18 offset:12544
 s_waitcnt vmcnt(15)
 s_waitcnt lgkmcnt(0)
 s_barrier
 s_add_u32 m0, s72, 73728
 s_add_u32 s47, s70, 4194304
 buffer_load_dwordx4 v12, s[8:11], s47 offen nt lds
 s_add_u32 m0, s72, 74752
 s_nop 0
 buffer_load_dwordx4 v13, s[8:11], s47 offen nt lds
 ds_read_b64_tr_b16 a[72:73], v18 offset:16384
 ds_read_b64_tr_b16 a[74:75], v18 offset:16640
 ds_read_b64_tr_b16 a[76:77], v18 offset:20480
 ds_read_b64_tr_b16 a[78:79], v18 offset:20736
 s_waitcnt vmcnt(15)
 s_waitcnt lgkmcnt(0)
 s_barrier
 s_add_u32 m0, s72, 81920
 s_add_u32 s47, s70, 4194432
 buffer_load_dwordx4 v12, s[8:11], s47 offen nt lds
 s_add_u32 m0, s72, 82944
 s_nop 0
 buffer_load_dwordx4 v13, s[8:11], s47 offen nt lds
 ds_read_b64_tr_b16 a[80:81], v18 offset:24576
 ds_read_b64_tr_b16 a[82:83], v18 offset:24832
 ds_read_b64_tr_b16 a[84:85], v18 offset:28672
 ds_read_b64_tr_b16 a[86:87], v18 offset:28928
 s_waitcnt vmcnt(15)
 s_waitcnt lgkmcnt(0)
 s_barrier
 s_add_u32 m0, s72, 90112
 s_add_u32 s47, s70, 4194304
 buffer_load_dwordx4 v12, s[12:15], s47 offen nt lds
 s_add_u32 m0, s72, 91136
 s_nop 0
 buffer_load_dwordx4 v13, s[12:15], s47 offen nt lds
 ds_read_b64_tr_b16 a[88:89], v16 offset:24576
 ds_read_b64_tr_b16 a[90:91], v16 offset:24832
 ds_read_b64_tr_b16 a[92:93], v16 offset:28672
 ds_read_b64_tr_b16 a[94:95], v16 offset:28928
 s_waitcnt vmcnt(15)
 s_waitcnt lgkmcnt(0)
 s_barrier
 s_add_u32 m0, s72, 98304
 s_add_u32 s47, s70, 4194304
 buffer_load_dwordx4 v12, s[16:19], s47 offen nt lds
 s_add_u32 m0, s72, 99328
 s_nop 0
 buffer_load_dwordx4 v13, s[16:19], s47 offen nt lds
 ds_read_b64_tr_b16 a[96:97], v16 offset:32768
 ds_read_b64_tr_b16 a[98:99], v16 offset:33024
 ds_read_b64_tr_b16 a[100:101], v16 offset:36864
 ds_read_b64_tr_b16 a[102:103], v16 offset:37120
 s_waitcnt vmcnt(15)
 s_waitcnt lgkmcnt(0)
 s_barrier
 s_add_u32 m0, s72, 106496
 s_add_u32 s47, s70, 4194432
 buffer_load_dwordx4 v12, s[16:19], s47 offen nt lds
 s_add_u32 m0, s72, 107520
 s_nop 0
 buffer_load_dwordx4 v13, s[16:19], s47 offen nt lds
 ds_read_b64_tr_b16 a[104:105], v16 offset:40960
 ds_read_b64_tr_b16 a[106:107], v16 offset:41216
 ds_read_b64_tr_b16 a[108:109], v16 offset:45056
 ds_read_b64_tr_b16 a[110:111], v16 offset:45312
 s_waitcnt vmcnt(15)
 s_waitcnt lgkmcnt(0)
 s_barrier
 s_add_u32 m0, s72, 114688
 s_add_u32 s47, s71, 0
 buffer_load_dwordx4 v14, s[24:27], s47 offen nt lds
 s_add_u32 m0, s72, 115712
 s_nop 0
 buffer_load_dwordx4 v15, s[24:27], s47 offen nt lds
 ds_read_b64_tr_b16 a[112:113], v16 offset:49152
 ds_read_b64_tr_b16 a[114:115], v16 offset:49408
 ds_read_b64_tr_b16 a[116:117], v16 offset:53248
 ds_read_b64_tr_b16 a[118:119], v16 offset:53504
 s_waitcnt vmcnt(15)
 s_waitcnt lgkmcnt(0)
 s_barrier
 s_add_u32 m0, s72, 122880
 s_add_u32 s47, s71, 128
 buffer_load_dwordx4 v14, s[24:27], s47 offen nt lds
 s_add_u32 m0, s72, 123904
 s_nop 0
 buffer_load_dwordx4 v15, s[24:27], s47 offen nt lds
 ds_read_b64_tr_b16 a[120:121], v16 offset:57344
 ds_read_b64_tr_b16 a[122:123], v16 offset:57600
 ds_read_b64_tr_b16 a[124:125], v16 offset:61440
 ds_read_b64_tr_b16 a[126:127], v16 offset:61696
 s_waitcnt vmcnt(14)
 s_waitcnt lgkmcnt(0)
 s_barrier
 s_add_u32 m0, s72, 131072
 s_add_u32 s47, s71, 256
 buffer_load_dwordx4 v14, s[24:27], s47 offen nt lds
 s_add_u32 m0, s72, 132096
 s_nop 0
 buffer_load_dwordx4 v15, s[24:27], s47 offen nt lds
 ds_read_b64_tr_b16 a[128:129], v17 offset:0
 ds_read_b64_tr_b16 a[130:131], v17 offset:256
 ds_read_b64_tr_b16 a[132:133], v17 offset:4096
 ds_read_b64_tr_b16 a[134:135], v17 offset:4352
 s_waitcnt vmcnt(14)
 s_waitcnt lgkmcnt(0)
 s_barrier
 s_add_u32 m0, s72, 139264
 s_add_u32 s47, s71, 384
 buffer_load_dwordx4 v14, s[24:27], s47 offen nt lds
 s_add_u32 m0, s72, 140288
 s_nop 0
 buffer_load_dwordx4 v15, s[24:27], s47 offen nt lds
 s_branch Lhsc_41
Lhs_40:
 buffer_load_dwordx4 v[68:71], v65, s[28:31], 0 offen sc1
 s_waitcnt vmcnt(0)
Lhsc_41:
 v_sad_u8 v69, v70, 0, 0
 v_sad_u8 v69, v71, 0, v69
 v_lshrrev_b32 v69, 5, v69
 v_min_u32 v68, v68, v69
 v_cmp_ne_u32 vcc, 0, v68
 s_cbranch_vccnz Lhsok_42
 s_sub_u32 s54, s54, 1
 s_cbranch_scc0 Lhs_40
 s_endpgm
Lhsok_42:
 v_readfirstlane_b32 s74, v70
 v_readfirstlane_b32 s75, v71
 buffer_load_dwordx4 v[20:23], v3, s[20:23], s39 offen offset:0 sc1
 buffer_load_dwordx4 v[20:23], v3, s[20:23], s39 offen offset:1024 sc1
 buffer_load_dwordx4 v[20:23], v3, s[20:23], s40 offen offset:0 sc1
 buffer_load_dwordx4 v[20:23], v3, s[20:23], s40 offen offset:1024 sc1
 v_lshlrev_b32 v67, 6, v0
 ds_read_b64_tr_b16 a[136:137], v17 offset:8192
 ds_read_b64_tr_b16 a[138:139], v17 offset:8448
 ds_read_b64_tr_b16 a[140:141], v17 offset:12288
 ds_read_b64_tr_b16 a[142:143], v17 offset:12544
 s_waitcnt vmcnt(18)
 s_waitcnt lgkmcnt(0)
 s_barrier
 s_add_u32 m0, s72, 147456
 s_add_u32 s47, s71, 512
 buffer_load_dwordx4 v14, s[24:27], s47 offen nt lds
 s_add_u32 m0, s72, 148480
 s_nop 0
 buffer_load_dwordx4 v15, s[24:27], s47 offen nt lds
 ds_read_b64_tr_b16 a[144:145], v17 offset:16384
 ds_read_b64_tr_b16 a[146:147], v17 offset:16640
 ds_read_b64_tr_b16 a[148:149], v17 offset:20480
 ds_read_b64_tr_b16 a[150:151], v17 offset:20736
 s_waitcnt vmcnt(18)
 s_waitcnt lgkmcnt(0)
 s_barrier
 s_add_u32 m0, s72, 155648
 s_add_u32 s47, s71, 640
 buffer_load_dwordx4 v14, s[24:27], s47 offen nt lds
 s_add_u32 m0, s72, 156672
 s_nop 0
 buffer_load_dwordx4 v15, s[24:27], s47 offen nt lds
 ds_read_b64_tr_b16 a[152:153], v17 offset:24576
 ds_read_b64_tr_b16 a[154:155], v17 offset:24832
 ds_read_b64_tr_b16 a[156:157], v17 offset:28672
 ds_read_b64_tr_b16 a[158:159], v17 offset:28928
 s_waitcnt vmcnt(18)
 s_waitcnt lgkmcnt(0)
 s_barrier
 s_add_u32 m0, s72, 24576
 s_add_u32 s47, s71, 768
 buffer_load_dwordx4 v14, s[24:27], s47 offen nt lds
 s_add_u32 m0, s72, 25600
 s_nop 0
 buffer_load_dwordx4 v15, s[24:27], s47 offen nt lds
 ds_read_b64_tr_b16 a[160:161], v17 offset:32768
 ds_read_b64_tr_b16 a[162:163], v17 offset:33024
 ds_read_b64_tr_b16 a[164:165], v17 offset:36864
 ds_read_b64_tr_b16 a[166:167], v17 offset:37120
 s_waitcnt vmcnt(18)
 s_waitcnt lgkmcnt(0)
 s_barrier
 s_add_u32 m0, s72, 32768
 s_add_u32 s47, s71, 896
 buffer_load_dwordx4 v14, s[24:27], s47 offen nt lds
 s_add_u32 m0, s72, 33792
 s_nop 0
 buffer_load_dwordx4 v15, s[24:27], s47 offen nt lds
 ds_read_b64_tr_b16 a[168:169], v17 offset:40960
 ds_read_b64_tr_b16 a[170:171], v17 offset:41216
 ds_read_b64_tr_b16 a[172:173], v17 offset:45056
 ds_read_b64_tr_b16 a[174:175], v17 offset:45312
 s_waitcnt vmcnt(18)
 s_waitcnt lgkmcnt(0)
 s_barrier
 s_add_u32 m0, s72, 40960
 s_add_u32 s47, s71, 37760
 buffer_load_dwordx4 v14, s[24:27], s47 offen nt lds
 s_add_u32 m0, s72, 41984
 s_nop 0
 buffer_load_dwordx4 v15, s[24:27], s47 offen nt lds
 ds_read_b64_tr_b16 a[176:177], v17 offset:49152
 ds_read_b64_tr_b16 a[178:179], v17 offset:49408
 ds_read_b64_tr_b16 a[180:181], v17 offset:53248
 ds_read_b64_tr_b16 a[182:183], v17 offset:53504
 s_waitcnt vmcnt(18)
 s_waitcnt lgkmcnt(0)
 s_barrier
 s_add_u32 m0, s72, 49152
 s_add_u32 s47, s71, 1024
 buffer_load_dwordx4 v14, s[24:27], s47 offen nt lds
 s_add_u32 m0, s72, 50176
 s_nop 0
 buffer_load_dwordx4 v15, s[24:27], s47 offen nt lds
 ds_read_b64_tr_b16 a[184:185], v17 offset:57344
 ds_read_b64_tr_b16 a[186:187], v17 offset:57600
 ds_read_b64_tr_b16 a[188:189], v17 offset:61440
 ds_read_b64_tr_b16 a[190:191], v17 offset:61696
 s_waitcnt vmcnt(18)
 s_waitcnt lgkmcnt(0)
 s_barrier
 s_add_u32 m0, s72, 57344
 s_add_u32 s47, s70, 2097280
 buffer_load_dwordx4 v56, s[12:15], s47 offen nt lds
 s_add_u32 m0, s72, 58368
 s_nop 0
 buffer_load_dwordx4 v57, s[12:15], s47 offen nt lds
 ds_read_b64_tr_b16 a[192:193], v18 offset:0
 ds_read_b64_tr_b16 a[194:195], v18 offset:256
 ds_read_b64_tr_b16 a[196:197], v18 offset:4096
 ds_read_b64_tr_b16 a[198:199], v18 offset:4352
 s_waitcnt vmcnt(18)
 s_waitcnt lgkmcnt(0)
 s_barrier
 s_add_u32 m0, s72, 65536
 s_add_u32 s47, s70, 2359424
 buffer_load_dwordx4 v56, s[12:15], s47 offen nt lds
 s_add_u32 m0, s72, 66560
 s_nop 0
 buffer_load_dwordx4 v57, s[12:15], s47 offen nt lds
 s_lshl_b32 s47, s6, 2
 s_add_u32 s47, s47, 0x4000
 v_mov_b32 v64, 1
 buffer_store_dword v64, v66, s[20:23], s47 offen
 ds_read_b64_tr_b16 a[200:201], v18 offset:8192
 ds_read_b64_tr_b16 a[202:203], v18 offset:8448
 ds_read_b64_tr_b16 a[204:205], v18 offset:12288
 ds_read_b64_tr_b16 a[206:207], v18 offset:12544
 s_waitcnt vmcnt(15)
 s_waitcnt lgkmcnt(0)
 s_barrier
 s_add_u32 m0, s72, 73728
 s_add_u32 s47, s70, 3145856
 buffer_load_dwordx4 v56, s[12:15], s47 offen nt lds
 s_add_u32 m0, s72, 74752
 s_nop 0
 buffer_load_dwordx4 v57, s[12:15], s47 offen nt lds
 ds_read_b64_tr_b16 a[208:209], v18 offset:16384
 ds_read_b64_tr_b16 a[210:211], v18 offset:16640
 ds_read_b64_tr_b16 a[212:213], v18 offset:20480
 ds_read_b64_tr_b16 a[214:215], v18 offset:20736
 s_waitcnt vmcnt(15)
 s_waitcnt lgkmcnt(0)
 s_barrier
 s_add_u32 m0, s72, 81920
 s_add_u32 s47, s70, 3408000
 buffer_load_dwordx4 v56, s[12:15], s47 offen nt lds
 s_add_u32 m0, s72, 82944
 s_nop 0
 buffer_load_dwordx4 v57, s[12:15], s47 offen nt lds
 ds_read_b64_tr_b16 a[216:217], v18 offset:24576
 ds_read_b64_tr_b16 a[218:219], v18 offset:24832
 ds_read_b64_tr_b16 a[220:221], v18 offset:28672
 ds_read_b64_tr_b16 a[222:223], v18 offset:28928
 s_waitcnt vmcnt(15)
 s_waitcnt lgkmcnt(0)
 s_barrier
 s_add_u32 m0, s72, 90112
 s_add_u32 s47, s70, 4194432
 buffer_load_dwordx4 v12, s[12:15], s47 offen nt lds
 s_add_u32 m0, s72, 91136
 s_nop 0
 buffer_load_dwordx4 v13, s[12:15], s47 offen nt lds
 ds_read_b64_tr_b16 a[224:225], v16 offset:24576
 ds_read_b64_tr_b16 a[226:227], v16 offset:24832
 ds_read_b64_tr_b16 a[228:229], v16 offset:28672
 ds_read_b64_tr_b16 a[230:231], v16 offset:28928
 s_waitcnt vmcnt(15)
 s_waitcnt lgkmcnt(0)
 s_barrier
 s_add_u32 m0, s72, 98304
 s_add_u32 s47, s71, 37888
 buffer_load_dwordx4 v14, s[24:27], s47 offen nt lds
 s_add_u32 m0, s72, 99328
 s_nop 0
 buffer_load_dwordx4 v15, s[24:27], s47 offen nt lds
 ds_read_b64_tr_b16 a[232:233], v16 offset:32768
 ds_read_b64_tr_b16 a[234:235], v16 offset:33024
 ds_read_b64_tr_b16 a[236:237], v16 offset:36864
 ds_read_b64_tr_b16 a[238:239], v16 offset:37120
 s_waitcnt vmcnt(15)
 s_waitcnt lgkmcnt(0)
 s_barrier
 s_add_u32 m0, s72, 106496
 s_add_u32 s47, s71, 36864
 buffer_load_dwordx4 v14, s[24:27], s47 offen nt lds
 s_add_u32 m0, s72, 107520
 s_nop 0
 buffer_load_dwordx4 v15, s[24:27], s47 offen nt lds
 ds_read_b64_tr_b16 a[240:241], v16 offset:40960
 ds_read_b64_tr_b16 a[242:243], v16 offset:41216
 ds_read_b64_tr_b16 a[244:245], v16 offset:45056
 ds_read_b64_tr_b16 a[246:247], v16 offset:45312
 s_waitcnt vmcnt(15)
 s_waitcnt lgkmcnt(0)
 s_barrier
 s_add_u32 m0, s72, 114688
 s_add_u32 s47, s71, 36992
 buffer_load_dwordx4 v14, s[24:27], s47 offen nt lds
 s_add_u32 m0, s72, 115712
 s_nop 0
 buffer_load_dwordx4 v15, s[24:27], s47 offen nt lds
 ds_read_b64_tr_b16 a[248:249], v16 offset:49152
 ds_read_b64_tr_b16 a[250:251], v16 offset:49408
 ds_read_b64_tr_b16 a[252:253], v16 offset:53248
 ds_read_b64_tr_b16 a[254:255], v16 offset:53504
 s_waitcnt vmcnt(15)
 s_waitcnt lgkmcnt(0)
 s_barrier
 s_add_u32 m0, s72, 122880
 s_add_u32 s47, s71, 37120
 buffer_load_dwordx4 v14, s[24:27], s47 offen nt lds
 s_add_u32 m0, s72, 123904
 s_nop 0
 buffer_load_dwordx4 v15, s[24:27], s47 offen nt lds
 v_lshrrev_b32 v68, 2, v3
 s_mov_b32 s47, 0x4000
 buffer_load_dword v68, v68, s[20:23], s47 offen sc1
 ds_read_b64_tr_b16 v[48:49], v16 offset:57344
 ds_read_b64_tr_b16 v[50:51], v16 offset:57600
 ds_read_b64_tr_b16 v[52:53], v16 offset:61440
 ds_read_b64_tr_b16 v[54:55], v16 offset:61696
 s_waitcnt vmcnt(16)
 s_waitcnt lgkmcnt(0)
 s_barrier
 s_add_u32 m0, s72, 131072
 s_add_u32 s47, s71, 37248
 buffer_load_dwordx4 v14, s[24:27], s47 offen nt lds
 s_add_u32 m0, s72, 132096
 s_nop 0
 buffer_load_dwordx4 v15, s[24:27], s47 offen nt lds
 ds_write_b128 v60, v[48:51] offset:57344
 ds_write_b128 v60, v[52:55] offset:61440
 ds_read_b64_tr_b16 v[40:41], v17 offset:0
 ds_read_b64_tr_b16 v[42:43], v17 offset:256
 ds_read_b64_tr_b16 v[44:45], v17 offset:4096
 ds_read_b64_tr_b16 v[46:47], v17 offset:4352
 s_waitcnt vmcnt(15)
 s_waitcnt lgkmcnt(0)
 s_barrier
 s_add_u32 m0, s72, 139264
 s_add_u32 s47, s71, 37376
 buffer_load_dwordx4 v14, s[24:27], s47 offen nt lds
 s_add_u32 m0, s72, 140288
 s_nop 0
 buffer_load_dwordx4 v15, s[24:27], s47 offen nt lds
 ds_write_b128 v61, v[40:43] offset:0
 ds_write_b128 v61, v[44:47] offset:4096
 ds_read_b64_tr_b16 v[48:49], v17 offset:8192
 ds_read_b64_tr_b16 v[50:51], v17 offset:8448
 ds_read_b64_tr_b16 v[52:53], v17 offset:12288
 ds_read_b64_tr_b16 v[54:55], v17 offset:12544
 s_waitcnt vmcnt(15)
 s_waitcnt lgkmcnt(0)
 s_barrier
 s_add_u32 m0, s72, 147456
 s_add_u32 s47, s71, 37504
 buffer_load_dwordx4 v14, s[24:27], s47 offen nt lds
 s_add_u32 m0, s72, 148480
 s_nop 0
 buffer_load_dwordx4 v15, s[24:27], s47 offen nt lds
 ds_write_b128 v61, v[48:51] offset:8192
 ds_write_b128 v61, v[52:55] offset:12288
 ds_read_b64_tr_b16 v[40:41], v17 offset:16384
 ds_read_b64_tr_b16 v[42:43], v17 offset:16640
 ds_read_b64_tr_b16 v[44:45], v17 offset:20480
 ds_read_b64_tr_b16 v[46:47], v17 offset:20736
 s_waitcnt vmcnt(15)
 s_waitcnt lgkmcnt(0)
 s_barrier
 s_add_u32 m0, s72, 155648
 s_add_u32 s47, s71, 37632
 buffer_load_dwordx4 v14, s[24:27], s47 offen nt lds
 s_add_u32 m0, s72, 156672
 s_nop 0
 buffer_load_dwordx4 v15, s[24:27], s47 offen nt lds
 ds_write_b128 v61, v[40:43] offset:16384
 ds_write_b128 v61, v[44:47] offset:20480
 ds_read_b64_tr_b16 v[48:49], v17 offset:24576
 ds_read_b64_tr_b16 v[50:51], v17 offset:24832
 ds_read_b64_tr_b16 v[52:53], v17 offset:28672
 ds_read_b64_tr_b16 v[54:55], v17 offset:28928
 s_waitcnt vmcnt(15)
 s_waitcnt lgkmcnt(0)
 s_barrier
 s_add_u32 m0, s72, 24576
 s_add_u32 s47, s70, 128
 buffer_load_dwordx4 v56, s[12:15], s47 offen nt lds
 s_add_u32 m0, s72, 25600
 s_nop 0
 buffer_load_dwordx4 v57, s[12:15], s47 offen nt lds
 ds_write_b128 v61, v[48:51] offset:24576
 ds_write_b128 v61, v[52:55] offset:28672
 ds_read_b64_tr_b16 v[40:41], v17 offset:32768
 ds_read_b64_tr_b16 v[42:43], v17 offset:33024
 ds_read_b64_tr_b16 v[44:45], v17 offset:36864
 ds_read_b64_tr_b16 v[46:47], v17 offset:37120
 s_waitcnt vmcnt(15)
 s_waitcnt lgkmcnt(0)
 s_barrier
 s_add_u32 m0, s72, 32768
 s_add_u32 s47, s70, 262272
 buffer_load_dwordx4 v56, s[12:15], s47 offen nt lds
 s_add_u32 m0, s72, 33792
 s_nop 0
 buffer_load_dwordx4 v57, s[12:15], s47 offen nt lds
 ds_write_b128 v61, v[40:43] offset:32768
 ds_write_b128 v61, v[44:47] offset:36864
 ds_read_b64_tr_b16 v[48:49], v17 offset:40960
 ds_read_b64_tr_b16 v[50:51], v17 offset:41216
 ds_read_b64_tr_b16 v[52:53], v17 offset:45056
 ds_read_b64_tr_b16 v[54:55], v17 offset:45312
 s_waitcnt vmcnt(15)
 s_waitcnt lgkmcnt(0)
 s_barrier
 s_add_u32 m0, s72, 40960
 s_add_u32 s47, s70, 1048704
 buffer_load_dwordx4 v56, s[12:15], s47 offen nt lds
 s_add_u32 m0, s72, 41984
 s_nop 0
 buffer_load_dwordx4 v57, s[12:15], s47 offen nt lds
 ds_write_b128 v61, v[48:51] offset:40960
 ds_write_b128 v61, v[52:55] offset:45056
 ds_read_b64_tr_b16 v[40:41], v17 offset:49152
 ds_read_b64_tr_b16 v[42:43], v17 offset:49408
 ds_read_b64_tr_b16 v[44:45], v17 offset:53248
 ds_read_b64_tr_b16 v[46:47], v17 offset:53504
 s_waitcnt vmcnt(15)
 s_waitcnt lgkmcnt(0)
 s_barrier
 s_add_u32 m0, s72, 49152
 s_add_u32 s47, s70, 1310848
 buffer_load_dwordx4 v56, s[12:15], s47 offen nt lds
 s_add_u32 m0, s72, 50176
 s_nop 0
 buffer_load_dwordx4 v57, s[12:15], s47 offen nt lds
 buffer_load_dword v1, v65, s[20:23], s56 offen sc1
 ds_write_b128 v61, v[40:43] offset:49152
 ds_write_b128 v61, v[44:47] offset:53248
 ds_read_b64_tr_b16 v[48:49], v17 offset:57344
 ds_read_b64_tr_b16 v[50:51], v17 offset:57600
 ds_read_b64_tr_b16 v[52:53], v17 offset:61440
 ds_read_b64_tr_b16 v[54:55], v17 offset:61696
 s_waitcnt vmcnt(15)
 s_waitcnt lgkmcnt(0)
 s_barrier
 v_cmp_ne_u32 vcc, 0, v68
 s_mov_b32 s77, vcc_lo
 s_and_b32 s47, s6, 29
 s_cbranch_scc1 Lgt_43
 buffer_store_dword v64, v66, s[28:31], 0 offen offset:128 sc1
Lgt_43:
 s_add_u32 s58, s6, 1
 s_and_b32 s58, s58, 31
 s_bitcmp1_b32 s77, s58
 s_cbranch_scc1 Lhlp_44
 s_lshl_b32 s76, s58, 8
 s_mul_i32 s80, s58, 147456
 s_add_u32 s47, s76, 3145856
 buffer_load_dword v63, v19, s[12:15], s47 offen
 s_add_u32 s47, s80, 37888
 buffer_load_dword v63, v59, s[24:27], s47 offen
 s_add_u32 s47, s80, 37120
 buffer_load_dword v63, v59, s[24:27], s47 offen
 s_add_u32 s47, s80, 37504
 buffer_load_dword v63, v59, s[24:27], s47 offen
 s_add_u32 s47, s76, 262272
 buffer_load_dword v63, v19, s[12:15], s47 offen
Lhlp_44:
 s_add_u32 s58, s6, 2
 s_and_b32 s58, s58, 31
 s_bitcmp1_b32 s77, s58
 s_cbranch_scc1 Lhlp_45
 s_lshl_b32 s76, s58, 8
 s_mul_i32 s80, s58, 147456
 s_add_u32 s47, s76, 3408000
 buffer_load_dword v63, v19, s[12:15], s47 offen
 s_add_u32 s47, s80, 36864
 buffer_load_dword v63, v59, s[24:27], s47 offen
 s_add_u32 s47, s80, 37248
 buffer_load_dword v63, v59, s[24:27], s47 offen
 s_add_u32 s47, s80, 37632
 buffer_load_dword v63, v59, s[24:27], s47 offen
 s_add_u32 s47, s76, 1048704
 buffer_load_dword v63, v19, s[12:15], s47 offen
Lhlp_45:
 s_add_u32 s58, s6, 3
 s_and_b32 s58, s58, 31
 s_bitcmp1_b32 s77, s58
 s_cbranch_scc1 Lhlp_46
 s_lshl_b32 s76, s58, 8
 s_mul_i32 s80, s58, 147456
 s_add_u32 s47, s76, 4194432
 buffer_load_dword v63, v58, s[12:15], s47 offen
 s_add_u32 s47, s80, 36992
 buffer_load_dword v63, v59, s[24:27], s47 offen
 s_add_u32 s47, s80, 37376
 buffer_load_dword v63, v59, s[24:27], s47 offen
 s_add_u32 s47, s76, 128
 buffer_load_dword v63, v19, s[12:15], s47 offen
 s_add_u32 s47, s76, 1310848
 buffer_load_dword v63, v19, s[12:15], s47 offen
Lhlp_46:
 ds_write_b128 v61, v[48:51] offset:57344
 ds_write_b128 v61, v[52:55] offset:61440
 ds_read_b64_tr_b16 v[40:41], v18 offset:0
 ds_read_b64_tr_b16 v[42:43], v18 offset:256
 ds_read_b64_tr_b16 v[44:45], v18 offset:4096
 ds_read_b64_tr_b16 v[46:47], v18 offset:4352
 s_waitcnt vmcnt(13)
 s_waitcnt lgkmcnt(0)
 s_barrier
 ds_write_b128 v62, v[40:43] offset:0
 ds_write_b128 v62, v[44:47] offset:4096
 ds_read_b64_tr_b16 v[48:49], v18 offset:8192
 ds_read_b64_tr_b16 v[50:51], v18 offset:8448
 ds_read_b64_tr_b16 v[52:53], v18 offset:12288
 ds_read_b64_tr_b16 v[54:55], v18 offset:12544
 s_waitcnt vmcnt(11)
 s_waitcnt lgkmcnt(0)
 s_barrier
 ds_write_b128 v62, v[48:51] offset:8192
 ds_write_b128 v62, v[52:55] offset:12288
 ds_read_b64_tr_b16 v[40:41], v18 offset:16384
 ds_read_b64_tr_b16 v[42:43], v18 offset:16640
 ds_read_b64_tr_b16 v[44:45], v18 offset:20480
 ds_read_b64_tr_b16 v[46:47], v18 offset:20736
 s_waitcnt vmcnt(9)
 s_waitcnt lgkmcnt(0)
 s_barrier
 ds_write_b128 v62, v[40:43] offset:16384
 ds_write_b128 v62, v[44:47] offset:20480
 ds_read_b64_tr_b16 v[48:49], v18 offset:24576
 ds_read_b64_tr_b16 v[50:51], v18 offset:24832
 ds_read_b64_tr_b16 v[52:53], v18 offset:28672
 ds_read_b64_tr_b16 v[54:55], v18 offset:28928
 s_waitcnt vmcnt(7)
 s_waitcnt lgkmcnt(0)
 s_barrier
 ds_write_b128 v62, v[48:51] offset:24576
 ds_write_b128 v62, v[52:55] offset:28672
 ds_read_b64_tr_b16 v[40:41], v16 offset:24576
 ds_read_b64_tr_b16 v[42:43], v16 offset:24832
 ds_read_b64_tr_b16 v[44:45], v16 offset:28672
 ds_read_b64_tr_b16 v[46:47], v16 offset:28928
 s_waitcnt vmcnt(5)
 s_waitcnt lgkmcnt(0)
 s_barrier
 ds_write_b128 v60, v[40:43] offset:24576
 ds_write_b128 v60, v[44:47] offset:28672
 ds_read_b64_tr_b16 v[48:49], v16 offset:32768
 ds_read_b64_tr_b16 v[50:51], v16 offset:33024
 ds_read_b64_tr_b16 v[52:53], v16 offset:36864
 ds_read_b64_tr_b16 v[54:55], v16 offset:37120
 s_waitcnt vmcnt(3)
 s_waitcnt lgkmcnt(0)
 s_barrier
 ds_write_b128 v60, v[48:51] offset:32768
 ds_write_b128 v60, v[52:55] offset:36864
 ds_read_b64_tr_b16 v[40:41], v16 offset:40960
 ds_read_b64_tr_b16 v[42:43], v16 offset:41216
 ds_read_b64_tr_b16 v[44:45], v16 offset:45056
 ds_read_b64_tr_b16 v[46:47], v16 offset:45312
 s_waitcnt vmcnt(1)
 s_waitcnt lgkmcnt(0)
 s_barrier
 ds_write_b128 v60, v[40:43] offset:40960
 ds_write_b128 v60, v[44:47] offset:45056
 ds_read_b64_tr_b16 v[48:49], v16 offset:49152
 ds_read_b64_tr_b16 v[50:51], v16 offset:49408
 ds_read_b64_tr_b16 v[52:53], v16 offset:53248
 ds_read_b64_tr_b16 v[54:55], v16 offset:53504
 s_waitcnt lgkmcnt(0)
 s_barrier
 ds_write_b128 v60, v[48:51] offset:49152
 ds_write_b128 v60, v[52:55] offset:53248
 v_lshlrev_b32 v0, 4, v0
 s_waitcnt vmcnt(0)
 v_cmp_le_u32 vcc, 2, v1
 s_cbranch_vccnz Lpbk_47
Lpb0_48:
 buffer_load_dword v1, v7, s[20:23], s56 offen sc1
 s_waitcnt vmcnt(0)
 v_cmp_le_u32 vcc, 2, v1
 s_cbranch_vccnz Lpb0ok_49
 s_sub_u32 s54, s54, 1
 s_cbranch_scc0 Lpb0_48
 s_endpgm
Lpb0ok_49:
Lpbk_47:
 s_lshl_b32 s47, s4, 11
 s_add_u32 m0, s47, 9216
 s_add_u32 s68, s37, 0x80000
 buffer_load_dwordx4 v3, s[20:23], s67 offen offset:0 sc1 lds
 buffer_load_dwordx4 v3, s[20:23], s67 offen offset:1024 sc1 lds
 buffer_load_dword v68, v67, s[20:23], s37 offen sc1
 buffer_load_dword v68, v67, s[20:23], s68 offen sc1
 s_add_u32 s68, s68, 0x80000
 s_mov_b32 s24, 0xf000f
 s_mov_b32 s25, 0xf000f
 s_mov_b32 s26, 0xf000f0
 s_mov_b32 s27, 0xf000f0
 s_mov_b32 s28, 0xf000f00
 s_mov_b32 s29, 0xf000f00
 s_mov_b32 s30, 0xf000f000
 s_mov_b32 s31, 0xf000f000
 s_mov_b32 s32, 0xaaaaaaaa
 s_mov_b32 s33, 0xaaaaaaaa
 s_mov_b32 s34, 0x3f803f80
 s_mov_b32 s35, 0x3f803f80
 s_mov_b32 s70, -1
 s_mov_b32 s71, 0
 s_lshl_b32 s47, s4, 12
 s_add_u32 s68, s68, s47
 v_mov_b32 v2, 0
 v_mov_b32 v4, 0
 s_waitcnt lgkmcnt(0)
 ds_read_b128 v[20:23], v0 offset:24576
 ds_read_b128 v[24:27], v0 offset:28672
 ds_read_b128 v[28:31], v0 offset:32768
 ds_read_b128 v[32:35], v0 offset:36864
 v_mov_b64 v[36:37], 0
 v_mov_b64 v[38:39], 0
 v_mov_b64 v[40:41], 0
 v_mov_b64 v[42:43], 0
 v_mov_b64 v[44:45], 0
 v_mov_b64 v[46:47], 0
 v_mov_b64 v[48:49], 0
 v_mov_b64 v[50:51], 0
 v_lshl_add_u32 v1, v3, 3, s68
 v_mov_b32 v6, s56
 v_cndmask_b32 v1, v6, v1, s[70:71]
 s_xor_b32 s44, s44, 0x80000
 s_xor_b32 s45, s45, 0x80000
 s_xor_b32 s65, s65, 0x80000
 s_xor_b32 s66, s66, 0x80000
 s_xor_b32 s41, s41, 0x80000
 s_xor_b32 s43, s43, 0x80000
 s_lshr_b64 s[74:75], s[74:75], s73
 s_and_b32 s74, s74, 0xff
 s_cmp_eq_u32 s74, 32
 s_waitcnt vmcnt(2)
 s_cbranch_scc0 Lslow_50
 .p2align 3
Lstep_52:
 s_mov_b64 exec, -1
 s_waitcnt lgkmcnt(0)
 s_barrier
 ds_read_b128 v[52:55], v3 offset:0
 ds_read_b128 v[56:59], v3 offset:1024
 ds_read_b128 v[60:63], v3 offset:2048
 buffer_load_dwordx4 v[12:15], v3, s[20:23], s59 offen offset:0 sc1
 s_waitcnt lgkmcnt(2)
 v_smfmac_f32_16x16x64_bf16 v[36:39], v[52:55], v[72:79], v5
 v_smfmac_f32_16x16x64_bf16 v[40:43], v[52:55], v[80:87], v5
 buffer_load_dwordx4 v[16:19], v3, s[20:23], s59 offen offset:1024 sc1
 v_smfmac_f32_16x16x64_bf16 v[44:47], v[52:55], v[88:95], v5
 s_waitcnt lgkmcnt(1)
 v_smfmac_f32_16x16x64_bf16 v[48:51], v[52:55], v[20:27], v5
 v_smfmac_f32_16x16x64_bf16 v[36:39], v[56:59], v[112:119], v5
 ds_read_b128 v[20:23], v0 offset:40960
 v_smfmac_f32_16x16x64_bf16 v[40:43], v[56:59], v[120:127], v5
 ds_read_b128 v[24:27], v0 offset:45056
 v_smfmac_f32_16x16x64_bf16 v[44:47], v[56:59], v[128:135], v5
 ds_read_b128 v[52:55], v3 offset:3072
 s_waitcnt lgkmcnt(3)
 v_smfmac_f32_16x16x64_bf16 v[48:51], v[56:59], v[28:35], v5
 buffer_load_dword v1, v1, s[20:23], 0 offen sc1
 v_smfmac_f32_16x16x64_bf16 v[36:39], v[60:63], v[152:159], v5
 ds_read_b128 v[28:31], v0 offset:49152
 s_max_u32 s47, s36, 1
 v_smfmac_f32_16x16x64_bf16 v[40:43], v[60:63], v[160:167], v5
 ds_read_b128 v[32:35], v0 offset:53248
 s_sub_u32 s47, s47, 1
 v_smfmac_f32_16x16x64_bf16 v[44:47], v[60:63], v[168:175], v5
 ds_read_b128 v[56:59], v3 offset:4096
 s_waitcnt lgkmcnt(3)
 v_smfmac_f32_16x16x64_bf16 v[48:51], v[60:63], v[20:27], v5
 v_smfmac_f32_16x16x64_bf16 v[36:39], v[52:55], v[192:199], v5
 ds_read_b128 v[20:23], v0 offset:57344
 v_min_u32 v6, 16, v0
 v_smfmac_f32_16x16x64_bf16 v[40:43], v[52:55], v[200:207], v5
 ds_read_b128 v[24:27], v0 offset:61440
 v_lshlrev_b32 v6, 24, v6
 v_smfmac_f32_16x16x64_bf16 v[44:47], v[52:55], v[208:215], v5
 ds_read_b128 v[60:63], v3 offset:5120
 s_waitcnt lgkmcnt(3)
 v_add_u32 v0, 0x10000, v0
 v_smfmac_f32_16x16x64_bf16 v[48:51], v[52:55], v[28:35], v5
 buffer_store_dwordx4 v[64:67], v0, s[20:23], s38 offen sc1
 v_smfmac_f32_16x16x64_bf16 v[36:39], v[56:59], v[232:239], v5
 ds_read_b128 v[28:31], v0 offset:0
 v_smfmac_f32_16x16x64_bf16 v[40:43], v[56:59], v[240:247], v5
 ds_read_b128 v[32:35], v0 offset:4096
 v_smfmac_f32_16x16x64_bf16 v[44:47], v[56:59], v[248:255], v5
 ds_read_b128 v[52:55], v3 offset:6144
 s_waitcnt lgkmcnt(3)
 v_smfmac_f32_16x16x64_bf16 v[48:51], v[56:59], v[20:27], v5
 v_smfmac_f32_16x16x64_bf16 v[36:39], v[60:63], a[16:23], v5
 ds_read_b128 v[20:23], v0 offset:8192
 v_mov_b32 v64, s47
 v_smfmac_f32_16x16x64_bf16 v[40:43], v[60:63], a[24:31], v5
 ds_read_b128 v[24:27], v0 offset:12288
 v_smfmac_f32_16x16x64_bf16 v[44:47], v[60:63], a[32:39], v5
 ds_read_b128 v[56:59], v3 offset:7168
 s_waitcnt lgkmcnt(3)
 v_smfmac_f32_16x16x64_bf16 v[48:51], v[60:63], v[28:35], v5
 buffer_store_dword v64, v6, s[20:23], s57 offen sc1
 v_smfmac_f32_16x16x64_bf16 v[36:39], v[52:55], a[56:63], v5
 ds_read_b128 v[28:31], v0 offset:16384
 v_smfmac_f32_16x16x64_bf16 v[40:43], v[52:55], a[64:71], v5
 ds_read_b128 v[32:35], v0 offset:20480
 v_smfmac_f32_16x16x64_bf16 v[44:47], v[52:55], a[72:79], v5
 ds_read_b128 v[60:63], v3 offset:8192
 s_waitcnt lgkmcnt(3)
 v_smfmac_f32_16x16x64_bf16 v[48:51], v[52:55], v[20:27], v5
 s_waitcnt vmcnt(5)
 v_smfmac_f32_16x16x64_bf16 v[36:39], v[56:59], a[96:103], v5
 ds_read_b128 v[20:23], v0 offset:24576
 v_mov_b64 v[64:65], 0
 v_smfmac_f32_16x16x64_bf16 v[40:43], v[56:59], a[104:111], v5
 ds_read_b128 v[24:27], v0 offset:28672
 v_mov_b64 v[66:67], 0
 v_smfmac_f32_16x16x64_bf16 v[44:47], v[56:59], a[112:119], v5
 ds_read_b128 v[52:55], v3 offset:0
 s_waitcnt lgkmcnt(3)
 v_mov_b64 v[68:69], 0
 v_smfmac_f32_16x16x64_bf16 v[48:51], v[56:59], v[28:35], v5
 v_mov_b64 v[70:71], 0
 v_smfmac_f32_16x16x64_bf16 v[36:39], v[60:63], a[136:143], v5
 ds_read_b128 v[32:35], v3 offset:11264
 v_mov_b64 v[28:29], 0
 v_smfmac_f32_16x16x64_bf16 v[40:43], v[60:63], a[144:151], v5
 v_mov_b64 v[30:31], 0
 v_smfmac_f32_16x16x64_bf16 v[44:47], v[60:63], a[152:159], v5
 ds_read_b128 v[56:59], v3 offset:1024
 s_waitcnt lgkmcnt(2)
 v_add_f32 v36, v36, v38
 v_smfmac_f32_16x16x64_bf16 v[48:51], v[60:63], v[20:27], v5
 ds_read_b128 v[60:63], v3 offset:2048
 ds_read_b128 v[20:23], v3 offset:9216
 v_add_f32 v37, v37, v39
 v_cvt_pk_bf16_f32 v36, v36, v37
 v_smfmac_f32_16x16x64_bf16 v[64:67], v[52:55], v[96:103], v5
 ds_write_b16 v10, v36 offset:17408
 ds_write_b16_d16_hi v10, v36 offset:17472
 v_add_f32 v40, v40, v42
 v_add_f32 v41, v41, v43
 v_cvt_pk_bf16_f32 v40, v40, v41
 v_smfmac_f32_16x16x64_bf16 v[68:71], v[52:55], v[104:111], v5
 ds_write_b16 v10, v40 offset:17412
 ds_write_b16_d16_hi v10, v40 offset:17476
 v_add_f32 v44, v44, v46
 v_add_f32 v45, v45, v47
 v_add_f32 v48, v48, v50
 v_add_f32 v49, v49, v51
 v_cvt_pk_bf16_f32 v44, v44, v45
 v_cvt_pk_bf16_f32 v45, v48, v49
 ds_write_b64 v8, v[44:45] offset:19456
 s_waitcnt lgkmcnt(7)
 v_smfmac_f32_16x16x64_bf16 v[64:67], v[56:59], v[136:143], v5
 ds_read_b128 v[52:55], v3 offset:3072
 ds_read_b128 v[24:27], v3 offset:10240
 v_smfmac_f32_16x16x64_bf16 v[68:71], v[56:59], v[144:151], v5
 ds_read_b128 v[56:59], v3 offset:4096
 s_waitcnt lgkmcnt(9)
 v_smfmac_f32_16x16x64_bf16 v[64:67], v[60:63], v[176:183], v5
 v_smfmac_f32_16x16x64_bf16 v[68:71], v[60:63], v[184:191], v5
 s_waitcnt lgkmcnt(3)
 s_barrier
 ds_read_b128 v[36:39], v11 offset:17408
 ds_read_b128 v[40:43], v11 offset:17920
 s_waitcnt lgkmcnt(4)
 v_smfmac_f32_16x16x64_bf16 v[64:67], v[52:55], v[216:223], v5
 ds_read_b64_tr_b16 v[60:61], v9 offset:19456
 ds_read_b64_tr_b16 v[62:63], v9 offset:19488
 v_smfmac_f32_16x16x64_bf16 v[68:71], v[52:55], v[224:231], v5
 ds_read_b128 v[52:55], v3 offset:5120
 ds_read_b128 v[44:47], v11 offset:18432
 s_waitcnt lgkmcnt(6)
 v_smfmac_f32_16x16x64_bf16 v[64:67], v[56:59], a[0:7], v5
 ds_read_b128 v[48:51], v11 offset:18944
 v_smfmac_f32_16x16x64_bf16 v[68:71], v[56:59], a[8:15], v5
 ds_read_b128 v[56:59], v3 offset:6144
 s_waitcnt lgkmcnt(7)
 v_mfma_f32_16x16x32_bf16 v[20:23], v[20:23], v[36:39], 0
 v_mfma_f32_16x16x32_bf16 v[24:27], v[24:27], v[36:39], 0
 s_waitcnt lgkmcnt(6)
 v_mfma_f32_16x16x32_bf16 v[20:23], v[32:35], v[40:43], v[20:23]
 ds_read_b128 v[32:35], v3 offset:12288
 s_waitcnt lgkmcnt(5)
 v_smfmac_f32_16x16x64_bf16 v[28:31], v[60:63], v[36:43], v5
 ds_read_b64_tr_b16 v[60:61], v9 offset:20544
 ds_read_b64_tr_b16 v[62:63], v9 offset:20576
 ds_read_b128 v[36:39], v3 offset:13312
 s_waitcnt lgkmcnt(7)
 v_smfmac_f32_16x16x64_bf16 v[64:67], v[52:55], a[40:47], v5
 v_smfmac_f32_16x16x64_bf16 v[68:71], v[52:55], a[48:55], v5
 ds_read_b128 v[52:55], v3 offset:7168
 s_waitcnt lgkmcnt(4)
 v_mfma_f32_16x16x32_bf16 v[24:27], v[32:35], v[40:43], v[24:27]
 ds_read_b128 v[40:43], v3 offset:14336
 ds_read_b128 v[32:35], v3 offset:15360
 s_waitcnt lgkmcnt(4)
 v_smfmac_f32_16x16x64_bf16 v[28:31], v[60:63], v[44:51], v5
 ds_read_b128 v[60:63], v3 offset:16384
 s_waitcnt lgkmcnt(4)
 v_mfma_f32_16x16x32_bf16 v[20:23], v[36:39], v[44:47], v[20:23]
 v_smfmac_f32_16x16x64_bf16 v[64:67], v[56:59], a[80:87], v5
 v_smfmac_f32_16x16x64_bf16 v[68:71], v[56:59], a[88:95], v5
 ds_read_b128 v[56:59], v3 offset:8192
 v_add_f32 v28, v28, v30
 s_waitcnt lgkmcnt(3)
 v_mfma_f32_16x16x32_bf16 v[24:27], v[40:43], v[44:47], v[24:27]
 v_add_f32 v29, v29, v31
 v_max_f32 v30, v28, v29
 s_waitcnt lgkmcnt(2)
 v_mfma_f32_16x16x32_bf16 v[20:23], v[32:35], v[48:51], v[20:23]
 v_cndmask_b32 v28, v28, v29, s[48:49]
 s_waitcnt lgkmcnt(1)
 v_mfma_f32_16x16x32_bf16 v[24:27], v[60:63], v[48:51], v[24:27]
 v_mov_b64 v[32:33], s[34:35]
 v_mov_b64 v[34:35], s[34:35]
 v_smfmac_f32_16x16x64_bf16 v[64:67], v[52:55], a[120:127], v5
 ds_read_b128 v[36:39], v0 offset:32768
 ds_read_b128 v[40:43], v0 offset:36864
 v_max3_f32 v30, v30, v20, v21
 v_smfmac_f32_16x16x64_bf16 v[68:71], v[52:55], a[128:135], v5
 ds_read_b128 v[44:47], v0 offset:40960
 ds_read_b128 v[48:51], v0 offset:45056
 v_max3_f32 v30, v30, v22, v23
 v_max3_f32 v30, v30, v24, v25
 v_max3_f32 v31, v30, v26, v27
 v_max3_f32 v29, v30, v26, v27
 s_waitcnt lgkmcnt(4)
 v_smfmac_f32_16x16x64_bf16 v[64:67], v[56:59], a[160:167], v5
 v_cndmask_b32 v20, v20, v24, s[48:49]
 v_smfmac_f32_16x16x64_bf16 v[68:71], v[56:59], a[168:175], v5
 v_cndmask_b32 v21, v21, v25, s[48:49]
 v_permlane16_swap_b32 v31, v29
 v_max_f32 v30, v31, v29
 v_max_f32 v6, v31, v29
 v_cndmask_b32 v22, v22, v26, s[48:49]
 v_cndmask_b32 v23, v23, v27, s[48:49]
 v_permlane32_swap_b32 v30, v6
 v_max_f32 v30, v30, v6
 v_mul_f32 v30, -s55, v30
 v_fma_f32 v28, v28, s55, v30
 v_fma_f32 v20, v20, s55, v30
 v_fma_f32 v21, v21, s55, v30
 v_fma_f32 v22, v22, s55, v30
 v_fma_f32 v23, v23, s55, v30
 v_exp_f32 v28, v28
 v_add_f32 v64, v64, v66
 v_add_f32 v65, v65, v67
 v_cndmask_b32 v29, 0, v28, s[48:49]
 v_cndmask_b32 v28, v28, 0, s[48:49]
 v_cvt_pk_bf16_f32 v6, v28, v29
 v_add_f32 v68, v68, v70
 v_add_f32 v69, v69, v71
 v_mfma_f32_16x16x16_bf16 v[60:63], v[6:7], v[32:33], 0
 v_cvt_pk_bf16_f32 v2, v64, v65
 v_cvt_pk_bf16_f32 v4, v68, v69
 v_exp_f32 v20, v20
 v_exp_f32 v21, v21
 v_mfma_f32_16x16x16_bf16 v[52:55], v[6:7], v[2:3], 0
 s_waitcnt vmcnt(3)
 v_exp_f32 v22, v22
 v_mfma_f32_16x16x16_bf16 v[56:59], v[6:7], v[4:5], 0
 s_cmp_eq_u32 s36, 63
 v_exp_f32 v23, v23
 v_cvt_pk_bf16_f32 v30, v20, v21
 v_cvt_pk_bf16_f32 v31, v22, v23
 v_mov_b64 v[64:65], 0
 v_mov_b64 v[66:67], 0
 v_smfmac_f32_16x16x32_bf16 v[60:63], v[30:31], v[32:35], v5
 v_mov_b64 v[68:69], 0
 v_mov_b64 v[70:71], 0
 v_smfmac_f32_16x16x32_bf16 v[52:55], v[30:31], v[12:15], v5
 v_mov_b64 v[20:21], 0
 v_mov_b64 v[22:23], 0
 v_smfmac_f32_16x16x32_bf16 v[56:59], v[30:31], v[16:19], v5
 s_nop 0
 v_add_f32 v60, v60, v62
 v_add_f32 v61, v61, v63
 v_rcp_f32 v60, v60
 v_rcp_f32 v61, v61
 v_add_f32 v52, v52, v54
 v_add_f32 v53, v53, v55
 v_mul_f32 v52, v52, v60
 v_mul_f32 v53, v53, v61
 v_add_f32 v56, v56, v58
 v_add_f32 v57, v57, v59
 v_mul_f32 v56, v56, v60
 v_mul_f32 v57, v57, v61
 v_cvt_pk_bf16_f32 v52, v52, v53
 v_cvt_pk_bf16_f32 v53, v56, v57
 ds_write_b64 v8, v[52:53] offset:21632
 s_cbranch_scc1 Lchexit_51
 v_bfe_u32 v6, v0, 7, 5
 v_mul_u32_u24 v6, 10496, v6
 v_bfe_u32 v60, v3, 4, 3
 v_lshl_add_u32 v6, v60, 3, v6
 s_xor_b32 s46, s46, 0x1
 v_mov_b64 v[24:25], 0
 s_add_u32 s67, s67, 0x80000
 v_mov_b64 v[26:27], 0
 s_add_u32 s59, s59, 0x80000
 v_mov_b64 v[28:29], 0
 s_add_u32 s38, s38, 0x20000
 v_mov_b64 v[30:31], 0
 s_waitcnt lgkmcnt(0)
 s_barrier
 ds_read_b64_tr_b16 v[52:53], v9 offset:21632
 ds_read_b64_tr_b16 v[54:55], v9 offset:21664
 v_mov_b64 v[32:33], 0
 ds_read_b64_tr_b16 v[56:57], v9 offset:22720
 ds_read_b64_tr_b16 v[58:59], v9 offset:22752
 v_mov_b64 v[34:35], 0
 s_cmp_lt_u32 s36, 61
 v_mov_b64 v[12:13], 0
 s_cselect_b32 s47, 0x80000, 0
 v_mov_b64 v[14:15], 0
 s_add_u32 s68, s68, s47
 v_mov_b64 v[16:17], 0
 s_add_u32 s36, s36, 1
 v_mov_b64 v[18:19], 0
 s_waitcnt lgkmcnt(2)
 v_smfmac_f32_16x16x64_bf16 v[64:67], v[52:55], a[248:255], v5
 s_add_u32 s58, s36, 2
 s_min_u32 s58, s58, 64
 v_mov_b64 v[60:61], 0
 v_smfmac_f32_16x16x64_bf16 v[68:71], v[52:55], a[176:183], v5
 buffer_load_dwordx4 v3, s[20:23], s67 offen offset:0 sc1 lds
 v_mov_b64 v[62:63], 0
 s_waitcnt lgkmcnt(0)
 v_smfmac_f32_16x16x64_bf16 v[64:67], v[56:59], v[36:43], v5
 ds_read_b128 v[36:39], v0 offset:49152
 ds_read_b128 v[40:43], v0 offset:53248
 v_smfmac_f32_16x16x64_bf16 v[20:23], v[52:55], a[184:191], v5
 buffer_load_dwordx4 v3, s[20:23], s67 offen offset:1024 sc1 lds
 v_smfmac_f32_16x16x64_bf16 v[68:71], v[56:59], v[44:51], v5
 ds_read_b128 v[44:47], v0 offset:57344
 ds_read_b128 v[48:51], v0 offset:61440
 v_add_f32 v64, v64, v66
 v_add_f32 v65, v65, v67
 v_smfmac_f32_16x16x64_bf16 v[24:27], v[52:55], a[192:199], v5
 s_xor_b32 s44, s44, 0x80000
 s_xor_b32 s45, s45, 0x80000
 v_cvt_pk_bf16_f32 v65, v65, v65
 v_cvt_pk_bf16_f32 v64, v64, v64
 s_waitcnt lgkmcnt(2)
 v_add_u32 v0, 0x10000, v0
 v_smfmac_f32_16x16x64_bf16 v[20:23], v[56:59], v[36:43], v5
 ds_read_b128 v[36:39], v0 offset:0
 ds_read_b128 v[40:43], v0 offset:4096
 v_and_or_b32 v65, v65, -2, s46
 v_smfmac_f32_16x16x64_bf16 v[28:31], v[52:55], a[200:207], v5
 buffer_store_dwordx2 v[64:65], v6, s[20:23], s62 offen
 v_add_f32 v68, v68, v70
 v_add_f32 v69, v69, v71
 s_waitcnt lgkmcnt(2)
 v_smfmac_f32_16x16x64_bf16 v[24:27], v[56:59], v[44:51], v5
 ds_read_b128 v[44:47], v0 offset:8192
 ds_read_b128 v[48:51], v0 offset:12288
 v_add_f32 v20, v20, v22
 v_add_f32 v21, v21, v23
 v_smfmac_f32_16x16x64_bf16 v[32:35], v[52:55], a[208:215], v5
 s_xor_b32 s65, s65, 0x80000
 s_xor_b32 s66, s66, 0x80000
 v_cvt_pk_bf16_f32 v69, v69, v21
 v_cvt_pk_bf16_f32 v68, v68, v20
 s_waitcnt lgkmcnt(2)
 v_smfmac_f32_16x16x64_bf16 v[28:31], v[56:59], v[36:43], v5
 ds_read_b128 v[36:39], v0 offset:16384
 ds_read_b128 v[40:43], v0 offset:20480
 v_and_or_b32 v69, v69, -2, s46
 v_smfmac_f32_16x16x64_bf16 v[12:15], v[52:55], a[216:223], v5
 buffer_store_dwordx2 v[68:69], v6, s[20:23], s60 offen offset:0
 v_add_f32 v24, v24, v26
 v_add_f32 v25, v25, v27
 s_waitcnt lgkmcnt(2)
 v_smfmac_f32_16x16x64_bf16 v[32:35], v[56:59], v[44:51], v5
 ds_read_b128 v[44:47], v0 offset:24576
 ds_read_b128 v[48:51], v0 offset:28672
 v_add_f32 v28, v28, v30
 v_add_f32 v29, v29, v31
 v_smfmac_f32_16x16x64_bf16 v[16:19], v[52:55], a[224:231], v5
 s_xor_b32 s41, s41, 0x80000
 s_xor_b32 s43, s43, 0x80000
 v_cvt_pk_bf16_f32 v25, v25, v29
 v_cvt_pk_bf16_f32 v24, v24, v28
 s_waitcnt lgkmcnt(2)
 v_smfmac_f32_16x16x64_bf16 v[12:15], v[56:59], v[36:43], v5
 v_and_or_b32 v25, v25, -2, s46
 v_smfmac_f32_16x16x64_bf16 v[60:63], v[52:55], a[232:239], v5
 buffer_store_dwordx2 v[24:25], v6, s[20:23], s60 offen offset:2048
 v_add_f32 v32, v32, v34
 v_add_f32 v33, v33, v35
 s_waitcnt lgkmcnt(0)
 v_smfmac_f32_16x16x64_bf16 v[16:19], v[56:59], v[44:51], v5
 s_nop 0
 v_add_f32 v12, v12, v14
 v_add_f32 v13, v13, v15
 v_smfmac_f32_16x16x64_bf16 v[60:63], v[56:59], a[240:247], v5
 v_cvt_pk_bf16_f32 v33, v33, v13
 v_cvt_pk_bf16_f32 v32, v32, v12
 v_and_or_b32 v33, v33, -2, s46
 buffer_store_dwordx2 v[32:33], v6, s[20:23], s61 offen offset:0
 v_add_f32 v16, v16, v18
 v_add_f32 v17, v17, v19
 s_cmp_eq_u32 s4, 0
 s_nop 0
 v_add_f32 v60, v60, v62
 v_add_f32 v61, v61, v63
 v_cvt_pk_bf16_f32 v17, v17, v61
 v_cvt_pk_bf16_f32 v16, v16, v60
 v_and_or_b32 v17, v17, -2, s46
 buffer_store_dwordx2 v[16:17], v6, s[20:23], s61 offen offset:2048
 s_cbranch_scc1 LwH_54
 v_mov_b32 v47, 0x3f80
 v_cndmask_b32 v47, v47, 1.0, s[32:33]
 v_cndmask_b32 v44, 0, v47, s[24:25]
 v_cndmask_b32 v45, 0, v47, s[26:27]
 v_cndmask_b32 v46, 0, v47, s[28:29]
 v_cndmask_b32 v47, 0, v47, s[30:31]
 v_bfe_u32 v52, v3, 8, 2
 v_bfe_u32 v58, v3, 2, 4
 v_lshl_or_b32 v52, v52, 4, v58
 v_and_b32 v58, 0xc0, v3
 v_lshl_or_b32 v52, v58, 24, v52
 v_subrev_u32 v0, 0x20000, v0
 v_mov_b32 v59, -1
 v_add_u32 v54, s42, v3
 v_add_u32 v58, s69, v9
 ds_read_b64_tr_b16 v[64:65], v58 offset:19456
 v_mov_b32 v66, v2
 v_mov_b32 v67, v4
 ds_read_b128 v[20:23], v0 offset:24576
 ds_read_b128 v[24:27], v0 offset:28672
 ds_read_b128 v[28:31], v0 offset:32768
 ds_read_b128 v[32:35], v0 offset:36864
 s_cmp_eq_u32 s4, 1
 s_waitcnt vmcnt(2)
 s_cbranch_scc1 Lq1_55
 s_cmp_eq_u32 s4, 2
 s_waitcnt vmcnt(1)
 s_cbranch_scc1 Lq1_55
 s_waitcnt vmcnt(0)
Lq1_55:
 buffer_load_dwordx4 v[36:39], v3, s[20:23], s39 offen offset:0 sc1
 buffer_load_dwordx4 v[40:43], v3, s[20:23], s39 offen offset:1024 sc1
 s_nop 15
 s_nop 11
 buffer_load_dwordx4 v[12:15], v3, s[20:23], s39 offen offset:0 sc1
 buffer_load_dwordx4 v[16:19], v3, s[20:23], s39 offen offset:1024 sc1
 s_waitcnt vmcnt(3)
 v_mfma_f32_16x16x32_bf16 v[48:51], v[44:47], v[36:39], 0
 s_waitcnt vmcnt(2)
 v_mfma_f32_16x16x32_bf16 v[48:51], v[44:47], v[40:43], v[48:51]
 v_bitop3_b32 v55, v37, v39, s46 bitop3:0x7e
 v_bitop3_b32 v56, v41, v43, s46 bitop3:0x7e
 v_bitop3_b32 v55, v55, 1, v56 bitop3:0xc8
 v_cmp_ne_u32 vcc, 0, v55
 s_nop 3
 v_add_f32_dpp v48, v48, v48 row_ror:4 row_mask:0xf bank_mask:0xf
 v_add_f32_dpp v49, v49, v49 row_ror:4 row_mask:0xf bank_mask:0xf
 s_cbranch_vccnz Lr2_57
 v_add_f32_dpp v48, v48, v48 row_ror:8 row_mask:0xf bank_mask:0xf
 v_add_f32_dpp v49, v49, v49 row_ror:8 row_mask:0xf bank_mask:0xf
 v_cvt_pk_bf16_f32 v48, v48, v49
 buffer_store_dword v48, v52, s[20:23], s44 offen
Lb1_58:
 buffer_store_dword v59, v52, s[20:23], s45 offen
 v_cmp_gt_u32 vcc, s58, v1
 v_mov_b64 v[36:37], 0
 v_mov_b64 v[38:39], 0
 v_mov_b64 v[40:41], 0
 v_mov_b64 v[42:43], 0
 v_mov_b64 v[44:45], 0
 v_mov_b64 v[46:47], 0
 v_mov_b64 v[48:49], 0
 v_mov_b64 v[50:51], 0
 s_cmp_lg_u32 vcc_hi, 0
 s_cbranch_scc1 Lfw_60
Lfok_59:
 v_lshl_add_u32 v1, v3, 3, s68
 v_mov_b32 v6, s56
 v_cndmask_b32 v1, v6, v1, s[70:71]
 s_nop 15
 s_nop 3
 buffer_load_dwordx4 v[12:15], v3, s[20:23], s41 offen offset:0 sc1
 buffer_load_dwordx4 v[16:19], v3, s[20:23], s41 offen offset:1024 sc1
 s_nop 15
 s_nop 7
Lp2_61:
 buffer_load_dwordx4 v[12:15], v3, s[20:23], s41 offen offset:0 sc1
 buffer_load_dwordx4 v[16:19], v3, s[20:23], s41 offen offset:1024 sc1
 s_waitcnt vmcnt(2)
 v_max3_u32 v55, v12, v13, v14
 v_max3_u32 v55, v55, v15, v16
 v_max3_u32 v55, v55, v17, v18
 v_max_u32 v55, v55, v19
 ds_write_b128 v54, v[12:15] offset:0
 ds_write_b128 v54, v[16:19] offset:1024
 v_cmpx_eq_u32 vcc, -1, v55
 s_cbranch_execz Lstep_52
 buffer_load_dwordx4 v[12:15], v3, s[20:23], s41 offen offset:0 sc1
 buffer_load_dwordx4 v[16:19], v3, s[20:23], s41 offen offset:1024 sc1
 s_waitcnt vmcnt(2)
 v_max3_u32 v55, v12, v13, v14
 v_max3_u32 v55, v55, v15, v16
 v_max3_u32 v55, v55, v17, v18
 v_max_u32 v55, v55, v19
 ds_write_b128 v54, v[12:15] offset:0
 ds_write_b128 v54, v[16:19] offset:1024
 v_cmpx_eq_u32 vcc, -1, v55
 s_cbranch_execz Lstep_52
 buffer_load_dwordx4 v[12:15], v3, s[20:23], s41 offen offset:0 sc1
 buffer_load_dwordx4 v[16:19], v3, s[20:23], s41 offen offset:1024 sc1
 s_waitcnt vmcnt(2)
 v_max3_u32 v55, v12, v13, v14
 v_max3_u32 v55, v55, v15, v16
 v_max3_u32 v55, v55, v17, v18
 v_max_u32 v55, v55, v19
 ds_write_b128 v54, v[12:15] offset:0
 ds_write_b128 v54, v[16:19] offset:1024
 v_cmpx_eq_u32 vcc, -1, v55
 s_cbranch_execz Lstep_52
 s_sub_u32 s54, s54, 1
 s_cbranch_scc0 Lp2_61
 s_endpgm
LwH_54:
 v_bfe_u32 v53, v3, 8, 1
 v_bfe_u32 v58, v3, 9, 1
 v_lshl_or_b32 v53, v53, 1, v58
 v_bfe_u32 v58, v3, 5, 1
 v_lshl_or_b32 v53, v53, 1, v58
 v_and_b32 v58, 0xd0, v3
 v_lshlrev_b32 v58, 24, v58
 v_lshl_or_b32 v53, v53, 2, v58
 s_waitcnt vmcnt(2)
 buffer_load_dwordx4 v[20:23], v3, s[20:23], s40 offen offset:0 sc1
 buffer_load_dwordx4 v[24:27], v3, s[20:23], s40 offen offset:1024 sc1
 buffer_load_dwordx4 v[36:39], v3, s[20:23], s39 offen offset:0 sc1
 buffer_load_dwordx4 v[40:43], v3, s[20:23], s39 offen offset:1024 sc1
 v_mov_b32 v47, 0x3f80
 v_cndmask_b32 v47, v47, 1.0, s[32:33]
 v_cndmask_b32 v44, 0, v47, s[24:25]
 v_cndmask_b32 v45, 0, v47, s[26:27]
 v_cndmask_b32 v46, 0, v47, s[28:29]
 v_cndmask_b32 v47, 0, v47, s[30:31]
 v_bfe_u32 v52, v3, 8, 2
 v_bfe_u32 v58, v3, 2, 4
 v_lshl_or_b32 v52, v52, 4, v58
 v_and_b32 v58, 0xc0, v3
 v_lshl_or_b32 v52, v58, 24, v52
 v_subrev_u32 v0, 0x20000, v0
 v_mov_b32 v59, -1
 v_add_u32 v54, s42, v3
 v_add_u32 v58, s69, v9
 ds_read_b64_tr_b16 v[64:65], v58 offset:19456
 v_mov_b32 v66, v2
 v_mov_b32 v67, v4
 s_waitcnt vmcnt(2)
 v_mfma_f32_16x16x32_bf16 v[28:31], v[44:47], v[20:23], 0
 v_mfma_f32_16x16x32_bf16 v[28:31], v[44:47], v[24:27], v[28:31]
 s_waitcnt vmcnt(1)
 v_mfma_f32_16x16x32_bf16 v[48:51], v[44:47], v[36:39], 0
 s_waitcnt vmcnt(0)
 v_mfma_f32_16x16x32_bf16 v[48:51], v[44:47], v[40:43], v[48:51]
 v_bitop3_b32 v55, v37, v39, s46 bitop3:0x7e
 v_bitop3_b32 v56, v41, v43, s46 bitop3:0x7e
 v_bitop3_b32 v57, v21, v23, s46 bitop3:0x7e
 v_or3_b32 v55, v55, v56, v57
 v_bitop3_b32 v56, v25, v27, s46 bitop3:0x7e
 v_bitop3_b32 v55, v55, 1, v56 bitop3:0xc8
 v_cmp_ne_u32 vcc, 0, v55
 v_add_f32_dpp v29, v29, v29 row_ror:4 row_mask:0xf bank_mask:0xf
 v_add_f32_dpp v48, v48, v48 row_ror:4 row_mask:0xf bank_mask:0xf
 v_add_f32_dpp v49, v49, v49 row_ror:4 row_mask:0xf bank_mask:0xf
 v_add_f32_dpp v29, v29, v29 row_ror:8 row_mask:0xf bank_mask:0xf
 v_add_f32_dpp v48, v48, v48 row_ror:8 row_mask:0xf bank_mask:0xf
 v_add_f32_dpp v49, v49, v49 row_ror:8 row_mask:0xf bank_mask:0xf
 s_cbranch_vccnz Lr1_62
 v_cvt_pk_bf16_f32 v48, v48, v49
 buffer_store_dword v48, v52, s[20:23], s44 offen
 v_mov_b32_dpp v30, v29 quad_perm:[1,0,3,2] row_mask:0xf bank_mask:0xf
 v_cvt_pk_bf16_f32 v29, v29, v30
 buffer_store_dword v29, v53, s[20:23], s65 offen
Lb1_63:
 buffer_store_dword v59, v52, s[20:23], s45 offen
 buffer_store_dword v59, v53, s[20:23], s66 offen
 v_cmp_gt_u32 vcc, s58, v1
 ds_read_b128 v[20:23], v0 offset:24576
 ds_read_b128 v[24:27], v0 offset:28672
 ds_read_b128 v[28:31], v0 offset:32768
 ds_read_b128 v[32:35], v0 offset:36864
 v_mov_b64 v[36:37], 0
 v_mov_b64 v[38:39], 0
 v_mov_b64 v[40:41], 0
 v_mov_b64 v[42:43], 0
 v_mov_b64 v[44:45], 0
 v_mov_b64 v[46:47], 0
 v_mov_b64 v[48:49], 0
 v_mov_b64 v[50:51], 0
 s_cmp_lg_u32 vcc_hi, 0
 s_cbranch_scc1 Lfw_65
Lfok_64:
 v_lshl_add_u32 v1, v3, 3, s68
 v_mov_b32 v6, s56
 v_cndmask_b32 v1, v6, v1, s[70:71]
 s_nop 13
 buffer_load_dwordx4 v[12:15], v3, s[20:23], s41 offen offset:0 sc1
 buffer_load_dwordx4 v[16:19], v3, s[20:23], s41 offen offset:1024 sc1
 buffer_load_dwordx4 v[68:71], v3, s[20:23], s43 offen offset:0 sc1
 s_nop 15
 s_nop 7
Lp2_66:
 buffer_load_dwordx4 v[12:15], v3, s[20:23], s41 offen offset:0 sc1
 buffer_load_dwordx4 v[16:19], v3, s[20:23], s41 offen offset:1024 sc1
 buffer_load_dwordx4 v[68:71], v3, s[20:23], s43 offen offset:0 sc1
 s_waitcnt vmcnt(3)
 v_max3_u32 v55, v12, v13, v14
 v_max3_u32 v55, v55, v15, v16
 v_max3_u32 v55, v55, v17, v18
 v_max3_u32 v55, v55, v19, v68
 v_max3_u32 v55, v55, v69, v70
 v_max_u32 v55, v55, v71
 ds_write_b128 v54, v[12:15] offset:0
 ds_write_b128 v54, v[16:19] offset:1024
 ds_write_b128 v54, v[68:71] offset:8192
 v_cmpx_eq_u32 vcc, -1, v55
 s_cbranch_execz Lstep_52
 buffer_load_dwordx4 v[12:15], v3, s[20:23], s41 offen offset:0 sc1
 buffer_load_dwordx4 v[16:19], v3, s[20:23], s41 offen offset:1024 sc1
 buffer_load_dwordx4 v[68:71], v3, s[20:23], s43 offen offset:0 sc1
 s_waitcnt vmcnt(3)
 v_max3_u32 v55, v12, v13, v14
 v_max3_u32 v55, v55, v15, v16
 v_max3_u32 v55, v55, v17, v18
 v_max3_u32 v55, v55, v19, v68
 v_max3_u32 v55, v55, v69, v70
 v_max_u32 v55, v55, v71
 ds_write_b128 v54, v[12:15] offset:0
 ds_write_b128 v54, v[16:19] offset:1024
 ds_write_b128 v54, v[68:71] offset:8192
 v_cmpx_eq_u32 vcc, -1, v55
 s_cbranch_execz Lstep_52
 buffer_load_dwordx4 v[12:15], v3, s[20:23], s41 offen offset:0 sc1
 buffer_load_dwordx4 v[16:19], v3, s[20:23], s41 offen offset:1024 sc1
 buffer_load_dwordx4 v[68:71], v3, s[20:23], s43 offen offset:0 sc1
 s_waitcnt vmcnt(3)
 v_max3_u32 v55, v12, v13, v14
 v_max3_u32 v55, v55, v15, v16
 v_max3_u32 v55, v55, v17, v18
 v_max3_u32 v55, v55, v19, v68
 v_max3_u32 v55, v55, v69, v70
 v_max_u32 v55, v55, v71
 ds_write_b128 v54, v[12:15] offset:0
 ds_write_b128 v54, v[16:19] offset:1024
 ds_write_b128 v54, v[68:71] offset:8192
 v_cmpx_eq_u32 vcc, -1, v55
 s_cbranch_execz Lstep_52
 s_sub_u32 s54, s54, 1
 s_cbranch_scc0 Lp2_66
 s_endpgm
Lr1_62:
 s_mov_b64 exec, vcc
Lrt_67:
 buffer_load_dwordx4 v[20:23], v3, s[20:23], s40 offen offset:0 sc1
 buffer_load_dwordx4 v[24:27], v3, s[20:23], s40 offen offset:1024 sc1
 buffer_load_dwordx4 v[36:39], v3, s[20:23], s39 offen offset:0 sc1
 buffer_load_dwordx4 v[40:43], v3, s[20:23], s39 offen offset:1024 sc1
 s_waitcnt vmcnt(4)
 v_bitop3_b32 v55, v37, v39, s46 bitop3:0x7e
 v_bitop3_b32 v56, v41, v43, s46 bitop3:0x7e
 v_bitop3_b32 v57, v21, v23, s46 bitop3:0x7e
 v_or3_b32 v55, v55, v56, v57
 v_bitop3_b32 v56, v25, v27, s46 bitop3:0x7e
 v_bitop3_b32 v55, v55, 1, v56 bitop3:0xc8
 v_cmpx_ne_u32 vcc, 0, v55
 s_cbranch_execz Lrte_68
 buffer_load_dwordx4 v[20:23], v3, s[20:23], s40 offen offset:0 sc1
 buffer_load_dwordx4 v[24:27], v3, s[20:23], s40 offen offset:1024 sc1
 buffer_load_dwordx4 v[36:39], v3, s[20:23], s39 offen offset:0 sc1
 buffer_load_dwordx4 v[40:43], v3, s[20:23], s39 offen offset:1024 sc1
 s_waitcnt vmcnt(4)
 v_bitop3_b32 v55, v37, v39, s46 bitop3:0x7e
 v_bitop3_b32 v56, v41, v43, s46 bitop3:0x7e
 v_bitop3_b32 v57, v21, v23, s46 bitop3:0x7e
 v_or3_b32 v55, v55, v56, v57
 v_bitop3_b32 v56, v25, v27, s46 bitop3:0x7e
 v_bitop3_b32 v55, v55, 1, v56 bitop3:0xc8
 v_cmpx_ne_u32 vcc, 0, v55
 s_cbranch_execz Lrte_68
 buffer_load_dwordx4 v[20:23], v3, s[20:23], s40 offen offset:0 sc1
 buffer_load_dwordx4 v[24:27], v3, s[20:23], s40 offen offset:1024 sc1
 buffer_load_dwordx4 v[36:39], v3, s[20:23], s39 offen offset:0 sc1
 buffer_load_dwordx4 v[40:43], v3, s[20:23], s39 offen offset:1024 sc1
 s_waitcnt vmcnt(4)
 v_bitop3_b32 v55, v37, v39, s46 bitop3:0x7e
 v_bitop3_b32 v56, v41, v43, s46 bitop3:0x7e
 v_bitop3_b32 v57, v21, v23, s46 bitop3:0x7e
 v_or3_b32 v55, v55, v56, v57
 v_bitop3_b32 v56, v25, v27, s46 bitop3:0x7e
 v_bitop3_b32 v55, v55, 1, v56 bitop3:0xc8
 v_cmpx_ne_u32 vcc, 0, v55
 s_cbranch_execz Lrte_68
 s_sub_u32 s54, s54, 1
 s_cbranch_scc0 Lrt_67
 s_endpgm
Lrte_68:
 s_mov_b64 exec, -1
 s_nop 2
 v_mfma_f32_16x16x32_bf16 v[28:31], v[44:47], v[20:23], 0
 v_mfma_f32_16x16x32_bf16 v[28:31], v[44:47], v[24:27], v[28:31]
 v_mfma_f32_16x16x32_bf16 v[48:51], v[44:47], v[36:39], 0
 v_mfma_f32_16x16x32_bf16 v[48:51], v[44:47], v[40:43], v[48:51]
 s_nop 6
 v_add_f32_dpp v29, v29, v29 row_ror:4 row_mask:0xf bank_mask:0xf
 v_add_f32_dpp v48, v48, v48 row_ror:4 row_mask:0xf bank_mask:0xf
 v_add_f32_dpp v49, v49, v49 row_ror:4 row_mask:0xf bank_mask:0xf
 v_add_f32_dpp v29, v29, v29 row_ror:8 row_mask:0xf bank_mask:0xf
 v_add_f32_dpp v48, v48, v48 row_ror:8 row_mask:0xf bank_mask:0xf
 v_add_f32_dpp v49, v49, v49 row_ror:8 row_mask:0xf bank_mask:0xf
 v_cvt_pk_bf16_f32 v48, v48, v49
 buffer_store_dword v48, v52, s[20:23], s44 offen
 v_mov_b32_dpp v30, v29 quad_perm:[1,0,3,2] row_mask:0xf bank_mask:0xf
 v_cvt_pk_bf16_f32 v29, v29, v30
 buffer_store_dword v29, v53, s[20:23], s65 offen
 s_waitcnt vmcnt(2)
 s_branch Lb1_63
Lr2_57:
 s_waitcnt vmcnt(1)
 v_mfma_f32_16x16x32_bf16 v[48:51], v[44:47], v[12:15], 0
 s_waitcnt vmcnt(0)
 v_mfma_f32_16x16x32_bf16 v[48:51], v[44:47], v[16:19], v[48:51]
 v_bitop3_b32 v55, v13, v15, s46 bitop3:0x7e
 v_bitop3_b32 v56, v17, v19, s46 bitop3:0x7e
 v_bitop3_b32 v55, v55, 1, v56 bitop3:0xc8
 v_cmp_ne_u32 vcc, 0, v55
 s_nop 3
 v_add_f32_dpp v48, v48, v48 row_ror:4 row_mask:0xf bank_mask:0xf
 v_add_f32_dpp v49, v49, v49 row_ror:4 row_mask:0xf bank_mask:0xf
 s_cbranch_vccnz Lr1_56
 v_add_f32_dpp v48, v48, v48 row_ror:8 row_mask:0xf bank_mask:0xf
 v_add_f32_dpp v49, v49, v49 row_ror:8 row_mask:0xf bank_mask:0xf
 v_cvt_pk_bf16_f32 v48, v48, v49
 buffer_store_dword v48, v52, s[20:23], s44 offen
 s_branch Lb1_58
Lr1_56:
 s_mov_b64 exec, vcc
Lrt_69:
 buffer_load_dwordx4 v[12:15], v3, s[20:23], s39 offen offset:0 sc1
 buffer_load_dwordx4 v[16:19], v3, s[20:23], s39 offen offset:1024 sc1
 s_waitcnt vmcnt(2)
 v_bitop3_b32 v55, v13, v15, s46 bitop3:0x7e
 v_bitop3_b32 v56, v17, v19, s46 bitop3:0x7e
 v_bitop3_b32 v55, v55, 1, v56 bitop3:0xc8
 v_cmpx_ne_u32 vcc, 0, v55
 s_cbranch_execz Lrte_70
 buffer_load_dwordx4 v[12:15], v3, s[20:23], s39 offen offset:0 sc1
 buffer_load_dwordx4 v[16:19], v3, s[20:23], s39 offen offset:1024 sc1
 s_waitcnt vmcnt(2)
 v_bitop3_b32 v55, v13, v15, s46 bitop3:0x7e
 v_bitop3_b32 v56, v17, v19, s46 bitop3:0x7e
 v_bitop3_b32 v55, v55, 1, v56 bitop3:0xc8
 v_cmpx_ne_u32 vcc, 0, v55
 s_cbranch_execz Lrte_70
 buffer_load_dwordx4 v[12:15], v3, s[20:23], s39 offen offset:0 sc1
 buffer_load_dwordx4 v[16:19], v3, s[20:23], s39 offen offset:1024 sc1
 s_waitcnt vmcnt(2)
 v_bitop3_b32 v55, v13, v15, s46 bitop3:0x7e
 v_bitop3_b32 v56, v17, v19, s46 bitop3:0x7e
 v_bitop3_b32 v55, v55, 1, v56 bitop3:0xc8
 v_cmpx_ne_u32 vcc, 0, v55
 s_cbranch_execz Lrte_70
 s_sub_u32 s54, s54, 1
 s_cbranch_scc0 Lrt_69
 s_endpgm
Lrte_70:
 s_mov_b64 exec, -1
 s_nop 2
 v_mfma_f32_16x16x32_bf16 v[48:51], v[44:47], v[12:15], 0
 v_mfma_f32_16x16x32_bf16 v[48:51], v[44:47], v[16:19], v[48:51]
 s_nop 7
 v_add_f32_dpp v48, v48, v48 row_ror:4 row_mask:0xf bank_mask:0xf
 v_add_f32_dpp v49, v49, v49 row_ror:4 row_mask:0xf bank_mask:0xf
 s_nop 0
 v_add_f32_dpp v48, v48, v48 row_ror:8 row_mask:0xf bank_mask:0xf
 v_add_f32_dpp v49, v49, v49 row_ror:8 row_mask:0xf bank_mask:0xf
 v_cvt_pk_bf16_f32 v48, v48, v49
 buffer_store_dword v48, v52, s[20:23], s44 offen
 s_branch Lb1_58
Lfw_60:
Lpb_71:
 buffer_load_dword v1, v7, s[20:23], s56 offen sc1
 s_waitcnt vmcnt(0)
 v_cmp_le_u32 vcc, s58, v1
 s_cbranch_vccnz Lpbok_72
 s_sub_u32 s54, s54, 1
 s_cbranch_scc0 Lpb_71
 s_endpgm
Lpbok_72:
 s_branch Lfok_59
Lfw_65:
Lpb_73:
 buffer_load_dword v1, v7, s[20:23], s56 offen sc1
 s_waitcnt vmcnt(0)
 v_cmp_le_u32 vcc, s58, v1
 s_cbranch_vccnz Lpbok_74
 s_sub_u32 s54, s54, 1
 s_cbranch_scc0 Lpb_73
 s_endpgm
Lpbok_74:
 s_branch Lfok_64
Lfail_53:
 s_endpgm
Lslow_50:
 .p2align 3
Lstep_75:
 s_mov_b64 exec, -1
 s_waitcnt lgkmcnt(0)
 s_barrier
 ds_read_b128 v[52:55], v3 offset:0
 ds_read_b128 v[56:59], v3 offset:1024
 ds_read_b128 v[60:63], v3 offset:2048
 buffer_load_dwordx4 v[12:15], v3, s[20:23], s59 offen offset:0 sc1
 s_waitcnt lgkmcnt(2)
 v_smfmac_f32_16x16x64_bf16 v[36:39], v[52:55], v[72:79], v5
 v_smfmac_f32_16x16x64_bf16 v[40:43], v[52:55], v[80:87], v5
 buffer_load_dwordx4 v[16:19], v3, s[20:23], s59 offen offset:1024 sc1
 v_smfmac_f32_16x16x64_bf16 v[44:47], v[52:55], v[88:95], v5
 s_waitcnt lgkmcnt(1)
 v_smfmac_f32_16x16x64_bf16 v[48:51], v[52:55], v[20:27], v5
 v_smfmac_f32_16x16x64_bf16 v[36:39], v[56:59], v[112:119], v5
 ds_read_b128 v[20:23], v0 offset:40960
 v_smfmac_f32_16x16x64_bf16 v[40:43], v[56:59], v[120:127], v5
 ds_read_b128 v[24:27], v0 offset:45056
 v_smfmac_f32_16x16x64_bf16 v[44:47], v[56:59], v[128:135], v5
 ds_read_b128 v[52:55], v3 offset:3072
 s_waitcnt lgkmcnt(3)
 v_smfmac_f32_16x16x64_bf16 v[48:51], v[56:59], v[28:35], v5
 buffer_load_dword v1, v1, s[20:23], 0 offen sc1
 v_smfmac_f32_16x16x64_bf16 v[36:39], v[60:63], v[152:159], v5
 ds_read_b128 v[28:31], v0 offset:49152
 s_max_u32 s47, s36, 1
 v_smfmac_f32_16x16x64_bf16 v[40:43], v[60:63], v[160:167], v5
 ds_read_b128 v[32:35], v0 offset:53248
 s_sub_u32 s47, s47, 1
 v_smfmac_f32_16x16x64_bf16 v[44:47], v[60:63], v[168:175], v5
 ds_read_b128 v[56:59], v3 offset:4096
 s_waitcnt lgkmcnt(3)
 v_smfmac_f32_16x16x64_bf16 v[48:51], v[60:63], v[20:27], v5
 v_smfmac_f32_16x16x64_bf16 v[36:39], v[52:55], v[192:199], v5
 ds_read_b128 v[20:23], v0 offset:57344
 v_min_u32 v6, 16, v0
 v_smfmac_f32_16x16x64_bf16 v[40:43], v[52:55], v[200:207], v5
 ds_read_b128 v[24:27], v0 offset:61440
 v_lshlrev_b32 v6, 24, v6
 v_smfmac_f32_16x16x64_bf16 v[44:47], v[52:55], v[208:215], v5
 ds_read_b128 v[60:63], v3 offset:5120
 s_waitcnt lgkmcnt(3)
 v_add_u32 v0, 0x10000, v0
 v_smfmac_f32_16x16x64_bf16 v[48:51], v[52:55], v[28:35], v5
 buffer_store_dwordx4 v[64:67], v0, s[20:23], s38 offen sc1
 v_smfmac_f32_16x16x64_bf16 v[36:39], v[56:59], v[232:239], v5
 ds_read_b128 v[28:31], v0 offset:0
 v_smfmac_f32_16x16x64_bf16 v[40:43], v[56:59], v[240:247], v5
 ds_read_b128 v[32:35], v0 offset:4096
 v_smfmac_f32_16x16x64_bf16 v[44:47], v[56:59], v[248:255], v5
 ds_read_b128 v[52:55], v3 offset:6144
 s_waitcnt lgkmcnt(3)
 v_smfmac_f32_16x16x64_bf16 v[48:51], v[56:59], v[20:27], v5
 v_smfmac_f32_16x16x64_bf16 v[36:39], v[60:63], a[16:23], v5
 ds_read_b128 v[20:23], v0 offset:8192
 v_mov_b32 v64, s47
 v_smfmac_f32_16x16x64_bf16 v[40:43], v[60:63], a[24:31], v5
 ds_read_b128 v[24:27], v0 offset:12288
 v_smfmac_f32_16x16x64_bf16 v[44:47], v[60:63], a[32:39], v5
 ds_read_b128 v[56:59], v3 offset:7168
 s_waitcnt lgkmcnt(3)
 v_smfmac_f32_16x16x64_bf16 v[48:51], v[60:63], v[28:35], v5
 buffer_store_dword v64, v6, s[20:23], s57 offen sc1
 v_smfmac_f32_16x16x64_bf16 v[36:39], v[52:55], a[56:63], v5
 ds_read_b128 v[28:31], v0 offset:16384
 v_smfmac_f32_16x16x64_bf16 v[40:43], v[52:55], a[64:71], v5
 ds_read_b128 v[32:35], v0 offset:20480
 v_smfmac_f32_16x16x64_bf16 v[44:47], v[52:55], a[72:79], v5
 ds_read_b128 v[60:63], v3 offset:8192
 s_waitcnt lgkmcnt(3)
 v_smfmac_f32_16x16x64_bf16 v[48:51], v[52:55], v[20:27], v5
 s_waitcnt vmcnt(5)
 v_smfmac_f32_16x16x64_bf16 v[36:39], v[56:59], a[96:103], v5
 ds_read_b128 v[20:23], v0 offset:24576
 v_mov_b64 v[64:65], 0
 v_smfmac_f32_16x16x64_bf16 v[40:43], v[56:59], a[104:111], v5
 ds_read_b128 v[24:27], v0 offset:28672
 v_mov_b64 v[66:67], 0
 v_smfmac_f32_16x16x64_bf16 v[44:47], v[56:59], a[112:119], v5
 ds_read_b128 v[52:55], v3 offset:0
 s_waitcnt lgkmcnt(3)
 v_mov_b64 v[68:69], 0
 v_smfmac_f32_16x16x64_bf16 v[48:51], v[56:59], v[28:35], v5
 v_mov_b64 v[70:71], 0
 v_smfmac_f32_16x16x64_bf16 v[36:39], v[60:63], a[136:143], v5
 ds_read_b128 v[32:35], v3 offset:11264
 v_mov_b64 v[28:29], 0
 v_smfmac_f32_16x16x64_bf16 v[40:43], v[60:63], a[144:151], v5
 v_mov_b64 v[30:31], 0
 v_smfmac_f32_16x16x64_bf16 v[44:47], v[60:63], a[152:159], v5
 ds_read_b128 v[56:59], v3 offset:1024
 s_waitcnt lgkmcnt(2)
 v_add_f32 v36, v36, v38
 v_smfmac_f32_16x16x64_bf16 v[48:51], v[60:63], v[20:27], v5
 ds_read_b128 v[60:63], v3 offset:2048
 ds_read_b128 v[20:23], v3 offset:9216
 v_add_f32 v37, v37, v39
 v_cvt_pk_bf16_f32 v36, v36, v37
 v_smfmac_f32_16x16x64_bf16 v[64:67], v[52:55], v[96:103], v5
 ds_write_b16 v10, v36 offset:17408
 ds_write_b16_d16_hi v10, v36 offset:17472
 v_add_f32 v40, v40, v42
 v_add_f32 v41, v41, v43
 v_cvt_pk_bf16_f32 v40, v40, v41
 v_smfmac_f32_16x16x64_bf16 v[68:71], v[52:55], v[104:111], v5
 ds_write_b16 v10, v40 offset:17412
 ds_write_b16_d16_hi v10, v40 offset:17476
 v_add_f32 v44, v44, v46
 v_add_f32 v45, v45, v47
 v_add_f32 v48, v48, v50
 v_add_f32 v49, v49, v51
 v_cvt_pk_bf16_f32 v44, v44, v45
 v_cvt_pk_bf16_f32 v45, v48, v49
 ds_write_b64 v8, v[44:45] offset:19456
 s_waitcnt lgkmcnt(7)
 v_smfmac_f32_16x16x64_bf16 v[64:67], v[56:59], v[136:143], v5
 ds_read_b128 v[52:55], v3 offset:3072
 ds_read_b128 v[24:27], v3 offset:10240
 v_smfmac_f32_16x16x64_bf16 v[68:71], v[56:59], v[144:151], v5
 ds_read_b128 v[56:59], v3 offset:4096
 s_waitcnt lgkmcnt(9)
 v_smfmac_f32_16x16x64_bf16 v[64:67], v[60:63], v[176:183], v5
 v_smfmac_f32_16x16x64_bf16 v[68:71], v[60:63], v[184:191], v5
 s_waitcnt lgkmcnt(3)
 s_barrier
 ds_read_b128 v[36:39], v11 offset:17408
 ds_read_b128 v[40:43], v11 offset:17920
 s_waitcnt lgkmcnt(4)
 v_smfmac_f32_16x16x64_bf16 v[64:67], v[52:55], v[216:223], v5
 ds_read_b64_tr_b16 v[60:61], v9 offset:19456
 ds_read_b64_tr_b16 v[62:63], v9 offset:19488
 v_smfmac_f32_16x16x64_bf16 v[68:71], v[52:55], v[224:231], v5
 ds_read_b128 v[52:55], v3 offset:5120
 ds_read_b128 v[44:47], v11 offset:18432
 s_waitcnt lgkmcnt(6)
 v_smfmac_f32_16x16x64_bf16 v[64:67], v[56:59], a[0:7], v5
 ds_read_b128 v[48:51], v11 offset:18944
 v_smfmac_f32_16x16x64_bf16 v[68:71], v[56:59], a[8:15], v5
 ds_read_b128 v[56:59], v3 offset:6144
 s_waitcnt lgkmcnt(7)
 v_mfma_f32_16x16x32_bf16 v[20:23], v[20:23], v[36:39], 0
 v_mfma_f32_16x16x32_bf16 v[24:27], v[24:27], v[36:39], 0
 s_waitcnt lgkmcnt(6)
 v_mfma_f32_16x16x32_bf16 v[20:23], v[32:35], v[40:43], v[20:23]
 ds_read_b128 v[32:35], v3 offset:12288
 s_waitcnt lgkmcnt(5)
 v_smfmac_f32_16x16x64_bf16 v[28:31], v[60:63], v[36:43], v5
 ds_read_b64_tr_b16 v[60:61], v9 offset:20544
 ds_read_b64_tr_b16 v[62:63], v9 offset:20576
 ds_read_b128 v[36:39], v3 offset:13312
 s_waitcnt lgkmcnt(7)
 v_smfmac_f32_16x16x64_bf16 v[64:67], v[52:55], a[40:47], v5
 v_smfmac_f32_16x16x64_bf16 v[68:71], v[52:55], a[48:55], v5
 ds_read_b128 v[52:55], v3 offset:7168
 s_waitcnt lgkmcnt(4)
 v_mfma_f32_16x16x32_bf16 v[24:27], v[32:35], v[40:43], v[24:27]
 ds_read_b128 v[40:43], v3 offset:14336
 ds_read_b128 v[32:35], v3 offset:15360
 s_waitcnt lgkmcnt(4)
 v_smfmac_f32_16x16x64_bf16 v[28:31], v[60:63], v[44:51], v5
 ds_read_b128 v[60:63], v3 offset:16384
 s_waitcnt lgkmcnt(4)
 v_mfma_f32_16x16x32_bf16 v[20:23], v[36:39], v[44:47], v[20:23]
 v_smfmac_f32_16x16x64_bf16 v[64:67], v[56:59], a[80:87], v5
 v_smfmac_f32_16x16x64_bf16 v[68:71], v[56:59], a[88:95], v5
 ds_read_b128 v[56:59], v3 offset:8192
 v_add_f32 v28, v28, v30
 s_waitcnt lgkmcnt(3)
 v_mfma_f32_16x16x32_bf16 v[24:27], v[40:43], v[44:47], v[24:27]
 v_add_f32 v29, v29, v31
 v_max_f32 v30, v28, v29
 s_waitcnt lgkmcnt(2)
 v_mfma_f32_16x16x32_bf16 v[20:23], v[32:35], v[48:51], v[20:23]
 v_cndmask_b32 v28, v28, v29, s[48:49]
 s_waitcnt lgkmcnt(1)
 v_mfma_f32_16x16x32_bf16 v[24:27], v[60:63], v[48:51], v[24:27]
 v_mov_b64 v[32:33], s[34:35]
 v_mov_b64 v[34:35], s[34:35]
 v_smfmac_f32_16x16x64_bf16 v[64:67], v[52:55], a[120:127], v5
 ds_read_b128 v[36:39], v0 offset:32768
 ds_read_b128 v[40:43], v0 offset:36864
 v_max3_f32 v30, v30, v20, v21
 v_smfmac_f32_16x16x64_bf16 v[68:71], v[52:55], a[128:135], v5
 ds_read_b128 v[44:47], v0 offset:40960
 ds_read_b128 v[48:51], v0 offset:45056
 v_max3_f32 v30, v30, v22, v23
 v_max3_f32 v30, v30, v24, v25
 v_max3_f32 v31, v30, v26, v27
 v_max3_f32 v29, v30, v26, v27
 s_waitcnt lgkmcnt(4)
 v_smfmac_f32_16x16x64_bf16 v[64:67], v[56:59], a[160:167], v5
 v_cndmask_b32 v20, v20, v24, s[48:49]
 v_smfmac_f32_16x16x64_bf16 v[68:71], v[56:59], a[168:175], v5
 v_cndmask_b32 v21, v21, v25, s[48:49]
 v_permlane16_swap_b32 v31, v29
 v_max_f32 v30, v31, v29
 v_max_f32 v6, v31, v29
 v_cndmask_b32 v22, v22, v26, s[48:49]
 v_cndmask_b32 v23, v23, v27, s[48:49]
 v_permlane32_swap_b32 v30, v6
 v_max_f32 v30, v30, v6
 v_mul_f32 v30, -s55, v30
 v_fma_f32 v28, v28, s55, v30
 v_fma_f32 v20, v20, s55, v30
 v_fma_f32 v21, v21, s55, v30
 v_fma_f32 v22, v22, s55, v30
 v_fma_f32 v23, v23, s55, v30
 v_exp_f32 v28, v28
 v_add_f32 v64, v64, v66
 v_add_f32 v65, v65, v67
 v_cndmask_b32 v29, 0, v28, s[48:49]
 v_cndmask_b32 v28, v28, 0, s[48:49]
 v_cvt_pk_bf16_f32 v6, v28, v29
 v_add_f32 v68, v68, v70
 v_add_f32 v69, v69, v71
 v_mfma_f32_16x16x16_bf16 v[60:63], v[6:7], v[32:33], 0
 v_cvt_pk_bf16_f32 v2, v64, v65
 v_cvt_pk_bf16_f32 v4, v68, v69
 v_exp_f32 v20, v20
 v_exp_f32 v21, v21
 v_mfma_f32_16x16x16_bf16 v[52:55], v[6:7], v[2:3], 0
 s_waitcnt vmcnt(3)
 v_exp_f32 v22, v22
 v_mfma_f32_16x16x16_bf16 v[56:59], v[6:7], v[4:5], 0
 s_cmp_eq_u32 s36, 63
 v_exp_f32 v23, v23
 v_cvt_pk_bf16_f32 v30, v20, v21
 v_cvt_pk_bf16_f32 v31, v22, v23
 v_mov_b64 v[64:65], 0
 v_mov_b64 v[66:67], 0
 v_smfmac_f32_16x16x32_bf16 v[60:63], v[30:31], v[32:35], v5
 v_mov_b64 v[68:69], 0
 v_mov_b64 v[70:71], 0
 v_smfmac_f32_16x16x32_bf16 v[52:55], v[30:31], v[12:15], v5
 v_mov_b64 v[20:21], 0
 v_mov_b64 v[22:23], 0
 v_smfmac_f32_16x16x32_bf16 v[56:59], v[30:31], v[16:19], v5
 s_nop 0
 v_add_f32 v60, v60, v62
 v_add_f32 v61, v61, v63
 v_rcp_f32 v60, v60
 v_rcp_f32 v61, v61
 v_add_f32 v52, v52, v54
 v_add_f32 v53, v53, v55
 v_mul_f32 v52, v52, v60
 v_mul_f32 v53, v53, v61
 v_add_f32 v56, v56, v58
 v_add_f32 v57, v57, v59
 v_mul_f32 v56, v56, v60
 v_mul_f32 v57, v57, v61
 v_cvt_pk_bf16_f32 v52, v52, v53
 v_cvt_pk_bf16_f32 v53, v56, v57
 ds_write_b64 v8, v[52:53] offset:21632
 s_cbranch_scc1 Lchexit_51
 v_bfe_u32 v6, v0, 7, 5
 v_mul_u32_u24 v6, 10496, v6
 v_bfe_u32 v60, v3, 4, 3
 v_lshl_add_u32 v6, v60, 3, v6
 s_xor_b32 s46, s46, 0x1
 v_mov_b64 v[24:25], 0
 s_add_u32 s67, s67, 0x80000
 v_mov_b64 v[26:27], 0
 s_add_u32 s59, s59, 0x80000
 v_mov_b64 v[28:29], 0
 s_add_u32 s38, s38, 0x20000
 v_mov_b64 v[30:31], 0
 s_waitcnt lgkmcnt(0)
 s_barrier
 ds_read_b64_tr_b16 v[52:53], v9 offset:21632
 ds_read_b64_tr_b16 v[54:55], v9 offset:21664
 v_mov_b64 v[32:33], 0
 ds_read_b64_tr_b16 v[56:57], v9 offset:22720
 ds_read_b64_tr_b16 v[58:59], v9 offset:22752
 v_mov_b64 v[34:35], 0
 s_cmp_lt_u32 s36, 61
 v_mov_b64 v[12:13], 0
 s_cselect_b32 s47, 0x80000, 0
 v_mov_b64 v[14:15], 0
 s_add_u32 s68, s68, s47
 v_mov_b64 v[16:17], 0
 s_add_u32 s36, s36, 1
 v_mov_b64 v[18:19], 0
 s_waitcnt lgkmcnt(2)
 v_smfmac_f32_16x16x64_bf16 v[64:67], v[52:55], a[248:255], v5
 s_add_u32 s58, s36, 2
 s_min_u32 s58, s58, 64
 v_mov_b64 v[60:61], 0
 v_smfmac_f32_16x16x64_bf16 v[68:71], v[52:55], a[176:183], v5
 buffer_load_dwordx4 v3, s[20:23], s67 offen offset:0 sc1 lds
 v_mov_b64 v[62:63], 0
 s_waitcnt lgkmcnt(0)
 v_smfmac_f32_16x16x64_bf16 v[64:67], v[56:59], v[36:43], v5
 ds_read_b128 v[36:39], v0 offset:49152
 ds_read_b128 v[40:43], v0 offset:53248
 v_smfmac_f32_16x16x64_bf16 v[20:23], v[52:55], a[184:191], v5
 buffer_load_dwordx4 v3, s[20:23], s67 offen offset:1024 sc1 lds
 v_smfmac_f32_16x16x64_bf16 v[68:71], v[56:59], v[44:51], v5
 ds_read_b128 v[44:47], v0 offset:57344
 ds_read_b128 v[48:51], v0 offset:61440
 v_add_f32 v64, v64, v66
 v_add_f32 v65, v65, v67
 v_smfmac_f32_16x16x64_bf16 v[24:27], v[52:55], a[192:199], v5
 s_xor_b32 s44, s44, 0x80000
 s_xor_b32 s45, s45, 0x80000
 v_cvt_pk_bf16_f32 v65, v65, v65
 v_cvt_pk_bf16_f32 v64, v64, v64
 s_waitcnt lgkmcnt(2)
 v_add_u32 v0, 0x10000, v0
 v_smfmac_f32_16x16x64_bf16 v[20:23], v[56:59], v[36:43], v5
 ds_read_b128 v[36:39], v0 offset:0
 ds_read_b128 v[40:43], v0 offset:4096
 v_and_or_b32 v65, v65, -2, s46
 v_smfmac_f32_16x16x64_bf16 v[28:31], v[52:55], a[200:207], v5
 buffer_store_dwordx2 v[64:65], v6, s[20:23], s62 offen sc1
 v_add_f32 v68, v68, v70
 v_add_f32 v69, v69, v71
 s_waitcnt lgkmcnt(2)
 v_smfmac_f32_16x16x64_bf16 v[24:27], v[56:59], v[44:51], v5
 ds_read_b128 v[44:47], v0 offset:8192
 ds_read_b128 v[48:51], v0 offset:12288
 v_add_f32 v20, v20, v22
 v_add_f32 v21, v21, v23
 v_smfmac_f32_16x16x64_bf16 v[32:35], v[52:55], a[208:215], v5
 s_xor_b32 s65, s65, 0x80000
 s_xor_b32 s66, s66, 0x80000
 v_cvt_pk_bf16_f32 v69, v69, v21
 v_cvt_pk_bf16_f32 v68, v68, v20
 s_waitcnt lgkmcnt(2)
 v_smfmac_f32_16x16x64_bf16 v[28:31], v[56:59], v[36:43], v5
 ds_read_b128 v[36:39], v0 offset:16384
 ds_read_b128 v[40:43], v0 offset:20480
 v_and_or_b32 v69, v69, -2, s46
 v_smfmac_f32_16x16x64_bf16 v[12:15], v[52:55], a[216:223], v5
 buffer_store_dwordx2 v[68:69], v6, s[20:23], s60 offen offset:0 sc1
 v_add_f32 v24, v24, v26
 v_add_f32 v25, v25, v27
 s_waitcnt lgkmcnt(2)
 v_smfmac_f32_16x16x64_bf16 v[32:35], v[56:59], v[44:51], v5
 ds_read_b128 v[44:47], v0 offset:24576
 ds_read_b128 v[48:51], v0 offset:28672
 v_add_f32 v28, v28, v30
 v_add_f32 v29, v29, v31
 v_smfmac_f32_16x16x64_bf16 v[16:19], v[52:55], a[224:231], v5
 s_xor_b32 s41, s41, 0x80000
 s_xor_b32 s43, s43, 0x80000
 v_cvt_pk_bf16_f32 v25, v25, v29
 v_cvt_pk_bf16_f32 v24, v24, v28
 s_waitcnt lgkmcnt(2)
 v_smfmac_f32_16x16x64_bf16 v[12:15], v[56:59], v[36:43], v5
 v_and_or_b32 v25, v25, -2, s46
 v_smfmac_f32_16x16x64_bf16 v[60:63], v[52:55], a[232:239], v5
 buffer_store_dwordx2 v[24:25], v6, s[20:23], s60 offen offset:2048 sc1
 v_add_f32 v32, v32, v34
 v_add_f32 v33, v33, v35
 s_waitcnt lgkmcnt(0)
 v_smfmac_f32_16x16x64_bf16 v[16:19], v[56:59], v[44:51], v5
 s_nop 0
 v_add_f32 v12, v12, v14
 v_add_f32 v13, v13, v15
 v_smfmac_f32_16x16x64_bf16 v[60:63], v[56:59], a[240:247], v5
 v_cvt_pk_bf16_f32 v33, v33, v13
 v_cvt_pk_bf16_f32 v32, v32, v12
 v_and_or_b32 v33, v33, -2, s46
 buffer_store_dwordx2 v[32:33], v6, s[20:23], s61 offen offset:0 sc1
 v_add_f32 v16, v16, v18
 v_add_f32 v17, v17, v19
 s_cmp_eq_u32 s4, 0
 s_nop 0
 v_add_f32 v60, v60, v62
 v_add_f32 v61, v61, v63
 v_cvt_pk_bf16_f32 v17, v17, v61
 v_cvt_pk_bf16_f32 v16, v16, v60
 v_and_or_b32 v17, v17, -2, s46
 buffer_store_dwordx2 v[16:17], v6, s[20:23], s61 offen offset:2048 sc1
 s_cbranch_scc1 LwH_77
 v_mov_b32 v47, 0x3f80
 v_cndmask_b32 v47, v47, 1.0, s[32:33]
 v_cndmask_b32 v44, 0, v47, s[24:25]
 v_cndmask_b32 v45, 0, v47, s[26:27]
 v_cndmask_b32 v46, 0, v47, s[28:29]
 v_cndmask_b32 v47, 0, v47, s[30:31]
 v_bfe_u32 v52, v3, 8, 2
 v_bfe_u32 v58, v3, 2, 4
 v_lshl_or_b32 v52, v52, 4, v58
 v_and_b32 v58, 0xc0, v3
 v_lshl_or_b32 v52, v58, 24, v52
 v_subrev_u32 v0, 0x20000, v0
 v_mov_b32 v59, -1
 v_add_u32 v54, s42, v3
 v_add_u32 v58, s69, v9
 ds_read_b64_tr_b16 v[64:65], v58 offset:19456
 v_mov_b32 v66, v2
 v_mov_b32 v67, v4
 ds_read_b128 v[20:23], v0 offset:24576
 ds_read_b128 v[24:27], v0 offset:28672
 ds_read_b128 v[28:31], v0 offset:32768
 ds_read_b128 v[32:35], v0 offset:36864
 s_cmp_eq_u32 s4, 1
 s_waitcnt vmcnt(2)
 s_cbranch_scc1 Lq1_78
 s_cmp_eq_u32 s4, 2
 s_waitcnt vmcnt(1)
 s_cbranch_scc1 Lq1_78
 s_waitcnt vmcnt(0)
Lq1_78:
 buffer_load_dwordx4 v[36:39], v3, s[20:23], s39 offen offset:0 sc1
 buffer_load_dwordx4 v[40:43], v3, s[20:23], s39 offen offset:1024 sc1
 s_nop 15
 s_nop 11
 buffer_load_dwordx4 v[12:15], v3, s[20:23], s39 offen offset:0 sc1
 buffer_load_dwordx4 v[16:19], v3, s[20:23], s39 offen offset:1024 sc1
 s_waitcnt vmcnt(3)
 v_mfma_f32_16x16x32_bf16 v[48:51], v[44:47], v[36:39], 0
 s_waitcnt vmcnt(2)
 v_mfma_f32_16x16x32_bf16 v[48:51], v[44:47], v[40:43], v[48:51]
 v_bitop3_b32 v55, v37, v39, s46 bitop3:0x7e
 v_bitop3_b32 v56, v41, v43, s46 bitop3:0x7e
 v_bitop3_b32 v55, v55, 1, v56 bitop3:0xc8
 v_cmp_ne_u32 vcc, 0, v55
 s_nop 3
 v_add_f32_dpp v48, v48, v48 row_ror:4 row_mask:0xf bank_mask:0xf
 v_add_f32_dpp v49, v49, v49 row_ror:4 row_mask:0xf bank_mask:0xf
 s_cbranch_vccnz Lr2_80
 v_add_f32_dpp v48, v48, v48 row_ror:8 row_mask:0xf bank_mask:0xf
 v_add_f32_dpp v49, v49, v49 row_ror:8 row_mask:0xf bank_mask:0xf
 v_cvt_pk_bf16_f32 v48, v48, v49
 buffer_store_dword v48, v52, s[20:23], s44 offen sc1
Lb1_81:
 buffer_store_dword v59, v52, s[20:23], s45 offen sc1
 v_cmp_gt_u32 vcc, s58, v1
 v_mov_b64 v[36:37], 0
 v_mov_b64 v[38:39], 0
 v_mov_b64 v[40:41], 0
 v_mov_b64 v[42:43], 0
 v_mov_b64 v[44:45], 0
 v_mov_b64 v[46:47], 0
 v_mov_b64 v[48:49], 0
 v_mov_b64 v[50:51], 0
 s_cmp_lg_u32 vcc_hi, 0
 s_cbranch_scc1 Lfw_83
Lfok_82:
 v_lshl_add_u32 v1, v3, 3, s68
 v_mov_b32 v6, s56
 v_cndmask_b32 v1, v6, v1, s[70:71]
 s_nop 15
 s_nop 3
 buffer_load_dwordx4 v[12:15], v3, s[20:23], s41 offen offset:0 sc1
 buffer_load_dwordx4 v[16:19], v3, s[20:23], s41 offen offset:1024 sc1
 s_nop 15
 s_nop 7
Lp2_84:
 buffer_load_dwordx4 v[12:15], v3, s[20:23], s41 offen offset:0 sc1
 buffer_load_dwordx4 v[16:19], v3, s[20:23], s41 offen offset:1024 sc1
 s_waitcnt vmcnt(2)
 v_max3_u32 v55, v12, v13, v14
 v_max3_u32 v55, v55, v15, v16
 v_max3_u32 v55, v55, v17, v18
 v_max_u32 v55, v55, v19
 ds_write_b128 v54, v[12:15] offset:0
 ds_write_b128 v54, v[16:19] offset:1024
 v_cmpx_eq_u32 vcc, -1, v55
 s_cbranch_execz Lstep_75
 buffer_load_dwordx4 v[12:15], v3, s[20:23], s41 offen offset:0 sc1
 buffer_load_dwordx4 v[16:19], v3, s[20:23], s41 offen offset:1024 sc1
 s_waitcnt vmcnt(2)
 v_max3_u32 v55, v12, v13, v14
 v_max3_u32 v55, v55, v15, v16
 v_max3_u32 v55, v55, v17, v18
 v_max_u32 v55, v55, v19
 ds_write_b128 v54, v[12:15] offset:0
 ds_write_b128 v54, v[16:19] offset:1024
 v_cmpx_eq_u32 vcc, -1, v55
 s_cbranch_execz Lstep_75
 buffer_load_dwordx4 v[12:15], v3, s[20:23], s41 offen offset:0 sc1
 buffer_load_dwordx4 v[16:19], v3, s[20:23], s41 offen offset:1024 sc1
 s_waitcnt vmcnt(2)
 v_max3_u32 v55, v12, v13, v14
 v_max3_u32 v55, v55, v15, v16
 v_max3_u32 v55, v55, v17, v18
 v_max_u32 v55, v55, v19
 ds_write_b128 v54, v[12:15] offset:0
 ds_write_b128 v54, v[16:19] offset:1024
 v_cmpx_eq_u32 vcc, -1, v55
 s_cbranch_execz Lstep_75
 s_sub_u32 s54, s54, 1
 s_cbranch_scc0 Lp2_84
 s_endpgm
LwH_77:
 v_bfe_u32 v53, v3, 8, 1
 v_bfe_u32 v58, v3, 9, 1
 v_lshl_or_b32 v53, v53, 1, v58
 v_bfe_u32 v58, v3, 5, 1
 v_lshl_or_b32 v53, v53, 1, v58
 v_and_b32 v58, 0xd0, v3
 v_lshlrev_b32 v58, 24, v58
 v_lshl_or_b32 v53, v53, 2, v58
 s_waitcnt vmcnt(2)
 buffer_load_dwordx4 v[20:23], v3, s[20:23], s40 offen offset:0 sc1
 buffer_load_dwordx4 v[24:27], v3, s[20:23], s40 offen offset:1024 sc1
 buffer_load_dwordx4 v[36:39], v3, s[20:23], s39 offen offset:0 sc1
 buffer_load_dwordx4 v[40:43], v3, s[20:23], s39 offen offset:1024 sc1
 v_mov_b32 v47, 0x3f80
 v_cndmask_b32 v47, v47, 1.0, s[32:33]
 v_cndmask_b32 v44, 0, v47, s[24:25]
 v_cndmask_b32 v45, 0, v47, s[26:27]
 v_cndmask_b32 v46, 0, v47, s[28:29]
 v_cndmask_b32 v47, 0, v47, s[30:31]
 v_bfe_u32 v52, v3, 8, 2
 v_bfe_u32 v58, v3, 2, 4
 v_lshl_or_b32 v52, v52, 4, v58
 v_and_b32 v58, 0xc0, v3
 v_lshl_or_b32 v52, v58, 24, v52
 v_subrev_u32 v0, 0x20000, v0
 v_mov_b32 v59, -1
 v_add_u32 v54, s42, v3
 v_add_u32 v58, s69, v9
 ds_read_b64_tr_b16 v[64:65], v58 offset:19456
 v_mov_b32 v66, v2
 v_mov_b32 v67, v4
 s_waitcnt vmcnt(2)
 v_mfma_f32_16x16x32_bf16 v[28:31], v[44:47], v[20:23], 0
 v_mfma_f32_16x16x32_bf16 v[28:31], v[44:47], v[24:27], v[28:31]
 s_waitcnt vmcnt(1)
 v_mfma_f32_16x16x32_bf16 v[48:51], v[44:47], v[36:39], 0
 s_waitcnt vmcnt(0)
 v_mfma_f32_16x16x32_bf16 v[48:51], v[44:47], v[40:43], v[48:51]
 v_bitop3_b32 v55, v37, v39, s46 bitop3:0x7e
 v_bitop3_b32 v56, v41, v43, s46 bitop3:0x7e
 v_bitop3_b32 v57, v21, v23, s46 bitop3:0x7e
 v_or3_b32 v55, v55, v56, v57
 v_bitop3_b32 v56, v25, v27, s46 bitop3:0x7e
 v_bitop3_b32 v55, v55, 1, v56 bitop3:0xc8
 v_cmp_ne_u32 vcc, 0, v55
 v_add_f32_dpp v29, v29, v29 row_ror:4 row_mask:0xf bank_mask:0xf
 v_add_f32_dpp v48, v48, v48 row_ror:4 row_mask:0xf bank_mask:0xf
 v_add_f32_dpp v49, v49, v49 row_ror:4 row_mask:0xf bank_mask:0xf
 v_add_f32_dpp v29, v29, v29 row_ror:8 row_mask:0xf bank_mask:0xf
 v_add_f32_dpp v48, v48, v48 row_ror:8 row_mask:0xf bank_mask:0xf
 v_add_f32_dpp v49, v49, v49 row_ror:8 row_mask:0xf bank_mask:0xf
 s_cbranch_vccnz Lr1_85
 v_cvt_pk_bf16_f32 v48, v48, v49
 buffer_store_dword v48, v52, s[20:23], s44 offen sc1
 v_mov_b32_dpp v30, v29 quad_perm:[1,0,3,2] row_mask:0xf bank_mask:0xf
 v_cvt_pk_bf16_f32 v29, v29, v30
 buffer_store_dword v29, v53, s[20:23], s65 offen sc1
Lb1_86:
 buffer_store_dword v59, v52, s[20:23], s45 offen sc1
 buffer_store_dword v59, v53, s[20:23], s66 offen sc1
 v_cmp_gt_u32 vcc, s58, v1
 ds_read_b128 v[20:23], v0 offset:24576
 ds_read_b128 v[24:27], v0 offset:28672
 ds_read_b128 v[28:31], v0 offset:32768
 ds_read_b128 v[32:35], v0 offset:36864
 v_mov_b64 v[36:37], 0
 v_mov_b64 v[38:39], 0
 v_mov_b64 v[40:41], 0
 v_mov_b64 v[42:43], 0
 v_mov_b64 v[44:45], 0
 v_mov_b64 v[46:47], 0
 v_mov_b64 v[48:49], 0
 v_mov_b64 v[50:51], 0
 s_cmp_lg_u32 vcc_hi, 0
 s_cbranch_scc1 Lfw_88
Lfok_87:
 v_lshl_add_u32 v1, v3, 3, s68
 v_mov_b32 v6, s56
 v_cndmask_b32 v1, v6, v1, s[70:71]
 s_nop 13
 buffer_load_dwordx4 v[12:15], v3, s[20:23], s41 offen offset:0 sc1
 buffer_load_dwordx4 v[16:19], v3, s[20:23], s41 offen offset:1024 sc1
 buffer_load_dwordx4 v[68:71], v3, s[20:23], s43 offen offset:0 sc1
 s_nop 15
 s_nop 7
Lp2_89:
 buffer_load_dwordx4 v[12:15], v3, s[20:23], s41 offen offset:0 sc1
 buffer_load_dwordx4 v[16:19], v3, s[20:23], s41 offen offset:1024 sc1
 buffer_load_dwordx4 v[68:71], v3, s[20:23], s43 offen offset:0 sc1
 s_waitcnt vmcnt(3)
 v_max3_u32 v55, v12, v13, v14
 v_max3_u32 v55, v55, v15, v16
 v_max3_u32 v55, v55, v17, v18
 v_max3_u32 v55, v55, v19, v68
 v_max3_u32 v55, v55, v69, v70
 v_max_u32 v55, v55, v71
 ds_write_b128 v54, v[12:15] offset:0
 ds_write_b128 v54, v[16:19] offset:1024
 ds_write_b128 v54, v[68:71] offset:8192
 v_cmpx_eq_u32 vcc, -1, v55
 s_cbranch_execz Lstep_75
 buffer_load_dwordx4 v[12:15], v3, s[20:23], s41 offen offset:0 sc1
 buffer_load_dwordx4 v[16:19], v3, s[20:23], s41 offen offset:1024 sc1
 buffer_load_dwordx4 v[68:71], v3, s[20:23], s43 offen offset:0 sc1
 s_waitcnt vmcnt(3)
 v_max3_u32 v55, v12, v13, v14
 v_max3_u32 v55, v55, v15, v16
 v_max3_u32 v55, v55, v17, v18
 v_max3_u32 v55, v55, v19, v68
 v_max3_u32 v55, v55, v69, v70
 v_max_u32 v55, v55, v71
 ds_write_b128 v54, v[12:15] offset:0
 ds_write_b128 v54, v[16:19] offset:1024
 ds_write_b128 v54, v[68:71] offset:8192
 v_cmpx_eq_u32 vcc, -1, v55
 s_cbranch_execz Lstep_75
 buffer_load_dwordx4 v[12:15], v3, s[20:23], s41 offen offset:0 sc1
 buffer_load_dwordx4 v[16:19], v3, s[20:23], s41 offen offset:1024 sc1
 buffer_load_dwordx4 v[68:71], v3, s[20:23], s43 offen offset:0 sc1
 s_waitcnt vmcnt(3)
 v_max3_u32 v55, v12, v13, v14
 v_max3_u32 v55, v55, v15, v16
 v_max3_u32 v55, v55, v17, v18
 v_max3_u32 v55, v55, v19, v68
 v_max3_u32 v55, v55, v69, v70
 v_max_u32 v55, v55, v71
 ds_write_b128 v54, v[12:15] offset:0
 ds_write_b128 v54, v[16:19] offset:1024
 ds_write_b128 v54, v[68:71] offset:8192
 v_cmpx_eq_u32 vcc, -1, v55
 s_cbranch_execz Lstep_75
 s_sub_u32 s54, s54, 1
 s_cbranch_scc0 Lp2_89
 s_endpgm
Lr1_85:
 s_mov_b64 exec, vcc
Lrt_90:
 buffer_load_dwordx4 v[20:23], v3, s[20:23], s40 offen offset:0 sc1
 buffer_load_dwordx4 v[24:27], v3, s[20:23], s40 offen offset:1024 sc1
 buffer_load_dwordx4 v[36:39], v3, s[20:23], s39 offen offset:0 sc1
 buffer_load_dwordx4 v[40:43], v3, s[20:23], s39 offen offset:1024 sc1
 s_waitcnt vmcnt(4)
 v_bitop3_b32 v55, v37, v39, s46 bitop3:0x7e
 v_bitop3_b32 v56, v41, v43, s46 bitop3:0x7e
 v_bitop3_b32 v57, v21, v23, s46 bitop3:0x7e
 v_or3_b32 v55, v55, v56, v57
 v_bitop3_b32 v56, v25, v27, s46 bitop3:0x7e
 v_bitop3_b32 v55, v55, 1, v56 bitop3:0xc8
 v_cmpx_ne_u32 vcc, 0, v55
 s_cbranch_execz Lrte_91
 buffer_load_dwordx4 v[20:23], v3, s[20:23], s40 offen offset:0 sc1
 buffer_load_dwordx4 v[24:27], v3, s[20:23], s40 offen offset:1024 sc1
 buffer_load_dwordx4 v[36:39], v3, s[20:23], s39 offen offset:0 sc1
 buffer_load_dwordx4 v[40:43], v3, s[20:23], s39 offen offset:1024 sc1
 s_waitcnt vmcnt(4)
 v_bitop3_b32 v55, v37, v39, s46 bitop3:0x7e
 v_bitop3_b32 v56, v41, v43, s46 bitop3:0x7e
 v_bitop3_b32 v57, v21, v23, s46 bitop3:0x7e
 v_or3_b32 v55, v55, v56, v57
 v_bitop3_b32 v56, v25, v27, s46 bitop3:0x7e
 v_bitop3_b32 v55, v55, 1, v56 bitop3:0xc8
 v_cmpx_ne_u32 vcc, 0, v55
 s_cbranch_execz Lrte_91
 buffer_load_dwordx4 v[20:23], v3, s[20:23], s40 offen offset:0 sc1
 buffer_load_dwordx4 v[24:27], v3, s[20:23], s40 offen offset:1024 sc1
 buffer_load_dwordx4 v[36:39], v3, s[20:23], s39 offen offset:0 sc1
 buffer_load_dwordx4 v[40:43], v3, s[20:23], s39 offen offset:1024 sc1
 s_waitcnt vmcnt(4)
 v_bitop3_b32 v55, v37, v39, s46 bitop3:0x7e
 v_bitop3_b32 v56, v41, v43, s46 bitop3:0x7e
 v_bitop3_b32 v57, v21, v23, s46 bitop3:0x7e
 v_or3_b32 v55, v55, v56, v57
 v_bitop3_b32 v56, v25, v27, s46 bitop3:0x7e
 v_bitop3_b32 v55, v55, 1, v56 bitop3:0xc8
 v_cmpx_ne_u32 vcc, 0, v55
 s_cbranch_execz Lrte_91
 s_sub_u32 s54, s54, 1
 s_cbranch_scc0 Lrt_90
 s_endpgm
Lrte_91:
 s_mov_b64 exec, -1
 s_nop 2
 v_mfma_f32_16x16x32_bf16 v[28:31], v[44:47], v[20:23], 0
 v_mfma_f32_16x16x32_bf16 v[28:31], v[44:47], v[24:27], v[28:31]
 v_mfma_f32_16x16x32_bf16 v[48:51], v[44:47], v[36:39], 0
 v_mfma_f32_16x16x32_bf16 v[48:51], v[44:47], v[40:43], v[48:51]
 s_nop 6
 v_add_f32_dpp v29, v29, v29 row_ror:4 row_mask:0xf bank_mask:0xf
 v_add_f32_dpp v48, v48, v48 row_ror:4 row_mask:0xf bank_mask:0xf
 v_add_f32_dpp v49, v49, v49 row_ror:4 row_mask:0xf bank_mask:0xf
 v_add_f32_dpp v29, v29, v29 row_ror:8 row_mask:0xf bank_mask:0xf
 v_add_f32_dpp v48, v48, v48 row_ror:8 row_mask:0xf bank_mask:0xf
 v_add_f32_dpp v49, v49, v49 row_ror:8 row_mask:0xf bank_mask:0xf
 v_cvt_pk_bf16_f32 v48, v48, v49
 buffer_store_dword v48, v52, s[20:23], s44 offen sc1
 v_mov_b32_dpp v30, v29 quad_perm:[1,0,3,2] row_mask:0xf bank_mask:0xf
 v_cvt_pk_bf16_f32 v29, v29, v30
 buffer_store_dword v29, v53, s[20:23], s65 offen sc1
 s_waitcnt vmcnt(2)
 s_branch Lb1_86
Lr2_80:
 s_waitcnt vmcnt(1)
 v_mfma_f32_16x16x32_bf16 v[48:51], v[44:47], v[12:15], 0
 s_waitcnt vmcnt(0)
 v_mfma_f32_16x16x32_bf16 v[48:51], v[44:47], v[16:19], v[48:51]
 v_bitop3_b32 v55, v13, v15, s46 bitop3:0x7e
 v_bitop3_b32 v56, v17, v19, s46 bitop3:0x7e
 v_bitop3_b32 v55, v55, 1, v56 bitop3:0xc8
 v_cmp_ne_u32 vcc, 0, v55
 s_nop 3
 v_add_f32_dpp v48, v48, v48 row_ror:4 row_mask:0xf bank_mask:0xf
 v_add_f32_dpp v49, v49, v49 row_ror:4 row_mask:0xf bank_mask:0xf
 s_cbranch_vccnz Lr1_79
 v_add_f32_dpp v48, v48, v48 row_ror:8 row_mask:0xf bank_mask:0xf
 v_add_f32_dpp v49, v49, v49 row_ror:8 row_mask:0xf bank_mask:0xf
 v_cvt_pk_bf16_f32 v48, v48, v49
 buffer_store_dword v48, v52, s[20:23], s44 offen sc1
 s_branch Lb1_81
Lr1_79:
 s_mov_b64 exec, vcc
Lrt_92:
 buffer_load_dwordx4 v[12:15], v3, s[20:23], s39 offen offset:0 sc1
 buffer_load_dwordx4 v[16:19], v3, s[20:23], s39 offen offset:1024 sc1
 s_waitcnt vmcnt(2)
 v_bitop3_b32 v55, v13, v15, s46 bitop3:0x7e
 v_bitop3_b32 v56, v17, v19, s46 bitop3:0x7e
 v_bitop3_b32 v55, v55, 1, v56 bitop3:0xc8
 v_cmpx_ne_u32 vcc, 0, v55
 s_cbranch_execz Lrte_93
 buffer_load_dwordx4 v[12:15], v3, s[20:23], s39 offen offset:0 sc1
 buffer_load_dwordx4 v[16:19], v3, s[20:23], s39 offen offset:1024 sc1
 s_waitcnt vmcnt(2)
 v_bitop3_b32 v55, v13, v15, s46 bitop3:0x7e
 v_bitop3_b32 v56, v17, v19, s46 bitop3:0x7e
 v_bitop3_b32 v55, v55, 1, v56 bitop3:0xc8
 v_cmpx_ne_u32 vcc, 0, v55
 s_cbranch_execz Lrte_93
 buffer_load_dwordx4 v[12:15], v3, s[20:23], s39 offen offset:0 sc1
 buffer_load_dwordx4 v[16:19], v3, s[20:23], s39 offen offset:1024 sc1
 s_waitcnt vmcnt(2)
 v_bitop3_b32 v55, v13, v15, s46 bitop3:0x7e
 v_bitop3_b32 v56, v17, v19, s46 bitop3:0x7e
 v_bitop3_b32 v55, v55, 1, v56 bitop3:0xc8
 v_cmpx_ne_u32 vcc, 0, v55
 s_cbranch_execz Lrte_93
 s_sub_u32 s54, s54, 1
 s_cbranch_scc0 Lrt_92
 s_endpgm
Lrte_93:
 s_mov_b64 exec, -1
 s_nop 2
 v_mfma_f32_16x16x32_bf16 v[48:51], v[44:47], v[12:15], 0
 v_mfma_f32_16x16x32_bf16 v[48:51], v[44:47], v[16:19], v[48:51]
 s_nop 7
 v_add_f32_dpp v48, v48, v48 row_ror:4 row_mask:0xf bank_mask:0xf
 v_add_f32_dpp v49, v49, v49 row_ror:4 row_mask:0xf bank_mask:0xf
 s_nop 0
 v_add_f32_dpp v48, v48, v48 row_ror:8 row_mask:0xf bank_mask:0xf
 v_add_f32_dpp v49, v49, v49 row_ror:8 row_mask:0xf bank_mask:0xf
 v_cvt_pk_bf16_f32 v48, v48, v49
 buffer_store_dword v48, v52, s[20:23], s44 offen sc1
 s_branch Lb1_81
Lfw_83:
Lpb_94:
 buffer_load_dword v1, v7, s[20:23], s56 offen sc1
 s_waitcnt vmcnt(0)
 v_cmp_le_u32 vcc, s58, v1
 s_cbranch_vccnz Lpbok_95
 s_sub_u32 s54, s54, 1
 s_cbranch_scc0 Lpb_94
 s_endpgm
Lpbok_95:
 s_branch Lfok_82
Lfw_88:
Lpb_96:
 buffer_load_dword v1, v7, s[20:23], s56 offen sc1
 s_waitcnt vmcnt(0)
 v_cmp_le_u32 vcc, s58, v1
 s_cbranch_vccnz Lpbok_97
 s_sub_u32 s54, s54, 1
 s_cbranch_scc0 Lpb_96
 s_endpgm
Lpbok_97:
 s_branch Lfok_87
Lfail_76:
 s_endpgm
Lchexit_51:
 s_add_u32 s38, s38, 0x20000
 v_add_u32 v6, s69, v9
 ds_read_b64_tr_b16 v[64:65], v6 offset:19456
 v_mov_b32 v66, v2
 v_mov_b32 v67, v4
 s_waitcnt lgkmcnt(0)
 buffer_store_dwordx4 v[64:67], v0, s[20:23], s38 offen sc1
 s_waitcnt vmcnt(0) lgkmcnt(0)
 s_barrier
 v_subrev_u32 v0, 0x10000, v0
 v_min_u32 v0, 16, v0
 v_lshlrev_b32 v0, 24, v0
 v_mov_b32 v6, 64
 buffer_store_dword v6, v0, s[20:23], s57 offen sc1
Lfin:
Lend:
 s_endpgm
.section .rodata,"a"
.p2align 6
.amdhsa_kernel concat_heads__compressed_kv_cla__memory_aug_recurrent_mem_tr__prompt_kernel
  .amdhsa_next_free_vgpr 512
  .amdhsa_next_free_sgpr 102
  .amdhsa_accum_offset 256
  .amdhsa_group_segment_fixed_size 0
  .amdhsa_kernarg_size 128
  .amdhsa_user_sgpr_count 2
  .amdhsa_user_sgpr_kernarg_segment_ptr 1
  .amdhsa_system_sgpr_workgroup_id_x 1
  .amdhsa_float_denorm_mode_32 3
.end_amdhsa_kernel
```

```asm
; @launch grid=(256,1,1) block=(256,1,1) lds=163840
.amdgcn_target "amdgcn-amd-amdhsa--gfx950"
.text
.globl concat_heads__compressed_kv_cla__memory_aug_recurrent_mem_tr__prompt_kernel
.p2align 8
.type concat_heads__compressed_kv_cla__memory_aug_recurrent_mem_tr__prompt_kernel,@function
concat_heads__compressed_kv_cla__memory_aug_recurrent_mem_tr__prompt_kernel:
 s_cmp_ge_u32 s2, 256
 s_cbranch_scc1 Lend
 s_load_dwordx2 s[20:21], s[0:1], 120
 s_mov_b32 s22, 0x10000000
 s_mov_b32 s23, 0x20000
 s_load_dwordx2 s[28:29], s[0:1], 112
 s_mov_b32 s30, 0x100
 s_mov_b32 s31, 0x20000
 v_lshrrev_b32 v1, 6, v0
 s_and_b32 s5, s2, 7
 s_lshr_b32 s6, s2, 3
 v_readfirstlane_b32 s4, v1
 s_lshl_b32 s5, s5, 2
 s_lshr_b32 s5, 0x37654120, s5
 s_and_b32 s5, s5, 7
 s_waitcnt lgkmcnt(0)
 s_cmp_eq_u32 s5, 0
 s_cbranch_scc1 Lchain
 s_cmp_eq_u32 s5, 1
 s_cbranch_scc1 Lpb
 s_cmp_lt_u32 s5, 4
 s_cbranch_scc1 Lqa
 s_load_dwordx2 s[8:9], s[0:1], 8
 s_mov_b32 s10, 0x200000
 s_mov_b32 s11, 0x20000
 s_load_dwordx2 s[12:13], s[0:1], 24
 s_mov_b32 s14, 0x400000
 s_mov_b32 s15, 0x20000
 s_load_dwordx2 s[16:17], s[0:1], 32
 s_mov_b32 s18, 0x400000
 s_mov_b32 s19, 0x20000
 s_sub_u32 s3, s5, 4
 s_lshl_b32 s3, s3, 3
 s_lshr_b32 s7, s6, 2
 s_add_u32 s3, s3, s7
 s_lshl_b32 s32, s3, 8
 s_mov_b32 s33, s32
 s_lshl_b32 s34, s3, 14
 s_add_u32 s34, s34, 0x1000000
 s_add_u32 s35, s34, 8192
 s_mov_b32 s36, 16
 s_and_b32 s37, s6, 3
 s_lshl_b32 s7, s3, 5
 s_add_u32 s7, s7, s37
 s_lshl_b32 s7, s7, 2
 s_add_u32 s7, s7, 0x2000
 v_min_u32 v1, 1, v0
 v_lshlrev_b32 v1, 28, v1
 v_add_u32 v13, s7, v1
 s_waitcnt lgkmcnt(0)
 v_and_b32 v1, 63, v0
 v_lshrrev_b32 v2, 3, v0
 v_mul_u32_u24 v10, 1024, v2
 v_lshrrev_b32 v2, 4, v0
 v_xor_b32 v2, v2, v0
 v_and_b32 v2, 7, v2
 v_lshl_add_u32 v10, v2, 4, v10
 v_lshrrev_b32 v2, 4, v1
 v_bfe_u32 v3, v1, 1, 3
 v_xor_b32 v2, v2, v3
 v_and_b32 v3, 15, v1
 v_lshlrev_b32 v3, 7, v3
 v_lshl_add_u32 v4, v2, 4, v3
 v_xor_b32 v5, 64, v4
 v_lshrrev_b32 v2, 4, v0
 v_lshlrev_b32 v11, 13, v2
 v_lshrrev_b32 v2, 7, v0
 v_lshrrev_b32 v3, 4, v1
 v_lshl_add_u32 v3, v2, 2, v3
 v_bfe_u32 v2, v1, 1, 3
 v_xor_b32 v2, v2, v3
 v_lshl_add_u32 v11, v2, 5, v11
 v_and_b32 v2, 1, v1
 v_lshl_add_u32 v11, v2, 4, v11
 v_bfe_u32 v2, v1, 2, 3
 v_xor_b32 v3, s4, v2
 v_lshlrev_b32 v3, 5, v3
 v_and_b32 v2, 3, v2
 v_lshl_add_u32 v3, v2, 8, v3
 v_lshrrev_b32 v2, 4, v1
 v_lshl_add_u32 v3, v2, 11, v3
 v_and_b32 v2, 3, v1
 v_lshl_add_u32 v3, v2, 3, v3
 v_add_u32 v8, 65536, v3
 v_xor_b32 v3, 0x80, v3
 v_add_u32 v9, 65536, v3
 s_lshl_b32 s45, s4, 11
 v_lshl_add_u32 v12, v1, 4, s45
 s_mov_b32 s39, s37
 s_add_u32 s40, s39, 4
 s_lshl_b32 s49, s4, 10
 s_mul_i32 s46, s39, 32768
 s_add_u32 m0, s49, 0
 s_nop 0
 buffer_load_dwordx4 v10, s[8:11], s46 offen offset:0  lds
 s_add_u32 m0, s49, 3968
 s_nop 0
 buffer_load_dwordx4 v10, s[8:11], s46 offen offset:128  lds
 s_add_u32 m0, s49, 7936
 s_nop 0
 buffer_load_dwordx4 v10, s[8:11], s46 offen offset:256  lds
 s_add_u32 m0, s49, 11904
 s_nop 0
 buffer_load_dwordx4 v10, s[8:11], s46 offen offset:384  lds
 s_add_u32 m0, s49, 15872
 s_nop 0
 buffer_load_dwordx4 v10, s[8:11], s46 offen offset:512  lds
 s_add_u32 m0, s49, 19840
 s_nop 0
 buffer_load_dwordx4 v10, s[8:11], s46 offen offset:640  lds
 s_add_u32 m0, s49, 23808
 s_nop 0
 buffer_load_dwordx4 v10, s[8:11], s46 offen offset:768  lds
 s_add_u32 m0, s49, 27776
 s_nop 0
 buffer_load_dwordx4 v10, s[8:11], s46 offen offset:896  lds
 s_lshl_b32 s49, s4, 10
 s_add_u32 s49, s49, 32768
 s_mul_i32 s46, s40, 32768
 s_add_u32 m0, s49, 0
 s_nop 0
 buffer_load_dwordx4 v10, s[8:11], s46 offen offset:0  lds
 s_add_u32 m0, s49, 3968
 s_nop 0
 buffer_load_dwordx4 v10, s[8:11], s46 offen offset:128  lds
 s_add_u32 m0, s49, 7936
 s_nop 0
 buffer_load_dwordx4 v10, s[8:11], s46 offen offset:256  lds
 s_add_u32 m0, s49, 11904
 s_nop 0
 buffer_load_dwordx4 v10, s[8:11], s46 offen offset:384  lds
 s_add_u32 m0, s49, 15872
 s_nop 0
 buffer_load_dwordx4 v10, s[8:11], s46 offen offset:512  lds
 s_add_u32 m0, s49, 19840
 s_nop 0
 buffer_load_dwordx4 v10, s[8:11], s46 offen offset:640  lds
 s_add_u32 m0, s49, 23808
 s_nop 0
 buffer_load_dwordx4 v10, s[8:11], s46 offen offset:768  lds
 s_add_u32 m0, s49, 27776
 s_nop 0
 buffer_load_dwordx4 v10, s[8:11], s46 offen offset:896  lds
 s_lshl_b32 s49, s4, 10
 s_add_u32 m0, s49, 65536
 s_add_u32 s45, s32, 0
 buffer_load_dwordx4 v11, s[12:15], s45 offen  lds
 s_add_u32 m0, s49, 69632
 s_add_u32 s45, s32, 131072
 buffer_load_dwordx4 v11, s[12:15], s45 offen  lds
 s_add_u32 m0, s49, 73728
 s_add_u32 s45, s33, 0
 buffer_load_dwordx4 v11, s[16:19], s45 offen  lds
 s_add_u32 m0, s49, 77824
 s_add_u32 s45, s33, 131072
 buffer_load_dwordx4 v11, s[16:19], s45 offen  lds
 s_add_u32 m0, s49, 81920
 s_add_u32 s45, s32, 262144
 buffer_load_dwordx4 v11, s[12:15], s45 offen  lds
 s_add_u32 m0, s49, 86016
 s_add_u32 s45, s32, 393216
 buffer_load_dwordx4 v11, s[12:15], s45 offen  lds
 s_add_u32 m0, s49, 90112
 s_add_u32 s45, s33, 262144
 buffer_load_dwordx4 v11, s[16:19], s45 offen  lds
 s_add_u32 m0, s49, 94208
 s_add_u32 s45, s33, 393216
 buffer_load_dwordx4 v11, s[16:19], s45 offen  lds
 s_add_u32 m0, s49, 98304
 s_add_u32 s45, s32, 524288
 buffer_load_dwordx4 v11, s[12:15], s45 offen  lds
 s_add_u32 m0, s49, 102400
 s_add_u32 s45, s32, 655360
 buffer_load_dwordx4 v11, s[12:15], s45 offen  lds
 s_add_u32 m0, s49, 106496
 s_add_u32 s45, s33, 524288
 buffer_load_dwordx4 v11, s[16:19], s45 offen  lds
 s_add_u32 m0, s49, 110592
 s_add_u32 s45, s33, 655360
 buffer_load_dwordx4 v11, s[16:19], s45 offen  lds
 s_waitcnt vmcnt(8) lgkmcnt(0)
 s_barrier
 s_add_u32 m0, s49, 114688
 s_add_u32 s45, s32, 786432
 buffer_load_dwordx4 v11, s[12:15], s45 offen  lds
 s_add_u32 m0, s49, 118784
 s_add_u32 s45, s32, 917504
 buffer_load_dwordx4 v11, s[12:15], s45 offen  lds
 s_add_u32 m0, s49, 122880
 s_add_u32 s45, s33, 786432
 buffer_load_dwordx4 v11, s[16:19], s45 offen  lds
 s_add_u32 m0, s49, 126976
 s_add_u32 s45, s33, 917504
 buffer_load_dwordx4 v11, s[16:19], s45 offen  lds
 ds_read_b64_tr_b16 a[0:1], v8 offset:0
 ds_read_b64_tr_b16 a[2:3], v8 offset:1024
 ds_read_b64_tr_b16 a[64:65], v9 offset:0
 ds_read_b64_tr_b16 a[66:67], v9 offset:1024
 ds_read_b64_tr_b16 a[128:129], v8 offset:8192
 ds_read_b64_tr_b16 a[130:131], v8 offset:9216
 ds_read_b64_tr_b16 a[192:193], v9 offset:8192
 ds_read_b64_tr_b16 a[194:195], v9 offset:9216
 s_waitcnt vmcnt(8) lgkmcnt(0)
 s_barrier
 s_add_u32 m0, s49, 65536
 s_add_u32 s45, s32, 1048576
 buffer_load_dwordx4 v11, s[12:15], s45 offen  lds
 s_add_u32 m0, s49, 69632
 s_add_u32 s45, s32, 1179648
 buffer_load_dwordx4 v11, s[12:15], s45 offen  lds
 s_add_u32 m0, s49, 73728
 s_add_u32 s45, s33, 1048576
 buffer_load_dwordx4 v11, s[16:19], s45 offen  lds
 s_add_u32 m0, s49, 77824
 s_add_u32 s45, s33, 1179648
 buffer_load_dwordx4 v11, s[16:19], s45 offen  lds
 ds_read_b64_tr_b16 a[4:5], v8 offset:16384
 ds_read_b64_tr_b16 a[6:7], v8 offset:17408
 ds_read_b64_tr_b16 a[68:69], v9 offset:16384
 ds_read_b64_tr_b16 a[70:71], v9 offset:17408
 ds_read_b64_tr_b16 a[132:133], v8 offset:24576
 ds_read_b64_tr_b16 a[134:135], v8 offset:25600
 ds_read_b64_tr_b16 a[196:197], v9 offset:24576
 ds_read_b64_tr_b16 a[198:199], v9 offset:25600
 s_waitcnt vmcnt(8) lgkmcnt(0)
 s_barrier
 s_add_u32 m0, s49, 81920
 s_add_u32 s45, s32, 1310720
 buffer_load_dwordx4 v11, s[12:15], s45 offen  lds
 s_add_u32 m0, s49, 86016
 s_add_u32 s45, s32, 1441792
 buffer_load_dwordx4 v11, s[12:15], s45 offen  lds
 s_add_u32 m0, s49, 90112
 s_add_u32 s45, s33, 1310720
 buffer_load_dwordx4 v11, s[16:19], s45 offen  lds
 s_add_u32 m0, s49, 94208
 s_add_u32 s45, s33, 1441792
 buffer_load_dwordx4 v11, s[16:19], s45 offen  lds
 ds_read_b64_tr_b16 a[8:9], v8 offset:32768
 ds_read_b64_tr_b16 a[10:11], v8 offset:33792
 ds_read_b64_tr_b16 a[72:73], v9 offset:32768
 ds_read_b64_tr_b16 a[74:75], v9 offset:33792
 ds_read_b64_tr_b16 a[136:137], v8 offset:40960
 ds_read_b64_tr_b16 a[138:139], v8 offset:41984
 ds_read_b64_tr_b16 a[200:201], v9 offset:40960
 ds_read_b64_tr_b16 a[202:203], v9 offset:41984
 s_waitcnt vmcnt(8) lgkmcnt(0)
 s_barrier
 s_add_u32 m0, s49, 98304
 s_add_u32 s45, s32, 1572864
 buffer_load_dwordx4 v11, s[12:15], s45 offen  lds
 s_add_u32 m0, s49, 102400
 s_add_u32 s45, s32, 1703936
 buffer_load_dwordx4 v11, s[12:15], s45 offen  lds
 s_add_u32 m0, s49, 106496
 s_add_u32 s45, s33, 1572864
 buffer_load_dwordx4 v11, s[16:19], s45 offen  lds
 s_add_u32 m0, s49, 110592
 s_add_u32 s45, s33, 1703936
 buffer_load_dwordx4 v11, s[16:19], s45 offen  lds
 ds_read_b64_tr_b16 a[12:13], v8 offset:49152
 ds_read_b64_tr_b16 a[14:15], v8 offset:50176
 ds_read_b64_tr_b16 a[76:77], v9 offset:49152
 ds_read_b64_tr_b16 a[78:79], v9 offset:50176
 ds_read_b64_tr_b16 a[140:141], v8 offset:57344
 ds_read_b64_tr_b16 a[142:143], v8 offset:58368
 ds_read_b64_tr_b16 a[204:205], v9 offset:57344
 ds_read_b64_tr_b16 a[206:207], v9 offset:58368
 s_waitcnt vmcnt(8) lgkmcnt(0)
 s_barrier
 s_add_u32 m0, s49, 114688
 s_add_u32 s45, s32, 1835008
 buffer_load_dwordx4 v11, s[12:15], s45 offen  lds
 s_add_u32 m0, s49, 118784
 s_add_u32 s45, s32, 1966080
 buffer_load_dwordx4 v11, s[12:15], s45 offen  lds
 s_add_u32 m0, s49, 122880
 s_add_u32 s45, s33, 1835008
 buffer_load_dwordx4 v11, s[16:19], s45 offen  lds
 s_add_u32 m0, s49, 126976
 s_add_u32 s45, s33, 1966080
 buffer_load_dwordx4 v11, s[16:19], s45 offen  lds
 ds_read_b64_tr_b16 a[16:17], v8 offset:0
 ds_read_b64_tr_b16 a[18:19], v8 offset:1024
 ds_read_b64_tr_b16 a[80:81], v9 offset:0
 ds_read_b64_tr_b16 a[82:83], v9 offset:1024
 ds_read_b64_tr_b16 a[144:145], v8 offset:8192
 ds_read_b64_tr_b16 a[146:147], v8 offset:9216
 ds_read_b64_tr_b16 a[208:209], v9 offset:8192
 ds_read_b64_tr_b16 a[210:211], v9 offset:9216
 s_waitcnt vmcnt(8) lgkmcnt(0)
 s_barrier
 s_add_u32 m0, s49, 65536
 s_add_u32 s45, s32, 2097152
 buffer_load_dwordx4 v11, s[12:15], s45 offen  lds
 s_add_u32 m0, s49, 69632
 s_add_u32 s45, s32, 2228224
 buffer_load_dwordx4 v11, s[12:15], s45 offen  lds
 s_add_u32 m0, s49, 73728
 s_add_u32 s45, s33, 2097152
 buffer_load_dwordx4 v11, s[16:19], s45 offen  lds
 s_add_u32 m0, s49, 77824
 s_add_u32 s45, s33, 2228224
 buffer_load_dwordx4 v11, s[16:19], s45 offen  lds
 ds_read_b64_tr_b16 a[20:21], v8 offset:16384
 ds_read_b64_tr_b16 a[22:23], v8 offset:17408
 ds_read_b64_tr_b16 a[84:85], v9 offset:16384
 ds_read_b64_tr_b16 a[86:87], v9 offset:17408
 ds_read_b64_tr_b16 a[148:149], v8 offset:24576
 ds_read_b64_tr_b16 a[150:151], v8 offset:25600
 ds_read_b64_tr_b16 a[212:213], v9 offset:24576
 ds_read_b64_tr_b16 a[214:215], v9 offset:25600
 s_waitcnt vmcnt(8) lgkmcnt(0)
 s_barrier
 s_add_u32 m0, s49, 81920
 s_add_u32 s45, s32, 2359296
 buffer_load_dwordx4 v11, s[12:15], s45 offen  lds
 s_add_u32 m0, s49, 86016
 s_add_u32 s45, s32, 2490368
 buffer_load_dwordx4 v11, s[12:15], s45 offen  lds
 s_add_u32 m0, s49, 90112
 s_add_u32 s45, s33, 2359296
 buffer_load_dwordx4 v11, s[16:19], s45 offen  lds
 s_add_u32 m0, s49, 94208
 s_add_u32 s45, s33, 2490368
 buffer_load_dwordx4 v11, s[16:19], s45 offen  lds
 ds_read_b64_tr_b16 a[24:25], v8 offset:32768
 ds_read_b64_tr_b16 a[26:27], v8 offset:33792
 ds_read_b64_tr_b16 a[88:89], v9 offset:32768
 ds_read_b64_tr_b16 a[90:91], v9 offset:33792
 ds_read_b64_tr_b16 a[152:153], v8 offset:40960
 ds_read_b64_tr_b16 a[154:155], v8 offset:41984
 ds_read_b64_tr_b16 a[216:217], v9 offset:40960
 ds_read_b64_tr_b16 a[218:219], v9 offset:41984
 s_waitcnt vmcnt(8) lgkmcnt(0)
 s_barrier
 s_add_u32 m0, s49, 98304
 s_add_u32 s45, s32, 2621440
 buffer_load_dwordx4 v11, s[12:15], s45 offen  lds
 s_add_u32 m0, s49, 102400
 s_add_u32 s45, s32, 2752512
 buffer_load_dwordx4 v11, s[12:15], s45 offen  lds
 s_add_u32 m0, s49, 106496
 s_add_u32 s45, s33, 2621440
 buffer_load_dwordx4 v11, s[16:19], s45 offen  lds
 s_add_u32 m0, s49, 110592
 s_add_u32 s45, s33, 2752512
 buffer_load_dwordx4 v11, s[16:19], s45 offen  lds
 ds_read_b64_tr_b16 a[28:29], v8 offset:49152
 ds_read_b64_tr_b16 a[30:31], v8 offset:50176
 ds_read_b64_tr_b16 a[92:93], v9 offset:49152
 ds_read_b64_tr_b16 a[94:95], v9 offset:50176
 ds_read_b64_tr_b16 a[156:157], v8 offset:57344
 ds_read_b64_tr_b16 a[158:159], v8 offset:58368
 ds_read_b64_tr_b16 a[220:221], v9 offset:57344
 ds_read_b64_tr_b16 a[222:223], v9 offset:58368
 s_waitcnt vmcnt(8) lgkmcnt(0)
 s_barrier
 s_add_u32 m0, s49, 114688
 s_add_u32 s45, s32, 2883584
 buffer_load_dwordx4 v11, s[12:15], s45 offen  lds
 s_add_u32 m0, s49, 118784
 s_add_u32 s45, s32, 3014656
 buffer_load_dwordx4 v11, s[12:15], s45 offen  lds
 s_add_u32 m0, s49, 122880
 s_add_u32 s45, s33, 2883584
 buffer_load_dwordx4 v11, s[16:19], s45 offen  lds
 s_add_u32 m0, s49, 126976
 s_add_u32 s45, s33, 3014656
 buffer_load_dwordx4 v11, s[16:19], s45 offen  lds
 ds_read_b64_tr_b16 a[32:33], v8 offset:0
 ds_read_b64_tr_b16 a[34:35], v8 offset:1024
 ds_read_b64_tr_b16 a[96:97], v9 offset:0
 ds_read_b64_tr_b16 a[98:99], v9 offset:1024
 ds_read_b64_tr_b16 a[160:161], v8 offset:8192
 ds_read_b64_tr_b16 a[162:163], v8 offset:9216
 ds_read_b64_tr_b16 a[224:225], v9 offset:8192
 ds_read_b64_tr_b16 a[226:227], v9 offset:9216
 s_waitcnt vmcnt(8) lgkmcnt(0)
 s_barrier
 s_add_u32 m0, s49, 65536
 s_add_u32 s45, s32, 3145728
 buffer_load_dwordx4 v11, s[12:15], s45 offen  lds
 s_add_u32 m0, s49, 69632
 s_add_u32 s45, s32, 3276800
 buffer_load_dwordx4 v11, s[12:15], s45 offen  lds
 s_add_u32 m0, s49, 73728
 s_add_u32 s45, s33, 3145728
 buffer_load_dwordx4 v11, s[16:19], s45 offen  lds
 s_add_u32 m0, s49, 77824
 s_add_u32 s45, s33, 3276800
 buffer_load_dwordx4 v11, s[16:19], s45 offen  lds
 ds_read_b64_tr_b16 a[36:37], v8 offset:16384
 ds_read_b64_tr_b16 a[38:39], v8 offset:17408
 ds_read_b64_tr_b16 a[100:101], v9 offset:16384
 ds_read_b64_tr_b16 a[102:103], v9 offset:17408
 ds_read_b64_tr_b16 a[164:165], v8 offset:24576
 ds_read_b64_tr_b16 a[166:167], v8 offset:25600
 ds_read_b64_tr_b16 a[228:229], v9 offset:24576
 ds_read_b64_tr_b16 a[230:231], v9 offset:25600
 s_waitcnt vmcnt(8) lgkmcnt(0)
 s_barrier
 s_add_u32 m0, s49, 81920
 s_add_u32 s45, s32, 3407872
 buffer_load_dwordx4 v11, s[12:15], s45 offen  lds
 s_add_u32 m0, s49, 86016
 s_add_u32 s45, s32, 3538944
 buffer_load_dwordx4 v11, s[12:15], s45 offen  lds
 s_add_u32 m0, s49, 90112
 s_add_u32 s45, s33, 3407872
 buffer_load_dwordx4 v11, s[16:19], s45 offen  lds
 s_add_u32 m0, s49, 94208
 s_add_u32 s45, s33, 3538944
 buffer_load_dwordx4 v11, s[16:19], s45 offen  lds
 ds_read_b64_tr_b16 a[40:41], v8 offset:32768
 ds_read_b64_tr_b16 a[42:43], v8 offset:33792
 ds_read_b64_tr_b16 a[104:105], v9 offset:32768
 ds_read_b64_tr_b16 a[106:107], v9 offset:33792
 ds_read_b64_tr_b16 a[168:169], v8 offset:40960
 ds_read_b64_tr_b16 a[170:171], v8 offset:41984
 ds_read_b64_tr_b16 a[232:233], v9 offset:40960
 ds_read_b64_tr_b16 a[234:235], v9 offset:41984
 s_waitcnt vmcnt(8) lgkmcnt(0)
 s_barrier
 s_add_u32 m0, s49, 98304
 s_add_u32 s45, s32, 3670016
 buffer_load_dwordx4 v11, s[12:15], s45 offen  lds
 s_add_u32 m0, s49, 102400
 s_add_u32 s45, s32, 3801088
 buffer_load_dwordx4 v11, s[12:15], s45 offen  lds
 s_add_u32 m0, s49, 106496
 s_add_u32 s45, s33, 3670016
 buffer_load_dwordx4 v11, s[16:19], s45 offen  lds
 s_add_u32 m0, s49, 110592
 s_add_u32 s45, s33, 3801088
 buffer_load_dwordx4 v11, s[16:19], s45 offen  lds
 ds_read_b64_tr_b16 a[44:45], v8 offset:49152
 ds_read_b64_tr_b16 a[46:47], v8 offset:50176
 ds_read_b64_tr_b16 a[108:109], v9 offset:49152
 ds_read_b64_tr_b16 a[110:111], v9 offset:50176
 ds_read_b64_tr_b16 a[172:173], v8 offset:57344
 ds_read_b64_tr_b16 a[174:175], v8 offset:58368
 ds_read_b64_tr_b16 a[236:237], v9 offset:57344
 ds_read_b64_tr_b16 a[238:239], v9 offset:58368
 s_waitcnt vmcnt(8) lgkmcnt(0)
 s_barrier
 s_add_u32 m0, s49, 114688
 s_add_u32 s45, s32, 3932160
 buffer_load_dwordx4 v11, s[12:15], s45 offen  lds
 s_add_u32 m0, s49, 118784
 s_add_u32 s45, s32, 4063232
 buffer_load_dwordx4 v11, s[12:15], s45 offen  lds
 s_add_u32 m0, s49, 122880
 s_add_u32 s45, s33, 3932160
 buffer_load_dwordx4 v11, s[16:19], s45 offen  lds
 s_add_u32 m0, s49, 126976
 s_add_u32 s45, s33, 4063232
 buffer_load_dwordx4 v11, s[16:19], s45 offen  lds
 ds_read_b64_tr_b16 a[48:49], v8 offset:0
 ds_read_b64_tr_b16 a[50:51], v8 offset:1024
 ds_read_b64_tr_b16 a[112:113], v9 offset:0
 ds_read_b64_tr_b16 a[114:115], v9 offset:1024
 ds_read_b64_tr_b16 a[176:177], v8 offset:8192
 ds_read_b64_tr_b16 a[178:179], v8 offset:9216
 ds_read_b64_tr_b16 a[240:241], v9 offset:8192
 ds_read_b64_tr_b16 a[242:243], v9 offset:9216
 s_waitcnt vmcnt(8) lgkmcnt(0)
 s_barrier
 ds_read_b64_tr_b16 a[52:53], v8 offset:16384
 ds_read_b64_tr_b16 a[54:55], v8 offset:17408
 ds_read_b64_tr_b16 a[116:117], v9 offset:16384
 ds_read_b64_tr_b16 a[118:119], v9 offset:17408
 ds_read_b64_tr_b16 a[180:181], v8 offset:24576
 ds_read_b64_tr_b16 a[182:183], v8 offset:25600
 ds_read_b64_tr_b16 a[244:245], v9 offset:24576
 ds_read_b64_tr_b16 a[246:247], v9 offset:25600
 s_waitcnt vmcnt(4) lgkmcnt(0)
 s_barrier
 ds_read_b64_tr_b16 a[56:57], v8 offset:32768
 ds_read_b64_tr_b16 a[58:59], v8 offset:33792
 ds_read_b64_tr_b16 a[120:121], v9 offset:32768
 ds_read_b64_tr_b16 a[122:123], v9 offset:33792
 ds_read_b64_tr_b16 a[184:185], v8 offset:40960
 ds_read_b64_tr_b16 a[186:187], v8 offset:41984
 ds_read_b64_tr_b16 a[248:249], v9 offset:40960
 ds_read_b64_tr_b16 a[250:251], v9 offset:41984
 s_waitcnt vmcnt(0) lgkmcnt(0)
 s_barrier
 ds_read_b64_tr_b16 a[60:61], v8 offset:49152
 ds_read_b64_tr_b16 a[62:63], v8 offset:50176
 ds_read_b64_tr_b16 a[124:125], v9 offset:49152
 ds_read_b64_tr_b16 a[126:127], v9 offset:50176
 ds_read_b64_tr_b16 a[188:189], v8 offset:57344
 ds_read_b64_tr_b16 a[190:191], v8 offset:58368
 ds_read_b64_tr_b16 a[252:253], v9 offset:57344
 ds_read_b64_tr_b16 a[254:255], v9 offset:58368
 s_mov_b32 s50, 0x3e0293ee
 s_mov_b32 s42, 0
 s_mov_b32 s43, 0
 s_mov_b32 s44, 65536
 v_mov_b32 v6, v4
 v_mov_b32 v7, v5
 s_mov_b32 s95, 0x40000
 s_cmp_lg_u32 s4, 0
 s_cbranch_scc1 Lfrk_2
 v_min_u32 v21, 1, v0
 v_lshlrev_b32 v21, 28, v21
Lfr_1:
 buffer_load_dword v20, v21, s[28:31], 0 offen offset:0 sc1
 s_waitcnt vmcnt(0)
 v_cmp_eq_u32 vcc, 1, v20
 s_cbranch_vccnz Lfrk_2
 s_sub_u32 s95, s95, 1
 s_cbranch_scc0 Lfr_1
 s_endpgm
Lfrk_2:
 s_lshl_b32 s47, s2, 13
 s_add_u32 s47, s47, 0x8000000
 s_mov_b32 s48, s47
 v_mov_b32 v14, 0
 s_waitcnt vmcnt(0) lgkmcnt(0)
 s_barrier
 ds_read_b128 v[32:35], v6 offset:0
 ds_read_b128 v[36:39], v6 offset:2048
 ds_read_b128 v[40:43], v7 offset:0
 ds_read_b128 v[44:47], v7 offset:2048
 v_lshlrev_b32 v1, 12, v0
 s_lshl_b32 s45, s6, 7
 buffer_load_dword v15, v1, s[8:11], s45 offen
 v_add_u32 v1, 0x100000, v1
 buffer_load_dword v15, v1, s[8:11], s45 offen
 v_add_u32 v1, 0x100000, v1
 s_waitcnt lgkmcnt(2)
Lps_loop_3:
 v_mfma_f32_16x16x32_bf16 v[64:67], a[0:3], v[32:35], 0
 ds_read_b128 v[48:51], v6 offset:4096
 v_mfma_f32_16x16x32_bf16 v[72:75], a[64:67], v[32:35], 0
 ds_read_b128 v[52:55], v6 offset:6144
 v_mfma_f32_16x16x32_bf16 v[80:83], v[32:35], a[128:131], 0
 s_add_u32 s41, s40, 4
 v_mfma_f32_16x16x32_bf16 v[88:91], v[32:35], a[192:195], 0
 s_add_u32 s45, s42, 2
 s_mul_i32 s46, s41, 32768
 v_mfma_f32_16x16x32_bf16 v[68:71], a[0:3], v[36:39], 0
 s_cmp_lt_u32 s45, s36
 s_cselect_b32 s46, s46, 0
 v_mfma_f32_16x16x32_bf16 v[76:79], a[64:67], v[36:39], 0
 s_lshl_b32 s49, s4, 10
 s_add_u32 s49, s49, s44
 v_mfma_f32_16x16x32_bf16 v[84:87], v[36:39], a[128:131], 0
 v_mfma_f32_16x16x32_bf16 v[92:95], v[36:39], a[192:195], 0
 s_waitcnt lgkmcnt(2)
 v_mfma_f32_16x16x32_bf16 v[64:67], a[4:7], v[40:43], v[64:67]
 ds_read_b128 v[56:59], v7 offset:4096
 v_mfma_f32_16x16x32_bf16 v[72:75], a[68:71], v[40:43], v[72:75]
 ds_read_b128 v[60:63], v7 offset:6144
 v_mfma_f32_16x16x32_bf16 v[80:83], v[40:43], a[132:135], v[80:83]
 s_add_u32 m0, s49, 0
 v_mfma_f32_16x16x32_bf16 v[88:91], v[40:43], a[196:199], v[88:91]
 buffer_load_dwordx4 v10, s[8:11], s46 offen offset:0  lds
 v_mfma_f32_16x16x32_bf16 v[68:71], a[4:7], v[44:47], v[68:71]
 s_add_u32 m0, s49, 3968
 v_mfma_f32_16x16x32_bf16 v[76:79], a[68:71], v[44:47], v[76:79]
 buffer_load_dwordx4 v10, s[8:11], s46 offen offset:128  lds
 v_mfma_f32_16x16x32_bf16 v[84:87], v[44:47], a[132:135], v[84:87]
 v_mfma_f32_16x16x32_bf16 v[92:95], v[44:47], a[196:199], v[92:95]
 s_waitcnt lgkmcnt(2)
 v_mfma_f32_16x16x32_bf16 v[64:67], a[8:11], v[48:51], v[64:67]
 ds_read_b128 v[32:35], v6 offset:8192
 v_mfma_f32_16x16x32_bf16 v[72:75], a[72:75], v[48:51], v[72:75]
 ds_read_b128 v[36:39], v6 offset:10240
 v_mfma_f32_16x16x32_bf16 v[80:83], v[48:51], a[136:139], v[80:83]
 s_add_u32 m0, s49, 7936
 v_mfma_f32_16x16x32_bf16 v[88:91], v[48:51], a[200:203], v[88:91]
 buffer_load_dwordx4 v10, s[8:11], s46 offen offset:256  lds
 v_mfma_f32_16x16x32_bf16 v[68:71], a[8:11], v[52:55], v[68:71]
 s_add_u32 m0, s49, 11904
 v_mfma_f32_16x16x32_bf16 v[76:79], a[72:75], v[52:55], v[76:79]
 buffer_load_dwordx4 v10, s[8:11], s46 offen offset:384  lds
 v_mfma_f32_16x16x32_bf16 v[84:87], v[52:55], a[136:139], v[84:87]
 v_mfma_f32_16x16x32_bf16 v[92:95], v[52:55], a[200:203], v[92:95]
 s_waitcnt lgkmcnt(2)
 v_mfma_f32_16x16x32_bf16 v[64:67], a[12:15], v[56:59], v[64:67]
 ds_read_b128 v[40:43], v7 offset:8192
 v_mfma_f32_16x16x32_bf16 v[72:75], a[76:79], v[56:59], v[72:75]
 ds_read_b128 v[44:47], v7 offset:10240
 v_mfma_f32_16x16x32_bf16 v[80:83], v[56:59], a[140:143], v[80:83]
 s_add_u32 m0, s49, 15872
 v_mfma_f32_16x16x32_bf16 v[88:91], v[56:59], a[204:207], v[88:91]
 buffer_load_dwordx4 v10, s[8:11], s46 offen offset:512  lds
 v_mfma_f32_16x16x32_bf16 v[68:71], a[12:15], v[60:63], v[68:71]
 s_add_u32 m0, s49, 19840
 v_mfma_f32_16x16x32_bf16 v[76:79], a[76:79], v[60:63], v[76:79]
 buffer_load_dwordx4 v10, s[8:11], s46 offen offset:640  lds
 v_mfma_f32_16x16x32_bf16 v[84:87], v[60:63], a[140:143], v[84:87]
 v_mfma_f32_16x16x32_bf16 v[92:95], v[60:63], a[204:207], v[92:95]
 s_waitcnt lgkmcnt(2)
 v_mfma_f32_16x16x32_bf16 v[64:67], a[16:19], v[32:35], v[64:67]
 ds_read_b128 v[48:51], v6 offset:12288
 v_mfma_f32_16x16x32_bf16 v[72:75], a[80:83], v[32:35], v[72:75]
 ds_read_b128 v[52:55], v6 offset:14336
 v_mfma_f32_16x16x32_bf16 v[80:83], v[32:35], a[144:147], v[80:83]
 s_add_u32 m0, s49, 23808
 v_mfma_f32_16x16x32_bf16 v[88:91], v[32:35], a[208:211], v[88:91]
 buffer_load_dwordx4 v10, s[8:11], s46 offen offset:768  lds
 v_mfma_f32_16x16x32_bf16 v[68:71], a[16:19], v[36:39], v[68:71]
 s_add_u32 m0, s49, 27776
 v_mfma_f32_16x16x32_bf16 v[76:79], a[80:83], v[36:39], v[76:79]
 buffer_load_dwordx4 v10, s[8:11], s46 offen offset:896  lds
 v_mfma_f32_16x16x32_bf16 v[84:87], v[36:39], a[144:147], v[84:87]
 v_mfma_f32_16x16x32_bf16 v[92:95], v[36:39], a[208:211], v[92:95]
 s_waitcnt lgkmcnt(2)
 v_mfma_f32_16x16x32_bf16 v[64:67], a[20:23], v[40:43], v[64:67]
 ds_read_b128 v[56:59], v7 offset:12288
 v_mfma_f32_16x16x32_bf16 v[72:75], a[84:87], v[40:43], v[72:75]
 ds_read_b128 v[60:63], v7 offset:14336
 v_mfma_f32_16x16x32_bf16 v[80:83], v[40:43], a[148:151], v[80:83]
 v_mfma_f32_16x16x32_bf16 v[88:91], v[40:43], a[212:215], v[88:91]
 v_mfma_f32_16x16x32_bf16 v[68:71], a[20:23], v[44:47], v[68:71]
 v_mfma_f32_16x16x32_bf16 v[76:79], a[84:87], v[44:47], v[76:79]
 v_mfma_f32_16x16x32_bf16 v[84:87], v[44:47], a[148:151], v[84:87]
 v_mfma_f32_16x16x32_bf16 v[92:95], v[44:47], a[212:215], v[92:95]
 s_waitcnt lgkmcnt(2)
 v_mfma_f32_16x16x32_bf16 v[64:67], a[24:27], v[48:51], v[64:67]
 ds_read_b128 v[32:35], v6 offset:16384
 v_mfma_f32_16x16x32_bf16 v[72:75], a[88:91], v[48:51], v[72:75]
 ds_read_b128 v[36:39], v6 offset:18432
 v_mfma_f32_16x16x32_bf16 v[80:83], v[48:51], a[152:155], v[80:83]
 v_cvt_pk_bf16_f32 v16, v96, v97
 v_mfma_f32_16x16x32_bf16 v[88:91], v[48:51], a[216:219], v[88:91]
 v_cvt_pk_bf16_f32 v17, v104, v105
 v_mfma_f32_16x16x32_bf16 v[68:71], a[24:27], v[52:55], v[68:71]
 v_mfma_f32_16x16x32_bf16 v[76:79], a[88:91], v[52:55], v[76:79]
 v_cvt_pk_bf16_f32 v18, v98, v99
 v_mfma_f32_16x16x32_bf16 v[84:87], v[52:55], a[152:155], v[84:87]
 v_mfma_f32_16x16x32_bf16 v[92:95], v[52:55], a[216:219], v[92:95]
 s_waitcnt lgkmcnt(2)
 v_mfma_f32_16x16x32_bf16 v[64:67], a[28:31], v[56:59], v[64:67]
 ds_read_b128 v[40:43], v7 offset:16384
 v_mfma_f32_16x16x32_bf16 v[72:75], a[92:95], v[56:59], v[72:75]
 ds_read_b128 v[44:47], v7 offset:18432
 v_mfma_f32_16x16x32_bf16 v[80:83], v[56:59], a[156:159], v[80:83]
 v_cvt_pk_bf16_f32 v19, v106, v107
 v_mfma_f32_16x16x32_bf16 v[88:91], v[56:59], a[220:223], v[88:91]
 v_mfma_f32_16x16x32_bf16 v[68:71], a[28:31], v[60:63], v[68:71]
 buffer_store_dwordx4 v[16:19], v12, s[20:23], s47 offen offset:0 sc1
 v_mfma_f32_16x16x32_bf16 v[76:79], a[92:95], v[60:63], v[76:79]
 v_cvt_pk_bf16_f32 v20, v100, v101
 v_mfma_f32_16x16x32_bf16 v[84:87], v[60:63], a[156:159], v[84:87]
 v_mfma_f32_16x16x32_bf16 v[92:95], v[60:63], a[220:223], v[92:95]
 s_waitcnt lgkmcnt(2)
 v_mfma_f32_16x16x32_bf16 v[64:67], a[32:35], v[32:35], v[64:67]
 ds_read_b128 v[48:51], v6 offset:20480
 v_mfma_f32_16x16x32_bf16 v[72:75], a[96:99], v[32:35], v[72:75]
 ds_read_b128 v[52:55], v6 offset:22528
 v_mfma_f32_16x16x32_bf16 v[80:83], v[32:35], a[160:163], v[80:83]
 v_cvt_pk_bf16_f32 v21, v108, v109
 v_mfma_f32_16x16x32_bf16 v[88:91], v[32:35], a[224:227], v[88:91]
 v_mfma_f32_16x16x32_bf16 v[68:71], a[32:35], v[36:39], v[68:71]
 v_cvt_pk_bf16_f32 v22, v102, v103
 v_mfma_f32_16x16x32_bf16 v[76:79], a[96:99], v[36:39], v[76:79]
 v_mfma_f32_16x16x32_bf16 v[84:87], v[36:39], a[160:163], v[84:87]
 v_cvt_pk_bf16_f32 v23, v110, v111
 v_mfma_f32_16x16x32_bf16 v[92:95], v[36:39], a[224:227], v[92:95]
 s_waitcnt lgkmcnt(2)
 v_mfma_f32_16x16x32_bf16 v[64:67], a[36:39], v[40:43], v[64:67]
 ds_read_b128 v[56:59], v7 offset:20480
 v_mfma_f32_16x16x32_bf16 v[72:75], a[100:103], v[40:43], v[72:75]
 ds_read_b128 v[60:63], v7 offset:22528
 v_mfma_f32_16x16x32_bf16 v[80:83], v[40:43], a[164:167], v[80:83]
 buffer_store_dwordx4 v[20:23], v12, s[20:23], s47 offen offset:1024 sc1
 v_mfma_f32_16x16x32_bf16 v[88:91], v[40:43], a[228:231], v[88:91]
 v_mfma_f32_16x16x32_bf16 v[68:71], a[36:39], v[44:47], v[68:71]
 v_cvt_pk_bf16_f32 v24, v112, v113
 v_mfma_f32_16x16x32_bf16 v[76:79], a[100:103], v[44:47], v[76:79]
 v_mfma_f32_16x16x32_bf16 v[84:87], v[44:47], a[164:167], v[84:87]
 v_cvt_pk_bf16_f32 v25, v116, v117
 v_mfma_f32_16x16x32_bf16 v[92:95], v[44:47], a[228:231], v[92:95]
 s_waitcnt lgkmcnt(2)
 v_mfma_f32_16x16x32_bf16 v[64:67], a[40:43], v[48:51], v[64:67]
 ds_read_b128 v[32:35], v6 offset:24576
 v_mfma_f32_16x16x32_bf16 v[72:75], a[104:107], v[48:51], v[72:75]
 ds_read_b128 v[36:39], v6 offset:26624
 v_mfma_f32_16x16x32_bf16 v[80:83], v[48:51], a[168:171], v[80:83]
 v_mfma_f32_16x16x32_bf16 v[88:91], v[48:51], a[232:235], v[88:91]
 v_cvt_pk_bf16_f32 v26, v114, v115
 v_mfma_f32_16x16x32_bf16 v[68:71], a[40:43], v[52:55], v[68:71]
 v_cvt_pk_bf16_f32 v27, v118, v119
 v_mfma_f32_16x16x32_bf16 v[76:79], a[104:107], v[52:55], v[76:79]
 v_mfma_f32_16x16x32_bf16 v[84:87], v[52:55], a[168:171], v[84:87]
 buffer_store_dwordx4 v[24:27], v12, s[20:23], s48 offen offset:0 sc1
 v_mfma_f32_16x16x32_bf16 v[92:95], v[52:55], a[232:235], v[92:95]
 s_waitcnt lgkmcnt(2)
 v_mfma_f32_16x16x32_bf16 v[64:67], a[44:47], v[56:59], v[64:67]
 ds_read_b128 v[40:43], v7 offset:24576
 v_mfma_f32_16x16x32_bf16 v[72:75], a[108:111], v[56:59], v[72:75]
 ds_read_b128 v[44:47], v7 offset:26624
 v_mfma_f32_16x16x32_bf16 v[80:83], v[56:59], a[172:175], v[80:83]
 s_add_u32 s43, s43, 32768
 s_cmp_eq_u32 s43, 131072
 v_mfma_f32_16x16x32_bf16 v[88:91], v[56:59], a[236:239], v[88:91]
 s_cselect_b32 s43, 0, s43
 s_add_u32 s44, s44, 32768
 v_mfma_f32_16x16x32_bf16 v[68:71], a[44:47], v[60:63], v[68:71]
 s_cmp_eq_u32 s44, 131072
 s_cselect_b32 s44, 0, s44
 v_mfma_f32_16x16x32_bf16 v[76:79], a[108:111], v[60:63], v[76:79]
 v_mfma_f32_16x16x32_bf16 v[84:87], v[60:63], a[172:175], v[84:87]
 v_cvt_pk_bf16_f32 v28, v120, v121
 v_mfma_f32_16x16x32_bf16 v[92:95], v[60:63], a[236:239], v[92:95]
 s_waitcnt lgkmcnt(2)
 v_mfma_f32_16x16x32_bf16 v[64:67], a[48:51], v[32:35], v[64:67]
 ds_read_b128 v[48:51], v6 offset:28672
 v_mfma_f32_16x16x32_bf16 v[72:75], a[112:115], v[32:35], v[72:75]
 ds_read_b128 v[52:55], v6 offset:30720
 v_mfma_f32_16x16x32_bf16 v[80:83], v[32:35], a[176:179], v[80:83]
 v_add_u32 v6, s43, v4
 v_mfma_f32_16x16x32_bf16 v[88:91], v[32:35], a[240:243], v[88:91]
 v_mfma_f32_16x16x32_bf16 v[68:71], a[48:51], v[36:39], v[68:71]
 v_cvt_pk_bf16_f32 v29, v124, v125
 v_mfma_f32_16x16x32_bf16 v[76:79], a[112:115], v[36:39], v[76:79]
 v_cvt_pk_bf16_f32 v30, v122, v123
 v_mfma_f32_16x16x32_bf16 v[84:87], v[36:39], a[176:179], v[84:87]
 v_mfma_f32_16x16x32_bf16 v[92:95], v[36:39], a[240:243], v[92:95]
 s_waitcnt lgkmcnt(2)
 v_mfma_f32_16x16x32_bf16 v[64:67], a[52:55], v[40:43], v[64:67]
 ds_read_b128 v[56:59], v7 offset:28672
 v_mfma_f32_16x16x32_bf16 v[72:75], a[116:119], v[40:43], v[72:75]
 ds_read_b128 v[60:63], v7 offset:30720
 v_mfma_f32_16x16x32_bf16 v[80:83], v[40:43], a[180:183], v[80:83]
 v_add_u32 v7, s43, v5
 v_mfma_f32_16x16x32_bf16 v[88:91], v[40:43], a[244:247], v[88:91]
 v_cvt_pk_bf16_f32 v31, v126, v127
 v_mfma_f32_16x16x32_bf16 v[68:71], a[52:55], v[44:47], v[68:71]
 v_mfma_f32_16x16x32_bf16 v[76:79], a[116:119], v[44:47], v[76:79]
 buffer_store_dwordx4 v[28:31], v12, s[20:23], s48 offen offset:1024 sc1
 v_mfma_f32_16x16x32_bf16 v[84:87], v[44:47], a[180:183], v[84:87]
 v_mfma_f32_16x16x32_bf16 v[92:95], v[44:47], a[244:247], v[92:95]
 s_waitcnt lgkmcnt(2)
 v_mfma_f32_16x16x32_bf16 v[64:67], a[56:59], v[48:51], v[64:67]
 s_waitcnt vmcnt(12)
 s_barrier
 ds_read_b128 v[32:35], v6 offset:0
 v_mfma_f32_16x16x32_bf16 v[72:75], a[120:123], v[48:51], v[72:75]
 ds_read_b128 v[36:39], v6 offset:2048
 v_mfma_f32_16x16x32_bf16 v[80:83], v[48:51], a[184:187], v[80:83]
 v_mfma_f32_16x16x32_bf16 v[88:91], v[48:51], a[248:251], v[88:91]
 v_mfma_f32_16x16x32_bf16 v[68:71], a[56:59], v[52:55], v[68:71]
 v_mfma_f32_16x16x32_bf16 v[76:79], a[120:123], v[52:55], v[76:79]
 v_mfma_f32_16x16x32_bf16 v[84:87], v[52:55], a[184:187], v[84:87]
 v_mfma_f32_16x16x32_bf16 v[92:95], v[52:55], a[248:251], v[92:95]
 s_waitcnt lgkmcnt(2)
 v_mfma_f32_16x16x32_bf16 v[64:67], a[60:63], v[56:59], v[64:67]
 ds_read_b128 v[40:43], v7 offset:0
 v_mfma_f32_16x16x32_bf16 v[72:75], a[124:127], v[56:59], v[72:75]
 ds_read_b128 v[44:47], v7 offset:2048
 v_mfma_f32_16x16x32_bf16 v[80:83], v[56:59], a[188:191], v[80:83]
 s_mul_i32 s45, s39, 524288
 s_add_u32 s47, s34, s45
 v_mfma_f32_16x16x32_bf16 v[88:91], v[56:59], a[252:255], v[88:91]
 s_add_u32 s48, s35, s45
 v_mov_b32 v14, s42
 v_mfma_f32_16x16x32_bf16 v[68:71], a[60:63], v[60:63], v[68:71]
 s_mov_b32 s39, s40
 s_mov_b32 s40, s41
 v_mfma_f32_16x16x32_bf16 v[76:79], a[124:127], v[60:63], v[76:79]
 s_add_u32 s42, s42, 1
 v_mfma_f32_16x16x32_bf16 v[84:87], v[60:63], a[188:191], v[84:87]
 v_mfma_f32_16x16x32_bf16 v[92:95], v[60:63], a[252:255], v[92:95]
 s_waitcnt lgkmcnt(2)
 v_mfma_f32_16x16x32_bf16 v[96:99], a[0:3], v[32:35], 0
 ds_read_b128 v[48:51], v6 offset:4096
 v_mfma_f32_16x16x32_bf16 v[104:107], a[64:67], v[32:35], 0
 ds_read_b128 v[52:55], v6 offset:6144
 v_mfma_f32_16x16x32_bf16 v[112:115], v[32:35], a[128:131], 0
 s_add_u32 s41, s40, 4
 v_mfma_f32_16x16x32_bf16 v[120:123], v[32:35], a[192:195], 0
 s_add_u32 s45, s42, 2
 s_mul_i32 s46, s41, 32768
 v_mfma_f32_16x16x32_bf16 v[100:103], a[0:3], v[36:39], 0
 s_cmp_lt_u32 s45, s36
 s_cselect_b32 s46, s46, 0
 v_mfma_f32_16x16x32_bf16 v[108:111], a[64:67], v[36:39], 0
 s_lshl_b32 s49, s4, 10
 s_add_u32 s49, s49, s44
 v_mfma_f32_16x16x32_bf16 v[116:119], v[36:39], a[128:131], 0
 v_mfma_f32_16x16x32_bf16 v[124:127], v[36:39], a[192:195], 0
 s_waitcnt lgkmcnt(2)
 v_mfma_f32_16x16x32_bf16 v[96:99], a[4:7], v[40:43], v[96:99]
 ds_read_b128 v[56:59], v7 offset:4096
 v_mfma_f32_16x16x32_bf16 v[104:107], a[68:71], v[40:43], v[104:107]
 ds_read_b128 v[60:63], v7 offset:6144
 v_mfma_f32_16x16x32_bf16 v[112:115], v[40:43], a[132:135], v[112:115]
 s_add_u32 m0, s49, 0
 v_mfma_f32_16x16x32_bf16 v[120:123], v[40:43], a[196:199], v[120:123]
 buffer_load_dwordx4 v10, s[8:11], s46 offen offset:0  lds
 v_mfma_f32_16x16x32_bf16 v[100:103], a[4:7], v[44:47], v[100:103]
 s_add_u32 m0, s49, 3968
 v_mfma_f32_16x16x32_bf16 v[108:111], a[68:71], v[44:47], v[108:111]
 buffer_load_dwordx4 v10, s[8:11], s46 offen offset:128  lds
 v_mfma_f32_16x16x32_bf16 v[116:119], v[44:47], a[132:135], v[116:119]
 v_mfma_f32_16x16x32_bf16 v[124:127], v[44:47], a[196:199], v[124:127]
 s_waitcnt lgkmcnt(2)
 v_mfma_f32_16x16x32_bf16 v[96:99], a[8:11], v[48:51], v[96:99]
 ds_read_b128 v[32:35], v6 offset:8192
 v_mfma_f32_16x16x32_bf16 v[104:107], a[72:75], v[48:51], v[104:107]
 ds_read_b128 v[36:39], v6 offset:10240
 v_mfma_f32_16x16x32_bf16 v[112:115], v[48:51], a[136:139], v[112:115]
 s_add_u32 m0, s49, 7936
 v_mfma_f32_16x16x32_bf16 v[120:123], v[48:51], a[200:203], v[120:123]
 buffer_load_dwordx4 v10, s[8:11], s46 offen offset:256  lds
 v_mfma_f32_16x16x32_bf16 v[100:103], a[8:11], v[52:55], v[100:103]
 s_add_u32 m0, s49, 11904
 v_mfma_f32_16x16x32_bf16 v[108:111], a[72:75], v[52:55], v[108:111]
 buffer_load_dwordx4 v10, s[8:11], s46 offen offset:384  lds
 v_mfma_f32_16x16x32_bf16 v[116:119], v[52:55], a[136:139], v[116:119]
 v_mfma_f32_16x16x32_bf16 v[124:127], v[52:55], a[200:203], v[124:127]
 s_waitcnt lgkmcnt(2)
 v_mfma_f32_16x16x32_bf16 v[96:99], a[12:15], v[56:59], v[96:99]
 ds_read_b128 v[40:43], v7 offset:8192
 v_mfma_f32_16x16x32_bf16 v[104:107], a[76:79], v[56:59], v[104:107]
 ds_read_b128 v[44:47], v7 offset:10240
 v_mfma_f32_16x16x32_bf16 v[112:115], v[56:59], a[140:143], v[112:115]
 s_add_u32 m0, s49, 15872
 v_mfma_f32_16x16x32_bf16 v[120:123], v[56:59], a[204:207], v[120:123]
 buffer_load_dwordx4 v10, s[8:11], s46 offen offset:512  lds
 v_mfma_f32_16x16x32_bf16 v[100:103], a[12:15], v[60:63], v[100:103]
 s_add_u32 m0, s49, 19840
 v_mfma_f32_16x16x32_bf16 v[108:111], a[76:79], v[60:63], v[108:111]
 buffer_load_dwordx4 v10, s[8:11], s46 offen offset:640  lds
 v_mfma_f32_16x16x32_bf16 v[116:119], v[60:63], a[140:143], v[116:119]
 v_mfma_f32_16x16x32_bf16 v[124:127], v[60:63], a[204:207], v[124:127]
 s_waitcnt lgkmcnt(2)
 v_mfma_f32_16x16x32_bf16 v[96:99], a[16:19], v[32:35], v[96:99]
 ds_read_b128 v[48:51], v6 offset:12288
 v_mfma_f32_16x16x32_bf16 v[104:107], a[80:83], v[32:35], v[104:107]
 ds_read_b128 v[52:55], v6 offset:14336
 v_mfma_f32_16x16x32_bf16 v[112:115], v[32:35], a[144:147], v[112:115]
 s_add_u32 m0, s49, 23808
 v_mfma_f32_16x16x32_bf16 v[120:123], v[32:35], a[208:211], v[120:123]
 buffer_load_dwordx4 v10, s[8:11], s46 offen offset:768  lds
 v_mfma_f32_16x16x32_bf16 v[100:103], a[16:19], v[36:39], v[100:103]
 s_add_u32 m0, s49, 27776
 v_mfma_f32_16x16x32_bf16 v[108:111], a[80:83], v[36:39], v[108:111]
 buffer_load_dwordx4 v10, s[8:11], s46 offen offset:896  lds
 v_mfma_f32_16x16x32_bf16 v[116:119], v[36:39], a[144:147], v[116:119]
 v_mfma_f32_16x16x32_bf16 v[124:127], v[36:39], a[208:211], v[124:127]
 s_waitcnt lgkmcnt(2)
 v_mfma_f32_16x16x32_bf16 v[96:99], a[20:23], v[40:43], v[96:99]
 ds_read_b128 v[56:59], v7 offset:12288
 v_mfma_f32_16x16x32_bf16 v[104:107], a[84:87], v[40:43], v[104:107]
 ds_read_b128 v[60:63], v7 offset:14336
 v_mfma_f32_16x16x32_bf16 v[112:115], v[40:43], a[148:151], v[112:115]
 v_mfma_f32_16x16x32_bf16 v[120:123], v[40:43], a[212:215], v[120:123]
 v_mfma_f32_16x16x32_bf16 v[100:103], a[20:23], v[44:47], v[100:103]
 v_mfma_f32_16x16x32_bf16 v[108:111], a[84:87], v[44:47], v[108:111]
 v_mfma_f32_16x16x32_bf16 v[116:119], v[44:47], a[148:151], v[116:119]
 v_mfma_f32_16x16x32_bf16 v[124:127], v[44:47], a[212:215], v[124:127]
 s_waitcnt lgkmcnt(2)
 v_mfma_f32_16x16x32_bf16 v[96:99], a[24:27], v[48:51], v[96:99]
 ds_read_b128 v[32:35], v6 offset:16384
 v_mfma_f32_16x16x32_bf16 v[104:107], a[88:91], v[48:51], v[104:107]
 ds_read_b128 v[36:39], v6 offset:18432
 v_mfma_f32_16x16x32_bf16 v[112:115], v[48:51], a[152:155], v[112:115]
 v_cvt_pk_bf16_f32 v16, v64, v65
 v_mfma_f32_16x16x32_bf16 v[120:123], v[48:51], a[216:219], v[120:123]
 v_cvt_pk_bf16_f32 v17, v72, v73
 v_mfma_f32_16x16x32_bf16 v[100:103], a[24:27], v[52:55], v[100:103]
 v_mfma_f32_16x16x32_bf16 v[108:111], a[88:91], v[52:55], v[108:111]
 v_cvt_pk_bf16_f32 v18, v66, v67
 v_mfma_f32_16x16x32_bf16 v[116:119], v[52:55], a[152:155], v[116:119]
 v_mfma_f32_16x16x32_bf16 v[124:127], v[52:55], a[216:219], v[124:127]
 s_waitcnt lgkmcnt(2)
 v_mfma_f32_16x16x32_bf16 v[96:99], a[28:31], v[56:59], v[96:99]
 ds_read_b128 v[40:43], v7 offset:16384
 v_mfma_f32_16x16x32_bf16 v[104:107], a[92:95], v[56:59], v[104:107]
 ds_read_b128 v[44:47], v7 offset:18432
 v_mfma_f32_16x16x32_bf16 v[112:115], v[56:59], a[156:159], v[112:115]
 v_cvt_pk_bf16_f32 v19, v74, v75
 v_mfma_f32_16x16x32_bf16 v[120:123], v[56:59], a[220:223], v[120:123]
 v_mfma_f32_16x16x32_bf16 v[100:103], a[28:31], v[60:63], v[100:103]
 buffer_store_dwordx4 v[16:19], v12, s[20:23], s47 offen offset:0 sc1
 v_mfma_f32_16x16x32_bf16 v[108:111], a[92:95], v[60:63], v[108:111]
 v_cvt_pk_bf16_f32 v20, v68, v69
 v_mfma_f32_16x16x32_bf16 v[116:119], v[60:63], a[156:159], v[116:119]
 v_mfma_f32_16x16x32_bf16 v[124:127], v[60:63], a[220:223], v[124:127]
 s_waitcnt lgkmcnt(2)
 v_mfma_f32_16x16x32_bf16 v[96:99], a[32:35], v[32:35], v[96:99]
 ds_read_b128 v[48:51], v6 offset:20480
 v_mfma_f32_16x16x32_bf16 v[104:107], a[96:99], v[32:35], v[104:107]
 ds_read_b128 v[52:55], v6 offset:22528
 v_mfma_f32_16x16x32_bf16 v[112:115], v[32:35], a[160:163], v[112:115]
 v_cvt_pk_bf16_f32 v21, v76, v77
 v_mfma_f32_16x16x32_bf16 v[120:123], v[32:35], a[224:227], v[120:123]
 v_mfma_f32_16x16x32_bf16 v[100:103], a[32:35], v[36:39], v[100:103]
 v_cvt_pk_bf16_f32 v22, v70, v71
 v_mfma_f32_16x16x32_bf16 v[108:111], a[96:99], v[36:39], v[108:111]
 v_mfma_f32_16x16x32_bf16 v[116:119], v[36:39], a[160:163], v[116:119]
 v_cvt_pk_bf16_f32 v23, v78, v79
 v_mfma_f32_16x16x32_bf16 v[124:127], v[36:39], a[224:227], v[124:127]
 s_waitcnt lgkmcnt(2)
 v_mfma_f32_16x16x32_bf16 v[96:99], a[36:39], v[40:43], v[96:99]
 ds_read_b128 v[56:59], v7 offset:20480
 v_mfma_f32_16x16x32_bf16 v[104:107], a[100:103], v[40:43], v[104:107]
 ds_read_b128 v[60:63], v7 offset:22528
 v_mfma_f32_16x16x32_bf16 v[112:115], v[40:43], a[164:167], v[112:115]
 buffer_store_dwordx4 v[20:23], v12, s[20:23], s47 offen offset:1024 sc1
 v_mfma_f32_16x16x32_bf16 v[120:123], v[40:43], a[228:231], v[120:123]
 v_mfma_f32_16x16x32_bf16 v[100:103], a[36:39], v[44:47], v[100:103]
 v_cvt_pk_bf16_f32 v24, v80, v81
 v_mfma_f32_16x16x32_bf16 v[108:111], a[100:103], v[44:47], v[108:111]
 v_mfma_f32_16x16x32_bf16 v[116:119], v[44:47], a[164:167], v[116:119]
 v_cvt_pk_bf16_f32 v25, v84, v85
 v_mfma_f32_16x16x32_bf16 v[124:127], v[44:47], a[228:231], v[124:127]
 s_waitcnt lgkmcnt(2)
 v_mfma_f32_16x16x32_bf16 v[96:99], a[40:43], v[48:51], v[96:99]
 ds_read_b128 v[32:35], v6 offset:24576
 v_mfma_f32_16x16x32_bf16 v[104:107], a[104:107], v[48:51], v[104:107]
 ds_read_b128 v[36:39], v6 offset:26624
 v_mfma_f32_16x16x32_bf16 v[112:115], v[48:51], a[168:171], v[112:115]
 v_mfma_f32_16x16x32_bf16 v[120:123], v[48:51], a[232:235], v[120:123]
 v_cvt_pk_bf16_f32 v26, v82, v83
 v_mfma_f32_16x16x32_bf16 v[100:103], a[40:43], v[52:55], v[100:103]
 v_cvt_pk_bf16_f32 v27, v86, v87
 v_mfma_f32_16x16x32_bf16 v[108:111], a[104:107], v[52:55], v[108:111]
 v_mfma_f32_16x16x32_bf16 v[116:119], v[52:55], a[168:171], v[116:119]
 buffer_store_dwordx4 v[24:27], v12, s[20:23], s48 offen offset:0 sc1
 v_mfma_f32_16x16x32_bf16 v[124:127], v[52:55], a[232:235], v[124:127]
 s_waitcnt lgkmcnt(2)
 v_mfma_f32_16x16x32_bf16 v[96:99], a[44:47], v[56:59], v[96:99]
 ds_read_b128 v[40:43], v7 offset:24576
 v_mfma_f32_16x16x32_bf16 v[104:107], a[108:111], v[56:59], v[104:107]
 ds_read_b128 v[44:47], v7 offset:26624
 v_mfma_f32_16x16x32_bf16 v[112:115], v[56:59], a[172:175], v[112:115]
 s_add_u32 s43, s43, 32768
 s_cmp_eq_u32 s43, 131072
 v_mfma_f32_16x16x32_bf16 v[120:123], v[56:59], a[236:239], v[120:123]
 s_cselect_b32 s43, 0, s43
 s_add_u32 s44, s44, 32768
 v_mfma_f32_16x16x32_bf16 v[100:103], a[44:47], v[60:63], v[100:103]
 s_cmp_eq_u32 s44, 131072
 s_cselect_b32 s44, 0, s44
 v_mfma_f32_16x16x32_bf16 v[108:111], a[108:111], v[60:63], v[108:111]
 v_mfma_f32_16x16x32_bf16 v[116:119], v[60:63], a[172:175], v[116:119]
 v_cvt_pk_bf16_f32 v28, v88, v89
 v_mfma_f32_16x16x32_bf16 v[124:127], v[60:63], a[236:239], v[124:127]
 s_waitcnt lgkmcnt(2)
 v_mfma_f32_16x16x32_bf16 v[96:99], a[48:51], v[32:35], v[96:99]
 ds_read_b128 v[48:51], v6 offset:28672
 v_mfma_f32_16x16x32_bf16 v[104:107], a[112:115], v[32:35], v[104:107]
 ds_read_b128 v[52:55], v6 offset:30720
 v_mfma_f32_16x16x32_bf16 v[112:115], v[32:35], a[176:179], v[112:115]
 v_add_u32 v6, s43, v4
 v_mfma_f32_16x16x32_bf16 v[120:123], v[32:35], a[240:243], v[120:123]
 v_mfma_f32_16x16x32_bf16 v[100:103], a[48:51], v[36:39], v[100:103]
 v_cvt_pk_bf16_f32 v29, v92, v93
 v_mfma_f32_16x16x32_bf16 v[108:111], a[112:115], v[36:39], v[108:111]
 v_cvt_pk_bf16_f32 v30, v90, v91
 v_mfma_f32_16x16x32_bf16 v[116:119], v[36:39], a[176:179], v[116:119]
 v_mfma_f32_16x16x32_bf16 v[124:127], v[36:39], a[240:243], v[124:127]
 s_waitcnt lgkmcnt(2)
 v_mfma_f32_16x16x32_bf16 v[96:99], a[52:55], v[40:43], v[96:99]
 ds_read_b128 v[56:59], v7 offset:28672
 v_mfma_f32_16x16x32_bf16 v[104:107], a[116:119], v[40:43], v[104:107]
 ds_read_b128 v[60:63], v7 offset:30720
 v_mfma_f32_16x16x32_bf16 v[112:115], v[40:43], a[180:183], v[112:115]
 v_add_u32 v7, s43, v5
 v_mfma_f32_16x16x32_bf16 v[120:123], v[40:43], a[244:247], v[120:123]
 v_cvt_pk_bf16_f32 v31, v94, v95
 v_mfma_f32_16x16x32_bf16 v[100:103], a[52:55], v[44:47], v[100:103]
 v_mfma_f32_16x16x32_bf16 v[108:111], a[116:119], v[44:47], v[108:111]
 buffer_store_dwordx4 v[28:31], v12, s[20:23], s48 offen offset:1024 sc1
 v_mfma_f32_16x16x32_bf16 v[116:119], v[44:47], a[180:183], v[116:119]
 v_mfma_f32_16x16x32_bf16 v[124:127], v[44:47], a[244:247], v[124:127]
 s_waitcnt lgkmcnt(2)
 v_mfma_f32_16x16x32_bf16 v[96:99], a[56:59], v[48:51], v[96:99]
 s_waitcnt vmcnt(12)
 s_barrier
 ds_read_b128 v[32:35], v6 offset:0
 v_mfma_f32_16x16x32_bf16 v[104:107], a[120:123], v[48:51], v[104:107]
 ds_read_b128 v[36:39], v6 offset:2048
 v_mfma_f32_16x16x32_bf16 v[112:115], v[48:51], a[184:187], v[112:115]
 v_mfma_f32_16x16x32_bf16 v[120:123], v[48:51], a[248:251], v[120:123]
 v_mfma_f32_16x16x32_bf16 v[100:103], a[56:59], v[52:55], v[100:103]
 v_mfma_f32_16x16x32_bf16 v[108:111], a[120:123], v[52:55], v[108:111]
 v_mfma_f32_16x16x32_bf16 v[116:119], v[52:55], a[184:187], v[116:119]
 v_mfma_f32_16x16x32_bf16 v[124:127], v[52:55], a[248:251], v[124:127]
 s_waitcnt lgkmcnt(2)
 v_mfma_f32_16x16x32_bf16 v[96:99], a[60:63], v[56:59], v[96:99]
 ds_read_b128 v[40:43], v7 offset:0
 v_mfma_f32_16x16x32_bf16 v[104:107], a[124:127], v[56:59], v[104:107]
 ds_read_b128 v[44:47], v7 offset:2048
 v_mfma_f32_16x16x32_bf16 v[112:115], v[56:59], a[188:191], v[112:115]
 s_mul_i32 s45, s39, 524288
 s_add_u32 s47, s34, s45
 v_mfma_f32_16x16x32_bf16 v[120:123], v[56:59], a[252:255], v[120:123]
 s_add_u32 s48, s35, s45
 v_mov_b32 v14, s42
 v_mfma_f32_16x16x32_bf16 v[100:103], a[60:63], v[60:63], v[100:103]
 s_mov_b32 s39, s40
 s_mov_b32 s40, s41
 v_mfma_f32_16x16x32_bf16 v[108:111], a[124:127], v[60:63], v[108:111]
 s_add_u32 s42, s42, 1
 s_cmp_lt_u32 s42, s36
 v_mfma_f32_16x16x32_bf16 v[116:119], v[60:63], a[188:191], v[116:119]
 v_mfma_f32_16x16x32_bf16 v[124:127], v[60:63], a[252:255], v[124:127]
 s_waitcnt lgkmcnt(2)
 s_cbranch_scc1 Lps_loop_3
 s_nop 7
 v_cvt_pk_bf16_f32 v16, v96, v97
 v_cvt_pk_bf16_f32 v17, v104, v105
 v_cvt_pk_bf16_f32 v18, v98, v99
 v_cvt_pk_bf16_f32 v19, v106, v107
 buffer_store_dwordx4 v[16:19], v12, s[20:23], s47 offen offset:0 sc1
 v_cvt_pk_bf16_f32 v20, v100, v101
 v_cvt_pk_bf16_f32 v21, v108, v109
 v_cvt_pk_bf16_f32 v22, v102, v103
 v_cvt_pk_bf16_f32 v23, v110, v111
 buffer_store_dwordx4 v[20:23], v12, s[20:23], s47 offen offset:1024 sc1
 v_cvt_pk_bf16_f32 v24, v112, v113
 v_cvt_pk_bf16_f32 v25, v116, v117
 v_cvt_pk_bf16_f32 v26, v114, v115
 v_cvt_pk_bf16_f32 v27, v118, v119
 buffer_store_dwordx4 v[24:27], v12, s[20:23], s48 offen offset:0 sc1
 v_cvt_pk_bf16_f32 v28, v120, v121
 v_cvt_pk_bf16_f32 v29, v124, v125
 v_cvt_pk_bf16_f32 v30, v122, v123
 v_cvt_pk_bf16_f32 v31, v126, v127
 buffer_store_dwordx4 v[28:31], v12, s[20:23], s48 offen offset:1024 sc1
 s_waitcnt vmcnt(0) lgkmcnt(0)
 s_barrier
 v_mov_b32 v14, s36
 buffer_store_dword v14, v13, s[20:23], 0 offen sc1
 s_mov_b32 s32, s3
 s_and_b32 s33, s6, 3
 s_sub_u32 s34, 7, s33
 v_and_b32 v1, 63, v0
 v_lshlrev_b32 v1, 4, v1
 v_mov_b32 v4, 0xff800000
 v_min_u32 v5, 1, v0
 v_lshlrev_b32 v5, 28, v5
 v_mov_b32 v6, 0x3f803f80
 v_accvgpr_write_b32 a192, v6
 v_accvgpr_write_b32 a193, v6
 v_accvgpr_write_b32 a194, v6
 v_accvgpr_write_b32 a195, v6
 s_mov_b32 s52, 0xfff0ffff
 s_mov_b32 s53, 0xf000ff00
 s_mov_b32 s54, 0xffe0fffe
 s_mov_b32 s55, 0xe000fe00
 s_mov_b32 s56, 0xffc0fffc
 s_mov_b32 s57, 0xc000fc00
 s_mov_b32 s58, 0xff80fff8
 s_mov_b32 s59, 0x8000f800
 s_mov_b32 s73, 0x53800000
 s_mov_b32 s74, 0x21800000
 s_lshl_b32 s50, s4, 12
 s_lshl_b32 s45, s32, 14
 s_add_u32 s45, s45, s50
 s_add_u32 s45, s45, 0x1000000
 s_lshl_b32 s36, s33, 3
 s_add_u32 s36, s36, 8
 s_lshl_b32 s47, s34, 3
 s_add_u32 s47, s47, 8
 s_mov_b32 s35, 0
 s_mov_b32 s38, 0
 s_mov_b32 s46, 0
 s_lshl_b32 s7, s3, 7
 s_add_u32 s7, s7, 0x2000
 s_lshr_b32 s94, s3, 1
 s_lshl_b32 s94, s94, 7
 s_add_u32 s94, s94, 0x3000
 v_mov_b32 v8, 0
Law_4:
 buffer_load_dwordx4 v[16:19], v8, s[20:23], s7 offen sc1
 buffer_load_dwordx4 v[20:23], v8, s[20:23], s94 offen sc1
 s_waitcnt vmcnt(0)
 v_min3_u32 v16, v16, v17, v18
 v_min3_u32 v16, v16, v19, v20
 v_min3_u32 v16, v16, v21, v22
 v_min_u32 v16, v16, v23
 v_cmp_le_u32 vcc, 16, v16
 s_cbranch_vccnz Lawk_5
 s_sleep 2
 s_sub_u32 s95, s95, 1
 s_cbranch_scc0 Law_4
 s_endpgm
Lawk_5:
 s_lshl_b32 s37, s35, 19
 s_add_u32 m0, s38, s50
 s_add_u32 s37, s37, s45
 buffer_load_dwordx4 v1, s[20:23], s37 offen offset:0 sc1 lds
 buffer_load_dwordx4 v1, s[20:23], s37 offen offset:1024 sc1 lds
 buffer_load_dwordx4 v1, s[20:23], s37 offen offset:2048 sc1 lds
 buffer_load_dwordx4 v1, s[20:23], s37 offen offset:3072 sc1 lds
 s_add_u32 s38, s38, 0x4000
 s_and_b32 s38, s38, 0x1ffff
 s_add_u32 s35, s35, 1
 s_cmp_eq_u32 s35, s36
 s_cselect_b32 s36, s47, s36
 s_cselect_b32 s35, 0, s35
 s_lshl_b32 s44, s33, 3
 s_add_u32 s44, s44, s4
 s_lshl_b32 s44, s44, 5
 s_add_u32 s44, s44, s32
 s_lshl_b32 s44, s44, 13
 s_add_u32 s44, s44, 0x5000000
 buffer_load_dwordx4 a[0:3], v1, s[20:23], s44 offen offset:0 sc1
 buffer_load_dwordx4 a[16:19], v1, s[20:23], s44 offen offset:1024 sc1
 buffer_load_dwordx4 a[4:7], v1, s[20:23], s44 offen offset:2048 sc1
 buffer_load_dwordx4 a[20:23], v1, s[20:23], s44 offen offset:3072 sc1
 s_add_u32 s44, s44, 4096
 buffer_load_dwordx4 a[8:11], v1, s[20:23], s44 offen offset:0 sc1
 buffer_load_dwordx4 a[24:27], v1, s[20:23], s44 offen offset:1024 sc1
 buffer_load_dwordx4 a[12:15], v1, s[20:23], s44 offen offset:2048 sc1
 buffer_load_dwordx4 a[28:31], v1, s[20:23], s44 offen offset:3072 sc1
 s_lshl_b32 s44, s33, 3
 s_add_u32 s44, s44, 7
 s_sub_u32 s44, s44, s4
 s_lshl_b32 s44, s44, 5
 s_add_u32 s44, s44, s32
 s_lshl_b32 s44, s44, 13
 s_add_u32 s44, s44, 0x5000000
 buffer_load_dwordx4 a[32:35], v1, s[20:23], s44 offen offset:0 sc1
 buffer_load_dwordx4 a[48:51], v1, s[20:23], s44 offen offset:1024 sc1
 buffer_load_dwordx4 a[36:39], v1, s[20:23], s44 offen offset:2048 sc1
 buffer_load_dwordx4 a[52:55], v1, s[20:23], s44 offen offset:3072 sc1
 s_add_u32 s44, s44, 4096
 buffer_load_dwordx4 a[40:43], v1, s[20:23], s44 offen offset:0 sc1
 buffer_load_dwordx4 a[56:59], v1, s[20:23], s44 offen offset:1024 sc1
 buffer_load_dwordx4 a[44:47], v1, s[20:23], s44 offen offset:2048 sc1
 buffer_load_dwordx4 a[60:63], v1, s[20:23], s44 offen offset:3072 sc1
 s_lshl_b32 s37, s35, 19
 s_add_u32 m0, s38, s50
 s_add_u32 s37, s37, s45
 buffer_load_dwordx4 v1, s[20:23], s37 offen offset:0 sc1 lds
 buffer_load_dwordx4 v1, s[20:23], s37 offen offset:1024 sc1 lds
 buffer_load_dwordx4 v1, s[20:23], s37 offen offset:2048 sc1 lds
 buffer_load_dwordx4 v1, s[20:23], s37 offen offset:3072 sc1 lds
 s_add_u32 s38, s38, 0x4000
 s_and_b32 s38, s38, 0x1ffff
 s_add_u32 s35, s35, 1
 s_cmp_eq_u32 s35, s36
 s_cselect_b32 s36, s47, s36
 s_cselect_b32 s35, 0, s35
 s_lshl_b32 s37, s35, 19
 s_add_u32 m0, s38, s50
 s_add_u32 s37, s37, s45
 buffer_load_dwordx4 v1, s[20:23], s37 offen offset:0 sc1 lds
 buffer_load_dwordx4 v1, s[20:23], s37 offen offset:1024 sc1 lds
 buffer_load_dwordx4 v1, s[20:23], s37 offen offset:2048 sc1 lds
 buffer_load_dwordx4 v1, s[20:23], s37 offen offset:3072 sc1 lds
 s_add_u32 s38, s38, 0x4000
 s_and_b32 s38, s38, 0x1ffff
 s_add_u32 s35, s35, 1
 s_cmp_eq_u32 s35, s36
 s_cselect_b32 s36, s47, s36
 s_cselect_b32 s35, 0, s35
 s_lshl_b32 s37, s35, 19
 s_add_u32 m0, s38, s50
 s_add_u32 s37, s37, s45
 buffer_load_dwordx4 v1, s[20:23], s37 offen offset:0 sc1 lds
 buffer_load_dwordx4 v1, s[20:23], s37 offen offset:1024 sc1 lds
 buffer_load_dwordx4 v1, s[20:23], s37 offen offset:2048 sc1 lds
 buffer_load_dwordx4 v1, s[20:23], s37 offen offset:3072 sc1 lds
 s_add_u32 s38, s38, 0x4000
 s_and_b32 s38, s38, 0x1ffff
 s_add_u32 s35, s35, 1
 s_cmp_eq_u32 s35, s36
 s_cselect_b32 s36, s47, s36
 s_cselect_b32 s35, 0, s35
 s_lshl_b32 s37, s35, 19
 s_add_u32 m0, s38, s50
 s_add_u32 s37, s37, s45
 buffer_load_dwordx4 v1, s[20:23], s37 offen offset:0 sc1 lds
 buffer_load_dwordx4 v1, s[20:23], s37 offen offset:1024 sc1 lds
 buffer_load_dwordx4 v1, s[20:23], s37 offen offset:2048 sc1 lds
 buffer_load_dwordx4 v1, s[20:23], s37 offen offset:3072 sc1 lds
 s_add_u32 s38, s38, 0x4000
 s_and_b32 s38, s38, 0x1ffff
 s_add_u32 s35, s35, 1
 s_cmp_eq_u32 s35, s36
 s_cselect_b32 s36, s47, s36
 s_cselect_b32 s35, 0, s35
 s_lshl_b32 s37, s35, 19
 s_add_u32 m0, s38, s50
 s_add_u32 s37, s37, s45
 buffer_load_dwordx4 v1, s[20:23], s37 offen offset:0 sc1 lds
 buffer_load_dwordx4 v1, s[20:23], s37 offen offset:1024 sc1 lds
 buffer_load_dwordx4 v1, s[20:23], s37 offen offset:2048 sc1 lds
 buffer_load_dwordx4 v1, s[20:23], s37 offen offset:3072 sc1 lds
 s_add_u32 s38, s38, 0x4000
 s_and_b32 s38, s38, 0x1ffff
 s_add_u32 s35, s35, 1
 s_cmp_eq_u32 s35, s36
 s_cselect_b32 s36, s47, s36
 s_cselect_b32 s35, 0, s35
 s_lshl_b32 s37, s35, 19
 s_add_u32 m0, s38, s50
 s_add_u32 s37, s37, s45
 buffer_load_dwordx4 v1, s[20:23], s37 offen offset:0 sc1 lds
 buffer_load_dwordx4 v1, s[20:23], s37 offen offset:1024 sc1 lds
 buffer_load_dwordx4 v1, s[20:23], s37 offen offset:2048 sc1 lds
 buffer_load_dwordx4 v1, s[20:23], s37 offen offset:3072 sc1 lds
 s_add_u32 s38, s38, 0x4000
 s_and_b32 s38, s38, 0x1ffff
 s_add_u32 s35, s35, 1
 s_cmp_eq_u32 s35, s36
 s_cselect_b32 s36, s47, s36
 s_cselect_b32 s35, 0, s35
 s_lshl_b32 s44, s34, 3
 s_add_u32 s44, s44, s4
 s_lshl_b32 s44, s44, 5
 s_add_u32 s44, s44, s32
 s_lshl_b32 s44, s44, 13
 s_add_u32 s44, s44, 0x5000000
 buffer_load_dwordx4 a[64:67], v1, s[20:23], s44 offen offset:0 sc1
 buffer_load_dwordx4 a[80:83], v1, s[20:23], s44 offen offset:1024 sc1
 buffer_load_dwordx4 a[68:71], v1, s[20:23], s44 offen offset:2048 sc1
 buffer_load_dwordx4 a[84:87], v1, s[20:23], s44 offen offset:3072 sc1
 s_add_u32 s44, s44, 4096
 buffer_load_dwordx4 a[72:75], v1, s[20:23], s44 offen offset:0 sc1
 buffer_load_dwordx4 a[88:91], v1, s[20:23], s44 offen offset:1024 sc1
 buffer_load_dwordx4 a[76:79], v1, s[20:23], s44 offen offset:2048 sc1
 buffer_load_dwordx4 a[92:95], v1, s[20:23], s44 offen offset:3072 sc1
 s_lshl_b32 s44, s34, 3
 s_add_u32 s44, s44, 7
 s_sub_u32 s44, s44, s4
 s_lshl_b32 s44, s44, 5
 s_add_u32 s44, s44, s32
 s_lshl_b32 s44, s44, 13
 s_add_u32 s44, s44, 0x5000000
 buffer_load_dwordx4 a[96:99], v1, s[20:23], s44 offen offset:0 sc1
 buffer_load_dwordx4 a[112:115], v1, s[20:23], s44 offen offset:1024 sc1
 buffer_load_dwordx4 a[100:103], v1, s[20:23], s44 offen offset:2048 sc1
 buffer_load_dwordx4 a[116:119], v1, s[20:23], s44 offen offset:3072 sc1
 s_add_u32 s44, s44, 4096
 buffer_load_dwordx4 a[104:107], v1, s[20:23], s44 offen offset:0 sc1
 buffer_load_dwordx4 a[120:123], v1, s[20:23], s44 offen offset:1024 sc1
 buffer_load_dwordx4 a[108:111], v1, s[20:23], s44 offen offset:2048 sc1
 buffer_load_dwordx4 a[124:127], v1, s[20:23], s44 offen offset:3072 sc1
 s_waitcnt vmcnt(40)
 s_barrier
 v_mov_b32 v2, v1
 ds_read_b128 a[128:131], v2 offset:0
 ds_read_b128 a[132:135], v2 offset:1024
 ds_read_b128 a[136:139], v2 offset:2048
 ds_read_b128 a[140:143], v2 offset:3072
 ds_read_b128 a[144:147], v2 offset:4096
 ds_read_b128 a[148:151], v2 offset:5120
 ds_read_b128 a[152:155], v2 offset:6144
 ds_read_b128 a[156:159], v2 offset:7168
 s_mov_b32 s39, 0
 s_add_u32 s39, s39, 0x4000
 s_and_b32 s39, s39, 0x1ffff
 v_mov_b32 v3, v2
 v_add_u32 v2, s39, v1
 s_mov_b32 s72, 0x8000000
Lablk_6:
 s_lshl_b32 s43, s33, 3
 s_add_u32 s41, s43, s4
 s_add_u32 s42, s43, 7
 s_sub_u32 s42, s42, s4
 s_mov_b32 s49, 0
 s_waitcnt lgkmcnt(0)
 v_mfma_f32_16x16x32_bf16 v[48:51], a[128:131], a[0:3], 0
 s_cmp_lt_u32 s49, s41
 v_mov_b64 v[176:177], 0
 v_mov_b64 v[178:179], 0
 v_mfma_f32_16x16x32_bf16 v[56:59], a[128:131], a[16:19], 0
 s_cselect_b64 s[68:69], -1, 0
 v_mov_b64 v[180:181], 0
 v_mov_b64 v[182:183], 0
 v_mfma_f32_16x16x32_bf16 v[64:67], a[128:131], a[32:35], 0
 v_mfma_f32_16x16x32_bf16 v[72:75], a[128:131], a[48:51], 0
 s_cmp_le_u32 s49, s41
 v_mov_b64 v[184:185], 0
 v_mov_b64 v[186:187], 0
 v_mfma_f32_16x16x32_bf16 v[48:51], a[136:139], a[4:7], v[48:51]
 v_mfma_f32_16x16x32_bf16 v[56:59], a[136:139], a[20:23], v[56:59]
 s_cselect_b64 s[70:71], -1, 0
 v_mov_b64 v[188:189], 0
 v_mov_b64 v[190:191], 0
 v_mfma_f32_16x16x32_bf16 v[64:67], a[136:139], a[36:39], v[64:67]
 v_mfma_f32_16x16x32_bf16 v[72:75], a[136:139], a[52:55], v[72:75]
 s_cmp_eq_u32 s49, s41
 v_mov_b64 v[192:193], 0
 v_mov_b64 v[194:195], 0
 v_mfma_f32_16x16x32_bf16 v[48:51], a[144:147], a[8:11], v[48:51]
 s_cselect_b64 s[60:61], s[52:53], s[68:69]
 v_mfma_f32_16x16x32_bf16 v[56:59], a[144:147], a[24:27], v[56:59]
 v_mov_b64 v[196:197], 0
 v_mov_b64 v[198:199], 0
 v_mfma_f32_16x16x32_bf16 v[64:67], a[144:147], a[40:43], v[64:67]
 s_cselect_b64 s[62:63], s[54:55], s[68:69]
 v_mfma_f32_16x16x32_bf16 v[72:75], a[144:147], a[56:59], v[72:75]
 v_mov_b64 v[200:201], 0
 v_mov_b64 v[202:203], 0
 v_mfma_f32_16x16x32_bf16 v[48:51], a[152:155], a[12:15], v[48:51]
 s_cselect_b64 s[64:65], s[56:57], s[68:69]
 v_mfma_f32_16x16x32_bf16 v[56:59], a[152:155], a[28:31], v[56:59]
 v_mov_b64 v[204:205], 0
 v_mov_b64 v[206:207], 0
 v_mfma_f32_16x16x32_bf16 v[64:67], a[152:155], a[44:47], v[64:67]
 s_cselect_b64 s[66:67], s[58:59], s[68:69]
 v_mfma_f32_16x16x32_bf16 v[72:75], a[152:155], a[60:63], v[72:75]
 s_nop 4
 v_max3_f32 v12, v48, v49, v50
 v_max3_f32 v13, v56, v57, v58
 v_max3_f32 v14, v64, v65, v66
 v_max3_f32 v15, v72, v73, v74
 v_max_f32 v12, v12, v51
 v_max_f32 v13, v13, v59
 v_max_f32 v14, v14, v67
 v_max_f32 v15, v15, v75
 v_mov_b32 v6, v12
 v_mov_b32 v7, v13
 v_mov_b32 v8, v14
 v_mov_b32 v9, v15
 v_permlane16_swap_b32 v12, v6
 v_permlane16_swap_b32 v13, v7
 v_permlane16_swap_b32 v14, v8
 v_permlane16_swap_b32 v15, v9
 v_max_f32 v12, v12, v6
 v_max_f32 v13, v13, v7
 v_max_f32 v14, v14, v8
 v_max_f32 v15, v15, v9
 v_mov_b32 v6, v12
 v_mov_b32 v7, v13
 v_mov_b32 v8, v14
 v_mov_b32 v9, v15
 v_permlane32_swap_b32 v12, v6
 v_permlane32_swap_b32 v13, v7
 v_permlane32_swap_b32 v14, v8
 v_permlane32_swap_b32 v15, v9
 v_max_f32 v12, v12, v6
 v_max_f32 v13, v13, v7
 v_max_f32 v14, v14, v8
 v_max_f32 v15, v15, v9
 v_sub_f32 v12, 0, v12
 v_sub_f32 v13, 0, v13
 v_sub_f32 v14, 0, v14
 v_sub_f32 v15, 0, v15
 v_cndmask_b32 v80, v4, v12, s[60:61]
 v_cndmask_b32 v81, v4, v12, s[62:63]
 v_cndmask_b32 v82, v4, v12, s[64:65]
 v_cndmask_b32 v83, v4, v12, s[66:67]
 v_cndmask_b32 v84, v4, v12, s[68:69]
 v_cndmask_b32 v85, v4, v12, s[68:69]
 v_cndmask_b32 v86, v4, v12, s[68:69]
 v_cndmask_b32 v87, v4, v12, s[68:69]
 v_cndmask_b32 v88, v4, v13, s[70:71]
 v_cndmask_b32 v89, v4, v13, s[70:71]
 v_cndmask_b32 v90, v4, v13, s[70:71]
 v_cndmask_b32 v91, v4, v13, s[70:71]
 v_cndmask_b32 v92, v4, v13, s[60:61]
 v_cndmask_b32 v93, v4, v13, s[62:63]
 v_cndmask_b32 v94, v4, v13, s[64:65]
 v_cndmask_b32 v95, v4, v13, s[66:67]
 v_mov_b32 v96, v14
 v_mov_b32 v97, v14
 v_mov_b32 v98, v14
 v_mov_b32 v99, v14
 v_mov_b32 v100, v14
 v_mov_b32 v101, v14
 v_mov_b32 v102, v14
 v_mov_b32 v103, v14
 v_mov_b32 v104, v15
 v_mov_b32 v105, v15
 v_mov_b32 v106, v15
 v_mov_b32 v107, v15
 v_mov_b32 v108, v15
 v_mov_b32 v109, v15
 v_mov_b32 v110, v15
 v_mov_b32 v111, v15
 v_mov_b32 v6, 1
 s_waitcnt lgkmcnt(0)
 v_mfma_f32_16x16x32_bf16 v[48:51], a[128:131], a[0:3], v[80:83]
 ds_read_b128 a[160:163], v3 offset:8192
 v_mov_b64 v[208:209], 0
 v_mov_b64 v[210:211], 0
 v_mfma_f32_16x16x32_bf16 v[56:59], a[128:131], a[16:19], v[88:91]
 v_mov_b64 v[212:213], 0
 v_mov_b64 v[214:215], 0
 v_mfma_f32_16x16x32_bf16 v[52:55], a[132:135], a[0:3], v[84:87]
 ds_read_b128 a[164:167], v3 offset:9216
 v_mfma_f32_16x16x32_bf16 v[60:63], a[132:135], a[16:19], v[92:95]
 v_mov_b64 v[216:217], 0
 v_mov_b64 v[218:219], 0
 v_mfma_f32_16x16x32_bf16 v[48:51], a[136:139], a[4:7], v[48:51]
 ds_read_b128 a[168:171], v3 offset:10240
 v_mov_b64 v[220:221], 0
 v_mov_b64 v[222:223], 0
 v_mfma_f32_16x16x32_bf16 v[56:59], a[136:139], a[20:23], v[56:59]
 v_mfma_f32_16x16x32_bf16 v[52:55], a[140:143], a[4:7], v[52:55]
 ds_read_b128 a[172:175], v3 offset:11264
 v_mov_b64 v[224:225], 0
 v_mov_b64 v[226:227], 0
 v_mfma_f32_16x16x32_bf16 v[60:63], a[140:143], a[20:23], v[60:63]
 v_mov_b64 v[228:229], 0
 v_mov_b64 v[230:231], 0
 v_mfma_f32_16x16x32_bf16 v[48:51], a[144:147], a[8:11], v[48:51]
 ds_read_b128 a[176:179], v3 offset:12288
 v_mfma_f32_16x16x32_bf16 v[56:59], a[144:147], a[24:27], v[56:59]
 v_mov_b64 v[232:233], 0
 v_mov_b64 v[234:235], 0
 v_mfma_f32_16x16x32_bf16 v[52:55], a[148:151], a[8:11], v[52:55]
 ds_read_b128 a[180:183], v3 offset:13312
 v_mov_b64 v[236:237], 0
 v_mov_b64 v[238:239], 0
 v_mfma_f32_16x16x32_bf16 v[60:63], a[148:151], a[24:27], v[60:63]
 v_mfma_f32_16x16x32_bf16 v[48:51], a[152:155], a[12:15], v[48:51]
 ds_read_b128 a[184:187], v3 offset:14336
 v_mov_b64 v[40:41], 0
 v_mov_b64 v[42:43], 0
 v_mfma_f32_16x16x32_bf16 v[56:59], a[152:155], a[28:31], v[56:59]
 v_mov_b64 v[44:45], 0
 v_mov_b64 v[46:47], 0
 v_mfma_f32_16x16x32_bf16 v[52:55], a[156:159], a[12:15], v[52:55]
 ds_read_b128 a[188:191], v3 offset:15360
 v_mfma_f32_16x16x32_bf16 v[60:63], a[156:159], a[28:31], v[60:63]
 v_mfma_f32_16x16x32_bf16 v[64:67], a[128:131], a[32:35], v[96:99]
 s_waitcnt vmcnt(0)
 s_barrier
 buffer_store_dword v6, v5, s[20:23], s72 offen sc1
 v_mfma_f32_16x16x32_bf16 v[72:75], a[128:131], a[48:51], v[104:107]
 ds_read_b128 a[128:131], v2 offset:0
 v_mfma_f32_16x16x32_bf16 v[68:71], a[132:135], a[32:35], v[100:103]
 s_add_u32 s49, s49, 1
 v_mfma_f32_16x16x32_bf16 v[76:79], a[132:135], a[48:51], v[108:111]
 ds_read_b128 a[132:135], v2 offset:1024
 v_exp_f32 v48, v48
 v_exp_f32 v49, v49
 v_mfma_f32_16x16x32_bf16 v[64:67], a[136:139], a[36:39], v[64:67]
 s_cmp_lt_u32 s49, s41
 v_exp_f32 v52, v52
 v_exp_f32 v53, v53
 v_mfma_f32_16x16x32_bf16 v[72:75], a[136:139], a[52:55], v[72:75]
 ds_read_b128 a[136:139], v2 offset:2048
 v_exp_f32 v50, v50
 v_mfma_f32_16x16x32_bf16 v[68:71], a[140:143], a[36:39], v[68:71]
 s_cselect_b64 s[68:69], -1, 0
 v_cvt_pk_bf16_f32 v16, v48, v49
 v_cvt_pk_bf16_f32 v17, v52, v53
 v_exp_f32 v51, v51
 v_mfma_f32_16x16x32_bf16 v[76:79], a[140:143], a[52:55], v[76:79]
 ds_read_b128 a[140:143], v2 offset:3072
 v_exp_f32 v54, v54
 v_exp_f32 v55, v55
 v_mfma_f32_16x16x32_bf16 v[64:67], a[144:147], a[40:43], v[64:67]
 v_cvt_pk_bf16_f32 v18, v50, v51
 v_cvt_pk_bf16_f32 v19, v54, v55
 v_mfma_f32_16x16x32_bf16 v[72:75], a[144:147], a[56:59], v[72:75]
 ds_read_b128 a[144:147], v2 offset:4096
 v_exp_f32 v56, v56
 v_exp_f32 v57, v57
 v_mfma_f32_16x16x32_bf16 v[68:71], a[148:151], a[40:43], v[68:71]
 s_cmp_le_u32 s49, s41
 v_exp_f32 v60, v60
 v_exp_f32 v61, v61
 v_mfma_f32_16x16x32_bf16 v[76:79], a[148:151], a[56:59], v[76:79]
 ds_read_b128 a[148:151], v2 offset:5120
 v_exp_f32 v58, v58
 v_mfma_f32_16x16x32_bf16 v[64:67], a[152:155], a[44:47], v[64:67]
 s_cselect_b64 s[70:71], -1, 0
 v_cvt_pk_bf16_f32 v20, v56, v57
 v_cvt_pk_bf16_f32 v21, v60, v61
 v_exp_f32 v59, v59
 v_mfma_f32_16x16x32_bf16 v[72:75], a[152:155], a[60:63], v[72:75]
 ds_read_b128 a[152:155], v2 offset:6144
 v_exp_f32 v62, v62
 v_exp_f32 v63, v63
 v_mfma_f32_16x16x32_bf16 v[68:71], a[156:159], a[44:47], v[68:71]
 v_cvt_pk_bf16_f32 v22, v58, v59
 v_cvt_pk_bf16_f32 v23, v62, v63
 v_mfma_f32_16x16x32_bf16 v[76:79], a[156:159], a[60:63], v[76:79]
 ds_read_b128 a[156:159], v2 offset:7168
 s_waitcnt lgkmcnt(8)
 v_mfma_f32_16x16x32_bf16 v[112:115], a[160:163], v[16:19], 0
 s_add_u32 s39, s39, 0x4000
 s_and_b32 s39, s39, 0x1ffff
 v_mfma_f32_16x16x32_bf16 v[144:147], a[160:163], v[20:23], 0
 s_cmp_eq_u32 s49, s41
 v_mfma_f32_16x16x32_bf16 v[116:119], a[164:167], v[16:19], 0
 s_cselect_b64 s[60:61], s[52:53], s[68:69]
 v_mfma_f32_16x16x32_bf16 v[148:151], a[164:167], v[20:23], 0
 s_cselect_b64 s[62:63], s[54:55], s[68:69]
 v_mov_b32 v3, v2
 v_add_u32 v2, s39, v1
 v_exp_f32 v64, v64
 v_mfma_f32_16x16x32_bf16 v[120:123], a[168:171], v[16:19], 0
 s_cselect_b64 s[64:65], s[56:57], s[68:69]
 v_exp_f32 v65, v65
 v_mfma_f32_16x16x32_bf16 v[152:155], a[168:171], v[20:23], 0
 s_cselect_b64 s[66:67], s[58:59], s[68:69]
 v_exp_f32 v68, v68
 v_mfma_f32_16x16x32_bf16 v[124:127], a[172:175], v[16:19], 0
 s_lshl_b32 s37, s35, 19
 v_exp_f32 v69, v69
 v_exp_f32 v66, v66
 v_mfma_f32_16x16x32_bf16 v[156:159], a[172:175], v[20:23], 0
 s_add_u32 m0, s38, s50
 v_cvt_pk_bf16_f32 v24, v64, v65
 v_cvt_pk_bf16_f32 v25, v68, v69
 v_mfma_f32_16x16x32_bf16 v[128:131], a[176:179], v[16:19], 0
 s_add_u32 s37, s37, s45
 v_exp_f32 v67, v67
 v_mfma_f32_16x16x32_bf16 v[160:163], a[176:179], v[20:23], 0
 buffer_load_dwordx4 v1, s[20:23], s37 offen offset:0 sc1 lds
 buffer_load_dwordx4 v1, s[20:23], s37 offen offset:1024 sc1 lds
 v_exp_f32 v70, v70
 v_mfma_f32_16x16x32_bf16 v[132:135], a[180:183], v[16:19], 0
 buffer_load_dwordx4 v1, s[20:23], s37 offen offset:2048 sc1 lds
 v_exp_f32 v71, v71
 v_cvt_pk_bf16_f32 v26, v66, v67
 v_cvt_pk_bf16_f32 v27, v70, v71
 v_mfma_f32_16x16x32_bf16 v[164:167], a[180:183], v[20:23], 0
 buffer_load_dwordx4 v1, s[20:23], s37 offen offset:3072 sc1 lds
 v_cndmask_b32 v80, v4, v12, s[60:61]
 v_cndmask_b32 v81, v4, v12, s[62:63]
 v_mfma_f32_16x16x32_bf16 v[136:139], a[184:187], v[16:19], 0
 s_add_u32 s38, s38, 0x4000
 v_cndmask_b32 v82, v4, v12, s[64:65]
 v_cndmask_b32 v83, v4, v12, s[66:67]
 v_mfma_f32_16x16x32_bf16 v[168:171], a[184:187], v[20:23], 0
 s_and_b32 s38, s38, 0x1ffff
 v_cndmask_b32 v84, v4, v12, s[68:69]
 v_cndmask_b32 v85, v4, v12, s[68:69]
 v_mfma_f32_16x16x32_bf16 v[140:143], a[188:191], v[16:19], 0
 s_add_u32 s35, s35, 1
 v_cndmask_b32 v86, v4, v12, s[68:69]
 v_cndmask_b32 v87, v4, v12, s[68:69]
 v_cndmask_b32 v88, v4, v13, s[70:71]
 v_cndmask_b32 v89, v4, v13, s[70:71]
 v_mfma_f32_16x16x32_bf16 v[172:175], a[188:191], v[20:23], 0
 s_cmp_eq_u32 s35, s36
 v_cndmask_b32 v90, v4, v13, s[70:71]
 v_cndmask_b32 v91, v4, v13, s[70:71]
 v_mfma_f32_16x16x32_bf16 v[32:35], a[192:195], v[16:19], 0
 s_cselect_b32 s36, s47, s36
 v_cndmask_b32 v92, v4, v13, s[60:61]
 v_cndmask_b32 v93, v4, v13, s[62:63]
 v_mfma_f32_16x16x32_bf16 v[36:39], a[192:195], v[20:23], 0
 s_cselect_b32 s35, 0, s35
 v_cndmask_b32 v94, v4, v13, s[64:65]
 v_cndmask_b32 v95, v4, v13, s[66:67]
 s_cmp_eq_u32 s43, 0
 s_cbranch_scc1 Lamk_11
 s_sub_u32 s40, s43, 1
 .p2align 3
Lapl_10:
 s_waitcnt lgkmcnt(0)
 v_mfma_f32_16x16x32_bf16 v[48:51], a[128:131], a[0:3], v[80:83]
 v_exp_f32 v72, v72
 v_mfma_f32_16x16x32_bf16 v[56:59], a[128:131], a[16:19], v[88:91]
 v_exp_f32 v73, v73
 v_mfma_f32_16x16x32_bf16 v[52:55], a[132:135], a[0:3], v[84:87]
 v_mfma_f32_16x16x32_bf16 v[60:63], a[132:135], a[16:19], v[92:95]
 v_exp_f32 v76, v76
 v_mfma_f32_16x16x32_bf16 v[48:51], a[136:139], a[4:7], v[48:51]
 v_exp_f32 v77, v77
 v_mfma_f32_16x16x32_bf16 v[56:59], a[136:139], a[20:23], v[56:59]
 v_mfma_f32_16x16x32_bf16 v[52:55], a[140:143], a[4:7], v[52:55]
 v_exp_f32 v74, v74
 v_mfma_f32_16x16x32_bf16 v[60:63], a[140:143], a[20:23], v[60:63]
 v_cvt_pk_bf16_f32 v28, v72, v73
 v_cvt_pk_bf16_f32 v29, v76, v77
 v_mfma_f32_16x16x32_bf16 v[48:51], a[144:147], a[8:11], v[48:51]
 v_mfma_f32_16x16x32_bf16 v[56:59], a[144:147], a[24:27], v[56:59]
 v_exp_f32 v75, v75
 v_mfma_f32_16x16x32_bf16 v[52:55], a[148:151], a[8:11], v[52:55]
 v_exp_f32 v78, v78
 v_mfma_f32_16x16x32_bf16 v[60:63], a[148:151], a[24:27], v[60:63]
 v_mfma_f32_16x16x32_bf16 v[48:51], a[152:155], a[12:15], v[48:51]
 v_exp_f32 v79, v79
 v_mfma_f32_16x16x32_bf16 v[56:59], a[152:155], a[28:31], v[56:59]
 v_cvt_pk_bf16_f32 v30, v74, v75
 v_cvt_pk_bf16_f32 v31, v78, v79
 v_mfma_f32_16x16x32_bf16 v[52:55], a[156:159], a[12:15], v[52:55]
 v_mfma_f32_16x16x32_bf16 v[60:63], a[156:159], a[28:31], v[60:63]
 v_mfma_f32_16x16x32_bf16 v[176:179], a[160:163], v[24:27], v[176:179]
 v_mfma_f32_16x16x32_bf16 v[208:211], a[160:163], v[28:31], v[208:211]
 ds_read_b128 a[160:163], v3 offset:8192
 v_mfma_f32_16x16x32_bf16 v[180:183], a[164:167], v[24:27], v[180:183]
 v_mfma_f32_16x16x32_bf16 v[212:215], a[164:167], v[28:31], v[212:215]
 ds_read_b128 a[164:167], v3 offset:9216
 v_exp_f32 v48, v48
 v_mfma_f32_16x16x32_bf16 v[184:187], a[168:171], v[24:27], v[184:187]
 v_exp_f32 v49, v49
 v_mfma_f32_16x16x32_bf16 v[216:219], a[168:171], v[28:31], v[216:219]
 ds_read_b128 a[168:171], v3 offset:10240
 v_exp_f32 v52, v52
 v_mfma_f32_16x16x32_bf16 v[188:191], a[172:175], v[24:27], v[188:191]
 v_mfma_f32_16x16x32_bf16 v[220:223], a[172:175], v[28:31], v[220:223]
 ds_read_b128 a[172:175], v3 offset:11264
 v_exp_f32 v53, v53
 v_mfma_f32_16x16x32_bf16 v[192:195], a[176:179], v[24:27], v[192:195]
 v_exp_f32 v50, v50
 v_mfma_f32_16x16x32_bf16 v[224:227], a[176:179], v[28:31], v[224:227]
 ds_read_b128 a[176:179], v3 offset:12288
 v_mfma_f32_16x16x32_bf16 v[196:199], a[180:183], v[24:27], v[196:199]
 v_cvt_pk_bf16_f32 v16, v48, v49
 v_cvt_pk_bf16_f32 v17, v52, v53
 v_mfma_f32_16x16x32_bf16 v[228:231], a[180:183], v[28:31], v[228:231]
 ds_read_b128 a[180:183], v3 offset:13312
 v_exp_f32 v51, v51
 v_mfma_f32_16x16x32_bf16 v[200:203], a[184:187], v[24:27], v[200:203]
 v_exp_f32 v54, v54
 v_mfma_f32_16x16x32_bf16 v[232:235], a[184:187], v[28:31], v[232:235]
 ds_read_b128 a[184:187], v3 offset:14336
 v_mfma_f32_16x16x32_bf16 v[204:207], a[188:191], v[24:27], v[204:207]
 v_exp_f32 v55, v55
 v_mfma_f32_16x16x32_bf16 v[236:239], a[188:191], v[28:31], v[236:239]
 ds_read_b128 a[188:191], v3 offset:15360
 v_cvt_pk_bf16_f32 v18, v50, v51
 v_cvt_pk_bf16_f32 v19, v54, v55
 v_mfma_f32_16x16x32_bf16 v[40:43], a[192:195], v[24:27], v[40:43]
 v_mfma_f32_16x16x32_bf16 v[44:47], a[192:195], v[28:31], v[44:47]
 v_mfma_f32_16x16x32_bf16 v[64:67], a[128:131], a[32:35], v[96:99]
 s_waitcnt vmcnt(20)
 s_barrier
 v_exp_f32 v56, v56
 v_mfma_f32_16x16x32_bf16 v[72:75], a[128:131], a[48:51], v[104:107]
 ds_read_b128 a[128:131], v2 offset:0
 v_exp_f32 v57, v57
 v_mfma_f32_16x16x32_bf16 v[68:71], a[132:135], a[32:35], v[100:103]
 s_add_u32 s39, s39, 0x4000
 v_mfma_f32_16x16x32_bf16 v[76:79], a[132:135], a[48:51], v[108:111]
 ds_read_b128 a[132:135], v2 offset:1024
 v_exp_f32 v60, v60
 v_mfma_f32_16x16x32_bf16 v[64:67], a[136:139], a[36:39], v[64:67]
 v_exp_f32 v61, v61
 v_mfma_f32_16x16x32_bf16 v[72:75], a[136:139], a[52:55], v[72:75]
 ds_read_b128 a[136:139], v2 offset:2048
 v_mfma_f32_16x16x32_bf16 v[68:71], a[140:143], a[36:39], v[68:71]
 v_exp_f32 v58, v58
 v_mfma_f32_16x16x32_bf16 v[76:79], a[140:143], a[52:55], v[76:79]
 ds_read_b128 a[140:143], v2 offset:3072
 v_cvt_pk_bf16_f32 v20, v56, v57
 v_cvt_pk_bf16_f32 v21, v60, v61
 v_mfma_f32_16x16x32_bf16 v[64:67], a[144:147], a[40:43], v[64:67]
 s_and_b32 s39, s39, 0x1ffff
 v_mfma_f32_16x16x32_bf16 v[72:75], a[144:147], a[56:59], v[72:75]
 ds_read_b128 a[144:147], v2 offset:4096
 v_exp_f32 v59, v59
 v_mfma_f32_16x16x32_bf16 v[68:71], a[148:151], a[40:43], v[68:71]
 v_exp_f32 v62, v62
 v_mfma_f32_16x16x32_bf16 v[76:79], a[148:151], a[56:59], v[76:79]
 ds_read_b128 a[148:151], v2 offset:5120
 v_mfma_f32_16x16x32_bf16 v[64:67], a[152:155], a[44:47], v[64:67]
 v_exp_f32 v63, v63
 v_mfma_f32_16x16x32_bf16 v[72:75], a[152:155], a[60:63], v[72:75]
 ds_read_b128 a[152:155], v2 offset:6144
 v_cvt_pk_bf16_f32 v22, v58, v59
 v_cvt_pk_bf16_f32 v23, v62, v63
 v_mfma_f32_16x16x32_bf16 v[68:71], a[156:159], a[44:47], v[68:71]
 v_mfma_f32_16x16x32_bf16 v[76:79], a[156:159], a[60:63], v[76:79]
 ds_read_b128 a[156:159], v2 offset:7168
 s_waitcnt lgkmcnt(8)
 v_mfma_f32_16x16x32_bf16 v[112:115], a[160:163], v[16:19], v[112:115]
 s_lshl_b32 s37, s35, 19
 v_mov_b32 v3, v2
 v_add_u32 v2, s39, v1
 v_mfma_f32_16x16x32_bf16 v[144:147], a[160:163], v[20:23], v[144:147]
 s_add_u32 m0, s38, s50
 v_mfma_f32_16x16x32_bf16 v[116:119], a[164:167], v[16:19], v[116:119]
 s_add_u32 s37, s37, s45
 v_mfma_f32_16x16x32_bf16 v[148:151], a[164:167], v[20:23], v[148:151]
 buffer_load_dwordx4 v1, s[20:23], s37 offen offset:0 sc1 lds
 v_exp_f32 v64, v64
 v_mfma_f32_16x16x32_bf16 v[120:123], a[168:171], v[16:19], v[120:123]
 buffer_load_dwordx4 v1, s[20:23], s37 offen offset:1024 sc1 lds
 v_mfma_f32_16x16x32_bf16 v[152:155], a[168:171], v[20:23], v[152:155]
 v_exp_f32 v65, v65
 v_mfma_f32_16x16x32_bf16 v[124:127], a[172:175], v[16:19], v[124:127]
 buffer_load_dwordx4 v1, s[20:23], s37 offen offset:2048 sc1 lds
 v_exp_f32 v68, v68
 v_mfma_f32_16x16x32_bf16 v[156:159], a[172:175], v[20:23], v[156:159]
 buffer_load_dwordx4 v1, s[20:23], s37 offen offset:3072 sc1 lds
 v_exp_f32 v69, v69
 v_mfma_f32_16x16x32_bf16 v[128:131], a[176:179], v[16:19], v[128:131]
 s_add_u32 s38, s38, 0x4000
 v_mfma_f32_16x16x32_bf16 v[160:163], a[176:179], v[20:23], v[160:163]
 s_and_b32 s38, s38, 0x1ffff
 v_exp_f32 v66, v66
 v_mfma_f32_16x16x32_bf16 v[132:135], a[180:183], v[16:19], v[132:135]
 s_add_u32 s35, s35, 1
 v_cvt_pk_bf16_f32 v24, v64, v65
 v_cvt_pk_bf16_f32 v25, v68, v69
 v_mfma_f32_16x16x32_bf16 v[164:167], a[180:183], v[20:23], v[164:167]
 v_exp_f32 v67, v67
 v_mfma_f32_16x16x32_bf16 v[136:139], a[184:187], v[16:19], v[136:139]
 s_cmp_eq_u32 s35, s36
 v_mfma_f32_16x16x32_bf16 v[168:171], a[184:187], v[20:23], v[168:171]
 s_cselect_b32 s36, s47, s36
 v_exp_f32 v70, v70
 v_mfma_f32_16x16x32_bf16 v[140:143], a[188:191], v[16:19], v[140:143]
 s_cselect_b32 s35, 0, s35
 v_exp_f32 v71, v71
 v_mfma_f32_16x16x32_bf16 v[172:175], a[188:191], v[20:23], v[172:175]
 s_add_u32 s49, s49, 1
 v_cvt_pk_bf16_f32 v26, v66, v67
 v_cvt_pk_bf16_f32 v27, v70, v71
 v_mfma_f32_16x16x32_bf16 v[32:35], a[192:195], v[16:19], v[32:35]
 s_cmp_lt_u32 s49, s40
 v_mfma_f32_16x16x32_bf16 v[36:39], a[192:195], v[20:23], v[36:39]
 s_cbranch_scc1 Lapl_10
Lamk_11:
 s_add_u32 s40, s43, 4
 .p2align 3
Lamk_13:
 s_waitcnt lgkmcnt(0)
 v_mfma_f32_16x16x32_bf16 v[48:51], a[128:131], a[0:3], v[80:83]
 s_add_u32 s49, s49, 1
 v_exp_f32 v72, v72
 v_mfma_f32_16x16x32_bf16 v[56:59], a[128:131], a[16:19], v[88:91]
 s_cmp_lt_u32 s49, s41
 v_exp_f32 v73, v73
 v_mfma_f32_16x16x32_bf16 v[52:55], a[132:135], a[0:3], v[84:87]
 v_mfma_f32_16x16x32_bf16 v[60:63], a[132:135], a[16:19], v[92:95]
 s_cselect_b64 s[68:69], -1, 0
 v_exp_f32 v76, v76
 v_mfma_f32_16x16x32_bf16 v[48:51], a[136:139], a[4:7], v[48:51]
 s_cmp_le_u32 s49, s41
 v_exp_f32 v77, v77
 v_mfma_f32_16x16x32_bf16 v[56:59], a[136:139], a[20:23], v[56:59]
 v_mfma_f32_16x16x32_bf16 v[52:55], a[140:143], a[4:7], v[52:55]
 s_cselect_b64 s[70:71], -1, 0
 v_exp_f32 v74, v74
 v_mfma_f32_16x16x32_bf16 v[60:63], a[140:143], a[20:23], v[60:63]
 v_cvt_pk_bf16_f32 v28, v72, v73
 v_cvt_pk_bf16_f32 v29, v76, v77
 v_mfma_f32_16x16x32_bf16 v[48:51], a[144:147], a[8:11], v[48:51]
 s_cmp_eq_u32 s49, s41
 v_mfma_f32_16x16x32_bf16 v[56:59], a[144:147], a[24:27], v[56:59]
 s_cselect_b64 s[60:61], s[52:53], s[68:69]
 v_exp_f32 v75, v75
 v_mfma_f32_16x16x32_bf16 v[52:55], a[148:151], a[8:11], v[52:55]
 v_exp_f32 v78, v78
 v_mfma_f32_16x16x32_bf16 v[60:63], a[148:151], a[24:27], v[60:63]
 s_cselect_b64 s[62:63], s[54:55], s[68:69]
 v_mfma_f32_16x16x32_bf16 v[48:51], a[152:155], a[12:15], v[48:51]
 s_cselect_b64 s[64:65], s[56:57], s[68:69]
 v_exp_f32 v79, v79
 v_mfma_f32_16x16x32_bf16 v[56:59], a[152:155], a[28:31], v[56:59]
 v_cvt_pk_bf16_f32 v30, v74, v75
 v_cvt_pk_bf16_f32 v31, v78, v79
 v_mfma_f32_16x16x32_bf16 v[52:55], a[156:159], a[12:15], v[52:55]
 s_cselect_b64 s[66:67], s[58:59], s[68:69]
 v_mfma_f32_16x16x32_bf16 v[60:63], a[156:159], a[28:31], v[60:63]
 v_mfma_f32_16x16x32_bf16 v[176:179], a[160:163], v[24:27], v[176:179]
 v_mfma_f32_16x16x32_bf16 v[208:211], a[160:163], v[28:31], v[208:211]
 ds_read_b128 a[160:163], v3 offset:8192
 v_mfma_f32_16x16x32_bf16 v[180:183], a[164:167], v[24:27], v[180:183]
 v_mfma_f32_16x16x32_bf16 v[212:215], a[164:167], v[28:31], v[212:215]
 ds_read_b128 a[164:167], v3 offset:9216
 v_exp_f32 v48, v48
 v_mfma_f32_16x16x32_bf16 v[184:187], a[168:171], v[24:27], v[184:187]
 v_exp_f32 v49, v49
 v_mfma_f32_16x16x32_bf16 v[216:219], a[168:171], v[28:31], v[216:219]
 ds_read_b128 a[168:171], v3 offset:10240
 v_exp_f32 v52, v52
 v_mfma_f32_16x16x32_bf16 v[188:191], a[172:175], v[24:27], v[188:191]
 v_exp_f32 v53, v53
 v_mfma_f32_16x16x32_bf16 v[220:223], a[172:175], v[28:31], v[220:223]
 ds_read_b128 a[172:175], v3 offset:11264
 v_exp_f32 v50, v50
 v_mfma_f32_16x16x32_bf16 v[192:195], a[176:179], v[24:27], v[192:195]
 v_cvt_pk_bf16_f32 v16, v48, v49
 v_cvt_pk_bf16_f32 v17, v52, v53
 v_mfma_f32_16x16x32_bf16 v[224:227], a[176:179], v[28:31], v[224:227]
 ds_read_b128 a[176:179], v3 offset:12288
 v_exp_f32 v51, v51
 v_mfma_f32_16x16x32_bf16 v[196:199], a[180:183], v[24:27], v[196:199]
 v_exp_f32 v54, v54
 v_mfma_f32_16x16x32_bf16 v[228:231], a[180:183], v[28:31], v[228:231]
 ds_read_b128 a[180:183], v3 offset:13312
 v_exp_f32 v55, v55
 v_mfma_f32_16x16x32_bf16 v[200:203], a[184:187], v[24:27], v[200:203]
 v_cvt_pk_bf16_f32 v18, v50, v51
 v_cvt_pk_bf16_f32 v19, v54, v55
 v_mfma_f32_16x16x32_bf16 v[232:235], a[184:187], v[28:31], v[232:235]
 ds_read_b128 a[184:187], v3 offset:14336
 v_cndmask_b32 v80, v4, v12, s[60:61]
 v_cndmask_b32 v81, v4, v12, s[62:63]
 v_mfma_f32_16x16x32_bf16 v[204:207], a[188:191], v[24:27], v[204:207]
 v_cndmask_b32 v82, v4, v12, s[64:65]
 v_cndmask_b32 v83, v4, v12, s[66:67]
 v_mfma_f32_16x16x32_bf16 v[236:239], a[188:191], v[28:31], v[236:239]
 ds_read_b128 a[188:191], v3 offset:15360
 v_cndmask_b32 v84, v4, v12, s[68:69]
 v_cndmask_b32 v85, v4, v12, s[68:69]
 v_mfma_f32_16x16x32_bf16 v[40:43], a[192:195], v[24:27], v[40:43]
 v_cndmask_b32 v86, v4, v12, s[68:69]
 v_cndmask_b32 v87, v4, v12, s[68:69]
 v_mfma_f32_16x16x32_bf16 v[44:47], a[192:195], v[28:31], v[44:47]
 v_mfma_f32_16x16x32_bf16 v[64:67], a[128:131], a[32:35], v[96:99]
 s_waitcnt vmcnt(20)
 s_barrier
 v_exp_f32 v56, v56
 v_mfma_f32_16x16x32_bf16 v[72:75], a[128:131], a[48:51], v[104:107]
 ds_read_b128 a[128:131], v2 offset:0
 v_exp_f32 v57, v57
 v_mfma_f32_16x16x32_bf16 v[68:71], a[132:135], a[32:35], v[100:103]
 s_add_u32 s39, s39, 0x4000
 v_exp_f32 v60, v60
 v_mfma_f32_16x16x32_bf16 v[76:79], a[132:135], a[48:51], v[108:111]
 ds_read_b128 a[132:135], v2 offset:1024
 v_exp_f32 v61, v61
 v_mfma_f32_16x16x32_bf16 v[64:67], a[136:139], a[36:39], v[64:67]
 v_exp_f32 v58, v58
 v_mfma_f32_16x16x32_bf16 v[72:75], a[136:139], a[52:55], v[72:75]
 ds_read_b128 a[136:139], v2 offset:2048
 v_cvt_pk_bf16_f32 v20, v56, v57
 v_cvt_pk_bf16_f32 v21, v60, v61
 v_mfma_f32_16x16x32_bf16 v[68:71], a[140:143], a[36:39], v[68:71]
 v_exp_f32 v59, v59
 v_mfma_f32_16x16x32_bf16 v[76:79], a[140:143], a[52:55], v[76:79]
 ds_read_b128 a[140:143], v2 offset:3072
 v_exp_f32 v62, v62
 v_mfma_f32_16x16x32_bf16 v[64:67], a[144:147], a[40:43], v[64:67]
 s_and_b32 s39, s39, 0x1ffff
 v_exp_f32 v63, v63
 v_mfma_f32_16x16x32_bf16 v[72:75], a[144:147], a[56:59], v[72:75]
 ds_read_b128 a[144:147], v2 offset:4096
 v_cvt_pk_bf16_f32 v22, v58, v59
 v_cvt_pk_bf16_f32 v23, v62, v63
 v_mfma_f32_16x16x32_bf16 v[68:71], a[148:151], a[40:43], v[68:71]
 v_cndmask_b32 v88, v4, v13, s[70:71]
 v_cndmask_b32 v89, v4, v13, s[70:71]
 v_mfma_f32_16x16x32_bf16 v[76:79], a[148:151], a[56:59], v[76:79]
 ds_read_b128 a[148:151], v2 offset:5120
 v_cndmask_b32 v90, v4, v13, s[70:71]
 v_cndmask_b32 v91, v4, v13, s[70:71]
 v_mfma_f32_16x16x32_bf16 v[64:67], a[152:155], a[44:47], v[64:67]
 v_cndmask_b32 v92, v4, v13, s[60:61]
 v_cndmask_b32 v93, v4, v13, s[62:63]
 v_mfma_f32_16x16x32_bf16 v[72:75], a[152:155], a[60:63], v[72:75]
 ds_read_b128 a[152:155], v2 offset:6144
 v_cndmask_b32 v94, v4, v13, s[64:65]
 v_cndmask_b32 v95, v4, v13, s[66:67]
 v_mfma_f32_16x16x32_bf16 v[68:71], a[156:159], a[44:47], v[68:71]
 v_mfma_f32_16x16x32_bf16 v[76:79], a[156:159], a[60:63], v[76:79]
 ds_read_b128 a[156:159], v2 offset:7168
 s_waitcnt lgkmcnt(8)
 v_mfma_f32_16x16x32_bf16 v[112:115], a[160:163], v[16:19], v[112:115]
 s_lshl_b32 s37, s35, 19
 v_mov_b32 v3, v2
 v_add_u32 v2, s39, v1
 v_mfma_f32_16x16x32_bf16 v[144:147], a[160:163], v[20:23], v[144:147]
 s_add_u32 m0, s38, s50
 v_mfma_f32_16x16x32_bf16 v[116:119], a[164:167], v[16:19], v[116:119]
 s_add_u32 s37, s37, s45
 v_mfma_f32_16x16x32_bf16 v[148:151], a[164:167], v[20:23], v[148:151]
 buffer_load_dwordx4 v1, s[20:23], s37 offen offset:0 sc1 lds
 v_exp_f32 v64, v64
 v_mfma_f32_16x16x32_bf16 v[120:123], a[168:171], v[16:19], v[120:123]
 v_mfma_f32_16x16x32_bf16 v[152:155], a[168:171], v[20:23], v[152:155]
 buffer_load_dwordx4 v1, s[20:23], s37 offen offset:1024 sc1 lds
 v_exp_f32 v65, v65
 v_mfma_f32_16x16x32_bf16 v[124:127], a[172:175], v[16:19], v[124:127]
 buffer_load_dwordx4 v1, s[20:23], s37 offen offset:2048 sc1 lds
 v_exp_f32 v68, v68
 v_mfma_f32_16x16x32_bf16 v[156:159], a[172:175], v[20:23], v[156:159]
 buffer_load_dwordx4 v1, s[20:23], s37 offen offset:3072 sc1 lds
 v_exp_f32 v69, v69
 v_mfma_f32_16x16x32_bf16 v[128:131], a[176:179], v[16:19], v[128:131]
 v_mfma_f32_16x16x32_bf16 v[160:163], a[176:179], v[20:23], v[160:163]
 s_add_u32 s38, s38, 0x4000
 v_exp_f32 v66, v66
 v_mfma_f32_16x16x32_bf16 v[132:135], a[180:183], v[16:19], v[132:135]
 s_and_b32 s38, s38, 0x1ffff
 v_cvt_pk_bf16_f32 v24, v64, v65
 v_cvt_pk_bf16_f32 v25, v68, v69
 v_mfma_f32_16x16x32_bf16 v[164:167], a[180:183], v[20:23], v[164:167]
 s_add_u32 s35, s35, 1
 v_exp_f32 v67, v67
 v_mfma_f32_16x16x32_bf16 v[136:139], a[184:187], v[16:19], v[136:139]
 s_cmp_eq_u32 s35, s36
 v_mfma_f32_16x16x32_bf16 v[168:171], a[184:187], v[20:23], v[168:171]
 v_exp_f32 v70, v70
 v_mfma_f32_16x16x32_bf16 v[140:143], a[188:191], v[16:19], v[140:143]
 s_cselect_b32 s36, s47, s36
 v_exp_f32 v71, v71
 v_mfma_f32_16x16x32_bf16 v[172:175], a[188:191], v[20:23], v[172:175]
 s_cselect_b32 s35, 0, s35
 v_cvt_pk_bf16_f32 v26, v66, v67
 v_cvt_pk_bf16_f32 v27, v70, v71
 v_mfma_f32_16x16x32_bf16 v[32:35], a[192:195], v[16:19], v[32:35]
 s_cmp_lt_u32 s49, s40
 v_mfma_f32_16x16x32_bf16 v[36:39], a[192:195], v[20:23], v[36:39]
 s_cbranch_scc1 Lamk_13
 s_add_u32 s40, s43, 8
 s_cmp_lt_u32 s49, s42
 s_cselect_b64 s[68:69], -1, 0
 s_cmp_le_u32 s49, s42
 s_cselect_b64 s[70:71], -1, 0
 s_cmp_eq_u32 s49, s42
 s_cselect_b64 s[60:61], s[52:53], s[68:69]
 s_cselect_b64 s[62:63], s[54:55], s[68:69]
 s_cselect_b64 s[64:65], s[56:57], s[68:69]
 s_cselect_b64 s[66:67], s[58:59], s[68:69]
 v_mfma_f32_16x16x32_bf16 v[176:179], a[160:163], v[24:27], v[176:179]
 v_cndmask_b32 v96, v4, v14, s[60:61]
 v_cndmask_b32 v97, v4, v14, s[62:63]
 v_mfma_f32_16x16x32_bf16 v[180:183], a[164:167], v[24:27], v[180:183]
 v_cndmask_b32 v98, v4, v14, s[64:65]
 v_cndmask_b32 v99, v4, v14, s[66:67]
 v_mfma_f32_16x16x32_bf16 v[184:187], a[168:171], v[24:27], v[184:187]
 v_cndmask_b32 v100, v4, v14, s[68:69]
 v_cndmask_b32 v101, v4, v14, s[68:69]
 v_mfma_f32_16x16x32_bf16 v[188:191], a[172:175], v[24:27], v[188:191]
 v_exp_f32 v72, v72
 v_mfma_f32_16x16x32_bf16 v[192:195], a[176:179], v[24:27], v[192:195]
 v_exp_f32 v73, v73
 v_mfma_f32_16x16x32_bf16 v[196:199], a[180:183], v[24:27], v[196:199]
 v_exp_f32 v76, v76
 v_mfma_f32_16x16x32_bf16 v[200:203], a[184:187], v[24:27], v[200:203]
 v_exp_f32 v77, v77
 v_mfma_f32_16x16x32_bf16 v[204:207], a[188:191], v[24:27], v[204:207]
 v_exp_f32 v74, v74
 v_mfma_f32_16x16x32_bf16 v[40:43], a[192:195], v[24:27], v[40:43]
 v_cndmask_b32 v102, v4, v14, s[68:69]
 v_cndmask_b32 v103, v4, v14, s[68:69]
 s_nop 0
 .p2align 3
Lam1_12:
 s_waitcnt lgkmcnt(0)
 v_mfma_f32_16x16x32_bf16 v[64:67], a[128:131], a[32:35], v[96:99]
 v_cvt_pk_bf16_f32 v28, v72, v73
 v_cvt_pk_bf16_f32 v29, v76, v77
 v_mfma_f32_16x16x32_bf16 v[68:71], a[132:135], a[32:35], v[100:103]
 v_exp_f32 v75, v75
 v_mfma_f32_16x16x32_bf16 v[64:67], a[136:139], a[36:39], v[64:67]
 v_exp_f32 v78, v78
 v_mfma_f32_16x16x32_bf16 v[68:71], a[140:143], a[36:39], v[68:71]
 v_exp_f32 v79, v79
 v_mfma_f32_16x16x32_bf16 v[64:67], a[144:147], a[40:43], v[64:67]
 v_cvt_pk_bf16_f32 v30, v74, v75
 v_cvt_pk_bf16_f32 v31, v78, v79
 v_mfma_f32_16x16x32_bf16 v[68:71], a[148:151], a[40:43], v[68:71]
 v_cndmask_b32 v104, v4, v15, s[70:71]
 v_cndmask_b32 v105, v4, v15, s[70:71]
 v_mfma_f32_16x16x32_bf16 v[64:67], a[152:155], a[44:47], v[64:67]
 v_mfma_f32_16x16x32_bf16 v[68:71], a[156:159], a[44:47], v[68:71]
 v_mfma_f32_16x16x32_bf16 v[208:211], a[160:163], v[28:31], v[208:211]
 ds_read_b128 a[160:163], v3 offset:8192
 v_cndmask_b32 v106, v4, v15, s[70:71]
 v_cndmask_b32 v107, v4, v15, s[70:71]
 v_mfma_f32_16x16x32_bf16 v[212:215], a[164:167], v[28:31], v[212:215]
 ds_read_b128 a[164:167], v3 offset:9216
 v_cndmask_b32 v108, v4, v15, s[60:61]
 v_cndmask_b32 v109, v4, v15, s[62:63]
 v_mfma_f32_16x16x32_bf16 v[216:219], a[168:171], v[28:31], v[216:219]
 ds_read_b128 a[168:171], v3 offset:10240
 v_cndmask_b32 v110, v4, v15, s[64:65]
 v_cndmask_b32 v111, v4, v15, s[66:67]
 v_mfma_f32_16x16x32_bf16 v[220:223], a[172:175], v[28:31], v[220:223]
 ds_read_b128 a[172:175], v3 offset:11264
 v_exp_f32 v64, v64
 v_mfma_f32_16x16x32_bf16 v[224:227], a[176:179], v[28:31], v[224:227]
 ds_read_b128 a[176:179], v3 offset:12288
 v_exp_f32 v65, v65
 v_mfma_f32_16x16x32_bf16 v[228:231], a[180:183], v[28:31], v[228:231]
 ds_read_b128 a[180:183], v3 offset:13312
 v_exp_f32 v68, v68
 v_mfma_f32_16x16x32_bf16 v[232:235], a[184:187], v[28:31], v[232:235]
 ds_read_b128 a[184:187], v3 offset:14336
 v_exp_f32 v69, v69
 v_mfma_f32_16x16x32_bf16 v[236:239], a[188:191], v[28:31], v[236:239]
 ds_read_b128 a[188:191], v3 offset:15360
 v_exp_f32 v66, v66
 v_mfma_f32_16x16x32_bf16 v[44:47], a[192:195], v[28:31], v[44:47]
 v_mfma_f32_16x16x32_bf16 v[72:75], a[128:131], a[48:51], v[104:107]
 s_waitcnt vmcnt(20)
 s_barrier
 ds_read_b128 a[128:131], v2 offset:0
 s_add_u32 s39, s39, 0x4000
 v_cvt_pk_bf16_f32 v24, v64, v65
 v_cvt_pk_bf16_f32 v25, v68, v69
 v_mfma_f32_16x16x32_bf16 v[76:79], a[132:135], a[48:51], v[108:111]
 ds_read_b128 a[132:135], v2 offset:1024
 v_exp_f32 v67, v67
 v_mfma_f32_16x16x32_bf16 v[72:75], a[136:139], a[52:55], v[72:75]
 ds_read_b128 a[136:139], v2 offset:2048
 v_exp_f32 v70, v70
 v_mfma_f32_16x16x32_bf16 v[76:79], a[140:143], a[52:55], v[76:79]
 ds_read_b128 a[140:143], v2 offset:3072
 v_mfma_f32_16x16x32_bf16 v[72:75], a[144:147], a[56:59], v[72:75]
 ds_read_b128 a[144:147], v2 offset:4096
 s_and_b32 s39, s39, 0x1ffff
 v_exp_f32 v71, v71
 v_mfma_f32_16x16x32_bf16 v[76:79], a[148:151], a[56:59], v[76:79]
 ds_read_b128 a[148:151], v2 offset:5120
 v_cvt_pk_bf16_f32 v26, v66, v67
 v_cvt_pk_bf16_f32 v27, v70, v71
 v_mfma_f32_16x16x32_bf16 v[72:75], a[152:155], a[60:63], v[72:75]
 ds_read_b128 a[152:155], v2 offset:6144
 v_mfma_f32_16x16x32_bf16 v[76:79], a[156:159], a[60:63], v[76:79]
 ds_read_b128 a[156:159], v2 offset:7168
 s_waitcnt lgkmcnt(8)
 s_add_u32 s49, s49, 1
 s_cmp_lt_u32 s49, s42
 s_cselect_b64 s[68:69], -1, 0
 s_cmp_le_u32 s49, s42
 s_cselect_b64 s[70:71], -1, 0
 s_cmp_eq_u32 s49, s42
 s_cselect_b64 s[60:61], s[52:53], s[68:69]
 s_cselect_b64 s[62:63], s[54:55], s[68:69]
 s_cselect_b64 s[64:65], s[56:57], s[68:69]
 s_cselect_b64 s[66:67], s[58:59], s[68:69]
 v_mfma_f32_16x16x32_bf16 v[176:179], a[160:163], v[24:27], v[176:179]
 s_lshl_b32 s37, s35, 19
 s_add_u32 m0, s38, s50
 v_mov_b32 v3, v2
 v_add_u32 v2, s39, v1
 v_cndmask_b32 v96, v4, v14, s[60:61]
 v_cndmask_b32 v97, v4, v14, s[62:63]
 v_mfma_f32_16x16x32_bf16 v[180:183], a[164:167], v[24:27], v[180:183]
 s_add_u32 s37, s37, s45
 buffer_load_dwordx4 v1, s[20:23], s37 offen offset:0 sc1 lds
 v_cndmask_b32 v98, v4, v14, s[64:65]
 v_cndmask_b32 v99, v4, v14, s[66:67]
 v_mfma_f32_16x16x32_bf16 v[184:187], a[168:171], v[24:27], v[184:187]
 buffer_load_dwordx4 v1, s[20:23], s37 offen offset:1024 sc1 lds
 v_exp_f32 v72, v72
 v_mfma_f32_16x16x32_bf16 v[188:191], a[172:175], v[24:27], v[188:191]
 buffer_load_dwordx4 v1, s[20:23], s37 offen offset:2048 sc1 lds
 buffer_load_dwordx4 v1, s[20:23], s37 offen offset:3072 sc1 lds
 v_exp_f32 v73, v73
 v_mfma_f32_16x16x32_bf16 v[192:195], a[176:179], v[24:27], v[192:195]
 s_add_u32 s38, s38, 0x4000
 v_exp_f32 v76, v76
 v_mfma_f32_16x16x32_bf16 v[196:199], a[180:183], v[24:27], v[196:199]
 s_and_b32 s38, s38, 0x1ffff
 s_add_u32 s35, s35, 1
 v_exp_f32 v77, v77
 v_mfma_f32_16x16x32_bf16 v[200:203], a[184:187], v[24:27], v[200:203]
 s_cmp_eq_u32 s35, s36
 v_exp_f32 v74, v74
 v_mfma_f32_16x16x32_bf16 v[204:207], a[188:191], v[24:27], v[204:207]
 s_cselect_b32 s36, s47, s36
 s_cselect_b32 s35, 0, s35
 v_cndmask_b32 v100, v4, v14, s[68:69]
 v_cndmask_b32 v101, v4, v14, s[68:69]
 v_mfma_f32_16x16x32_bf16 v[40:43], a[192:195], v[24:27], v[40:43]
 s_cmp_lt_u32 s49, s40
 v_cndmask_b32 v102, v4, v14, s[68:69]
 v_cndmask_b32 v103, v4, v14, s[68:69]
 s_cbranch_scc1 Lam1_12
 v_cvt_pk_bf16_f32 v28, v72, v73
 v_cvt_pk_bf16_f32 v29, v76, v77
 v_exp_f32 v75, v75
 v_exp_f32 v78, v78
 v_exp_f32 v79, v79
 v_cvt_pk_bf16_f32 v30, v74, v75
 v_cvt_pk_bf16_f32 v31, v78, v79
 s_nop 1
 v_mfma_f32_16x16x32_bf16 v[44:47], a[192:195], v[28:31], v[44:47]
 v_mfma_f32_16x16x32_bf16 v[208:211], a[160:163], v[28:31], v[208:211]
 v_mfma_f32_16x16x32_bf16 v[212:215], a[164:167], v[28:31], v[212:215]
 v_mfma_f32_16x16x32_bf16 v[216:219], a[168:171], v[28:31], v[216:219]
 v_mfma_f32_16x16x32_bf16 v[220:223], a[172:175], v[28:31], v[220:223]
 v_mfma_f32_16x16x32_bf16 v[224:227], a[176:179], v[28:31], v[224:227]
 v_mfma_f32_16x16x32_bf16 v[228:231], a[180:183], v[28:31], v[228:231]
 v_mfma_f32_16x16x32_bf16 v[232:235], a[184:187], v[28:31], v[232:235]
 v_mfma_f32_16x16x32_bf16 v[236:239], a[188:191], v[28:31], v[236:239]
 v_cmp_ngt_f32 s[60:61], s73, v32
 v_cmp_nlt_f32 vcc, s74, v32
 s_or_b64 s[60:61], s[60:61], vcc
 v_cmp_ngt_f32 s[62:63], s73, v36
 v_cmp_nlt_f32 vcc, s74, v36
 s_or_b64 s[62:63], s[62:63], vcc
 v_cmp_ngt_f32 s[64:65], s73, v40
 v_cmp_nlt_f32 vcc, s74, v40
 s_or_b64 s[64:65], s[64:65], vcc
 v_cmp_ngt_f32 s[66:67], s73, v44
 v_cmp_nlt_f32 vcc, s74, v44
 s_or_b64 s[66:67], s[66:67], vcc
 s_or_b64 s[60:61], s[60:61], s[62:63]
 s_or_b64 s[64:65], s[64:65], s[66:67]
 s_or_b64 s[60:61], s[60:61], s[64:65]
 s_cbranch_scc1 Laslow_7
Laback_8:
 v_rcp_f32 v32, v32
 v_rcp_f32 v36, v36
 v_rcp_f32 v40, v40
 v_rcp_f32 v44, v44
 s_lshl_b32 s40, s41, 5
 s_add_u32 s40, s40, s32
 s_lshl_b32 s40, s40, 13
 s_add_u32 s40, s40, 0x6000000
 s_add_u32 s44, s40, 4096
 v_pk_mul_f32 v[112:113], v[112:113], v[32:33] op_sel_hi:[1,0]
 v_pk_mul_f32 v[114:115], v[114:115], v[32:33] op_sel_hi:[1,0]
 v_pk_mul_f32 v[116:117], v[116:117], v[32:33] op_sel_hi:[1,0]
 v_pk_mul_f32 v[118:119], v[118:119], v[32:33] op_sel_hi:[1,0]
 v_cvt_pk_bf16_f32 v240, v112, v113
 v_cvt_pk_bf16_f32 v241, v116, v117
 v_cvt_pk_bf16_f32 v242, v114, v115
 v_cvt_pk_bf16_f32 v243, v118, v119
 buffer_store_dwordx4 v[240:243], v1, s[20:23], s40 offen offset:0 sc1
 v_pk_mul_f32 v[120:121], v[120:121], v[32:33] op_sel_hi:[1,0]
 v_pk_mul_f32 v[122:123], v[122:123], v[32:33] op_sel_hi:[1,0]
 v_pk_mul_f32 v[124:125], v[124:125], v[32:33] op_sel_hi:[1,0]
 v_pk_mul_f32 v[126:127], v[126:127], v[32:33] op_sel_hi:[1,0]
 v_cvt_pk_bf16_f32 v244, v120, v121
 v_cvt_pk_bf16_f32 v245, v124, v125
 v_cvt_pk_bf16_f32 v246, v122, v123
 v_cvt_pk_bf16_f32 v247, v126, v127
 buffer_store_dwordx4 v[244:247], v1, s[20:23], s40 offen offset:2048 sc1
 v_pk_mul_f32 v[128:129], v[128:129], v[32:33] op_sel_hi:[1,0]
 v_pk_mul_f32 v[130:131], v[130:131], v[32:33] op_sel_hi:[1,0]
 v_pk_mul_f32 v[132:133], v[132:133], v[32:33] op_sel_hi:[1,0]
 v_pk_mul_f32 v[134:135], v[134:135], v[32:33] op_sel_hi:[1,0]
 v_cvt_pk_bf16_f32 v248, v128, v129
 v_cvt_pk_bf16_f32 v249, v132, v133
 v_cvt_pk_bf16_f32 v250, v130, v131
 v_cvt_pk_bf16_f32 v251, v134, v135
 buffer_store_dwordx4 v[248:251], v1, s[20:23], s44 offen offset:0 sc1
 v_pk_mul_f32 v[136:137], v[136:137], v[32:33] op_sel_hi:[1,0]
 v_pk_mul_f32 v[138:139], v[138:139], v[32:33] op_sel_hi:[1,0]
 v_pk_mul_f32 v[140:141], v[140:141], v[32:33] op_sel_hi:[1,0]
 v_pk_mul_f32 v[142:143], v[142:143], v[32:33] op_sel_hi:[1,0]
 v_cvt_pk_bf16_f32 v252, v136, v137
 v_cvt_pk_bf16_f32 v253, v140, v141
 v_cvt_pk_bf16_f32 v254, v138, v139
 v_cvt_pk_bf16_f32 v255, v142, v143
 buffer_store_dwordx4 v[252:255], v1, s[20:23], s44 offen offset:2048 sc1
 v_pk_mul_f32 v[144:145], v[144:145], v[36:37] op_sel_hi:[1,0]
 v_pk_mul_f32 v[146:147], v[146:147], v[36:37] op_sel_hi:[1,0]
 v_pk_mul_f32 v[148:149], v[148:149], v[36:37] op_sel_hi:[1,0]
 v_pk_mul_f32 v[150:151], v[150:151], v[36:37] op_sel_hi:[1,0]
 v_cvt_pk_bf16_f32 v240, v144, v145
 v_cvt_pk_bf16_f32 v241, v148, v149
 v_cvt_pk_bf16_f32 v242, v146, v147
 v_cvt_pk_bf16_f32 v243, v150, v151
 buffer_store_dwordx4 v[240:243], v1, s[20:23], s40 offen offset:1024 sc1
 v_pk_mul_f32 v[152:153], v[152:153], v[36:37] op_sel_hi:[1,0]
 v_pk_mul_f32 v[154:155], v[154:155], v[36:37] op_sel_hi:[1,0]
 v_pk_mul_f32 v[156:157], v[156:157], v[36:37] op_sel_hi:[1,0]
 v_pk_mul_f32 v[158:159], v[158:159], v[36:37] op_sel_hi:[1,0]
 v_cvt_pk_bf16_f32 v244, v152, v153
 v_cvt_pk_bf16_f32 v245, v156, v157
 v_cvt_pk_bf16_f32 v246, v154, v155
 v_cvt_pk_bf16_f32 v247, v158, v159
 buffer_store_dwordx4 v[244:247], v1, s[20:23], s40 offen offset:3072 sc1
 v_pk_mul_f32 v[160:161], v[160:161], v[36:37] op_sel_hi:[1,0]
 v_pk_mul_f32 v[162:163], v[162:163], v[36:37] op_sel_hi:[1,0]
 v_pk_mul_f32 v[164:165], v[164:165], v[36:37] op_sel_hi:[1,0]
 v_pk_mul_f32 v[166:167], v[166:167], v[36:37] op_sel_hi:[1,0]
 v_cvt_pk_bf16_f32 v248, v160, v161
 v_cvt_pk_bf16_f32 v249, v164, v165
 v_cvt_pk_bf16_f32 v250, v162, v163
 v_cvt_pk_bf16_f32 v251, v166, v167
 buffer_store_dwordx4 v[248:251], v1, s[20:23], s44 offen offset:1024 sc1
 v_pk_mul_f32 v[168:169], v[168:169], v[36:37] op_sel_hi:[1,0]
 v_pk_mul_f32 v[170:171], v[170:171], v[36:37] op_sel_hi:[1,0]
 v_pk_mul_f32 v[172:173], v[172:173], v[36:37] op_sel_hi:[1,0]
 v_pk_mul_f32 v[174:175], v[174:175], v[36:37] op_sel_hi:[1,0]
 v_cvt_pk_bf16_f32 v252, v168, v169
 v_cvt_pk_bf16_f32 v253, v172, v173
 v_cvt_pk_bf16_f32 v254, v170, v171
 v_cvt_pk_bf16_f32 v255, v174, v175
 buffer_store_dwordx4 v[252:255], v1, s[20:23], s44 offen offset:3072 sc1
 s_lshl_b32 s40, s42, 5
 s_add_u32 s40, s40, s32
 s_lshl_b32 s40, s40, 13
 s_add_u32 s40, s40, 0x6000000
 s_add_u32 s44, s40, 4096
 v_pk_mul_f32 v[176:177], v[176:177], v[40:41] op_sel_hi:[1,0]
 v_pk_mul_f32 v[178:179], v[178:179], v[40:41] op_sel_hi:[1,0]
 v_pk_mul_f32 v[180:181], v[180:181], v[40:41] op_sel_hi:[1,0]
 v_pk_mul_f32 v[182:183], v[182:183], v[40:41] op_sel_hi:[1,0]
 v_cvt_pk_bf16_f32 v240, v176, v177
 v_cvt_pk_bf16_f32 v241, v180, v181
 v_cvt_pk_bf16_f32 v242, v178, v179
 v_cvt_pk_bf16_f32 v243, v182, v183
 buffer_store_dwordx4 v[240:243], v1, s[20:23], s40 offen offset:0 sc1
 v_pk_mul_f32 v[184:185], v[184:185], v[40:41] op_sel_hi:[1,0]
 v_pk_mul_f32 v[186:187], v[186:187], v[40:41] op_sel_hi:[1,0]
 v_pk_mul_f32 v[188:189], v[188:189], v[40:41] op_sel_hi:[1,0]
 v_pk_mul_f32 v[190:191], v[190:191], v[40:41] op_sel_hi:[1,0]
 v_cvt_pk_bf16_f32 v244, v184, v185
 v_cvt_pk_bf16_f32 v245, v188, v189
 v_cvt_pk_bf16_f32 v246, v186, v187
 v_cvt_pk_bf16_f32 v247, v190, v191
 buffer_store_dwordx4 v[244:247], v1, s[20:23], s40 offen offset:2048 sc1
 v_pk_mul_f32 v[192:193], v[192:193], v[40:41] op_sel_hi:[1,0]
 v_pk_mul_f32 v[194:195], v[194:195], v[40:41] op_sel_hi:[1,0]
 v_pk_mul_f32 v[196:197], v[196:197], v[40:41] op_sel_hi:[1,0]
 v_pk_mul_f32 v[198:199], v[198:199], v[40:41] op_sel_hi:[1,0]
 v_cvt_pk_bf16_f32 v248, v192, v193
 v_cvt_pk_bf16_f32 v249, v196, v197
 v_cvt_pk_bf16_f32 v250, v194, v195
 v_cvt_pk_bf16_f32 v251, v198, v199
 buffer_store_dwordx4 v[248:251], v1, s[20:23], s44 offen offset:0 sc1
 v_pk_mul_f32 v[200:201], v[200:201], v[40:41] op_sel_hi:[1,0]
 v_pk_mul_f32 v[202:203], v[202:203], v[40:41] op_sel_hi:[1,0]
 v_pk_mul_f32 v[204:205], v[204:205], v[40:41] op_sel_hi:[1,0]
 v_pk_mul_f32 v[206:207], v[206:207], v[40:41] op_sel_hi:[1,0]
 v_cvt_pk_bf16_f32 v252, v200, v201
 v_cvt_pk_bf16_f32 v253, v204, v205
 v_cvt_pk_bf16_f32 v254, v202, v203
 v_cvt_pk_bf16_f32 v255, v206, v207
 buffer_store_dwordx4 v[252:255], v1, s[20:23], s44 offen offset:2048 sc1
 v_pk_mul_f32 v[208:209], v[208:209], v[44:45] op_sel_hi:[1,0]
 v_pk_mul_f32 v[210:211], v[210:211], v[44:45] op_sel_hi:[1,0]
 v_pk_mul_f32 v[212:213], v[212:213], v[44:45] op_sel_hi:[1,0]
 v_pk_mul_f32 v[214:215], v[214:215], v[44:45] op_sel_hi:[1,0]
 v_cvt_pk_bf16_f32 v240, v208, v209
 v_cvt_pk_bf16_f32 v241, v212, v213
 v_cvt_pk_bf16_f32 v242, v210, v211
 v_cvt_pk_bf16_f32 v243, v214, v215
 buffer_store_dwordx4 v[240:243], v1, s[20:23], s40 offen offset:1024 sc1
 v_pk_mul_f32 v[216:217], v[216:217], v[44:45] op_sel_hi:[1,0]
 v_pk_mul_f32 v[218:219], v[218:219], v[44:45] op_sel_hi:[1,0]
 v_pk_mul_f32 v[220:221], v[220:221], v[44:45] op_sel_hi:[1,0]
 v_pk_mul_f32 v[222:223], v[222:223], v[44:45] op_sel_hi:[1,0]
 v_cvt_pk_bf16_f32 v244, v216, v217
 v_cvt_pk_bf16_f32 v245, v220, v221
 v_cvt_pk_bf16_f32 v246, v218, v219
 v_cvt_pk_bf16_f32 v247, v222, v223
 buffer_store_dwordx4 v[244:247], v1, s[20:23], s40 offen offset:3072 sc1
 v_pk_mul_f32 v[224:225], v[224:225], v[44:45] op_sel_hi:[1,0]
 v_pk_mul_f32 v[226:227], v[226:227], v[44:45] op_sel_hi:[1,0]
 v_pk_mul_f32 v[228:229], v[228:229], v[44:45] op_sel_hi:[1,0]
 v_pk_mul_f32 v[230:231], v[230:231], v[44:45] op_sel_hi:[1,0]
 v_cvt_pk_bf16_f32 v248, v224, v225
 v_cvt_pk_bf16_f32 v249, v228, v229
 v_cvt_pk_bf16_f32 v250, v226, v227
 v_cvt_pk_bf16_f32 v251, v230, v231
 buffer_store_dwordx4 v[248:251], v1, s[20:23], s44 offen offset:1024 sc1
 v_pk_mul_f32 v[232:233], v[232:233], v[44:45] op_sel_hi:[1,0]
 v_pk_mul_f32 v[234:235], v[234:235], v[44:45] op_sel_hi:[1,0]
 v_pk_mul_f32 v[236:237], v[236:237], v[44:45] op_sel_hi:[1,0]
 v_pk_mul_f32 v[238:239], v[238:239], v[44:45] op_sel_hi:[1,0]
 v_cvt_pk_bf16_f32 v252, v232, v233
 v_cvt_pk_bf16_f32 v253, v236, v237
 v_cvt_pk_bf16_f32 v254, v234, v235
 v_cvt_pk_bf16_f32 v255, v238, v239
 buffer_store_dwordx4 v[252:255], v1, s[20:23], s44 offen offset:3072 sc1
 s_lshl_b32 s72, s33, 5
 s_add_u32 s72, s72, s32
 s_lshl_b32 s72, s72, 2
 s_add_u32 s72, s72, 0x3c00
 s_cmp_eq_u32 s46, 1
 s_cbranch_scc1 Ladone_9
 s_mov_b32 s46, 1
 s_mov_b32 s33, s34
 v_accvgpr_mov_b32 a0, a64
 v_accvgpr_mov_b32 a1, a65
 v_accvgpr_mov_b32 a2, a66
 v_accvgpr_mov_b32 a3, a67
 v_accvgpr_mov_b32 a4, a68
 v_accvgpr_mov_b32 a5, a69
 v_accvgpr_mov_b32 a6, a70
 v_accvgpr_mov_b32 a7, a71
 v_accvgpr_mov_b32 a8, a72
 v_accvgpr_mov_b32 a9, a73
 v_accvgpr_mov_b32 a10, a74
 v_accvgpr_mov_b32 a11, a75
 v_accvgpr_mov_b32 a12, a76
 v_accvgpr_mov_b32 a13, a77
 v_accvgpr_mov_b32 a14, a78
 v_accvgpr_mov_b32 a15, a79
 v_accvgpr_mov_b32 a16, a80
 v_accvgpr_mov_b32 a17, a81
 v_accvgpr_mov_b32 a18, a82
 v_accvgpr_mov_b32 a19, a83
 v_accvgpr_mov_b32 a20, a84
 v_accvgpr_mov_b32 a21, a85
 v_accvgpr_mov_b32 a22, a86
 v_accvgpr_mov_b32 a23, a87
 v_accvgpr_mov_b32 a24, a88
 v_accvgpr_mov_b32 a25, a89
 v_accvgpr_mov_b32 a26, a90
 v_accvgpr_mov_b32 a27, a91
 v_accvgpr_mov_b32 a28, a92
 v_accvgpr_mov_b32 a29, a93
 v_accvgpr_mov_b32 a30, a94
 v_accvgpr_mov_b32 a31, a95
 v_accvgpr_mov_b32 a32, a96
 v_accvgpr_mov_b32 a33, a97
 v_accvgpr_mov_b32 a34, a98
 v_accvgpr_mov_b32 a35, a99
 v_accvgpr_mov_b32 a36, a100
 v_accvgpr_mov_b32 a37, a101
 v_accvgpr_mov_b32 a38, a102
 v_accvgpr_mov_b32 a39, a103
 v_accvgpr_mov_b32 a40, a104
 v_accvgpr_mov_b32 a41, a105
 v_accvgpr_mov_b32 a42, a106
 v_accvgpr_mov_b32 a43, a107
 v_accvgpr_mov_b32 a44, a108
 v_accvgpr_mov_b32 a45, a109
 v_accvgpr_mov_b32 a46, a110
 v_accvgpr_mov_b32 a47, a111
 v_accvgpr_mov_b32 a48, a112
 v_accvgpr_mov_b32 a49, a113
 v_accvgpr_mov_b32 a50, a114
 v_accvgpr_mov_b32 a51, a115
 v_accvgpr_mov_b32 a52, a116
 v_accvgpr_mov_b32 a53, a117
 v_accvgpr_mov_b32 a54, a118
 v_accvgpr_mov_b32 a55, a119
 v_accvgpr_mov_b32 a56, a120
 v_accvgpr_mov_b32 a57, a121
 v_accvgpr_mov_b32 a58, a122
 v_accvgpr_mov_b32 a59, a123
 v_accvgpr_mov_b32 a60, a124
 v_accvgpr_mov_b32 a61, a125
 v_accvgpr_mov_b32 a62, a126
 v_accvgpr_mov_b32 a63, a127
 s_branch Lablk_6
Laslow_7:
 s_waitcnt vmcnt(0) lgkmcnt(0)
 v_mov_b32 v12, 0
 v_mov_b32 v240, v4
 v_mov_b32 v13, 0
 v_mov_b32 v241, v4
 v_mov_b32 v14, 0
 v_mov_b32 v242, v4
 v_mov_b32 v15, 0
 v_mov_b32 v243, v4
 s_mov_b32 s49, 0
Lsl_14:
 s_lshl_b32 s37, s49, 19
 s_add_u32 s37, s37, s45
 s_sub_u32 s37, s37, s50
 s_add_u32 s44, s37, 0
 buffer_load_dwordx4 a[128:131], v1, s[20:23], s44 offen offset:0 sc1
 buffer_load_dwordx4 a[132:135], v1, s[20:23], s44 offen offset:1024 sc1
 buffer_load_dwordx4 a[136:139], v1, s[20:23], s44 offen offset:2048 sc1
 buffer_load_dwordx4 a[140:143], v1, s[20:23], s44 offen offset:3072 sc1
 s_add_u32 s44, s37, 4096
 buffer_load_dwordx4 a[144:147], v1, s[20:23], s44 offen offset:0 sc1
 buffer_load_dwordx4 a[148:151], v1, s[20:23], s44 offen offset:1024 sc1
 buffer_load_dwordx4 a[152:155], v1, s[20:23], s44 offen offset:2048 sc1
 buffer_load_dwordx4 a[156:159], v1, s[20:23], s44 offen offset:3072 sc1
 s_cmp_lt_u32 s49, s41
 s_cselect_b64 s[68:69], -1, 0
 s_cmp_le_u32 s49, s41
 s_cselect_b64 s[70:71], -1, 0
 s_cmp_eq_u32 s49, s41
 s_cselect_b64 s[60:61], s[52:53], s[68:69]
 s_cselect_b64 s[62:63], s[54:55], s[68:69]
 s_cselect_b64 s[64:65], s[56:57], s[68:69]
 s_cselect_b64 s[66:67], s[58:59], s[68:69]
 v_cndmask_b32 v80, v4, v12, s[60:61]
 v_cndmask_b32 v81, v4, v12, s[62:63]
 v_cndmask_b32 v82, v4, v12, s[64:65]
 v_cndmask_b32 v83, v4, v12, s[66:67]
 v_cndmask_b32 v84, v4, v12, s[68:69]
 v_cndmask_b32 v85, v4, v12, s[68:69]
 v_cndmask_b32 v86, v4, v12, s[68:69]
 v_cndmask_b32 v87, v4, v12, s[68:69]
 v_cndmask_b32 v88, v4, v13, s[70:71]
 v_cndmask_b32 v89, v4, v13, s[70:71]
 v_cndmask_b32 v90, v4, v13, s[70:71]
 v_cndmask_b32 v91, v4, v13, s[70:71]
 v_cndmask_b32 v92, v4, v13, s[60:61]
 v_cndmask_b32 v93, v4, v13, s[62:63]
 v_cndmask_b32 v94, v4, v13, s[64:65]
 v_cndmask_b32 v95, v4, v13, s[66:67]
 s_cmp_lt_u32 s49, s42
 s_cselect_b64 s[68:69], -1, 0
 s_cmp_le_u32 s49, s42
 s_cselect_b64 s[70:71], -1, 0
 s_cmp_eq_u32 s49, s42
 s_cselect_b64 s[60:61], s[52:53], s[68:69]
 s_cselect_b64 s[62:63], s[54:55], s[68:69]
 s_cselect_b64 s[64:65], s[56:57], s[68:69]
 s_cselect_b64 s[66:67], s[58:59], s[68:69]
 v_cndmask_b32 v96, v4, v14, s[60:61]
 v_cndmask_b32 v97, v4, v14, s[62:63]
 v_cndmask_b32 v98, v4, v14, s[64:65]
 v_cndmask_b32 v99, v4, v14, s[66:67]
 v_cndmask_b32 v100, v4, v14, s[68:69]
 v_cndmask_b32 v101, v4, v14, s[68:69]
 v_cndmask_b32 v102, v4, v14, s[68:69]
 v_cndmask_b32 v103, v4, v14, s[68:69]
 v_cndmask_b32 v104, v4, v15, s[70:71]
 v_cndmask_b32 v105, v4, v15, s[70:71]
 v_cndmask_b32 v106, v4, v15, s[70:71]
 v_cndmask_b32 v107, v4, v15, s[70:71]
 v_cndmask_b32 v108, v4, v15, s[60:61]
 v_cndmask_b32 v109, v4, v15, s[62:63]
 v_cndmask_b32 v110, v4, v15, s[64:65]
 v_cndmask_b32 v111, v4, v15, s[66:67]
 s_waitcnt vmcnt(0)
 s_nop 0
 v_mfma_f32_16x16x32_bf16 v[48:51], a[128:131], a[0:3], v[80:83]
 v_mfma_f32_16x16x32_bf16 v[56:59], a[128:131], a[16:19], v[88:91]
 v_mfma_f32_16x16x32_bf16 v[64:67], a[128:131], a[32:35], v[96:99]
 v_mfma_f32_16x16x32_bf16 v[72:75], a[128:131], a[48:51], v[104:107]
 v_mfma_f32_16x16x32_bf16 v[52:55], a[132:135], a[0:3], v[84:87]
 v_mfma_f32_16x16x32_bf16 v[60:63], a[132:135], a[16:19], v[92:95]
 v_mfma_f32_16x16x32_bf16 v[68:71], a[132:135], a[32:35], v[100:103]
 v_mfma_f32_16x16x32_bf16 v[76:79], a[132:135], a[48:51], v[108:111]
 v_mfma_f32_16x16x32_bf16 v[48:51], a[136:139], a[4:7], v[48:51]
 v_mfma_f32_16x16x32_bf16 v[56:59], a[136:139], a[20:23], v[56:59]
 v_mfma_f32_16x16x32_bf16 v[64:67], a[136:139], a[36:39], v[64:67]
 v_mfma_f32_16x16x32_bf16 v[72:75], a[136:139], a[52:55], v[72:75]
 v_mfma_f32_16x16x32_bf16 v[52:55], a[140:143], a[4:7], v[52:55]
 v_mfma_f32_16x16x32_bf16 v[60:63], a[140:143], a[20:23], v[60:63]
 v_mfma_f32_16x16x32_bf16 v[68:71], a[140:143], a[36:39], v[68:71]
 v_mfma_f32_16x16x32_bf16 v[76:79], a[140:143], a[52:55], v[76:79]
 v_mfma_f32_16x16x32_bf16 v[48:51], a[144:147], a[8:11], v[48:51]
 v_mfma_f32_16x16x32_bf16 v[56:59], a[144:147], a[24:27], v[56:59]
 v_mfma_f32_16x16x32_bf16 v[64:67], a[144:147], a[40:43], v[64:67]
 v_mfma_f32_16x16x32_bf16 v[72:75], a[144:147], a[56:59], v[72:75]
 v_mfma_f32_16x16x32_bf16 v[52:55], a[148:151], a[8:11], v[52:55]
 v_mfma_f32_16x16x32_bf16 v[60:63], a[148:151], a[24:27], v[60:63]
 v_mfma_f32_16x16x32_bf16 v[68:71], a[148:151], a[40:43], v[68:71]
 v_mfma_f32_16x16x32_bf16 v[76:79], a[148:151], a[56:59], v[76:79]
 v_mfma_f32_16x16x32_bf16 v[48:51], a[152:155], a[12:15], v[48:51]
 v_mfma_f32_16x16x32_bf16 v[56:59], a[152:155], a[28:31], v[56:59]
 v_mfma_f32_16x16x32_bf16 v[64:67], a[152:155], a[44:47], v[64:67]
 v_mfma_f32_16x16x32_bf16 v[72:75], a[152:155], a[60:63], v[72:75]
 v_mfma_f32_16x16x32_bf16 v[52:55], a[156:159], a[12:15], v[52:55]
 v_mfma_f32_16x16x32_bf16 v[60:63], a[156:159], a[28:31], v[60:63]
 v_mfma_f32_16x16x32_bf16 v[68:71], a[156:159], a[44:47], v[68:71]
 v_mfma_f32_16x16x32_bf16 v[76:79], a[156:159], a[60:63], v[76:79]
 s_nop 7
 v_max3_f32 v240, v240, v48, v49
 v_max3_f32 v240, v240, v50, v51
 v_max3_f32 v240, v240, v52, v53
 v_max3_f32 v240, v240, v54, v55
 v_max3_f32 v241, v241, v56, v57
 v_max3_f32 v241, v241, v58, v59
 v_max3_f32 v241, v241, v60, v61
 v_max3_f32 v241, v241, v62, v63
 v_max3_f32 v242, v242, v64, v65
 v_max3_f32 v242, v242, v66, v67
 v_max3_f32 v242, v242, v68, v69
 v_max3_f32 v242, v242, v70, v71
 v_max3_f32 v243, v243, v72, v73
 v_max3_f32 v243, v243, v74, v75
 v_max3_f32 v243, v243, v76, v77
 v_max3_f32 v243, v243, v78, v79
 s_add_u32 s49, s49, 1
 s_cmp_le_u32 s49, s42
 s_cbranch_scc1 Lsl_14
 v_mov_b32 v244, v240
 v_mov_b32 v245, v241
 v_mov_b32 v246, v242
 v_mov_b32 v247, v243
 v_permlane16_swap_b32 v240, v244
 v_permlane16_swap_b32 v241, v245
 v_permlane16_swap_b32 v242, v246
 v_permlane16_swap_b32 v243, v247
 v_max_f32 v240, v240, v244
 v_max_f32 v241, v241, v245
 v_max_f32 v242, v242, v246
 v_max_f32 v243, v243, v247
 v_mov_b32 v244, v240
 v_mov_b32 v245, v241
 v_mov_b32 v246, v242
 v_mov_b32 v247, v243
 v_permlane32_swap_b32 v240, v244
 v_permlane32_swap_b32 v241, v245
 v_permlane32_swap_b32 v242, v246
 v_permlane32_swap_b32 v243, v247
 v_max_f32 v240, v240, v244
 v_max_f32 v241, v241, v245
 v_max_f32 v242, v242, v246
 v_max_f32 v243, v243, v247
 v_sub_f32 v12, 0, v240
 v_sub_f32 v13, 0, v241
 v_sub_f32 v14, 0, v242
 v_sub_f32 v15, 0, v243
 v_mov_b64 v[112:113], 0
 v_mov_b64 v[114:115], 0
 v_mov_b64 v[116:117], 0
 v_mov_b64 v[118:119], 0
 v_mov_b64 v[120:121], 0
 v_mov_b64 v[122:123], 0
 v_mov_b64 v[124:125], 0
 v_mov_b64 v[126:127], 0
 v_mov_b64 v[128:129], 0
 v_mov_b64 v[130:131], 0
 v_mov_b64 v[132:133], 0
 v_mov_b64 v[134:135], 0
 v_mov_b64 v[136:137], 0
 v_mov_b64 v[138:139], 0
 v_mov_b64 v[140:141], 0
 v_mov_b64 v[142:143], 0
 v_mov_b64 v[144:145], 0
 v_mov_b64 v[146:147], 0
 v_mov_b64 v[148:149], 0
 v_mov_b64 v[150:151], 0
 v_mov_b64 v[152:153], 0
 v_mov_b64 v[154:155], 0
 v_mov_b64 v[156:157], 0
 v_mov_b64 v[158:159], 0
 v_mov_b64 v[160:161], 0
 v_mov_b64 v[162:163], 0
 v_mov_b64 v[164:165], 0
 v_mov_b64 v[166:167], 0
 v_mov_b64 v[168:169], 0
 v_mov_b64 v[170:171], 0
 v_mov_b64 v[172:173], 0
 v_mov_b64 v[174:175], 0
 v_mov_b64 v[176:177], 0
 v_mov_b64 v[178:179], 0
 v_mov_b64 v[180:181], 0
 v_mov_b64 v[182:183], 0
 v_mov_b64 v[184:185], 0
 v_mov_b64 v[186:187], 0
 v_mov_b64 v[188:189], 0
 v_mov_b64 v[190:191], 0
 v_mov_b64 v[192:193], 0
 v_mov_b64 v[194:195], 0
 v_mov_b64 v[196:197], 0
 v_mov_b64 v[198:199], 0
 v_mov_b64 v[200:201], 0
 v_mov_b64 v[202:203], 0
 v_mov_b64 v[204:205], 0
 v_mov_b64 v[206:207], 0
 v_mov_b64 v[208:209], 0
 v_mov_b64 v[210:211], 0
 v_mov_b64 v[212:213], 0
 v_mov_b64 v[214:215], 0
 v_mov_b64 v[216:217], 0
 v_mov_b64 v[218:219], 0
 v_mov_b64 v[220:221], 0
 v_mov_b64 v[222:223], 0
 v_mov_b64 v[224:225], 0
 v_mov_b64 v[226:227], 0
 v_mov_b64 v[228:229], 0
 v_mov_b64 v[230:231], 0
 v_mov_b64 v[232:233], 0
 v_mov_b64 v[234:235], 0
 v_mov_b64 v[236:237], 0
 v_mov_b64 v[238:239], 0
 v_mov_b64 v[32:33], 0
 v_mov_b64 v[34:35], 0
 v_mov_b64 v[36:37], 0
 v_mov_b64 v[38:39], 0
 v_mov_b64 v[40:41], 0
 v_mov_b64 v[42:43], 0
 v_mov_b64 v[44:45], 0
 v_mov_b64 v[46:47], 0
 s_mov_b32 s49, 0
Lsl_15:
 s_lshl_b32 s37, s49, 19
 s_add_u32 s37, s37, s45
 s_sub_u32 s37, s37, s50
 s_add_u32 s44, s37, 0
 buffer_load_dwordx4 a[128:131], v1, s[20:23], s44 offen offset:0 sc1
 buffer_load_dwordx4 a[132:135], v1, s[20:23], s44 offen offset:1024 sc1
 buffer_load_dwordx4 a[136:139], v1, s[20:23], s44 offen offset:2048 sc1
 buffer_load_dwordx4 a[140:143], v1, s[20:23], s44 offen offset:3072 sc1
 s_add_u32 s44, s37, 4096
 buffer_load_dwordx4 a[144:147], v1, s[20:23], s44 offen offset:0 sc1
 buffer_load_dwordx4 a[148:151], v1, s[20:23], s44 offen offset:1024 sc1
 buffer_load_dwordx4 a[152:155], v1, s[20:23], s44 offen offset:2048 sc1
 buffer_load_dwordx4 a[156:159], v1, s[20:23], s44 offen offset:3072 sc1
 s_add_u32 s44, s37, 8192
 buffer_load_dwordx4 a[160:163], v1, s[20:23], s44 offen offset:0 sc1
 buffer_load_dwordx4 a[164:167], v1, s[20:23], s44 offen offset:1024 sc1
 buffer_load_dwordx4 a[168:171], v1, s[20:23], s44 offen offset:2048 sc1
 buffer_load_dwordx4 a[172:175], v1, s[20:23], s44 offen offset:3072 sc1
 s_add_u32 s44, s37, 12288
 buffer_load_dwordx4 a[176:179], v1, s[20:23], s44 offen offset:0 sc1
 buffer_load_dwordx4 a[180:183], v1, s[20:23], s44 offen offset:1024 sc1
 buffer_load_dwordx4 a[184:187], v1, s[20:23], s44 offen offset:2048 sc1
 buffer_load_dwordx4 a[188:191], v1, s[20:23], s44 offen offset:3072 sc1
 s_cmp_lt_u32 s49, s41
 s_cselect_b64 s[68:69], -1, 0
 s_cmp_le_u32 s49, s41
 s_cselect_b64 s[70:71], -1, 0
 s_cmp_eq_u32 s49, s41
 s_cselect_b64 s[60:61], s[52:53], s[68:69]
 s_cselect_b64 s[62:63], s[54:55], s[68:69]
 s_cselect_b64 s[64:65], s[56:57], s[68:69]
 s_cselect_b64 s[66:67], s[58:59], s[68:69]
 v_cndmask_b32 v80, v4, v12, s[60:61]
 v_cndmask_b32 v81, v4, v12, s[62:63]
 v_cndmask_b32 v82, v4, v12, s[64:65]
 v_cndmask_b32 v83, v4, v12, s[66:67]
 v_cndmask_b32 v84, v4, v12, s[68:69]
 v_cndmask_b32 v85, v4, v12, s[68:69]
 v_cndmask_b32 v86, v4, v12, s[68:69]
 v_cndmask_b32 v87, v4, v12, s[68:69]
 v_cndmask_b32 v88, v4, v13, s[70:71]
 v_cndmask_b32 v89, v4, v13, s[70:71]
 v_cndmask_b32 v90, v4, v13, s[70:71]
 v_cndmask_b32 v91, v4, v13, s[70:71]
 v_cndmask_b32 v92, v4, v13, s[60:61]
 v_cndmask_b32 v93, v4, v13, s[62:63]
 v_cndmask_b32 v94, v4, v13, s[64:65]
 v_cndmask_b32 v95, v4, v13, s[66:67]
 s_cmp_lt_u32 s49, s42
 s_cselect_b64 s[68:69], -1, 0
 s_cmp_le_u32 s49, s42
 s_cselect_b64 s[70:71], -1, 0
 s_cmp_eq_u32 s49, s42
 s_cselect_b64 s[60:61], s[52:53], s[68:69]
 s_cselect_b64 s[62:63], s[54:55], s[68:69]
 s_cselect_b64 s[64:65], s[56:57], s[68:69]
 s_cselect_b64 s[66:67], s[58:59], s[68:69]
 v_cndmask_b32 v96, v4, v14, s[60:61]
 v_cndmask_b32 v97, v4, v14, s[62:63]
 v_cndmask_b32 v98, v4, v14, s[64:65]
 v_cndmask_b32 v99, v4, v14, s[66:67]
 v_cndmask_b32 v100, v4, v14, s[68:69]
 v_cndmask_b32 v101, v4, v14, s[68:69]
 v_cndmask_b32 v102, v4, v14, s[68:69]
 v_cndmask_b32 v103, v4, v14, s[68:69]
 v_cndmask_b32 v104, v4, v15, s[70:71]
 v_cndmask_b32 v105, v4, v15, s[70:71]
 v_cndmask_b32 v106, v4, v15, s[70:71]
 v_cndmask_b32 v107, v4, v15, s[70:71]
 v_cndmask_b32 v108, v4, v15, s[60:61]
 v_cndmask_b32 v109, v4, v15, s[62:63]
 v_cndmask_b32 v110, v4, v15, s[64:65]
 v_cndmask_b32 v111, v4, v15, s[66:67]
 s_waitcnt vmcnt(0)
 s_nop 0
 v_mfma_f32_16x16x32_bf16 v[48:51], a[128:131], a[0:3], v[80:83]
 v_mfma_f32_16x16x32_bf16 v[56:59], a[128:131], a[16:19], v[88:91]
 v_mfma_f32_16x16x32_bf16 v[64:67], a[128:131], a[32:35], v[96:99]
 v_mfma_f32_16x16x32_bf16 v[72:75], a[128:131], a[48:51], v[104:107]
 v_mfma_f32_16x16x32_bf16 v[52:55], a[132:135], a[0:3], v[84:87]
 v_mfma_f32_16x16x32_bf16 v[60:63], a[132:135], a[16:19], v[92:95]
 v_mfma_f32_16x16x32_bf16 v[68:71], a[132:135], a[32:35], v[100:103]
 v_mfma_f32_16x16x32_bf16 v[76:79], a[132:135], a[48:51], v[108:111]
 v_mfma_f32_16x16x32_bf16 v[48:51], a[136:139], a[4:7], v[48:51]
 v_mfma_f32_16x16x32_bf16 v[56:59], a[136:139], a[20:23], v[56:59]
 v_mfma_f32_16x16x32_bf16 v[64:67], a[136:139], a[36:39], v[64:67]
 v_mfma_f32_16x16x32_bf16 v[72:75], a[136:139], a[52:55], v[72:75]
 v_mfma_f32_16x16x32_bf16 v[52:55], a[140:143], a[4:7], v[52:55]
 v_mfma_f32_16x16x32_bf16 v[60:63], a[140:143], a[20:23], v[60:63]
 v_mfma_f32_16x16x32_bf16 v[68:71], a[140:143], a[36:39], v[68:71]
 v_mfma_f32_16x16x32_bf16 v[76:79], a[140:143], a[52:55], v[76:79]
 v_mfma_f32_16x16x32_bf16 v[48:51], a[144:147], a[8:11], v[48:51]
 v_mfma_f32_16x16x32_bf16 v[56:59], a[144:147], a[24:27], v[56:59]
 v_mfma_f32_16x16x32_bf16 v[64:67], a[144:147], a[40:43], v[64:67]
 v_mfma_f32_16x16x32_bf16 v[72:75], a[144:147], a[56:59], v[72:75]
 v_mfma_f32_16x16x32_bf16 v[52:55], a[148:151], a[8:11], v[52:55]
 v_mfma_f32_16x16x32_bf16 v[60:63], a[148:151], a[24:27], v[60:63]
 v_mfma_f32_16x16x32_bf16 v[68:71], a[148:151], a[40:43], v[68:71]
 v_mfma_f32_16x16x32_bf16 v[76:79], a[148:151], a[56:59], v[76:79]
 v_mfma_f32_16x16x32_bf16 v[48:51], a[152:155], a[12:15], v[48:51]
 v_mfma_f32_16x16x32_bf16 v[56:59], a[152:155], a[28:31], v[56:59]
 v_mfma_f32_16x16x32_bf16 v[64:67], a[152:155], a[44:47], v[64:67]
 v_mfma_f32_16x16x32_bf16 v[72:75], a[152:155], a[60:63], v[72:75]
 v_mfma_f32_16x16x32_bf16 v[52:55], a[156:159], a[12:15], v[52:55]
 v_mfma_f32_16x16x32_bf16 v[60:63], a[156:159], a[28:31], v[60:63]
 v_mfma_f32_16x16x32_bf16 v[68:71], a[156:159], a[44:47], v[68:71]
 v_mfma_f32_16x16x32_bf16 v[76:79], a[156:159], a[60:63], v[76:79]
 s_nop 7
 v_exp_f32 v48, v48
 v_exp_f32 v49, v49
 v_exp_f32 v52, v52
 v_exp_f32 v53, v53
 v_exp_f32 v50, v50
 v_cvt_pk_bf16_f32 v16, v48, v49
 v_cvt_pk_bf16_f32 v17, v52, v53
 v_exp_f32 v51, v51
 v_exp_f32 v54, v54
 v_exp_f32 v55, v55
 v_cvt_pk_bf16_f32 v18, v50, v51
 v_cvt_pk_bf16_f32 v19, v54, v55
 v_exp_f32 v56, v56
 v_exp_f32 v57, v57
 v_exp_f32 v60, v60
 v_exp_f32 v61, v61
 v_exp_f32 v58, v58
 v_cvt_pk_bf16_f32 v20, v56, v57
 v_cvt_pk_bf16_f32 v21, v60, v61
 v_exp_f32 v59, v59
 v_exp_f32 v62, v62
 v_exp_f32 v63, v63
 v_cvt_pk_bf16_f32 v22, v58, v59
 v_cvt_pk_bf16_f32 v23, v62, v63
 v_exp_f32 v64, v64
 v_exp_f32 v65, v65
 v_exp_f32 v68, v68
 v_exp_f32 v69, v69
 v_exp_f32 v66, v66
 v_cvt_pk_bf16_f32 v24, v64, v65
 v_cvt_pk_bf16_f32 v25, v68, v69
 v_exp_f32 v67, v67
 v_exp_f32 v70, v70
 v_exp_f32 v71, v71
 v_cvt_pk_bf16_f32 v26, v66, v67
 v_cvt_pk_bf16_f32 v27, v70, v71
 v_exp_f32 v72, v72
 v_exp_f32 v73, v73
 v_exp_f32 v76, v76
 v_exp_f32 v77, v77
 v_exp_f32 v74, v74
 v_cvt_pk_bf16_f32 v28, v72, v73
 v_cvt_pk_bf16_f32 v29, v76, v77
 v_exp_f32 v75, v75
 v_exp_f32 v78, v78
 v_exp_f32 v79, v79
 v_cvt_pk_bf16_f32 v30, v74, v75
 v_cvt_pk_bf16_f32 v31, v78, v79
 s_nop 1
 v_mfma_f32_16x16x32_bf16 v[112:115], a[160:163], v[16:19], v[112:115]
 v_mfma_f32_16x16x32_bf16 v[144:147], a[160:163], v[20:23], v[144:147]
 v_mfma_f32_16x16x32_bf16 v[176:179], a[160:163], v[24:27], v[176:179]
 v_mfma_f32_16x16x32_bf16 v[208:211], a[160:163], v[28:31], v[208:211]
 v_mfma_f32_16x16x32_bf16 v[116:119], a[164:167], v[16:19], v[116:119]
 v_mfma_f32_16x16x32_bf16 v[148:151], a[164:167], v[20:23], v[148:151]
 v_mfma_f32_16x16x32_bf16 v[180:183], a[164:167], v[24:27], v[180:183]
 v_mfma_f32_16x16x32_bf16 v[212:215], a[164:167], v[28:31], v[212:215]
 v_mfma_f32_16x16x32_bf16 v[120:123], a[168:171], v[16:19], v[120:123]
 v_mfma_f32_16x16x32_bf16 v[152:155], a[168:171], v[20:23], v[152:155]
 v_mfma_f32_16x16x32_bf16 v[184:187], a[168:171], v[24:27], v[184:187]
 v_mfma_f32_16x16x32_bf16 v[216:219], a[168:171], v[28:31], v[216:219]
 v_mfma_f32_16x16x32_bf16 v[124:127], a[172:175], v[16:19], v[124:127]
 v_mfma_f32_16x16x32_bf16 v[156:159], a[172:175], v[20:23], v[156:159]
 v_mfma_f32_16x16x32_bf16 v[188:191], a[172:175], v[24:27], v[188:191]
 v_mfma_f32_16x16x32_bf16 v[220:223], a[172:175], v[28:31], v[220:223]
 v_mfma_f32_16x16x32_bf16 v[128:131], a[176:179], v[16:19], v[128:131]
 v_mfma_f32_16x16x32_bf16 v[160:163], a[176:179], v[20:23], v[160:163]
 v_mfma_f32_16x16x32_bf16 v[192:195], a[176:179], v[24:27], v[192:195]
 v_mfma_f32_16x16x32_bf16 v[224:227], a[176:179], v[28:31], v[224:227]
 v_mfma_f32_16x16x32_bf16 v[132:135], a[180:183], v[16:19], v[132:135]
 v_mfma_f32_16x16x32_bf16 v[164:167], a[180:183], v[20:23], v[164:167]
 v_mfma_f32_16x16x32_bf16 v[196:199], a[180:183], v[24:27], v[196:199]
 v_mfma_f32_16x16x32_bf16 v[228:231], a[180:183], v[28:31], v[228:231]
 v_mfma_f32_16x16x32_bf16 v[136:139], a[184:187], v[16:19], v[136:139]
 v_mfma_f32_16x16x32_bf16 v[168:171], a[184:187], v[20:23], v[168:171]
 v_mfma_f32_16x16x32_bf16 v[200:203], a[184:187], v[24:27], v[200:203]
 v_mfma_f32_16x16x32_bf16 v[232:235], a[184:187], v[28:31], v[232:235]
 v_mfma_f32_16x16x32_bf16 v[140:143], a[188:191], v[16:19], v[140:143]
 v_mfma_f32_16x16x32_bf16 v[172:175], a[188:191], v[20:23], v[172:175]
 v_mfma_f32_16x16x32_bf16 v[204:207], a[188:191], v[24:27], v[204:207]
 v_mfma_f32_16x16x32_bf16 v[236:239], a[188:191], v[28:31], v[236:239]
 v_mfma_f32_16x16x32_bf16 v[32:35], a[192:195], v[16:19], v[32:35]
 v_mfma_f32_16x16x32_bf16 v[36:39], a[192:195], v[20:23], v[36:39]
 v_mfma_f32_16x16x32_bf16 v[40:43], a[192:195], v[24:27], v[40:43]
 v_mfma_f32_16x16x32_bf16 v[44:47], a[192:195], v[28:31], v[44:47]
 s_add_u32 s49, s49, 1
 s_cmp_le_u32 s49, s42
 s_cbranch_scc1 Lsl_15
 ds_read_b128 a[128:131], v3 offset:0
 ds_read_b128 a[132:135], v3 offset:1024
 ds_read_b128 a[136:139], v3 offset:2048
 ds_read_b128 a[140:143], v3 offset:3072
 ds_read_b128 a[144:147], v3 offset:4096
 ds_read_b128 a[148:151], v3 offset:5120
 ds_read_b128 a[152:155], v3 offset:6144
 ds_read_b128 a[156:159], v3 offset:7168
 s_branch Laback_8
Ladone_9:
 s_waitcnt vmcnt(0) lgkmcnt(0)
 s_barrier
 v_mov_b32 v6, 1
 buffer_store_dword v6, v5, s[20:23], s72 offen sc1
 s_cmp_ge_u32 s6, 27
 s_cbranch_scc1 Lfin
 s_load_dwordx2 s[8:9], s[0:1], 40
 s_mov_b32 s10, 0x480000
 s_mov_b32 s11, 0x20000
 s_mul_i32 s7, s6, 29
 s_lshr_b32 s7, s7, 8
 s_mul_i32 s94, s7, 9
 s_sub_u32 s32, s6, s94
 s_mul_i32 s40, s7, 3
 s_lshl_b32 s7, s7, 2
 s_add_u32 s7, s7, s5
 s_sub_u32 s33, s7, 4
 s_mov_b32 s34, 12
 s_cmp_lt_u32 s33, 4
 s_cselect_b32 s35, 6, 5
 s_mov_b32 s36, 0x6000000
 s_mov_b32 s37, 0
 s_lshl_b32 s38, s4, 5
 s_add_u32 s38, s38, 0x3c00
 s_mov_b32 s39, 0
 s_mov_b32 s93, 0x38
 s_mov_b32 s92, 7
 s_mov_b32 s91, 4
 s_mov_b32 s90, 31
 s_branch Los
Lpb:
 s_load_dwordx2 s[8:9], s[0:1], 48
 s_mov_b32 s10, 0x240000
 s_mov_b32 s11, 0x20000
 s_load_dwordx2 s[12:13], s[0:1], 72
 s_mov_b32 s14, 0x480000
 s_mov_b32 s15, 0x20000
 s_load_dwordx2 s[16:17], s[0:1], 80
 s_mov_b32 s18, 0x480000
 s_mov_b32 s19, 0x20000
 s_lshl_b32 s32, s6, 8
 s_mov_b32 s33, s32
 s_lshl_b32 s34, s6, 14
 s_add_u32 s34, s34, 0x3000000
 s_add_u32 s35, s34, 8192
 s_mov_b32 s36, 64
 s_mov_b32 s37, 0
 s_lshl_b32 s7, s6, 7
 s_add_u32 s7, s7, 0x0
 v_min_u32 v1, 1, v0
 v_lshlrev_b32 v1, 28, v1
 v_add_u32 v13, s7, v1
 s_waitcnt lgkmcnt(0)
 v_and_b32 v1, 63, v0
 v_lshrrev_b32 v2, 3, v0
 v_mul_u32_u24 v10, 1152, v2
 v_lshrrev_b32 v2, 4, v0
 v_xor_b32 v2, v2, v0
 v_and_b32 v2, 7, v2
 v_lshl_add_u32 v10, v2, 4, v10
 v_lshrrev_b32 v2, 4, v1
 v_bfe_u32 v3, v1, 1, 3
 v_xor_b32 v2, v2, v3
 v_and_b32 v3, 15, v1
 v_lshlrev_b32 v3, 7, v3
 v_lshl_add_u32 v4, v2, 4, v3
 v_xor_b32 v5, 64, v4
 v_lshrrev_b32 v2, 4, v0
 v_lshlrev_b32 v11, 13, v2
 v_lshrrev_b32 v2, 7, v0
 v_lshrrev_b32 v3, 4, v1
 v_lshl_add_u32 v3, v2, 2, v3
 v_bfe_u32 v2, v1, 1, 3
 v_xor_b32 v2, v2, v3
 v_lshl_add_u32 v11, v2, 5, v11
 v_and_b32 v2, 1, v1
 v_lshl_add_u32 v11, v2, 4, v11
 v_bfe_u32 v2, v1, 2, 3
 v_xor_b32 v3, s4, v2
 v_lshlrev_b32 v3, 5, v3
 v_and_b32 v2, 3, v2
 v_lshl_add_u32 v3, v2, 8, v3
 v_lshrrev_b32 v2, 4, v1
 v_lshl_add_u32 v3, v2, 11, v3
 v_and_b32 v2, 3, v1
 v_lshl_add_u32 v3, v2, 3, v3
 v_add_u32 v8, 73728, v3
 v_xor_b32 v3, 0x80, v3
 v_add_u32 v9, 73728, v3
 s_lshl_b32 s45, s4, 11
 v_lshl_add_u32 v12, v1, 4, s45
 s_mov_b32 s39, s37
 s_add_u32 s40, s39, 1
 s_lshl_b32 s49, s4, 10
 s_mul_i32 s46, s39, 36864
 s_add_u32 m0, s49, 0
 s_nop 0
 buffer_load_dwordx4 v10, s[8:11], s46 offen offset:0  lds
 s_add_u32 m0, s49, 3968
 s_nop 0
 buffer_load_dwordx4 v10, s[8:11], s46 offen offset:128  lds
 s_add_u32 m0, s49, 7936
 s_nop 0
 buffer_load_dwordx4 v10, s[8:11], s46 offen offset:256  lds
 s_add_u32 m0, s49, 11904
 s_nop 0
 buffer_load_dwordx4 v10, s[8:11], s46 offen offset:384  lds
 s_add_u32 m0, s49, 15872
 s_nop 0
 buffer_load_dwordx4 v10, s[8:11], s46 offen offset:512  lds
 s_add_u32 m0, s49, 19840
 s_nop 0
 buffer_load_dwordx4 v10, s[8:11], s46 offen offset:640  lds
 s_add_u32 m0, s49, 23808
 s_nop 0
 buffer_load_dwordx4 v10, s[8:11], s46 offen offset:768  lds
 s_add_u32 m0, s49, 27776
 s_nop 0
 buffer_load_dwordx4 v10, s[8:11], s46 offen offset:896  lds
 s_add_u32 m0, s49, 31744
 s_nop 0
 buffer_load_dwordx4 v10, s[8:11], s46 offen offset:1024  lds
 s_lshl_b32 s49, s4, 10
 s_add_u32 s49, s49, 36864
 s_mul_i32 s46, s40, 36864
 s_add_u32 m0, s49, 0
 s_nop 0
 buffer_load_dwordx4 v10, s[8:11], s46 offen offset:0  lds
 s_add_u32 m0, s49, 3968
 s_nop 0
 buffer_load_dwordx4 v10, s[8:11], s46 offen offset:128  lds
 s_add_u32 m0, s49, 7936
 s_nop 0
 buffer_load_dwordx4 v10, s[8:11], s46 offen offset:256  lds
 s_add_u32 m0, s49, 11904
 s_nop 0
 buffer_load_dwordx4 v10, s[8:11], s46 offen offset:384  lds
 s_add_u32 m0, s49, 15872
 s_nop 0
 buffer_load_dwordx4 v10, s[8:11], s46 offen offset:512  lds
 s_add_u32 m0, s49, 19840
 s_nop 0
 buffer_load_dwordx4 v10, s[8:11], s46 offen offset:640  lds
 s_add_u32 m0, s49, 23808
 s_nop 0
 buffer_load_dwordx4 v10, s[8:11], s46 offen offset:768  lds
 s_add_u32 m0, s49, 27776
 s_nop 0
 buffer_load_dwordx4 v10, s[8:11], s46 offen offset:896  lds
 s_add_u32 m0, s49, 31744
 s_nop 0
 buffer_load_dwordx4 v10, s[8:11], s46 offen offset:1024  lds
 s_lshl_b32 s49, s4, 10
 s_add_u32 m0, s49, 73728
 s_add_u32 s45, s32, 0
 buffer_load_dwordx4 v11, s[12:15], s45 offen  lds
 s_add_u32 m0, s49, 77824
 s_add_u32 s45, s32, 131072
 buffer_load_dwordx4 v11, s[12:15], s45 offen  lds
 s_add_u32 m0, s49, 81920
 s_add_u32 s45, s33, 0
 buffer_load_dwordx4 v11, s[16:19], s45 offen  lds
 s_add_u32 m0, s49, 86016
 s_add_u32 s45, s33, 131072
 buffer_load_dwordx4 v11, s[16:19], s45 offen  lds
 s_add_u32 m0, s49, 90112
 s_add_u32 s45, s32, 262144
 buffer_load_dwordx4 v11, s[12:15], s45 offen  lds
 s_add_u32 m0, s49, 94208
 s_add_u32 s45, s32, 393216
 buffer_load_dwordx4 v11, s[12:15], s45 offen  lds
 s_add_u32 m0, s49, 98304
 s_add_u32 s45, s33, 262144
 buffer_load_dwordx4 v11, s[16:19], s45 offen  lds
 s_add_u32 m0, s49, 102400
 s_add_u32 s45, s33, 393216
 buffer_load_dwordx4 v11, s[16:19], s45 offen  lds
 s_add_u32 m0, s49, 106496
 s_add_u32 s45, s32, 524288
 buffer_load_dwordx4 v11, s[12:15], s45 offen  lds
 s_add_u32 m0, s49, 110592
 s_add_u32 s45, s32, 655360
 buffer_load_dwordx4 v11, s[12:15], s45 offen  lds
 s_add_u32 m0, s49, 114688
 s_add_u32 s45, s33, 524288
 buffer_load_dwordx4 v11, s[16:19], s45 offen  lds
 s_add_u32 m0, s49, 118784
 s_add_u32 s45, s33, 655360
 buffer_load_dwordx4 v11, s[16:19], s45 offen  lds
 s_waitcnt vmcnt(8) lgkmcnt(0)
 s_barrier
 s_add_u32 m0, s49, 122880
 s_add_u32 s45, s32, 786432
 buffer_load_dwordx4 v11, s[12:15], s45 offen  lds
 s_add_u32 m0, s49, 126976
 s_add_u32 s45, s32, 917504
 buffer_load_dwordx4 v11, s[12:15], s45 offen  lds
 s_add_u32 m0, s49, 131072
 s_add_u32 s45, s33, 786432
 buffer_load_dwordx4 v11, s[16:19], s45 offen  lds
 s_add_u32 m0, s49, 135168
 s_add_u32 s45, s33, 917504
 buffer_load_dwordx4 v11, s[16:19], s45 offen  lds
 ds_read_b64_tr_b16 a[0:1], v8 offset:0
 ds_read_b64_tr_b16 a[2:3], v8 offset:1024
 ds_read_b64_tr_b16 a[72:73], v9 offset:0
 ds_read_b64_tr_b16 a[74:75], v9 offset:1024
 ds_read_b64_tr_b16 a[144:145], v8 offset:8192
 ds_read_b64_tr_b16 a[146:147], v8 offset:9216
 ds_read_b64_tr_b16 a[216:217], v9 offset:8192
 ds_read_b64_tr_b16 a[218:219], v9 offset:9216
 s_waitcnt vmcnt(8) lgkmcnt(0)
 s_barrier
 s_add_u32 m0, s49, 73728
 s_add_u32 s45, s32, 1048576
 buffer_load_dwordx4 v11, s[12:15], s45 offen  lds
 s_add_u32 m0, s49, 77824
 s_add_u32 s45, s32, 1179648
 buffer_load_dwordx4 v11, s[12:15], s45 offen  lds
 s_add_u32 m0, s49, 81920
 s_add_u32 s45, s33, 1048576
 buffer_load_dwordx4 v11, s[16:19], s45 offen  lds
 s_add_u32 m0, s49, 86016
 s_add_u32 s45, s33, 1179648
 buffer_load_dwordx4 v11, s[16:19], s45 offen  lds
 ds_read_b64_tr_b16 a[4:5], v8 offset:16384
 ds_read_b64_tr_b16 a[6:7], v8 offset:17408
 ds_read_b64_tr_b16 a[76:77], v9 offset:16384
 ds_read_b64_tr_b16 a[78:79], v9 offset:17408
 ds_read_b64_tr_b16 a[148:149], v8 offset:24576
 ds_read_b64_tr_b16 a[150:151], v8 offset:25600
 ds_read_b64_tr_b16 a[220:221], v9 offset:24576
 ds_read_b64_tr_b16 a[222:223], v9 offset:25600
 s_waitcnt vmcnt(8) lgkmcnt(0)
 s_barrier
 s_add_u32 m0, s49, 90112
 s_add_u32 s45, s32, 1310720
 buffer_load_dwordx4 v11, s[12:15], s45 offen  lds
 s_add_u32 m0, s49, 94208
 s_add_u32 s45, s32, 1441792
 buffer_load_dwordx4 v11, s[12:15], s45 offen  lds
 s_add_u32 m0, s49, 98304
 s_add_u32 s45, s33, 1310720
 buffer_load_dwordx4 v11, s[16:19], s45 offen  lds
 s_add_u32 m0, s49, 102400
 s_add_u32 s45, s33, 1441792
 buffer_load_dwordx4 v11, s[16:19], s45 offen  lds
 ds_read_b64_tr_b16 a[8:9], v8 offset:32768
 ds_read_b64_tr_b16 a[10:11], v8 offset:33792
 ds_read_b64_tr_b16 a[80:81], v9 offset:32768
 ds_read_b64_tr_b16 a[82:83], v9 offset:33792
 ds_read_b64_tr_b16 a[152:153], v8 offset:40960
 ds_read_b64_tr_b16 a[154:155], v8 offset:41984
 ds_read_b64_tr_b16 a[224:225], v9 offset:40960
 ds_read_b64_tr_b16 a[226:227], v9 offset:41984
 s_waitcnt vmcnt(8) lgkmcnt(0)
 s_barrier
 s_add_u32 m0, s49, 106496
 s_add_u32 s45, s32, 1572864
 buffer_load_dwordx4 v11, s[12:15], s45 offen  lds
 s_add_u32 m0, s49, 110592
 s_add_u32 s45, s32, 1703936
 buffer_load_dwordx4 v11, s[12:15], s45 offen  lds
 s_add_u32 m0, s49, 114688
 s_add_u32 s45, s33, 1572864
 buffer_load_dwordx4 v11, s[16:19], s45 offen  lds
 s_add_u32 m0, s49, 118784
 s_add_u32 s45, s33, 1703936
 buffer_load_dwordx4 v11, s[16:19], s45 offen  lds
 ds_read_b64_tr_b16 a[12:13], v8 offset:49152
 ds_read_b64_tr_b16 a[14:15], v8 offset:50176
 ds_read_b64_tr_b16 a[84:85], v9 offset:49152
 ds_read_b64_tr_b16 a[86:87], v9 offset:50176
 ds_read_b64_tr_b16 a[156:157], v8 offset:57344
 ds_read_b64_tr_b16 a[158:159], v8 offset:58368
 ds_read_b64_tr_b16 a[228:229], v9 offset:57344
 ds_read_b64_tr_b16 a[230:231], v9 offset:58368
 s_waitcnt vmcnt(8) lgkmcnt(0)
 s_barrier
 s_add_u32 m0, s49, 122880
 s_add_u32 s45, s32, 1835008
 buffer_load_dwordx4 v11, s[12:15], s45 offen  lds
 s_add_u32 m0, s49, 126976
 s_add_u32 s45, s32, 1966080
 buffer_load_dwordx4 v11, s[12:15], s45 offen  lds
 s_add_u32 m0, s49, 131072
 s_add_u32 s45, s33, 1835008
 buffer_load_dwordx4 v11, s[16:19], s45 offen  lds
 s_add_u32 m0, s49, 135168
 s_add_u32 s45, s33, 1966080
 buffer_load_dwordx4 v11, s[16:19], s45 offen  lds
 ds_read_b64_tr_b16 a[16:17], v8 offset:0
 ds_read_b64_tr_b16 a[18:19], v8 offset:1024
 ds_read_b64_tr_b16 a[88:89], v9 offset:0
 ds_read_b64_tr_b16 a[90:91], v9 offset:1024
 ds_read_b64_tr_b16 a[160:161], v8 offset:8192
 ds_read_b64_tr_b16 a[162:163], v8 offset:9216
 ds_read_b64_tr_b16 a[232:233], v9 offset:8192
 ds_read_b64_tr_b16 a[234:235], v9 offset:9216
 s_waitcnt vmcnt(8) lgkmcnt(0)
 s_barrier
 s_add_u32 m0, s49, 73728
 s_add_u32 s45, s32, 2097152
 buffer_load_dwordx4 v11, s[12:15], s45 offen  lds
 s_add_u32 m0, s49, 77824
 s_add_u32 s45, s32, 2228224
 buffer_load_dwordx4 v11, s[12:15], s45 offen  lds
 s_add_u32 m0, s49, 81920
 s_add_u32 s45, s33, 2097152
 buffer_load_dwordx4 v11, s[16:19], s45 offen  lds
 s_add_u32 m0, s49, 86016
 s_add_u32 s45, s33, 2228224
 buffer_load_dwordx4 v11, s[16:19], s45 offen  lds
 ds_read_b64_tr_b16 a[20:21], v8 offset:16384
 ds_read_b64_tr_b16 a[22:23], v8 offset:17408
 ds_read_b64_tr_b16 a[92:93], v9 offset:16384
 ds_read_b64_tr_b16 a[94:95], v9 offset:17408
 ds_read_b64_tr_b16 a[164:165], v8 offset:24576
 ds_read_b64_tr_b16 a[166:167], v8 offset:25600
 ds_read_b64_tr_b16 a[236:237], v9 offset:24576
 ds_read_b64_tr_b16 a[238:239], v9 offset:25600
 s_waitcnt vmcnt(8) lgkmcnt(0)
 s_barrier
 s_add_u32 m0, s49, 90112
 s_add_u32 s45, s32, 2359296
 buffer_load_dwordx4 v11, s[12:15], s45 offen  lds
 s_add_u32 m0, s49, 94208
 s_add_u32 s45, s32, 2490368
 buffer_load_dwordx4 v11, s[12:15], s45 offen  lds
 s_add_u32 m0, s49, 98304
 s_add_u32 s45, s33, 2359296
 buffer_load_dwordx4 v11, s[16:19], s45 offen  lds
 s_add_u32 m0, s49, 102400
 s_add_u32 s45, s33, 2490368
 buffer_load_dwordx4 v11, s[16:19], s45 offen  lds
 ds_read_b64_tr_b16 a[24:25], v8 offset:32768
 ds_read_b64_tr_b16 a[26:27], v8 offset:33792
 ds_read_b64_tr_b16 a[96:97], v9 offset:32768
 ds_read_b64_tr_b16 a[98:99], v9 offset:33792
 ds_read_b64_tr_b16 a[168:169], v8 offset:40960
 ds_read_b64_tr_b16 a[170:171], v8 offset:41984
 ds_read_b64_tr_b16 a[240:241], v9 offset:40960
 ds_read_b64_tr_b16 a[242:243], v9 offset:41984
 s_waitcnt vmcnt(8) lgkmcnt(0)
 s_barrier
 s_add_u32 m0, s49, 106496
 s_add_u32 s45, s32, 2621440
 buffer_load_dwordx4 v11, s[12:15], s45 offen  lds
 s_add_u32 m0, s49, 110592
 s_add_u32 s45, s32, 2752512
 buffer_load_dwordx4 v11, s[12:15], s45 offen  lds
 s_add_u32 m0, s49, 114688
 s_add_u32 s45, s33, 2621440
 buffer_load_dwordx4 v11, s[16:19], s45 offen  lds
 s_add_u32 m0, s49, 118784
 s_add_u32 s45, s33, 2752512
 buffer_load_dwordx4 v11, s[16:19], s45 offen  lds
 ds_read_b64_tr_b16 a[28:29], v8 offset:49152
 ds_read_b64_tr_b16 a[30:31], v8 offset:50176
 ds_read_b64_tr_b16 a[100:101], v9 offset:49152
 ds_read_b64_tr_b16 a[102:103], v9 offset:50176
 ds_read_b64_tr_b16 a[172:173], v8 offset:57344
 ds_read_b64_tr_b16 a[174:175], v8 offset:58368
 ds_read_b64_tr_b16 a[244:245], v9 offset:57344
 ds_read_b64_tr_b16 a[246:247], v9 offset:58368
 s_waitcnt vmcnt(8) lgkmcnt(0)
 s_barrier
 s_add_u32 m0, s49, 122880
 s_add_u32 s45, s32, 2883584
 buffer_load_dwordx4 v11, s[12:15], s45 offen  lds
 s_add_u32 m0, s49, 126976
 s_add_u32 s45, s32, 3014656
 buffer_load_dwordx4 v11, s[12:15], s45 offen  lds
 s_add_u32 m0, s49, 131072
 s_add_u32 s45, s33, 2883584
 buffer_load_dwordx4 v11, s[16:19], s45 offen  lds
 s_add_u32 m0, s49, 135168
 s_add_u32 s45, s33, 3014656
 buffer_load_dwordx4 v11, s[16:19], s45 offen  lds
 ds_read_b64_tr_b16 a[32:33], v8 offset:0
 ds_read_b64_tr_b16 a[34:35], v8 offset:1024
 ds_read_b64_tr_b16 a[104:105], v9 offset:0
 ds_read_b64_tr_b16 a[106:107], v9 offset:1024
 ds_read_b64_tr_b16 a[176:177], v8 offset:8192
 ds_read_b64_tr_b16 a[178:179], v8 offset:9216
 ds_read_b64_tr_b16 a[248:249], v9 offset:8192
 ds_read_b64_tr_b16 a[250:251], v9 offset:9216
 s_waitcnt vmcnt(8) lgkmcnt(0)
 s_barrier
 s_add_u32 m0, s49, 73728
 s_add_u32 s45, s32, 3145728
 buffer_load_dwordx4 v11, s[12:15], s45 offen  lds
 s_add_u32 m0, s49, 77824
 s_add_u32 s45, s32, 3276800
 buffer_load_dwordx4 v11, s[12:15], s45 offen  lds
 s_add_u32 m0, s49, 81920
 s_add_u32 s45, s33, 3145728
 buffer_load_dwordx4 v11, s[16:19], s45 offen  lds
 s_add_u32 m0, s49, 86016
 s_add_u32 s45, s33, 3276800
 buffer_load_dwordx4 v11, s[16:19], s45 offen  lds
 ds_read_b64_tr_b16 a[36:37], v8 offset:16384
 ds_read_b64_tr_b16 a[38:39], v8 offset:17408
 ds_read_b64_tr_b16 a[108:109], v9 offset:16384
 ds_read_b64_tr_b16 a[110:111], v9 offset:17408
 ds_read_b64_tr_b16 a[180:181], v8 offset:24576
 ds_read_b64_tr_b16 a[182:183], v8 offset:25600
 ds_read_b64_tr_b16 a[252:253], v9 offset:24576
 ds_read_b64_tr_b16 a[254:255], v9 offset:25600
 s_waitcnt vmcnt(8) lgkmcnt(0)
 s_barrier
 s_add_u32 m0, s49, 90112
 s_add_u32 s45, s32, 3407872
 buffer_load_dwordx4 v11, s[12:15], s45 offen  lds
 s_add_u32 m0, s49, 94208
 s_add_u32 s45, s32, 3538944
 buffer_load_dwordx4 v11, s[12:15], s45 offen  lds
 s_add_u32 m0, s49, 98304
 s_add_u32 s45, s33, 3407872
 buffer_load_dwordx4 v11, s[16:19], s45 offen  lds
 s_add_u32 m0, s49, 102400
 s_add_u32 s45, s33, 3538944
 buffer_load_dwordx4 v11, s[16:19], s45 offen  lds
 ds_read_b64_tr_b16 a[40:41], v8 offset:32768
 ds_read_b64_tr_b16 a[42:43], v8 offset:33792
 ds_read_b64_tr_b16 a[112:113], v9 offset:32768
 ds_read_b64_tr_b16 a[114:115], v9 offset:33792
 ds_read_b64_tr_b16 a[184:185], v8 offset:40960
 ds_read_b64_tr_b16 a[186:187], v8 offset:41984
 ds_read_b64_tr_b16 v[224:225], v9 offset:40960
 ds_read_b64_tr_b16 v[226:227], v9 offset:41984
 s_waitcnt vmcnt(8) lgkmcnt(0)
 s_barrier
 s_add_u32 m0, s49, 106496
 s_add_u32 s45, s32, 3670016
 buffer_load_dwordx4 v11, s[12:15], s45 offen  lds
 s_add_u32 m0, s49, 110592
 s_add_u32 s45, s32, 3801088
 buffer_load_dwordx4 v11, s[12:15], s45 offen  lds
 s_add_u32 m0, s49, 114688
 s_add_u32 s45, s33, 3670016
 buffer_load_dwordx4 v11, s[16:19], s45 offen  lds
 s_add_u32 m0, s49, 118784
 s_add_u32 s45, s33, 3801088
 buffer_load_dwordx4 v11, s[16:19], s45 offen  lds
 ds_read_b64_tr_b16 a[44:45], v8 offset:49152
 ds_read_b64_tr_b16 a[46:47], v8 offset:50176
 ds_read_b64_tr_b16 a[116:117], v9 offset:49152
 ds_read_b64_tr_b16 a[118:119], v9 offset:50176
 ds_read_b64_tr_b16 a[188:189], v8 offset:57344
 ds_read_b64_tr_b16 a[190:191], v8 offset:58368
 ds_read_b64_tr_b16 v[228:229], v9 offset:57344
 ds_read_b64_tr_b16 v[230:231], v9 offset:58368
 s_waitcnt vmcnt(8) lgkmcnt(0)
 s_barrier
 s_add_u32 m0, s49, 122880
 s_add_u32 s45, s32, 3932160
 buffer_load_dwordx4 v11, s[12:15], s45 offen  lds
 s_add_u32 m0, s49, 126976
 s_add_u32 s45, s32, 4063232
 buffer_load_dwordx4 v11, s[12:15], s45 offen  lds
 s_add_u32 m0, s49, 131072
 s_add_u32 s45, s33, 3932160
 buffer_load_dwordx4 v11, s[16:19], s45 offen  lds
 s_add_u32 m0, s49, 135168
 s_add_u32 s45, s33, 4063232
 buffer_load_dwordx4 v11, s[16:19], s45 offen  lds
 ds_read_b64_tr_b16 a[48:49], v8 offset:0
 ds_read_b64_tr_b16 a[50:51], v8 offset:1024
 ds_read_b64_tr_b16 a[120:121], v9 offset:0
 ds_read_b64_tr_b16 a[122:123], v9 offset:1024
 ds_read_b64_tr_b16 a[192:193], v8 offset:8192
 ds_read_b64_tr_b16 a[194:195], v8 offset:9216
 ds_read_b64_tr_b16 v[232:233], v9 offset:8192
 ds_read_b64_tr_b16 v[234:235], v9 offset:9216
 s_waitcnt vmcnt(8) lgkmcnt(0)
 s_barrier
 s_add_u32 m0, s49, 73728
 s_add_u32 s45, s32, 4194304
 buffer_load_dwordx4 v11, s[12:15], s45 offen  lds
 s_add_u32 m0, s49, 77824
 s_add_u32 s45, s32, 4325376
 buffer_load_dwordx4 v11, s[12:15], s45 offen  lds
 s_add_u32 m0, s49, 81920
 s_add_u32 s45, s33, 4194304
 buffer_load_dwordx4 v11, s[16:19], s45 offen  lds
 s_add_u32 m0, s49, 86016
 s_add_u32 s45, s33, 4325376
 buffer_load_dwordx4 v11, s[16:19], s45 offen  lds
 ds_read_b64_tr_b16 a[52:53], v8 offset:16384
 ds_read_b64_tr_b16 a[54:55], v8 offset:17408
 ds_read_b64_tr_b16 a[124:125], v9 offset:16384
 ds_read_b64_tr_b16 a[126:127], v9 offset:17408
 ds_read_b64_tr_b16 a[196:197], v8 offset:24576
 ds_read_b64_tr_b16 a[198:199], v8 offset:25600
 ds_read_b64_tr_b16 v[236:237], v9 offset:24576
 ds_read_b64_tr_b16 v[238:239], v9 offset:25600
 s_waitcnt vmcnt(8) lgkmcnt(0)
 s_barrier
 s_add_u32 m0, s49, 90112
 s_add_u32 s45, s32, 4456448
 buffer_load_dwordx4 v11, s[12:15], s45 offen  lds
 s_add_u32 m0, s49, 94208
 s_add_u32 s45, s32, 4587520
 buffer_load_dwordx4 v11, s[12:15], s45 offen  lds
 s_add_u32 m0, s49, 98304
 s_add_u32 s45, s33, 4456448
 buffer_load_dwordx4 v11, s[16:19], s45 offen  lds
 s_add_u32 m0, s49, 102400
 s_add_u32 s45, s33, 4587520
 buffer_load_dwordx4 v11, s[16:19], s45 offen  lds
 ds_read_b64_tr_b16 a[56:57], v8 offset:32768
 ds_read_b64_tr_b16 a[58:59], v8 offset:33792
 ds_read_b64_tr_b16 a[128:129], v9 offset:32768
 ds_read_b64_tr_b16 a[130:131], v9 offset:33792
 ds_read_b64_tr_b16 a[200:201], v8 offset:40960
 ds_read_b64_tr_b16 a[202:203], v8 offset:41984
 ds_read_b64_tr_b16 v[240:241], v9 offset:40960
 ds_read_b64_tr_b16 v[242:243], v9 offset:41984
 s_waitcnt vmcnt(8) lgkmcnt(0)
 s_barrier
 ds_read_b64_tr_b16 a[60:61], v8 offset:49152
 ds_read_b64_tr_b16 a[62:63], v8 offset:50176
 ds_read_b64_tr_b16 a[132:133], v9 offset:49152
 ds_read_b64_tr_b16 a[134:135], v9 offset:50176
 ds_read_b64_tr_b16 a[204:205], v8 offset:57344
 ds_read_b64_tr_b16 a[206:207], v8 offset:58368
 ds_read_b64_tr_b16 v[244:245], v9 offset:57344
 ds_read_b64_tr_b16 v[246:247], v9 offset:58368
 s_waitcnt vmcnt(4) lgkmcnt(0)
 s_barrier
 ds_read_b64_tr_b16 a[64:65], v8 offset:0
 ds_read_b64_tr_b16 a[66:67], v8 offset:1024
 ds_read_b64_tr_b16 a[136:137], v9 offset:0
 ds_read_b64_tr_b16 a[138:139], v9 offset:1024
 ds_read_b64_tr_b16 a[208:209], v8 offset:8192
 ds_read_b64_tr_b16 a[210:211], v8 offset:9216
 ds_read_b64_tr_b16 v[248:249], v9 offset:8192
 ds_read_b64_tr_b16 v[250:251], v9 offset:9216
 s_waitcnt vmcnt(0) lgkmcnt(0)
 s_barrier
 ds_read_b64_tr_b16 a[68:69], v8 offset:16384
 ds_read_b64_tr_b16 a[70:71], v8 offset:17408
 ds_read_b64_tr_b16 a[140:141], v9 offset:16384
 ds_read_b64_tr_b16 a[142:143], v9 offset:17408
 ds_read_b64_tr_b16 a[212:213], v8 offset:24576
 ds_read_b64_tr_b16 a[214:215], v8 offset:25600
 ds_read_b64_tr_b16 v[252:253], v9 offset:24576
 ds_read_b64_tr_b16 v[254:255], v9 offset:25600
 s_mov_b32 s50, 0x3e0293ee
 s_mov_b32 s42, 0
 s_mov_b32 s43, 0
 s_mov_b32 s44, 73728
 v_mov_b32 v6, v4
 v_mov_b32 v7, v5
 s_mov_b32 s95, 0x40000
 s_cmp_lg_u32 s4, 0
 s_cbranch_scc1 Lfrk_17
 v_min_u32 v21, 1, v0
 v_lshlrev_b32 v21, 28, v21
Lfr_16:
 buffer_load_dword v20, v21, s[28:31], 0 offen offset:0 sc1
 s_waitcnt vmcnt(0)
 v_cmp_eq_u32 vcc, 1, v20
 s_cbranch_vccnz Lfrk_17
 s_sub_u32 s95, s95, 1
 s_cbranch_scc0 Lfr_16
 s_endpgm
Lfrk_17:
 s_lshl_b32 s47, s2, 13
 s_add_u32 s47, s47, 0x8000000
 s_mov_b32 s48, s47
 v_mov_b32 v14, 0
 s_waitcnt vmcnt(0) lgkmcnt(0)
 s_barrier
 ds_read_b128 v[32:35], v6 offset:0
 ds_read_b128 v[36:39], v6 offset:2048
 ds_read_b128 v[40:43], v7 offset:0
 ds_read_b128 v[44:47], v7 offset:2048
 v_lshlrev_b32 v1, 12, v0
 s_lshl_b32 s45, s6, 7
 buffer_load_dword v15, v1, s[8:11], s45 offen
 v_add_u32 v1, 0x100000, v1
 buffer_load_dword v15, v1, s[8:11], s45 offen
 v_add_u32 v1, 0x100000, v1
 buffer_load_dword v15, v1, s[8:11], s45 offen
 v_add_u32 v1, 0x100000, v1
 s_waitcnt lgkmcnt(2)
Lps_loop_18:
 v_mfma_f32_16x16x32_bf16 v[64:67], a[0:3], v[32:35], 0
 ds_read_b128 v[48:51], v6 offset:4096
 v_mfma_f32_16x16x32_bf16 v[72:75], a[72:75], v[32:35], 0
 ds_read_b128 v[52:55], v6 offset:6144
 v_mfma_f32_16x16x32_bf16 v[80:83], v[32:35], a[144:147], 0
 s_add_u32 s41, s40, 1
 v_mfma_f32_16x16x32_bf16 v[88:91], v[32:35], a[216:219], 0
 s_add_u32 s45, s42, 2
 s_mul_i32 s46, s41, 36864
 v_mfma_f32_16x16x32_bf16 v[68:71], a[0:3], v[36:39], 0
 s_cmp_lt_u32 s45, s36
 s_cselect_b32 s46, s46, 0
 v_mfma_f32_16x16x32_bf16 v[76:79], a[72:75], v[36:39], 0
 s_lshl_b32 s49, s4, 10
 s_add_u32 s49, s49, s44
 v_mfma_f32_16x16x32_bf16 v[84:87], v[36:39], a[144:147], 0
 v_cvt_pk_bf16_f32 v16, v96, v97
 v_mfma_f32_16x16x32_bf16 v[92:95], v[36:39], a[216:219], 0
 s_waitcnt lgkmcnt(2)
 v_mfma_f32_16x16x32_bf16 v[64:67], a[4:7], v[40:43], v[64:67]
 ds_read_b128 v[56:59], v7 offset:4096
 v_mfma_f32_16x16x32_bf16 v[72:75], a[76:79], v[40:43], v[72:75]
 ds_read_b128 v[60:63], v7 offset:6144
 v_mfma_f32_16x16x32_bf16 v[80:83], v[40:43], a[148:151], v[80:83]
 v_cvt_pk_bf16_f32 v17, v104, v105
 v_mfma_f32_16x16x32_bf16 v[88:91], v[40:43], a[220:223], v[88:91]
 v_cvt_pk_bf16_f32 v18, v98, v99
 v_mfma_f32_16x16x32_bf16 v[68:71], a[4:7], v[44:47], v[68:71]
 v_cvt_pk_bf16_f32 v19, v106, v107
 v_mfma_f32_16x16x32_bf16 v[76:79], a[76:79], v[44:47], v[76:79]
 buffer_store_dwordx4 v[16:19], v12, s[20:23], s47 offen offset:0 sc1
 v_mfma_f32_16x16x32_bf16 v[84:87], v[44:47], a[148:151], v[84:87]
 v_cvt_pk_bf16_f32 v20, v100, v101
 v_mfma_f32_16x16x32_bf16 v[92:95], v[44:47], a[220:223], v[92:95]
 s_waitcnt lgkmcnt(2)
 v_mfma_f32_16x16x32_bf16 v[64:67], a[8:11], v[48:51], v[64:67]
 ds_read_b128 v[32:35], v6 offset:8192
 v_mfma_f32_16x16x32_bf16 v[72:75], a[80:83], v[48:51], v[72:75]
 ds_read_b128 v[36:39], v6 offset:10240
 v_mfma_f32_16x16x32_bf16 v[80:83], v[48:51], a[152:155], v[80:83]
 v_cvt_pk_bf16_f32 v21, v108, v109
 v_mfma_f32_16x16x32_bf16 v[88:91], v[48:51], a[224:227], v[88:91]
 v_cvt_pk_bf16_f32 v22, v102, v103
 v_mfma_f32_16x16x32_bf16 v[68:71], a[8:11], v[52:55], v[68:71]
 v_cvt_pk_bf16_f32 v23, v110, v111
 v_mfma_f32_16x16x32_bf16 v[76:79], a[80:83], v[52:55], v[76:79]
 buffer_store_dwordx4 v[20:23], v12, s[20:23], s47 offen offset:1024 sc1
 v_mfma_f32_16x16x32_bf16 v[84:87], v[52:55], a[152:155], v[84:87]
 v_cvt_pk_bf16_f32 v24, v112, v113
 v_mfma_f32_16x16x32_bf16 v[92:95], v[52:55], a[224:227], v[92:95]
 s_waitcnt lgkmcnt(2)
 v_mfma_f32_16x16x32_bf16 v[64:67], a[12:15], v[56:59], v[64:67]
 ds_read_b128 v[40:43], v7 offset:8192
 v_mfma_f32_16x16x32_bf16 v[72:75], a[84:87], v[56:59], v[72:75]
 ds_read_b128 v[44:47], v7 offset:10240
 v_mfma_f32_16x16x32_bf16 v[80:83], v[56:59], a[156:159], v[80:83]
 v_cvt_pk_bf16_f32 v25, v116, v117
 v_mfma_f32_16x16x32_bf16 v[88:91], v[56:59], a[228:231], v[88:91]
 v_cvt_pk_bf16_f32 v26, v114, v115
 v_mfma_f32_16x16x32_bf16 v[68:71], a[12:15], v[60:63], v[68:71]
 v_cvt_pk_bf16_f32 v27, v118, v119
 v_mfma_f32_16x16x32_bf16 v[76:79], a[84:87], v[60:63], v[76:79]
 buffer_store_dwordx4 v[24:27], v12, s[20:23], s48 offen offset:0 sc1
 v_mfma_f32_16x16x32_bf16 v[84:87], v[60:63], a[156:159], v[84:87]
 v_cvt_pk_bf16_f32 v28, v120, v121
 v_mfma_f32_16x16x32_bf16 v[92:95], v[60:63], a[228:231], v[92:95]
 s_waitcnt lgkmcnt(2)
 v_mfma_f32_16x16x32_bf16 v[64:67], a[16:19], v[32:35], v[64:67]
 ds_read_b128 v[48:51], v6 offset:12288
 v_mfma_f32_16x16x32_bf16 v[72:75], a[88:91], v[32:35], v[72:75]
 ds_read_b128 v[52:55], v6 offset:14336
 v_mfma_f32_16x16x32_bf16 v[80:83], v[32:35], a[160:163], v[80:83]
 v_cvt_pk_bf16_f32 v29, v124, v125
 v_mfma_f32_16x16x32_bf16 v[88:91], v[32:35], a[232:235], v[88:91]
 v_cvt_pk_bf16_f32 v30, v122, v123
 v_mfma_f32_16x16x32_bf16 v[68:71], a[16:19], v[36:39], v[68:71]
 v_cvt_pk_bf16_f32 v31, v126, v127
 v_mfma_f32_16x16x32_bf16 v[76:79], a[88:91], v[36:39], v[76:79]
 buffer_store_dwordx4 v[28:31], v12, s[20:23], s48 offen offset:1024 sc1
 v_mfma_f32_16x16x32_bf16 v[84:87], v[36:39], a[160:163], v[84:87]
 v_mfma_f32_16x16x32_bf16 v[92:95], v[36:39], a[232:235], v[92:95]
 s_waitcnt lgkmcnt(2)
 v_mfma_f32_16x16x32_bf16 v[64:67], a[20:23], v[40:43], v[64:67]
 ds_read_b128 v[56:59], v7 offset:12288
 v_mfma_f32_16x16x32_bf16 v[72:75], a[92:95], v[40:43], v[72:75]
 ds_read_b128 v[60:63], v7 offset:14336
 v_mfma_f32_16x16x32_bf16 v[80:83], v[40:43], a[164:167], v[80:83]
 s_add_u32 m0, s49, 0
 v_mfma_f32_16x16x32_bf16 v[88:91], v[40:43], a[236:239], v[88:91]
 buffer_load_dwordx4 v10, s[8:11], s46 offen offset:0  lds
 v_mfma_f32_16x16x32_bf16 v[68:71], a[20:23], v[44:47], v[68:71]
 s_add_u32 m0, s49, 3968
 v_mfma_f32_16x16x32_bf16 v[76:79], a[92:95], v[44:47], v[76:79]
 buffer_load_dwordx4 v10, s[8:11], s46 offen offset:128  lds
 v_mfma_f32_16x16x32_bf16 v[84:87], v[44:47], a[164:167], v[84:87]
 v_mfma_f32_16x16x32_bf16 v[92:95], v[44:47], a[236:239], v[92:95]
 s_waitcnt lgkmcnt(2)
 v_mfma_f32_16x16x32_bf16 v[64:67], a[24:27], v[48:51], v[64:67]
 ds_read_b128 v[32:35], v6 offset:16384
 v_mfma_f32_16x16x32_bf16 v[72:75], a[96:99], v[48:51], v[72:75]
 ds_read_b128 v[36:39], v6 offset:18432
 v_mfma_f32_16x16x32_bf16 v[80:83], v[48:51], a[168:171], v[80:83]
 s_add_u32 m0, s49, 7936
 v_mfma_f32_16x16x32_bf16 v[88:91], v[48:51], a[240:243], v[88:91]
 buffer_load_dwordx4 v10, s[8:11], s46 offen offset:256  lds
 v_mfma_f32_16x16x32_bf16 v[68:71], a[24:27], v[52:55], v[68:71]
 s_add_u32 m0, s49, 11904
 v_mfma_f32_16x16x32_bf16 v[76:79], a[96:99], v[52:55], v[76:79]
 buffer_load_dwordx4 v10, s[8:11], s46 offen offset:384  lds
 v_mfma_f32_16x16x32_bf16 v[84:87], v[52:55], a[168:171], v[84:87]
 v_mfma_f32_16x16x32_bf16 v[92:95], v[52:55], a[240:243], v[92:95]
 s_waitcnt lgkmcnt(2)
 v_mfma_f32_16x16x32_bf16 v[64:67], a[28:31], v[56:59], v[64:67]
 ds_read_b128 v[40:43], v7 offset:16384
 v_mfma_f32_16x16x32_bf16 v[72:75], a[100:103], v[56:59], v[72:75]
 ds_read_b128 v[44:47], v7 offset:18432
 v_mfma_f32_16x16x32_bf16 v[80:83], v[56:59], a[172:175], v[80:83]
 s_add_u32 m0, s49, 15872
 v_mfma_f32_16x16x32_bf16 v[88:91], v[56:59], a[244:247], v[88:91]
 buffer_load_dwordx4 v10, s[8:11], s46 offen offset:512  lds
 v_mfma_f32_16x16x32_bf16 v[68:71], a[28:31], v[60:63], v[68:71]
 s_add_u32 m0, s49, 19840
 v_mfma_f32_16x16x32_bf16 v[76:79], a[100:103], v[60:63], v[76:79]
 buffer_load_dwordx4 v10, s[8:11], s46 offen offset:640  lds
 v_mfma_f32_16x16x32_bf16 v[84:87], v[60:63], a[172:175], v[84:87]
 v_mfma_f32_16x16x32_bf16 v[92:95], v[60:63], a[244:247], v[92:95]
 s_waitcnt lgkmcnt(2)
 v_mfma_f32_16x16x32_bf16 v[64:67], a[32:35], v[32:35], v[64:67]
 ds_read_b128 v[48:51], v6 offset:20480
 v_mfma_f32_16x16x32_bf16 v[72:75], a[104:107], v[32:35], v[72:75]
 ds_read_b128 v[52:55], v6 offset:22528
 v_mfma_f32_16x16x32_bf16 v[80:83], v[32:35], a[176:179], v[80:83]
 s_add_u32 m0, s49, 23808
 v_mfma_f32_16x16x32_bf16 v[88:91], v[32:35], a[248:251], v[88:91]
 buffer_load_dwordx4 v10, s[8:11], s46 offen offset:768  lds
 v_mfma_f32_16x16x32_bf16 v[68:71], a[32:35], v[36:39], v[68:71]
 s_add_u32 m0, s49, 27776
 v_mfma_f32_16x16x32_bf16 v[76:79], a[104:107], v[36:39], v[76:79]
 buffer_load_dwordx4 v10, s[8:11], s46 offen offset:896  lds
 v_mfma_f32_16x16x32_bf16 v[84:87], v[36:39], a[176:179], v[84:87]
 v_mfma_f32_16x16x32_bf16 v[92:95], v[36:39], a[248:251], v[92:95]
 s_waitcnt lgkmcnt(2)
 v_mfma_f32_16x16x32_bf16 v[64:67], a[36:39], v[40:43], v[64:67]
 ds_read_b128 v[56:59], v7 offset:20480
 v_mfma_f32_16x16x32_bf16 v[72:75], a[108:111], v[40:43], v[72:75]
 ds_read_b128 v[60:63], v7 offset:22528
 v_mfma_f32_16x16x32_bf16 v[80:83], v[40:43], a[180:183], v[80:83]
 s_add_u32 m0, s49, 31744
 v_mfma_f32_16x16x32_bf16 v[88:91], v[40:43], a[252:255], v[88:91]
 buffer_load_dwordx4 v10, s[8:11], s46 offen offset:1024  lds
 v_mfma_f32_16x16x32_bf16 v[68:71], a[36:39], v[44:47], v[68:71]
 v_mfma_f32_16x16x32_bf16 v[76:79], a[108:111], v[44:47], v[76:79]
 v_mfma_f32_16x16x32_bf16 v[84:87], v[44:47], a[180:183], v[84:87]
 v_mfma_f32_16x16x32_bf16 v[92:95], v[44:47], a[252:255], v[92:95]
 s_waitcnt lgkmcnt(2)
 v_mfma_f32_16x16x32_bf16 v[64:67], a[40:43], v[48:51], v[64:67]
 ds_read_b128 v[32:35], v6 offset:24576
 v_mfma_f32_16x16x32_bf16 v[72:75], a[112:115], v[48:51], v[72:75]
 ds_read_b128 v[36:39], v6 offset:26624
 v_mfma_f32_16x16x32_bf16 v[80:83], v[48:51], a[184:187], v[80:83]
 v_mfma_f32_16x16x32_bf16 v[88:91], v[48:51], v[224:227], v[88:91]
 v_mfma_f32_16x16x32_bf16 v[68:71], a[40:43], v[52:55], v[68:71]
 v_mfma_f32_16x16x32_bf16 v[76:79], a[112:115], v[52:55], v[76:79]
 v_mfma_f32_16x16x32_bf16 v[84:87], v[52:55], a[184:187], v[84:87]
 v_mfma_f32_16x16x32_bf16 v[92:95], v[52:55], v[224:227], v[92:95]
 s_waitcnt lgkmcnt(2)
 v_mfma_f32_16x16x32_bf16 v[64:67], a[44:47], v[56:59], v[64:67]
 ds_read_b128 v[40:43], v7 offset:24576
 v_mfma_f32_16x16x32_bf16 v[72:75], a[116:119], v[56:59], v[72:75]
 ds_read_b128 v[44:47], v7 offset:26624
 v_mfma_f32_16x16x32_bf16 v[80:83], v[56:59], a[188:191], v[80:83]
 v_mfma_f32_16x16x32_bf16 v[88:91], v[56:59], v[228:231], v[88:91]
 v_mfma_f32_16x16x32_bf16 v[68:71], a[44:47], v[60:63], v[68:71]
 v_mfma_f32_16x16x32_bf16 v[76:79], a[116:119], v[60:63], v[76:79]
 v_mfma_f32_16x16x32_bf16 v[84:87], v[60:63], a[188:191], v[84:87]
 v_mfma_f32_16x16x32_bf16 v[92:95], v[60:63], v[228:231], v[92:95]
 s_waitcnt lgkmcnt(2)
 v_mfma_f32_16x16x32_bf16 v[64:67], a[48:51], v[32:35], v[64:67]
 ds_read_b128 v[48:51], v6 offset:28672
 v_mfma_f32_16x16x32_bf16 v[72:75], a[120:123], v[32:35], v[72:75]
 ds_read_b128 v[52:55], v6 offset:30720
 v_mfma_f32_16x16x32_bf16 v[80:83], v[32:35], a[192:195], v[80:83]
 v_mfma_f32_16x16x32_bf16 v[88:91], v[32:35], v[232:235], v[88:91]
 v_mfma_f32_16x16x32_bf16 v[68:71], a[48:51], v[36:39], v[68:71]
 v_mfma_f32_16x16x32_bf16 v[76:79], a[120:123], v[36:39], v[76:79]
 v_mfma_f32_16x16x32_bf16 v[84:87], v[36:39], a[192:195], v[84:87]
 v_mfma_f32_16x16x32_bf16 v[92:95], v[36:39], v[232:235], v[92:95]
 s_waitcnt lgkmcnt(2)
 v_mfma_f32_16x16x32_bf16 v[64:67], a[52:55], v[40:43], v[64:67]
 ds_read_b128 v[56:59], v7 offset:28672
 v_mfma_f32_16x16x32_bf16 v[72:75], a[124:127], v[40:43], v[72:75]
 ds_read_b128 v[60:63], v7 offset:30720
 v_mfma_f32_16x16x32_bf16 v[80:83], v[40:43], a[196:199], v[80:83]
 s_add_u32 s43, s43, 36864
 s_cmp_eq_u32 s43, 147456
 v_mfma_f32_16x16x32_bf16 v[88:91], v[40:43], v[236:239], v[88:91]
 s_cselect_b32 s43, 0, s43
 s_add_u32 s44, s44, 36864
 v_mfma_f32_16x16x32_bf16 v[68:71], a[52:55], v[44:47], v[68:71]
 s_cmp_eq_u32 s44, 147456
 s_cselect_b32 s44, 0, s44
 v_mfma_f32_16x16x32_bf16 v[76:79], a[124:127], v[44:47], v[76:79]
 v_mfma_f32_16x16x32_bf16 v[84:87], v[44:47], a[196:199], v[84:87]
 v_mfma_f32_16x16x32_bf16 v[92:95], v[44:47], v[236:239], v[92:95]
 s_waitcnt lgkmcnt(2)
 v_mfma_f32_16x16x32_bf16 v[64:67], a[56:59], v[48:51], v[64:67]
 ds_read_b128 v[32:35], v6 offset:32768
 v_mfma_f32_16x16x32_bf16 v[72:75], a[128:131], v[48:51], v[72:75]
 ds_read_b128 v[36:39], v6 offset:34816
 v_mfma_f32_16x16x32_bf16 v[80:83], v[48:51], a[200:203], v[80:83]
 v_add_u32 v6, s43, v4
 v_mfma_f32_16x16x32_bf16 v[88:91], v[48:51], v[240:243], v[88:91]
 v_mfma_f32_16x16x32_bf16 v[68:71], a[56:59], v[52:55], v[68:71]
 v_mfma_f32_16x16x32_bf16 v[76:79], a[128:131], v[52:55], v[76:79]
 v_mfma_f32_16x16x32_bf16 v[84:87], v[52:55], a[200:203], v[84:87]
 v_mfma_f32_16x16x32_bf16 v[92:95], v[52:55], v[240:243], v[92:95]
 s_waitcnt lgkmcnt(2)
 v_mfma_f32_16x16x32_bf16 v[64:67], a[60:63], v[56:59], v[64:67]
 ds_read_b128 v[40:43], v7 offset:32768
 v_mfma_f32_16x16x32_bf16 v[72:75], a[132:135], v[56:59], v[72:75]
 ds_read_b128 v[44:47], v7 offset:34816
 v_mfma_f32_16x16x32_bf16 v[80:83], v[56:59], a[204:207], v[80:83]
 v_add_u32 v7, s43, v5
 v_mfma_f32_16x16x32_bf16 v[88:91], v[56:59], v[244:247], v[88:91]
 v_mfma_f32_16x16x32_bf16 v[68:71], a[60:63], v[60:63], v[68:71]
 v_mfma_f32_16x16x32_bf16 v[76:79], a[132:135], v[60:63], v[76:79]
 v_mfma_f32_16x16x32_bf16 v[84:87], v[60:63], a[204:207], v[84:87]
 v_mfma_f32_16x16x32_bf16 v[92:95], v[60:63], v[244:247], v[92:95]
 s_waitcnt lgkmcnt(2)
 v_mfma_f32_16x16x32_bf16 v[64:67], a[64:67], v[32:35], v[64:67]
 s_waitcnt vmcnt(9)
 s_barrier
 ds_read_b128 v[48:51], v6 offset:0
 v_mfma_f32_16x16x32_bf16 v[72:75], a[136:139], v[32:35], v[72:75]
 ds_read_b128 v[52:55], v6 offset:2048
 v_mfma_f32_16x16x32_bf16 v[80:83], v[32:35], a[208:211], v[80:83]
 buffer_store_dword v14, v13, s[20:23], 0 offen sc1
 v_mfma_f32_16x16x32_bf16 v[88:91], v[32:35], v[248:251], v[88:91]
 v_mfma_f32_16x16x32_bf16 v[68:71], a[64:67], v[36:39], v[68:71]
 v_mfma_f32_16x16x32_bf16 v[76:79], a[136:139], v[36:39], v[76:79]
 v_mfma_f32_16x16x32_bf16 v[84:87], v[36:39], a[208:211], v[84:87]
 v_mfma_f32_16x16x32_bf16 v[92:95], v[36:39], v[248:251], v[92:95]
 s_waitcnt lgkmcnt(2)
 v_mfma_f32_16x16x32_bf16 v[64:67], a[68:71], v[40:43], v[64:67]
 ds_read_b128 v[56:59], v7 offset:0
 v_mfma_f32_16x16x32_bf16 v[72:75], a[140:143], v[40:43], v[72:75]
 ds_read_b128 v[60:63], v7 offset:2048
 v_mfma_f32_16x16x32_bf16 v[80:83], v[40:43], a[212:215], v[80:83]
 s_mul_i32 s45, s39, 524288
 s_add_u32 s47, s34, s45
 v_mfma_f32_16x16x32_bf16 v[88:91], v[40:43], v[252:255], v[88:91]
 s_add_u32 s48, s35, s45
 v_add_u32 v14, 1, v14
 v_mfma_f32_16x16x32_bf16 v[68:71], a[68:71], v[44:47], v[68:71]
 s_mov_b32 s39, s40
 s_mov_b32 s40, s41
 v_mfma_f32_16x16x32_bf16 v[76:79], a[140:143], v[44:47], v[76:79]
 s_add_u32 s42, s42, 1
 v_mfma_f32_16x16x32_bf16 v[84:87], v[44:47], a[212:215], v[84:87]
 v_mfma_f32_16x16x32_bf16 v[92:95], v[44:47], v[252:255], v[92:95]
 s_waitcnt lgkmcnt(2)
 v_mfma_f32_16x16x32_bf16 v[96:99], a[0:3], v[48:51], 0
 ds_read_b128 v[32:35], v6 offset:4096
 v_mfma_f32_16x16x32_bf16 v[104:107], a[72:75], v[48:51], 0
 ds_read_b128 v[36:39], v6 offset:6144
 v_mfma_f32_16x16x32_bf16 v[112:115], v[48:51], a[144:147], 0
 s_add_u32 s41, s40, 1
 v_mfma_f32_16x16x32_bf16 v[120:123], v[48:51], a[216:219], 0
 s_add_u32 s45, s42, 2
 s_mul_i32 s46, s41, 36864
 v_mfma_f32_16x16x32_bf16 v[100:103], a[0:3], v[52:55], 0
 s_cmp_lt_u32 s45, s36
 s_cselect_b32 s46, s46, 0
 v_mfma_f32_16x16x32_bf16 v[108:111], a[72:75], v[52:55], 0
 s_lshl_b32 s49, s4, 10
 s_add_u32 s49, s49, s44
 v_mfma_f32_16x16x32_bf16 v[116:119], v[52:55], a[144:147], 0
 v_cvt_pk_bf16_f32 v16, v64, v65
 v_mfma_f32_16x16x32_bf16 v[124:127], v[52:55], a[216:219], 0
 s_waitcnt lgkmcnt(2)
 v_mfma_f32_16x16x32_bf16 v[96:99], a[4:7], v[56:59], v[96:99]
 ds_read_b128 v[40:43], v7 offset:4096
 v_mfma_f32_16x16x32_bf16 v[104:107], a[76:79], v[56:59], v[104:107]
 ds_read_b128 v[44:47], v7 offset:6144
 v_mfma_f32_16x16x32_bf16 v[112:115], v[56:59], a[148:151], v[112:115]
 v_cvt_pk_bf16_f32 v17, v72, v73
 v_mfma_f32_16x16x32_bf16 v[120:123], v[56:59], a[220:223], v[120:123]
 v_cvt_pk_bf16_f32 v18, v66, v67
 v_mfma_f32_16x16x32_bf16 v[100:103], a[4:7], v[60:63], v[100:103]
 v_cvt_pk_bf16_f32 v19, v74, v75
 v_mfma_f32_16x16x32_bf16 v[108:111], a[76:79], v[60:63], v[108:111]
 buffer_store_dwordx4 v[16:19], v12, s[20:23], s47 offen offset:0 sc1
 v_mfma_f32_16x16x32_bf16 v[116:119], v[60:63], a[148:151], v[116:119]
 v_cvt_pk_bf16_f32 v20, v68, v69
 v_mfma_f32_16x16x32_bf16 v[124:127], v[60:63], a[220:223], v[124:127]
 s_waitcnt lgkmcnt(2)
 v_mfma_f32_16x16x32_bf16 v[96:99], a[8:11], v[32:35], v[96:99]
 ds_read_b128 v[48:51], v6 offset:8192
 v_mfma_f32_16x16x32_bf16 v[104:107], a[80:83], v[32:35], v[104:107]
 ds_read_b128 v[52:55], v6 offset:10240
 v_mfma_f32_16x16x32_bf16 v[112:115], v[32:35], a[152:155], v[112:115]
 v_cvt_pk_bf16_f32 v21, v76, v77
 v_mfma_f32_16x16x32_bf16 v[120:123], v[32:35], a[224:227], v[120:123]
 v_cvt_pk_bf16_f32 v22, v70, v71
 v_mfma_f32_16x16x32_bf16 v[100:103], a[8:11], v[36:39], v[100:103]
 v_cvt_pk_bf16_f32 v23, v78, v79
 v_mfma_f32_16x16x32_bf16 v[108:111], a[80:83], v[36:39], v[108:111]
 buffer_store_dwordx4 v[20:23], v12, s[20:23], s47 offen offset:1024 sc1
 v_mfma_f32_16x16x32_bf16 v[116:119], v[36:39], a[152:155], v[116:119]
 v_cvt_pk_bf16_f32 v24, v80, v81
 v_mfma_f32_16x16x32_bf16 v[124:127], v[36:39], a[224:227], v[124:127]
 s_waitcnt lgkmcnt(2)
 v_mfma_f32_16x16x32_bf16 v[96:99], a[12:15], v[40:43], v[96:99]
 ds_read_b128 v[56:59], v7 offset:8192
 v_mfma_f32_16x16x32_bf16 v[104:107], a[84:87], v[40:43], v[104:107]
 ds_read_b128 v[60:63], v7 offset:10240
 v_mfma_f32_16x16x32_bf16 v[112:115], v[40:43], a[156:159], v[112:115]
 v_cvt_pk_bf16_f32 v25, v84, v85
 v_mfma_f32_16x16x32_bf16 v[120:123], v[40:43], a[228:231], v[120:123]
 v_cvt_pk_bf16_f32 v26, v82, v83
 v_mfma_f32_16x16x32_bf16 v[100:103], a[12:15], v[44:47], v[100:103]
 v_cvt_pk_bf16_f32 v27, v86, v87
 v_mfma_f32_16x16x32_bf16 v[108:111], a[84:87], v[44:47], v[108:111]
 buffer_store_dwordx4 v[24:27], v12, s[20:23], s48 offen offset:0 sc1
 v_mfma_f32_16x16x32_bf16 v[116:119], v[44:47], a[156:159], v[116:119]
 v_cvt_pk_bf16_f32 v28, v88, v89
 v_mfma_f32_16x16x32_bf16 v[124:127], v[44:47], a[228:231], v[124:127]
 s_waitcnt lgkmcnt(2)
 v_mfma_f32_16x16x32_bf16 v[96:99], a[16:19], v[48:51], v[96:99]
 ds_read_b128 v[32:35], v6 offset:12288
 v_mfma_f32_16x16x32_bf16 v[104:107], a[88:91], v[48:51], v[104:107]
 ds_read_b128 v[36:39], v6 offset:14336
 v_mfma_f32_16x16x32_bf16 v[112:115], v[48:51], a[160:163], v[112:115]
 v_cvt_pk_bf16_f32 v29, v92, v93
 v_mfma_f32_16x16x32_bf16 v[120:123], v[48:51], a[232:235], v[120:123]
 v_cvt_pk_bf16_f32 v30, v90, v91
 v_mfma_f32_16x16x32_bf16 v[100:103], a[16:19], v[52:55], v[100:103]
 v_cvt_pk_bf16_f32 v31, v94, v95
 v_mfma_f32_16x16x32_bf16 v[108:111], a[88:91], v[52:55], v[108:111]
 buffer_store_dwordx4 v[28:31], v12, s[20:23], s48 offen offset:1024 sc1
 v_mfma_f32_16x16x32_bf16 v[116:119], v[52:55], a[160:163], v[116:119]
 v_mfma_f32_16x16x32_bf16 v[124:127], v[52:55], a[232:235], v[124:127]
 s_waitcnt lgkmcnt(2)
 v_mfma_f32_16x16x32_bf16 v[96:99], a[20:23], v[56:59], v[96:99]
 ds_read_b128 v[40:43], v7 offset:12288
 v_mfma_f32_16x16x32_bf16 v[104:107], a[92:95], v[56:59], v[104:107]
 ds_read_b128 v[44:47], v7 offset:14336
 v_mfma_f32_16x16x32_bf16 v[112:115], v[56:59], a[164:167], v[112:115]
 s_add_u32 m0, s49, 0
 v_mfma_f32_16x16x32_bf16 v[120:123], v[56:59], a[236:239], v[120:123]
 buffer_load_dwordx4 v10, s[8:11], s46 offen offset:0  lds
 v_mfma_f32_16x16x32_bf16 v[100:103], a[20:23], v[60:63], v[100:103]
 s_add_u32 m0, s49, 3968
 v_mfma_f32_16x16x32_bf16 v[108:111], a[92:95], v[60:63], v[108:111]
 buffer_load_dwordx4 v10, s[8:11], s46 offen offset:128  lds
 v_mfma_f32_16x16x32_bf16 v[116:119], v[60:63], a[164:167], v[116:119]
 v_mfma_f32_16x16x32_bf16 v[124:127], v[60:63], a[236:239], v[124:127]
 s_waitcnt lgkmcnt(2)
 v_mfma_f32_16x16x32_bf16 v[96:99], a[24:27], v[32:35], v[96:99]
 ds_read_b128 v[48:51], v6 offset:16384
 v_mfma_f32_16x16x32_bf16 v[104:107], a[96:99], v[32:35], v[104:107]
 ds_read_b128 v[52:55], v6 offset:18432
 v_mfma_f32_16x16x32_bf16 v[112:115], v[32:35], a[168:171], v[112:115]
 s_add_u32 m0, s49, 7936
 v_mfma_f32_16x16x32_bf16 v[120:123], v[32:35], a[240:243], v[120:123]
 buffer_load_dwordx4 v10, s[8:11], s46 offen offset:256  lds
 v_mfma_f32_16x16x32_bf16 v[100:103], a[24:27], v[36:39], v[100:103]
 s_add_u32 m0, s49, 11904
 v_mfma_f32_16x16x32_bf16 v[108:111], a[96:99], v[36:39], v[108:111]
 buffer_load_dwordx4 v10, s[8:11], s46 offen offset:384  lds
 v_mfma_f32_16x16x32_bf16 v[116:119], v[36:39], a[168:171], v[116:119]
 v_mfma_f32_16x16x32_bf16 v[124:127], v[36:39], a[240:243], v[124:127]
 s_waitcnt lgkmcnt(2)
 v_mfma_f32_16x16x32_bf16 v[96:99], a[28:31], v[40:43], v[96:99]
 ds_read_b128 v[56:59], v7 offset:16384
 v_mfma_f32_16x16x32_bf16 v[104:107], a[100:103], v[40:43], v[104:107]
 ds_read_b128 v[60:63], v7 offset:18432
 v_mfma_f32_16x16x32_bf16 v[112:115], v[40:43], a[172:175], v[112:115]
 s_add_u32 m0, s49, 15872
 v_mfma_f32_16x16x32_bf16 v[120:123], v[40:43], a[244:247], v[120:123]
 buffer_load_dwordx4 v10, s[8:11], s46 offen offset:512  lds
 v_mfma_f32_16x16x32_bf16 v[100:103], a[28:31], v[44:47], v[100:103]
 s_add_u32 m0, s49, 19840
 v_mfma_f32_16x16x32_bf16 v[108:111], a[100:103], v[44:47], v[108:111]
 buffer_load_dwordx4 v10, s[8:11], s46 offen offset:640  lds
 v_mfma_f32_16x16x32_bf16 v[116:119], v[44:47], a[172:175], v[116:119]
 v_mfma_f32_16x16x32_bf16 v[124:127], v[44:47], a[244:247], v[124:127]
 s_waitcnt lgkmcnt(2)
 v_mfma_f32_16x16x32_bf16 v[96:99], a[32:35], v[48:51], v[96:99]
 ds_read_b128 v[32:35], v6 offset:20480
 v_mfma_f32_16x16x32_bf16 v[104:107], a[104:107], v[48:51], v[104:107]
 ds_read_b128 v[36:39], v6 offset:22528
 v_mfma_f32_16x16x32_bf16 v[112:115], v[48:51], a[176:179], v[112:115]
 s_add_u32 m0, s49, 23808
 v_mfma_f32_16x16x32_bf16 v[120:123], v[48:51], a[248:251], v[120:123]
 buffer_load_dwordx4 v10, s[8:11], s46 offen offset:768  lds
 v_mfma_f32_16x16x32_bf16 v[100:103], a[32:35], v[52:55], v[100:103]
 s_add_u32 m0, s49, 27776
 v_mfma_f32_16x16x32_bf16 v[108:111], a[104:107], v[52:55], v[108:111]
 buffer_load_dwordx4 v10, s[8:11], s46 offen offset:896  lds
 v_mfma_f32_16x16x32_bf16 v[116:119], v[52:55], a[176:179], v[116:119]
 v_mfma_f32_16x16x32_bf16 v[124:127], v[52:55], a[248:251], v[124:127]
 s_waitcnt lgkmcnt(2)
 v_mfma_f32_16x16x32_bf16 v[96:99], a[36:39], v[56:59], v[96:99]
 ds_read_b128 v[40:43], v7 offset:20480
 v_mfma_f32_16x16x32_bf16 v[104:107], a[108:111], v[56:59], v[104:107]
 ds_read_b128 v[44:47], v7 offset:22528
 v_mfma_f32_16x16x32_bf16 v[112:115], v[56:59], a[180:183], v[112:115]
 s_add_u32 m0, s49, 31744
 v_mfma_f32_16x16x32_bf16 v[120:123], v[56:59], a[252:255], v[120:123]
 buffer_load_dwordx4 v10, s[8:11], s46 offen offset:1024  lds
 v_mfma_f32_16x16x32_bf16 v[100:103], a[36:39], v[60:63], v[100:103]
 v_mfma_f32_16x16x32_bf16 v[108:111], a[108:111], v[60:63], v[108:111]
 v_mfma_f32_16x16x32_bf16 v[116:119], v[60:63], a[180:183], v[116:119]
 v_mfma_f32_16x16x32_bf16 v[124:127], v[60:63], a[252:255], v[124:127]
 s_waitcnt lgkmcnt(2)
 v_mfma_f32_16x16x32_bf16 v[96:99], a[40:43], v[32:35], v[96:99]
 ds_read_b128 v[48:51], v6 offset:24576
 v_mfma_f32_16x16x32_bf16 v[104:107], a[112:115], v[32:35], v[104:107]
 ds_read_b128 v[52:55], v6 offset:26624
 v_mfma_f32_16x16x32_bf16 v[112:115], v[32:35], a[184:187], v[112:115]
 v_mfma_f32_16x16x32_bf16 v[120:123], v[32:35], v[224:227], v[120:123]
 v_mfma_f32_16x16x32_bf16 v[100:103], a[40:43], v[36:39], v[100:103]
 v_mfma_f32_16x16x32_bf16 v[108:111], a[112:115], v[36:39], v[108:111]
 v_mfma_f32_16x16x32_bf16 v[116:119], v[36:39], a[184:187], v[116:119]
 v_mfma_f32_16x16x32_bf16 v[124:127], v[36:39], v[224:227], v[124:127]
 s_waitcnt lgkmcnt(2)
 v_mfma_f32_16x16x32_bf16 v[96:99], a[44:47], v[40:43], v[96:99]
 ds_read_b128 v[56:59], v7 offset:24576
 v_mfma_f32_16x16x32_bf16 v[104:107], a[116:119], v[40:43], v[104:107]
 ds_read_b128 v[60:63], v7 offset:26624
 v_mfma_f32_16x16x32_bf16 v[112:115], v[40:43], a[188:191], v[112:115]
 v_mfma_f32_16x16x32_bf16 v[120:123], v[40:43], v[228:231], v[120:123]
 v_mfma_f32_16x16x32_bf16 v[100:103], a[44:47], v[44:47], v[100:103]
 v_mfma_f32_16x16x32_bf16 v[108:111], a[116:119], v[44:47], v[108:111]
 v_mfma_f32_16x16x32_bf16 v[116:119], v[44:47], a[188:191], v[116:119]
 v_mfma_f32_16x16x32_bf16 v[124:127], v[44:47], v[228:231], v[124:127]
 s_waitcnt lgkmcnt(2)
 v_mfma_f32_16x16x32_bf16 v[96:99], a[48:51], v[48:51], v[96:99]
 ds_read_b128 v[32:35], v6 offset:28672
 v_mfma_f32_16x16x32_bf16 v[104:107], a[120:123], v[48:51], v[104:107]
 ds_read_b128 v[36:39], v6 offset:30720
 v_mfma_f32_16x16x32_bf16 v[112:115], v[48:51], a[192:195], v[112:115]
 v_mfma_f32_16x16x32_bf16 v[120:123], v[48:51], v[232:235], v[120:123]
 v_mfma_f32_16x16x32_bf16 v[100:103], a[48:51], v[52:55], v[100:103]
 v_mfma_f32_16x16x32_bf16 v[108:111], a[120:123], v[52:55], v[108:111]
 v_mfma_f32_16x16x32_bf16 v[116:119], v[52:55], a[192:195], v[116:119]
 v_mfma_f32_16x16x32_bf16 v[124:127], v[52:55], v[232:235], v[124:127]
 s_waitcnt lgkmcnt(2)
 v_mfma_f32_16x16x32_bf16 v[96:99], a[52:55], v[56:59], v[96:99]
 ds_read_b128 v[40:43], v7 offset:28672
 v_mfma_f32_16x16x32_bf16 v[104:107], a[124:127], v[56:59], v[104:107]
 ds_read_b128 v[44:47], v7 offset:30720
 v_mfma_f32_16x16x32_bf16 v[112:115], v[56:59], a[196:199], v[112:115]
 s_add_u32 s43, s43, 36864
 s_cmp_eq_u32 s43, 147456
 v_mfma_f32_16x16x32_bf16 v[120:123], v[56:59], v[236:239], v[120:123]
 s_cselect_b32 s43, 0, s43
 s_add_u32 s44, s44, 36864
 v_mfma_f32_16x16x32_bf16 v[100:103], a[52:55], v[60:63], v[100:103]
 s_cmp_eq_u32 s44, 147456
 s_cselect_b32 s44, 0, s44
 v_mfma_f32_16x16x32_bf16 v[108:111], a[124:127], v[60:63], v[108:111]
 v_mfma_f32_16x16x32_bf16 v[116:119], v[60:63], a[196:199], v[116:119]
 v_mfma_f32_16x16x32_bf16 v[124:127], v[60:63], v[236:239], v[124:127]
 s_waitcnt lgkmcnt(2)
 v_mfma_f32_16x16x32_bf16 v[96:99], a[56:59], v[32:35], v[96:99]
 ds_read_b128 v[48:51], v6 offset:32768
 v_mfma_f32_16x16x32_bf16 v[104:107], a[128:131], v[32:35], v[104:107]
 ds_read_b128 v[52:55], v6 offset:34816
 v_mfma_f32_16x16x32_bf16 v[112:115], v[32:35], a[200:203], v[112:115]
 v_add_u32 v6, s43, v4
 v_mfma_f32_16x16x32_bf16 v[120:123], v[32:35], v[240:243], v[120:123]
 v_mfma_f32_16x16x32_bf16 v[100:103], a[56:59], v[36:39], v[100:103]
 v_mfma_f32_16x16x32_bf16 v[108:111], a[128:131], v[36:39], v[108:111]
 v_mfma_f32_16x16x32_bf16 v[116:119], v[36:39], a[200:203], v[116:119]
 v_mfma_f32_16x16x32_bf16 v[124:127], v[36:39], v[240:243], v[124:127]
 s_waitcnt lgkmcnt(2)
 v_mfma_f32_16x16x32_bf16 v[96:99], a[60:63], v[40:43], v[96:99]
 ds_read_b128 v[56:59], v7 offset:32768
 v_mfma_f32_16x16x32_bf16 v[104:107], a[132:135], v[40:43], v[104:107]
 ds_read_b128 v[60:63], v7 offset:34816
 v_mfma_f32_16x16x32_bf16 v[112:115], v[40:43], a[204:207], v[112:115]
 v_add_u32 v7, s43, v5
 v_mfma_f32_16x16x32_bf16 v[120:123], v[40:43], v[244:247], v[120:123]
 v_mfma_f32_16x16x32_bf16 v[100:103], a[60:63], v[44:47], v[100:103]
 v_mfma_f32_16x16x32_bf16 v[108:111], a[132:135], v[44:47], v[108:111]
 v_mfma_f32_16x16x32_bf16 v[116:119], v[44:47], a[204:207], v[116:119]
 v_mfma_f32_16x16x32_bf16 v[124:127], v[44:47], v[244:247], v[124:127]
 s_waitcnt lgkmcnt(2)
 v_mfma_f32_16x16x32_bf16 v[96:99], a[64:67], v[48:51], v[96:99]
 s_waitcnt vmcnt(9)
 s_barrier
 ds_read_b128 v[32:35], v6 offset:0
 v_mfma_f32_16x16x32_bf16 v[104:107], a[136:139], v[48:51], v[104:107]
 ds_read_b128 v[36:39], v6 offset:2048
 v_mfma_f32_16x16x32_bf16 v[112:115], v[48:51], a[208:211], v[112:115]
 buffer_store_dword v14, v13, s[20:23], 0 offen sc1
 v_mfma_f32_16x16x32_bf16 v[120:123], v[48:51], v[248:251], v[120:123]
 v_mfma_f32_16x16x32_bf16 v[100:103], a[64:67], v[52:55], v[100:103]
 v_mfma_f32_16x16x32_bf16 v[108:111], a[136:139], v[52:55], v[108:111]
 v_mfma_f32_16x16x32_bf16 v[116:119], v[52:55], a[208:211], v[116:119]
 v_mfma_f32_16x16x32_bf16 v[124:127], v[52:55], v[248:251], v[124:127]
 s_waitcnt lgkmcnt(2)
 v_mfma_f32_16x16x32_bf16 v[96:99], a[68:71], v[56:59], v[96:99]
 ds_read_b128 v[40:43], v7 offset:0
 v_mfma_f32_16x16x32_bf16 v[104:107], a[140:143], v[56:59], v[104:107]
 ds_read_b128 v[44:47], v7 offset:2048
 v_mfma_f32_16x16x32_bf16 v[112:115], v[56:59], a[212:215], v[112:115]
 s_mul_i32 s45, s39, 524288
 s_add_u32 s47, s34, s45
 v_mfma_f32_16x16x32_bf16 v[120:123], v[56:59], v[252:255], v[120:123]
 s_add_u32 s48, s35, s45
 v_add_u32 v14, 1, v14
 v_mfma_f32_16x16x32_bf16 v[100:103], a[68:71], v[60:63], v[100:103]
 s_mov_b32 s39, s40
 s_mov_b32 s40, s41
 v_mfma_f32_16x16x32_bf16 v[108:111], a[140:143], v[60:63], v[108:111]
 s_add_u32 s42, s42, 1
 s_cmp_lt_u32 s42, s36
 v_mfma_f32_16x16x32_bf16 v[116:119], v[60:63], a[212:215], v[116:119]
 v_mfma_f32_16x16x32_bf16 v[124:127], v[60:63], v[252:255], v[124:127]
 s_waitcnt lgkmcnt(2)
 s_cbranch_scc1 Lps_loop_18
 s_nop 7
 v_cvt_pk_bf16_f32 v16, v96, v97
 v_cvt_pk_bf16_f32 v17, v104, v105
 v_cvt_pk_bf16_f32 v18, v98, v99
 v_cvt_pk_bf16_f32 v19, v106, v107
 buffer_store_dwordx4 v[16:19], v12, s[20:23], s47 offen offset:0 sc1
 v_cvt_pk_bf16_f32 v20, v100, v101
 v_cvt_pk_bf16_f32 v21, v108, v109
 v_cvt_pk_bf16_f32 v22, v102, v103
 v_cvt_pk_bf16_f32 v23, v110, v111
 buffer_store_dwordx4 v[20:23], v12, s[20:23], s47 offen offset:1024 sc1
 v_cvt_pk_bf16_f32 v24, v112, v113
 v_cvt_pk_bf16_f32 v25, v116, v117
 v_cvt_pk_bf16_f32 v26, v114, v115
 v_cvt_pk_bf16_f32 v27, v118, v119
 buffer_store_dwordx4 v[24:27], v12, s[20:23], s48 offen offset:0 sc1
 v_cvt_pk_bf16_f32 v28, v120, v121
 v_cvt_pk_bf16_f32 v29, v124, v125
 v_cvt_pk_bf16_f32 v30, v122, v123
 v_cvt_pk_bf16_f32 v31, v126, v127
 buffer_store_dwordx4 v[28:31], v12, s[20:23], s48 offen offset:1024 sc1
 s_waitcnt vmcnt(0) lgkmcnt(0)
 s_barrier
 v_mov_b32 v14, s36
 buffer_store_dword v14, v13, s[20:23], 0 offen sc1
 s_branch Lfin
Lqa:
 s_load_dwordx2 s[8:9], s[0:1], 0
 s_mov_b32 s10, 0x240000
 s_mov_b32 s11, 0x20000
 s_load_dwordx2 s[12:13], s[0:1], 16
 s_mov_b32 s14, 0x480000
 s_mov_b32 s15, 0x20000
 s_load_dwordx2 s[16:17], s[0:1], 16
 s_mov_b32 s18, 0x480000
 s_mov_b32 s19, 0x20000
 s_cmp_eq_u32 s2, 255
 s_cbranch_scc0 Lqa1
 v_mov_b32 v4, 0
 v_mov_b32 v5, 0
 v_mov_b32 v6, 0
 v_mov_b32 v7, 0
 v_lshlrev_b32 v1, 4, v0
 s_mov_b32 s7, 0
 buffer_store_dwordx4 v[4:7], v1, s[20:23], s7 offen sc1
 s_mov_b32 s7, 4096
 buffer_store_dwordx4 v[4:7], v1, s[20:23], s7 offen sc1
 s_mov_b32 s7, 8192
 buffer_store_dwordx4 v[4:7], v1, s[20:23], s7 offen sc1
 s_mov_b32 s7, 12288
 buffer_store_dwordx4 v[4:7], v1, s[20:23], s7 offen sc1
 s_mov_b32 s7, 16384
 buffer_store_dwordx4 v[4:7], v1, s[20:23], s7 offen sc1
 v_min_u32 v1, 1, v0
 v_lshlrev_b32 v1, 28, v1
 v_mov_b32 v2, 1
 s_waitcnt vmcnt(0)
 s_barrier
 buffer_store_dword v2, v1, s[28:31], 0 offen sc1
Lqa1:
 s_sub_u32 s3, s5, 2
 s_lshl_b32 s3, s3, 3
 s_lshr_b32 s7, s6, 2
 s_add_u32 s3, s3, s7
 s_lshl_b32 s32, s3, 9
 s_add_u32 s33, s32, 256
 s_lshl_b32 s34, s3, 14
 s_add_u32 s34, s34, 0x5000000
 s_add_u32 s35, s34, 8192
 s_mov_b32 s36, 16
 s_and_b32 s37, s6, 3
 s_lshl_b32 s7, s3, 5
 s_add_u32 s7, s7, s37
 s_lshl_b32 s7, s7, 2
 s_add_u32 s7, s7, 0x3000
 v_min_u32 v1, 1, v0
 v_lshlrev_b32 v1, 28, v1
 v_add_u32 v13, s7, v1
 s_waitcnt lgkmcnt(0)
 v_and_b32 v1, 63, v0
 v_lshrrev_b32 v2, 3, v0
 v_mul_u32_u24 v10, 1152, v2
 v_lshrrev_b32 v2, 4, v0
 v_xor_b32 v2, v2, v0
 v_and_b32 v2, 7, v2
 v_lshl_add_u32 v10, v2, 4, v10
 v_lshrrev_b32 v2, 4, v1
 v_bfe_u32 v3, v1, 1, 3
 v_xor_b32 v2, v2, v3
 v_and_b32 v3, 15, v1
 v_lshlrev_b32 v3, 7, v3
 v_lshl_add_u32 v4, v2, 4, v3
 v_xor_b32 v5, 64, v4
 v_lshrrev_b32 v2, 4, v0
 v_lshlrev_b32 v11, 13, v2
 v_lshrrev_b32 v2, 7, v0
 v_lshrrev_b32 v3, 4, v1
 v_lshl_add_u32 v3, v2, 2, v3
 v_bfe_u32 v2, v1, 1, 3
 v_xor_b32 v2, v2, v3
 v_lshl_add_u32 v11, v2, 5, v11
 v_and_b32 v2, 1, v1
 v_lshl_add_u32 v11, v2, 4, v11
 v_bfe_u32 v2, v1, 2, 3
 v_xor_b32 v3, s4, v2
 v_lshlrev_b32 v3, 5, v3
 v_and_b32 v2, 3, v2
 v_lshl_add_u32 v3, v2, 8, v3
 v_lshrrev_b32 v2, 4, v1
 v_lshl_add_u32 v3, v2, 11, v3
 v_and_b32 v2, 3, v1
 v_lshl_add_u32 v3, v2, 3, v3
 v_add_u32 v8, 73728, v3
 v_xor_b32 v3, 0x80, v3
 v_add_u32 v9, 73728, v3
 s_lshl_b32 s45, s4, 11
 v_lshl_add_u32 v12, v1, 4, s45
 s_mov_b32 s39, s37
 s_add_u32 s40, s39, 4
 s_lshl_b32 s49, s4, 10
 s_mul_i32 s46, s39, 36864
 s_add_u32 m0, s49, 0
 s_nop 0
 buffer_load_dwordx4 v10, s[8:11], s46 offen offset:0  lds
 s_add_u32 m0, s49, 3968
 s_nop 0
 buffer_load_dwordx4 v10, s[8:11], s46 offen offset:128  lds
 s_add_u32 m0, s49, 7936
 s_nop 0
 buffer_load_dwordx4 v10, s[8:11], s46 offen offset:256  lds
 s_add_u32 m0, s49, 11904
 s_nop 0
 buffer_load_dwordx4 v10, s[8:11], s46 offen offset:384  lds
 s_add_u32 m0, s49, 15872
 s_nop 0
 buffer_load_dwordx4 v10, s[8:11], s46 offen offset:512  lds
 s_add_u32 m0, s49, 19840
 s_nop 0
 buffer_load_dwordx4 v10, s[8:11], s46 offen offset:640  lds
 s_add_u32 m0, s49, 23808
 s_nop 0
 buffer_load_dwordx4 v10, s[8:11], s46 offen offset:768  lds
 s_add_u32 m0, s49, 27776
 s_nop 0
 buffer_load_dwordx4 v10, s[8:11], s46 offen offset:896  lds
 s_add_u32 m0, s49, 31744
 s_nop 0
 buffer_load_dwordx4 v10, s[8:11], s46 offen offset:1024  lds
 s_lshl_b32 s49, s4, 10
 s_add_u32 s49, s49, 36864
 s_mul_i32 s46, s40, 36864
 s_add_u32 m0, s49, 0
 s_nop 0
 buffer_load_dwordx4 v10, s[8:11], s46 offen offset:0  lds
 s_add_u32 m0, s49, 3968
 s_nop 0
 buffer_load_dwordx4 v10, s[8:11], s46 offen offset:128  lds
 s_add_u32 m0, s49, 7936
 s_nop 0
 buffer_load_dwordx4 v10, s[8:11], s46 offen offset:256  lds
 s_add_u32 m0, s49, 11904
 s_nop 0
 buffer_load_dwordx4 v10, s[8:11], s46 offen offset:384  lds
 s_add_u32 m0, s49, 15872
 s_nop 0
 buffer_load_dwordx4 v10, s[8:11], s46 offen offset:512  lds
 s_add_u32 m0, s49, 19840
 s_nop 0
 buffer_load_dwordx4 v10, s[8:11], s46 offen offset:640  lds
 s_add_u32 m0, s49, 23808
 s_nop 0
 buffer_load_dwordx4 v10, s[8:11], s46 offen offset:768  lds
 s_add_u32 m0, s49, 27776
 s_nop 0
 buffer_load_dwordx4 v10, s[8:11], s46 offen offset:896  lds
 s_add_u32 m0, s49, 31744
 s_nop 0
 buffer_load_dwordx4 v10, s[8:11], s46 offen offset:1024  lds
 s_lshl_b32 s49, s4, 10
 s_add_u32 m0, s49, 73728
 s_add_u32 s45, s32, 0
 buffer_load_dwordx4 v11, s[12:15], s45 offen  lds
 s_add_u32 m0, s49, 77824
 s_add_u32 s45, s32, 131072
 buffer_load_dwordx4 v11, s[12:15], s45 offen  lds
 s_add_u32 m0, s49, 81920
 s_add_u32 s45, s33, 0
 buffer_load_dwordx4 v11, s[16:19], s45 offen  lds
 s_add_u32 m0, s49, 86016
 s_add_u32 s45, s33, 131072
 buffer_load_dwordx4 v11, s[16:19], s45 offen  lds
 s_add_u32 m0, s49, 90112
 s_add_u32 s45, s32, 262144
 buffer_load_dwordx4 v11, s[12:15], s45 offen  lds
 s_add_u32 m0, s49, 94208
 s_add_u32 s45, s32, 393216
 buffer_load_dwordx4 v11, s[12:15], s45 offen  lds
 s_add_u32 m0, s49, 98304
 s_add_u32 s45, s33, 262144
 buffer_load_dwordx4 v11, s[16:19], s45 offen  lds
 s_add_u32 m0, s49, 102400
 s_add_u32 s45, s33, 393216
 buffer_load_dwordx4 v11, s[16:19], s45 offen  lds
 s_add_u32 m0, s49, 106496
 s_add_u32 s45, s32, 524288
 buffer_load_dwordx4 v11, s[12:15], s45 offen  lds
 s_add_u32 m0, s49, 110592
 s_add_u32 s45, s32, 655360
 buffer_load_dwordx4 v11, s[12:15], s45 offen  lds
 s_add_u32 m0, s49, 114688
 s_add_u32 s45, s33, 524288
 buffer_load_dwordx4 v11, s[16:19], s45 offen  lds
 s_add_u32 m0, s49, 118784
 s_add_u32 s45, s33, 655360
 buffer_load_dwordx4 v11, s[16:19], s45 offen  lds
 s_waitcnt vmcnt(8) lgkmcnt(0)
 s_barrier
 s_add_u32 m0, s49, 122880
 s_add_u32 s45, s32, 786432
 buffer_load_dwordx4 v11, s[12:15], s45 offen  lds
 s_add_u32 m0, s49, 126976
 s_add_u32 s45, s32, 917504
 buffer_load_dwordx4 v11, s[12:15], s45 offen  lds
 s_add_u32 m0, s49, 131072
 s_add_u32 s45, s33, 786432
 buffer_load_dwordx4 v11, s[16:19], s45 offen  lds
 s_add_u32 m0, s49, 135168
 s_add_u32 s45, s33, 917504
 buffer_load_dwordx4 v11, s[16:19], s45 offen  lds
 ds_read_b64_tr_b16 a[0:1], v8 offset:0
 ds_read_b64_tr_b16 a[2:3], v8 offset:1024
 ds_read_b64_tr_b16 a[72:73], v9 offset:0
 ds_read_b64_tr_b16 a[74:75], v9 offset:1024
 ds_read_b64_tr_b16 a[144:145], v8 offset:8192
 ds_read_b64_tr_b16 a[146:147], v8 offset:9216
 ds_read_b64_tr_b16 a[216:217], v9 offset:8192
 ds_read_b64_tr_b16 a[218:219], v9 offset:9216
 s_waitcnt vmcnt(8) lgkmcnt(0)
 s_barrier
 s_add_u32 m0, s49, 73728
 s_add_u32 s45, s32, 1048576
 buffer_load_dwordx4 v11, s[12:15], s45 offen  lds
 s_add_u32 m0, s49, 77824
 s_add_u32 s45, s32, 1179648
 buffer_load_dwordx4 v11, s[12:15], s45 offen  lds
 s_add_u32 m0, s49, 81920
 s_add_u32 s45, s33, 1048576
 buffer_load_dwordx4 v11, s[16:19], s45 offen  lds
 s_add_u32 m0, s49, 86016
 s_add_u32 s45, s33, 1179648
 buffer_load_dwordx4 v11, s[16:19], s45 offen  lds
 ds_read_b64_tr_b16 a[4:5], v8 offset:16384
 ds_read_b64_tr_b16 a[6:7], v8 offset:17408
 ds_read_b64_tr_b16 a[76:77], v9 offset:16384
 ds_read_b64_tr_b16 a[78:79], v9 offset:17408
 ds_read_b64_tr_b16 a[148:149], v8 offset:24576
 ds_read_b64_tr_b16 a[150:151], v8 offset:25600
 ds_read_b64_tr_b16 a[220:221], v9 offset:24576
 ds_read_b64_tr_b16 a[222:223], v9 offset:25600
 s_waitcnt vmcnt(8) lgkmcnt(0)
 s_barrier
 s_add_u32 m0, s49, 90112
 s_add_u32 s45, s32, 1310720
 buffer_load_dwordx4 v11, s[12:15], s45 offen  lds
 s_add_u32 m0, s49, 94208
 s_add_u32 s45, s32, 1441792
 buffer_load_dwordx4 v11, s[12:15], s45 offen  lds
 s_add_u32 m0, s49, 98304
 s_add_u32 s45, s33, 1310720
 buffer_load_dwordx4 v11, s[16:19], s45 offen  lds
 s_add_u32 m0, s49, 102400
 s_add_u32 s45, s33, 1441792
 buffer_load_dwordx4 v11, s[16:19], s45 offen  lds
 ds_read_b64_tr_b16 a[8:9], v8 offset:32768
 ds_read_b64_tr_b16 a[10:11], v8 offset:33792
 ds_read_b64_tr_b16 a[80:81], v9 offset:32768
 ds_read_b64_tr_b16 a[82:83], v9 offset:33792
 ds_read_b64_tr_b16 a[152:153], v8 offset:40960
 ds_read_b64_tr_b16 a[154:155], v8 offset:41984
 ds_read_b64_tr_b16 a[224:225], v9 offset:40960
 ds_read_b64_tr_b16 a[226:227], v9 offset:41984
 s_waitcnt vmcnt(8) lgkmcnt(0)
 s_barrier
 s_add_u32 m0, s49, 106496
 s_add_u32 s45, s32, 1572864
 buffer_load_dwordx4 v11, s[12:15], s45 offen  lds
 s_add_u32 m0, s49, 110592
 s_add_u32 s45, s32, 1703936
 buffer_load_dwordx4 v11, s[12:15], s45 offen  lds
 s_add_u32 m0, s49, 114688
 s_add_u32 s45, s33, 1572864
 buffer_load_dwordx4 v11, s[16:19], s45 offen  lds
 s_add_u32 m0, s49, 118784
 s_add_u32 s45, s33, 1703936
 buffer_load_dwordx4 v11, s[16:19], s45 offen  lds
 ds_read_b64_tr_b16 a[12:13], v8 offset:49152
 ds_read_b64_tr_b16 a[14:15], v8 offset:50176
 ds_read_b64_tr_b16 a[84:85], v9 offset:49152
 ds_read_b64_tr_b16 a[86:87], v9 offset:50176
 ds_read_b64_tr_b16 a[156:157], v8 offset:57344
 ds_read_b64_tr_b16 a[158:159], v8 offset:58368
 ds_read_b64_tr_b16 a[228:229], v9 offset:57344
 ds_read_b64_tr_b16 a[230:231], v9 offset:58368
 s_waitcnt vmcnt(8) lgkmcnt(0)
 s_barrier
 s_add_u32 m0, s49, 122880
 s_add_u32 s45, s32, 1835008
 buffer_load_dwordx4 v11, s[12:15], s45 offen  lds
 s_add_u32 m0, s49, 126976
 s_add_u32 s45, s32, 1966080
 buffer_load_dwordx4 v11, s[12:15], s45 offen  lds
 s_add_u32 m0, s49, 131072
 s_add_u32 s45, s33, 1835008
 buffer_load_dwordx4 v11, s[16:19], s45 offen  lds
 s_add_u32 m0, s49, 135168
 s_add_u32 s45, s33, 1966080
 buffer_load_dwordx4 v11, s[16:19], s45 offen  lds
 ds_read_b64_tr_b16 a[16:17], v8 offset:0
 ds_read_b64_tr_b16 a[18:19], v8 offset:1024
 ds_read_b64_tr_b16 a[88:89], v9 offset:0
 ds_read_b64_tr_b16 a[90:91], v9 offset:1024
 ds_read_b64_tr_b16 a[160:161], v8 offset:8192
 ds_read_b64_tr_b16 a[162:163], v8 offset:9216
 ds_read_b64_tr_b16 a[232:233], v9 offset:8192
 ds_read_b64_tr_b16 a[234:235], v9 offset:9216
 s_waitcnt vmcnt(8) lgkmcnt(0)
 s_barrier
 s_add_u32 m0, s49, 73728
 s_add_u32 s45, s32, 2097152
 buffer_load_dwordx4 v11, s[12:15], s45 offen  lds
 s_add_u32 m0, s49, 77824
 s_add_u32 s45, s32, 2228224
 buffer_load_dwordx4 v11, s[12:15], s45 offen  lds
 s_add_u32 m0, s49, 81920
 s_add_u32 s45, s33, 2097152
 buffer_load_dwordx4 v11, s[16:19], s45 offen  lds
 s_add_u32 m0, s49, 86016
 s_add_u32 s45, s33, 2228224
 buffer_load_dwordx4 v11, s[16:19], s45 offen  lds
 ds_read_b64_tr_b16 a[20:21], v8 offset:16384
 ds_read_b64_tr_b16 a[22:23], v8 offset:17408
 ds_read_b64_tr_b16 a[92:93], v9 offset:16384
 ds_read_b64_tr_b16 a[94:95], v9 offset:17408
 ds_read_b64_tr_b16 a[164:165], v8 offset:24576
 ds_read_b64_tr_b16 a[166:167], v8 offset:25600
 ds_read_b64_tr_b16 a[236:237], v9 offset:24576
 ds_read_b64_tr_b16 a[238:239], v9 offset:25600
 s_waitcnt vmcnt(8) lgkmcnt(0)
 s_barrier
 s_add_u32 m0, s49, 90112
 s_add_u32 s45, s32, 2359296
 buffer_load_dwordx4 v11, s[12:15], s45 offen  lds
 s_add_u32 m0, s49, 94208
 s_add_u32 s45, s32, 2490368
 buffer_load_dwordx4 v11, s[12:15], s45 offen  lds
 s_add_u32 m0, s49, 98304
 s_add_u32 s45, s33, 2359296
 buffer_load_dwordx4 v11, s[16:19], s45 offen  lds
 s_add_u32 m0, s49, 102400
 s_add_u32 s45, s33, 2490368
 buffer_load_dwordx4 v11, s[16:19], s45 offen  lds
 ds_read_b64_tr_b16 a[24:25], v8 offset:32768
 ds_read_b64_tr_b16 a[26:27], v8 offset:33792
 ds_read_b64_tr_b16 a[96:97], v9 offset:32768
 ds_read_b64_tr_b16 a[98:99], v9 offset:33792
 ds_read_b64_tr_b16 a[168:169], v8 offset:40960
 ds_read_b64_tr_b16 a[170:171], v8 offset:41984
 ds_read_b64_tr_b16 a[240:241], v9 offset:40960
 ds_read_b64_tr_b16 a[242:243], v9 offset:41984
 s_waitcnt vmcnt(8) lgkmcnt(0)
 s_barrier
 s_add_u32 m0, s49, 106496
 s_add_u32 s45, s32, 2621440
 buffer_load_dwordx4 v11, s[12:15], s45 offen  lds
 s_add_u32 m0, s49, 110592
 s_add_u32 s45, s32, 2752512
 buffer_load_dwordx4 v11, s[12:15], s45 offen  lds
 s_add_u32 m0, s49, 114688
 s_add_u32 s45, s33, 2621440
 buffer_load_dwordx4 v11, s[16:19], s45 offen  lds
 s_add_u32 m0, s49, 118784
 s_add_u32 s45, s33, 2752512
 buffer_load_dwordx4 v11, s[16:19], s45 offen  lds
 ds_read_b64_tr_b16 a[28:29], v8 offset:49152
 ds_read_b64_tr_b16 a[30:31], v8 offset:50176
 ds_read_b64_tr_b16 a[100:101], v9 offset:49152
 ds_read_b64_tr_b16 a[102:103], v9 offset:50176
 ds_read_b64_tr_b16 a[172:173], v8 offset:57344
 ds_read_b64_tr_b16 a[174:175], v8 offset:58368
 ds_read_b64_tr_b16 a[244:245], v9 offset:57344
 ds_read_b64_tr_b16 a[246:247], v9 offset:58368
 s_waitcnt vmcnt(8) lgkmcnt(0)
 s_barrier
 s_add_u32 m0, s49, 122880
 s_add_u32 s45, s32, 2883584
 buffer_load_dwordx4 v11, s[12:15], s45 offen  lds
 s_add_u32 m0, s49, 126976
 s_add_u32 s45, s32, 3014656
 buffer_load_dwordx4 v11, s[12:15], s45 offen  lds
 s_add_u32 m0, s49, 131072
 s_add_u32 s45, s33, 2883584
 buffer_load_dwordx4 v11, s[16:19], s45 offen  lds
 s_add_u32 m0, s49, 135168
 s_add_u32 s45, s33, 3014656
 buffer_load_dwordx4 v11, s[16:19], s45 offen  lds
 ds_read_b64_tr_b16 a[32:33], v8 offset:0
 ds_read_b64_tr_b16 a[34:35], v8 offset:1024
 ds_read_b64_tr_b16 a[104:105], v9 offset:0
 ds_read_b64_tr_b16 a[106:107], v9 offset:1024
 ds_read_b64_tr_b16 a[176:177], v8 offset:8192
 ds_read_b64_tr_b16 a[178:179], v8 offset:9216
 ds_read_b64_tr_b16 a[248:249], v9 offset:8192
 ds_read_b64_tr_b16 a[250:251], v9 offset:9216
 s_waitcnt vmcnt(8) lgkmcnt(0)
 s_barrier
 s_add_u32 m0, s49, 73728
 s_add_u32 s45, s32, 3145728
 buffer_load_dwordx4 v11, s[12:15], s45 offen  lds
 s_add_u32 m0, s49, 77824
 s_add_u32 s45, s32, 3276800
 buffer_load_dwordx4 v11, s[12:15], s45 offen  lds
 s_add_u32 m0, s49, 81920
 s_add_u32 s45, s33, 3145728
 buffer_load_dwordx4 v11, s[16:19], s45 offen  lds
 s_add_u32 m0, s49, 86016
 s_add_u32 s45, s33, 3276800
 buffer_load_dwordx4 v11, s[16:19], s45 offen  lds
 ds_read_b64_tr_b16 a[36:37], v8 offset:16384
 ds_read_b64_tr_b16 a[38:39], v8 offset:17408
 ds_read_b64_tr_b16 a[108:109], v9 offset:16384
 ds_read_b64_tr_b16 a[110:111], v9 offset:17408
 ds_read_b64_tr_b16 a[180:181], v8 offset:24576
 ds_read_b64_tr_b16 a[182:183], v8 offset:25600
 ds_read_b64_tr_b16 a[252:253], v9 offset:24576
 ds_read_b64_tr_b16 a[254:255], v9 offset:25600
 s_waitcnt vmcnt(8) lgkmcnt(0)
 s_barrier
 s_add_u32 m0, s49, 90112
 s_add_u32 s45, s32, 3407872
 buffer_load_dwordx4 v11, s[12:15], s45 offen  lds
 s_add_u32 m0, s49, 94208
 s_add_u32 s45, s32, 3538944
 buffer_load_dwordx4 v11, s[12:15], s45 offen  lds
 s_add_u32 m0, s49, 98304
 s_add_u32 s45, s33, 3407872
 buffer_load_dwordx4 v11, s[16:19], s45 offen  lds
 s_add_u32 m0, s49, 102400
 s_add_u32 s45, s33, 3538944
 buffer_load_dwordx4 v11, s[16:19], s45 offen  lds
 ds_read_b64_tr_b16 a[40:41], v8 offset:32768
 ds_read_b64_tr_b16 a[42:43], v8 offset:33792
 ds_read_b64_tr_b16 a[112:113], v9 offset:32768
 ds_read_b64_tr_b16 a[114:115], v9 offset:33792
 ds_read_b64_tr_b16 a[184:185], v8 offset:40960
 ds_read_b64_tr_b16 a[186:187], v8 offset:41984
 ds_read_b64_tr_b16 v[224:225], v9 offset:40960
 ds_read_b64_tr_b16 v[226:227], v9 offset:41984
 s_waitcnt vmcnt(8) lgkmcnt(0)
 s_barrier
 s_add_u32 m0, s49, 106496
 s_add_u32 s45, s32, 3670016
 buffer_load_dwordx4 v11, s[12:15], s45 offen  lds
 s_add_u32 m0, s49, 110592
 s_add_u32 s45, s32, 3801088
 buffer_load_dwordx4 v11, s[12:15], s45 offen  lds
 s_add_u32 m0, s49, 114688
 s_add_u32 s45, s33, 3670016
 buffer_load_dwordx4 v11, s[16:19], s45 offen  lds
 s_add_u32 m0, s49, 118784
 s_add_u32 s45, s33, 3801088
 buffer_load_dwordx4 v11, s[16:19], s45 offen  lds
 ds_read_b64_tr_b16 a[44:45], v8 offset:49152
 ds_read_b64_tr_b16 a[46:47], v8 offset:50176
 ds_read_b64_tr_b16 a[116:117], v9 offset:49152
 ds_read_b64_tr_b16 a[118:119], v9 offset:50176
 ds_read_b64_tr_b16 a[188:189], v8 offset:57344
 ds_read_b64_tr_b16 a[190:191], v8 offset:58368
 ds_read_b64_tr_b16 v[228:229], v9 offset:57344
 ds_read_b64_tr_b16 v[230:231], v9 offset:58368
 s_waitcnt vmcnt(8) lgkmcnt(0)
 s_barrier
 s_add_u32 m0, s49, 122880
 s_add_u32 s45, s32, 3932160
 buffer_load_dwordx4 v11, s[12:15], s45 offen  lds
 s_add_u32 m0, s49, 126976
 s_add_u32 s45, s32, 4063232
 buffer_load_dwordx4 v11, s[12:15], s45 offen  lds
 s_add_u32 m0, s49, 131072
 s_add_u32 s45, s33, 3932160
 buffer_load_dwordx4 v11, s[16:19], s45 offen  lds
 s_add_u32 m0, s49, 135168
 s_add_u32 s45, s33, 4063232
 buffer_load_dwordx4 v11, s[16:19], s45 offen  lds
 ds_read_b64_tr_b16 a[48:49], v8 offset:0
 ds_read_b64_tr_b16 a[50:51], v8 offset:1024
 ds_read_b64_tr_b16 a[120:121], v9 offset:0
 ds_read_b64_tr_b16 a[122:123], v9 offset:1024
 ds_read_b64_tr_b16 a[192:193], v8 offset:8192
 ds_read_b64_tr_b16 a[194:195], v8 offset:9216
 ds_read_b64_tr_b16 v[232:233], v9 offset:8192
 ds_read_b64_tr_b16 v[234:235], v9 offset:9216
 s_waitcnt vmcnt(8) lgkmcnt(0)
 s_barrier
 s_add_u32 m0, s49, 73728
 s_add_u32 s45, s32, 4194304
 buffer_load_dwordx4 v11, s[12:15], s45 offen  lds
 s_add_u32 m0, s49, 77824
 s_add_u32 s45, s32, 4325376
 buffer_load_dwordx4 v11, s[12:15], s45 offen  lds
 s_add_u32 m0, s49, 81920
 s_add_u32 s45, s33, 4194304
 buffer_load_dwordx4 v11, s[16:19], s45 offen  lds
 s_add_u32 m0, s49, 86016
 s_add_u32 s45, s33, 4325376
 buffer_load_dwordx4 v11, s[16:19], s45 offen  lds
 ds_read_b64_tr_b16 a[52:53], v8 offset:16384
 ds_read_b64_tr_b16 a[54:55], v8 offset:17408
 ds_read_b64_tr_b16 a[124:125], v9 offset:16384
 ds_read_b64_tr_b16 a[126:127], v9 offset:17408
 ds_read_b64_tr_b16 a[196:197], v8 offset:24576
 ds_read_b64_tr_b16 a[198:199], v8 offset:25600
 ds_read_b64_tr_b16 v[236:237], v9 offset:24576
 ds_read_b64_tr_b16 v[238:239], v9 offset:25600
 s_waitcnt vmcnt(8) lgkmcnt(0)
 s_barrier
 s_add_u32 m0, s49, 90112
 s_add_u32 s45, s32, 4456448
 buffer_load_dwordx4 v11, s[12:15], s45 offen  lds
 s_add_u32 m0, s49, 94208
 s_add_u32 s45, s32, 4587520
 buffer_load_dwordx4 v11, s[12:15], s45 offen  lds
 s_add_u32 m0, s49, 98304
 s_add_u32 s45, s33, 4456448
 buffer_load_dwordx4 v11, s[16:19], s45 offen  lds
 s_add_u32 m0, s49, 102400
 s_add_u32 s45, s33, 4587520
 buffer_load_dwordx4 v11, s[16:19], s45 offen  lds
 ds_read_b64_tr_b16 a[56:57], v8 offset:32768
 ds_read_b64_tr_b16 a[58:59], v8 offset:33792
 ds_read_b64_tr_b16 a[128:129], v9 offset:32768
 ds_read_b64_tr_b16 a[130:131], v9 offset:33792
 ds_read_b64_tr_b16 a[200:201], v8 offset:40960
 ds_read_b64_tr_b16 a[202:203], v8 offset:41984
 ds_read_b64_tr_b16 v[240:241], v9 offset:40960
 ds_read_b64_tr_b16 v[242:243], v9 offset:41984
 s_waitcnt vmcnt(8) lgkmcnt(0)
 s_barrier
 ds_read_b64_tr_b16 a[60:61], v8 offset:49152
 ds_read_b64_tr_b16 a[62:63], v8 offset:50176
 ds_read_b64_tr_b16 a[132:133], v9 offset:49152
 ds_read_b64_tr_b16 a[134:135], v9 offset:50176
 ds_read_b64_tr_b16 a[204:205], v8 offset:57344
 ds_read_b64_tr_b16 a[206:207], v8 offset:58368
 ds_read_b64_tr_b16 v[244:245], v9 offset:57344
 ds_read_b64_tr_b16 v[246:247], v9 offset:58368
 s_waitcnt vmcnt(4) lgkmcnt(0)
 s_barrier
 ds_read_b64_tr_b16 a[64:65], v8 offset:0
 ds_read_b64_tr_b16 a[66:67], v8 offset:1024
 ds_read_b64_tr_b16 a[136:137], v9 offset:0
 ds_read_b64_tr_b16 a[138:139], v9 offset:1024
 ds_read_b64_tr_b16 a[208:209], v8 offset:8192
 ds_read_b64_tr_b16 a[210:211], v8 offset:9216
 ds_read_b64_tr_b16 v[248:249], v9 offset:8192
 ds_read_b64_tr_b16 v[250:251], v9 offset:9216
 s_waitcnt vmcnt(0) lgkmcnt(0)
 s_barrier
 ds_read_b64_tr_b16 a[68:69], v8 offset:16384
 ds_read_b64_tr_b16 a[70:71], v8 offset:17408
 ds_read_b64_tr_b16 a[140:141], v9 offset:16384
 ds_read_b64_tr_b16 a[142:143], v9 offset:17408
 ds_read_b64_tr_b16 a[212:213], v8 offset:24576
 ds_read_b64_tr_b16 a[214:215], v8 offset:25600
 ds_read_b64_tr_b16 v[252:253], v9 offset:24576
 ds_read_b64_tr_b16 v[254:255], v9 offset:25600
 s_mov_b32 s50, 0x3e0293ee
 s_mov_b32 s42, 0
 s_mov_b32 s43, 0
 s_mov_b32 s44, 73728
 v_mov_b32 v6, v4
 v_mov_b32 v7, v5
 s_mov_b32 s95, 0x40000
 s_cmp_lg_u32 s4, 0
 s_cbranch_scc1 Lfrk_20
 v_min_u32 v21, 1, v0
 v_lshlrev_b32 v21, 28, v21
Lfr_19:
 buffer_load_dword v20, v21, s[28:31], 0 offen offset:0 sc1
 s_waitcnt vmcnt(0)
 v_cmp_eq_u32 vcc, 1, v20
 s_cbranch_vccnz Lfrk_20
 s_sub_u32 s95, s95, 1
 s_cbranch_scc0 Lfr_19
 s_endpgm
Lfrk_20:
 s_lshl_b32 s47, s2, 13
 s_add_u32 s47, s47, 0x8000000
 s_mov_b32 s48, s47
 v_mov_b32 v14, 0
 s_waitcnt vmcnt(0) lgkmcnt(0)
 s_barrier
 ds_read_b128 v[32:35], v6 offset:0
 ds_read_b128 v[36:39], v6 offset:2048
 ds_read_b128 v[40:43], v7 offset:0
 ds_read_b128 v[44:47], v7 offset:2048
 v_lshlrev_b32 v1, 12, v0
 s_lshl_b32 s45, s6, 7
 buffer_load_dword v15, v1, s[8:11], s45 offen
 v_add_u32 v1, 0x100000, v1
 buffer_load_dword v15, v1, s[8:11], s45 offen
 v_add_u32 v1, 0x100000, v1
 buffer_load_dword v15, v1, s[8:11], s45 offen
 v_add_u32 v1, 0x100000, v1
 s_waitcnt lgkmcnt(2)
Lps_loop_21:
 v_mfma_f32_16x16x32_bf16 v[64:67], a[0:3], v[32:35], 0
 ds_read_b128 v[48:51], v6 offset:4096
 v_mfma_f32_16x16x32_bf16 v[72:75], a[72:75], v[32:35], 0
 ds_read_b128 v[52:55], v6 offset:6144
 v_mfma_f32_16x16x32_bf16 v[80:83], a[144:147], v[32:35], 0
 s_add_u32 s41, s40, 4
 v_mfma_f32_16x16x32_bf16 v[88:91], a[216:219], v[32:35], 0
 s_add_u32 s45, s42, 2
 s_mul_i32 s46, s41, 36864
 v_mfma_f32_16x16x32_bf16 v[68:71], a[0:3], v[36:39], 0
 s_cmp_lt_u32 s45, s36
 s_cselect_b32 s46, s46, 0
 v_mfma_f32_16x16x32_bf16 v[76:79], a[72:75], v[36:39], 0
 s_lshl_b32 s49, s4, 10
 s_add_u32 s49, s49, s44
 v_mfma_f32_16x16x32_bf16 v[84:87], a[144:147], v[36:39], 0
 v_mfma_f32_16x16x32_bf16 v[92:95], a[216:219], v[36:39], 0
 s_waitcnt lgkmcnt(2)
 v_mfma_f32_16x16x32_bf16 v[64:67], a[4:7], v[40:43], v[64:67]
 ds_read_b128 v[56:59], v7 offset:4096
 v_mfma_f32_16x16x32_bf16 v[72:75], a[76:79], v[40:43], v[72:75]
 ds_read_b128 v[60:63], v7 offset:6144
 v_mfma_f32_16x16x32_bf16 v[80:83], a[148:151], v[40:43], v[80:83]
 s_add_u32 m0, s49, 0
 v_mfma_f32_16x16x32_bf16 v[88:91], a[220:223], v[40:43], v[88:91]
 buffer_load_dwordx4 v10, s[8:11], s46 offen offset:0  lds
 v_mfma_f32_16x16x32_bf16 v[68:71], a[4:7], v[44:47], v[68:71]
 s_add_u32 m0, s49, 3968
 v_mfma_f32_16x16x32_bf16 v[76:79], a[76:79], v[44:47], v[76:79]
 buffer_load_dwordx4 v10, s[8:11], s46 offen offset:128  lds
 v_mfma_f32_16x16x32_bf16 v[84:87], a[148:151], v[44:47], v[84:87]
 v_mfma_f32_16x16x32_bf16 v[92:95], a[220:223], v[44:47], v[92:95]
 s_waitcnt lgkmcnt(2)
 v_mfma_f32_16x16x32_bf16 v[64:67], a[8:11], v[48:51], v[64:67]
 ds_read_b128 v[32:35], v6 offset:8192
 v_mfma_f32_16x16x32_bf16 v[72:75], a[80:83], v[48:51], v[72:75]
 ds_read_b128 v[36:39], v6 offset:10240
 v_mfma_f32_16x16x32_bf16 v[80:83], a[152:155], v[48:51], v[80:83]
 s_add_u32 m0, s49, 7936
 v_mfma_f32_16x16x32_bf16 v[88:91], a[224:227], v[48:51], v[88:91]
 buffer_load_dwordx4 v10, s[8:11], s46 offen offset:256  lds
 v_mfma_f32_16x16x32_bf16 v[68:71], a[8:11], v[52:55], v[68:71]
 s_add_u32 m0, s49, 11904
 v_mfma_f32_16x16x32_bf16 v[76:79], a[80:83], v[52:55], v[76:79]
 buffer_load_dwordx4 v10, s[8:11], s46 offen offset:384  lds
 v_mfma_f32_16x16x32_bf16 v[84:87], a[152:155], v[52:55], v[84:87]
 v_mfma_f32_16x16x32_bf16 v[92:95], a[224:227], v[52:55], v[92:95]
 s_waitcnt lgkmcnt(2)
 v_mfma_f32_16x16x32_bf16 v[64:67], a[12:15], v[56:59], v[64:67]
 ds_read_b128 v[40:43], v7 offset:8192
 v_mfma_f32_16x16x32_bf16 v[72:75], a[84:87], v[56:59], v[72:75]
 ds_read_b128 v[44:47], v7 offset:10240
 v_mfma_f32_16x16x32_bf16 v[80:83], a[156:159], v[56:59], v[80:83]
 s_add_u32 m0, s49, 15872
 v_mfma_f32_16x16x32_bf16 v[88:91], a[228:231], v[56:59], v[88:91]
 buffer_load_dwordx4 v10, s[8:11], s46 offen offset:512  lds
 v_mfma_f32_16x16x32_bf16 v[68:71], a[12:15], v[60:63], v[68:71]
 s_add_u32 m0, s49, 19840
 v_mfma_f32_16x16x32_bf16 v[76:79], a[84:87], v[60:63], v[76:79]
 buffer_load_dwordx4 v10, s[8:11], s46 offen offset:640  lds
 v_mfma_f32_16x16x32_bf16 v[84:87], a[156:159], v[60:63], v[84:87]
 v_mfma_f32_16x16x32_bf16 v[92:95], a[228:231], v[60:63], v[92:95]
 s_waitcnt lgkmcnt(2)
 v_mfma_f32_16x16x32_bf16 v[64:67], a[16:19], v[32:35], v[64:67]
 ds_read_b128 v[48:51], v6 offset:12288
 v_mfma_f32_16x16x32_bf16 v[72:75], a[88:91], v[32:35], v[72:75]
 ds_read_b128 v[52:55], v6 offset:14336
 v_mfma_f32_16x16x32_bf16 v[80:83], a[160:163], v[32:35], v[80:83]
 s_add_u32 m0, s49, 23808
 v_mfma_f32_16x16x32_bf16 v[88:91], a[232:235], v[32:35], v[88:91]
 buffer_load_dwordx4 v10, s[8:11], s46 offen offset:768  lds
 v_mfma_f32_16x16x32_bf16 v[68:71], a[16:19], v[36:39], v[68:71]
 s_add_u32 m0, s49, 27776
 v_mfma_f32_16x16x32_bf16 v[76:79], a[88:91], v[36:39], v[76:79]
 buffer_load_dwordx4 v10, s[8:11], s46 offen offset:896  lds
 v_mfma_f32_16x16x32_bf16 v[84:87], a[160:163], v[36:39], v[84:87]
 v_mfma_f32_16x16x32_bf16 v[92:95], a[232:235], v[36:39], v[92:95]
 s_waitcnt lgkmcnt(2)
 v_mfma_f32_16x16x32_bf16 v[64:67], a[20:23], v[40:43], v[64:67]
 ds_read_b128 v[56:59], v7 offset:12288
 v_mfma_f32_16x16x32_bf16 v[72:75], a[92:95], v[40:43], v[72:75]
 ds_read_b128 v[60:63], v7 offset:14336
 v_mfma_f32_16x16x32_bf16 v[80:83], a[164:167], v[40:43], v[80:83]
 s_add_u32 m0, s49, 31744
 v_mfma_f32_16x16x32_bf16 v[88:91], a[236:239], v[40:43], v[88:91]
 buffer_load_dwordx4 v10, s[8:11], s46 offen offset:1024  lds
 v_mfma_f32_16x16x32_bf16 v[68:71], a[20:23], v[44:47], v[68:71]
 v_mfma_f32_16x16x32_bf16 v[76:79], a[92:95], v[44:47], v[76:79]
 v_mfma_f32_16x16x32_bf16 v[84:87], a[164:167], v[44:47], v[84:87]
 v_mfma_f32_16x16x32_bf16 v[92:95], a[236:239], v[44:47], v[92:95]
 s_waitcnt lgkmcnt(2)
 v_mfma_f32_16x16x32_bf16 v[64:67], a[24:27], v[48:51], v[64:67]
 ds_read_b128 v[32:35], v6 offset:16384
 v_mul_f32 v96, s50, v96
 v_mfma_f32_16x16x32_bf16 v[72:75], a[96:99], v[48:51], v[72:75]
 ds_read_b128 v[36:39], v6 offset:18432
 v_mfma_f32_16x16x32_bf16 v[80:83], a[168:171], v[48:51], v[80:83]
 v_mul_f32 v97, s50, v97
 v_mfma_f32_16x16x32_bf16 v[88:91], a[240:243], v[48:51], v[88:91]
 v_mul_f32 v98, s50, v98
 v_mfma_f32_16x16x32_bf16 v[68:71], a[24:27], v[52:55], v[68:71]
 v_mul_f32 v99, s50, v99
 v_mfma_f32_16x16x32_bf16 v[76:79], a[96:99], v[52:55], v[76:79]
 v_mul_f32 v104, s50, v104
 v_mfma_f32_16x16x32_bf16 v[84:87], a[168:171], v[52:55], v[84:87]
 v_mul_f32 v105, s50, v105
 v_mfma_f32_16x16x32_bf16 v[92:95], a[240:243], v[52:55], v[92:95]
 s_waitcnt lgkmcnt(2)
 v_mfma_f32_16x16x32_bf16 v[64:67], a[28:31], v[56:59], v[64:67]
 ds_read_b128 v[40:43], v7 offset:16384
 v_mfma_f32_16x16x32_bf16 v[72:75], a[100:103], v[56:59], v[72:75]
 ds_read_b128 v[44:47], v7 offset:18432
 v_mul_f32 v106, s50, v106
 v_mfma_f32_16x16x32_bf16 v[80:83], a[172:175], v[56:59], v[80:83]
 v_mul_f32 v107, s50, v107
 v_mfma_f32_16x16x32_bf16 v[88:91], a[244:247], v[56:59], v[88:91]
 v_cvt_pk_bf16_f32 v16, v96, v97
 v_mfma_f32_16x16x32_bf16 v[68:71], a[28:31], v[60:63], v[68:71]
 v_mfma_f32_16x16x32_bf16 v[76:79], a[100:103], v[60:63], v[76:79]
 v_cvt_pk_bf16_f32 v17, v104, v105
 v_mfma_f32_16x16x32_bf16 v[84:87], a[172:175], v[60:63], v[84:87]
 v_cvt_pk_bf16_f32 v18, v98, v99
 v_mfma_f32_16x16x32_bf16 v[92:95], a[244:247], v[60:63], v[92:95]
 s_waitcnt lgkmcnt(2)
 v_cvt_pk_bf16_f32 v19, v106, v107
 v_mfma_f32_16x16x32_bf16 v[64:67], a[32:35], v[32:35], v[64:67]
 ds_read_b128 v[48:51], v6 offset:20480
 v_mfma_f32_16x16x32_bf16 v[72:75], a[104:107], v[32:35], v[72:75]
 ds_read_b128 v[52:55], v6 offset:22528
 v_mfma_f32_16x16x32_bf16 v[80:83], a[176:179], v[32:35], v[80:83]
 buffer_store_dwordx4 v[16:19], v12, s[20:23], s47 offen offset:0 sc1
 v_mfma_f32_16x16x32_bf16 v[88:91], a[248:251], v[32:35], v[88:91]
 v_mul_f32 v100, s50, v100
 v_mfma_f32_16x16x32_bf16 v[68:71], a[32:35], v[36:39], v[68:71]
 v_mul_f32 v101, s50, v101
 v_mfma_f32_16x16x32_bf16 v[76:79], a[104:107], v[36:39], v[76:79]
 v_mul_f32 v102, s50, v102
 v_mfma_f32_16x16x32_bf16 v[84:87], a[176:179], v[36:39], v[84:87]
 v_mul_f32 v103, s50, v103
 v_mfma_f32_16x16x32_bf16 v[92:95], a[248:251], v[36:39], v[92:95]
 s_waitcnt lgkmcnt(2)
 v_mfma_f32_16x16x32_bf16 v[64:67], a[36:39], v[40:43], v[64:67]
 ds_read_b128 v[56:59], v7 offset:20480
 v_mul_f32 v108, s50, v108
 v_mfma_f32_16x16x32_bf16 v[72:75], a[108:111], v[40:43], v[72:75]
 ds_read_b128 v[60:63], v7 offset:22528
 v_mfma_f32_16x16x32_bf16 v[80:83], a[180:183], v[40:43], v[80:83]
 v_mul_f32 v109, s50, v109
 v_mfma_f32_16x16x32_bf16 v[88:91], a[252:255], v[40:43], v[88:91]
 v_mul_f32 v110, s50, v110
 v_mfma_f32_16x16x32_bf16 v[68:71], a[36:39], v[44:47], v[68:71]
 v_mul_f32 v111, s50, v111
 v_mfma_f32_16x16x32_bf16 v[76:79], a[108:111], v[44:47], v[76:79]
 v_mfma_f32_16x16x32_bf16 v[84:87], a[180:183], v[44:47], v[84:87]
 v_cvt_pk_bf16_f32 v20, v100, v101
 v_mfma_f32_16x16x32_bf16 v[92:95], a[252:255], v[44:47], v[92:95]
 s_waitcnt lgkmcnt(2)
 v_cvt_pk_bf16_f32 v21, v108, v109
 v_mfma_f32_16x16x32_bf16 v[64:67], a[40:43], v[48:51], v[64:67]
 ds_read_b128 v[32:35], v6 offset:24576
 v_mfma_f32_16x16x32_bf16 v[72:75], a[112:115], v[48:51], v[72:75]
 ds_read_b128 v[36:39], v6 offset:26624
 v_cvt_pk_bf16_f32 v22, v102, v103
 v_mfma_f32_16x16x32_bf16 v[80:83], a[184:187], v[48:51], v[80:83]
 v_mfma_f32_16x16x32_bf16 v[88:91], v[224:227], v[48:51], v[88:91]
 v_cvt_pk_bf16_f32 v23, v110, v111
 v_mfma_f32_16x16x32_bf16 v[68:71], a[40:43], v[52:55], v[68:71]
 buffer_store_dwordx4 v[20:23], v12, s[20:23], s47 offen offset:1024 sc1
 v_mfma_f32_16x16x32_bf16 v[76:79], a[112:115], v[52:55], v[76:79]
 v_mul_f32 v112, s50, v112
 v_mfma_f32_16x16x32_bf16 v[84:87], a[184:187], v[52:55], v[84:87]
 v_mul_f32 v113, s50, v113
 v_mfma_f32_16x16x32_bf16 v[92:95], v[224:227], v[52:55], v[92:95]
 s_waitcnt lgkmcnt(2)
 v_mfma_f32_16x16x32_bf16 v[64:67], a[44:47], v[56:59], v[64:67]
 ds_read_b128 v[40:43], v7 offset:24576
 v_mul_f32 v114, s50, v114
 v_mfma_f32_16x16x32_bf16 v[72:75], a[116:119], v[56:59], v[72:75]
 ds_read_b128 v[44:47], v7 offset:26624
 v_mfma_f32_16x16x32_bf16 v[80:83], a[188:191], v[56:59], v[80:83]
 v_mul_f32 v115, s50, v115
 v_mfma_f32_16x16x32_bf16 v[88:91], v[228:231], v[56:59], v[88:91]
 v_mul_f32 v120, s50, v120
 v_mfma_f32_16x16x32_bf16 v[68:71], a[44:47], v[60:63], v[68:71]
 v_mul_f32 v121, s50, v121
 v_mfma_f32_16x16x32_bf16 v[76:79], a[116:119], v[60:63], v[76:79]
 v_mfma_f32_16x16x32_bf16 v[84:87], a[188:191], v[60:63], v[84:87]
 v_mul_f32 v122, s50, v122
 v_mfma_f32_16x16x32_bf16 v[92:95], v[228:231], v[60:63], v[92:95]
 s_waitcnt lgkmcnt(2)
 v_mul_f32 v123, s50, v123
 v_mfma_f32_16x16x32_bf16 v[64:67], a[48:51], v[32:35], v[64:67]
 ds_read_b128 v[48:51], v6 offset:28672
 v_mfma_f32_16x16x32_bf16 v[72:75], a[120:123], v[32:35], v[72:75]
 ds_read_b128 v[52:55], v6 offset:30720
 v_cvt_pk_bf16_f32 v24, v112, v113
 v_mfma_f32_16x16x32_bf16 v[80:83], a[192:195], v[32:35], v[80:83]
 v_mfma_f32_16x16x32_bf16 v[88:91], v[232:235], v[32:35], v[88:91]
 v_cvt_pk_bf16_f32 v25, v120, v121
 v_mfma_f32_16x16x32_bf16 v[68:71], a[48:51], v[36:39], v[68:71]
 v_cvt_pk_bf16_f32 v26, v114, v115
 v_mfma_f32_16x16x32_bf16 v[76:79], a[120:123], v[36:39], v[76:79]
 v_cvt_pk_bf16_f32 v27, v122, v123
 v_mfma_f32_16x16x32_bf16 v[84:87], a[192:195], v[36:39], v[84:87]
 buffer_store_dwordx4 v[24:27], v12, s[20:23], s48 offen offset:0 sc1
 v_mfma_f32_16x16x32_bf16 v[92:95], v[232:235], v[36:39], v[92:95]
 s_waitcnt lgkmcnt(2)
 v_mfma_f32_16x16x32_bf16 v[64:67], a[52:55], v[40:43], v[64:67]
 ds_read_b128 v[56:59], v7 offset:28672
 v_mul_f32 v116, s50, v116
 v_mfma_f32_16x16x32_bf16 v[72:75], a[124:127], v[40:43], v[72:75]
 ds_read_b128 v[60:63], v7 offset:30720
 v_mfma_f32_16x16x32_bf16 v[80:83], a[196:199], v[40:43], v[80:83]
 s_add_u32 s43, s43, 36864
 s_cmp_eq_u32 s43, 147456
 v_mfma_f32_16x16x32_bf16 v[88:91], v[236:239], v[40:43], v[88:91]
 s_cselect_b32 s43, 0, s43
 s_add_u32 s44, s44, 36864
 v_mfma_f32_16x16x32_bf16 v[68:71], a[52:55], v[44:47], v[68:71]
 s_cmp_eq_u32 s44, 147456
 s_cselect_b32 s44, 0, s44
 v_mfma_f32_16x16x32_bf16 v[76:79], a[124:127], v[44:47], v[76:79]
 v_mul_f32 v117, s50, v117
 v_mfma_f32_16x16x32_bf16 v[84:87], a[196:199], v[44:47], v[84:87]
 v_mul_f32 v118, s50, v118
 v_mfma_f32_16x16x32_bf16 v[92:95], v[236:239], v[44:47], v[92:95]
 s_waitcnt lgkmcnt(2)
 v_mfma_f32_16x16x32_bf16 v[64:67], a[56:59], v[48:51], v[64:67]
 ds_read_b128 v[32:35], v6 offset:32768
 v_mul_f32 v119, s50, v119
 v_mfma_f32_16x16x32_bf16 v[72:75], a[128:131], v[48:51], v[72:75]
 ds_read_b128 v[36:39], v6 offset:34816
 v_mfma_f32_16x16x32_bf16 v[80:83], a[200:203], v[48:51], v[80:83]
 v_add_u32 v6, s43, v4
 v_mul_f32 v124, s50, v124
 v_mfma_f32_16x16x32_bf16 v[88:91], v[240:243], v[48:51], v[88:91]
 v_mfma_f32_16x16x32_bf16 v[68:71], a[56:59], v[52:55], v[68:71]
 v_mul_f32 v125, s50, v125
 v_mfma_f32_16x16x32_bf16 v[76:79], a[128:131], v[52:55], v[76:79]
 v_mul_f32 v126, s50, v126
 v_mfma_f32_16x16x32_bf16 v[84:87], a[200:203], v[52:55], v[84:87]
 v_mul_f32 v127, s50, v127
 v_mfma_f32_16x16x32_bf16 v[92:95], v[240:243], v[52:55], v[92:95]
 s_waitcnt lgkmcnt(2)
 v_mfma_f32_16x16x32_bf16 v[64:67], a[60:63], v[56:59], v[64:67]
 ds_read_b128 v[40:43], v7 offset:32768
 v_cvt_pk_bf16_f32 v28, v116, v117
 v_mfma_f32_16x16x32_bf16 v[72:75], a[132:135], v[56:59], v[72:75]
 ds_read_b128 v[44:47], v7 offset:34816
 v_mfma_f32_16x16x32_bf16 v[80:83], a[204:207], v[56:59], v[80:83]
 v_add_u32 v7, s43, v5
 v_cvt_pk_bf16_f32 v29, v124, v125
 v_mfma_f32_16x16x32_bf16 v[88:91], v[244:247], v[56:59], v[88:91]
 v_cvt_pk_bf16_f32 v30, v118, v119
 v_mfma_f32_16x16x32_bf16 v[68:71], a[60:63], v[60:63], v[68:71]
 v_mfma_f32_16x16x32_bf16 v[76:79], a[132:135], v[60:63], v[76:79]
 v_cvt_pk_bf16_f32 v31, v126, v127
 v_mfma_f32_16x16x32_bf16 v[84:87], a[204:207], v[60:63], v[84:87]
 buffer_store_dwordx4 v[28:31], v12, s[20:23], s48 offen offset:1024 sc1
 v_mfma_f32_16x16x32_bf16 v[92:95], v[244:247], v[60:63], v[92:95]
 s_waitcnt lgkmcnt(2)
 v_mfma_f32_16x16x32_bf16 v[64:67], a[64:67], v[32:35], v[64:67]
 s_waitcnt vmcnt(13)
 s_barrier
 ds_read_b128 v[48:51], v6 offset:0
 v_mfma_f32_16x16x32_bf16 v[72:75], a[136:139], v[32:35], v[72:75]
 ds_read_b128 v[52:55], v6 offset:2048
 v_mfma_f32_16x16x32_bf16 v[80:83], a[208:211], v[32:35], v[80:83]
 v_mfma_f32_16x16x32_bf16 v[88:91], v[248:251], v[32:35], v[88:91]
 v_mfma_f32_16x16x32_bf16 v[68:71], a[64:67], v[36:39], v[68:71]
 v_mfma_f32_16x16x32_bf16 v[76:79], a[136:139], v[36:39], v[76:79]
 v_mfma_f32_16x16x32_bf16 v[84:87], a[208:211], v[36:39], v[84:87]
 v_mfma_f32_16x16x32_bf16 v[92:95], v[248:251], v[36:39], v[92:95]
 s_waitcnt lgkmcnt(2)
 v_mfma_f32_16x16x32_bf16 v[64:67], a[68:71], v[40:43], v[64:67]
 ds_read_b128 v[56:59], v7 offset:0
 v_mfma_f32_16x16x32_bf16 v[72:75], a[140:143], v[40:43], v[72:75]
 ds_read_b128 v[60:63], v7 offset:2048
 v_mfma_f32_16x16x32_bf16 v[80:83], a[212:215], v[40:43], v[80:83]
 s_mul_i32 s45, s39, 262144
 s_add_u32 s47, s34, s45
 v_mfma_f32_16x16x32_bf16 v[88:91], v[252:255], v[40:43], v[88:91]
 s_add_u32 s48, s35, s45
 v_mov_b32 v14, s42
 v_mfma_f32_16x16x32_bf16 v[68:71], a[68:71], v[44:47], v[68:71]
 s_mov_b32 s39, s40
 s_mov_b32 s40, s41
 v_mfma_f32_16x16x32_bf16 v[76:79], a[140:143], v[44:47], v[76:79]
 s_add_u32 s42, s42, 1
 v_mfma_f32_16x16x32_bf16 v[84:87], a[212:215], v[44:47], v[84:87]
 v_mfma_f32_16x16x32_bf16 v[92:95], v[252:255], v[44:47], v[92:95]
 s_waitcnt lgkmcnt(2)
 v_mfma_f32_16x16x32_bf16 v[96:99], a[0:3], v[48:51], 0
 ds_read_b128 v[32:35], v6 offset:4096
 v_mfma_f32_16x16x32_bf16 v[104:107], a[72:75], v[48:51], 0
 ds_read_b128 v[36:39], v6 offset:6144
 v_mfma_f32_16x16x32_bf16 v[112:115], a[144:147], v[48:51], 0
 s_add_u32 s41, s40, 4
 v_mfma_f32_16x16x32_bf16 v[120:123], a[216:219], v[48:51], 0
 s_add_u32 s45, s42, 2
 s_mul_i32 s46, s41, 36864
 v_mfma_f32_16x16x32_bf16 v[100:103], a[0:3], v[52:55], 0
 s_cmp_lt_u32 s45, s36
 s_cselect_b32 s46, s46, 0
 v_mfma_f32_16x16x32_bf16 v[108:111], a[72:75], v[52:55], 0
 s_lshl_b32 s49, s4, 10
 s_add_u32 s49, s49, s44
 v_mfma_f32_16x16x32_bf16 v[116:119], a[144:147], v[52:55], 0
 v_mfma_f32_16x16x32_bf16 v[124:127], a[216:219], v[52:55], 0
 s_waitcnt lgkmcnt(2)
 v_mfma_f32_16x16x32_bf16 v[96:99], a[4:7], v[56:59], v[96:99]
 ds_read_b128 v[40:43], v7 offset:4096
 v_mfma_f32_16x16x32_bf16 v[104:107], a[76:79], v[56:59], v[104:107]
 ds_read_b128 v[44:47], v7 offset:6144
 v_mfma_f32_16x16x32_bf16 v[112:115], a[148:151], v[56:59], v[112:115]
 s_add_u32 m0, s49, 0
 v_mfma_f32_16x16x32_bf16 v[120:123], a[220:223], v[56:59], v[120:123]
 buffer_load_dwordx4 v10, s[8:11], s46 offen offset:0  lds
 v_mfma_f32_16x16x32_bf16 v[100:103], a[4:7], v[60:63], v[100:103]
 s_add_u32 m0, s49, 3968
 v_mfma_f32_16x16x32_bf16 v[108:111], a[76:79], v[60:63], v[108:111]
 buffer_load_dwordx4 v10, s[8:11], s46 offen offset:128  lds
 v_mfma_f32_16x16x32_bf16 v[116:119], a[148:151], v[60:63], v[116:119]
 v_mfma_f32_16x16x32_bf16 v[124:127], a[220:223], v[60:63], v[124:127]
 s_waitcnt lgkmcnt(2)
 v_mfma_f32_16x16x32_bf16 v[96:99], a[8:11], v[32:35], v[96:99]
 ds_read_b128 v[48:51], v6 offset:8192
 v_mfma_f32_16x16x32_bf16 v[104:107], a[80:83], v[32:35], v[104:107]
 ds_read_b128 v[52:55], v6 offset:10240
 v_mfma_f32_16x16x32_bf16 v[112:115], a[152:155], v[32:35], v[112:115]
 s_add_u32 m0, s49, 7936
 v_mfma_f32_16x16x32_bf16 v[120:123], a[224:227], v[32:35], v[120:123]
 buffer_load_dwordx4 v10, s[8:11], s46 offen offset:256  lds
 v_mfma_f32_16x16x32_bf16 v[100:103], a[8:11], v[36:39], v[100:103]
 s_add_u32 m0, s49, 11904
 v_mfma_f32_16x16x32_bf16 v[108:111], a[80:83], v[36:39], v[108:111]
 buffer_load_dwordx4 v10, s[8:11], s46 offen offset:384  lds
 v_mfma_f32_16x16x32_bf16 v[116:119], a[152:155], v[36:39], v[116:119]
 v_mfma_f32_16x16x32_bf16 v[124:127], a[224:227], v[36:39], v[124:127]
 s_waitcnt lgkmcnt(2)
 v_mfma_f32_16x16x32_bf16 v[96:99], a[12:15], v[40:43], v[96:99]
 ds_read_b128 v[56:59], v7 offset:8192
 v_mfma_f32_16x16x32_bf16 v[104:107], a[84:87], v[40:43], v[104:107]
 ds_read_b128 v[60:63], v7 offset:10240
 v_mfma_f32_16x16x32_bf16 v[112:115], a[156:159], v[40:43], v[112:115]
 s_add_u32 m0, s49, 15872
 v_mfma_f32_16x16x32_bf16 v[120:123], a[228:231], v[40:43], v[120:123]
 buffer_load_dwordx4 v10, s[8:11], s46 offen offset:512  lds
 v_mfma_f32_16x16x32_bf16 v[100:103], a[12:15], v[44:47], v[100:103]
 s_add_u32 m0, s49, 19840
 v_mfma_f32_16x16x32_bf16 v[108:111], a[84:87], v[44:47], v[108:111]
 buffer_load_dwordx4 v10, s[8:11], s46 offen offset:640  lds
 v_mfma_f32_16x16x32_bf16 v[116:119], a[156:159], v[44:47], v[116:119]
 v_mfma_f32_16x16x32_bf16 v[124:127], a[228:231], v[44:47], v[124:127]
 s_waitcnt lgkmcnt(2)
 v_mfma_f32_16x16x32_bf16 v[96:99], a[16:19], v[48:51], v[96:99]
 ds_read_b128 v[32:35], v6 offset:12288
 v_mfma_f32_16x16x32_bf16 v[104:107], a[88:91], v[48:51], v[104:107]
 ds_read_b128 v[36:39], v6 offset:14336
 v_mfma_f32_16x16x32_bf16 v[112:115], a[160:163], v[48:51], v[112:115]
 s_add_u32 m0, s49, 23808
 v_mfma_f32_16x16x32_bf16 v[120:123], a[232:235], v[48:51], v[120:123]
 buffer_load_dwordx4 v10, s[8:11], s46 offen offset:768  lds
 v_mfma_f32_16x16x32_bf16 v[100:103], a[16:19], v[52:55], v[100:103]
 s_add_u32 m0, s49, 27776
 v_mfma_f32_16x16x32_bf16 v[108:111], a[88:91], v[52:55], v[108:111]
 buffer_load_dwordx4 v10, s[8:11], s46 offen offset:896  lds
 v_mfma_f32_16x16x32_bf16 v[116:119], a[160:163], v[52:55], v[116:119]
 v_mfma_f32_16x16x32_bf16 v[124:127], a[232:235], v[52:55], v[124:127]
 s_waitcnt lgkmcnt(2)
 v_mfma_f32_16x16x32_bf16 v[96:99], a[20:23], v[56:59], v[96:99]
 ds_read_b128 v[40:43], v7 offset:12288
 v_mfma_f32_16x16x32_bf16 v[104:107], a[92:95], v[56:59], v[104:107]
 ds_read_b128 v[44:47], v7 offset:14336
 v_mfma_f32_16x16x32_bf16 v[112:115], a[164:167], v[56:59], v[112:115]
 s_add_u32 m0, s49, 31744
 v_mfma_f32_16x16x32_bf16 v[120:123], a[236:239], v[56:59], v[120:123]
 buffer_load_dwordx4 v10, s[8:11], s46 offen offset:1024  lds
 v_mfma_f32_16x16x32_bf16 v[100:103], a[20:23], v[60:63], v[100:103]
 v_mfma_f32_16x16x32_bf16 v[108:111], a[92:95], v[60:63], v[108:111]
 v_mfma_f32_16x16x32_bf16 v[116:119], a[164:167], v[60:63], v[116:119]
 v_mfma_f32_16x16x32_bf16 v[124:127], a[236:239], v[60:63], v[124:127]
 s_waitcnt lgkmcnt(2)
 v_mfma_f32_16x16x32_bf16 v[96:99], a[24:27], v[32:35], v[96:99]
 ds_read_b128 v[48:51], v6 offset:16384
 v_mul_f32 v64, s50, v64
 v_mfma_f32_16x16x32_bf16 v[104:107], a[96:99], v[32:35], v[104:107]
 ds_read_b128 v[52:55], v6 offset:18432
 v_mfma_f32_16x16x32_bf16 v[112:115], a[168:171], v[32:35], v[112:115]
 v_mul_f32 v65, s50, v65
 v_mfma_f32_16x16x32_bf16 v[120:123], a[240:243], v[32:35], v[120:123]
 v_mul_f32 v66, s50, v66
 v_mfma_f32_16x16x32_bf16 v[100:103], a[24:27], v[36:39], v[100:103]
 v_mul_f32 v67, s50, v67
 v_mfma_f32_16x16x32_bf16 v[108:111], a[96:99], v[36:39], v[108:111]
 v_mul_f32 v72, s50, v72
 v_mfma_f32_16x16x32_bf16 v[116:119], a[168:171], v[36:39], v[116:119]
 v_mul_f32 v73, s50, v73
 v_mfma_f32_16x16x32_bf16 v[124:127], a[240:243], v[36:39], v[124:127]
 s_waitcnt lgkmcnt(2)
 v_mfma_f32_16x16x32_bf16 v[96:99], a[28:31], v[40:43], v[96:99]
 ds_read_b128 v[56:59], v7 offset:16384
 v_mfma_f32_16x16x32_bf16 v[104:107], a[100:103], v[40:43], v[104:107]
 ds_read_b128 v[60:63], v7 offset:18432
 v_mul_f32 v74, s50, v74
 v_mfma_f32_16x16x32_bf16 v[112:115], a[172:175], v[40:43], v[112:115]
 v_mul_f32 v75, s50, v75
 v_mfma_f32_16x16x32_bf16 v[120:123], a[244:247], v[40:43], v[120:123]
 v_cvt_pk_bf16_f32 v16, v64, v65
 v_mfma_f32_16x16x32_bf16 v[100:103], a[28:31], v[44:47], v[100:103]
 v_mfma_f32_16x16x32_bf16 v[108:111], a[100:103], v[44:47], v[108:111]
 v_cvt_pk_bf16_f32 v17, v72, v73
 v_mfma_f32_16x16x32_bf16 v[116:119], a[172:175], v[44:47], v[116:119]
 v_cvt_pk_bf16_f32 v18, v66, v67
 v_mfma_f32_16x16x32_bf16 v[124:127], a[244:247], v[44:47], v[124:127]
 s_waitcnt lgkmcnt(2)
 v_cvt_pk_bf16_f32 v19, v74, v75
 v_mfma_f32_16x16x32_bf16 v[96:99], a[32:35], v[48:51], v[96:99]
 ds_read_b128 v[32:35], v6 offset:20480
 v_mfma_f32_16x16x32_bf16 v[104:107], a[104:107], v[48:51], v[104:107]
 ds_read_b128 v[36:39], v6 offset:22528
 v_mfma_f32_16x16x32_bf16 v[112:115], a[176:179], v[48:51], v[112:115]
 buffer_store_dwordx4 v[16:19], v12, s[20:23], s47 offen offset:0 sc1
 v_mfma_f32_16x16x32_bf16 v[120:123], a[248:251], v[48:51], v[120:123]
 v_mul_f32 v68, s50, v68
 v_mfma_f32_16x16x32_bf16 v[100:103], a[32:35], v[52:55], v[100:103]
 v_mul_f32 v69, s50, v69
 v_mfma_f32_16x16x32_bf16 v[108:111], a[104:107], v[52:55], v[108:111]
 v_mul_f32 v70, s50, v70
 v_mfma_f32_16x16x32_bf16 v[116:119], a[176:179], v[52:55], v[116:119]
 v_mul_f32 v71, s50, v71
 v_mfma_f32_16x16x32_bf16 v[124:127], a[248:251], v[52:55], v[124:127]
 s_waitcnt lgkmcnt(2)
 v_mfma_f32_16x16x32_bf16 v[96:99], a[36:39], v[56:59], v[96:99]
 ds_read_b128 v[40:43], v7 offset:20480
 v_mul_f32 v76, s50, v76
 v_mfma_f32_16x16x32_bf16 v[104:107], a[108:111], v[56:59], v[104:107]
 ds_read_b128 v[44:47], v7 offset:22528
 v_mfma_f32_16x16x32_bf16 v[112:115], a[180:183], v[56:59], v[112:115]
 v_mul_f32 v77, s50, v77
 v_mfma_f32_16x16x32_bf16 v[120:123], a[252:255], v[56:59], v[120:123]
 v_mul_f32 v78, s50, v78
 v_mfma_f32_16x16x32_bf16 v[100:103], a[36:39], v[60:63], v[100:103]
 v_mul_f32 v79, s50, v79
 v_mfma_f32_16x16x32_bf16 v[108:111], a[108:111], v[60:63], v[108:111]
 v_mfma_f32_16x16x32_bf16 v[116:119], a[180:183], v[60:63], v[116:119]
 v_cvt_pk_bf16_f32 v20, v68, v69
 v_mfma_f32_16x16x32_bf16 v[124:127], a[252:255], v[60:63], v[124:127]
 s_waitcnt lgkmcnt(2)
 v_cvt_pk_bf16_f32 v21, v76, v77
 v_mfma_f32_16x16x32_bf16 v[96:99], a[40:43], v[32:35], v[96:99]
 ds_read_b128 v[48:51], v6 offset:24576
 v_mfma_f32_16x16x32_bf16 v[104:107], a[112:115], v[32:35], v[104:107]
 ds_read_b128 v[52:55], v6 offset:26624
 v_cvt_pk_bf16_f32 v22, v70, v71
 v_mfma_f32_16x16x32_bf16 v[112:115], a[184:187], v[32:35], v[112:115]
 v_mfma_f32_16x16x32_bf16 v[120:123], v[224:227], v[32:35], v[120:123]
 v_cvt_pk_bf16_f32 v23, v78, v79
 v_mfma_f32_16x16x32_bf16 v[100:103], a[40:43], v[36:39], v[100:103]
 buffer_store_dwordx4 v[20:23], v12, s[20:23], s47 offen offset:1024 sc1
 v_mfma_f32_16x16x32_bf16 v[108:111], a[112:115], v[36:39], v[108:111]
 v_mul_f32 v80, s50, v80
 v_mfma_f32_16x16x32_bf16 v[116:119], a[184:187], v[36:39], v[116:119]
 v_mul_f32 v81, s50, v81
 v_mfma_f32_16x16x32_bf16 v[124:127], v[224:227], v[36:39], v[124:127]
 s_waitcnt lgkmcnt(2)
 v_mfma_f32_16x16x32_bf16 v[96:99], a[44:47], v[40:43], v[96:99]
 ds_read_b128 v[56:59], v7 offset:24576
 v_mul_f32 v82, s50, v82
 v_mfma_f32_16x16x32_bf16 v[104:107], a[116:119], v[40:43], v[104:107]
 ds_read_b128 v[60:63], v7 offset:26624
 v_mfma_f32_16x16x32_bf16 v[112:115], a[188:191], v[40:43], v[112:115]
 v_mul_f32 v83, s50, v83
 v_mfma_f32_16x16x32_bf16 v[120:123], v[228:231], v[40:43], v[120:123]
 v_mul_f32 v88, s50, v88
 v_mfma_f32_16x16x32_bf16 v[100:103], a[44:47], v[44:47], v[100:103]
 v_mul_f32 v89, s50, v89
 v_mfma_f32_16x16x32_bf16 v[108:111], a[116:119], v[44:47], v[108:111]
 v_mfma_f32_16x16x32_bf16 v[116:119], a[188:191], v[44:47], v[116:119]
 v_mul_f32 v90, s50, v90
 v_mfma_f32_16x16x32_bf16 v[124:127], v[228:231], v[44:47], v[124:127]
 s_waitcnt lgkmcnt(2)
 v_mul_f32 v91, s50, v91
 v_mfma_f32_16x16x32_bf16 v[96:99], a[48:51], v[48:51], v[96:99]
 ds_read_b128 v[32:35], v6 offset:28672
 v_mfma_f32_16x16x32_bf16 v[104:107], a[120:123], v[48:51], v[104:107]
 ds_read_b128 v[36:39], v6 offset:30720
 v_cvt_pk_bf16_f32 v24, v80, v81
 v_mfma_f32_16x16x32_bf16 v[112:115], a[192:195], v[48:51], v[112:115]
 v_mfma_f32_16x16x32_bf16 v[120:123], v[232:235], v[48:51], v[120:123]
 v_cvt_pk_bf16_f32 v25, v88, v89
 v_mfma_f32_16x16x32_bf16 v[100:103], a[48:51], v[52:55], v[100:103]
 v_cvt_pk_bf16_f32 v26, v82, v83
 v_mfma_f32_16x16x32_bf16 v[108:111], a[120:123], v[52:55], v[108:111]
 v_cvt_pk_bf16_f32 v27, v90, v91
 v_mfma_f32_16x16x32_bf16 v[116:119], a[192:195], v[52:55], v[116:119]
 buffer_store_dwordx4 v[24:27], v12, s[20:23], s48 offen offset:0 sc1
 v_mfma_f32_16x16x32_bf16 v[124:127], v[232:235], v[52:55], v[124:127]
 s_waitcnt lgkmcnt(2)
 v_mfma_f32_16x16x32_bf16 v[96:99], a[52:55], v[56:59], v[96:99]
 ds_read_b128 v[40:43], v7 offset:28672
 v_mul_f32 v84, s50, v84
 v_mfma_f32_16x16x32_bf16 v[104:107], a[124:127], v[56:59], v[104:107]
 ds_read_b128 v[44:47], v7 offset:30720
 v_mfma_f32_16x16x32_bf16 v[112:115], a[196:199], v[56:59], v[112:115]
 s_add_u32 s43, s43, 36864
 s_cmp_eq_u32 s43, 147456
 v_mfma_f32_16x16x32_bf16 v[120:123], v[236:239], v[56:59], v[120:123]
 s_cselect_b32 s43, 0, s43
 s_add_u32 s44, s44, 36864
 v_mfma_f32_16x16x32_bf16 v[100:103], a[52:55], v[60:63], v[100:103]
 s_cmp_eq_u32 s44, 147456
 s_cselect_b32 s44, 0, s44
 v_mfma_f32_16x16x32_bf16 v[108:111], a[124:127], v[60:63], v[108:111]
 v_mul_f32 v85, s50, v85
 v_mfma_f32_16x16x32_bf16 v[116:119], a[196:199], v[60:63], v[116:119]
 v_mul_f32 v86, s50, v86
 v_mfma_f32_16x16x32_bf16 v[124:127], v[236:239], v[60:63], v[124:127]
 s_waitcnt lgkmcnt(2)
 v_mfma_f32_16x16x32_bf16 v[96:99], a[56:59], v[32:35], v[96:99]
 ds_read_b128 v[48:51], v6 offset:32768
 v_mul_f32 v87, s50, v87
 v_mfma_f32_16x16x32_bf16 v[104:107], a[128:131], v[32:35], v[104:107]
 ds_read_b128 v[52:55], v6 offset:34816
 v_mfma_f32_16x16x32_bf16 v[112:115], a[200:203], v[32:35], v[112:115]
 v_add_u32 v6, s43, v4
 v_mul_f32 v92, s50, v92
 v_mfma_f32_16x16x32_bf16 v[120:123], v[240:243], v[32:35], v[120:123]
 v_mfma_f32_16x16x32_bf16 v[100:103], a[56:59], v[36:39], v[100:103]
 v_mul_f32 v93, s50, v93
 v_mfma_f32_16x16x32_bf16 v[108:111], a[128:131], v[36:39], v[108:111]
 v_mul_f32 v94, s50, v94
 v_mfma_f32_16x16x32_bf16 v[116:119], a[200:203], v[36:39], v[116:119]
 v_mul_f32 v95, s50, v95
 v_mfma_f32_16x16x32_bf16 v[124:127], v[240:243], v[36:39], v[124:127]
 s_waitcnt lgkmcnt(2)
 v_mfma_f32_16x16x32_bf16 v[96:99], a[60:63], v[40:43], v[96:99]
 ds_read_b128 v[56:59], v7 offset:32768
 v_cvt_pk_bf16_f32 v28, v84, v85
 v_mfma_f32_16x16x32_bf16 v[104:107], a[132:135], v[40:43], v[104:107]
 ds_read_b128 v[60:63], v7 offset:34816
 v_mfma_f32_16x16x32_bf16 v[112:115], a[204:207], v[40:43], v[112:115]
 v_add_u32 v7, s43, v5
 v_cvt_pk_bf16_f32 v29, v92, v93
 v_mfma_f32_16x16x32_bf16 v[120:123], v[244:247], v[40:43], v[120:123]
 v_cvt_pk_bf16_f32 v30, v86, v87
 v_mfma_f32_16x16x32_bf16 v[100:103], a[60:63], v[44:47], v[100:103]
 v_mfma_f32_16x16x32_bf16 v[108:111], a[132:135], v[44:47], v[108:111]
 v_cvt_pk_bf16_f32 v31, v94, v95
 v_mfma_f32_16x16x32_bf16 v[116:119], a[204:207], v[44:47], v[116:119]
 buffer_store_dwordx4 v[28:31], v12, s[20:23], s48 offen offset:1024 sc1
 v_mfma_f32_16x16x32_bf16 v[124:127], v[244:247], v[44:47], v[124:127]
 s_waitcnt lgkmcnt(2)
 v_mfma_f32_16x16x32_bf16 v[96:99], a[64:67], v[48:51], v[96:99]
 s_waitcnt vmcnt(13)
 s_barrier
 ds_read_b128 v[32:35], v6 offset:0
 v_mfma_f32_16x16x32_bf16 v[104:107], a[136:139], v[48:51], v[104:107]
 ds_read_b128 v[36:39], v6 offset:2048
 v_mfma_f32_16x16x32_bf16 v[112:115], a[208:211], v[48:51], v[112:115]
 v_mfma_f32_16x16x32_bf16 v[120:123], v[248:251], v[48:51], v[120:123]
 v_mfma_f32_16x16x32_bf16 v[100:103], a[64:67], v[52:55], v[100:103]
 v_mfma_f32_16x16x32_bf16 v[108:111], a[136:139], v[52:55], v[108:111]
 v_mfma_f32_16x16x32_bf16 v[116:119], a[208:211], v[52:55], v[116:119]
 v_mfma_f32_16x16x32_bf16 v[124:127], v[248:251], v[52:55], v[124:127]
 s_waitcnt lgkmcnt(2)
 v_mfma_f32_16x16x32_bf16 v[96:99], a[68:71], v[56:59], v[96:99]
 ds_read_b128 v[40:43], v7 offset:0
 v_mfma_f32_16x16x32_bf16 v[104:107], a[140:143], v[56:59], v[104:107]
 ds_read_b128 v[44:47], v7 offset:2048
 v_mfma_f32_16x16x32_bf16 v[112:115], a[212:215], v[56:59], v[112:115]
 s_mul_i32 s45, s39, 262144
 s_add_u32 s47, s34, s45
 v_mfma_f32_16x16x32_bf16 v[120:123], v[252:255], v[56:59], v[120:123]
 s_add_u32 s48, s35, s45
 v_mov_b32 v14, s42
 v_mfma_f32_16x16x32_bf16 v[100:103], a[68:71], v[60:63], v[100:103]
 s_mov_b32 s39, s40
 s_mov_b32 s40, s41
 v_mfma_f32_16x16x32_bf16 v[108:111], a[140:143], v[60:63], v[108:111]
 s_add_u32 s42, s42, 1
 s_cmp_lt_u32 s42, s36
 v_mfma_f32_16x16x32_bf16 v[116:119], a[212:215], v[60:63], v[116:119]
 v_mfma_f32_16x16x32_bf16 v[124:127], v[252:255], v[60:63], v[124:127]
 s_waitcnt lgkmcnt(2)
 s_cbranch_scc1 Lps_loop_21
 s_nop 7
 v_mul_f32 v96, s50, v96
 v_mul_f32 v97, s50, v97
 v_mul_f32 v98, s50, v98
 v_mul_f32 v99, s50, v99
 v_mul_f32 v104, s50, v104
 v_mul_f32 v105, s50, v105
 v_mul_f32 v106, s50, v106
 v_mul_f32 v107, s50, v107
 v_cvt_pk_bf16_f32 v16, v96, v97
 v_cvt_pk_bf16_f32 v17, v104, v105
 v_cvt_pk_bf16_f32 v18, v98, v99
 v_cvt_pk_bf16_f32 v19, v106, v107
 buffer_store_dwordx4 v[16:19], v12, s[20:23], s47 offen offset:0 sc1
 v_mul_f32 v100, s50, v100
 v_mul_f32 v101, s50, v101
 v_mul_f32 v102, s50, v102
 v_mul_f32 v103, s50, v103
 v_mul_f32 v108, s50, v108
 v_mul_f32 v109, s50, v109
 v_mul_f32 v110, s50, v110
 v_mul_f32 v111, s50, v111
 v_cvt_pk_bf16_f32 v20, v100, v101
 v_cvt_pk_bf16_f32 v21, v108, v109
 v_cvt_pk_bf16_f32 v22, v102, v103
 v_cvt_pk_bf16_f32 v23, v110, v111
 buffer_store_dwordx4 v[20:23], v12, s[20:23], s47 offen offset:1024 sc1
 v_mul_f32 v112, s50, v112
 v_mul_f32 v113, s50, v113
 v_mul_f32 v114, s50, v114
 v_mul_f32 v115, s50, v115
 v_mul_f32 v120, s50, v120
 v_mul_f32 v121, s50, v121
 v_mul_f32 v122, s50, v122
 v_mul_f32 v123, s50, v123
 v_cvt_pk_bf16_f32 v24, v112, v113
 v_cvt_pk_bf16_f32 v25, v120, v121
 v_cvt_pk_bf16_f32 v26, v114, v115
 v_cvt_pk_bf16_f32 v27, v122, v123
 buffer_store_dwordx4 v[24:27], v12, s[20:23], s48 offen offset:0 sc1
 v_mul_f32 v116, s50, v116
 v_mul_f32 v117, s50, v117
 v_mul_f32 v118, s50, v118
 v_mul_f32 v119, s50, v119
 v_mul_f32 v124, s50, v124
 v_mul_f32 v125, s50, v125
 v_mul_f32 v126, s50, v126
 v_mul_f32 v127, s50, v127
 v_cvt_pk_bf16_f32 v28, v116, v117
 v_cvt_pk_bf16_f32 v29, v124, v125
 v_cvt_pk_bf16_f32 v30, v118, v119
 v_cvt_pk_bf16_f32 v31, v126, v127
 buffer_store_dwordx4 v[28:31], v12, s[20:23], s48 offen offset:1024 sc1
 s_waitcnt vmcnt(0) lgkmcnt(0)
 s_barrier
 v_mov_b32 v14, s36
 buffer_store_dword v14, v13, s[20:23], 0 offen sc1
 s_sub_u32 s3, s5, 2
 s_add_u32 s7, s6, s3
 s_cmp_ge_u32 s7, 30
 s_cbranch_scc1 Lfin
 s_cmp_ge_u32 s6, 16
 s_cbranch_scc1 Lob
 s_load_dwordx2 s[8:9], s[0:1], 48
 s_mov_b32 s10, 0x240000
 s_mov_b32 s11, 0x20000
 s_load_dwordx2 s[12:13], s[0:1], 64
 s_mov_b32 s14, 0x480000
 s_mov_b32 s15, 0x20000
 s_load_dwordx2 s[16:17], s[0:1], 64
 s_mov_b32 s18, 0x480000
 s_mov_b32 s19, 0x20000
 s_lshl_b32 s32, s6, 9
 s_add_u32 s33, s32, 256
 s_mov_b32 s36, 32
 s_mov_b32 s37, s3
 s_lshl_b32 s52, s6, 1
 s_lshl_b32 s7, s3, 4
 s_add_u32 s7, s7, s6
 s_and_b32 s94, s7, 3
 s_lshr_b32 s7, s7, 2
 s_lshl_b32 s7, s7, 5
 s_add_u32 s7, s7, s94
 s_lshl_b32 s7, s7, 2
 s_add_u32 s59, s7, 0x3800
 s_waitcnt lgkmcnt(0)
 v_and_b32 v1, 63, v0
 v_lshrrev_b32 v2, 3, v0
 v_mul_u32_u24 v10, 1152, v2
 v_lshrrev_b32 v2, 4, v0
 v_xor_b32 v2, v2, v0
 v_and_b32 v2, 7, v2
 v_lshl_add_u32 v10, v2, 4, v10
 v_lshrrev_b32 v2, 4, v1
 v_bfe_u32 v3, v1, 1, 3
 v_xor_b32 v2, v2, v3
 v_and_b32 v3, 15, v1
 v_lshlrev_b32 v3, 7, v3
 v_lshl_add_u32 v4, v2, 4, v3
 v_xor_b32 v5, 64, v4
 v_lshrrev_b32 v2, 4, v0
 v_lshlrev_b32 v11, 13, v2
 v_lshrrev_b32 v2, 7, v0
 v_lshrrev_b32 v3, 4, v1
 v_lshl_add_u32 v3, v2, 2, v3
 v_bfe_u32 v2, v1, 1, 3
 v_xor_b32 v2, v2, v3
 v_lshl_add_u32 v11, v2, 5, v11
 v_and_b32 v2, 1, v1
 v_lshl_add_u32 v11, v2, 4, v11
 v_bfe_u32 v2, v1, 2, 3
 v_xor_b32 v3, s4, v2
 v_lshlrev_b32 v3, 5, v3
 v_and_b32 v2, 3, v2
 v_lshl_add_u32 v3, v2, 8, v3
 v_lshrrev_b32 v2, 4, v1
 v_lshl_add_u32 v3, v2, 11, v3
 v_and_b32 v2, 3, v1
 v_lshl_add_u32 v3, v2, 3, v3
 v_add_u32 v8, 73728, v3
 v_xor_b32 v3, 0x80, v3
 v_add_u32 v9, 73728, v3
 s_lshl_b32 s45, s4, 11
 v_lshl_add_u32 v12, v1, 4, s45
 s_mov_b32 s39, s37
 s_add_u32 s40, s39, 2
 s_lshl_b32 s49, s4, 10
 s_mul_i32 s46, s39, 36864
 s_add_u32 m0, s49, 0
 s_nop 0
 buffer_load_dwordx4 v10, s[8:11], s46 offen offset:0  lds
 s_add_u32 m0, s49, 3968
 s_nop 0
 buffer_load_dwordx4 v10, s[8:11], s46 offen offset:128  lds
 s_add_u32 m0, s49, 7936
 s_nop 0
 buffer_load_dwordx4 v10, s[8:11], s46 offen offset:256  lds
 s_add_u32 m0, s49, 11904
 s_nop 0
 buffer_load_dwordx4 v10, s[8:11], s46 offen offset:384  lds
 s_add_u32 m0, s49, 15872
 s_nop 0
 buffer_load_dwordx4 v10, s[8:11], s46 offen offset:512  lds
 s_add_u32 m0, s49, 19840
 s_nop 0
 buffer_load_dwordx4 v10, s[8:11], s46 offen offset:640  lds
 s_add_u32 m0, s49, 23808
 s_nop 0
 buffer_load_dwordx4 v10, s[8:11], s46 offen offset:768  lds
 s_add_u32 m0, s49, 27776
 s_nop 0
 buffer_load_dwordx4 v10, s[8:11], s46 offen offset:896  lds
 s_add_u32 m0, s49, 31744
 s_nop 0
 buffer_load_dwordx4 v10, s[8:11], s46 offen offset:1024  lds
 s_lshl_b32 s49, s4, 10
 s_add_u32 s49, s49, 36864
 s_mul_i32 s46, s40, 36864
 s_add_u32 m0, s49, 0
 s_nop 0
 buffer_load_dwordx4 v10, s[8:11], s46 offen offset:0  lds
 s_add_u32 m0, s49, 3968
 s_nop 0
 buffer_load_dwordx4 v10, s[8:11], s46 offen offset:128  lds
 s_add_u32 m0, s49, 7936
 s_nop 0
 buffer_load_dwordx4 v10, s[8:11], s46 offen offset:256  lds
 s_add_u32 m0, s49, 11904
 s_nop 0
 buffer_load_dwordx4 v10, s[8:11], s46 offen offset:384  lds
 s_add_u32 m0, s49, 15872
 s_nop 0
 buffer_load_dwordx4 v10, s[8:11], s46 offen offset:512  lds
 s_add_u32 m0, s49, 19840
 s_nop 0
 buffer_load_dwordx4 v10, s[8:11], s46 offen offset:640  lds
 s_add_u32 m0, s49, 23808
 s_nop 0
 buffer_load_dwordx4 v10, s[8:11], s46 offen offset:768  lds
 s_add_u32 m0, s49, 27776
 s_nop 0
 buffer_load_dwordx4 v10, s[8:11], s46 offen offset:896  lds
 s_add_u32 m0, s49, 31744
 s_nop 0
 buffer_load_dwordx4 v10, s[8:11], s46 offen offset:1024  lds
 s_lshl_b32 s49, s4, 10
 s_add_u32 m0, s49, 73728
 s_add_u32 s45, s32, 0
 buffer_load_dwordx4 v11, s[12:15], s45 offen  lds
 s_add_u32 m0, s49, 77824
 s_add_u32 s45, s32, 131072
 buffer_load_dwordx4 v11, s[12:15], s45 offen  lds
 s_add_u32 m0, s49, 81920
 s_add_u32 s45, s33, 0
 buffer_load_dwordx4 v11, s[16:19], s45 offen  lds
 s_add_u32 m0, s49, 86016
 s_add_u32 s45, s33, 131072
 buffer_load_dwordx4 v11, s[16:19], s45 offen  lds
 s_add_u32 m0, s49, 90112
 s_add_u32 s45, s32, 262144
 buffer_load_dwordx4 v11, s[12:15], s45 offen  lds
 s_add_u32 m0, s49, 94208
 s_add_u32 s45, s32, 393216
 buffer_load_dwordx4 v11, s[12:15], s45 offen  lds
 s_add_u32 m0, s49, 98304
 s_add_u32 s45, s33, 262144
 buffer_load_dwordx4 v11, s[16:19], s45 offen  lds
 s_add_u32 m0, s49, 102400
 s_add_u32 s45, s33, 393216
 buffer_load_dwordx4 v11, s[16:19], s45 offen  lds
 s_add_u32 m0, s49, 106496
 s_add_u32 s45, s32, 524288
 buffer_load_dwordx4 v11, s[12:15], s45 offen  lds
 s_add_u32 m0, s49, 110592
 s_add_u32 s45, s32, 655360
 buffer_load_dwordx4 v11, s[12:15], s45 offen  lds
 s_add_u32 m0, s49, 114688
 s_add_u32 s45, s33, 524288
 buffer_load_dwordx4 v11, s[16:19], s45 offen  lds
 s_add_u32 m0, s49, 118784
 s_add_u32 s45, s33, 655360
 buffer_load_dwordx4 v11, s[16:19], s45 offen  lds
 s_waitcnt vmcnt(8) lgkmcnt(0)
 s_barrier
 s_add_u32 m0, s49, 122880
 s_add_u32 s45, s32, 786432
 buffer_load_dwordx4 v11, s[12:15], s45 offen  lds
 s_add_u32 m0, s49, 126976
 s_add_u32 s45, s32, 917504
 buffer_load_dwordx4 v11, s[12:15], s45 offen  lds
 s_add_u32 m0, s49, 131072
 s_add_u32 s45, s33, 786432
 buffer_load_dwordx4 v11, s[16:19], s45 offen  lds
 s_add_u32 m0, s49, 135168
 s_add_u32 s45, s33, 917504
 buffer_load_dwordx4 v11, s[16:19], s45 offen  lds
 ds_read_b64_tr_b16 a[0:1], v8 offset:0
 ds_read_b64_tr_b16 a[2:3], v8 offset:1024
 ds_read_b64_tr_b16 a[72:73], v9 offset:0
 ds_read_b64_tr_b16 a[74:75], v9 offset:1024
 ds_read_b64_tr_b16 a[144:145], v8 offset:8192
 ds_read_b64_tr_b16 a[146:147], v8 offset:9216
 ds_read_b64_tr_b16 a[216:217], v9 offset:8192
 ds_read_b64_tr_b16 a[218:219], v9 offset:9216
 s_waitcnt vmcnt(8) lgkmcnt(0)
 s_barrier
 s_add_u32 m0, s49, 73728
 s_add_u32 s45, s32, 1048576
 buffer_load_dwordx4 v11, s[12:15], s45 offen  lds
 s_add_u32 m0, s49, 77824
 s_add_u32 s45, s32, 1179648
 buffer_load_dwordx4 v11, s[12:15], s45 offen  lds
 s_add_u32 m0, s49, 81920
 s_add_u32 s45, s33, 1048576
 buffer_load_dwordx4 v11, s[16:19], s45 offen  lds
 s_add_u32 m0, s49, 86016
 s_add_u32 s45, s33, 1179648
 buffer_load_dwordx4 v11, s[16:19], s45 offen  lds
 ds_read_b64_tr_b16 a[4:5], v8 offset:16384
 ds_read_b64_tr_b16 a[6:7], v8 offset:17408
 ds_read_b64_tr_b16 a[76:77], v9 offset:16384
 ds_read_b64_tr_b16 a[78:79], v9 offset:17408
 ds_read_b64_tr_b16 a[148:149], v8 offset:24576
 ds_read_b64_tr_b16 a[150:151], v8 offset:25600
 ds_read_b64_tr_b16 a[220:221], v9 offset:24576
 ds_read_b64_tr_b16 a[222:223], v9 offset:25600
 s_waitcnt vmcnt(8) lgkmcnt(0)
 s_barrier
 s_add_u32 m0, s49, 90112
 s_add_u32 s45, s32, 1310720
 buffer_load_dwordx4 v11, s[12:15], s45 offen  lds
 s_add_u32 m0, s49, 94208
 s_add_u32 s45, s32, 1441792
 buffer_load_dwordx4 v11, s[12:15], s45 offen  lds
 s_add_u32 m0, s49, 98304
 s_add_u32 s45, s33, 1310720
 buffer_load_dwordx4 v11, s[16:19], s45 offen  lds
 s_add_u32 m0, s49, 102400
 s_add_u32 s45, s33, 1441792
 buffer_load_dwordx4 v11, s[16:19], s45 offen  lds
 ds_read_b64_tr_b16 a[8:9], v8 offset:32768
 ds_read_b64_tr_b16 a[10:11], v8 offset:33792
 ds_read_b64_tr_b16 a[80:81], v9 offset:32768
 ds_read_b64_tr_b16 a[82:83], v9 offset:33792
 ds_read_b64_tr_b16 a[152:153], v8 offset:40960
 ds_read_b64_tr_b16 a[154:155], v8 offset:41984
 ds_read_b64_tr_b16 a[224:225], v9 offset:40960
 ds_read_b64_tr_b16 a[226:227], v9 offset:41984
 s_waitcnt vmcnt(8) lgkmcnt(0)
 s_barrier
 s_add_u32 m0, s49, 106496
 s_add_u32 s45, s32, 1572864
 buffer_load_dwordx4 v11, s[12:15], s45 offen  lds
 s_add_u32 m0, s49, 110592
 s_add_u32 s45, s32, 1703936
 buffer_load_dwordx4 v11, s[12:15], s45 offen  lds
 s_add_u32 m0, s49, 114688
 s_add_u32 s45, s33, 1572864
 buffer_load_dwordx4 v11, s[16:19], s45 offen  lds
 s_add_u32 m0, s49, 118784
 s_add_u32 s45, s33, 1703936
 buffer_load_dwordx4 v11, s[16:19], s45 offen  lds
 ds_read_b64_tr_b16 a[12:13], v8 offset:49152
 ds_read_b64_tr_b16 a[14:15], v8 offset:50176
 ds_read_b64_tr_b16 a[84:85], v9 offset:49152
 ds_read_b64_tr_b16 a[86:87], v9 offset:50176
 ds_read_b64_tr_b16 a[156:157], v8 offset:57344
 ds_read_b64_tr_b16 a[158:159], v8 offset:58368
 ds_read_b64_tr_b16 a[228:229], v9 offset:57344
 ds_read_b64_tr_b16 a[230:231], v9 offset:58368
 s_waitcnt vmcnt(8) lgkmcnt(0)
 s_barrier
 s_add_u32 m0, s49, 122880
 s_add_u32 s45, s32, 1835008
 buffer_load_dwordx4 v11, s[12:15], s45 offen  lds
 s_add_u32 m0, s49, 126976
 s_add_u32 s45, s32, 1966080
 buffer_load_dwordx4 v11, s[12:15], s45 offen  lds
 s_add_u32 m0, s49, 131072
 s_add_u32 s45, s33, 1835008
 buffer_load_dwordx4 v11, s[16:19], s45 offen  lds
 s_add_u32 m0, s49, 135168
 s_add_u32 s45, s33, 1966080
 buffer_load_dwordx4 v11, s[16:19], s45 offen  lds
 ds_read_b64_tr_b16 a[16:17], v8 offset:0
 ds_read_b64_tr_b16 a[18:19], v8 offset:1024
 ds_read_b64_tr_b16 a[88:89], v9 offset:0
 ds_read_b64_tr_b16 a[90:91], v9 offset:1024
 ds_read_b64_tr_b16 a[160:161], v8 offset:8192
 ds_read_b64_tr_b16 a[162:163], v8 offset:9216
 ds_read_b64_tr_b16 a[232:233], v9 offset:8192
 ds_read_b64_tr_b16 a[234:235], v9 offset:9216
 s_waitcnt vmcnt(8) lgkmcnt(0)
 s_barrier
 s_add_u32 m0, s49, 73728
 s_add_u32 s45, s32, 2097152
 buffer_load_dwordx4 v11, s[12:15], s45 offen  lds
 s_add_u32 m0, s49, 77824
 s_add_u32 s45, s32, 2228224
 buffer_load_dwordx4 v11, s[12:15], s45 offen  lds
 s_add_u32 m0, s49, 81920
 s_add_u32 s45, s33, 2097152
 buffer_load_dwordx4 v11, s[16:19], s45 offen  lds
 s_add_u32 m0, s49, 86016
 s_add_u32 s45, s33, 2228224
 buffer_load_dwordx4 v11, s[16:19], s45 offen  lds
 ds_read_b64_tr_b16 a[20:21], v8 offset:16384
 ds_read_b64_tr_b16 a[22:23], v8 offset:17408
 ds_read_b64_tr_b16 a[92:93], v9 offset:16384
 ds_read_b64_tr_b16 a[94:95], v9 offset:17408
 ds_read_b64_tr_b16 a[164:165], v8 offset:24576
 ds_read_b64_tr_b16 a[166:167], v8 offset:25600
 ds_read_b64_tr_b16 a[236:237], v9 offset:24576
 ds_read_b64_tr_b16 a[238:239], v9 offset:25600
 s_waitcnt vmcnt(8) lgkmcnt(0)
 s_barrier
 s_add_u32 m0, s49, 90112
 s_add_u32 s45, s32, 2359296
 buffer_load_dwordx4 v11, s[12:15], s45 offen  lds
 s_add_u32 m0, s49, 94208
 s_add_u32 s45, s32, 2490368
 buffer_load_dwordx4 v11, s[12:15], s45 offen  lds
 s_add_u32 m0, s49, 98304
 s_add_u32 s45, s33, 2359296
 buffer_load_dwordx4 v11, s[16:19], s45 offen  lds
 s_add_u32 m0, s49, 102400
 s_add_u32 s45, s33, 2490368
 buffer_load_dwordx4 v11, s[16:19], s45 offen  lds
 ds_read_b64_tr_b16 a[24:25], v8 offset:32768
 ds_read_b64_tr_b16 a[26:27], v8 offset:33792
 ds_read_b64_tr_b16 a[96:97], v9 offset:32768
 ds_read_b64_tr_b16 a[98:99], v9 offset:33792
 ds_read_b64_tr_b16 a[168:169], v8 offset:40960
 ds_read_b64_tr_b16 a[170:171], v8 offset:41984
 ds_read_b64_tr_b16 a[240:241], v9 offset:40960
 ds_read_b64_tr_b16 a[242:243], v9 offset:41984
 s_waitcnt vmcnt(8) lgkmcnt(0)
 s_barrier
 s_add_u32 m0, s49, 106496
 s_add_u32 s45, s32, 2621440
 buffer_load_dwordx4 v11, s[12:15], s45 offen  lds
 s_add_u32 m0, s49, 110592
 s_add_u32 s45, s32, 2752512
 buffer_load_dwordx4 v11, s[12:15], s45 offen  lds
 s_add_u32 m0, s49, 114688
 s_add_u32 s45, s33, 2621440
 buffer_load_dwordx4 v11, s[16:19], s45 offen  lds
 s_add_u32 m0, s49, 118784
 s_add_u32 s45, s33, 2752512
 buffer_load_dwordx4 v11, s[16:19], s45 offen  lds
 ds_read_b64_tr_b16 a[28:29], v8 offset:49152
 ds_read_b64_tr_b16 a[30:31], v8 offset:50176
 ds_read_b64_tr_b16 a[100:101], v9 offset:49152
 ds_read_b64_tr_b16 a[102:103], v9 offset:50176
 ds_read_b64_tr_b16 a[172:173], v8 offset:57344
 ds_read_b64_tr_b16 a[174:175], v8 offset:58368
 ds_read_b64_tr_b16 a[244:245], v9 offset:57344
 ds_read_b64_tr_b16 a[246:247], v9 offset:58368
 s_waitcnt vmcnt(8) lgkmcnt(0)
 s_barrier
 s_add_u32 m0, s49, 122880
 s_add_u32 s45, s32, 2883584
 buffer_load_dwordx4 v11, s[12:15], s45 offen  lds
 s_add_u32 m0, s49, 126976
 s_add_u32 s45, s32, 3014656
 buffer_load_dwordx4 v11, s[12:15], s45 offen  lds
 s_add_u32 m0, s49, 131072
 s_add_u32 s45, s33, 2883584
 buffer_load_dwordx4 v11, s[16:19], s45 offen  lds
 s_add_u32 m0, s49, 135168
 s_add_u32 s45, s33, 3014656
 buffer_load_dwordx4 v11, s[16:19], s45 offen  lds
 ds_read_b64_tr_b16 a[32:33], v8 offset:0
 ds_read_b64_tr_b16 a[34:35], v8 offset:1024
 ds_read_b64_tr_b16 a[104:105], v9 offset:0
 ds_read_b64_tr_b16 a[106:107], v9 offset:1024
 ds_read_b64_tr_b16 a[176:177], v8 offset:8192
 ds_read_b64_tr_b16 a[178:179], v8 offset:9216
 ds_read_b64_tr_b16 a[248:249], v9 offset:8192
 ds_read_b64_tr_b16 a[250:251], v9 offset:9216
 s_waitcnt vmcnt(8) lgkmcnt(0)
 s_barrier
 s_add_u32 m0, s49, 73728
 s_add_u32 s45, s32, 3145728
 buffer_load_dwordx4 v11, s[12:15], s45 offen  lds
 s_add_u32 m0, s49, 77824
 s_add_u32 s45, s32, 3276800
 buffer_load_dwordx4 v11, s[12:15], s45 offen  lds
 s_add_u32 m0, s49, 81920
 s_add_u32 s45, s33, 3145728
 buffer_load_dwordx4 v11, s[16:19], s45 offen  lds
 s_add_u32 m0, s49, 86016
 s_add_u32 s45, s33, 3276800
 buffer_load_dwordx4 v11, s[16:19], s45 offen  lds
 ds_read_b64_tr_b16 a[36:37], v8 offset:16384
 ds_read_b64_tr_b16 a[38:39], v8 offset:17408
 ds_read_b64_tr_b16 a[108:109], v9 offset:16384
 ds_read_b64_tr_b16 a[110:111], v9 offset:17408
 ds_read_b64_tr_b16 a[180:181], v8 offset:24576
 ds_read_b64_tr_b16 a[182:183], v8 offset:25600
 ds_read_b64_tr_b16 a[252:253], v9 offset:24576
 ds_read_b64_tr_b16 a[254:255], v9 offset:25600
 s_waitcnt vmcnt(8) lgkmcnt(0)
 s_barrier
 s_add_u32 m0, s49, 90112
 s_add_u32 s45, s32, 3407872
 buffer_load_dwordx4 v11, s[12:15], s45 offen  lds
 s_add_u32 m0, s49, 94208
 s_add_u32 s45, s32, 3538944
 buffer_load_dwordx4 v11, s[12:15], s45 offen  lds
 s_add_u32 m0, s49, 98304
 s_add_u32 s45, s33, 3407872
 buffer_load_dwordx4 v11, s[16:19], s45 offen  lds
 s_add_u32 m0, s49, 102400
 s_add_u32 s45, s33, 3538944
 buffer_load_dwordx4 v11, s[16:19], s45 offen  lds
 ds_read_b64_tr_b16 a[40:41], v8 offset:32768
 ds_read_b64_tr_b16 a[42:43], v8 offset:33792
 ds_read_b64_tr_b16 a[112:113], v9 offset:32768
 ds_read_b64_tr_b16 a[114:115], v9 offset:33792
 ds_read_b64_tr_b16 a[184:185], v8 offset:40960
 ds_read_b64_tr_b16 a[186:187], v8 offset:41984
 ds_read_b64_tr_b16 v[224:225], v9 offset:40960
 ds_read_b64_tr_b16 v[226:227], v9 offset:41984
 s_waitcnt vmcnt(8) lgkmcnt(0)
 s_barrier
 s_add_u32 m0, s49, 106496
 s_add_u32 s45, s32, 3670016
 buffer_load_dwordx4 v11, s[12:15], s45 offen  lds
 s_add_u32 m0, s49, 110592
 s_add_u32 s45, s32, 3801088
 buffer_load_dwordx4 v11, s[12:15], s45 offen  lds
 s_add_u32 m0, s49, 114688
 s_add_u32 s45, s33, 3670016
 buffer_load_dwordx4 v11, s[16:19], s45 offen  lds
 s_add_u32 m0, s49, 118784
 s_add_u32 s45, s33, 3801088
 buffer_load_dwordx4 v11, s[16:19], s45 offen  lds
 ds_read_b64_tr_b16 a[44:45], v8 offset:49152
 ds_read_b64_tr_b16 a[46:47], v8 offset:50176
 ds_read_b64_tr_b16 a[116:117], v9 offset:49152
 ds_read_b64_tr_b16 a[118:119], v9 offset:50176
 ds_read_b64_tr_b16 a[188:189], v8 offset:57344
 ds_read_b64_tr_b16 a[190:191], v8 offset:58368
 ds_read_b64_tr_b16 v[228:229], v9 offset:57344
 ds_read_b64_tr_b16 v[230:231], v9 offset:58368
 s_waitcnt vmcnt(8) lgkmcnt(0)
 s_barrier
 s_add_u32 m0, s49, 122880
 s_add_u32 s45, s32, 3932160
 buffer_load_dwordx4 v11, s[12:15], s45 offen  lds
 s_add_u32 m0, s49, 126976
 s_add_u32 s45, s32, 4063232
 buffer_load_dwordx4 v11, s[12:15], s45 offen  lds
 s_add_u32 m0, s49, 131072
 s_add_u32 s45, s33, 3932160
 buffer_load_dwordx4 v11, s[16:19], s45 offen  lds
 s_add_u32 m0, s49, 135168
 s_add_u32 s45, s33, 4063232
 buffer_load_dwordx4 v11, s[16:19], s45 offen  lds
 ds_read_b64_tr_b16 a[48:49], v8 offset:0
 ds_read_b64_tr_b16 a[50:51], v8 offset:1024
 ds_read_b64_tr_b16 a[120:121], v9 offset:0
 ds_read_b64_tr_b16 a[122:123], v9 offset:1024
 ds_read_b64_tr_b16 a[192:193], v8 offset:8192
 ds_read_b64_tr_b16 a[194:195], v8 offset:9216
 ds_read_b64_tr_b16 v[232:233], v9 offset:8192
 ds_read_b64_tr_b16 v[234:235], v9 offset:9216
 s_waitcnt vmcnt(8) lgkmcnt(0)
 s_barrier
 s_add_u32 m0, s49, 73728
 s_add_u32 s45, s32, 4194304
 buffer_load_dwordx4 v11, s[12:15], s45 offen  lds
 s_add_u32 m0, s49, 77824
 s_add_u32 s45, s32, 4325376
 buffer_load_dwordx4 v11, s[12:15], s45 offen  lds
 s_add_u32 m0, s49, 81920
 s_add_u32 s45, s33, 4194304
 buffer_load_dwordx4 v11, s[16:19], s45 offen  lds
 s_add_u32 m0, s49, 86016
 s_add_u32 s45, s33, 4325376
 buffer_load_dwordx4 v11, s[16:19], s45 offen  lds
 ds_read_b64_tr_b16 a[52:53], v8 offset:16384
 ds_read_b64_tr_b16 a[54:55], v8 offset:17408
 ds_read_b64_tr_b16 a[124:125], v9 offset:16384
 ds_read_b64_tr_b16 a[126:127], v9 offset:17408
 ds_read_b64_tr_b16 a[196:197], v8 offset:24576
 ds_read_b64_tr_b16 a[198:199], v8 offset:25600
 ds_read_b64_tr_b16 v[236:237], v9 offset:24576
 ds_read_b64_tr_b16 v[238:239], v9 offset:25600
 s_waitcnt vmcnt(8) lgkmcnt(0)
 s_barrier
 s_add_u32 m0, s49, 90112
 s_add_u32 s45, s32, 4456448
 buffer_load_dwordx4 v11, s[12:15], s45 offen  lds
 s_add_u32 m0, s49, 94208
 s_add_u32 s45, s32, 4587520
 buffer_load_dwordx4 v11, s[12:15], s45 offen  lds
 s_add_u32 m0, s49, 98304
 s_add_u32 s45, s33, 4456448
 buffer_load_dwordx4 v11, s[16:19], s45 offen  lds
 s_add_u32 m0, s49, 102400
 s_add_u32 s45, s33, 4587520
 buffer_load_dwordx4 v11, s[16:19], s45 offen  lds
 ds_read_b64_tr_b16 a[56:57], v8 offset:32768
 ds_read_b64_tr_b16 a[58:59], v8 offset:33792
 ds_read_b64_tr_b16 a[128:129], v9 offset:32768
 ds_read_b64_tr_b16 a[130:131], v9 offset:33792
 ds_read_b64_tr_b16 a[200:201], v8 offset:40960
 ds_read_b64_tr_b16 a[202:203], v8 offset:41984
 ds_read_b64_tr_b16 v[240:241], v9 offset:40960
 ds_read_b64_tr_b16 v[242:243], v9 offset:41984
 s_waitcnt vmcnt(8) lgkmcnt(0)
 s_barrier
 ds_read_b64_tr_b16 a[60:61], v8 offset:49152
 ds_read_b64_tr_b16 a[62:63], v8 offset:50176
 ds_read_b64_tr_b16 a[132:133], v9 offset:49152
 ds_read_b64_tr_b16 a[134:135], v9 offset:50176
 ds_read_b64_tr_b16 a[204:205], v8 offset:57344
 ds_read_b64_tr_b16 a[206:207], v8 offset:58368
 ds_read_b64_tr_b16 v[244:245], v9 offset:57344
 ds_read_b64_tr_b16 v[246:247], v9 offset:58368
 s_waitcnt vmcnt(4) lgkmcnt(0)
 s_barrier
 ds_read_b64_tr_b16 a[64:65], v8 offset:0
 ds_read_b64_tr_b16 a[66:67], v8 offset:1024
 ds_read_b64_tr_b16 a[136:137], v9 offset:0
 ds_read_b64_tr_b16 a[138:139], v9 offset:1024
 ds_read_b64_tr_b16 a[208:209], v8 offset:8192
 ds_read_b64_tr_b16 a[210:211], v8 offset:9216
 ds_read_b64_tr_b16 v[248:249], v9 offset:8192
 ds_read_b64_tr_b16 v[250:251], v9 offset:9216
 s_waitcnt vmcnt(0) lgkmcnt(0)
 s_barrier
 ds_read_b64_tr_b16 a[68:69], v8 offset:16384
 ds_read_b64_tr_b16 a[70:71], v8 offset:17408
 ds_read_b64_tr_b16 a[140:141], v9 offset:16384
 ds_read_b64_tr_b16 a[142:143], v9 offset:17408
 ds_read_b64_tr_b16 a[212:213], v8 offset:24576
 ds_read_b64_tr_b16 a[214:215], v8 offset:25600
 ds_read_b64_tr_b16 v[252:253], v9 offset:24576
 ds_read_b64_tr_b16 v[254:255], v9 offset:25600
 s_mov_b32 s50, 0x3e0293ee
 s_mov_b32 s42, 0
 s_mov_b32 s43, 0
 s_mov_b32 s44, 73728
 v_mov_b32 v6, v4
 v_mov_b32 v7, v5
 v_and_b32 v17, 63, v0
 v_lshlrev_b32 v1, 4, v17
 s_lshl_b32 s45, s4, 11
 s_add_u32 s45, s45, 147456
 v_add_u32 v2, s45, v1
 s_lshr_b32 s53, s4, 1
 s_and_b32 s54, s4, 1
 s_add_u32 s52, s52, s53
 s_lshl_b32 s53, s53, 13
 s_lshl_b32 s54, s54, 10
 s_add_u32 s45, s53, s54
 s_add_u32 s45, s45, 147456
 v_add_u32 v3, s45, v1
 s_lshl_b32 s63, s52, 13
 s_add_u32 s63, s63, s54
 s_add_u32 s63, s63, 0x7000000
 s_lshl_b32 s61, s52, 14
 s_add_u32 s61, s61, 0x3000000
 s_lshl_b32 s62, s52, 12
 s_add_u32 s62, s62, 0x400000
 s_lshl_b32 s57, s52, 7
 s_add_u32 s57, s57, 0x1000
 s_waitcnt lgkmcnt(0)
 v_min_u32 v8, 1, v0
 v_lshlrev_b32 v8, 28, v8
 s_mov_b32 s58, 0x40000
 v_mov_b32 v13, 0
 v_mov_b32 v14, 0
 v_min_u32 v15, 1, v17
 v_lshlrev_b32 v15, 28, v15
 v_bfe_u32 v18, v17, 3, 2
 v_and_b32 v19, 7, v17
 v_lshlrev_b32 v19, 7, v19
 v_lshl_add_u32 v18, v18, 11, v19
 v_lshrrev_b32 v19, 5, v17
 v_lshl_or_b32 v11, v19, 28, v18
 s_mov_b32 s56, s61
 v_mov_b32 v18, 0x44444444
 v_mov_b32 v19, 0xeeeeeeee
 v_and_b32 v20, 2, v17
 v_cmp_eq_u32 vcc, 0, v20
 s_nop 1
 v_cndmask_b32 v12, v19, v18, vcc
 v_mov_b32 v217, 0
 v_mov_b32 v218, 0
 v_mov_b32 v220, 0x3f803f80
 v_mov_b32 v221, 0x3f803f80
 v_mov_b32 v222, 0x3f803f80
 v_mov_b32 v223, 0x3f803f80
 v_and_b32 v18, 15, v17
 v_lshrrev_b32 v19, 4, v17
 v_lshlrev_b32 v19, 2, v19
 v_sub_u32 v18, v18, v19
 s_lshr_b32 s45, s54, 6
 v_add_u32 v18, s45, v18
 v_mov_b32 v19, 0xff800000
 v_cmp_le_i32 vcc, 0, v18
 s_nop 1
 v_cndmask_b32 v208, v19, v13, vcc
 v_cmp_le_i32 vcc, 1, v18
 s_nop 1
 v_cndmask_b32 v209, v19, v13, vcc
 v_cmp_le_i32 vcc, 2, v18
 s_nop 1
 v_cndmask_b32 v210, v19, v13, vcc
 v_cmp_le_i32 vcc, 3, v18
 s_nop 1
 v_cndmask_b32 v211, v19, v13, vcc
 v_cmp_le_i32 vcc, 16, v18
 s_nop 1
 v_cndmask_b32 v212, v19, v13, vcc
 v_cmp_le_i32 vcc, 17, v18
 s_nop 1
 v_cndmask_b32 v213, v19, v13, vcc
 v_cmp_le_i32 vcc, 18, v18
 s_nop 1
 v_cndmask_b32 v214, v19, v13, vcc
 v_cmp_le_i32 vcc, 19, v18
 s_nop 1
 v_cndmask_b32 v215, v19, v13, vcc
Lqs_22:
 buffer_load_dword v16, v15, s[20:23], s57 offen sc1
 s_waitcnt vmcnt(0)
 v_cmp_le_u32 vcc, 1, v16
 s_cbranch_vccnz Lqsk_23
 s_sleep 2
 s_sub_u32 s58, s58, 1
 s_cbranch_scc0 Lqs_22
 s_endpgm
Lqsk_23:
 s_waitcnt vmcnt(0) lgkmcnt(0)
 s_barrier
 ds_read_b128 v[32:35], v6 offset:0
 ds_read_b128 v[36:39], v6 offset:2048
 ds_read_b128 v[40:43], v7 offset:0
 ds_read_b128 v[44:47], v7 offset:2048
 s_waitcnt lgkmcnt(2)
Lqb_loop_24:
 v_mfma_f32_16x16x32_bf16 v[64:67], a[0:3], v[32:35], 0
 ds_read_b128 v[48:51], v6 offset:4096
 v_mfma_f32_16x16x32_bf16 v[72:75], a[72:75], v[32:35], 0
 ds_read_b128 v[52:55], v6 offset:6144
 v_mfma_f32_16x16x32_bf16 v[80:83], a[144:147], v[32:35], 0
 s_add_u32 s41, s40, 2
 v_mfma_f32_16x16x32_bf16 v[88:91], a[216:219], v[32:35], 0
 s_add_u32 s45, s42, 2
 s_mul_i32 s46, s41, 36864
 v_mfma_f32_16x16x32_bf16 v[68:71], a[0:3], v[36:39], 0
 s_cmp_lt_u32 s45, s36
 s_cselect_b32 s46, s46, 0
 v_mfma_f32_16x16x32_bf16 v[76:79], a[72:75], v[36:39], 0
 s_lshl_b32 s49, s4, 10
 s_add_u32 s49, s49, s44
 v_mfma_f32_16x16x32_bf16 v[84:87], a[144:147], v[36:39], 0
 s_lshl_b32 s53, s39, 19
 s_add_u32 s53, s53, s61
 v_mfma_f32_16x16x32_bf16 v[92:95], a[216:219], v[36:39], 0
 s_waitcnt lgkmcnt(2)
 v_mfma_f32_16x16x32_bf16 v[64:67], a[4:7], v[40:43], v[64:67]
 ds_read_b128 v[56:59], v7 offset:4096
 v_mfma_f32_16x16x32_bf16 v[72:75], a[76:79], v[40:43], v[72:75]
 ds_read_b128 v[60:63], v7 offset:6144
 v_mfma_f32_16x16x32_bf16 v[80:83], a[148:151], v[40:43], v[80:83]
 s_add_u32 m0, s49, 0
 v_mfma_f32_16x16x32_bf16 v[88:91], a[220:223], v[40:43], v[88:91]
 buffer_load_dwordx4 v10, s[8:11], s46 offen offset:0  lds
 v_mfma_f32_16x16x32_bf16 v[68:71], a[4:7], v[44:47], v[68:71]
 s_add_u32 m0, s49, 3968
 v_mfma_f32_16x16x32_bf16 v[76:79], a[76:79], v[44:47], v[76:79]
 buffer_load_dwordx4 v10, s[8:11], s46 offen offset:128  lds
 v_mfma_f32_16x16x32_bf16 v[84:87], a[148:151], v[44:47], v[84:87]
 s_lshl_b32 s55, s39, 17
 s_add_u32 s55, s55, s62
 v_mfma_f32_16x16x32_bf16 v[92:95], a[220:223], v[44:47], v[92:95]
 s_waitcnt lgkmcnt(2)
 v_mfma_f32_16x16x32_bf16 v[64:67], a[8:11], v[48:51], v[64:67]
 ds_read_b128 v[32:35], v6 offset:8192
 v_mfma_f32_16x16x32_bf16 v[72:75], a[80:83], v[48:51], v[72:75]
 ds_read_b128 v[36:39], v6 offset:10240
 v_mfma_f32_16x16x32_bf16 v[80:83], a[152:155], v[48:51], v[80:83]
 s_add_u32 m0, s49, 7936
 v_mfma_f32_16x16x32_bf16 v[88:91], a[224:227], v[48:51], v[88:91]
 buffer_load_dwordx4 v10, s[8:11], s46 offen offset:256  lds
 v_mfma_f32_16x16x32_bf16 v[68:71], a[8:11], v[52:55], v[68:71]
 s_add_u32 m0, s49, 11904
 v_mfma_f32_16x16x32_bf16 v[76:79], a[80:83], v[52:55], v[76:79]
 buffer_load_dwordx4 v10, s[8:11], s46 offen offset:384  lds
 v_mfma_f32_16x16x32_bf16 v[84:87], a[152:155], v[52:55], v[84:87]
 v_mfma_f32_16x16x32_bf16 v[92:95], a[224:227], v[52:55], v[92:95]
 s_waitcnt lgkmcnt(2)
 v_mfma_f32_16x16x32_bf16 v[64:67], a[12:15], v[56:59], v[64:67]
 ds_read_b128 v[40:43], v7 offset:8192
 v_mfma_f32_16x16x32_bf16 v[72:75], a[84:87], v[56:59], v[72:75]
 ds_read_b128 v[44:47], v7 offset:10240
 v_mfma_f32_16x16x32_bf16 v[80:83], a[156:159], v[56:59], v[80:83]
 s_add_u32 m0, s49, 15872
 v_mfma_f32_16x16x32_bf16 v[88:91], a[228:231], v[56:59], v[88:91]
 buffer_load_dwordx4 v10, s[8:11], s46 offen offset:512  lds
 v_mfma_f32_16x16x32_bf16 v[68:71], a[12:15], v[60:63], v[68:71]
 s_add_u32 m0, s49, 19840
 v_mfma_f32_16x16x32_bf16 v[76:79], a[84:87], v[60:63], v[76:79]
 buffer_load_dwordx4 v10, s[8:11], s46 offen offset:640  lds
 v_mfma_f32_16x16x32_bf16 v[84:87], a[156:159], v[60:63], v[84:87]
 s_add_u32 s60, s39, 1
 v_mfma_f32_16x16x32_bf16 v[92:95], a[228:231], v[60:63], v[92:95]
 s_waitcnt lgkmcnt(2)
 v_mfma_f32_16x16x32_bf16 v[64:67], a[16:19], v[32:35], v[64:67]
 ds_read_b128 v[48:51], v6 offset:12288
 v_mfma_f32_16x16x32_bf16 v[72:75], a[88:91], v[32:35], v[72:75]
 ds_read_b128 v[52:55], v6 offset:14336
 v_mfma_f32_16x16x32_bf16 v[80:83], a[160:163], v[32:35], v[80:83]
 s_add_u32 m0, s49, 23808
 v_mfma_f32_16x16x32_bf16 v[88:91], a[232:235], v[32:35], v[88:91]
 buffer_load_dwordx4 v10, s[8:11], s46 offen offset:768  lds
 v_mfma_f32_16x16x32_bf16 v[68:71], a[16:19], v[36:39], v[68:71]
 s_add_u32 m0, s49, 27776
 v_mfma_f32_16x16x32_bf16 v[76:79], a[88:91], v[36:39], v[76:79]
 buffer_load_dwordx4 v10, s[8:11], s46 offen offset:896  lds
 v_mfma_f32_16x16x32_bf16 v[84:87], a[160:163], v[36:39], v[84:87]
 v_mfma_f32_16x16x32_bf16 v[92:95], a[232:235], v[36:39], v[92:95]
 s_waitcnt lgkmcnt(2)
 v_mfma_f32_16x16x32_bf16 v[64:67], a[20:23], v[40:43], v[64:67]
 ds_read_b128 v[56:59], v7 offset:12288
 v_mfma_f32_16x16x32_bf16 v[72:75], a[92:95], v[40:43], v[72:75]
 ds_read_b128 v[60:63], v7 offset:14336
 v_mfma_f32_16x16x32_bf16 v[80:83], a[164:167], v[40:43], v[80:83]
 s_add_u32 m0, s49, 31744
 v_mfma_f32_16x16x32_bf16 v[88:91], a[236:239], v[40:43], v[88:91]
 buffer_load_dwordx4 v10, s[8:11], s46 offen offset:1024  lds
 v_mfma_f32_16x16x32_bf16 v[68:71], a[20:23], v[44:47], v[68:71]
 v_mfma_f32_16x16x32_bf16 v[76:79], a[92:95], v[44:47], v[76:79]
 v_mfma_f32_16x16x32_bf16 v[84:87], a[164:167], v[44:47], v[84:87]
 v_mfma_f32_16x16x32_bf16 v[92:95], a[236:239], v[44:47], v[92:95]
 s_waitcnt lgkmcnt(2)
 v_mfma_f32_16x16x32_bf16 v[64:67], a[24:27], v[48:51], v[64:67]
 ds_read_b128 v[32:35], v6 offset:16384
 v_mfma_f32_16x16x32_bf16 v[72:75], a[96:99], v[48:51], v[72:75]
 ds_read_b128 v[36:39], v6 offset:18432
 v_mfma_f32_16x16x32_bf16 v[80:83], a[168:171], v[48:51], v[80:83]
 s_waitcnt vmcnt(9)
 buffer_load_dword v17, v11, s[20:23], s56 offen sc1
 v_mfma_f32_16x16x32_bf16 v[88:91], a[240:243], v[48:51], v[88:91]
 s_barrier
 buffer_store_dword v14, v8, s[20:23], s59 offen sc1
 v_mfma_f32_16x16x32_bf16 v[68:71], a[24:27], v[52:55], v[68:71]
 buffer_load_dword v16, v15, s[20:23], s57 offen sc1
 v_mfma_f32_16x16x32_bf16 v[76:79], a[96:99], v[52:55], v[76:79]
 v_mfma_f32_16x16x32_bf16 v[84:87], a[168:171], v[52:55], v[84:87]
 s_lshl_b32 s56, s39, 18
 s_add_u32 s56, s56, s63
 v_mfma_f32_16x16x32_bf16 v[92:95], a[240:243], v[52:55], v[92:95]
 s_waitcnt lgkmcnt(2)
 v_mfma_f32_16x16x32_bf16 v[64:67], a[28:31], v[56:59], v[64:67]
 ds_read_b128 v[40:43], v7 offset:16384
 v_mfma_f32_16x16x32_bf16 v[72:75], a[100:103], v[56:59], v[72:75]
 ds_read_b128 v[44:47], v7 offset:18432
 v_mfma_f32_16x16x32_bf16 v[80:83], a[172:175], v[56:59], v[80:83]
 buffer_load_dwordx4 v[128:131], v1, s[20:23], s53 offen offset:0 sc1
 v_mfma_f32_16x16x32_bf16 v[88:91], a[244:247], v[56:59], v[88:91]
 v_mfma_f32_16x16x32_bf16 v[68:71], a[28:31], v[60:63], v[68:71]
 buffer_load_dwordx4 v[132:135], v1, s[20:23], s53 offen offset:1024 sc1
 v_mfma_f32_16x16x32_bf16 v[76:79], a[100:103], v[60:63], v[76:79]
 v_mfma_f32_16x16x32_bf16 v[84:87], a[172:175], v[60:63], v[84:87]
 v_mfma_f32_16x16x32_bf16 v[92:95], a[244:247], v[60:63], v[92:95]
 s_waitcnt lgkmcnt(2)
 v_mfma_f32_16x16x32_bf16 v[64:67], a[32:35], v[32:35], v[64:67]
 ds_read_b128 v[48:51], v6 offset:20480
 v_mfma_f32_16x16x32_bf16 v[72:75], a[104:107], v[32:35], v[72:75]
 ds_read_b128 v[52:55], v6 offset:22528
 v_mfma_f32_16x16x32_bf16 v[80:83], a[176:179], v[32:35], v[80:83]
 buffer_load_dwordx4 v[136:139], v1, s[20:23], s53 offen offset:2048 sc1
 v_mfma_f32_16x16x32_bf16 v[88:91], a[248:251], v[32:35], v[88:91]
 v_mfma_f32_16x16x32_bf16 v[68:71], a[32:35], v[36:39], v[68:71]
 buffer_load_dwordx4 v[140:143], v1, s[20:23], s53 offen offset:3072 sc1
 v_mfma_f32_16x16x32_bf16 v[76:79], a[104:107], v[36:39], v[76:79]
 v_mfma_f32_16x16x32_bf16 v[84:87], a[176:179], v[36:39], v[84:87]
 s_add_u32 s53, s53, 4096
 v_mfma_f32_16x16x32_bf16 v[92:95], a[248:251], v[36:39], v[92:95]
 s_waitcnt lgkmcnt(2)
 v_mfma_f32_16x16x32_bf16 v[64:67], a[36:39], v[40:43], v[64:67]
 ds_read_b128 v[56:59], v7 offset:20480
 v_mfma_f32_16x16x32_bf16 v[72:75], a[108:111], v[40:43], v[72:75]
 ds_read_b128 v[60:63], v7 offset:22528
 v_mfma_f32_16x16x32_bf16 v[80:83], a[180:183], v[40:43], v[80:83]
 buffer_load_dwordx4 v[144:147], v1, s[20:23], s53 offen offset:0 sc1
 v_mfma_f32_16x16x32_bf16 v[88:91], a[252:255], v[40:43], v[88:91]
 v_mfma_f32_16x16x32_bf16 v[68:71], a[36:39], v[44:47], v[68:71]
 buffer_load_dwordx4 v[148:151], v1, s[20:23], s53 offen offset:1024 sc1
 v_mfma_f32_16x16x32_bf16 v[76:79], a[108:111], v[44:47], v[76:79]
 v_mfma_f32_16x16x32_bf16 v[84:87], a[180:183], v[44:47], v[84:87]
 v_mfma_f32_16x16x32_bf16 v[92:95], a[252:255], v[44:47], v[92:95]
 s_waitcnt lgkmcnt(2)
 v_mfma_f32_16x16x32_bf16 v[64:67], a[40:43], v[48:51], v[64:67]
 ds_read_b128 v[32:35], v6 offset:24576
 v_mfma_f32_16x16x32_bf16 v[72:75], a[112:115], v[48:51], v[72:75]
 ds_read_b128 v[36:39], v6 offset:26624
 v_mfma_f32_16x16x32_bf16 v[80:83], a[184:187], v[48:51], v[80:83]
 buffer_load_dwordx4 v[152:155], v1, s[20:23], s53 offen offset:2048 sc1
 v_mfma_f32_16x16x32_bf16 v[88:91], v[224:227], v[48:51], v[88:91]
 v_mfma_f32_16x16x32_bf16 v[68:71], a[40:43], v[52:55], v[68:71]
 buffer_load_dwordx4 v[156:159], v1, s[20:23], s53 offen offset:3072 sc1
 v_mfma_f32_16x16x32_bf16 v[76:79], a[112:115], v[52:55], v[76:79]
 v_mfma_f32_16x16x32_bf16 v[84:87], a[184:187], v[52:55], v[84:87]
 s_add_u32 s53, s53, 4096
 v_mfma_f32_16x16x32_bf16 v[92:95], v[224:227], v[52:55], v[92:95]
 s_waitcnt lgkmcnt(2)
 v_mfma_f32_16x16x32_bf16 v[64:67], a[44:47], v[56:59], v[64:67]
 ds_read_b128 v[40:43], v7 offset:24576
 v_mfma_f32_16x16x32_bf16 v[72:75], a[116:119], v[56:59], v[72:75]
 ds_read_b128 v[44:47], v7 offset:26624
 v_mfma_f32_16x16x32_bf16 v[80:83], a[188:191], v[56:59], v[80:83]
 buffer_load_dwordx4 v[160:163], v1, s[20:23], s53 offen offset:0 sc1
 v_mfma_f32_16x16x32_bf16 v[88:91], v[228:231], v[56:59], v[88:91]
 v_mfma_f32_16x16x32_bf16 v[68:71], a[44:47], v[60:63], v[68:71]
 buffer_load_dwordx4 v[164:167], v1, s[20:23], s53 offen offset:1024 sc1
 v_mfma_f32_16x16x32_bf16 v[76:79], a[116:119], v[60:63], v[76:79]
 v_mfma_f32_16x16x32_bf16 v[84:87], a[188:191], v[60:63], v[84:87]
 v_mfma_f32_16x16x32_bf16 v[92:95], v[228:231], v[60:63], v[92:95]
 s_waitcnt lgkmcnt(2)
 v_mfma_f32_16x16x32_bf16 v[64:67], a[48:51], v[32:35], v[64:67]
 ds_read_b128 v[48:51], v6 offset:28672
 v_mfma_f32_16x16x32_bf16 v[72:75], a[120:123], v[32:35], v[72:75]
 ds_read_b128 v[52:55], v6 offset:30720
 v_mfma_f32_16x16x32_bf16 v[80:83], a[192:195], v[32:35], v[80:83]
 buffer_load_dwordx4 v[168:171], v1, s[20:23], s53 offen offset:2048 sc1
 v_mfma_f32_16x16x32_bf16 v[88:91], v[232:235], v[32:35], v[88:91]
 v_mfma_f32_16x16x32_bf16 v[68:71], a[48:51], v[36:39], v[68:71]
 buffer_load_dwordx4 v[172:175], v1, s[20:23], s53 offen offset:3072 sc1
 v_mfma_f32_16x16x32_bf16 v[76:79], a[120:123], v[36:39], v[76:79]
 v_mfma_f32_16x16x32_bf16 v[84:87], a[192:195], v[36:39], v[84:87]
 s_add_u32 s53, s53, 4096
 v_mfma_f32_16x16x32_bf16 v[92:95], v[232:235], v[36:39], v[92:95]
 s_waitcnt lgkmcnt(2)
 v_mfma_f32_16x16x32_bf16 v[64:67], a[52:55], v[40:43], v[64:67]
 ds_read_b128 v[56:59], v7 offset:28672
 v_mfma_f32_16x16x32_bf16 v[72:75], a[124:127], v[40:43], v[72:75]
 ds_read_b128 v[60:63], v7 offset:30720
 v_mfma_f32_16x16x32_bf16 v[80:83], a[196:199], v[40:43], v[80:83]
 s_add_u32 s43, s43, 36864
 s_cmp_eq_u32 s43, 147456
 buffer_load_dwordx4 v[176:179], v1, s[20:23], s53 offen offset:0 sc1
 v_mfma_f32_16x16x32_bf16 v[88:91], v[236:239], v[40:43], v[88:91]
 s_cselect_b32 s43, 0, s43
 s_add_u32 s44, s44, 36864
 v_mfma_f32_16x16x32_bf16 v[68:71], a[52:55], v[44:47], v[68:71]
 s_cmp_eq_u32 s44, 147456
 s_cselect_b32 s44, 0, s44
 buffer_load_dwordx4 v[180:183], v1, s[20:23], s53 offen offset:1024 sc1
 v_mfma_f32_16x16x32_bf16 v[76:79], a[124:127], v[44:47], v[76:79]
 v_mfma_f32_16x16x32_bf16 v[84:87], a[196:199], v[44:47], v[84:87]
 v_mfma_f32_16x16x32_bf16 v[92:95], v[236:239], v[44:47], v[92:95]
 s_waitcnt lgkmcnt(2)
 v_mfma_f32_16x16x32_bf16 v[64:67], a[56:59], v[48:51], v[64:67]
 ds_read_b128 v[32:35], v6 offset:32768
 v_mfma_f32_16x16x32_bf16 v[72:75], a[128:131], v[48:51], v[72:75]
 ds_read_b128 v[36:39], v6 offset:34816
 v_mfma_f32_16x16x32_bf16 v[80:83], a[200:203], v[48:51], v[80:83]
 v_add_u32 v6, s43, v4
 buffer_load_dwordx4 v[184:187], v1, s[20:23], s53 offen offset:2048 sc1
 v_mfma_f32_16x16x32_bf16 v[88:91], v[240:243], v[48:51], v[88:91]
 v_mfma_f32_16x16x32_bf16 v[68:71], a[56:59], v[52:55], v[68:71]
 buffer_load_dwordx4 v[188:191], v1, s[20:23], s53 offen offset:3072 sc1
 v_mfma_f32_16x16x32_bf16 v[76:79], a[128:131], v[52:55], v[76:79]
 v_mfma_f32_16x16x32_bf16 v[84:87], a[200:203], v[52:55], v[84:87]
 v_mfma_f32_16x16x32_bf16 v[92:95], v[240:243], v[52:55], v[92:95]
 s_waitcnt lgkmcnt(2)
 v_mfma_f32_16x16x32_bf16 v[64:67], a[60:63], v[56:59], v[64:67]
 ds_read_b128 v[40:43], v7 offset:32768
 v_mfma_f32_16x16x32_bf16 v[72:75], a[132:135], v[56:59], v[72:75]
 ds_read_b128 v[44:47], v7 offset:34816
 v_mfma_f32_16x16x32_bf16 v[80:83], a[204:207], v[56:59], v[80:83]
 v_add_u32 v7, s43, v5
 v_mfma_f32_16x16x32_bf16 v[88:91], v[244:247], v[56:59], v[88:91]
 v_mfma_f32_16x16x32_bf16 v[68:71], a[60:63], v[60:63], v[68:71]
 v_mfma_f32_16x16x32_bf16 v[76:79], a[132:135], v[60:63], v[76:79]
 v_mfma_f32_16x16x32_bf16 v[84:87], a[204:207], v[60:63], v[84:87]
 v_mfma_f32_16x16x32_bf16 v[92:95], v[244:247], v[60:63], v[92:95]
 s_waitcnt lgkmcnt(2)
 v_mfma_f32_16x16x32_bf16 v[64:67], a[64:67], v[32:35], v[64:67]
 s_waitcnt vmcnt(28)
 s_barrier
 ds_read_b128 v[48:51], v6 offset:0
 v_mfma_f32_16x16x32_bf16 v[72:75], a[136:139], v[32:35], v[72:75]
 ds_read_b128 v[52:55], v6 offset:2048
 v_mfma_f32_16x16x32_bf16 v[80:83], a[208:211], v[32:35], v[80:83]
 v_mfma_f32_16x16x32_bf16 v[88:91], v[248:251], v[32:35], v[88:91]
 s_waitcnt vmcnt(16)
 v_cmp_le_u32 vcc, s60, v16
 v_mfma_f32_16x16x32_bf16 v[68:71], a[64:67], v[36:39], v[68:71]
 v_mfma_f32_16x16x32_bf16 v[76:79], a[136:139], v[36:39], v[76:79]
 s_and_b32 s64, vcc_lo, 1
 s_cbranch_scc0 Lqsk_25
 buffer_load_dwordx4 v[192:195], v1, s[20:23], s55 offen offset:0 sc1
 buffer_load_dwordx4 v[196:199], v1, s[20:23], s55 offen offset:1024 sc1
 buffer_load_dwordx4 v[200:203], v1, s[20:23], s55 offen offset:2048 sc1
 buffer_load_dwordx4 v[204:207], v1, s[20:23], s55 offen offset:3072 sc1
Lqsk_25:
 v_mfma_f32_16x16x32_bf16 v[84:87], a[208:211], v[36:39], v[84:87]
 v_mfma_f32_16x16x32_bf16 v[92:95], v[248:251], v[36:39], v[92:95]
 s_waitcnt lgkmcnt(2)
 v_mfma_f32_16x16x32_bf16 v[64:67], a[68:71], v[40:43], v[64:67]
 ds_read_b128 v[56:59], v7 offset:0
 v_mfma_f32_16x16x32_bf16 v[72:75], a[140:143], v[40:43], v[72:75]
 ds_read_b128 v[60:63], v7 offset:2048
 v_mfma_f32_16x16x32_bf16 v[80:83], a[212:215], v[40:43], v[80:83]
 v_mfma_f32_16x16x32_bf16 v[88:91], v[252:255], v[40:43], v[88:91]
 s_mov_b32 s39, s40
 s_mov_b32 s40, s41
 v_mfma_f32_16x16x32_bf16 v[68:71], a[68:71], v[44:47], v[68:71]
 s_add_u32 s42, s42, 1
 v_mov_b32 v14, s42
 v_mfma_f32_16x16x32_bf16 v[76:79], a[140:143], v[44:47], v[76:79]
 v_mfma_f32_16x16x32_bf16 v[84:87], a[212:215], v[44:47], v[84:87]
 v_mfma_f32_16x16x32_bf16 v[92:95], v[252:255], v[44:47], v[92:95]
 s_waitcnt lgkmcnt(2)
 s_nop 3
 v_mul_f32 v64, s50, v64
 v_mul_f32 v65, s50, v65
 v_mul_f32 v66, s50, v66
 v_mul_f32 v67, s50, v67
 v_mul_f32 v72, s50, v72
 v_mul_f32 v73, s50, v73
 v_mul_f32 v74, s50, v74
 v_mul_f32 v75, s50, v75
 v_cvt_pk_bf16_f32 v16, v64, v65
 v_cvt_pk_bf16_f32 v17, v72, v73
 v_cvt_pk_bf16_f32 v18, v66, v67
 v_cvt_pk_bf16_f32 v19, v74, v75
 ds_write_b128 v2, v[16:19] offset:0
 v_mul_f32 v68, s50, v68
 v_mul_f32 v69, s50, v69
 v_mul_f32 v70, s50, v70
 v_mul_f32 v71, s50, v71
 v_mul_f32 v76, s50, v76
 v_mul_f32 v77, s50, v77
 v_mul_f32 v78, s50, v78
 v_mul_f32 v79, s50, v79
 v_cvt_pk_bf16_f32 v20, v68, v69
 v_cvt_pk_bf16_f32 v21, v76, v77
 v_cvt_pk_bf16_f32 v22, v70, v71
 v_cvt_pk_bf16_f32 v23, v78, v79
 ds_write_b128 v2, v[20:23] offset:1024
 v_mul_f32 v80, s50, v80
 v_mul_f32 v81, s50, v81
 v_mul_f32 v82, s50, v82
 v_mul_f32 v83, s50, v83
 v_mul_f32 v88, s50, v88
 v_mul_f32 v89, s50, v89
 v_mul_f32 v90, s50, v90
 v_mul_f32 v91, s50, v91
 v_cvt_pk_bf16_f32 v24, v80, v81
 v_cvt_pk_bf16_f32 v25, v88, v89
 v_cvt_pk_bf16_f32 v26, v82, v83
 v_cvt_pk_bf16_f32 v27, v90, v91
 ds_write_b128 v2, v[24:27] offset:8192
 v_mul_f32 v84, s50, v84
 v_mul_f32 v85, s50, v85
 v_mul_f32 v86, s50, v86
 v_mul_f32 v87, s50, v87
 v_mul_f32 v92, s50, v92
 v_mul_f32 v93, s50, v93
 v_mul_f32 v94, s50, v94
 v_mul_f32 v95, s50, v95
 v_cvt_pk_bf16_f32 v28, v84, v85
 v_cvt_pk_bf16_f32 v29, v92, v93
 v_cvt_pk_bf16_f32 v30, v86, v87
 v_cvt_pk_bf16_f32 v31, v94, v95
 ds_write_b128 v2, v[28:31] offset:9216
 v_mov_b64 v[120:121], 0
 v_mov_b64 v[122:123], 0
 s_waitcnt lgkmcnt(0)
 s_barrier
 ds_read_b128 v[96:99], v3 offset:0
 ds_read_b128 v[100:103], v3 offset:2048
 ds_read_b128 v[104:107], v3 offset:4096
 ds_read_b128 v[108:111], v3 offset:6144
 s_cmp_lg_u32 s64, 0
 s_cbranch_scc1 Lqpre_26
Lqs_27:
 buffer_load_dword v16, v15, s[20:23], s57 offen sc1
 s_waitcnt vmcnt(0)
 v_cmp_le_u32 vcc, s60, v16
 s_cbranch_vccnz Lqsk_28
 s_sleep 2
 s_sub_u32 s58, s58, 1
 s_cbranch_scc0 Lqs_27
 s_endpgm
Lqsk_28:
 buffer_load_dwordx4 v[192:195], v1, s[20:23], s55 offen offset:0 sc1
 buffer_load_dwordx4 v[196:199], v1, s[20:23], s55 offen offset:1024 sc1
 buffer_load_dwordx4 v[200:203], v1, s[20:23], s55 offen offset:2048 sc1
 buffer_load_dwordx4 v[204:207], v1, s[20:23], s55 offen offset:3072 sc1
Lqpre_26:
 s_waitcnt vmcnt(4) lgkmcnt(0)
 v_mfma_f32_16x16x32_bf16 v[112:115], v[128:131], v[96:99], v[208:211]
 v_mfma_f32_16x16x32_bf16 v[116:119], v[132:135], v[96:99], v[212:215]
 v_mfma_f32_16x16x32_bf16 v[112:115], v[136:139], v[100:103], v[112:115]
 v_mfma_f32_16x16x32_bf16 v[116:119], v[140:143], v[100:103], v[116:119]
 v_mfma_f32_16x16x32_bf16 v[112:115], v[144:147], v[104:107], v[112:115]
 v_mfma_f32_16x16x32_bf16 v[116:119], v[148:151], v[104:107], v[116:119]
 v_mfma_f32_16x16x32_bf16 v[112:115], v[152:155], v[108:111], v[112:115]
 v_mfma_f32_16x16x32_bf16 v[116:119], v[156:159], v[108:111], v[116:119]
 s_nop 7
 v_max3_f32 v24, v112, v113, v114
 v_max3_f32 v24, v24, v115, v116
 v_max3_f32 v24, v24, v117, v118
 v_max_f32 v24, v24, v119
 s_waitcnt vmcnt(2)
 v_mov_b64 v[16:17], v[192:193]
 v_mov_b64 v[18:19], v[196:197]
 s_nop 1
 v_smfmac_f32_16x16x64_bf16 v[120:123], v[16:19], v[96:103], v12
 s_waitcnt vmcnt(0)
 v_mov_b64 v[20:21], v[200:201]
 v_mov_b64 v[22:23], v[204:205]
 s_nop 1
 v_smfmac_f32_16x16x64_bf16 v[120:123], v[20:23], v[104:111], v12
 s_nop 7
 v_add_f32 v120, v120, v122
 v_add_f32 v121, v121, v123
 v_max3_f32 v24, v24, v120, v121
 v_mov_b32 v25, v24
 s_nop 1
 v_permlane16_swap_b32 v24, v25
 v_max_f32 v24, v24, v25
 v_mov_b32 v25, v24
 s_nop 1
 v_permlane32_swap_b32 v24, v25
 v_max_f32 v24, v24, v25
 v_sub_f32 v112, v112, v24
 v_sub_f32 v113, v113, v24
 v_sub_f32 v114, v114, v24
 v_sub_f32 v115, v115, v24
 v_sub_f32 v116, v116, v24
 v_sub_f32 v117, v117, v24
 v_sub_f32 v118, v118, v24
 v_sub_f32 v119, v119, v24
 v_sub_f32 v120, v120, v24
 v_sub_f32 v121, v121, v24
 v_exp_f32 v120, v120
 v_exp_f32 v121, v121
 v_exp_f32 v112, v112
 v_exp_f32 v113, v113
 v_exp_f32 v114, v114
 v_exp_f32 v115, v115
 v_exp_f32 v116, v116
 v_exp_f32 v117, v117
 v_exp_f32 v118, v118
 v_exp_f32 v119, v119
 v_cvt_pk_bf16_f32 v216, v120, v121
 v_cvt_pk_bf16_f32 v219, v120, v121
 v_cvt_pk_bf16_f32 v28, v112, v113
 v_cvt_pk_bf16_f32 v29, v116, v117
 v_cvt_pk_bf16_f32 v30, v114, v115
 v_cvt_pk_bf16_f32 v31, v118, v119
 v_mfma_f32_16x16x16_bf16 v[124:127], v[220:221], v[216:217], 0
 v_mfma_f32_16x16x16_bf16 v[64:67], v[194:195], v[216:217], 0
 v_mfma_f32_16x16x16_bf16 v[68:71], v[194:195], v[218:219], 0
 v_mfma_f32_16x16x16_bf16 v[72:75], v[198:199], v[216:217], 0
 v_mfma_f32_16x16x16_bf16 v[76:79], v[198:199], v[218:219], 0
 v_mfma_f32_16x16x16_bf16 v[80:83], v[202:203], v[216:217], 0
 v_mfma_f32_16x16x16_bf16 v[84:87], v[202:203], v[218:219], 0
 v_mfma_f32_16x16x16_bf16 v[88:91], v[206:207], v[216:217], 0
 v_mfma_f32_16x16x16_bf16 v[92:95], v[206:207], v[218:219], 0
 v_mfma_f32_16x16x32_bf16 v[124:127], v[220:223], v[28:31], v[124:127]
 v_mfma_f32_16x16x32_bf16 v[64:67], v[160:163], v[28:31], v[64:67]
 v_mfma_f32_16x16x32_bf16 v[68:71], v[164:167], v[28:31], v[68:71]
 v_mfma_f32_16x16x32_bf16 v[72:75], v[168:171], v[28:31], v[72:75]
 v_mfma_f32_16x16x32_bf16 v[76:79], v[172:175], v[28:31], v[76:79]
 v_mfma_f32_16x16x32_bf16 v[80:83], v[176:179], v[28:31], v[80:83]
 v_mfma_f32_16x16x32_bf16 v[84:87], v[180:183], v[28:31], v[84:87]
 v_mfma_f32_16x16x32_bf16 v[88:91], v[184:187], v[28:31], v[88:91]
 v_mfma_f32_16x16x32_bf16 v[92:95], v[188:191], v[28:31], v[92:95]
 v_rcp_f32 v124, v124
 s_add_u32 s45, s56, 4096
 v_mul_f32 v64, v64, v124
 v_mul_f32 v65, v65, v124
 v_mul_f32 v66, v66, v124
 v_mul_f32 v67, v67, v124
 v_mul_f32 v68, v68, v124
 v_mul_f32 v69, v69, v124
 v_mul_f32 v70, v70, v124
 v_mul_f32 v71, v71, v124
 v_cvt_pk_bf16_f32 v96, v64, v65
 v_cvt_pk_bf16_f32 v97, v68, v69
 v_cvt_pk_bf16_f32 v98, v66, v67
 v_cvt_pk_bf16_f32 v99, v70, v71
 buffer_store_dwordx4 v[96:99], v1, s[20:23], s56 offen offset:0 sc1
 v_mul_f32 v72, v72, v124
 v_mul_f32 v73, v73, v124
 v_mul_f32 v74, v74, v124
 v_mul_f32 v75, v75, v124
 v_mul_f32 v76, v76, v124
 v_mul_f32 v77, v77, v124
 v_mul_f32 v78, v78, v124
 v_mul_f32 v79, v79, v124
 v_cvt_pk_bf16_f32 v100, v72, v73
 v_cvt_pk_bf16_f32 v101, v76, v77
 v_cvt_pk_bf16_f32 v102, v74, v75
 v_cvt_pk_bf16_f32 v103, v78, v79
 buffer_store_dwordx4 v[100:103], v1, s[20:23], s56 offen offset:2048 sc1
 v_mul_f32 v80, v80, v124
 v_mul_f32 v81, v81, v124
 v_mul_f32 v82, v82, v124
 v_mul_f32 v83, v83, v124
 v_mul_f32 v84, v84, v124
 v_mul_f32 v85, v85, v124
 v_mul_f32 v86, v86, v124
 v_mul_f32 v87, v87, v124
 v_cvt_pk_bf16_f32 v104, v80, v81
 v_cvt_pk_bf16_f32 v105, v84, v85
 v_cvt_pk_bf16_f32 v106, v82, v83
 v_cvt_pk_bf16_f32 v107, v86, v87
 buffer_store_dwordx4 v[104:107], v1, s[20:23], s45 offen offset:0 sc1
 v_mul_f32 v88, v88, v124
 v_mul_f32 v89, v89, v124
 v_mul_f32 v90, v90, v124
 v_mul_f32 v91, v91, v124
 v_mul_f32 v92, v92, v124
 v_mul_f32 v93, v93, v124
 v_mul_f32 v94, v94, v124
 v_mul_f32 v95, v95, v124
 v_cvt_pk_bf16_f32 v108, v88, v89
 v_cvt_pk_bf16_f32 v109, v92, v93
 v_cvt_pk_bf16_f32 v110, v90, v91
 v_cvt_pk_bf16_f32 v111, v94, v95
 buffer_store_dwordx4 v[108:111], v1, s[20:23], s45 offen offset:2048 sc1
 v_mfma_f32_16x16x32_bf16 v[64:67], a[0:3], v[48:51], 0
 ds_read_b128 v[32:35], v6 offset:4096
 v_mfma_f32_16x16x32_bf16 v[72:75], a[72:75], v[48:51], 0
 ds_read_b128 v[36:39], v6 offset:6144
 v_mfma_f32_16x16x32_bf16 v[80:83], a[144:147], v[48:51], 0
 s_add_u32 s41, s40, 2
 v_mfma_f32_16x16x32_bf16 v[88:91], a[216:219], v[48:51], 0
 s_add_u32 s45, s42, 2
 s_mul_i32 s46, s41, 36864
 v_mfma_f32_16x16x32_bf16 v[68:71], a[0:3], v[52:55], 0
 s_cmp_lt_u32 s45, s36
 s_cselect_b32 s46, s46, 0
 v_mfma_f32_16x16x32_bf16 v[76:79], a[72:75], v[52:55], 0
 s_lshl_b32 s49, s4, 10
 s_add_u32 s49, s49, s44
 v_mfma_f32_16x16x32_bf16 v[84:87], a[144:147], v[52:55], 0
 s_lshl_b32 s53, s39, 19
 s_add_u32 s53, s53, s61
 v_mfma_f32_16x16x32_bf16 v[92:95], a[216:219], v[52:55], 0
 s_waitcnt lgkmcnt(2)
 v_mfma_f32_16x16x32_bf16 v[64:67], a[4:7], v[56:59], v[64:67]
 ds_read_b128 v[40:43], v7 offset:4096
 v_mfma_f32_16x16x32_bf16 v[72:75], a[76:79], v[56:59], v[72:75]
 ds_read_b128 v[44:47], v7 offset:6144
 v_mfma_f32_16x16x32_bf16 v[80:83], a[148:151], v[56:59], v[80:83]
 s_add_u32 m0, s49, 0
 v_mfma_f32_16x16x32_bf16 v[88:91], a[220:223], v[56:59], v[88:91]
 buffer_load_dwordx4 v10, s[8:11], s46 offen offset:0  lds
 v_mfma_f32_16x16x32_bf16 v[68:71], a[4:7], v[60:63], v[68:71]
 s_add_u32 m0, s49, 3968
 v_mfma_f32_16x16x32_bf16 v[76:79], a[76:79], v[60:63], v[76:79]
 buffer_load_dwordx4 v10, s[8:11], s46 offen offset:128  lds
 v_mfma_f32_16x16x32_bf16 v[84:87], a[148:151], v[60:63], v[84:87]
 s_lshl_b32 s55, s39, 17
 s_add_u32 s55, s55, s62
 v_mfma_f32_16x16x32_bf16 v[92:95], a[220:223], v[60:63], v[92:95]
 s_waitcnt lgkmcnt(2)
 v_mfma_f32_16x16x32_bf16 v[64:67], a[8:11], v[32:35], v[64:67]
 ds_read_b128 v[48:51], v6 offset:8192
 v_mfma_f32_16x16x32_bf16 v[72:75], a[80:83], v[32:35], v[72:75]
 ds_read_b128 v[52:55], v6 offset:10240
 v_mfma_f32_16x16x32_bf16 v[80:83], a[152:155], v[32:35], v[80:83]
 s_add_u32 m0, s49, 7936
 v_mfma_f32_16x16x32_bf16 v[88:91], a[224:227], v[32:35], v[88:91]
 buffer_load_dwordx4 v10, s[8:11], s46 offen offset:256  lds
 v_mfma_f32_16x16x32_bf16 v[68:71], a[8:11], v[36:39], v[68:71]
 s_add_u32 m0, s49, 11904
 v_mfma_f32_16x16x32_bf16 v[76:79], a[80:83], v[36:39], v[76:79]
 buffer_load_dwordx4 v10, s[8:11], s46 offen offset:384  lds
 v_mfma_f32_16x16x32_bf16 v[84:87], a[152:155], v[36:39], v[84:87]
 v_mfma_f32_16x16x32_bf16 v[92:95], a[224:227], v[36:39], v[92:95]
 s_waitcnt lgkmcnt(2)
 v_mfma_f32_16x16x32_bf16 v[64:67], a[12:15], v[40:43], v[64:67]
 ds_read_b128 v[56:59], v7 offset:8192
 v_mfma_f32_16x16x32_bf16 v[72:75], a[84:87], v[40:43], v[72:75]
 ds_read_b128 v[60:63], v7 offset:10240
 v_mfma_f32_16x16x32_bf16 v[80:83], a[156:159], v[40:43], v[80:83]
 s_add_u32 m0, s49, 15872
 v_mfma_f32_16x16x32_bf16 v[88:91], a[228:231], v[40:43], v[88:91]
 buffer_load_dwordx4 v10, s[8:11], s46 offen offset:512  lds
 v_mfma_f32_16x16x32_bf16 v[68:71], a[12:15], v[44:47], v[68:71]
 s_add_u32 m0, s49, 19840
 v_mfma_f32_16x16x32_bf16 v[76:79], a[84:87], v[44:47], v[76:79]
 buffer_load_dwordx4 v10, s[8:11], s46 offen offset:640  lds
 v_mfma_f32_16x16x32_bf16 v[84:87], a[156:159], v[44:47], v[84:87]
 s_add_u32 s60, s39, 1
 v_mfma_f32_16x16x32_bf16 v[92:95], a[228:231], v[44:47], v[92:95]
 s_waitcnt lgkmcnt(2)
 v_mfma_f32_16x16x32_bf16 v[64:67], a[16:19], v[48:51], v[64:67]
 ds_read_b128 v[32:35], v6 offset:12288
 v_mfma_f32_16x16x32_bf16 v[72:75], a[88:91], v[48:51], v[72:75]
 ds_read_b128 v[36:39], v6 offset:14336
 v_mfma_f32_16x16x32_bf16 v[80:83], a[160:163], v[48:51], v[80:83]
 s_add_u32 m0, s49, 23808
 v_mfma_f32_16x16x32_bf16 v[88:91], a[232:235], v[48:51], v[88:91]
 buffer_load_dwordx4 v10, s[8:11], s46 offen offset:768  lds
 v_mfma_f32_16x16x32_bf16 v[68:71], a[16:19], v[52:55], v[68:71]
 s_add_u32 m0, s49, 27776
 v_mfma_f32_16x16x32_bf16 v[76:79], a[88:91], v[52:55], v[76:79]
 buffer_load_dwordx4 v10, s[8:11], s46 offen offset:896  lds
 v_mfma_f32_16x16x32_bf16 v[84:87], a[160:163], v[52:55], v[84:87]
 v_mfma_f32_16x16x32_bf16 v[92:95], a[232:235], v[52:55], v[92:95]
 s_waitcnt lgkmcnt(2)
 v_mfma_f32_16x16x32_bf16 v[64:67], a[20:23], v[56:59], v[64:67]
 ds_read_b128 v[40:43], v7 offset:12288
 v_mfma_f32_16x16x32_bf16 v[72:75], a[92:95], v[56:59], v[72:75]
 ds_read_b128 v[44:47], v7 offset:14336
 v_mfma_f32_16x16x32_bf16 v[80:83], a[164:167], v[56:59], v[80:83]
 s_add_u32 m0, s49, 31744
 v_mfma_f32_16x16x32_bf16 v[88:91], a[236:239], v[56:59], v[88:91]
 buffer_load_dwordx4 v10, s[8:11], s46 offen offset:1024  lds
 v_mfma_f32_16x16x32_bf16 v[68:71], a[20:23], v[60:63], v[68:71]
 v_mfma_f32_16x16x32_bf16 v[76:79], a[92:95], v[60:63], v[76:79]
 v_mfma_f32_16x16x32_bf16 v[84:87], a[164:167], v[60:63], v[84:87]
 v_mfma_f32_16x16x32_bf16 v[92:95], a[236:239], v[60:63], v[92:95]
 s_waitcnt lgkmcnt(2)
 v_mfma_f32_16x16x32_bf16 v[64:67], a[24:27], v[32:35], v[64:67]
 ds_read_b128 v[48:51], v6 offset:16384
 v_mfma_f32_16x16x32_bf16 v[72:75], a[96:99], v[32:35], v[72:75]
 ds_read_b128 v[52:55], v6 offset:18432
 v_mfma_f32_16x16x32_bf16 v[80:83], a[168:171], v[32:35], v[80:83]
 s_waitcnt vmcnt(9)
 buffer_load_dword v17, v11, s[20:23], s56 offen sc1
 v_mfma_f32_16x16x32_bf16 v[88:91], a[240:243], v[32:35], v[88:91]
 s_barrier
 buffer_store_dword v14, v8, s[20:23], s59 offen sc1
 v_mfma_f32_16x16x32_bf16 v[68:71], a[24:27], v[36:39], v[68:71]
 buffer_load_dword v16, v15, s[20:23], s57 offen sc1
 v_mfma_f32_16x16x32_bf16 v[76:79], a[96:99], v[36:39], v[76:79]
 v_mfma_f32_16x16x32_bf16 v[84:87], a[168:171], v[36:39], v[84:87]
 s_lshl_b32 s56, s39, 18
 s_add_u32 s56, s56, s63
 v_mfma_f32_16x16x32_bf16 v[92:95], a[240:243], v[36:39], v[92:95]
 s_waitcnt lgkmcnt(2)
 v_mfma_f32_16x16x32_bf16 v[64:67], a[28:31], v[40:43], v[64:67]
 ds_read_b128 v[56:59], v7 offset:16384
 v_mfma_f32_16x16x32_bf16 v[72:75], a[100:103], v[40:43], v[72:75]
 ds_read_b128 v[60:63], v7 offset:18432
 v_mfma_f32_16x16x32_bf16 v[80:83], a[172:175], v[40:43], v[80:83]
 buffer_load_dwordx4 v[128:131], v1, s[20:23], s53 offen offset:0 sc1
 v_mfma_f32_16x16x32_bf16 v[88:91], a[244:247], v[40:43], v[88:91]
 v_mfma_f32_16x16x32_bf16 v[68:71], a[28:31], v[44:47], v[68:71]
 buffer_load_dwordx4 v[132:135], v1, s[20:23], s53 offen offset:1024 sc1
 v_mfma_f32_16x16x32_bf16 v[76:79], a[100:103], v[44:47], v[76:79]
 v_mfma_f32_16x16x32_bf16 v[84:87], a[172:175], v[44:47], v[84:87]
 v_mfma_f32_16x16x32_bf16 v[92:95], a[244:247], v[44:47], v[92:95]
 s_waitcnt lgkmcnt(2)
 v_mfma_f32_16x16x32_bf16 v[64:67], a[32:35], v[48:51], v[64:67]
 ds_read_b128 v[32:35], v6 offset:20480
 v_mfma_f32_16x16x32_bf16 v[72:75], a[104:107], v[48:51], v[72:75]
 ds_read_b128 v[36:39], v6 offset:22528
 v_mfma_f32_16x16x32_bf16 v[80:83], a[176:179], v[48:51], v[80:83]
 buffer_load_dwordx4 v[136:139], v1, s[20:23], s53 offen offset:2048 sc1
 v_mfma_f32_16x16x32_bf16 v[88:91], a[248:251], v[48:51], v[88:91]
 v_mfma_f32_16x16x32_bf16 v[68:71], a[32:35], v[52:55], v[68:71]
 buffer_load_dwordx4 v[140:143], v1, s[20:23], s53 offen offset:3072 sc1
 v_mfma_f32_16x16x32_bf16 v[76:79], a[104:107], v[52:55], v[76:79]
 v_mfma_f32_16x16x32_bf16 v[84:87], a[176:179], v[52:55], v[84:87]
 s_add_u32 s53, s53, 4096
 v_mfma_f32_16x16x32_bf16 v[92:95], a[248:251], v[52:55], v[92:95]
 s_waitcnt lgkmcnt(2)
 v_mfma_f32_16x16x32_bf16 v[64:67], a[36:39], v[56:59], v[64:67]
 ds_read_b128 v[40:43], v7 offset:20480
 v_mfma_f32_16x16x32_bf16 v[72:75], a[108:111], v[56:59], v[72:75]
 ds_read_b128 v[44:47], v7 offset:22528
 v_mfma_f32_16x16x32_bf16 v[80:83], a[180:183], v[56:59], v[80:83]
 buffer_load_dwordx4 v[144:147], v1, s[20:23], s53 offen offset:0 sc1
 v_mfma_f32_16x16x32_bf16 v[88:91], a[252:255], v[56:59], v[88:91]
 v_mfma_f32_16x16x32_bf16 v[68:71], a[36:39], v[60:63], v[68:71]
 buffer_load_dwordx4 v[148:151], v1, s[20:23], s53 offen offset:1024 sc1
 v_mfma_f32_16x16x32_bf16 v[76:79], a[108:111], v[60:63], v[76:79]
 v_mfma_f32_16x16x32_bf16 v[84:87], a[180:183], v[60:63], v[84:87]
 v_mfma_f32_16x16x32_bf16 v[92:95], a[252:255], v[60:63], v[92:95]
 s_waitcnt lgkmcnt(2)
 v_mfma_f32_16x16x32_bf16 v[64:67], a[40:43], v[32:35], v[64:67]
 ds_read_b128 v[48:51], v6 offset:24576
 v_mfma_f32_16x16x32_bf16 v[72:75], a[112:115], v[32:35], v[72:75]
 ds_read_b128 v[52:55], v6 offset:26624
 v_mfma_f32_16x16x32_bf16 v[80:83], a[184:187], v[32:35], v[80:83]
 buffer_load_dwordx4 v[152:155], v1, s[20:23], s53 offen offset:2048 sc1
 v_mfma_f32_16x16x32_bf16 v[88:91], v[224:227], v[32:35], v[88:91]
 v_mfma_f32_16x16x32_bf16 v[68:71], a[40:43], v[36:39], v[68:71]
 buffer_load_dwordx4 v[156:159], v1, s[20:23], s53 offen offset:3072 sc1
 v_mfma_f32_16x16x32_bf16 v[76:79], a[112:115], v[36:39], v[76:79]
 v_mfma_f32_16x16x32_bf16 v[84:87], a[184:187], v[36:39], v[84:87]
 s_add_u32 s53, s53, 4096
 v_mfma_f32_16x16x32_bf16 v[92:95], v[224:227], v[36:39], v[92:95]
 s_waitcnt lgkmcnt(2)
 v_mfma_f32_16x16x32_bf16 v[64:67], a[44:47], v[40:43], v[64:67]
 ds_read_b128 v[56:59], v7 offset:24576
 v_mfma_f32_16x16x32_bf16 v[72:75], a[116:119], v[40:43], v[72:75]
 ds_read_b128 v[60:63], v7 offset:26624
 v_mfma_f32_16x16x32_bf16 v[80:83], a[188:191], v[40:43], v[80:83]
 buffer_load_dwordx4 v[160:163], v1, s[20:23], s53 offen offset:0 sc1
 v_mfma_f32_16x16x32_bf16 v[88:91], v[228:231], v[40:43], v[88:91]
 v_mfma_f32_16x16x32_bf16 v[68:71], a[44:47], v[44:47], v[68:71]
 buffer_load_dwordx4 v[164:167], v1, s[20:23], s53 offen offset:1024 sc1
 v_mfma_f32_16x16x32_bf16 v[76:79], a[116:119], v[44:47], v[76:79]
 v_mfma_f32_16x16x32_bf16 v[84:87], a[188:191], v[44:47], v[84:87]
 v_mfma_f32_16x16x32_bf16 v[92:95], v[228:231], v[44:47], v[92:95]
 s_waitcnt lgkmcnt(2)
 v_mfma_f32_16x16x32_bf16 v[64:67], a[48:51], v[48:51], v[64:67]
 ds_read_b128 v[32:35], v6 offset:28672
 v_mfma_f32_16x16x32_bf16 v[72:75], a[120:123], v[48:51], v[72:75]
 ds_read_b128 v[36:39], v6 offset:30720
 v_mfma_f32_16x16x32_bf16 v[80:83], a[192:195], v[48:51], v[80:83]
 buffer_load_dwordx4 v[168:171], v1, s[20:23], s53 offen offset:2048 sc1
 v_mfma_f32_16x16x32_bf16 v[88:91], v[232:235], v[48:51], v[88:91]
 v_mfma_f32_16x16x32_bf16 v[68:71], a[48:51], v[52:55], v[68:71]
 buffer_load_dwordx4 v[172:175], v1, s[20:23], s53 offen offset:3072 sc1
 v_mfma_f32_16x16x32_bf16 v[76:79], a[120:123], v[52:55], v[76:79]
 v_mfma_f32_16x16x32_bf16 v[84:87], a[192:195], v[52:55], v[84:87]
 s_add_u32 s53, s53, 4096
 v_mfma_f32_16x16x32_bf16 v[92:95], v[232:235], v[52:55], v[92:95]
 s_waitcnt lgkmcnt(2)
 v_mfma_f32_16x16x32_bf16 v[64:67], a[52:55], v[56:59], v[64:67]
 ds_read_b128 v[40:43], v7 offset:28672
 v_mfma_f32_16x16x32_bf16 v[72:75], a[124:127], v[56:59], v[72:75]
 ds_read_b128 v[44:47], v7 offset:30720
 v_mfma_f32_16x16x32_bf16 v[80:83], a[196:199], v[56:59], v[80:83]
 s_add_u32 s43, s43, 36864
 s_cmp_eq_u32 s43, 147456
 buffer_load_dwordx4 v[176:179], v1, s[20:23], s53 offen offset:0 sc1
 v_mfma_f32_16x16x32_bf16 v[88:91], v[236:239], v[56:59], v[88:91]
 s_cselect_b32 s43, 0, s43
 s_add_u32 s44, s44, 36864
 v_mfma_f32_16x16x32_bf16 v[68:71], a[52:55], v[60:63], v[68:71]
 s_cmp_eq_u32 s44, 147456
 s_cselect_b32 s44, 0, s44
 buffer_load_dwordx4 v[180:183], v1, s[20:23], s53 offen offset:1024 sc1
 v_mfma_f32_16x16x32_bf16 v[76:79], a[124:127], v[60:63], v[76:79]
 v_mfma_f32_16x16x32_bf16 v[84:87], a[196:199], v[60:63], v[84:87]
 v_mfma_f32_16x16x32_bf16 v[92:95], v[236:239], v[60:63], v[92:95]
 s_waitcnt lgkmcnt(2)
 v_mfma_f32_16x16x32_bf16 v[64:67], a[56:59], v[32:35], v[64:67]
 ds_read_b128 v[48:51], v6 offset:32768
 v_mfma_f32_16x16x32_bf16 v[72:75], a[128:131], v[32:35], v[72:75]
 ds_read_b128 v[52:55], v6 offset:34816
 v_mfma_f32_16x16x32_bf16 v[80:83], a[200:203], v[32:35], v[80:83]
 v_add_u32 v6, s43, v4
 buffer_load_dwordx4 v[184:187], v1, s[20:23], s53 offen offset:2048 sc1
 v_mfma_f32_16x16x32_bf16 v[88:91], v[240:243], v[32:35], v[88:91]
 v_mfma_f32_16x16x32_bf16 v[68:71], a[56:59], v[36:39], v[68:71]
 buffer_load_dwordx4 v[188:191], v1, s[20:23], s53 offen offset:3072 sc1
 v_mfma_f32_16x16x32_bf16 v[76:79], a[128:131], v[36:39], v[76:79]
 v_mfma_f32_16x16x32_bf16 v[84:87], a[200:203], v[36:39], v[84:87]
 v_mfma_f32_16x16x32_bf16 v[92:95], v[240:243], v[36:39], v[92:95]
 s_waitcnt lgkmcnt(2)
 v_mfma_f32_16x16x32_bf16 v[64:67], a[60:63], v[40:43], v[64:67]
 ds_read_b128 v[56:59], v7 offset:32768
 v_mfma_f32_16x16x32_bf16 v[72:75], a[132:135], v[40:43], v[72:75]
 ds_read_b128 v[60:63], v7 offset:34816
 v_mfma_f32_16x16x32_bf16 v[80:83], a[204:207], v[40:43], v[80:83]
 v_add_u32 v7, s43, v5
 v_mfma_f32_16x16x32_bf16 v[88:91], v[244:247], v[40:43], v[88:91]
 v_mfma_f32_16x16x32_bf16 v[68:71], a[60:63], v[44:47], v[68:71]
 v_mfma_f32_16x16x32_bf16 v[76:79], a[132:135], v[44:47], v[76:79]
 v_mfma_f32_16x16x32_bf16 v[84:87], a[204:207], v[44:47], v[84:87]
 v_mfma_f32_16x16x32_bf16 v[92:95], v[244:247], v[44:47], v[92:95]
 s_waitcnt lgkmcnt(2)
 v_mfma_f32_16x16x32_bf16 v[64:67], a[64:67], v[48:51], v[64:67]
 s_waitcnt vmcnt(28)
 s_barrier
 ds_read_b128 v[32:35], v6 offset:0
 v_mfma_f32_16x16x32_bf16 v[72:75], a[136:139], v[48:51], v[72:75]
 ds_read_b128 v[36:39], v6 offset:2048
 v_mfma_f32_16x16x32_bf16 v[80:83], a[208:211], v[48:51], v[80:83]
 v_mfma_f32_16x16x32_bf16 v[88:91], v[248:251], v[48:51], v[88:91]
 s_waitcnt vmcnt(16)
 v_cmp_le_u32 vcc, s60, v16
 v_mfma_f32_16x16x32_bf16 v[68:71], a[64:67], v[52:55], v[68:71]
 v_mfma_f32_16x16x32_bf16 v[76:79], a[136:139], v[52:55], v[76:79]
 s_and_b32 s64, vcc_lo, 1
 s_cbranch_scc0 Lqsk_29
 buffer_load_dwordx4 v[192:195], v1, s[20:23], s55 offen offset:0 sc1
 buffer_load_dwordx4 v[196:199], v1, s[20:23], s55 offen offset:1024 sc1
 buffer_load_dwordx4 v[200:203], v1, s[20:23], s55 offen offset:2048 sc1
 buffer_load_dwordx4 v[204:207], v1, s[20:23], s55 offen offset:3072 sc1
Lqsk_29:
 v_mfma_f32_16x16x32_bf16 v[84:87], a[208:211], v[52:55], v[84:87]
 v_mfma_f32_16x16x32_bf16 v[92:95], v[248:251], v[52:55], v[92:95]
 s_waitcnt lgkmcnt(2)
 v_mfma_f32_16x16x32_bf16 v[64:67], a[68:71], v[56:59], v[64:67]
 ds_read_b128 v[40:43], v7 offset:0
 v_mfma_f32_16x16x32_bf16 v[72:75], a[140:143], v[56:59], v[72:75]
 ds_read_b128 v[44:47], v7 offset:2048
 v_mfma_f32_16x16x32_bf16 v[80:83], a[212:215], v[56:59], v[80:83]
 v_mfma_f32_16x16x32_bf16 v[88:91], v[252:255], v[56:59], v[88:91]
 s_mov_b32 s39, s40
 s_mov_b32 s40, s41
 v_mfma_f32_16x16x32_bf16 v[68:71], a[68:71], v[60:63], v[68:71]
 s_add_u32 s42, s42, 1
 v_mov_b32 v14, s42
 v_mfma_f32_16x16x32_bf16 v[76:79], a[140:143], v[60:63], v[76:79]
 v_mfma_f32_16x16x32_bf16 v[84:87], a[212:215], v[60:63], v[84:87]
 v_mfma_f32_16x16x32_bf16 v[92:95], v[252:255], v[60:63], v[92:95]
 s_waitcnt lgkmcnt(2)
 s_nop 3
 v_mul_f32 v64, s50, v64
 v_mul_f32 v65, s50, v65
 v_mul_f32 v66, s50, v66
 v_mul_f32 v67, s50, v67
 v_mul_f32 v72, s50, v72
 v_mul_f32 v73, s50, v73
 v_mul_f32 v74, s50, v74
 v_mul_f32 v75, s50, v75
 v_cvt_pk_bf16_f32 v16, v64, v65
 v_cvt_pk_bf16_f32 v17, v72, v73
 v_cvt_pk_bf16_f32 v18, v66, v67
 v_cvt_pk_bf16_f32 v19, v74, v75
 ds_write_b128 v2, v[16:19] offset:0
 v_mul_f32 v68, s50, v68
 v_mul_f32 v69, s50, v69
 v_mul_f32 v70, s50, v70
 v_mul_f32 v71, s50, v71
 v_mul_f32 v76, s50, v76
 v_mul_f32 v77, s50, v77
 v_mul_f32 v78, s50, v78
 v_mul_f32 v79, s50, v79
 v_cvt_pk_bf16_f32 v20, v68, v69
 v_cvt_pk_bf16_f32 v21, v76, v77
 v_cvt_pk_bf16_f32 v22, v70, v71
 v_cvt_pk_bf16_f32 v23, v78, v79
 ds_write_b128 v2, v[20:23] offset:1024
 v_mul_f32 v80, s50, v80
 v_mul_f32 v81, s50, v81
 v_mul_f32 v82, s50, v82
 v_mul_f32 v83, s50, v83
 v_mul_f32 v88, s50, v88
 v_mul_f32 v89, s50, v89
 v_mul_f32 v90, s50, v90
 v_mul_f32 v91, s50, v91
 v_cvt_pk_bf16_f32 v24, v80, v81
 v_cvt_pk_bf16_f32 v25, v88, v89
 v_cvt_pk_bf16_f32 v26, v82, v83
 v_cvt_pk_bf16_f32 v27, v90, v91
 ds_write_b128 v2, v[24:27] offset:8192
 v_mul_f32 v84, s50, v84
 v_mul_f32 v85, s50, v85
 v_mul_f32 v86, s50, v86
 v_mul_f32 v87, s50, v87
 v_mul_f32 v92, s50, v92
 v_mul_f32 v93, s50, v93
 v_mul_f32 v94, s50, v94
 v_mul_f32 v95, s50, v95
 v_cvt_pk_bf16_f32 v28, v84, v85
 v_cvt_pk_bf16_f32 v29, v92, v93
 v_cvt_pk_bf16_f32 v30, v86, v87
 v_cvt_pk_bf16_f32 v31, v94, v95
 ds_write_b128 v2, v[28:31] offset:9216
 v_mov_b64 v[120:121], 0
 v_mov_b64 v[122:123], 0
 s_waitcnt lgkmcnt(0)
 s_barrier
 ds_read_b128 v[96:99], v3 offset:0
 ds_read_b128 v[100:103], v3 offset:2048
 ds_read_b128 v[104:107], v3 offset:4096
 ds_read_b128 v[108:111], v3 offset:6144
 s_cmp_lg_u32 s64, 0
 s_cbranch_scc1 Lqpre_30
Lqs_31:
 buffer_load_dword v16, v15, s[20:23], s57 offen sc1
 s_waitcnt vmcnt(0)
 v_cmp_le_u32 vcc, s60, v16
 s_cbranch_vccnz Lqsk_32
 s_sleep 2
 s_sub_u32 s58, s58, 1
 s_cbranch_scc0 Lqs_31
 s_endpgm
Lqsk_32:
 buffer_load_dwordx4 v[192:195], v1, s[20:23], s55 offen offset:0 sc1
 buffer_load_dwordx4 v[196:199], v1, s[20:23], s55 offen offset:1024 sc1
 buffer_load_dwordx4 v[200:203], v1, s[20:23], s55 offen offset:2048 sc1
 buffer_load_dwordx4 v[204:207], v1, s[20:23], s55 offen offset:3072 sc1
Lqpre_30:
 s_waitcnt vmcnt(4) lgkmcnt(0)
 v_mfma_f32_16x16x32_bf16 v[112:115], v[128:131], v[96:99], v[208:211]
 v_mfma_f32_16x16x32_bf16 v[116:119], v[132:135], v[96:99], v[212:215]
 v_mfma_f32_16x16x32_bf16 v[112:115], v[136:139], v[100:103], v[112:115]
 v_mfma_f32_16x16x32_bf16 v[116:119], v[140:143], v[100:103], v[116:119]
 v_mfma_f32_16x16x32_bf16 v[112:115], v[144:147], v[104:107], v[112:115]
 v_mfma_f32_16x16x32_bf16 v[116:119], v[148:151], v[104:107], v[116:119]
 v_mfma_f32_16x16x32_bf16 v[112:115], v[152:155], v[108:111], v[112:115]
 v_mfma_f32_16x16x32_bf16 v[116:119], v[156:159], v[108:111], v[116:119]
 s_nop 7
 v_max3_f32 v24, v112, v113, v114
 v_max3_f32 v24, v24, v115, v116
 v_max3_f32 v24, v24, v117, v118
 v_max_f32 v24, v24, v119
 s_waitcnt vmcnt(2)
 v_mov_b64 v[16:17], v[192:193]
 v_mov_b64 v[18:19], v[196:197]
 s_nop 1
 v_smfmac_f32_16x16x64_bf16 v[120:123], v[16:19], v[96:103], v12
 s_waitcnt vmcnt(0)
 v_mov_b64 v[20:21], v[200:201]
 v_mov_b64 v[22:23], v[204:205]
 s_nop 1
 v_smfmac_f32_16x16x64_bf16 v[120:123], v[20:23], v[104:111], v12
 s_nop 7
 v_add_f32 v120, v120, v122
 v_add_f32 v121, v121, v123
 v_max3_f32 v24, v24, v120, v121
 v_mov_b32 v25, v24
 s_nop 1
 v_permlane16_swap_b32 v24, v25
 v_max_f32 v24, v24, v25
 v_mov_b32 v25, v24
 s_nop 1
 v_permlane32_swap_b32 v24, v25
 v_max_f32 v24, v24, v25
 v_sub_f32 v112, v112, v24
 v_sub_f32 v113, v113, v24
 v_sub_f32 v114, v114, v24
 v_sub_f32 v115, v115, v24
 v_sub_f32 v116, v116, v24
 v_sub_f32 v117, v117, v24
 v_sub_f32 v118, v118, v24
 v_sub_f32 v119, v119, v24
 v_sub_f32 v120, v120, v24
 v_sub_f32 v121, v121, v24
 v_exp_f32 v120, v120
 v_exp_f32 v121, v121
 v_exp_f32 v112, v112
 v_exp_f32 v113, v113
 v_exp_f32 v114, v114
 v_exp_f32 v115, v115
 v_exp_f32 v116, v116
 v_exp_f32 v117, v117
 v_exp_f32 v118, v118
 v_exp_f32 v119, v119
 v_cvt_pk_bf16_f32 v216, v120, v121
 v_cvt_pk_bf16_f32 v219, v120, v121
 v_cvt_pk_bf16_f32 v28, v112, v113
 v_cvt_pk_bf16_f32 v29, v116, v117
 v_cvt_pk_bf16_f32 v30, v114, v115
 v_cvt_pk_bf16_f32 v31, v118, v119
 v_mfma_f32_16x16x16_bf16 v[124:127], v[220:221], v[216:217], 0
 v_mfma_f32_16x16x16_bf16 v[64:67], v[194:195], v[216:217], 0
 v_mfma_f32_16x16x16_bf16 v[68:71], v[194:195], v[218:219], 0
 v_mfma_f32_16x16x16_bf16 v[72:75], v[198:199], v[216:217], 0
 v_mfma_f32_16x16x16_bf16 v[76:79], v[198:199], v[218:219], 0
 v_mfma_f32_16x16x16_bf16 v[80:83], v[202:203], v[216:217], 0
 v_mfma_f32_16x16x16_bf16 v[84:87], v[202:203], v[218:219], 0
 v_mfma_f32_16x16x16_bf16 v[88:91], v[206:207], v[216:217], 0
 v_mfma_f32_16x16x16_bf16 v[92:95], v[206:207], v[218:219], 0
 v_mfma_f32_16x16x32_bf16 v[124:127], v[220:223], v[28:31], v[124:127]
 v_mfma_f32_16x16x32_bf16 v[64:67], v[160:163], v[28:31], v[64:67]
 v_mfma_f32_16x16x32_bf16 v[68:71], v[164:167], v[28:31], v[68:71]
 v_mfma_f32_16x16x32_bf16 v[72:75], v[168:171], v[28:31], v[72:75]
 v_mfma_f32_16x16x32_bf16 v[76:79], v[172:175], v[28:31], v[76:79]
 v_mfma_f32_16x16x32_bf16 v[80:83], v[176:179], v[28:31], v[80:83]
 v_mfma_f32_16x16x32_bf16 v[84:87], v[180:183], v[28:31], v[84:87]
 v_mfma_f32_16x16x32_bf16 v[88:91], v[184:187], v[28:31], v[88:91]
 v_mfma_f32_16x16x32_bf16 v[92:95], v[188:191], v[28:31], v[92:95]
 v_rcp_f32 v124, v124
 s_add_u32 s45, s56, 4096
 v_mul_f32 v64, v64, v124
 v_mul_f32 v65, v65, v124
 v_mul_f32 v66, v66, v124
 v_mul_f32 v67, v67, v124
 v_mul_f32 v68, v68, v124
 v_mul_f32 v69, v69, v124
 v_mul_f32 v70, v70, v124
 v_mul_f32 v71, v71, v124
 v_cvt_pk_bf16_f32 v96, v64, v65
 v_cvt_pk_bf16_f32 v97, v68, v69
 v_cvt_pk_bf16_f32 v98, v66, v67
 v_cvt_pk_bf16_f32 v99, v70, v71
 buffer_store_dwordx4 v[96:99], v1, s[20:23], s56 offen offset:0 sc1
 v_mul_f32 v72, v72, v124
 v_mul_f32 v73, v73, v124
 v_mul_f32 v74, v74, v124
 v_mul_f32 v75, v75, v124
 v_mul_f32 v76, v76, v124
 v_mul_f32 v77, v77, v124
 v_mul_f32 v78, v78, v124
 v_mul_f32 v79, v79, v124
 v_cvt_pk_bf16_f32 v100, v72, v73
 v_cvt_pk_bf16_f32 v101, v76, v77
 v_cvt_pk_bf16_f32 v102, v74, v75
 v_cvt_pk_bf16_f32 v103, v78, v79
 buffer_store_dwordx4 v[100:103], v1, s[20:23], s56 offen offset:2048 sc1
 v_mul_f32 v80, v80, v124
 v_mul_f32 v81, v81, v124
 v_mul_f32 v82, v82, v124
 v_mul_f32 v83, v83, v124
 v_mul_f32 v84, v84, v124
 v_mul_f32 v85, v85, v124
 v_mul_f32 v86, v86, v124
 v_mul_f32 v87, v87, v124
 v_cvt_pk_bf16_f32 v104, v80, v81
 v_cvt_pk_bf16_f32 v105, v84, v85
 v_cvt_pk_bf16_f32 v106, v82, v83
 v_cvt_pk_bf16_f32 v107, v86, v87
 buffer_store_dwordx4 v[104:107], v1, s[20:23], s45 offen offset:0 sc1
 v_mul_f32 v88, v88, v124
 v_mul_f32 v89, v89, v124
 v_mul_f32 v90, v90, v124
 v_mul_f32 v91, v91, v124
 v_mul_f32 v92, v92, v124
 v_mul_f32 v93, v93, v124
 v_mul_f32 v94, v94, v124
 v_mul_f32 v95, v95, v124
 v_cvt_pk_bf16_f32 v108, v88, v89
 v_cvt_pk_bf16_f32 v109, v92, v93
 v_cvt_pk_bf16_f32 v110, v90, v91
 v_cvt_pk_bf16_f32 v111, v94, v95
 buffer_store_dwordx4 v[108:111], v1, s[20:23], s45 offen offset:2048 sc1
 s_cmp_lt_u32 s42, s36
 s_cbranch_scc1 Lqb_loop_24
 s_waitcnt vmcnt(0)
 buffer_load_dword v17, v11, s[20:23], s56 offen sc1
 s_barrier
 buffer_store_dword v14, v8, s[20:23], s59 offen sc1
 s_branch Lfin
Lob:
 s_load_dwordx2 s[8:9], s[0:1], 88
 s_mov_b32 s10, 0x480000
 s_mov_b32 s11, 0x20000
 s_sub_u32 s32, s6, 16
 s_mul_i32 s7, s3, 5
 s_add_u32 s7, s7, s6
 s_sub_u32 s7, s7, 25
 s_cmp_lt_u32 s6, 25
 s_cselect_b32 s32, s32, s7
 s_cselect_b32 s33, s3, 4
 s_cselect_b32 s34, 2, 1
 s_cselect_b32 s39, 6, 4
 s_cselect_b32 s35, 22, 20
 s_cselect_b32 s40, 0, 4
 s_mov_b32 s36, 0x7000000
 s_mov_b32 s37, 1152
 s_lshl_b32 s7, s4, 7
 s_add_u32 s38, s7, 0x3800
 s_mov_b32 s93, 1
 s_mov_b32 s92, 3
 s_mov_b32 s91, 9
 s_mov_b32 s90, 1
Los:
 s_load_dwordx2 s[24:25], s[0:1], 104
 s_mov_b32 s26, 0x480000
 s_mov_b32 s27, 0x20000
 s_waitcnt lgkmcnt(0)
 v_and_b32 v15, 63, v0
 v_lshlrev_b32 v1, 4, v15
 v_and_b32 v3, s92, v15
 v_lshlrev_b32 v3, 2, v3
 v_lshrrev_b32 v14, 4, v15
 v_min_u32 v14, 1, v14
 v_lshl_or_b32 v3, v14, 28, v3
 s_add_u32 s44, s32, s40
 s_and_b32 s44, s44, 7
 s_mov_b32 s50, 0x40000
 s_mul_i32 s49, s4, 40960
 v_add_u32 v5, s49, v1
 v_bfe_u32 v14, v15, 5, 1
 v_bfe_u32 v16, v15, 3, 1
 v_lshl_add_u32 v14, v14, 1, v16
 v_bfe_u32 v16, v15, 4, 1
 v_lshl_add_u32 v14, v16, 6, v14
 v_mul_u32_u24 v14, 1152, v14
 v_bfe_u32 v17, v15, 1, 2
 v_xor_b32 v17, v17, v16
 v_lshlrev_b32 v17, 5, v17
 v_and_b32 v16, 1, v15
 v_lshl_add_u32 v17, v16, 4, v17
 v_add_u32 v8, v14, v17
 v_xor_b32 v17, 64, v17
 v_add_u32 v9, v14, v17
 v_lshrrev_b32 v14, 4, v15
 v_bfe_u32 v16, v15, 2, 2
 v_lshl_add_u32 v14, v14, 3, v16
 v_lshlrev_b32 v14, 7, v14
 v_bfe_u32 v16, v15, 3, 2
 v_lshl_add_u32 v14, v16, 5, v14
 v_and_b32 v16, 3, v15
 v_lshl_add_u32 v14, v16, 3, v14
 v_xor_b32 v16, 0, v14
 v_add_u32 v10, s49, v16
 v_xor_b32 v16, 32, v14
 v_add_u32 v11, s49, v16
 v_xor_b32 v16, 64, v14
 v_add_u32 v12, s49, v16
 v_xor_b32 v16, 96, v14
 v_add_u32 v13, s49, v16
 s_lshl_b32 s47, s32, 7
 s_add_u32 s46, s44, 0
 s_and_b32 s46, s46, 7
 s_lshl_b32 s45, s4, 3
 s_add_u32 s46, s46, s45
 s_mul_i32 s46, s46, 147456
 s_add_u32 s46, s46, s47
 s_add_u32 m0, s49, 8192
 s_add_u32 s45, s46, 0
 buffer_load_dwordx4 v8, s[8:11], s45 offen  lds
 s_add_u32 m0, s49, 9216
 s_add_u32 s45, s46, 4608
 buffer_load_dwordx4 v9, s[8:11], s45 offen  lds
 s_add_u32 m0, s49, 10240
 s_add_u32 s45, s46, 9216
 buffer_load_dwordx4 v8, s[8:11], s45 offen  lds
 s_add_u32 m0, s49, 11264
 s_add_u32 s45, s46, 13824
 buffer_load_dwordx4 v9, s[8:11], s45 offen  lds
 s_add_u32 m0, s49, 12288
 s_add_u32 s45, s46, 18432
 buffer_load_dwordx4 v8, s[8:11], s45 offen  lds
 s_add_u32 m0, s49, 13312
 s_add_u32 s45, s46, 23040
 buffer_load_dwordx4 v9, s[8:11], s45 offen  lds
 s_add_u32 m0, s49, 14336
 s_add_u32 s45, s46, 27648
 buffer_load_dwordx4 v8, s[8:11], s45 offen  lds
 s_add_u32 m0, s49, 15360
 s_add_u32 s45, s46, 32256
 buffer_load_dwordx4 v9, s[8:11], s45 offen  lds
 s_add_u32 m0, s49, 16384
 s_add_u32 s45, s46, 36864
 buffer_load_dwordx4 v8, s[8:11], s45 offen  lds
 s_add_u32 m0, s49, 17408
 s_add_u32 s45, s46, 41472
 buffer_load_dwordx4 v9, s[8:11], s45 offen  lds
 s_add_u32 m0, s49, 18432
 s_add_u32 s45, s46, 46080
 buffer_load_dwordx4 v8, s[8:11], s45 offen  lds
 s_add_u32 m0, s49, 19456
 s_add_u32 s45, s46, 50688
 buffer_load_dwordx4 v9, s[8:11], s45 offen  lds
 s_add_u32 m0, s49, 20480
 s_add_u32 s45, s46, 55296
 buffer_load_dwordx4 v8, s[8:11], s45 offen  lds
 s_add_u32 m0, s49, 21504
 s_add_u32 s45, s46, 59904
 buffer_load_dwordx4 v9, s[8:11], s45 offen  lds
 s_add_u32 m0, s49, 22528
 s_add_u32 s45, s46, 64512
 buffer_load_dwordx4 v8, s[8:11], s45 offen  lds
 s_add_u32 m0, s49, 23552
 s_add_u32 s45, s46, 69120
 buffer_load_dwordx4 v9, s[8:11], s45 offen  lds
 s_add_u32 s46, s44, 1
 s_and_b32 s46, s46, 7
 s_lshl_b32 s45, s4, 3
 s_add_u32 s46, s46, s45
 s_mul_i32 s46, s46, 147456
 s_add_u32 s46, s46, s47
 s_add_u32 m0, s49, 24576
 s_add_u32 s45, s46, 0
 buffer_load_dwordx4 v8, s[8:11], s45 offen  lds
 s_add_u32 m0, s49, 25600
 s_add_u32 s45, s46, 4608
 buffer_load_dwordx4 v9, s[8:11], s45 offen  lds
 s_add_u32 m0, s49, 26624
 s_add_u32 s45, s46, 9216
 buffer_load_dwordx4 v8, s[8:11], s45 offen  lds
 s_add_u32 m0, s49, 27648
 s_add_u32 s45, s46, 13824
 buffer_load_dwordx4 v9, s[8:11], s45 offen  lds
 s_add_u32 m0, s49, 28672
 s_add_u32 s45, s46, 18432
 buffer_load_dwordx4 v8, s[8:11], s45 offen  lds
 s_add_u32 m0, s49, 29696
 s_add_u32 s45, s46, 23040
 buffer_load_dwordx4 v9, s[8:11], s45 offen  lds
 s_add_u32 m0, s49, 30720
 s_add_u32 s45, s46, 27648
 buffer_load_dwordx4 v8, s[8:11], s45 offen  lds
 s_add_u32 m0, s49, 31744
 s_add_u32 s45, s46, 32256
 buffer_load_dwordx4 v9, s[8:11], s45 offen  lds
 s_waitcnt vmcnt(20) lgkmcnt(0)
 s_add_u32 m0, s49, 32768
 s_add_u32 s45, s46, 36864
 buffer_load_dwordx4 v8, s[8:11], s45 offen  lds
 s_add_u32 m0, s49, 33792
 s_add_u32 s45, s46, 41472
 buffer_load_dwordx4 v9, s[8:11], s45 offen  lds
 s_add_u32 m0, s49, 34816
 s_add_u32 s45, s46, 46080
 buffer_load_dwordx4 v8, s[8:11], s45 offen  lds
 s_add_u32 m0, s49, 35840
 s_add_u32 s45, s46, 50688
 buffer_load_dwordx4 v9, s[8:11], s45 offen  lds
 ds_read_b64_tr_b16 a[0:1], v10 offset:8192
 ds_read_b64_tr_b16 a[2:3], v10 offset:8704
 ds_read_b64_tr_b16 a[4:5], v11 offset:8192
 ds_read_b64_tr_b16 a[6:7], v11 offset:8704
 ds_read_b64_tr_b16 a[8:9], v12 offset:8192
 ds_read_b64_tr_b16 a[10:11], v12 offset:8704
 ds_read_b64_tr_b16 v[16:17], v13 offset:8192
 ds_read_b64_tr_b16 v[18:19], v13 offset:8704
 s_waitcnt vmcnt(20) lgkmcnt(0)
 s_add_u32 m0, s49, 36864
 s_add_u32 s45, s46, 55296
 buffer_load_dwordx4 v8, s[8:11], s45 offen  lds
 s_add_u32 m0, s49, 37888
 s_add_u32 s45, s46, 59904
 buffer_load_dwordx4 v9, s[8:11], s45 offen  lds
 s_add_u32 m0, s49, 38912
 s_add_u32 s45, s46, 64512
 buffer_load_dwordx4 v8, s[8:11], s45 offen  lds
 s_add_u32 m0, s49, 39936
 s_add_u32 s45, s46, 69120
 buffer_load_dwordx4 v9, s[8:11], s45 offen  lds
 ds_write_b128 v5, v[16:19] offset:0
 ds_read_b64_tr_b16 a[12:13], v10 offset:12288
 ds_read_b64_tr_b16 a[14:15], v10 offset:12800
 ds_read_b64_tr_b16 a[16:17], v11 offset:12288
 ds_read_b64_tr_b16 a[18:19], v11 offset:12800
 ds_read_b64_tr_b16 a[20:21], v12 offset:12288
 ds_read_b64_tr_b16 a[22:23], v12 offset:12800
 ds_read_b64_tr_b16 v[20:21], v13 offset:12288
 ds_read_b64_tr_b16 v[22:23], v13 offset:12800
 s_waitcnt vmcnt(20) lgkmcnt(0)
 s_add_u32 s46, s44, 2
 s_and_b32 s46, s46, 7
 s_lshl_b32 s45, s4, 3
 s_add_u32 s46, s46, s45
 s_mul_i32 s46, s46, 147456
 s_add_u32 s46, s46, s47
 s_add_u32 m0, s49, 8192
 s_add_u32 s45, s46, 0
 buffer_load_dwordx4 v8, s[8:11], s45 offen  lds
 s_add_u32 m0, s49, 9216
 s_add_u32 s45, s46, 4608
 buffer_load_dwordx4 v9, s[8:11], s45 offen  lds
 s_add_u32 m0, s49, 10240
 s_add_u32 s45, s46, 9216
 buffer_load_dwordx4 v8, s[8:11], s45 offen  lds
 s_add_u32 m0, s49, 11264
 s_add_u32 s45, s46, 13824
 buffer_load_dwordx4 v9, s[8:11], s45 offen  lds
 ds_write_b128 v5, v[20:23] offset:1024
 ds_read_b64_tr_b16 a[24:25], v10 offset:16384
 ds_read_b64_tr_b16 a[26:27], v10 offset:16896
 ds_read_b64_tr_b16 a[28:29], v11 offset:16384
 ds_read_b64_tr_b16 a[30:31], v11 offset:16896
 ds_read_b64_tr_b16 a[32:33], v12 offset:16384
 ds_read_b64_tr_b16 a[34:35], v12 offset:16896
 ds_read_b64_tr_b16 v[16:17], v13 offset:16384
 ds_read_b64_tr_b16 v[18:19], v13 offset:16896
 s_waitcnt vmcnt(20) lgkmcnt(0)
 s_add_u32 m0, s49, 12288
 s_add_u32 s45, s46, 18432
 buffer_load_dwordx4 v8, s[8:11], s45 offen  lds
 s_add_u32 m0, s49, 13312
 s_add_u32 s45, s46, 23040
 buffer_load_dwordx4 v9, s[8:11], s45 offen  lds
 s_add_u32 m0, s49, 14336
 s_add_u32 s45, s46, 27648
 buffer_load_dwordx4 v8, s[8:11], s45 offen  lds
 s_add_u32 m0, s49, 15360
 s_add_u32 s45, s46, 32256
 buffer_load_dwordx4 v9, s[8:11], s45 offen  lds
 ds_write_b128 v5, v[16:19] offset:2048
 ds_read_b64_tr_b16 a[36:37], v10 offset:20480
 ds_read_b64_tr_b16 a[38:39], v10 offset:20992
 ds_read_b64_tr_b16 a[40:41], v11 offset:20480
 ds_read_b64_tr_b16 a[42:43], v11 offset:20992
 ds_read_b64_tr_b16 a[44:45], v12 offset:20480
 ds_read_b64_tr_b16 a[46:47], v12 offset:20992
 ds_read_b64_tr_b16 v[20:21], v13 offset:20480
 ds_read_b64_tr_b16 v[22:23], v13 offset:20992
 s_waitcnt vmcnt(20) lgkmcnt(0)
 s_add_u32 m0, s49, 16384
 s_add_u32 s45, s46, 36864
 buffer_load_dwordx4 v8, s[8:11], s45 offen  lds
 s_add_u32 m0, s49, 17408
 s_add_u32 s45, s46, 41472
 buffer_load_dwordx4 v9, s[8:11], s45 offen  lds
 s_add_u32 m0, s49, 18432
 s_add_u32 s45, s46, 46080
 buffer_load_dwordx4 v8, s[8:11], s45 offen  lds
 s_add_u32 m0, s49, 19456
 s_add_u32 s45, s46, 50688
 buffer_load_dwordx4 v9, s[8:11], s45 offen  lds
 ds_write_b128 v5, v[20:23] offset:3072
 ds_read_b64_tr_b16 a[48:49], v10 offset:24576
 ds_read_b64_tr_b16 a[50:51], v10 offset:25088
 ds_read_b64_tr_b16 a[52:53], v11 offset:24576
 ds_read_b64_tr_b16 a[54:55], v11 offset:25088
 ds_read_b64_tr_b16 a[56:57], v12 offset:24576
 ds_read_b64_tr_b16 a[58:59], v12 offset:25088
 ds_read_b64_tr_b16 v[16:17], v13 offset:24576
 ds_read_b64_tr_b16 v[18:19], v13 offset:25088
 s_waitcnt vmcnt(20) lgkmcnt(0)
 s_add_u32 m0, s49, 20480
 s_add_u32 s45, s46, 55296
 buffer_load_dwordx4 v8, s[8:11], s45 offen  lds
 s_add_u32 m0, s49, 21504
 s_add_u32 s45, s46, 59904
 buffer_load_dwordx4 v9, s[8:11], s45 offen  lds
 s_add_u32 m0, s49, 22528
 s_add_u32 s45, s46, 64512
 buffer_load_dwordx4 v8, s[8:11], s45 offen  lds
 s_add_u32 m0, s49, 23552
 s_add_u32 s45, s46, 69120
 buffer_load_dwordx4 v9, s[8:11], s45 offen  lds
 ds_write_b128 v5, v[16:19] offset:4096
 ds_read_b64_tr_b16 a[60:61], v10 offset:28672
 ds_read_b64_tr_b16 a[62:63], v10 offset:29184
 ds_read_b64_tr_b16 a[64:65], v11 offset:28672
 ds_read_b64_tr_b16 a[66:67], v11 offset:29184
 ds_read_b64_tr_b16 a[68:69], v12 offset:28672
 ds_read_b64_tr_b16 a[70:71], v12 offset:29184
 ds_read_b64_tr_b16 v[20:21], v13 offset:28672
 ds_read_b64_tr_b16 v[22:23], v13 offset:29184
 s_waitcnt vmcnt(20) lgkmcnt(0)
 s_add_u32 s46, s44, 3
 s_and_b32 s46, s46, 7
 s_lshl_b32 s45, s4, 3
 s_add_u32 s46, s46, s45
 s_mul_i32 s46, s46, 147456
 s_add_u32 s46, s46, s47
 s_add_u32 m0, s49, 24576
 s_add_u32 s45, s46, 0
 buffer_load_dwordx4 v8, s[8:11], s45 offen  lds
 s_add_u32 m0, s49, 25600
 s_add_u32 s45, s46, 4608
 buffer_load_dwordx4 v9, s[8:11], s45 offen  lds
 s_add_u32 m0, s49, 26624
 s_add_u32 s45, s46, 9216
 buffer_load_dwordx4 v8, s[8:11], s45 offen  lds
 s_add_u32 m0, s49, 27648
 s_add_u32 s45, s46, 13824
 buffer_load_dwordx4 v9, s[8:11], s45 offen  lds
 ds_write_b128 v5, v[20:23] offset:5120
 ds_read_b64_tr_b16 a[72:73], v10 offset:32768
 ds_read_b64_tr_b16 a[74:75], v10 offset:33280
 ds_read_b64_tr_b16 a[76:77], v11 offset:32768
 ds_read_b64_tr_b16 a[78:79], v11 offset:33280
 ds_read_b64_tr_b16 a[80:81], v12 offset:32768
 ds_read_b64_tr_b16 a[82:83], v12 offset:33280
 ds_read_b64_tr_b16 v[16:17], v13 offset:32768
 ds_read_b64_tr_b16 v[18:19], v13 offset:33280
 s_waitcnt vmcnt(20) lgkmcnt(0)
 s_add_u32 m0, s49, 28672
 s_add_u32 s45, s46, 18432
 buffer_load_dwordx4 v8, s[8:11], s45 offen  lds
 s_add_u32 m0, s49, 29696
 s_add_u32 s45, s46, 23040
 buffer_load_dwordx4 v9, s[8:11], s45 offen  lds
 s_add_u32 m0, s49, 30720
 s_add_u32 s45, s46, 27648
 buffer_load_dwordx4 v8, s[8:11], s45 offen  lds
 s_add_u32 m0, s49, 31744
 s_add_u32 s45, s46, 32256
 buffer_load_dwordx4 v9, s[8:11], s45 offen  lds
 ds_write_b128 v5, v[16:19] offset:6144
 ds_read_b64_tr_b16 a[84:85], v10 offset:36864
 ds_read_b64_tr_b16 a[86:87], v10 offset:37376
 ds_read_b64_tr_b16 a[88:89], v11 offset:36864
 ds_read_b64_tr_b16 a[90:91], v11 offset:37376
 ds_read_b64_tr_b16 a[92:93], v12 offset:36864
 ds_read_b64_tr_b16 a[94:95], v12 offset:37376
 ds_read_b64_tr_b16 v[20:21], v13 offset:36864
 ds_read_b64_tr_b16 v[22:23], v13 offset:37376
 s_waitcnt vmcnt(20) lgkmcnt(0)
 s_add_u32 m0, s49, 32768
 s_add_u32 s45, s46, 36864
 buffer_load_dwordx4 v8, s[8:11], s45 offen  lds
 s_add_u32 m0, s49, 33792
 s_add_u32 s45, s46, 41472
 buffer_load_dwordx4 v9, s[8:11], s45 offen  lds
 s_add_u32 m0, s49, 34816
 s_add_u32 s45, s46, 46080
 buffer_load_dwordx4 v8, s[8:11], s45 offen  lds
 s_add_u32 m0, s49, 35840
 s_add_u32 s45, s46, 50688
 buffer_load_dwordx4 v9, s[8:11], s45 offen  lds
 ds_write_b128 v5, v[20:23] offset:7168
 ds_read_b64_tr_b16 a[96:97], v10 offset:8192
 ds_read_b64_tr_b16 a[98:99], v10 offset:8704
 ds_read_b64_tr_b16 a[100:101], v11 offset:8192
 ds_read_b64_tr_b16 a[102:103], v11 offset:8704
 ds_read_b64_tr_b16 a[104:105], v12 offset:8192
 ds_read_b64_tr_b16 a[106:107], v12 offset:8704
 ds_read_b64_tr_b16 v[32:33], v13 offset:8192
 ds_read_b64_tr_b16 v[34:35], v13 offset:8704
 s_waitcnt vmcnt(20) lgkmcnt(0)
 s_add_u32 m0, s49, 36864
 s_add_u32 s45, s46, 55296
 buffer_load_dwordx4 v8, s[8:11], s45 offen  lds
 s_add_u32 m0, s49, 37888
 s_add_u32 s45, s46, 59904
 buffer_load_dwordx4 v9, s[8:11], s45 offen  lds
 s_add_u32 m0, s49, 38912
 s_add_u32 s45, s46, 64512
 buffer_load_dwordx4 v8, s[8:11], s45 offen  lds
 s_add_u32 m0, s49, 39936
 s_add_u32 s45, s46, 69120
 buffer_load_dwordx4 v9, s[8:11], s45 offen  lds
 ds_read_b64_tr_b16 a[108:109], v10 offset:12288
 ds_read_b64_tr_b16 a[110:111], v10 offset:12800
 ds_read_b64_tr_b16 a[112:113], v11 offset:12288
 ds_read_b64_tr_b16 a[114:115], v11 offset:12800
 ds_read_b64_tr_b16 a[116:117], v12 offset:12288
 ds_read_b64_tr_b16 a[118:119], v12 offset:12800
 ds_read_b64_tr_b16 v[36:37], v13 offset:12288
 ds_read_b64_tr_b16 v[38:39], v13 offset:12800
 s_waitcnt vmcnt(20) lgkmcnt(0)
 s_add_u32 s46, s44, 4
 s_and_b32 s46, s46, 7
 s_lshl_b32 s45, s4, 3
 s_add_u32 s46, s46, s45
 s_mul_i32 s46, s46, 147456
 s_add_u32 s46, s46, s47
 s_add_u32 m0, s49, 8192
 s_add_u32 s45, s46, 0
 buffer_load_dwordx4 v8, s[8:11], s45 offen  lds
 s_add_u32 m0, s49, 9216
 s_add_u32 s45, s46, 4608
 buffer_load_dwordx4 v9, s[8:11], s45 offen  lds
 s_add_u32 m0, s49, 10240
 s_add_u32 s45, s46, 9216
 buffer_load_dwordx4 v8, s[8:11], s45 offen  lds
 s_add_u32 m0, s49, 11264
 s_add_u32 s45, s46, 13824
 buffer_load_dwordx4 v9, s[8:11], s45 offen  lds
 ds_read_b64_tr_b16 a[120:121], v10 offset:16384
 ds_read_b64_tr_b16 a[122:123], v10 offset:16896
 ds_read_b64_tr_b16 a[124:125], v11 offset:16384
 ds_read_b64_tr_b16 a[126:127], v11 offset:16896
 ds_read_b64_tr_b16 a[128:129], v12 offset:16384
 ds_read_b64_tr_b16 a[130:131], v12 offset:16896
 ds_read_b64_tr_b16 v[40:41], v13 offset:16384
 ds_read_b64_tr_b16 v[42:43], v13 offset:16896
 s_waitcnt vmcnt(20) lgkmcnt(0)
 s_add_u32 m0, s49, 12288
 s_add_u32 s45, s46, 18432
 buffer_load_dwordx4 v8, s[8:11], s45 offen  lds
 s_add_u32 m0, s49, 13312
 s_add_u32 s45, s46, 23040
 buffer_load_dwordx4 v9, s[8:11], s45 offen  lds
 s_add_u32 m0, s49, 14336
 s_add_u32 s45, s46, 27648
 buffer_load_dwordx4 v8, s[8:11], s45 offen  lds
 s_add_u32 m0, s49, 15360
 s_add_u32 s45, s46, 32256
 buffer_load_dwordx4 v9, s[8:11], s45 offen  lds
 ds_read_b64_tr_b16 a[132:133], v10 offset:20480
 ds_read_b64_tr_b16 a[134:135], v10 offset:20992
 ds_read_b64_tr_b16 a[136:137], v11 offset:20480
 ds_read_b64_tr_b16 a[138:139], v11 offset:20992
 ds_read_b64_tr_b16 a[140:141], v12 offset:20480
 ds_read_b64_tr_b16 a[142:143], v12 offset:20992
 ds_read_b64_tr_b16 v[44:45], v13 offset:20480
 ds_read_b64_tr_b16 v[46:47], v13 offset:20992
 s_waitcnt vmcnt(20) lgkmcnt(0)
 s_add_u32 m0, s49, 16384
 s_add_u32 s45, s46, 36864
 buffer_load_dwordx4 v8, s[8:11], s45 offen  lds
 s_add_u32 m0, s49, 17408
 s_add_u32 s45, s46, 41472
 buffer_load_dwordx4 v9, s[8:11], s45 offen  lds
 s_add_u32 m0, s49, 18432
 s_add_u32 s45, s46, 46080
 buffer_load_dwordx4 v8, s[8:11], s45 offen  lds
 s_add_u32 m0, s49, 19456
 s_add_u32 s45, s46, 50688
 buffer_load_dwordx4 v9, s[8:11], s45 offen  lds
 ds_read_b64_tr_b16 a[144:145], v10 offset:24576
 ds_read_b64_tr_b16 a[146:147], v10 offset:25088
 ds_read_b64_tr_b16 a[148:149], v11 offset:24576
 ds_read_b64_tr_b16 a[150:151], v11 offset:25088
 ds_read_b64_tr_b16 a[152:153], v12 offset:24576
 ds_read_b64_tr_b16 a[154:155], v12 offset:25088
 ds_read_b64_tr_b16 v[48:49], v13 offset:24576
 ds_read_b64_tr_b16 v[50:51], v13 offset:25088
 s_waitcnt vmcnt(20) lgkmcnt(0)
 s_add_u32 m0, s49, 20480
 s_add_u32 s45, s46, 55296
 buffer_load_dwordx4 v8, s[8:11], s45 offen  lds
 s_add_u32 m0, s49, 21504
 s_add_u32 s45, s46, 59904
 buffer_load_dwordx4 v9, s[8:11], s45 offen  lds
 s_add_u32 m0, s49, 22528
 s_add_u32 s45, s46, 64512
 buffer_load_dwordx4 v8, s[8:11], s45 offen  lds
 s_add_u32 m0, s49, 23552
 s_add_u32 s45, s46, 69120
 buffer_load_dwordx4 v9, s[8:11], s45 offen  lds
 ds_read_b64_tr_b16 a[156:157], v10 offset:28672
 ds_read_b64_tr_b16 a[158:159], v10 offset:29184
 ds_read_b64_tr_b16 a[160:161], v11 offset:28672
 ds_read_b64_tr_b16 a[162:163], v11 offset:29184
 ds_read_b64_tr_b16 a[164:165], v12 offset:28672
 ds_read_b64_tr_b16 a[166:167], v12 offset:29184
 ds_read_b64_tr_b16 v[52:53], v13 offset:28672
 ds_read_b64_tr_b16 v[54:55], v13 offset:29184
 s_waitcnt vmcnt(20) lgkmcnt(0)
 s_add_u32 s46, s44, 5
 s_and_b32 s46, s46, 7
 s_lshl_b32 s45, s4, 3
 s_add_u32 s46, s46, s45
 s_mul_i32 s46, s46, 147456
 s_add_u32 s46, s46, s47
 s_add_u32 m0, s49, 24576
 s_add_u32 s45, s46, 0
 buffer_load_dwordx4 v8, s[8:11], s45 offen  lds
 s_add_u32 m0, s49, 25600
 s_add_u32 s45, s46, 4608
 buffer_load_dwordx4 v9, s[8:11], s45 offen  lds
 s_add_u32 m0, s49, 26624
 s_add_u32 s45, s46, 9216
 buffer_load_dwordx4 v8, s[8:11], s45 offen  lds
 s_add_u32 m0, s49, 27648
 s_add_u32 s45, s46, 13824
 buffer_load_dwordx4 v9, s[8:11], s45 offen  lds
 ds_read_b64_tr_b16 a[168:169], v10 offset:32768
 ds_read_b64_tr_b16 a[170:171], v10 offset:33280
 ds_read_b64_tr_b16 a[172:173], v11 offset:32768
 ds_read_b64_tr_b16 a[174:175], v11 offset:33280
 ds_read_b64_tr_b16 a[176:177], v12 offset:32768
 ds_read_b64_tr_b16 a[178:179], v12 offset:33280
 ds_read_b64_tr_b16 v[56:57], v13 offset:32768
 ds_read_b64_tr_b16 v[58:59], v13 offset:33280
 s_waitcnt vmcnt(20) lgkmcnt(0)
 s_add_u32 m0, s49, 28672
 s_add_u32 s45, s46, 18432
 buffer_load_dwordx4 v8, s[8:11], s45 offen  lds
 s_add_u32 m0, s49, 29696
 s_add_u32 s45, s46, 23040
 buffer_load_dwordx4 v9, s[8:11], s45 offen  lds
 s_add_u32 m0, s49, 30720
 s_add_u32 s45, s46, 27648
 buffer_load_dwordx4 v8, s[8:11], s45 offen  lds
 s_add_u32 m0, s49, 31744
 s_add_u32 s45, s46, 32256
 buffer_load_dwordx4 v9, s[8:11], s45 offen  lds
 ds_read_b64_tr_b16 a[180:181], v10 offset:36864
 ds_read_b64_tr_b16 a[182:183], v10 offset:37376
 ds_read_b64_tr_b16 a[184:185], v11 offset:36864
 ds_read_b64_tr_b16 a[186:187], v11 offset:37376
 ds_read_b64_tr_b16 a[188:189], v12 offset:36864
 ds_read_b64_tr_b16 a[190:191], v12 offset:37376
 ds_read_b64_tr_b16 v[60:61], v13 offset:36864
 ds_read_b64_tr_b16 v[62:63], v13 offset:37376
 s_waitcnt vmcnt(20) lgkmcnt(0)
 s_add_u32 m0, s49, 32768
 s_add_u32 s45, s46, 36864
 buffer_load_dwordx4 v8, s[8:11], s45 offen  lds
 s_add_u32 m0, s49, 33792
 s_add_u32 s45, s46, 41472
 buffer_load_dwordx4 v9, s[8:11], s45 offen  lds
 s_add_u32 m0, s49, 34816
 s_add_u32 s45, s46, 46080
 buffer_load_dwordx4 v8, s[8:11], s45 offen  lds
 s_add_u32 m0, s49, 35840
 s_add_u32 s45, s46, 50688
 buffer_load_dwordx4 v9, s[8:11], s45 offen  lds
 ds_read_b64_tr_b16 a[192:193], v10 offset:8192
 ds_read_b64_tr_b16 a[194:195], v10 offset:8704
 ds_read_b64_tr_b16 a[196:197], v11 offset:8192
 ds_read_b64_tr_b16 a[198:199], v11 offset:8704
 ds_read_b64_tr_b16 a[200:201], v12 offset:8192
 ds_read_b64_tr_b16 a[202:203], v12 offset:8704
 ds_read_b64_tr_b16 v[64:65], v13 offset:8192
 ds_read_b64_tr_b16 v[66:67], v13 offset:8704
 s_waitcnt vmcnt(20) lgkmcnt(0)
 s_add_u32 m0, s49, 36864
 s_add_u32 s45, s46, 55296
 buffer_load_dwordx4 v8, s[8:11], s45 offen  lds
 s_add_u32 m0, s49, 37888
 s_add_u32 s45, s46, 59904
 buffer_load_dwordx4 v9, s[8:11], s45 offen  lds
 s_add_u32 m0, s49, 38912
 s_add_u32 s45, s46, 64512
 buffer_load_dwordx4 v8, s[8:11], s45 offen  lds
 s_add_u32 m0, s49, 39936
 s_add_u32 s45, s46, 69120
 buffer_load_dwordx4 v9, s[8:11], s45 offen  lds
 ds_read_b64_tr_b16 a[204:205], v10 offset:12288
 ds_read_b64_tr_b16 a[206:207], v10 offset:12800
 ds_read_b64_tr_b16 a[208:209], v11 offset:12288
 ds_read_b64_tr_b16 a[210:211], v11 offset:12800
 ds_read_b64_tr_b16 a[212:213], v12 offset:12288
 ds_read_b64_tr_b16 a[214:215], v12 offset:12800
 ds_read_b64_tr_b16 v[68:69], v13 offset:12288
 ds_read_b64_tr_b16 v[70:71], v13 offset:12800
 s_waitcnt vmcnt(20) lgkmcnt(0)
 s_add_u32 s46, s44, 6
 s_and_b32 s46, s46, 7
 s_lshl_b32 s45, s4, 3
 s_add_u32 s46, s46, s45
 s_mul_i32 s46, s46, 147456
 s_add_u32 s46, s46, s47
 s_add_u32 m0, s49, 8192
 s_add_u32 s45, s46, 0
 buffer_load_dwordx4 v8, s[8:11], s45 offen  lds
 s_add_u32 m0, s49, 9216
 s_add_u32 s45, s46, 4608
 buffer_load_dwordx4 v9, s[8:11], s45 offen  lds
 s_add_u32 m0, s49, 10240
 s_add_u32 s45, s46, 9216
 buffer_load_dwordx4 v8, s[8:11], s45 offen  lds
 s_add_u32 m0, s49, 11264
 s_add_u32 s45, s46, 13824
 buffer_load_dwordx4 v9, s[8:11], s45 offen  lds
 ds_read_b64_tr_b16 a[216:217], v10 offset:16384
 ds_read_b64_tr_b16 a[218:219], v10 offset:16896
 ds_read_b64_tr_b16 a[220:221], v11 offset:16384
 ds_read_b64_tr_b16 a[222:223], v11 offset:16896
 ds_read_b64_tr_b16 a[224:225], v12 offset:16384
 ds_read_b64_tr_b16 a[226:227], v12 offset:16896
 ds_read_b64_tr_b16 v[72:73], v13 offset:16384
 ds_read_b64_tr_b16 v[74:75], v13 offset:16896
 s_waitcnt vmcnt(20) lgkmcnt(0)
 s_add_u32 m0, s49, 12288
 s_add_u32 s45, s46, 18432
 buffer_load_dwordx4 v8, s[8:11], s45 offen  lds
 s_add_u32 m0, s49, 13312
 s_add_u32 s45, s46, 23040
 buffer_load_dwordx4 v9, s[8:11], s45 offen  lds
 s_add_u32 m0, s49, 14336
 s_add_u32 s45, s46, 27648
 buffer_load_dwordx4 v8, s[8:11], s45 offen  lds
 s_add_u32 m0, s49, 15360
 s_add_u32 s45, s46, 32256
 buffer_load_dwordx4 v9, s[8:11], s45 offen  lds
 ds_read_b64_tr_b16 a[228:229], v10 offset:20480
 ds_read_b64_tr_b16 a[230:231], v10 offset:20992
 ds_read_b64_tr_b16 a[232:233], v11 offset:20480
 ds_read_b64_tr_b16 a[234:235], v11 offset:20992
 ds_read_b64_tr_b16 a[236:237], v12 offset:20480
 ds_read_b64_tr_b16 a[238:239], v12 offset:20992
 ds_read_b64_tr_b16 v[76:77], v13 offset:20480
 ds_read_b64_tr_b16 v[78:79], v13 offset:20992
 s_waitcnt vmcnt(20) lgkmcnt(0)
 s_add_u32 m0, s49, 16384
 s_add_u32 s45, s46, 36864
 buffer_load_dwordx4 v8, s[8:11], s45 offen  lds
 s_add_u32 m0, s49, 17408
 s_add_u32 s45, s46, 41472
 buffer_load_dwordx4 v9, s[8:11], s45 offen  lds
 s_add_u32 m0, s49, 18432
 s_add_u32 s45, s46, 46080
 buffer_load_dwordx4 v8, s[8:11], s45 offen  lds
 s_add_u32 m0, s49, 19456
 s_add_u32 s45, s46, 50688
 buffer_load_dwordx4 v9, s[8:11], s45 offen  lds
 ds_read_b64_tr_b16 a[240:241], v10 offset:24576
 ds_read_b64_tr_b16 a[242:243], v10 offset:25088
 ds_read_b64_tr_b16 a[244:245], v11 offset:24576
 ds_read_b64_tr_b16 a[246:247], v11 offset:25088
 ds_read_b64_tr_b16 a[248:249], v12 offset:24576
 ds_read_b64_tr_b16 a[250:251], v12 offset:25088
 ds_read_b64_tr_b16 v[80:81], v13 offset:24576
 ds_read_b64_tr_b16 v[82:83], v13 offset:25088
 s_waitcnt vmcnt(20) lgkmcnt(0)
 s_add_u32 m0, s49, 20480
 s_add_u32 s45, s46, 55296
 buffer_load_dwordx4 v8, s[8:11], s45 offen  lds
 s_add_u32 m0, s49, 21504
 s_add_u32 s45, s46, 59904
 buffer_load_dwordx4 v9, s[8:11], s45 offen  lds
 s_add_u32 m0, s49, 22528
 s_add_u32 s45, s46, 64512
 buffer_load_dwordx4 v8, s[8:11], s45 offen  lds
 s_add_u32 m0, s49, 23552
 s_add_u32 s45, s46, 69120
 buffer_load_dwordx4 v9, s[8:11], s45 offen  lds
 ds_read_b64_tr_b16 a[252:253], v10 offset:28672
 ds_read_b64_tr_b16 a[254:255], v10 offset:29184
 ds_read_b64_tr_b16 v[128:129], v11 offset:28672
 ds_read_b64_tr_b16 v[130:131], v11 offset:29184
 ds_read_b64_tr_b16 v[132:133], v12 offset:28672
 ds_read_b64_tr_b16 v[134:135], v12 offset:29184
 ds_read_b64_tr_b16 v[84:85], v13 offset:28672
 ds_read_b64_tr_b16 v[86:87], v13 offset:29184
 s_waitcnt vmcnt(20) lgkmcnt(0)
 s_add_u32 s46, s44, 7
 s_and_b32 s46, s46, 7
 s_lshl_b32 s45, s4, 3
 s_add_u32 s46, s46, s45
 s_mul_i32 s46, s46, 147456
 s_add_u32 s46, s46, s47
 s_add_u32 m0, s49, 24576
 s_add_u32 s45, s46, 0
 buffer_load_dwordx4 v8, s[8:11], s45 offen  lds
 s_add_u32 m0, s49, 25600
 s_add_u32 s45, s46, 4608
 buffer_load_dwordx4 v9, s[8:11], s45 offen  lds
 s_add_u32 m0, s49, 26624
 s_add_u32 s45, s46, 9216
 buffer_load_dwordx4 v8, s[8:11], s45 offen  lds
 s_add_u32 m0, s49, 27648
 s_add_u32 s45, s46, 13824
 buffer_load_dwordx4 v9, s[8:11], s45 offen  lds
 ds_read_b64_tr_b16 v[136:137], v10 offset:32768
 ds_read_b64_tr_b16 v[138:139], v10 offset:33280
 ds_read_b64_tr_b16 v[140:141], v11 offset:32768
 ds_read_b64_tr_b16 v[142:143], v11 offset:33280
 ds_read_b64_tr_b16 v[144:145], v12 offset:32768
 ds_read_b64_tr_b16 v[146:147], v12 offset:33280
 ds_read_b64_tr_b16 v[88:89], v13 offset:32768
 ds_read_b64_tr_b16 v[90:91], v13 offset:33280
 s_waitcnt vmcnt(20) lgkmcnt(0)
 s_add_u32 m0, s49, 28672
 s_add_u32 s45, s46, 18432
 buffer_load_dwordx4 v8, s[8:11], s45 offen  lds
 s_add_u32 m0, s49, 29696
 s_add_u32 s45, s46, 23040
 buffer_load_dwordx4 v9, s[8:11], s45 offen  lds
 s_add_u32 m0, s49, 30720
 s_add_u32 s45, s46, 27648
 buffer_load_dwordx4 v8, s[8:11], s45 offen  lds
 s_add_u32 m0, s49, 31744
 s_add_u32 s45, s46, 32256
 buffer_load_dwordx4 v9, s[8:11], s45 offen  lds
 ds_read_b64_tr_b16 v[148:149], v10 offset:36864
 ds_read_b64_tr_b16 v[150:151], v10 offset:37376
 ds_read_b64_tr_b16 v[152:153], v11 offset:36864
 ds_read_b64_tr_b16 v[154:155], v11 offset:37376
 ds_read_b64_tr_b16 v[156:157], v12 offset:36864
 ds_read_b64_tr_b16 v[158:159], v12 offset:37376
 ds_read_b64_tr_b16 v[92:93], v13 offset:36864
 ds_read_b64_tr_b16 v[94:95], v13 offset:37376
 s_waitcnt vmcnt(20) lgkmcnt(0)
 s_add_u32 m0, s49, 32768
 s_add_u32 s45, s46, 36864
 buffer_load_dwordx4 v8, s[8:11], s45 offen  lds
 s_add_u32 m0, s49, 33792
 s_add_u32 s45, s46, 41472
 buffer_load_dwordx4 v9, s[8:11], s45 offen  lds
 s_add_u32 m0, s49, 34816
 s_add_u32 s45, s46, 46080
 buffer_load_dwordx4 v8, s[8:11], s45 offen  lds
 s_add_u32 m0, s49, 35840
 s_add_u32 s45, s46, 50688
 buffer_load_dwordx4 v9, s[8:11], s45 offen  lds
 ds_read_b64_tr_b16 v[160:161], v10 offset:8192
 ds_read_b64_tr_b16 v[162:163], v10 offset:8704
 ds_read_b64_tr_b16 v[164:165], v11 offset:8192
 ds_read_b64_tr_b16 v[166:167], v11 offset:8704
 ds_read_b64_tr_b16 v[168:169], v12 offset:8192
 ds_read_b64_tr_b16 v[170:171], v12 offset:8704
 ds_read_b64_tr_b16 v[96:97], v13 offset:8192
 ds_read_b64_tr_b16 v[98:99], v13 offset:8704
 s_waitcnt vmcnt(20) lgkmcnt(0)
 s_add_u32 m0, s49, 36864
 s_add_u32 s45, s46, 55296
 buffer_load_dwordx4 v8, s[8:11], s45 offen  lds
 s_add_u32 m0, s49, 37888
 s_add_u32 s45, s46, 59904
 buffer_load_dwordx4 v9, s[8:11], s45 offen  lds
 s_add_u32 m0, s49, 38912
 s_add_u32 s45, s46, 64512
 buffer_load_dwordx4 v8, s[8:11], s45 offen  lds
 s_add_u32 m0, s49, 39936
 s_add_u32 s45, s46, 69120
 buffer_load_dwordx4 v9, s[8:11], s45 offen  lds
 ds_read_b64_tr_b16 v[172:173], v10 offset:12288
 ds_read_b64_tr_b16 v[174:175], v10 offset:12800
 ds_read_b64_tr_b16 v[176:177], v11 offset:12288
 ds_read_b64_tr_b16 v[178:179], v11 offset:12800
 ds_read_b64_tr_b16 v[180:181], v12 offset:12288
 ds_read_b64_tr_b16 v[182:183], v12 offset:12800
 ds_read_b64_tr_b16 v[100:101], v13 offset:12288
 ds_read_b64_tr_b16 v[102:103], v13 offset:12800
 s_waitcnt vmcnt(20) lgkmcnt(0)
 ds_read_b64_tr_b16 v[184:185], v10 offset:16384
 ds_read_b64_tr_b16 v[186:187], v10 offset:16896
 ds_read_b64_tr_b16 v[188:189], v11 offset:16384
 ds_read_b64_tr_b16 v[190:191], v11 offset:16896
 ds_read_b64_tr_b16 v[192:193], v12 offset:16384
 ds_read_b64_tr_b16 v[194:195], v12 offset:16896
 ds_read_b64_tr_b16 v[104:105], v13 offset:16384
 ds_read_b64_tr_b16 v[106:107], v13 offset:16896
 s_waitcnt vmcnt(16) lgkmcnt(0)
 ds_read_b64_tr_b16 v[196:197], v10 offset:20480
 ds_read_b64_tr_b16 v[198:199], v10 offset:20992
 ds_read_b64_tr_b16 v[200:201], v11 offset:20480
 ds_read_b64_tr_b16 v[202:203], v11 offset:20992
 ds_read_b64_tr_b16 v[204:205], v12 offset:20480
 ds_read_b64_tr_b16 v[206:207], v12 offset:20992
 ds_read_b64_tr_b16 v[108:109], v13 offset:20480
 ds_read_b64_tr_b16 v[110:111], v13 offset:20992
 s_waitcnt vmcnt(12) lgkmcnt(0)
 ds_read_b64_tr_b16 v[208:209], v10 offset:24576
 ds_read_b64_tr_b16 v[210:211], v10 offset:25088
 ds_read_b64_tr_b16 v[212:213], v11 offset:24576
 ds_read_b64_tr_b16 v[214:215], v11 offset:25088
 ds_read_b64_tr_b16 v[216:217], v12 offset:24576
 ds_read_b64_tr_b16 v[218:219], v12 offset:25088
 ds_read_b64_tr_b16 v[112:113], v13 offset:24576
 ds_read_b64_tr_b16 v[114:115], v13 offset:25088
 s_waitcnt vmcnt(8) lgkmcnt(0)
 ds_read_b64_tr_b16 v[220:221], v10 offset:28672
 ds_read_b64_tr_b16 v[222:223], v10 offset:29184
 ds_read_b64_tr_b16 v[224:225], v11 offset:28672
 ds_read_b64_tr_b16 v[226:227], v11 offset:29184
 ds_read_b64_tr_b16 v[228:229], v12 offset:28672
 ds_read_b64_tr_b16 v[230:231], v12 offset:29184
 ds_read_b64_tr_b16 v[116:117], v13 offset:28672
 ds_read_b64_tr_b16 v[118:119], v13 offset:29184
 s_waitcnt vmcnt(4) lgkmcnt(0)
 ds_read_b64_tr_b16 v[232:233], v10 offset:32768
 ds_read_b64_tr_b16 v[234:235], v10 offset:33280
 ds_read_b64_tr_b16 v[236:237], v11 offset:32768
 ds_read_b64_tr_b16 v[238:239], v11 offset:33280
 ds_read_b64_tr_b16 v[240:241], v12 offset:32768
 ds_read_b64_tr_b16 v[242:243], v12 offset:33280
 ds_read_b64_tr_b16 v[120:121], v13 offset:32768
 ds_read_b64_tr_b16 v[122:123], v13 offset:33280
 s_waitcnt vmcnt(0) lgkmcnt(0)
 ds_read_b64_tr_b16 v[244:245], v10 offset:36864
 ds_read_b64_tr_b16 v[246:247], v10 offset:37376
 ds_read_b64_tr_b16 v[248:249], v11 offset:36864
 ds_read_b64_tr_b16 v[250:251], v11 offset:37376
 ds_read_b64_tr_b16 v[252:253], v12 offset:36864
 ds_read_b64_tr_b16 v[254:255], v12 offset:37376
 ds_read_b64_tr_b16 v[124:125], v13 offset:36864
 ds_read_b64_tr_b16 v[126:127], v13 offset:37376
 s_waitcnt lgkmcnt(0)
 ds_write_b128 v5, v[32:35] offset:8192
 ds_write_b128 v5, v[36:39] offset:9216
 ds_write_b128 v5, v[40:43] offset:10240
 ds_write_b128 v5, v[44:47] offset:11264
 ds_write_b128 v5, v[48:51] offset:12288
 ds_write_b128 v5, v[52:55] offset:13312
 ds_write_b128 v5, v[56:59] offset:14336
 ds_write_b128 v5, v[60:63] offset:15360
 ds_write_b128 v5, v[64:67] offset:16384
 ds_write_b128 v5, v[68:71] offset:17408
 ds_write_b128 v5, v[72:75] offset:18432
 ds_write_b128 v5, v[76:79] offset:19456
 ds_write_b128 v5, v[80:83] offset:20480
 ds_write_b128 v5, v[84:87] offset:21504
 ds_write_b128 v5, v[88:91] offset:22528
 ds_write_b128 v5, v[92:95] offset:23552
 ds_write_b128 v5, v[96:99] offset:24576
 ds_write_b128 v5, v[100:103] offset:25600
 ds_write_b128 v5, v[104:107] offset:26624
 ds_write_b128 v5, v[108:111] offset:27648
 ds_write_b128 v5, v[112:115] offset:28672
 ds_write_b128 v5, v[116:119] offset:29696
 ds_write_b128 v5, v[120:123] offset:30720
 ds_write_b128 v5, v[124:127] offset:31744
 s_waitcnt lgkmcnt(0)
 v_lshrrev_b32 v13, 2, v15
 v_and_b32 v14, 3, v15
 s_lshr_b32 s45, s4, 1
 s_mul_i32 s45, s45, 36864
 s_and_b32 s46, s4, 1
 s_lshl_b32 s46, s46, 6
 s_add_u32 s45, s45, s46
 s_add_u32 s37, s37, s45
 v_mul_u32_u24 v6, 2304, v13
 v_lshl_add_u32 v6, v14, 4, v6
 v_lshl_add_u32 v13, v14, 2, v13
 v_and_b32 v13, 15, v13
 v_lshlrev_b32 v13, 4, v13
 s_lshl_b32 s45, s4, 11
 v_lshl_add_u32 v12, v14, 9, v13
 v_add_u32 v12, s45, v12
 v_lshrrev_b32 v13, 5, v15
 v_lshl_add_u32 v13, v13, 2, v15
 v_and_b32 v13, 15, v13
 v_and_or_b32 v13, v15, 48, v13
 v_lshlrev_b32 v13, 4, v13
 v_xor_b32 v14, 0x80, v13
 v_add_u32 v15, s49, v14
 v_add_u32 v14, s49, v13
 v_add_u32 v4, 32768, v12
 v_add_u32 v7, 114688, v12
 s_lshl_b32 s45, s32, 7
 s_add_u32 s37, s37, s45
 s_lshl_b32 s45, s4, 16
 s_add_u32 s36, s36, s45
 s_mov_b32 s42, s33
 s_mov_b32 s43, 0
 s_and_b32 s53, s42, s93
 s_lshl_b32 s53, s53, s91
 s_add_u32 s53, s53, s38
 s_lshr_b32 s51, s42, s90
 s_add_u32 s51, s51, 1
 ds_read_b128 v[16:19], v5 offset:0
 ds_read_b128 v[20:23], v5 offset:1024
Los0_33:
 buffer_load_dword v2, v3, s[20:23], s53 offen sc1
 s_waitcnt vmcnt(0)
 v_cmp_gt_u32 vcc, s51, v2
 s_and_b32 s52, vcc_lo, 0xffff
 s_cbranch_scc0 Los0k_34
 s_sleep 4
 s_sub_u32 s50, s50, 1
 s_cbranch_scc0 Los0_33
 s_endpgm
Los0k_34:
 s_lshl_b32 s48, s42, 18
 s_add_u32 s48, s48, s36
 s_add_u32 s52, s44, 0
 s_and_b32 s52, s52, 7
 s_lshl_b32 s52, s52, 13
 s_add_u32 s46, s48, s52
 s_add_u32 s47, s46, 4096
 buffer_load_dwordx4 v[32:35], v1, s[20:23], s46 offen offset:0 sc1
 buffer_load_dwordx4 v[36:39], v1, s[20:23], s46 offen offset:1024 sc1
 buffer_load_dwordx4 v[40:43], v1, s[20:23], s46 offen offset:2048 sc1
 buffer_load_dwordx4 v[44:47], v1, s[20:23], s46 offen offset:3072 sc1
 buffer_load_dwordx4 v[48:51], v1, s[20:23], s47 offen offset:0 sc1
 buffer_load_dwordx4 v[52:55], v1, s[20:23], s47 offen offset:1024 sc1
 buffer_load_dwordx4 v[56:59], v1, s[20:23], s47 offen offset:2048 sc1
 buffer_load_dwordx4 v[60:63], v1, s[20:23], s47 offen offset:3072 sc1
 s_add_u32 s52, s44, 1
 s_and_b32 s52, s52, 7
 s_lshl_b32 s52, s52, 13
 s_add_u32 s46, s48, s52
 s_add_u32 s47, s46, 4096
 buffer_load_dwordx4 v[64:67], v1, s[20:23], s46 offen offset:0 sc1
 buffer_load_dwordx4 v[68:71], v1, s[20:23], s46 offen offset:1024 sc1
 buffer_load_dwordx4 v[72:75], v1, s[20:23], s46 offen offset:2048 sc1
 buffer_load_dwordx4 v[76:79], v1, s[20:23], s46 offen offset:3072 sc1
 buffer_load_dwordx4 v[80:83], v1, s[20:23], s47 offen offset:0 sc1
 buffer_load_dwordx4 v[84:87], v1, s[20:23], s47 offen offset:1024 sc1
 buffer_load_dwordx4 v[88:91], v1, s[20:23], s47 offen offset:2048 sc1
 buffer_load_dwordx4 v[92:95], v1, s[20:23], s47 offen offset:3072 sc1
 .p2align 3
Losl_35:
 s_waitcnt vmcnt(14) lgkmcnt(1)
 v_mfma_f32_16x16x32_bf16 v[96:99], a[0:3], v[32:35], 0
 s_add_u32 s52, s44, 2
 s_and_b32 s52, s52, 7
 v_mfma_f32_16x16x32_bf16 v[100:103], a[4:7], v[32:35], 0
 s_lshl_b32 s52, s52, 13
 s_add_u32 s46, s48, s52
 v_mfma_f32_16x16x32_bf16 v[104:107], a[8:11], v[32:35], 0
 s_add_u32 s47, s46, 4096
 v_mfma_f32_16x16x32_bf16 v[108:111], v[16:19], v[32:35], 0
 buffer_load_dwordx4 v[32:35], v1, s[20:23], s46 offen offset:0 sc1
 v_mfma_f32_16x16x32_bf16 v[112:115], a[0:3], v[36:39], 0
 ds_read_b128 v[24:27], v5 offset:2048
 v_mfma_f32_16x16x32_bf16 v[116:119], a[4:7], v[36:39], 0
 v_mfma_f32_16x16x32_bf16 v[120:123], a[8:11], v[36:39], 0
 v_mfma_f32_16x16x32_bf16 v[124:127], v[16:19], v[36:39], 0
 buffer_load_dwordx4 v[36:39], v1, s[20:23], s46 offen offset:1024 sc1
 s_waitcnt vmcnt(14) lgkmcnt(1)
 v_mfma_f32_16x16x32_bf16 v[96:99], a[12:15], v[40:43], v[96:99]
 s_mov_b32 s41, s42
 s_add_u32 s43, s43, 1
 v_mfma_f32_16x16x32_bf16 v[100:103], a[16:19], v[40:43], v[100:103]
 s_cmp_lt_u32 s43, s35
 s_cselect_b32 s45, s34, 0
 v_mfma_f32_16x16x32_bf16 v[104:107], a[20:23], v[40:43], v[104:107]
 s_xor_b32 s34, s34, s39
 s_add_u32 s42, s42, s45
 v_mfma_f32_16x16x32_bf16 v[108:111], v[20:23], v[40:43], v[108:111]
 buffer_load_dwordx4 v[40:43], v1, s[20:23], s46 offen offset:2048 sc1
 v_mfma_f32_16x16x32_bf16 v[112:115], a[12:15], v[44:47], v[112:115]
 ds_read_b128 v[28:31], v5 offset:3072
 v_mfma_f32_16x16x32_bf16 v[116:119], a[16:19], v[44:47], v[116:119]
 v_mfma_f32_16x16x32_bf16 v[120:123], a[20:23], v[44:47], v[120:123]
 v_mfma_f32_16x16x32_bf16 v[124:127], v[20:23], v[44:47], v[124:127]
 buffer_load_dwordx4 v[44:47], v1, s[20:23], s46 offen offset:3072 sc1
 s_waitcnt vmcnt(14) lgkmcnt(1)
 v_mfma_f32_16x16x32_bf16 v[96:99], a[24:27], v[48:51], v[96:99]
 s_and_b32 s53, s42, s93
 s_lshl_b32 s53, s53, s91
 v_mfma_f32_16x16x32_bf16 v[100:103], a[28:31], v[48:51], v[100:103]
 s_add_u32 s53, s53, s38
 s_lshr_b32 s51, s42, s90
 v_mfma_f32_16x16x32_bf16 v[104:107], a[32:35], v[48:51], v[104:107]
 s_add_u32 s51, s51, 1
 v_mfma_f32_16x16x32_bf16 v[108:111], v[24:27], v[48:51], v[108:111]
 buffer_load_dwordx4 v[48:51], v1, s[20:23], s47 offen offset:0 sc1
 v_mfma_f32_16x16x32_bf16 v[112:115], a[24:27], v[52:55], v[112:115]
 ds_read_b128 v[16:19], v5 offset:4096
 v_mfma_f32_16x16x32_bf16 v[116:119], a[28:31], v[52:55], v[116:119]
 v_mfma_f32_16x16x32_bf16 v[120:123], a[32:35], v[52:55], v[120:123]
 v_mfma_f32_16x16x32_bf16 v[124:127], v[24:27], v[52:55], v[124:127]
 buffer_load_dwordx4 v[52:55], v1, s[20:23], s47 offen offset:1024 sc1
 s_waitcnt vmcnt(14) lgkmcnt(1)
 v_mfma_f32_16x16x32_bf16 v[96:99], a[36:39], v[56:59], v[96:99]
 s_mul_i32 s54, s41, 73728
 s_add_u32 s54, s54, s37
 v_mfma_f32_16x16x32_bf16 v[100:103], a[40:43], v[56:59], v[100:103]
 v_mfma_f32_16x16x32_bf16 v[104:107], a[44:47], v[56:59], v[104:107]
 v_mfma_f32_16x16x32_bf16 v[108:111], v[28:31], v[56:59], v[108:111]
 buffer_load_dwordx4 v[56:59], v1, s[20:23], s47 offen offset:2048 sc1
 v_mfma_f32_16x16x32_bf16 v[112:115], a[36:39], v[60:63], v[112:115]
 ds_read_b128 v[20:23], v5 offset:5120
 v_mfma_f32_16x16x32_bf16 v[116:119], a[40:43], v[60:63], v[116:119]
 v_mfma_f32_16x16x32_bf16 v[120:123], a[44:47], v[60:63], v[120:123]
 v_mfma_f32_16x16x32_bf16 v[124:127], v[28:31], v[60:63], v[124:127]
 buffer_load_dwordx4 v[60:63], v1, s[20:23], s47 offen offset:3072 sc1
 s_waitcnt vmcnt(14) lgkmcnt(1)
 v_mfma_f32_16x16x32_bf16 v[96:99], a[48:51], v[64:67], v[96:99]
 s_add_u32 s52, s44, 3
 s_and_b32 s52, s52, 7
 v_mfma_f32_16x16x32_bf16 v[100:103], a[52:55], v[64:67], v[100:103]
 s_lshl_b32 s52, s52, 13
 s_add_u32 s46, s48, s52
 v_mfma_f32_16x16x32_bf16 v[104:107], a[56:59], v[64:67], v[104:107]
 s_add_u32 s47, s46, 4096
 v_mfma_f32_16x16x32_bf16 v[108:111], v[16:19], v[64:67], v[108:111]
 buffer_load_dwordx4 v[64:67], v1, s[20:23], s46 offen offset:0 sc1
 v_mfma_f32_16x16x32_bf16 v[112:115], a[48:51], v[68:71], v[112:115]
 ds_read_b128 v[24:27], v5 offset:6144
 v_mfma_f32_16x16x32_bf16 v[116:119], a[52:55], v[68:71], v[116:119]
 v_mfma_f32_16x16x32_bf16 v[120:123], a[56:59], v[68:71], v[120:123]
 v_mfma_f32_16x16x32_bf16 v[124:127], v[16:19], v[68:71], v[124:127]
 buffer_load_dwordx4 v[68:71], v1, s[20:23], s46 offen offset:1024 sc1
 s_waitcnt vmcnt(14) lgkmcnt(1)
 v_mfma_f32_16x16x32_bf16 v[96:99], a[60:63], v[72:75], v[96:99]
 v_mfma_f32_16x16x32_bf16 v[100:103], a[64:67], v[72:75], v[100:103]
 v_mfma_f32_16x16x32_bf16 v[104:107], a[68:71], v[72:75], v[104:107]
 v_mfma_f32_16x16x32_bf16 v[108:111], v[20:23], v[72:75], v[108:111]
 buffer_load_dwordx4 v[72:75], v1, s[20:23], s46 offen offset:2048 sc1
 v_mfma_f32_16x16x32_bf16 v[112:115], a[60:63], v[76:79], v[112:115]
 ds_read_b128 v[28:31], v5 offset:7168
 v_mfma_f32_16x16x32_bf16 v[116:119], a[64:67], v[76:79], v[116:119]
 v_mfma_f32_16x16x32_bf16 v[120:123], a[68:71], v[76:79], v[120:123]
 v_mfma_f32_16x16x32_bf16 v[124:127], v[20:23], v[76:79], v[124:127]
 buffer_load_dwordx4 v[76:79], v1, s[20:23], s46 offen offset:3072 sc1
 s_waitcnt vmcnt(14) lgkmcnt(1)
 v_mfma_f32_16x16x32_bf16 v[96:99], a[72:75], v[80:83], v[96:99]
 v_mfma_f32_16x16x32_bf16 v[100:103], a[76:79], v[80:83], v[100:103]
 v_mfma_f32_16x16x32_bf16 v[104:107], a[80:83], v[80:83], v[104:107]
 v_mfma_f32_16x16x32_bf16 v[108:111], v[24:27], v[80:83], v[108:111]
 buffer_load_dwordx4 v[80:83], v1, s[20:23], s47 offen offset:0 sc1
 v_mfma_f32_16x16x32_bf16 v[112:115], a[72:75], v[84:87], v[112:115]
 ds_read_b128 v[16:19], v5 offset:8192
 v_mfma_f32_16x16x32_bf16 v[116:119], a[76:79], v[84:87], v[116:119]
 v_mfma_f32_16x16x32_bf16 v[120:123], a[80:83], v[84:87], v[120:123]
 v_mfma_f32_16x16x32_bf16 v[124:127], v[24:27], v[84:87], v[124:127]
 buffer_load_dwordx4 v[84:87], v1, s[20:23], s47 offen offset:1024 sc1
 s_waitcnt vmcnt(14) lgkmcnt(1)
 v_mfma_f32_16x16x32_bf16 v[96:99], a[84:87], v[88:91], v[96:99]
 v_mfma_f32_16x16x32_bf16 v[100:103], a[88:91], v[88:91], v[100:103]
 v_mfma_f32_16x16x32_bf16 v[104:107], a[92:95], v[88:91], v[104:107]
 v_mfma_f32_16x16x32_bf16 v[108:111], v[28:31], v[88:91], v[108:111]
 buffer_load_dwordx4 v[88:91], v1, s[20:23], s47 offen offset:2048 sc1
 v_mfma_f32_16x16x32_bf16 v[112:115], a[84:87], v[92:95], v[112:115]
 ds_read_b128 v[20:23], v5 offset:9216
 v_mfma_f32_16x16x32_bf16 v[116:119], a[88:91], v[92:95], v[116:119]
 v_mfma_f32_16x16x32_bf16 v[120:123], a[92:95], v[92:95], v[120:123]
 v_mfma_f32_16x16x32_bf16 v[124:127], v[28:31], v[92:95], v[124:127]
 buffer_load_dwordx4 v[92:95], v1, s[20:23], s47 offen offset:3072 sc1
 s_waitcnt vmcnt(14) lgkmcnt(1)
 v_mfma_f32_16x16x32_bf16 v[96:99], a[96:99], v[32:35], v[96:99]
 s_add_u32 s52, s44, 4
 s_and_b32 s52, s52, 7
 v_mfma_f32_16x16x32_bf16 v[100:103], a[100:103], v[32:35], v[100:103]
 s_lshl_b32 s52, s52, 13
 s_add_u32 s46, s48, s52
 v_mfma_f32_16x16x32_bf16 v[104:107], a[104:107], v[32:35], v[104:107]
 s_add_u32 s47, s46, 4096
 v_mfma_f32_16x16x32_bf16 v[108:111], v[16:19], v[32:35], v[108:111]
 buffer_load_dwordx4 v[32:35], v1, s[20:23], s46 offen offset:0 sc1
 v_mfma_f32_16x16x32_bf16 v[112:115], a[96:99], v[36:39], v[112:115]
 ds_read_b128 v[24:27], v5 offset:10240
 v_mfma_f32_16x16x32_bf16 v[116:119], a[100:103], v[36:39], v[116:119]
 v_mfma_f32_16x16x32_bf16 v[120:123], a[104:107], v[36:39], v[120:123]
 v_mfma_f32_16x16x32_bf16 v[124:127], v[16:19], v[36:39], v[124:127]
 buffer_load_dwordx4 v[36:39], v1, s[20:23], s46 offen offset:1024 sc1
 s_waitcnt vmcnt(14) lgkmcnt(1)
 v_mfma_f32_16x16x32_bf16 v[96:99], a[108:111], v[40:43], v[96:99]
 v_mfma_f32_16x16x32_bf16 v[100:103], a[112:115], v[40:43], v[100:103]
 v_mfma_f32_16x16x32_bf16 v[104:107], a[116:119], v[40:43], v[104:107]
 v_mfma_f32_16x16x32_bf16 v[108:111], v[20:23], v[40:43], v[108:111]
 buffer_load_dwordx4 v[40:43], v1, s[20:23], s46 offen offset:2048 sc1
 v_mfma_f32_16x16x32_bf16 v[112:115], a[108:111], v[44:47], v[112:115]
 ds_read_b128 v[28:31], v5 offset:11264
 v_mfma_f32_16x16x32_bf16 v[116:119], a[112:115], v[44:47], v[116:119]
 v_mfma_f32_16x16x32_bf16 v[120:123], a[116:119], v[44:47], v[120:123]
 v_mfma_f32_16x16x32_bf16 v[124:127], v[20:23], v[44:47], v[124:127]
 buffer_load_dwordx4 v[44:47], v1, s[20:23], s46 offen offset:3072 sc1
 s_waitcnt vmcnt(14) lgkmcnt(1)
 v_mfma_f32_16x16x32_bf16 v[96:99], a[120:123], v[48:51], v[96:99]
 s_barrier
 v_mfma_f32_16x16x32_bf16 v[100:103], a[124:127], v[48:51], v[100:103]
 v_mfma_f32_16x16x32_bf16 v[104:107], a[128:131], v[48:51], v[104:107]
 v_mfma_f32_16x16x32_bf16 v[108:111], v[24:27], v[48:51], v[108:111]
 buffer_load_dwordx4 v[48:51], v1, s[20:23], s47 offen offset:0 sc1
 v_mfma_f32_16x16x32_bf16 v[112:115], a[120:123], v[52:55], v[112:115]
 ds_read_b128 v[16:19], v5 offset:12288
 v_mfma_f32_16x16x32_bf16 v[116:119], a[124:127], v[52:55], v[116:119]
 v_mfma_f32_16x16x32_bf16 v[120:123], a[128:131], v[52:55], v[120:123]
 v_mfma_f32_16x16x32_bf16 v[124:127], v[24:27], v[52:55], v[124:127]
 buffer_load_dwordx4 v[52:55], v1, s[20:23], s47 offen offset:1024 sc1
 s_waitcnt vmcnt(14) lgkmcnt(1)
 v_mfma_f32_16x16x32_bf16 v[96:99], a[132:135], v[56:59], v[96:99]
 v_mfma_f32_16x16x32_bf16 v[100:103], a[136:139], v[56:59], v[100:103]
 v_mfma_f32_16x16x32_bf16 v[104:107], a[140:143], v[56:59], v[104:107]
 v_mfma_f32_16x16x32_bf16 v[108:111], v[28:31], v[56:59], v[108:111]
 buffer_load_dwordx4 v[56:59], v1, s[20:23], s47 offen offset:2048 sc1
 v_mfma_f32_16x16x32_bf16 v[112:115], a[132:135], v[60:63], v[112:115]
 ds_read_b128 v[20:23], v5 offset:13312
 v_mfma_f32_16x16x32_bf16 v[116:119], a[136:139], v[60:63], v[116:119]
 v_mfma_f32_16x16x32_bf16 v[120:123], a[140:143], v[60:63], v[120:123]
 v_mfma_f32_16x16x32_bf16 v[124:127], v[28:31], v[60:63], v[124:127]
 buffer_load_dwordx4 v[60:63], v1, s[20:23], s47 offen offset:3072 sc1
 s_waitcnt vmcnt(14) lgkmcnt(1)
 v_mfma_f32_16x16x32_bf16 v[96:99], a[144:147], v[64:67], v[96:99]
 s_add_u32 s52, s44, 5
 s_and_b32 s52, s52, 7
 v_mfma_f32_16x16x32_bf16 v[100:103], a[148:151], v[64:67], v[100:103]
 s_lshl_b32 s52, s52, 13
 s_add_u32 s46, s48, s52
 v_mfma_f32_16x16x32_bf16 v[104:107], a[152:155], v[64:67], v[104:107]
 s_add_u32 s47, s46, 4096
 v_mfma_f32_16x16x32_bf16 v[108:111], v[16:19], v[64:67], v[108:111]
 buffer_load_dwordx4 v[64:67], v1, s[20:23], s46 offen offset:0 sc1
 v_mfma_f32_16x16x32_bf16 v[112:115], a[144:147], v[68:71], v[112:115]
 ds_read_b128 v[24:27], v5 offset:14336
 v_mfma_f32_16x16x32_bf16 v[116:119], a[148:151], v[68:71], v[116:119]
 v_mfma_f32_16x16x32_bf16 v[120:123], a[152:155], v[68:71], v[120:123]
 v_mfma_f32_16x16x32_bf16 v[124:127], v[16:19], v[68:71], v[124:127]
 buffer_load_dwordx4 v[68:71], v1, s[20:23], s46 offen offset:1024 sc1
 s_waitcnt vmcnt(14) lgkmcnt(1)
 v_mfma_f32_16x16x32_bf16 v[96:99], a[156:159], v[72:75], v[96:99]
 buffer_load_dword v2, v3, s[20:23], s53 offen sc1
 v_mfma_f32_16x16x32_bf16 v[100:103], a[160:163], v[72:75], v[100:103]
 v_mfma_f32_16x16x32_bf16 v[104:107], a[164:167], v[72:75], v[104:107]
 v_mfma_f32_16x16x32_bf16 v[108:111], v[20:23], v[72:75], v[108:111]
 buffer_load_dwordx4 v[72:75], v1, s[20:23], s46 offen offset:2048 sc1
 v_mfma_f32_16x16x32_bf16 v[112:115], a[156:159], v[76:79], v[112:115]
 ds_read_b128 v[28:31], v5 offset:15360
 v_mfma_f32_16x16x32_bf16 v[116:119], a[160:163], v[76:79], v[116:119]
 v_mfma_f32_16x16x32_bf16 v[120:123], a[164:167], v[76:79], v[120:123]
 v_mfma_f32_16x16x32_bf16 v[124:127], v[20:23], v[76:79], v[124:127]
 buffer_load_dwordx4 v[76:79], v1, s[20:23], s46 offen offset:3072 sc1
 s_waitcnt vmcnt(14) lgkmcnt(1)
 v_mfma_f32_16x16x32_bf16 v[96:99], a[168:171], v[80:83], v[96:99]
 v_mfma_f32_16x16x32_bf16 v[100:103], a[172:175], v[80:83], v[100:103]
 v_mfma_f32_16x16x32_bf16 v[104:107], a[176:179], v[80:83], v[104:107]
 v_mfma_f32_16x16x32_bf16 v[108:111], v[24:27], v[80:83], v[108:111]
 buffer_load_dwordx4 v[80:83], v1, s[20:23], s47 offen offset:0 sc1
 v_mfma_f32_16x16x32_bf16 v[112:115], a[168:171], v[84:87], v[112:115]
 ds_read_b128 v[16:19], v5 offset:16384
 v_mfma_f32_16x16x32_bf16 v[116:119], a[172:175], v[84:87], v[116:119]
 v_mfma_f32_16x16x32_bf16 v[120:123], a[176:179], v[84:87], v[120:123]
 v_mfma_f32_16x16x32_bf16 v[124:127], v[24:27], v[84:87], v[124:127]
 buffer_load_dwordx4 v[84:87], v1, s[20:23], s47 offen offset:1024 sc1
 s_waitcnt vmcnt(14) lgkmcnt(1)
 v_mfma_f32_16x16x32_bf16 v[96:99], a[180:183], v[88:91], v[96:99]
 v_mfma_f32_16x16x32_bf16 v[100:103], a[184:187], v[88:91], v[100:103]
 v_mfma_f32_16x16x32_bf16 v[104:107], a[188:191], v[88:91], v[104:107]
 v_mfma_f32_16x16x32_bf16 v[108:111], v[28:31], v[88:91], v[108:111]
 buffer_load_dwordx4 v[88:91], v1, s[20:23], s47 offen offset:2048 sc1
 v_mfma_f32_16x16x32_bf16 v[112:115], a[180:183], v[92:95], v[112:115]
 ds_read_b128 v[20:23], v5 offset:17408
 v_mfma_f32_16x16x32_bf16 v[116:119], a[184:187], v[92:95], v[116:119]
 v_mfma_f32_16x16x32_bf16 v[120:123], a[188:191], v[92:95], v[120:123]
 v_mfma_f32_16x16x32_bf16 v[124:127], v[28:31], v[92:95], v[124:127]
 buffer_load_dwordx4 v[92:95], v1, s[20:23], s47 offen offset:3072 sc1
 s_waitcnt vmcnt(14) lgkmcnt(1)
 v_mfma_f32_16x16x32_bf16 v[96:99], a[192:195], v[32:35], v[96:99]
 s_add_u32 s52, s44, 6
 s_and_b32 s52, s52, 7
 v_mfma_f32_16x16x32_bf16 v[100:103], a[196:199], v[32:35], v[100:103]
 s_lshl_b32 s52, s52, 13
 s_add_u32 s46, s48, s52
 v_mfma_f32_16x16x32_bf16 v[104:107], a[200:203], v[32:35], v[104:107]
 s_add_u32 s47, s46, 4096
 v_mfma_f32_16x16x32_bf16 v[108:111], v[16:19], v[32:35], v[108:111]
 buffer_load_dwordx4 v[32:35], v1, s[20:23], s46 offen offset:0 sc1
 v_mfma_f32_16x16x32_bf16 v[112:115], a[192:195], v[36:39], v[112:115]
 ds_read_b128 v[24:27], v5 offset:18432
 v_mfma_f32_16x16x32_bf16 v[116:119], a[196:199], v[36:39], v[116:119]
 v_mfma_f32_16x16x32_bf16 v[120:123], a[200:203], v[36:39], v[120:123]
 v_mfma_f32_16x16x32_bf16 v[124:127], v[16:19], v[36:39], v[124:127]
 buffer_load_dwordx4 v[36:39], v1, s[20:23], s46 offen offset:1024 sc1
 s_waitcnt vmcnt(14) lgkmcnt(1)
 v_mfma_f32_16x16x32_bf16 v[96:99], a[204:207], v[40:43], v[96:99]
 v_mfma_f32_16x16x32_bf16 v[100:103], a[208:211], v[40:43], v[100:103]
 v_mfma_f32_16x16x32_bf16 v[104:107], a[212:215], v[40:43], v[104:107]
 v_mfma_f32_16x16x32_bf16 v[108:111], v[20:23], v[40:43], v[108:111]
 buffer_load_dwordx4 v[40:43], v1, s[20:23], s46 offen offset:2048 sc1
 v_mfma_f32_16x16x32_bf16 v[112:115], a[204:207], v[44:47], v[112:115]
 ds_read_b128 v[28:31], v5 offset:19456
 v_mfma_f32_16x16x32_bf16 v[116:119], a[208:211], v[44:47], v[116:119]
 v_mfma_f32_16x16x32_bf16 v[120:123], a[212:215], v[44:47], v[120:123]
 v_mfma_f32_16x16x32_bf16 v[124:127], v[20:23], v[44:47], v[124:127]
 buffer_load_dwordx4 v[44:47], v1, s[20:23], s46 offen offset:3072 sc1
 s_waitcnt vmcnt(14) lgkmcnt(1)
 v_mfma_f32_16x16x32_bf16 v[96:99], a[216:219], v[48:51], v[96:99]
 v_mfma_f32_16x16x32_bf16 v[100:103], a[220:223], v[48:51], v[100:103]
 v_mfma_f32_16x16x32_bf16 v[104:107], a[224:227], v[48:51], v[104:107]
 v_mfma_f32_16x16x32_bf16 v[108:111], v[24:27], v[48:51], v[108:111]
 buffer_load_dwordx4 v[48:51], v1, s[20:23], s47 offen offset:0 sc1
 v_mfma_f32_16x16x32_bf16 v[112:115], a[216:219], v[52:55], v[112:115]
 ds_read_b128 v[16:19], v5 offset:20480
 v_mfma_f32_16x16x32_bf16 v[116:119], a[220:223], v[52:55], v[116:119]
 v_mfma_f32_16x16x32_bf16 v[120:123], a[224:227], v[52:55], v[120:123]
 v_mfma_f32_16x16x32_bf16 v[124:127], v[24:27], v[52:55], v[124:127]
 buffer_load_dwordx4 v[52:55], v1, s[20:23], s47 offen offset:1024 sc1
 s_waitcnt vmcnt(14) lgkmcnt(1)
 v_mfma_f32_16x16x32_bf16 v[96:99], a[228:231], v[56:59], v[96:99]
 v_mfma_f32_16x16x32_bf16 v[100:103], a[232:235], v[56:59], v[100:103]
 v_mfma_f32_16x16x32_bf16 v[104:107], a[236:239], v[56:59], v[104:107]
 v_mfma_f32_16x16x32_bf16 v[108:111], v[28:31], v[56:59], v[108:111]
 buffer_load_dwordx4 v[56:59], v1, s[20:23], s47 offen offset:2048 sc1
 v_mfma_f32_16x16x32_bf16 v[112:115], a[228:231], v[60:63], v[112:115]
 ds_read_b128 v[20:23], v5 offset:21504
 v_mfma_f32_16x16x32_bf16 v[116:119], a[232:235], v[60:63], v[116:119]
 v_mfma_f32_16x16x32_bf16 v[120:123], a[236:239], v[60:63], v[120:123]
 v_mfma_f32_16x16x32_bf16 v[124:127], v[28:31], v[60:63], v[124:127]
 buffer_load_dwordx4 v[60:63], v1, s[20:23], s47 offen offset:3072 sc1
 s_waitcnt vmcnt(14) lgkmcnt(1)
 v_mfma_f32_16x16x32_bf16 v[96:99], a[240:243], v[64:67], v[96:99]
 s_add_u32 s52, s44, 7
 s_and_b32 s52, s52, 7
 v_mfma_f32_16x16x32_bf16 v[100:103], a[244:247], v[64:67], v[100:103]
 s_lshl_b32 s52, s52, 13
 s_add_u32 s46, s48, s52
 v_mfma_f32_16x16x32_bf16 v[104:107], a[248:251], v[64:67], v[104:107]
 s_add_u32 s47, s46, 4096
 v_mfma_f32_16x16x32_bf16 v[108:111], v[16:19], v[64:67], v[108:111]
 buffer_load_dwordx4 v[64:67], v1, s[20:23], s46 offen offset:0 sc1
 v_mfma_f32_16x16x32_bf16 v[112:115], a[240:243], v[68:71], v[112:115]
 ds_read_b128 v[24:27], v5 offset:22528
 v_mfma_f32_16x16x32_bf16 v[116:119], a[244:247], v[68:71], v[116:119]
 v_mfma_f32_16x16x32_bf16 v[120:123], a[248:251], v[68:71], v[120:123]
 v_mfma_f32_16x16x32_bf16 v[124:127], v[16:19], v[68:71], v[124:127]
 buffer_load_dwordx4 v[68:71], v1, s[20:23], s46 offen offset:1024 sc1
 s_waitcnt vmcnt(14) lgkmcnt(1)
 v_mfma_f32_16x16x32_bf16 v[96:99], a[252:255], v[72:75], v[96:99]
 v_mfma_f32_16x16x32_bf16 v[100:103], v[128:131], v[72:75], v[100:103]
 v_mfma_f32_16x16x32_bf16 v[104:107], v[132:135], v[72:75], v[104:107]
 v_mfma_f32_16x16x32_bf16 v[108:111], v[20:23], v[72:75], v[108:111]
 buffer_load_dwordx4 v[72:75], v1, s[20:23], s46 offen offset:2048 sc1
 v_mfma_f32_16x16x32_bf16 v[112:115], a[252:255], v[76:79], v[112:115]
 ds_read_b128 v[28:31], v5 offset:23552
 v_mfma_f32_16x16x32_bf16 v[116:119], v[128:131], v[76:79], v[116:119]
 v_mfma_f32_16x16x32_bf16 v[120:123], v[132:135], v[76:79], v[120:123]
 v_mfma_f32_16x16x32_bf16 v[124:127], v[20:23], v[76:79], v[124:127]
 buffer_load_dwordx4 v[76:79], v1, s[20:23], s46 offen offset:3072 sc1
 s_waitcnt vmcnt(14) lgkmcnt(1)
 v_mfma_f32_16x16x32_bf16 v[96:99], v[136:139], v[80:83], v[96:99]
 v_cmp_gt_u32 vcc, s51, v2
 v_mfma_f32_16x16x32_bf16 v[100:103], v[140:143], v[80:83], v[100:103]
 v_mfma_f32_16x16x32_bf16 v[104:107], v[144:147], v[80:83], v[104:107]
 v_mfma_f32_16x16x32_bf16 v[108:111], v[24:27], v[80:83], v[108:111]
 buffer_load_dwordx4 v[80:83], v1, s[20:23], s47 offen offset:0 sc1
 v_mfma_f32_16x16x32_bf16 v[112:115], v[136:139], v[84:87], v[112:115]
 ds_read_b128 v[16:19], v5 offset:24576
 v_mfma_f32_16x16x32_bf16 v[116:119], v[140:143], v[84:87], v[116:119]
 v_mfma_f32_16x16x32_bf16 v[120:123], v[144:147], v[84:87], v[120:123]
 v_mfma_f32_16x16x32_bf16 v[124:127], v[24:27], v[84:87], v[124:127]
 buffer_load_dwordx4 v[84:87], v1, s[20:23], s47 offen offset:1024 sc1
 s_waitcnt vmcnt(14) lgkmcnt(1)
 v_mfma_f32_16x16x32_bf16 v[96:99], v[148:151], v[88:91], v[96:99]
 s_and_b32 s52, vcc_lo, 0xffff
 s_cbranch_scc1 Losw_36
Loswk_37:
 v_mfma_f32_16x16x32_bf16 v[100:103], v[152:155], v[88:91], v[100:103]
 s_lshl_b32 s48, s42, 18
 s_add_u32 s48, s48, s36
 v_mfma_f32_16x16x32_bf16 v[104:107], v[156:159], v[88:91], v[104:107]
 v_mfma_f32_16x16x32_bf16 v[108:111], v[28:31], v[88:91], v[108:111]
 buffer_load_dwordx4 v[88:91], v1, s[20:23], s47 offen offset:2048 sc1
 v_mfma_f32_16x16x32_bf16 v[112:115], v[148:151], v[92:95], v[112:115]
 ds_read_b128 v[20:23], v5 offset:25600
 v_mfma_f32_16x16x32_bf16 v[116:119], v[152:155], v[92:95], v[116:119]
 v_mfma_f32_16x16x32_bf16 v[120:123], v[156:159], v[92:95], v[120:123]
 v_mfma_f32_16x16x32_bf16 v[124:127], v[28:31], v[92:95], v[124:127]
 buffer_load_dwordx4 v[92:95], v1, s[20:23], s47 offen offset:3072 sc1
 s_waitcnt vmcnt(14) lgkmcnt(1)
 v_mfma_f32_16x16x32_bf16 v[96:99], v[160:163], v[32:35], v[96:99]
 s_add_u32 s52, s44, 0
 s_and_b32 s52, s52, 7
 v_mfma_f32_16x16x32_bf16 v[100:103], v[164:167], v[32:35], v[100:103]
 s_lshl_b32 s52, s52, 13
 s_add_u32 s46, s48, s52
 v_mfma_f32_16x16x32_bf16 v[104:107], v[168:171], v[32:35], v[104:107]
 s_add_u32 s47, s46, 4096
 v_mfma_f32_16x16x32_bf16 v[108:111], v[16:19], v[32:35], v[108:111]
 buffer_load_dwordx4 v[32:35], v1, s[20:23], s46 offen offset:0 sc1
 v_mfma_f32_16x16x32_bf16 v[112:115], v[160:163], v[36:39], v[112:115]
 ds_read_b128 v[24:27], v5 offset:26624
 v_mfma_f32_16x16x32_bf16 v[116:119], v[164:167], v[36:39], v[116:119]
 v_mfma_f32_16x16x32_bf16 v[120:123], v[168:171], v[36:39], v[120:123]
 v_mfma_f32_16x16x32_bf16 v[124:127], v[16:19], v[36:39], v[124:127]
 buffer_load_dwordx4 v[36:39], v1, s[20:23], s46 offen offset:1024 sc1
 s_waitcnt vmcnt(14) lgkmcnt(1)
 v_mfma_f32_16x16x32_bf16 v[96:99], v[172:175], v[40:43], v[96:99]
 v_mfma_f32_16x16x32_bf16 v[100:103], v[176:179], v[40:43], v[100:103]
 v_mfma_f32_16x16x32_bf16 v[104:107], v[180:183], v[40:43], v[104:107]
 v_mfma_f32_16x16x32_bf16 v[108:111], v[20:23], v[40:43], v[108:111]
 buffer_load_dwordx4 v[40:43], v1, s[20:23], s46 offen offset:2048 sc1
 v_mfma_f32_16x16x32_bf16 v[112:115], v[172:175], v[44:47], v[112:115]
 ds_read_b128 v[28:31], v5 offset:27648
 v_mfma_f32_16x16x32_bf16 v[116:119], v[176:179], v[44:47], v[116:119]
 v_mfma_f32_16x16x32_bf16 v[120:123], v[180:183], v[44:47], v[120:123]
 v_mfma_f32_16x16x32_bf16 v[124:127], v[20:23], v[44:47], v[124:127]
 buffer_load_dwordx4 v[44:47], v1, s[20:23], s46 offen offset:3072 sc1
 s_waitcnt vmcnt(14) lgkmcnt(1)
 v_mfma_f32_16x16x32_bf16 v[96:99], v[184:187], v[48:51], v[96:99]
 v_mfma_f32_16x16x32_bf16 v[100:103], v[188:191], v[48:51], v[100:103]
 v_mfma_f32_16x16x32_bf16 v[104:107], v[192:195], v[48:51], v[104:107]
 v_mfma_f32_16x16x32_bf16 v[108:111], v[24:27], v[48:51], v[108:111]
 buffer_load_dwordx4 v[48:51], v1, s[20:23], s47 offen offset:0 sc1
 v_mfma_f32_16x16x32_bf16 v[112:115], v[184:187], v[52:55], v[112:115]
 ds_read_b128 v[16:19], v5 offset:28672
 v_mfma_f32_16x16x32_bf16 v[116:119], v[188:191], v[52:55], v[116:119]
 v_mfma_f32_16x16x32_bf16 v[120:123], v[192:195], v[52:55], v[120:123]
 v_mfma_f32_16x16x32_bf16 v[124:127], v[24:27], v[52:55], v[124:127]
 buffer_load_dwordx4 v[52:55], v1, s[20:23], s47 offen offset:1024 sc1
 s_waitcnt vmcnt(14) lgkmcnt(1)
 v_mfma_f32_16x16x32_bf16 v[96:99], v[196:199], v[56:59], v[96:99]
 v_mfma_f32_16x16x32_bf16 v[100:103], v[200:203], v[56:59], v[100:103]
 v_mfma_f32_16x16x32_bf16 v[104:107], v[204:207], v[56:59], v[104:107]
 v_mfma_f32_16x16x32_bf16 v[108:111], v[28:31], v[56:59], v[108:111]
 buffer_load_dwordx4 v[56:59], v1, s[20:23], s47 offen offset:2048 sc1
 v_mfma_f32_16x16x32_bf16 v[112:115], v[196:199], v[60:63], v[112:115]
 ds_read_b128 v[20:23], v5 offset:29696
 v_mfma_f32_16x16x32_bf16 v[116:119], v[200:203], v[60:63], v[116:119]
 v_mfma_f32_16x16x32_bf16 v[120:123], v[204:207], v[60:63], v[120:123]
 v_mfma_f32_16x16x32_bf16 v[124:127], v[28:31], v[60:63], v[124:127]
 buffer_load_dwordx4 v[60:63], v1, s[20:23], s47 offen offset:3072 sc1
 s_waitcnt vmcnt(14) lgkmcnt(1)
 v_mfma_f32_16x16x32_bf16 v[96:99], v[208:211], v[64:67], v[96:99]
 s_add_u32 s52, s44, 1
 s_and_b32 s52, s52, 7
 v_mfma_f32_16x16x32_bf16 v[100:103], v[212:215], v[64:67], v[100:103]
 s_lshl_b32 s52, s52, 13
 s_add_u32 s46, s48, s52
 v_mfma_f32_16x16x32_bf16 v[104:107], v[216:219], v[64:67], v[104:107]
 s_add_u32 s47, s46, 4096
 v_mfma_f32_16x16x32_bf16 v[108:111], v[16:19], v[64:67], v[108:111]
 buffer_load_dwordx4 v[64:67], v1, s[20:23], s46 offen offset:0 sc1
 v_mfma_f32_16x16x32_bf16 v[112:115], v[208:211], v[68:71], v[112:115]
 ds_read_b128 v[24:27], v5 offset:30720
 v_mfma_f32_16x16x32_bf16 v[116:119], v[212:215], v[68:71], v[116:119]
 v_mfma_f32_16x16x32_bf16 v[120:123], v[216:219], v[68:71], v[120:123]
 v_mfma_f32_16x16x32_bf16 v[124:127], v[16:19], v[68:71], v[124:127]
 buffer_load_dwordx4 v[68:71], v1, s[20:23], s46 offen offset:1024 sc1
 s_waitcnt vmcnt(14) lgkmcnt(1)
 v_mfma_f32_16x16x32_bf16 v[96:99], v[220:223], v[72:75], v[96:99]
 v_mfma_f32_16x16x32_bf16 v[100:103], v[224:227], v[72:75], v[100:103]
 v_mfma_f32_16x16x32_bf16 v[104:107], v[228:231], v[72:75], v[104:107]
 v_mfma_f32_16x16x32_bf16 v[108:111], v[20:23], v[72:75], v[108:111]
 buffer_load_dwordx4 v[72:75], v1, s[20:23], s46 offen offset:2048 sc1
 v_mfma_f32_16x16x32_bf16 v[112:115], v[220:223], v[76:79], v[112:115]
 ds_read_b128 v[28:31], v5 offset:31744
 v_mfma_f32_16x16x32_bf16 v[116:119], v[224:227], v[76:79], v[116:119]
 v_mfma_f32_16x16x32_bf16 v[120:123], v[228:231], v[76:79], v[120:123]
 v_mfma_f32_16x16x32_bf16 v[124:127], v[20:23], v[76:79], v[124:127]
 buffer_load_dwordx4 v[76:79], v1, s[20:23], s46 offen offset:3072 sc1
 s_waitcnt vmcnt(14) lgkmcnt(1)
 v_mfma_f32_16x16x32_bf16 v[96:99], v[232:235], v[80:83], v[96:99]
 v_mfma_f32_16x16x32_bf16 v[100:103], v[236:239], v[80:83], v[100:103]
 v_mfma_f32_16x16x32_bf16 v[104:107], v[240:243], v[80:83], v[104:107]
 v_mfma_f32_16x16x32_bf16 v[108:111], v[24:27], v[80:83], v[108:111]
 buffer_load_dwordx4 v[80:83], v1, s[20:23], s47 offen offset:0 sc1
 v_mfma_f32_16x16x32_bf16 v[112:115], v[232:235], v[84:87], v[112:115]
 ds_read_b128 v[16:19], v5 offset:0
 v_mfma_f32_16x16x32_bf16 v[116:119], v[236:239], v[84:87], v[116:119]
 v_mfma_f32_16x16x32_bf16 v[120:123], v[240:243], v[84:87], v[120:123]
 v_mfma_f32_16x16x32_bf16 v[124:127], v[24:27], v[84:87], v[124:127]
 buffer_load_dwordx4 v[84:87], v1, s[20:23], s47 offen offset:1024 sc1
 s_waitcnt vmcnt(14) lgkmcnt(1)
 v_mfma_f32_16x16x32_bf16 v[96:99], v[244:247], v[88:91], v[96:99]
 v_mfma_f32_16x16x32_bf16 v[100:103], v[248:251], v[88:91], v[100:103]
 v_mfma_f32_16x16x32_bf16 v[104:107], v[252:255], v[88:91], v[104:107]
 v_mfma_f32_16x16x32_bf16 v[108:111], v[28:31], v[88:91], v[108:111]
 buffer_load_dwordx4 v[88:91], v1, s[20:23], s47 offen offset:2048 sc1
 v_mfma_f32_16x16x32_bf16 v[112:115], v[244:247], v[92:95], v[112:115]
 ds_read_b128 v[20:23], v5 offset:1024
 v_mfma_f32_16x16x32_bf16 v[116:119], v[248:251], v[92:95], v[116:119]
 v_mfma_f32_16x16x32_bf16 v[120:123], v[252:255], v[92:95], v[120:123]
 v_mfma_f32_16x16x32_bf16 v[124:127], v[28:31], v[92:95], v[124:127]
 buffer_load_dwordx4 v[92:95], v1, s[20:23], s47 offen offset:3072 sc1
 s_cmp_lt_u32 s43, s35
 ds_write_b128 v14, v[96:99] offset:32768
 ds_write_b128 v15, v[100:103] offset:33792
 ds_write_b128 v14, v[104:107] offset:34816
 ds_write_b128 v15, v[108:111] offset:35840
 ds_write_b128 v14, v[112:115] offset:36864
 ds_write_b128 v15, v[116:119] offset:37888
 ds_write_b128 v14, v[120:123] offset:38912
 ds_write_b128 v15, v[124:127] offset:39936
 s_waitcnt lgkmcnt(0)
 s_barrier
 ds_read_b128 v[96:99], v4 offset:0
 ds_read_b128 v[100:103], v4 offset:256
 ds_read_b128 v[104:107], v4 offset:40960
 ds_read_b128 v[108:111], v4 offset:41216
 ds_read_b128 v[112:115], v7 offset:0
 ds_read_b128 v[116:119], v7 offset:256
 ds_read_b128 v[120:123], v7 offset:40960
 ds_read_b128 v[124:127], v7 offset:41216
 s_waitcnt lgkmcnt(4)
 v_pk_add_f32 v[96:97], v[96:97], v[104:105]
 v_pk_add_f32 v[98:99], v[98:99], v[106:107]
 v_pk_add_f32 v[100:101], v[100:101], v[108:109]
 v_pk_add_f32 v[102:103], v[102:103], v[110:111]
 s_waitcnt lgkmcnt(2)
 v_pk_add_f32 v[96:97], v[96:97], v[112:113]
 v_pk_add_f32 v[98:99], v[98:99], v[114:115]
 v_pk_add_f32 v[100:101], v[100:101], v[116:117]
 v_pk_add_f32 v[102:103], v[102:103], v[118:119]
 s_waitcnt lgkmcnt(0)
 v_pk_add_f32 v[96:97], v[96:97], v[120:121]
 v_pk_add_f32 v[98:99], v[98:99], v[122:123]
 v_pk_add_f32 v[100:101], v[100:101], v[124:125]
 v_pk_add_f32 v[102:103], v[102:103], v[126:127]
 v_cvt_pk_bf16_f32 v8, v96, v97
 v_cvt_pk_bf16_f32 v9, v98, v99
 v_cvt_pk_bf16_f32 v10, v100, v101
 v_cvt_pk_bf16_f32 v11, v102, v103
 buffer_store_dwordx4 v[8:11], v6, s[24:27], s54 offen
 s_cbranch_scc1 Losl_35
 s_branch Lose_38
Losw_36:
 buffer_load_dword v2, v3, s[20:23], s53 offen sc1
 s_waitcnt vmcnt(0)
 v_cmp_gt_u32 vcc, s51, v2
 s_and_b32 s52, vcc_lo, 0xffff
 s_cbranch_scc0 Loswk_37
 s_sleep 4
 s_sub_u32 s50, s50, 1
 s_cbranch_scc0 Losw_36
 s_endpgm
Lose_38:
 s_waitcnt vmcnt(0)
 s_branch Lfin
Lchain:
 s_load_dwordx2 s[8:9], s[0:1], 64
 s_mov_b32 s10, 0x480000
 s_mov_b32 s11, 0x20000
 s_load_dwordx2 s[12:13], s[0:1], 72
 s_mov_b32 s14, 0x480000
 s_mov_b32 s15, 0x20000
 s_load_dwordx2 s[16:17], s[0:1], 80
 s_mov_b32 s18, 0x480000
 s_mov_b32 s19, 0x20000
 s_load_dwordx2 s[24:25], s[0:1], 88
 s_mov_b32 s26, 0x480000
 s_mov_b32 s27, 0x20000
 s_load_dwordx2 s[28:29], s[0:1], 112
 s_mov_b32 s30, 0x100
 s_mov_b32 s31, 0x20000
 s_load_dwordx2 s[32:33], s[0:1], 56
 s_mov_b32 s34, 0x2400
 s_mov_b32 s35, 0x20000
 v_and_b32 v20, 63, v0
 v_lshlrev_b32 v3, 4, v20
 v_mov_b32 v7, 0
 s_mov_b32 s48, 0xcccccccc
 s_mov_b32 s49, 0xcccccccc
 v_mov_b32 v21, 0x44444444
 v_mov_b32 v22, 0xeeeeeeee
 v_cndmask_b32 v5, v21, v22, s[48:49]
 s_mul_i32 s47, s4, 544
 v_lshrrev_b32 v21, 4, v20
 v_lshlrev_b32 v21, 7, v21
 v_and_b32 v22, 32, v20
 v_add3_u32 v21, v21, v22, s47
 v_and_b32 v22, 15, v20
 v_lshl_add_u32 v8, v22, 3, v21
 v_lshrrev_b32 v21, 5, v20
 v_mul_u32_u24 v21, 544, v21
 v_and_b32 v22, 3, v20
 v_lshl_add_u32 v21, v22, 7, v21
 v_and_b32 v22, 2, v20
 v_lshl_add_u32 v21, v22, 4, v21
 v_and_b32 v22, 16, v20
 v_lshl_add_u32 v21, v22, 2, v21
 v_and_b32 v22, 12, v20
 v_lshl_add_u32 v9, v22, 1, v21
 v_lshrrev_b32 v21, 4, v0
 v_lshlrev_b32 v21, 7, v21
 v_and_b32 v22, 14, v20
 v_lshl_add_u32 v21, v22, 2, v21
 v_and_b32 v22, 1, v20
 v_lshl_add_u32 v10, v22, 1, v21
 v_and_b32 v21, 12, v20
 v_lshlrev_b32 v21, 5, v21
 v_lshl_add_u32 v21, v22, 6, v21
 v_and_b32 v22, 48, v20
 v_add_u32 v11, v21, v22
 s_mov_b32 s55, 0x3e0293ee
 s_mov_b32 s54, 0x40000
 s_lshl_b32 s47, s6, 6
 s_add_u32 s60, s47, 0x100000
 s_add_u32 s61, s47, 0x101000
 s_add_u32 s62, s47, 0x102000
 s_lshl_b32 s47, s6, 7
 s_add_u32 s56, s47, 0x0
 s_add_u32 s57, s47, 0x1000
 s_mul_i32 s47, s6, 10496
 s_add_u32 s40, s47, 0x102000
 s_lshl_b32 s58, s4, 11
 s_add_u32 s47, s47, s58
 s_add_u32 s39, s47, 0x100000
 s_lshl_b32 s42, s4, 11
 s_add_u32 s41, s42, 0x1e0000
 s_mov_b32 s43, 0x1e2000
 s_lshr_b32 s69, s4, 1
 s_mul_i32 s69, s69, 1088
 s_and_b32 s47, s4, 1
 s_lshl_b32 s47, s47, 5
 s_add_u32 s69, s69, s47
 s_lshl_b32 s47, s6, 5
 s_add_u32 s65, s47, 0x1e2000
 s_add_u32 s66, s47, 0x162000
 s_lshr_b32 s47, s6, 3
 s_lshl_b32 s47, s47, 9
 s_and_b32 s58, s6, 1
 s_lshl_b32 s58, s58, 8
 s_add_u32 s47, s47, s58
 s_and_b32 s58, s6, 6
 s_lshl_b32 s58, s58, 5
 s_add_u32 s47, s47, s58
 s_lshl_b32 s58, s4, 11
 s_add_u32 s47, s47, s58
 s_add_u32 s44, s47, 0x1e0000
 s_add_u32 s45, s47, 0x160000
 s_lshl_b32 s47, s6, 14
 s_add_u32 s37, s47, 0x3000000
 s_add_u32 s67, s37, s58
 s_add_u32 s59, s67, 8192
 s_lshl_b32 s47, s6, 12
 s_add_u32 s38, s47, 0x3d0000
 s_mov_b32 s36, 0
 s_mov_b32 s46, 0
 s_waitcnt lgkmcnt(0)
 v_mov_b32 v20, 0
 v_mov_b32 v21, 0
 v_mov_b32 v22, 0
 v_mov_b32 v23, 0
 v_mov_b32 v27, -1
 v_bfe_u32 v24, v3, 8, 1
 v_bfe_u32 v25, v3, 9, 1
 v_lshl_or_b32 v24, v24, 1, v25
 v_bfe_u32 v25, v3, 5, 1
 v_lshl_or_b32 v24, v24, 1, v25
 v_and_b32 v25, 0xd0, v3
 v_lshlrev_b32 v25, 24, v25
 v_lshl_or_b32 v24, v24, 2, v25
 v_bfe_u32 v26, v3, 8, 2
 v_bfe_u32 v25, v3, 2, 4
 v_lshl_or_b32 v26, v26, 4, v25
 v_and_b32 v25, 0xc0, v3
 v_lshl_or_b32 v26, v25, 24, v26
 buffer_store_dwordx4 v[20:23], v3, s[20:23], s39 offen offset:0 sc1
 buffer_store_dwordx4 v[20:23], v3, s[20:23], s39 offen offset:1024 sc1
 buffer_store_dwordx4 v[20:23], v3, s[20:23], s40 offen offset:0 sc1
 buffer_store_dwordx4 v[20:23], v3, s[20:23], s40 offen offset:1024 sc1
 buffer_store_dword v27, v26, s[20:23], s44 offen sc1
 buffer_store_dword v27, v26, s[20:23], s45 offen sc1
 buffer_store_dword v27, v24, s[20:23], s65 offen sc1
 buffer_store_dword v27, v24, s[20:23], s66 offen sc1
 v_and_b32 v30, 63, v0
 v_bfe_u32 v31, v30, 1, 2
 v_lshrrev_b32 v32, 5, v30
 v_xor_b32 v31, v31, v32
 v_lshlrev_b32 v31, 5, v31
 v_and_b32 v32, 1, v30
 v_lshl_add_u32 v31, v32, 4, v31
 v_xor_b32 v33, 64, v31
 v_lshrrev_b32 v32, 3, v30
 s_lshl_b32 s47, s4, 4
 v_and_b32 v34, 3, v32
 v_lshrrev_b32 v35, 2, v32
 v_lshl_add_u32 v34, v34, 1, v35
 v_add_u32 v34, s47, v34
 v_lshl_add_u32 v12, v34, 13, v31
 v_add_u32 v34, 8, v34
 v_lshl_add_u32 v13, v34, 13, v33
 v_and_b32 v34, 1, v32
 v_lshlrev_b32 v34, 6, v34
 v_and_b32 v35, 6, v32
 s_lshl_b32 s47, s4, 3
 v_add3_u32 v34, v34, v35, s47
 v_lshl_add_u32 v56, v34, 13, v31
 v_add_u32 v34, 1, v34
 v_lshl_add_u32 v57, v34, 13, v33
 v_lshrrev_b32 v34, 3, v0
 v_mul_u32_u24 v34, 1152, v34
 v_add_u32 v14, v34, v31
 v_add_u32 v34, 73728, v34
 v_add_u32 v15, v34, v33
 v_bfe_u32 v31, v30, 4, 1
 v_bfe_u32 v32, v30, 3, 1
 v_lshl_add_u32 v33, v32, 1, v31
 v_xor_b32 v33, s4, v33
 v_lshlrev_b32 v33, 5, v33
 v_lshl_add_u32 v33, v31, 9, v33
 v_lshl_add_u32 v33, v32, 10, v33
 v_bfe_u32 v31, v30, 2, 1
 v_lshl_add_u32 v33, v31, 7, v33
 v_lshrrev_b32 v31, 5, v30
 v_lshl_add_u32 v33, v31, 11, v33
 v_and_b32 v31, 3, v30
 v_lshl_add_u32 v16, v31, 3, v33
 v_add_u32 v17, 0x10000, v16
 v_add_u32 v18, 0x20000, v16
 v_lshlrev_b32 v60, 4, v0
 v_add_u32 v61, 0x10000, v60
 v_add_u32 v62, 0x20000, v60
 s_lshl_b32 s70, s6, 8
 s_mul_i32 s71, s6, 147456
 s_lshl_b32 s72, s4, 11
 s_lshl_b32 s47, s4, 4
 v_add_u32 v31, s47, v30
 s_lshr_b32 s47, s4, 1
 s_lshl_b32 s47, s47, 5
 v_add_u32 v32, s47, v31
 v_lshrrev_b32 v33, 4, v30
 v_lshlrev_b32 v33, 28, v33
 v_lshl_or_b32 v58, v31, 13, v33
 v_lshl_or_b32 v19, v32, 13, v33
 v_mul_u32_u24 v32, 1152, v32
 v_or_b32 v59, v32, v33
 s_add_u32 m0, s72, 24576
 s_add_u32 s47, s70, 0
 buffer_load_dwordx4 v56, s[8:11], s47 offen  lds
 s_add_u32 m0, s72, 25600
 s_nop 0
 buffer_load_dwordx4 v57, s[8:11], s47 offen  lds
 s_add_u32 m0, s72, 32768
 s_add_u32 s47, s70, 128
 buffer_load_dwordx4 v56, s[8:11], s47 offen  lds
 s_add_u32 m0, s72, 33792
 s_nop 0
 buffer_load_dwordx4 v57, s[8:11], s47 offen  lds
 s_add_u32 m0, s72, 40960
 s_add_u32 s47, s70, 0
 buffer_load_dwordx4 v56, s[12:15], s47 offen  lds
 s_add_u32 m0, s72, 41984
 s_nop 0
 buffer_load_dwordx4 v57, s[12:15], s47 offen  lds
 s_add_u32 m0, s72, 49152
 s_add_u32 s47, s70, 0
 buffer_load_dwordx4 v56, s[16:19], s47 offen  lds
 s_add_u32 m0, s72, 50176
 s_nop 0
 buffer_load_dwordx4 v57, s[16:19], s47 offen  lds
 s_add_u32 m0, s72, 57344
 s_add_u32 s47, s70, 128
 buffer_load_dwordx4 v56, s[16:19], s47 offen  lds
 s_add_u32 m0, s72, 58368
 s_nop 0
 buffer_load_dwordx4 v57, s[16:19], s47 offen  lds
 s_add_u32 m0, s72, 65536
 s_add_u32 s47, s70, 262144
 buffer_load_dwordx4 v56, s[8:11], s47 offen  lds
 s_add_u32 m0, s72, 66560
 s_nop 0
 buffer_load_dwordx4 v57, s[8:11], s47 offen  lds
 s_add_u32 m0, s72, 73728
 s_add_u32 s47, s70, 262272
 buffer_load_dwordx4 v56, s[8:11], s47 offen  lds
 s_add_u32 m0, s72, 74752
 s_nop 0
 buffer_load_dwordx4 v57, s[8:11], s47 offen  lds
 s_add_u32 m0, s72, 81920
 s_add_u32 s47, s70, 262144
 buffer_load_dwordx4 v56, s[12:15], s47 offen  lds
 s_add_u32 m0, s72, 82944
 s_nop 0
 buffer_load_dwordx4 v57, s[12:15], s47 offen  lds
 s_waitcnt vmcnt(14)
 s_waitcnt lgkmcnt(0)
 s_barrier
 s_getreg_b32 s73, hwreg(HW_REG_XCC_ID, 0, 3)
 s_lshl_b32 s73, s73, 3
 s_lshl_b64 s[74:75], 1, s73
 v_mov_b32 v64, s74
 v_mov_b32 v65, s75
 v_mov_b32 v66, 0x7ff00000
 v_cmp_eq_u32 vcc, 0, v0
 s_nop 1
 v_cndmask_b32 v66, v66, v7, vcc
 buffer_atomic_add_x2 v[64:65], v66, s[28:31], 0 offen offset:8
 s_add_u32 m0, s72, 90112
 s_add_u32 s47, s70, 262144
 buffer_load_dwordx4 v56, s[16:19], s47 offen  lds
 s_add_u32 m0, s72, 91136
 s_nop 0
 buffer_load_dwordx4 v57, s[16:19], s47 offen  lds
 ds_read_b64_tr_b16 v[72:73], v16 offset:24576
 ds_read_b64_tr_b16 v[74:75], v16 offset:24832
 ds_read_b64_tr_b16 v[76:77], v16 offset:28672
 ds_read_b64_tr_b16 v[78:79], v16 offset:28928
 s_waitcnt vmcnt(15)
 s_waitcnt lgkmcnt(0)
 s_barrier
 s_add_u32 m0, s72, 98304
 s_add_u32 s47, s70, 262272
 buffer_load_dwordx4 v56, s[16:19], s47 offen  lds
 s_add_u32 m0, s72, 99328
 s_nop 0
 buffer_load_dwordx4 v57, s[16:19], s47 offen  lds
 ds_read_b64_tr_b16 v[80:81], v16 offset:32768
 ds_read_b64_tr_b16 v[82:83], v16 offset:33024
 ds_read_b64_tr_b16 v[84:85], v16 offset:36864
 ds_read_b64_tr_b16 v[86:87], v16 offset:37120
 s_waitcnt vmcnt(15)
 s_waitcnt lgkmcnt(0)
 s_barrier
 s_add_u32 m0, s72, 106496
 s_add_u32 s47, s70, 1048576
 buffer_load_dwordx4 v56, s[8:11], s47 offen  lds
 s_add_u32 m0, s72, 107520
 s_nop 0
 buffer_load_dwordx4 v57, s[8:11], s47 offen  lds
 ds_read_b64_tr_b16 v[88:89], v16 offset:40960
 ds_read_b64_tr_b16 v[90:91], v16 offset:41216
 ds_read_b64_tr_b16 v[92:93], v16 offset:45056
 ds_read_b64_tr_b16 v[94:95], v16 offset:45312
 s_waitcnt vmcnt(15)
 s_waitcnt lgkmcnt(0)
 s_barrier
 s_add_u32 m0, s72, 114688
 s_add_u32 s47, s70, 1048704
 buffer_load_dwordx4 v56, s[8:11], s47 offen  lds
 s_add_u32 m0, s72, 115712
 s_nop 0
 buffer_load_dwordx4 v57, s[8:11], s47 offen  lds
 ds_read_b64_tr_b16 v[96:97], v16 offset:49152
 ds_read_b64_tr_b16 v[98:99], v16 offset:49408
 ds_read_b64_tr_b16 v[100:101], v16 offset:53248
 ds_read_b64_tr_b16 v[102:103], v16 offset:53504
 s_waitcnt vmcnt(15)
 s_waitcnt lgkmcnt(0)
 s_barrier
 s_add_u32 m0, s72, 122880
 s_add_u32 s47, s70, 1048576
 buffer_load_dwordx4 v56, s[12:15], s47 offen  lds
 s_add_u32 m0, s72, 123904
 s_nop 0
 buffer_load_dwordx4 v57, s[12:15], s47 offen  lds
 v_lshrrev_b32 v68, 4, v3
 v_bfe_u32 v69, v68, 2, 2
 v_and_b32 v70, 1, v68
 v_lshl_add_u32 v69, v69, 1, v70
 v_mul_u32_u24 v69, 1152, v69
 v_and_b32 v70, 48, v68
 v_and_b32 v71, 2, v68
 v_lshl_add_u32 v71, v71, 2, v70
 v_lshl_add_u32 v71, v71, 1, v69
 v_add_u32 v69, v70, v69
 s_lshr_b32 s47, s4, 1
 s_lshl_b32 s47, s47, 8
 s_and_b32 s58, s4, 1
 s_lshl_b32 s58, s58, 6
 s_add_u32 s47, s47, s58
 buffer_load_dwordx4 v[20:23], v69, s[32:35], s47 offen offset:0
 buffer_load_dwordx4 v[24:27], v69, s[32:35], s47 offen offset:128
 buffer_load_dwordx4 v[28:31], v69, s[32:35], s47 offen offset:512
 buffer_load_dwordx4 v[32:35], v69, s[32:35], s47 offen offset:640
 buffer_load_dwordx4 v[36:39], v71, s[32:35], 0 offen offset:1024
 ds_read_b64_tr_b16 v[104:105], v16 offset:57344
 ds_read_b64_tr_b16 v[106:107], v16 offset:57600
 ds_read_b64_tr_b16 v[108:109], v16 offset:61440
 ds_read_b64_tr_b16 v[110:111], v16 offset:61696
 s_waitcnt vmcnt(20)
 s_waitcnt lgkmcnt(0)
 s_barrier
 s_add_u32 m0, s72, 131072
 s_add_u32 s47, s70, 1048576
 buffer_load_dwordx4 v56, s[16:19], s47 offen  lds
 s_add_u32 m0, s72, 132096
 s_nop 0
 buffer_load_dwordx4 v57, s[16:19], s47 offen  lds
 ds_read_b64_tr_b16 v[112:113], v17 offset:0
 ds_read_b64_tr_b16 v[114:115], v17 offset:256
 ds_read_b64_tr_b16 v[116:117], v17 offset:4096
 ds_read_b64_tr_b16 v[118:119], v17 offset:4352
 s_waitcnt vmcnt(20)
 s_waitcnt lgkmcnt(0)
 s_barrier
 s_add_u32 m0, s72, 139264
 s_add_u32 s47, s70, 1048704
 buffer_load_dwordx4 v56, s[16:19], s47 offen  lds
 s_add_u32 m0, s72, 140288
 s_nop 0
 buffer_load_dwordx4 v57, s[16:19], s47 offen  lds
 ds_read_b64_tr_b16 v[120:121], v17 offset:8192
 ds_read_b64_tr_b16 v[122:123], v17 offset:8448
 ds_read_b64_tr_b16 v[124:125], v17 offset:12288
 ds_read_b64_tr_b16 v[126:127], v17 offset:12544
 s_waitcnt vmcnt(20)
 s_waitcnt lgkmcnt(0)
 s_barrier
 s_add_u32 m0, s72, 147456
 s_add_u32 s47, s70, 1310720
 buffer_load_dwordx4 v56, s[8:11], s47 offen  lds
 s_add_u32 m0, s72, 148480
 s_nop 0
 buffer_load_dwordx4 v57, s[8:11], s47 offen  lds
 ds_read_b64_tr_b16 v[128:129], v17 offset:16384
 ds_read_b64_tr_b16 v[130:131], v17 offset:16640
 ds_read_b64_tr_b16 v[132:133], v17 offset:20480
 ds_read_b64_tr_b16 v[134:135], v17 offset:20736
 s_waitcnt vmcnt(19)
 s_waitcnt lgkmcnt(0)
 s_barrier
 s_add_u32 m0, s72, 155648
 s_add_u32 s47, s70, 1310848
 buffer_load_dwordx4 v56, s[8:11], s47 offen  lds
 s_add_u32 m0, s72, 156672
 s_nop 0
 buffer_load_dwordx4 v57, s[8:11], s47 offen  lds
 ds_read_b64_tr_b16 v[136:137], v17 offset:24576
 ds_read_b64_tr_b16 v[138:139], v17 offset:24832
 ds_read_b64_tr_b16 v[140:141], v17 offset:28672
 ds_read_b64_tr_b16 v[142:143], v17 offset:28928
 s_waitcnt vmcnt(19)
 s_waitcnt lgkmcnt(0)
 s_barrier
 s_add_u32 m0, s72, 24576
 s_add_u32 s47, s70, 1310720
 buffer_load_dwordx4 v56, s[12:15], s47 offen  lds
 s_add_u32 m0, s72, 25600
 s_nop 0
 buffer_load_dwordx4 v57, s[12:15], s47 offen  lds
 ds_read_b64_tr_b16 v[144:145], v17 offset:32768
 ds_read_b64_tr_b16 v[146:147], v17 offset:33024
 ds_read_b64_tr_b16 v[148:149], v17 offset:36864
 ds_read_b64_tr_b16 v[150:151], v17 offset:37120
 s_waitcnt vmcnt(19)
 s_waitcnt lgkmcnt(0)
 s_barrier
 s_add_u32 m0, s72, 32768
 s_add_u32 s47, s70, 1310720
 buffer_load_dwordx4 v56, s[16:19], s47 offen  lds
 s_add_u32 m0, s72, 33792
 s_nop 0
 buffer_load_dwordx4 v57, s[16:19], s47 offen  lds
 ds_read_b64_tr_b16 v[152:153], v17 offset:40960
 ds_read_b64_tr_b16 v[154:155], v17 offset:41216
 ds_read_b64_tr_b16 v[156:157], v17 offset:45056
 ds_read_b64_tr_b16 v[158:159], v17 offset:45312
 s_waitcnt vmcnt(19)
 s_waitcnt lgkmcnt(0)
 s_barrier
 s_add_u32 m0, s72, 40960
 s_add_u32 s47, s70, 1310848
 buffer_load_dwordx4 v56, s[16:19], s47 offen  lds
 s_add_u32 m0, s72, 41984
 s_nop 0
 buffer_load_dwordx4 v57, s[16:19], s47 offen  lds
 ds_read_b64_tr_b16 v[160:161], v17 offset:49152
 ds_read_b64_tr_b16 v[162:163], v17 offset:49408
 ds_read_b64_tr_b16 v[164:165], v17 offset:53248
 ds_read_b64_tr_b16 v[166:167], v17 offset:53504
 s_waitcnt vmcnt(19)
 s_waitcnt lgkmcnt(0)
 s_barrier
 s_add_u32 m0, s72, 49152
 s_add_u32 s47, s70, 2097152
 buffer_load_dwordx4 v56, s[8:11], s47 offen  lds
 s_add_u32 m0, s72, 50176
 s_nop 0
 buffer_load_dwordx4 v57, s[8:11], s47 offen  lds
 ds_read_b64_tr_b16 v[168:169], v17 offset:57344
 ds_read_b64_tr_b16 v[170:171], v17 offset:57600
 ds_read_b64_tr_b16 v[172:173], v17 offset:61440
 ds_read_b64_tr_b16 v[174:175], v17 offset:61696
 s_waitcnt vmcnt(14)
 s_waitcnt lgkmcnt(0)
 s_barrier
 s_add_u32 m0, s72, 57344
 s_add_u32 s47, s70, 2097280
 buffer_load_dwordx4 v56, s[8:11], s47 offen  lds
 s_add_u32 m0, s72, 58368
 s_nop 0
 buffer_load_dwordx4 v57, s[8:11], s47 offen  lds
 ds_read_b64_tr_b16 v[176:177], v18 offset:0
 ds_read_b64_tr_b16 v[178:179], v18 offset:256
 ds_read_b64_tr_b16 v[180:181], v18 offset:4096
 ds_read_b64_tr_b16 v[182:183], v18 offset:4352
 s_waitcnt vmcnt(14)
 s_waitcnt lgkmcnt(0)
 s_barrier
 s_add_u32 m0, s72, 65536
 s_add_u32 s47, s70, 2097152
 buffer_load_dwordx4 v56, s[12:15], s47 offen  lds
 s_add_u32 m0, s72, 66560
 s_nop 0
 buffer_load_dwordx4 v57, s[12:15], s47 offen  lds
 v_mov_b32 v68, 0x05040100
 v_mov_b32 v69, 0x07060302
 v_cndmask_b32 v70, v68, v69, s[48:49]
 v_perm_b32 v20, v24, v20, v70
 v_perm_b32 v21, v25, v21, v70
 v_perm_b32 v22, v26, v22, v70
 v_perm_b32 v23, v27, v23, v70
 v_perm_b32 v28, v32, v28, v70
 v_perm_b32 v29, v33, v29, v70
 v_perm_b32 v30, v34, v30, v70
 v_perm_b32 v31, v35, v31, v70
 v_perm_b32 v24, v37, v36, v68
 v_perm_b32 v25, v39, v38, v68
 v_perm_b32 v26, v37, v36, v69
 v_perm_b32 v27, v39, v38, v69
 ds_write_b128 v60, v[20:23]
 ds_write_b128 v60, v[28:31] offset:4096
 ds_write_b128 v3, v[24:27] offset:8192
 ds_read_b64_tr_b16 v[184:185], v18 offset:8192
 ds_read_b64_tr_b16 v[186:187], v18 offset:8448
 ds_read_b64_tr_b16 v[188:189], v18 offset:12288
 ds_read_b64_tr_b16 v[190:191], v18 offset:12544
 s_waitcnt vmcnt(14)
 s_waitcnt lgkmcnt(0)
 s_barrier
 s_add_u32 m0, s72, 73728
 s_add_u32 s47, s70, 2097152
 buffer_load_dwordx4 v56, s[16:19], s47 offen  lds
 s_add_u32 m0, s72, 74752
 s_nop 0
 buffer_load_dwordx4 v57, s[16:19], s47 offen  lds
 ds_read_b64_tr_b16 v[192:193], v18 offset:16384
 ds_read_b64_tr_b16 v[194:195], v18 offset:16640
 ds_read_b64_tr_b16 v[196:197], v18 offset:20480
 ds_read_b64_tr_b16 v[198:199], v18 offset:20736
 s_waitcnt vmcnt(14)
 s_waitcnt lgkmcnt(0)
 s_barrier
 s_add_u32 m0, s72, 81920
 s_add_u32 s47, s70, 2097280
 buffer_load_dwordx4 v56, s[16:19], s47 offen  lds
 s_add_u32 m0, s72, 82944
 s_nop 0
 buffer_load_dwordx4 v57, s[16:19], s47 offen  lds
 ds_read_b64_tr_b16 v[200:201], v18 offset:24576
 ds_read_b64_tr_b16 v[202:203], v18 offset:24832
 ds_read_b64_tr_b16 v[204:205], v18 offset:28672
 ds_read_b64_tr_b16 v[206:207], v18 offset:28928
 s_waitcnt vmcnt(14)
 s_waitcnt lgkmcnt(0)
 s_barrier
 s_add_u32 m0, s72, 90112
 s_add_u32 s47, s70, 2359296
 buffer_load_dwordx4 v56, s[8:11], s47 offen  lds
 s_add_u32 m0, s72, 91136
 s_nop 0
 buffer_load_dwordx4 v57, s[8:11], s47 offen  lds
 ds_read_b64_tr_b16 v[208:209], v16 offset:24576
 ds_read_b64_tr_b16 v[210:211], v16 offset:24832
 ds_read_b64_tr_b16 v[212:213], v16 offset:28672
 ds_read_b64_tr_b16 v[214:215], v16 offset:28928
 s_waitcnt vmcnt(14)
 s_waitcnt lgkmcnt(0)
 s_barrier
 s_add_u32 m0, s72, 98304
 s_add_u32 s47, s70, 2359424
 buffer_load_dwordx4 v56, s[8:11], s47 offen  lds
 s_add_u32 m0, s72, 99328
 s_nop 0
 buffer_load_dwordx4 v57, s[8:11], s47 offen  lds
 ds_read_b64_tr_b16 v[216:217], v16 offset:32768
 ds_read_b64_tr_b16 v[218:219], v16 offset:33024
 ds_read_b64_tr_b16 v[220:221], v16 offset:36864
 ds_read_b64_tr_b16 v[222:223], v16 offset:37120
 s_waitcnt vmcnt(14)
 s_waitcnt lgkmcnt(0)
 s_barrier
 s_add_u32 m0, s72, 106496
 s_add_u32 s47, s70, 2359296
 buffer_load_dwordx4 v56, s[12:15], s47 offen  lds
 s_add_u32 m0, s72, 107520
 s_nop 0
 buffer_load_dwordx4 v57, s[12:15], s47 offen  lds
 ds_read_b64_tr_b16 v[224:225], v16 offset:40960
 ds_read_b64_tr_b16 v[226:227], v16 offset:41216
 ds_read_b64_tr_b16 v[228:229], v16 offset:45056
 ds_read_b64_tr_b16 v[230:231], v16 offset:45312
 s_waitcnt vmcnt(14)
 s_waitcnt lgkmcnt(0)
 s_barrier
 s_add_u32 m0, s72, 114688
 s_add_u32 s47, s70, 2359296
 buffer_load_dwordx4 v56, s[16:19], s47 offen  lds
 s_add_u32 m0, s72, 115712
 s_nop 0
 buffer_load_dwordx4 v57, s[16:19], s47 offen  lds
 ds_read_b64_tr_b16 v[232:233], v16 offset:49152
 ds_read_b64_tr_b16 v[234:235], v16 offset:49408
 ds_read_b64_tr_b16 v[236:237], v16 offset:53248
 ds_read_b64_tr_b16 v[238:239], v16 offset:53504
 s_waitcnt vmcnt(14)
 s_waitcnt lgkmcnt(0)
 s_barrier
 s_add_u32 m0, s72, 122880
 s_add_u32 s47, s70, 2359424
 buffer_load_dwordx4 v56, s[16:19], s47 offen  lds
 s_add_u32 m0, s72, 123904
 s_nop 0
 buffer_load_dwordx4 v57, s[16:19], s47 offen  lds
 ds_read_b64_tr_b16 v[240:241], v16 offset:57344
 ds_read_b64_tr_b16 v[242:243], v16 offset:57600
 ds_read_b64_tr_b16 v[244:245], v16 offset:61440
 ds_read_b64_tr_b16 v[246:247], v16 offset:61696
 s_waitcnt vmcnt(14)
 s_waitcnt lgkmcnt(0)
 s_barrier
 s_add_u32 m0, s72, 131072
 s_add_u32 s47, s70, 3145728
 buffer_load_dwordx4 v56, s[8:11], s47 offen  lds
 s_add_u32 m0, s72, 132096
 s_nop 0
 buffer_load_dwordx4 v57, s[8:11], s47 offen  lds
 ds_read_b64_tr_b16 v[248:249], v17 offset:0
 ds_read_b64_tr_b16 v[250:251], v17 offset:256
 ds_read_b64_tr_b16 v[252:253], v17 offset:4096
 ds_read_b64_tr_b16 v[254:255], v17 offset:4352
 s_waitcnt vmcnt(14)
 s_waitcnt lgkmcnt(0)
 s_barrier
 s_add_u32 m0, s72, 139264
 s_add_u32 s47, s70, 3145856
 buffer_load_dwordx4 v56, s[8:11], s47 offen  lds
 s_add_u32 m0, s72, 140288
 s_nop 0
 buffer_load_dwordx4 v57, s[8:11], s47 offen  lds
 ds_read_b64_tr_b16 a[0:1], v17 offset:8192
 ds_read_b64_tr_b16 a[2:3], v17 offset:8448
 ds_read_b64_tr_b16 a[4:5], v17 offset:12288
 ds_read_b64_tr_b16 a[6:7], v17 offset:12544
 s_waitcnt vmcnt(14)
 s_waitcnt lgkmcnt(0)
 s_barrier
 s_add_u32 m0, s72, 147456
 s_add_u32 s47, s70, 3145728
 buffer_load_dwordx4 v56, s[12:15], s47 offen  lds
 s_add_u32 m0, s72, 148480
 s_nop 0
 buffer_load_dwordx4 v57, s[12:15], s47 offen  lds
 ds_read_b64_tr_b16 a[8:9], v17 offset:16384
 ds_read_b64_tr_b16 a[10:11], v17 offset:16640
 ds_read_b64_tr_b16 a[12:13], v17 offset:20480
 ds_read_b64_tr_b16 a[14:15], v17 offset:20736
 s_waitcnt vmcnt(14)
 s_waitcnt lgkmcnt(0)
 s_barrier
 s_add_u32 m0, s72, 155648
 s_add_u32 s47, s70, 3145728
 buffer_load_dwordx4 v56, s[16:19], s47 offen  lds
 s_add_u32 m0, s72, 156672
 s_nop 0
 buffer_load_dwordx4 v57, s[16:19], s47 offen  lds
 ds_read_b64_tr_b16 a[16:17], v17 offset:24576
 ds_read_b64_tr_b16 a[18:19], v17 offset:24832
 ds_read_b64_tr_b16 a[20:21], v17 offset:28672
 ds_read_b64_tr_b16 a[22:23], v17 offset:28928
 s_waitcnt vmcnt(14)
 s_waitcnt lgkmcnt(0)
 s_barrier
 s_add_u32 m0, s72, 24576
 s_add_u32 s47, s70, 3145856
 buffer_load_dwordx4 v56, s[16:19], s47 offen  lds
 s_add_u32 m0, s72, 25600
 s_nop 0
 buffer_load_dwordx4 v57, s[16:19], s47 offen  lds
 ds_read_b64_tr_b16 a[24:25], v17 offset:32768
 ds_read_b64_tr_b16 a[26:27], v17 offset:33024
 ds_read_b64_tr_b16 a[28:29], v17 offset:36864
 ds_read_b64_tr_b16 a[30:31], v17 offset:37120
 s_waitcnt vmcnt(14)
 s_waitcnt lgkmcnt(0)
 s_barrier
 s_add_u32 m0, s72, 32768
 s_add_u32 s47, s70, 3407872
 buffer_load_dwordx4 v56, s[8:11], s47 offen  lds
 s_add_u32 m0, s72, 33792
 s_nop 0
 buffer_load_dwordx4 v57, s[8:11], s47 offen  lds
 ds_read_b64_tr_b16 a[32:33], v17 offset:40960
 ds_read_b64_tr_b16 a[34:35], v17 offset:41216
 ds_read_b64_tr_b16 a[36:37], v17 offset:45056
 ds_read_b64_tr_b16 a[38:39], v17 offset:45312
 s_waitcnt vmcnt(14)
 s_waitcnt lgkmcnt(0)
 s_barrier
 s_add_u32 m0, s72, 40960
 s_add_u32 s47, s70, 3408000
 buffer_load_dwordx4 v56, s[8:11], s47 offen  lds
 s_add_u32 m0, s72, 41984
 s_nop 0
 buffer_load_dwordx4 v57, s[8:11], s47 offen  lds
 ds_read_b64_tr_b16 a[40:41], v17 offset:49152
 ds_read_b64_tr_b16 a[42:43], v17 offset:49408
 ds_read_b64_tr_b16 a[44:45], v17 offset:53248
 ds_read_b64_tr_b16 a[46:47], v17 offset:53504
 s_waitcnt vmcnt(14)
 s_waitcnt lgkmcnt(0)
 s_barrier
 s_add_u32 m0, s72, 49152
 s_add_u32 s47, s70, 3407872
 buffer_load_dwordx4 v56, s[12:15], s47 offen  lds
 s_add_u32 m0, s72, 50176
 s_nop 0
 buffer_load_dwordx4 v57, s[12:15], s47 offen  lds
 ds_read_b64_tr_b16 a[48:49], v17 offset:57344
 ds_read_b64_tr_b16 a[50:51], v17 offset:57600
 ds_read_b64_tr_b16 a[52:53], v17 offset:61440
 ds_read_b64_tr_b16 a[54:55], v17 offset:61696
 s_waitcnt vmcnt(14)
 s_waitcnt lgkmcnt(0)
 s_barrier
 s_add_u32 m0, s72, 57344
 s_add_u32 s47, s70, 3407872
 buffer_load_dwordx4 v56, s[16:19], s47 offen  lds
 s_add_u32 m0, s72, 58368
 s_nop 0
 buffer_load_dwordx4 v57, s[16:19], s47 offen  lds
 v_min_u32 v65, 16, v3
 v_lshlrev_b32 v65, 24, v65
 buffer_load_dwordx4 v[68:71], v65, s[28:31], 0 offen sc1
 ds_read_b64_tr_b16 a[56:57], v18 offset:0
 ds_read_b64_tr_b16 a[58:59], v18 offset:256
 ds_read_b64_tr_b16 a[60:61], v18 offset:4096
 ds_read_b64_tr_b16 a[62:63], v18 offset:4352
 s_waitcnt vmcnt(15)
 s_waitcnt lgkmcnt(0)
 s_barrier
 s_add_u32 m0, s72, 65536
 s_add_u32 s47, s70, 3408000
 buffer_load_dwordx4 v56, s[16:19], s47 offen  lds
 s_add_u32 m0, s72, 66560
 s_nop 0
 buffer_load_dwordx4 v57, s[16:19], s47 offen  lds
 ds_read_b64_tr_b16 a[64:65], v18 offset:8192
 ds_read_b64_tr_b16 a[66:67], v18 offset:8448
 ds_read_b64_tr_b16 a[68:69], v18 offset:12288
 ds_read_b64_tr_b16 a[70:71], v18 offset:12544
 s_waitcnt vmcnt(15)
 s_waitcnt lgkmcnt(0)
 s_barrier
 s_add_u32 m0, s72, 73728
 s_add_u32 s47, s70, 4194304
 buffer_load_dwordx4 v12, s[8:11], s47 offen  lds
 s_add_u32 m0, s72, 74752
 s_nop 0
 buffer_load_dwordx4 v13, s[8:11], s47 offen  lds
 ds_read_b64_tr_b16 a[72:73], v18 offset:16384
 ds_read_b64_tr_b16 a[74:75], v18 offset:16640
 ds_read_b64_tr_b16 a[76:77], v18 offset:20480
 ds_read_b64_tr_b16 a[78:79], v18 offset:20736
 s_waitcnt vmcnt(15)
 s_waitcnt lgkmcnt(0)
 s_barrier
 s_add_u32 m0, s72, 81920
 s_add_u32 s47, s70, 4194432
 buffer_load_dwordx4 v12, s[8:11], s47 offen  lds
 s_add_u32 m0, s72, 82944
 s_nop 0
 buffer_load_dwordx4 v13, s[8:11], s47 offen  lds
 ds_read_b64_tr_b16 a[80:81], v18 offset:24576
 ds_read_b64_tr_b16 a[82:83], v18 offset:24832
 ds_read_b64_tr_b16 a[84:85], v18 offset:28672
 ds_read_b64_tr_b16 a[86:87], v18 offset:28928
 s_waitcnt vmcnt(15)
 s_waitcnt lgkmcnt(0)
 s_barrier
 s_add_u32 m0, s72, 90112
 s_add_u32 s47, s70, 4194304
 buffer_load_dwordx4 v12, s[12:15], s47 offen  lds
 s_add_u32 m0, s72, 91136
 s_nop 0
 buffer_load_dwordx4 v13, s[12:15], s47 offen  lds
 ds_read_b64_tr_b16 a[88:89], v16 offset:24576
 ds_read_b64_tr_b16 a[90:91], v16 offset:24832
 ds_read_b64_tr_b16 a[92:93], v16 offset:28672
 ds_read_b64_tr_b16 a[94:95], v16 offset:28928
 s_waitcnt vmcnt(15)
 s_waitcnt lgkmcnt(0)
 s_barrier
 s_add_u32 m0, s72, 98304
 s_add_u32 s47, s70, 4194304
 buffer_load_dwordx4 v12, s[16:19], s47 offen  lds
 s_add_u32 m0, s72, 99328
 s_nop 0
 buffer_load_dwordx4 v13, s[16:19], s47 offen  lds
 ds_read_b64_tr_b16 a[96:97], v16 offset:32768
 ds_read_b64_tr_b16 a[98:99], v16 offset:33024
 ds_read_b64_tr_b16 a[100:101], v16 offset:36864
 ds_read_b64_tr_b16 a[102:103], v16 offset:37120
 s_waitcnt vmcnt(15)
 s_waitcnt lgkmcnt(0)
 s_barrier
 s_add_u32 m0, s72, 106496
 s_add_u32 s47, s70, 4194432
 buffer_load_dwordx4 v12, s[16:19], s47 offen  lds
 s_add_u32 m0, s72, 107520
 s_nop 0
 buffer_load_dwordx4 v13, s[16:19], s47 offen  lds
 ds_read_b64_tr_b16 a[104:105], v16 offset:40960
 ds_read_b64_tr_b16 a[106:107], v16 offset:41216
 ds_read_b64_tr_b16 a[108:109], v16 offset:45056
 ds_read_b64_tr_b16 a[110:111], v16 offset:45312
 s_waitcnt vmcnt(15)
 s_waitcnt lgkmcnt(0)
 s_barrier
 s_add_u32 m0, s72, 114688
 s_add_u32 s47, s71, 0
 buffer_load_dwordx4 v14, s[24:27], s47 offen  lds
 s_add_u32 m0, s72, 115712
 s_nop 0
 buffer_load_dwordx4 v15, s[24:27], s47 offen  lds
 ds_read_b64_tr_b16 a[112:113], v16 offset:49152
 ds_read_b64_tr_b16 a[114:115], v16 offset:49408
 ds_read_b64_tr_b16 a[116:117], v16 offset:53248
 ds_read_b64_tr_b16 a[118:119], v16 offset:53504
 s_waitcnt vmcnt(15)
 s_waitcnt lgkmcnt(0)
 s_barrier
 s_add_u32 m0, s72, 122880
 s_add_u32 s47, s71, 128
 buffer_load_dwordx4 v14, s[24:27], s47 offen  lds
 s_add_u32 m0, s72, 123904
 s_nop 0
 buffer_load_dwordx4 v15, s[24:27], s47 offen  lds
 ds_read_b64_tr_b16 a[120:121], v16 offset:57344
 ds_read_b64_tr_b16 a[122:123], v16 offset:57600
 ds_read_b64_tr_b16 a[124:125], v16 offset:61440
 ds_read_b64_tr_b16 a[126:127], v16 offset:61696
 s_waitcnt vmcnt(14)
 s_waitcnt lgkmcnt(0)
 s_barrier
 s_add_u32 m0, s72, 131072
 s_add_u32 s47, s71, 256
 buffer_load_dwordx4 v14, s[24:27], s47 offen  lds
 s_add_u32 m0, s72, 132096
 s_nop 0
 buffer_load_dwordx4 v15, s[24:27], s47 offen  lds
 ds_read_b64_tr_b16 a[128:129], v17 offset:0
 ds_read_b64_tr_b16 a[130:131], v17 offset:256
 ds_read_b64_tr_b16 a[132:133], v17 offset:4096
 ds_read_b64_tr_b16 a[134:135], v17 offset:4352
 s_waitcnt vmcnt(14)
 s_waitcnt lgkmcnt(0)
 s_barrier
 s_add_u32 m0, s72, 139264
 s_add_u32 s47, s71, 384
 buffer_load_dwordx4 v14, s[24:27], s47 offen  lds
 s_add_u32 m0, s72, 140288
 s_nop 0
 buffer_load_dwordx4 v15, s[24:27], s47 offen  lds
 s_branch Lhsc_41
Lhs_40:
 buffer_load_dwordx4 v[68:71], v65, s[28:31], 0 offen sc1
 s_waitcnt vmcnt(0)
Lhsc_41:
 v_sad_u8 v69, v70, 0, 0
 v_sad_u8 v69, v71, 0, v69
 v_lshrrev_b32 v69, 5, v69
 v_min_u32 v68, v68, v69
 v_cmp_ne_u32 vcc, 0, v68
 s_cbranch_vccnz Lhsok_42
 s_sub_u32 s54, s54, 1
 s_cbranch_scc0 Lhs_40
 s_endpgm
Lhsok_42:
 v_readfirstlane_b32 s74, v70
 v_readfirstlane_b32 s75, v71
 buffer_load_dwordx4 v[20:23], v3, s[20:23], s39 offen offset:0 sc1
 buffer_load_dwordx4 v[20:23], v3, s[20:23], s39 offen offset:1024 sc1
 buffer_load_dwordx4 v[20:23], v3, s[20:23], s40 offen offset:0 sc1
 buffer_load_dwordx4 v[20:23], v3, s[20:23], s40 offen offset:1024 sc1
 v_lshlrev_b32 v67, 6, v0
 ds_read_b64_tr_b16 a[136:137], v17 offset:8192
 ds_read_b64_tr_b16 a[138:139], v17 offset:8448
 ds_read_b64_tr_b16 a[140:141], v17 offset:12288
 ds_read_b64_tr_b16 a[142:143], v17 offset:12544
 s_waitcnt vmcnt(18)
 s_waitcnt lgkmcnt(0)
 s_barrier
 s_add_u32 m0, s72, 147456
 s_add_u32 s47, s71, 512
 buffer_load_dwordx4 v14, s[24:27], s47 offen  lds
 s_add_u32 m0, s72, 148480
 s_nop 0
 buffer_load_dwordx4 v15, s[24:27], s47 offen  lds
 ds_read_b64_tr_b16 a[144:145], v17 offset:16384
 ds_read_b64_tr_b16 a[146:147], v17 offset:16640
 ds_read_b64_tr_b16 a[148:149], v17 offset:20480
 ds_read_b64_tr_b16 a[150:151], v17 offset:20736
 s_waitcnt vmcnt(18)
 s_waitcnt lgkmcnt(0)
 s_barrier
 s_add_u32 m0, s72, 155648
 s_add_u32 s47, s71, 640
 buffer_load_dwordx4 v14, s[24:27], s47 offen  lds
 s_add_u32 m0, s72, 156672
 s_nop 0
 buffer_load_dwordx4 v15, s[24:27], s47 offen  lds
 ds_read_b64_tr_b16 a[152:153], v17 offset:24576
 ds_read_b64_tr_b16 a[154:155], v17 offset:24832
 ds_read_b64_tr_b16 a[156:157], v17 offset:28672
 ds_read_b64_tr_b16 a[158:159], v17 offset:28928
 s_waitcnt vmcnt(18)
 s_waitcnt lgkmcnt(0)
 s_barrier
 s_add_u32 m0, s72, 24576
 s_add_u32 s47, s71, 768
 buffer_load_dwordx4 v14, s[24:27], s47 offen  lds
 s_add_u32 m0, s72, 25600
 s_nop 0
 buffer_load_dwordx4 v15, s[24:27], s47 offen  lds
 ds_read_b64_tr_b16 a[160:161], v17 offset:32768
 ds_read_b64_tr_b16 a[162:163], v17 offset:33024
 ds_read_b64_tr_b16 a[164:165], v17 offset:36864
 ds_read_b64_tr_b16 a[166:167], v17 offset:37120
 s_waitcnt vmcnt(18)
 s_waitcnt lgkmcnt(0)
 s_barrier
 s_add_u32 m0, s72, 32768
 s_add_u32 s47, s71, 896
 buffer_load_dwordx4 v14, s[24:27], s47 offen  lds
 s_add_u32 m0, s72, 33792
 s_nop 0
 buffer_load_dwordx4 v15, s[24:27], s47 offen  lds
 ds_read_b64_tr_b16 a[168:169], v17 offset:40960
 ds_read_b64_tr_b16 a[170:171], v17 offset:41216
 ds_read_b64_tr_b16 a[172:173], v17 offset:45056
 ds_read_b64_tr_b16 a[174:175], v17 offset:45312
 s_waitcnt vmcnt(18)
 s_waitcnt lgkmcnt(0)
 s_barrier
 s_add_u32 m0, s72, 40960
 s_add_u32 s47, s71, 37760
 buffer_load_dwordx4 v14, s[24:27], s47 offen  lds
 s_add_u32 m0, s72, 41984
 s_nop 0
 buffer_load_dwordx4 v15, s[24:27], s47 offen  lds
 ds_read_b64_tr_b16 a[176:177], v17 offset:49152
 ds_read_b64_tr_b16 a[178:179], v17 offset:49408
 ds_read_b64_tr_b16 a[180:181], v17 offset:53248
 ds_read_b64_tr_b16 a[182:183], v17 offset:53504
 s_waitcnt vmcnt(18)
 s_waitcnt lgkmcnt(0)
 s_barrier
 s_add_u32 m0, s72, 49152
 s_add_u32 s47, s71, 1024
 buffer_load_dwordx4 v14, s[24:27], s47 offen  lds
 s_add_u32 m0, s72, 50176
 s_nop 0
 buffer_load_dwordx4 v15, s[24:27], s47 offen  lds
 ds_read_b64_tr_b16 a[184:185], v17 offset:57344
 ds_read_b64_tr_b16 a[186:187], v17 offset:57600
 ds_read_b64_tr_b16 a[188:189], v17 offset:61440
 ds_read_b64_tr_b16 a[190:191], v17 offset:61696
 s_waitcnt vmcnt(18)
 s_waitcnt lgkmcnt(0)
 s_barrier
 s_add_u32 m0, s72, 57344
 s_add_u32 s47, s70, 2097280
 buffer_load_dwordx4 v56, s[12:15], s47 offen  lds
 s_add_u32 m0, s72, 58368
 s_nop 0
 buffer_load_dwordx4 v57, s[12:15], s47 offen  lds
 ds_read_b64_tr_b16 a[192:193], v18 offset:0
 ds_read_b64_tr_b16 a[194:195], v18 offset:256
 ds_read_b64_tr_b16 a[196:197], v18 offset:4096
 ds_read_b64_tr_b16 a[198:199], v18 offset:4352
 s_waitcnt vmcnt(18)
 s_waitcnt lgkmcnt(0)
 s_barrier
 s_add_u32 m0, s72, 65536
 s_add_u32 s47, s70, 2359424
 buffer_load_dwordx4 v56, s[12:15], s47 offen  lds
 s_add_u32 m0, s72, 66560
 s_nop 0
 buffer_load_dwordx4 v57, s[12:15], s47 offen  lds
 s_lshl_b32 s47, s6, 2
 s_add_u32 s47, s47, 0x4000
 v_mov_b32 v64, 1
 buffer_store_dword v64, v66, s[20:23], s47 offen
 ds_read_b64_tr_b16 a[200:201], v18 offset:8192
 ds_read_b64_tr_b16 a[202:203], v18 offset:8448
 ds_read_b64_tr_b16 a[204:205], v18 offset:12288
 ds_read_b64_tr_b16 a[206:207], v18 offset:12544
 s_waitcnt vmcnt(15)
 s_waitcnt lgkmcnt(0)
 s_barrier
 s_add_u32 m0, s72, 73728
 s_add_u32 s47, s70, 3145856
 buffer_load_dwordx4 v56, s[12:15], s47 offen  lds
 s_add_u32 m0, s72, 74752
 s_nop 0
 buffer_load_dwordx4 v57, s[12:15], s47 offen  lds
 ds_read_b64_tr_b16 a[208:209], v18 offset:16384
 ds_read_b64_tr_b16 a[210:211], v18 offset:16640
 ds_read_b64_tr_b16 a[212:213], v18 offset:20480
 ds_read_b64_tr_b16 a[214:215], v18 offset:20736
 s_waitcnt vmcnt(15)
 s_waitcnt lgkmcnt(0)
 s_barrier
 s_add_u32 m0, s72, 81920
 s_add_u32 s47, s70, 3408000
 buffer_load_dwordx4 v56, s[12:15], s47 offen  lds
 s_add_u32 m0, s72, 82944
 s_nop 0
 buffer_load_dwordx4 v57, s[12:15], s47 offen  lds
 ds_read_b64_tr_b16 a[216:217], v18 offset:24576
 ds_read_b64_tr_b16 a[218:219], v18 offset:24832
 ds_read_b64_tr_b16 a[220:221], v18 offset:28672
 ds_read_b64_tr_b16 a[222:223], v18 offset:28928
 s_waitcnt vmcnt(15)
 s_waitcnt lgkmcnt(0)
 s_barrier
 s_add_u32 m0, s72, 90112
 s_add_u32 s47, s70, 4194432
 buffer_load_dwordx4 v12, s[12:15], s47 offen  lds
 s_add_u32 m0, s72, 91136
 s_nop 0
 buffer_load_dwordx4 v13, s[12:15], s47 offen  lds
 ds_read_b64_tr_b16 a[224:225], v16 offset:24576
 ds_read_b64_tr_b16 a[226:227], v16 offset:24832
 ds_read_b64_tr_b16 a[228:229], v16 offset:28672
 ds_read_b64_tr_b16 a[230:231], v16 offset:28928
 s_waitcnt vmcnt(15)
 s_waitcnt lgkmcnt(0)
 s_barrier
 s_add_u32 m0, s72, 98304
 s_add_u32 s47, s71, 37888
 buffer_load_dwordx4 v14, s[24:27], s47 offen  lds
 s_add_u32 m0, s72, 99328
 s_nop 0
 buffer_load_dwordx4 v15, s[24:27], s47 offen  lds
 ds_read_b64_tr_b16 a[232:233], v16 offset:32768
 ds_read_b64_tr_b16 a[234:235], v16 offset:33024
 ds_read_b64_tr_b16 a[236:237], v16 offset:36864
 ds_read_b64_tr_b16 a[238:239], v16 offset:37120
 s_waitcnt vmcnt(15)
 s_waitcnt lgkmcnt(0)
 s_barrier
 s_add_u32 m0, s72, 106496
 s_add_u32 s47, s71, 36864
 buffer_load_dwordx4 v14, s[24:27], s47 offen  lds
 s_add_u32 m0, s72, 107520
 s_nop 0
 buffer_load_dwordx4 v15, s[24:27], s47 offen  lds
 ds_read_b64_tr_b16 a[240:241], v16 offset:40960
 ds_read_b64_tr_b16 a[242:243], v16 offset:41216
 ds_read_b64_tr_b16 a[244:245], v16 offset:45056
 ds_read_b64_tr_b16 a[246:247], v16 offset:45312
 s_waitcnt vmcnt(15)
 s_waitcnt lgkmcnt(0)
 s_barrier
 s_add_u32 m0, s72, 114688
 s_add_u32 s47, s71, 36992
 buffer_load_dwordx4 v14, s[24:27], s47 offen  lds
 s_add_u32 m0, s72, 115712
 s_nop 0
 buffer_load_dwordx4 v15, s[24:27], s47 offen  lds
 ds_read_b64_tr_b16 a[248:249], v16 offset:49152
 ds_read_b64_tr_b16 a[250:251], v16 offset:49408
 ds_read_b64_tr_b16 a[252:253], v16 offset:53248
 ds_read_b64_tr_b16 a[254:255], v16 offset:53504
 s_waitcnt vmcnt(15)
 s_waitcnt lgkmcnt(0)
 s_barrier
 s_add_u32 m0, s72, 122880
 s_add_u32 s47, s71, 37120
 buffer_load_dwordx4 v14, s[24:27], s47 offen  lds
 s_add_u32 m0, s72, 123904
 s_nop 0
 buffer_load_dwordx4 v15, s[24:27], s47 offen  lds
 v_lshrrev_b32 v68, 2, v3
 s_mov_b32 s47, 0x4000
 buffer_load_dword v68, v68, s[20:23], s47 offen sc1
 ds_read_b64_tr_b16 v[48:49], v16 offset:57344
 ds_read_b64_tr_b16 v[50:51], v16 offset:57600
 ds_read_b64_tr_b16 v[52:53], v16 offset:61440
 ds_read_b64_tr_b16 v[54:55], v16 offset:61696
 s_waitcnt vmcnt(16)
 s_waitcnt lgkmcnt(0)
 s_barrier
 s_add_u32 m0, s72, 131072
 s_add_u32 s47, s71, 37248
 buffer_load_dwordx4 v14, s[24:27], s47 offen  lds
 s_add_u32 m0, s72, 132096
 s_nop 0
 buffer_load_dwordx4 v15, s[24:27], s47 offen  lds
 ds_write_b128 v60, v[48:51] offset:57344
 ds_write_b128 v60, v[52:55] offset:61440
 ds_read_b64_tr_b16 v[40:41], v17 offset:0
 ds_read_b64_tr_b16 v[42:43], v17 offset:256
 ds_read_b64_tr_b16 v[44:45], v17 offset:4096
 ds_read_b64_tr_b16 v[46:47], v17 offset:4352
 s_waitcnt vmcnt(15)
 s_waitcnt lgkmcnt(0)
 s_barrier
 s_add_u32 m0, s72, 139264
 s_add_u32 s47, s71, 37376
 buffer_load_dwordx4 v14, s[24:27], s47 offen  lds
 s_add_u32 m0, s72, 140288
 s_nop 0
 buffer_load_dwordx4 v15, s[24:27], s47 offen  lds
 ds_write_b128 v61, v[40:43] offset:0
 ds_write_b128 v61, v[44:47] offset:4096
 ds_read_b64_tr_b16 v[48:49], v17 offset:8192
 ds_read_b64_tr_b16 v[50:51], v17 offset:8448
 ds_read_b64_tr_b16 v[52:53], v17 offset:12288
 ds_read_b64_tr_b16 v[54:55], v17 offset:12544
 s_waitcnt vmcnt(15)
 s_waitcnt lgkmcnt(0)
 s_barrier
 s_add_u32 m0, s72, 147456
 s_add_u32 s47, s71, 37504
 buffer_load_dwordx4 v14, s[24:27], s47 offen  lds
 s_add_u32 m0, s72, 148480
 s_nop 0
 buffer_load_dwordx4 v15, s[24:27], s47 offen  lds
 ds_write_b128 v61, v[48:51] offset:8192
 ds_write_b128 v61, v[52:55] offset:12288
 ds_read_b64_tr_b16 v[40:41], v17 offset:16384
 ds_read_b64_tr_b16 v[42:43], v17 offset:16640
 ds_read_b64_tr_b16 v[44:45], v17 offset:20480
 ds_read_b64_tr_b16 v[46:47], v17 offset:20736
 s_waitcnt vmcnt(15)
 s_waitcnt lgkmcnt(0)
 s_barrier
 s_add_u32 m0, s72, 155648
 s_add_u32 s47, s71, 37632
 buffer_load_dwordx4 v14, s[24:27], s47 offen  lds
 s_add_u32 m0, s72, 156672
 s_nop 0
 buffer_load_dwordx4 v15, s[24:27], s47 offen  lds
 ds_write_b128 v61, v[40:43] offset:16384
 ds_write_b128 v61, v[44:47] offset:20480
 ds_read_b64_tr_b16 v[48:49], v17 offset:24576
 ds_read_b64_tr_b16 v[50:51], v17 offset:24832
 ds_read_b64_tr_b16 v[52:53], v17 offset:28672
 ds_read_b64_tr_b16 v[54:55], v17 offset:28928
 s_waitcnt vmcnt(15)
 s_waitcnt lgkmcnt(0)
 s_barrier
 s_add_u32 m0, s72, 24576
 s_add_u32 s47, s70, 128
 buffer_load_dwordx4 v56, s[12:15], s47 offen  lds
 s_add_u32 m0, s72, 25600
 s_nop 0
 buffer_load_dwordx4 v57, s[12:15], s47 offen  lds
 ds_write_b128 v61, v[48:51] offset:24576
 ds_write_b128 v61, v[52:55] offset:28672
 ds_read_b64_tr_b16 v[40:41], v17 offset:32768
 ds_read_b64_tr_b16 v[42:43], v17 offset:33024
 ds_read_b64_tr_b16 v[44:45], v17 offset:36864
 ds_read_b64_tr_b16 v[46:47], v17 offset:37120
 s_waitcnt vmcnt(15)
 s_waitcnt lgkmcnt(0)
 s_barrier
 s_add_u32 m0, s72, 32768
 s_add_u32 s47, s70, 262272
 buffer_load_dwordx4 v56, s[12:15], s47 offen  lds
 s_add_u32 m0, s72, 33792
 s_nop 0
 buffer_load_dwordx4 v57, s[12:15], s47 offen  lds
 ds_write_b128 v61, v[40:43] offset:32768
 ds_write_b128 v61, v[44:47] offset:36864
 ds_read_b64_tr_b16 v[48:49], v17 offset:40960
 ds_read_b64_tr_b16 v[50:51], v17 offset:41216
 ds_read_b64_tr_b16 v[52:53], v17 offset:45056
 ds_read_b64_tr_b16 v[54:55], v17 offset:45312
 s_waitcnt vmcnt(15)
 s_waitcnt lgkmcnt(0)
 s_barrier
 s_add_u32 m0, s72, 40960
 s_add_u32 s47, s70, 1048704
 buffer_load_dwordx4 v56, s[12:15], s47 offen  lds
 s_add_u32 m0, s72, 41984
 s_nop 0
 buffer_load_dwordx4 v57, s[12:15], s47 offen  lds
 ds_write_b128 v61, v[48:51] offset:40960
 ds_write_b128 v61, v[52:55] offset:45056
 ds_read_b64_tr_b16 v[40:41], v17 offset:49152
 ds_read_b64_tr_b16 v[42:43], v17 offset:49408
 ds_read_b64_tr_b16 v[44:45], v17 offset:53248
 ds_read_b64_tr_b16 v[46:47], v17 offset:53504
 s_waitcnt vmcnt(15)
 s_waitcnt lgkmcnt(0)
 s_barrier
 s_add_u32 m0, s72, 49152
 s_add_u32 s47, s70, 1310848
 buffer_load_dwordx4 v56, s[12:15], s47 offen  lds
 s_add_u32 m0, s72, 50176
 s_nop 0
 buffer_load_dwordx4 v57, s[12:15], s47 offen  lds
 buffer_load_dword v1, v65, s[20:23], s56 offen sc1
 ds_write_b128 v61, v[40:43] offset:49152
 ds_write_b128 v61, v[44:47] offset:53248
 ds_read_b64_tr_b16 v[48:49], v17 offset:57344
 ds_read_b64_tr_b16 v[50:51], v17 offset:57600
 ds_read_b64_tr_b16 v[52:53], v17 offset:61440
 ds_read_b64_tr_b16 v[54:55], v17 offset:61696
 s_waitcnt vmcnt(15)
 s_waitcnt lgkmcnt(0)
 s_barrier
 v_cmp_ne_u32 vcc, 0, v68
 s_mov_b32 s77, vcc_lo
 s_and_b32 s47, s6, 29
 s_cbranch_scc1 Lgt_43
 buffer_store_dword v64, v66, s[28:31], 0 offen offset:128 sc1
Lgt_43:
 s_add_u32 s58, s6, 1
 s_and_b32 s58, s58, 31
 s_bitcmp1_b32 s77, s58
 s_cbranch_scc1 Lhlp_44
 s_lshl_b32 s76, s58, 8
 s_mul_i32 s80, s58, 147456
 s_add_u32 s47, s76, 3145856
 buffer_load_dword v63, v19, s[12:15], s47 offen
 s_add_u32 s47, s80, 37888
 buffer_load_dword v63, v59, s[24:27], s47 offen
 s_add_u32 s47, s80, 37120
 buffer_load_dword v63, v59, s[24:27], s47 offen
 s_add_u32 s47, s80, 37504
 buffer_load_dword v63, v59, s[24:27], s47 offen
 s_add_u32 s47, s76, 262272
 buffer_load_dword v63, v19, s[12:15], s47 offen
Lhlp_44:
 s_add_u32 s58, s6, 2
 s_and_b32 s58, s58, 31
 s_bitcmp1_b32 s77, s58
 s_cbranch_scc1 Lhlp_45
 s_lshl_b32 s76, s58, 8
 s_mul_i32 s80, s58, 147456
 s_add_u32 s47, s76, 3408000
 buffer_load_dword v63, v19, s[12:15], s47 offen
 s_add_u32 s47, s80, 36864
 buffer_load_dword v63, v59, s[24:27], s47 offen
 s_add_u32 s47, s80, 37248
 buffer_load_dword v63, v59, s[24:27], s47 offen
 s_add_u32 s47, s80, 37632
 buffer_load_dword v63, v59, s[24:27], s47 offen
 s_add_u32 s47, s76, 1048704
 buffer_load_dword v63, v19, s[12:15], s47 offen
Lhlp_45:
 s_add_u32 s58, s6, 3
 s_and_b32 s58, s58, 31
 s_bitcmp1_b32 s77, s58
 s_cbranch_scc1 Lhlp_46
 s_lshl_b32 s76, s58, 8
 s_mul_i32 s80, s58, 147456
 s_add_u32 s47, s76, 4194432
 buffer_load_dword v63, v58, s[12:15], s47 offen
 s_add_u32 s47, s80, 36992
 buffer_load_dword v63, v59, s[24:27], s47 offen
 s_add_u32 s47, s80, 37376
 buffer_load_dword v63, v59, s[24:27], s47 offen
 s_add_u32 s47, s76, 128
 buffer_load_dword v63, v19, s[12:15], s47 offen
 s_add_u32 s47, s76, 1310848
 buffer_load_dword v63, v19, s[12:15], s47 offen
Lhlp_46:
 ds_write_b128 v61, v[48:51] offset:57344
 ds_write_b128 v61, v[52:55] offset:61440
 ds_read_b64_tr_b16 v[40:41], v18 offset:0
 ds_read_b64_tr_b16 v[42:43], v18 offset:256
 ds_read_b64_tr_b16 v[44:45], v18 offset:4096
 ds_read_b64_tr_b16 v[46:47], v18 offset:4352
 s_waitcnt vmcnt(13)
 s_waitcnt lgkmcnt(0)
 s_barrier
 ds_write_b128 v62, v[40:43] offset:0
 ds_write_b128 v62, v[44:47] offset:4096
 ds_read_b64_tr_b16 v[48:49], v18 offset:8192
 ds_read_b64_tr_b16 v[50:51], v18 offset:8448
 ds_read_b64_tr_b16 v[52:53], v18 offset:12288
 ds_read_b64_tr_b16 v[54:55], v18 offset:12544
 s_waitcnt vmcnt(11)
 s_waitcnt lgkmcnt(0)
 s_barrier
 ds_write_b128 v62, v[48:51] offset:8192
 ds_write_b128 v62, v[52:55] offset:12288
 ds_read_b64_tr_b16 v[40:41], v18 offset:16384
 ds_read_b64_tr_b16 v[42:43], v18 offset:16640
 ds_read_b64_tr_b16 v[44:45], v18 offset:20480
 ds_read_b64_tr_b16 v[46:47], v18 offset:20736
 s_waitcnt vmcnt(9)
 s_waitcnt lgkmcnt(0)
 s_barrier
 ds_write_b128 v62, v[40:43] offset:16384
 ds_write_b128 v62, v[44:47] offset:20480
 ds_read_b64_tr_b16 v[48:49], v18 offset:24576
 ds_read_b64_tr_b16 v[50:51], v18 offset:24832
 ds_read_b64_tr_b16 v[52:53], v18 offset:28672
 ds_read_b64_tr_b16 v[54:55], v18 offset:28928
 s_waitcnt vmcnt(7)
 s_waitcnt lgkmcnt(0)
 s_barrier
 ds_write_b128 v62, v[48:51] offset:24576
 ds_write_b128 v62, v[52:55] offset:28672
 ds_read_b64_tr_b16 v[40:41], v16 offset:24576
 ds_read_b64_tr_b16 v[42:43], v16 offset:24832
 ds_read_b64_tr_b16 v[44:45], v16 offset:28672
 ds_read_b64_tr_b16 v[46:47], v16 offset:28928
 s_waitcnt vmcnt(5)
 s_waitcnt lgkmcnt(0)
 s_barrier
 ds_write_b128 v60, v[40:43] offset:24576
 ds_write_b128 v60, v[44:47] offset:28672
 ds_read_b64_tr_b16 v[48:49], v16 offset:32768
 ds_read_b64_tr_b16 v[50:51], v16 offset:33024
 ds_read_b64_tr_b16 v[52:53], v16 offset:36864
 ds_read_b64_tr_b16 v[54:55], v16 offset:37120
 s_waitcnt vmcnt(3)
 s_waitcnt lgkmcnt(0)
 s_barrier
 ds_write_b128 v60, v[48:51] offset:32768
 ds_write_b128 v60, v[52:55] offset:36864
 ds_read_b64_tr_b16 v[40:41], v16 offset:40960
 ds_read_b64_tr_b16 v[42:43], v16 offset:41216
 ds_read_b64_tr_b16 v[44:45], v16 offset:45056
 ds_read_b64_tr_b16 v[46:47], v16 offset:45312
 s_waitcnt vmcnt(1)
 s_waitcnt lgkmcnt(0)
 s_barrier
 ds_write_b128 v60, v[40:43] offset:40960
 ds_write_b128 v60, v[44:47] offset:45056
 ds_read_b64_tr_b16 v[48:49], v16 offset:49152
 ds_read_b64_tr_b16 v[50:51], v16 offset:49408
 ds_read_b64_tr_b16 v[52:53], v16 offset:53248
 ds_read_b64_tr_b16 v[54:55], v16 offset:53504
 s_waitcnt lgkmcnt(0)
 s_barrier
 ds_write_b128 v60, v[48:51] offset:49152
 ds_write_b128 v60, v[52:55] offset:53248
 v_lshlrev_b32 v0, 4, v0
 s_waitcnt vmcnt(0)
 v_cmp_le_u32 vcc, 2, v1
 s_cbranch_vccnz Lpbk_47
Lpb0_48:
 buffer_load_dword v1, v7, s[20:23], s56 offen sc1
 s_waitcnt vmcnt(0)
 v_cmp_le_u32 vcc, 2, v1
 s_cbranch_vccnz Lpb0ok_49
 s_sub_u32 s54, s54, 1
 s_cbranch_scc0 Lpb0_48
 s_endpgm
Lpb0ok_49:
Lpbk_47:
 s_lshl_b32 s47, s4, 11
 s_add_u32 m0, s47, 9216
 s_add_u32 s68, s37, 0x80000
 buffer_load_dwordx4 v3, s[20:23], s67 offen offset:0 sc1 lds
 buffer_load_dwordx4 v3, s[20:23], s67 offen offset:1024 sc1 lds
 buffer_load_dword v68, v67, s[20:23], s37 offen sc1
 buffer_load_dword v68, v67, s[20:23], s68 offen sc1
 s_add_u32 s68, s68, 0x80000
 s_mov_b32 s24, 0xf000f
 s_mov_b32 s25, 0xf000f
 s_mov_b32 s26, 0xf000f0
 s_mov_b32 s27, 0xf000f0
 s_mov_b32 s28, 0xf000f00
 s_mov_b32 s29, 0xf000f00
 s_mov_b32 s30, 0xf000f000
 s_mov_b32 s31, 0xf000f000
 s_mov_b32 s32, 0xaaaaaaaa
 s_mov_b32 s33, 0xaaaaaaaa
 s_mov_b32 s34, 0x3f803f80
 s_mov_b32 s35, 0x3f803f80
 s_mov_b32 s70, -1
 s_mov_b32 s71, 0
 s_lshl_b32 s47, s4, 12
 s_add_u32 s68, s68, s47
 v_mov_b32 v2, 0
 v_mov_b32 v4, 0
 s_waitcnt lgkmcnt(0)
 ds_read_b128 v[20:23], v0 offset:24576
 ds_read_b128 v[24:27], v0 offset:28672
 ds_read_b128 v[28:31], v0 offset:32768
 ds_read_b128 v[32:35], v0 offset:36864
 v_mov_b64 v[36:37], 0
 v_mov_b64 v[38:39], 0
 v_mov_b64 v[40:41], 0
 v_mov_b64 v[42:43], 0
 v_mov_b64 v[44:45], 0
 v_mov_b64 v[46:47], 0
 v_mov_b64 v[48:49], 0
 v_mov_b64 v[50:51], 0
 v_lshl_add_u32 v1, v3, 3, s68
 v_mov_b32 v6, s56
 v_cndmask_b32 v1, v6, v1, s[70:71]
 s_xor_b32 s44, s44, 0x80000
 s_xor_b32 s45, s45, 0x80000
 s_xor_b32 s65, s65, 0x80000
 s_xor_b32 s66, s66, 0x80000
 s_xor_b32 s41, s41, 0x80000
 s_xor_b32 s43, s43, 0x80000
 s_lshr_b64 s[74:75], s[74:75], s73
 s_and_b32 s74, s74, 0xff
 s_cmp_eq_u32 s74, 32
 s_waitcnt vmcnt(2)
 s_cbranch_scc0 Lslow_50
 .p2align 3
Lstep_52:
 s_mov_b64 exec, -1
 s_waitcnt lgkmcnt(0)
 s_barrier
 ds_read_b128 v[52:55], v3 offset:0
 ds_read_b128 v[56:59], v3 offset:1024
 ds_read_b128 v[60:63], v3 offset:2048
 buffer_load_dwordx4 v[12:15], v3, s[20:23], s59 offen offset:0 sc1
 s_waitcnt lgkmcnt(2)
 v_smfmac_f32_16x16x64_bf16 v[36:39], v[52:55], v[72:79], v5
 v_smfmac_f32_16x16x64_bf16 v[40:43], v[52:55], v[80:87], v5
 buffer_load_dwordx4 v[16:19], v3, s[20:23], s59 offen offset:1024 sc1
 v_smfmac_f32_16x16x64_bf16 v[44:47], v[52:55], v[88:95], v5
 s_waitcnt lgkmcnt(1)
 v_smfmac_f32_16x16x64_bf16 v[48:51], v[52:55], v[20:27], v5
 v_smfmac_f32_16x16x64_bf16 v[36:39], v[56:59], v[112:119], v5
 ds_read_b128 v[20:23], v0 offset:40960
 v_smfmac_f32_16x16x64_bf16 v[40:43], v[56:59], v[120:127], v5
 ds_read_b128 v[24:27], v0 offset:45056
 v_smfmac_f32_16x16x64_bf16 v[44:47], v[56:59], v[128:135], v5
 ds_read_b128 v[52:55], v3 offset:3072
 s_waitcnt lgkmcnt(3)
 v_smfmac_f32_16x16x64_bf16 v[48:51], v[56:59], v[28:35], v5
 buffer_load_dword v1, v1, s[20:23], 0 offen sc1
 v_smfmac_f32_16x16x64_bf16 v[36:39], v[60:63], v[152:159], v5
 ds_read_b128 v[28:31], v0 offset:49152
 s_max_u32 s47, s36, 1
 v_smfmac_f32_16x16x64_bf16 v[40:43], v[60:63], v[160:167], v5
 ds_read_b128 v[32:35], v0 offset:53248
 s_sub_u32 s47, s47, 1
 v_smfmac_f32_16x16x64_bf16 v[44:47], v[60:63], v[168:175], v5
 ds_read_b128 v[56:59], v3 offset:4096
 s_waitcnt lgkmcnt(3)
 v_smfmac_f32_16x16x64_bf16 v[48:51], v[60:63], v[20:27], v5
 v_smfmac_f32_16x16x64_bf16 v[36:39], v[52:55], v[192:199], v5
 ds_read_b128 v[20:23], v0 offset:57344
 v_min_u32 v6, 16, v0
 v_smfmac_f32_16x16x64_bf16 v[40:43], v[52:55], v[200:207], v5
 ds_read_b128 v[24:27], v0 offset:61440
 v_lshlrev_b32 v6, 24, v6
 v_smfmac_f32_16x16x64_bf16 v[44:47], v[52:55], v[208:215], v5
 ds_read_b128 v[60:63], v3 offset:5120
 s_waitcnt lgkmcnt(3)
 v_add_u32 v0, 0x10000, v0
 v_smfmac_f32_16x16x64_bf16 v[48:51], v[52:55], v[28:35], v5
 buffer_store_dwordx4 v[64:67], v0, s[20:23], s38 offen sc1
 v_smfmac_f32_16x16x64_bf16 v[36:39], v[56:59], v[232:239], v5
 ds_read_b128 v[28:31], v0 offset:0
 v_smfmac_f32_16x16x64_bf16 v[40:43], v[56:59], v[240:247], v5
 ds_read_b128 v[32:35], v0 offset:4096
 v_smfmac_f32_16x16x64_bf16 v[44:47], v[56:59], v[248:255], v5
 ds_read_b128 v[52:55], v3 offset:6144
 s_waitcnt lgkmcnt(3)
 v_smfmac_f32_16x16x64_bf16 v[48:51], v[56:59], v[20:27], v5
 v_smfmac_f32_16x16x64_bf16 v[36:39], v[60:63], a[16:23], v5
 ds_read_b128 v[20:23], v0 offset:8192
 v_mov_b32 v64, s47
 v_smfmac_f32_16x16x64_bf16 v[40:43], v[60:63], a[24:31], v5
 ds_read_b128 v[24:27], v0 offset:12288
 v_smfmac_f32_16x16x64_bf16 v[44:47], v[60:63], a[32:39], v5
 ds_read_b128 v[56:59], v3 offset:7168
 s_waitcnt lgkmcnt(3)
 v_smfmac_f32_16x16x64_bf16 v[48:51], v[60:63], v[28:35], v5
 buffer_store_dword v64, v6, s[20:23], s57 offen sc1
 v_smfmac_f32_16x16x64_bf16 v[36:39], v[52:55], a[56:63], v5
 ds_read_b128 v[28:31], v0 offset:16384
 v_smfmac_f32_16x16x64_bf16 v[40:43], v[52:55], a[64:71], v5
 ds_read_b128 v[32:35], v0 offset:20480
 v_smfmac_f32_16x16x64_bf16 v[44:47], v[52:55], a[72:79], v5
 ds_read_b128 v[60:63], v3 offset:8192
 s_waitcnt lgkmcnt(3)
 v_smfmac_f32_16x16x64_bf16 v[48:51], v[52:55], v[20:27], v5
 s_waitcnt vmcnt(5)
 v_smfmac_f32_16x16x64_bf16 v[36:39], v[56:59], a[96:103], v5
 ds_read_b128 v[20:23], v0 offset:24576
 v_mov_b64 v[64:65], 0
 v_smfmac_f32_16x16x64_bf16 v[40:43], v[56:59], a[104:111], v5
 ds_read_b128 v[24:27], v0 offset:28672
 v_mov_b64 v[66:67], 0
 v_smfmac_f32_16x16x64_bf16 v[44:47], v[56:59], a[112:119], v5
 ds_read_b128 v[52:55], v3 offset:0
 s_waitcnt lgkmcnt(3)
 v_mov_b64 v[68:69], 0
 v_smfmac_f32_16x16x64_bf16 v[48:51], v[56:59], v[28:35], v5
 v_mov_b64 v[70:71], 0
 v_smfmac_f32_16x16x64_bf16 v[36:39], v[60:63], a[136:143], v5
 ds_read_b128 v[32:35], v3 offset:11264
 v_mov_b64 v[28:29], 0
 v_smfmac_f32_16x16x64_bf16 v[40:43], v[60:63], a[144:151], v5
 v_mov_b64 v[30:31], 0
 v_smfmac_f32_16x16x64_bf16 v[44:47], v[60:63], a[152:159], v5
 ds_read_b128 v[56:59], v3 offset:1024
 s_waitcnt lgkmcnt(2)
 v_add_f32 v36, v36, v38
 v_smfmac_f32_16x16x64_bf16 v[48:51], v[60:63], v[20:27], v5
 ds_read_b128 v[60:63], v3 offset:2048
 ds_read_b128 v[20:23], v3 offset:9216
 v_add_f32 v37, v37, v39
 v_cvt_pk_bf16_f32 v36, v36, v37
 v_smfmac_f32_16x16x64_bf16 v[64:67], v[52:55], v[96:103], v5
 ds_write_b16 v10, v36 offset:17408
 ds_write_b16_d16_hi v10, v36 offset:17472
 v_add_f32 v40, v40, v42
 v_add_f32 v41, v41, v43
 v_cvt_pk_bf16_f32 v40, v40, v41
 v_smfmac_f32_16x16x64_bf16 v[68:71], v[52:55], v[104:111], v5
 ds_write_b16 v10, v40 offset:17412
 ds_write_b16_d16_hi v10, v40 offset:17476
 v_add_f32 v44, v44, v46
 v_add_f32 v45, v45, v47
 v_add_f32 v48, v48, v50
 v_add_f32 v49, v49, v51
 v_cvt_pk_bf16_f32 v44, v44, v45
 v_cvt_pk_bf16_f32 v45, v48, v49
 ds_write_b64 v8, v[44:45] offset:19456
 s_waitcnt lgkmcnt(7)
 v_smfmac_f32_16x16x64_bf16 v[64:67], v[56:59], v[136:143], v5
 ds_read_b128 v[52:55], v3 offset:3072
 ds_read_b128 v[24:27], v3 offset:10240
 v_smfmac_f32_16x16x64_bf16 v[68:71], v[56:59], v[144:151], v5
 ds_read_b128 v[56:59], v3 offset:4096
 s_waitcnt lgkmcnt(9)
 v_smfmac_f32_16x16x64_bf16 v[64:67], v[60:63], v[176:183], v5
 v_smfmac_f32_16x16x64_bf16 v[68:71], v[60:63], v[184:191], v5
 s_waitcnt lgkmcnt(3)
 s_barrier
 ds_read_b128 v[36:39], v11 offset:17408
 ds_read_b128 v[40:43], v11 offset:17920
 s_waitcnt lgkmcnt(4)
 v_smfmac_f32_16x16x64_bf16 v[64:67], v[52:55], v[216:223], v5
 ds_read_b64_tr_b16 v[60:61], v9 offset:19456
 ds_read_b64_tr_b16 v[62:63], v9 offset:19488
 v_smfmac_f32_16x16x64_bf16 v[68:71], v[52:55], v[224:231], v5
 ds_read_b128 v[52:55], v3 offset:5120
 ds_read_b128 v[44:47], v11 offset:18432
 s_waitcnt lgkmcnt(6)
 v_smfmac_f32_16x16x64_bf16 v[64:67], v[56:59], a[0:7], v5
 ds_read_b128 v[48:51], v11 offset:18944
 v_smfmac_f32_16x16x64_bf16 v[68:71], v[56:59], a[8:15], v5
 ds_read_b128 v[56:59], v3 offset:6144
 s_waitcnt lgkmcnt(7)
 v_mfma_f32_16x16x32_bf16 v[20:23], v[20:23], v[36:39], 0
 v_mfma_f32_16x16x32_bf16 v[24:27], v[24:27], v[36:39], 0
 s_waitcnt lgkmcnt(6)
 v_mfma_f32_16x16x32_bf16 v[20:23], v[32:35], v[40:43], v[20:23]
 ds_read_b128 v[32:35], v3 offset:12288
 s_waitcnt lgkmcnt(5)
 v_smfmac_f32_16x16x64_bf16 v[28:31], v[60:63], v[36:43], v5
 ds_read_b64_tr_b16 v[60:61], v9 offset:20544
 ds_read_b64_tr_b16 v[62:63], v9 offset:20576
 ds_read_b128 v[36:39], v3 offset:13312
 s_waitcnt lgkmcnt(7)
 v_smfmac_f32_16x16x64_bf16 v[64:67], v[52:55], a[40:47], v5
 v_smfmac_f32_16x16x64_bf16 v[68:71], v[52:55], a[48:55], v5
 ds_read_b128 v[52:55], v3 offset:7168
 s_waitcnt lgkmcnt(4)
 v_mfma_f32_16x16x32_bf16 v[24:27], v[32:35], v[40:43], v[24:27]
 ds_read_b128 v[40:43], v3 offset:14336
 ds_read_b128 v[32:35], v3 offset:15360
 s_waitcnt lgkmcnt(4)
 v_smfmac_f32_16x16x64_bf16 v[28:31], v[60:63], v[44:51], v5
 ds_read_b128 v[60:63], v3 offset:16384
 s_waitcnt lgkmcnt(4)
 v_mfma_f32_16x16x32_bf16 v[20:23], v[36:39], v[44:47], v[20:23]
 v_smfmac_f32_16x16x64_bf16 v[64:67], v[56:59], a[80:87], v5
 v_smfmac_f32_16x16x64_bf16 v[68:71], v[56:59], a[88:95], v5
 ds_read_b128 v[56:59], v3 offset:8192
 v_add_f32 v28, v28, v30
 s_waitcnt lgkmcnt(3)
 v_mfma_f32_16x16x32_bf16 v[24:27], v[40:43], v[44:47], v[24:27]
 v_add_f32 v29, v29, v31
 v_max_f32 v30, v28, v29
 s_waitcnt lgkmcnt(2)
 v_mfma_f32_16x16x32_bf16 v[20:23], v[32:35], v[48:51], v[20:23]
 v_cndmask_b32 v28, v28, v29, s[48:49]
 s_waitcnt lgkmcnt(1)
 v_mfma_f32_16x16x32_bf16 v[24:27], v[60:63], v[48:51], v[24:27]
 v_mov_b64 v[32:33], s[34:35]
 v_mov_b64 v[34:35], s[34:35]
 v_smfmac_f32_16x16x64_bf16 v[64:67], v[52:55], a[120:127], v5
 ds_read_b128 v[36:39], v0 offset:32768
 ds_read_b128 v[40:43], v0 offset:36864
 v_max3_f32 v30, v30, v20, v21
 v_smfmac_f32_16x16x64_bf16 v[68:71], v[52:55], a[128:135], v5
 ds_read_b128 v[44:47], v0 offset:40960
 ds_read_b128 v[48:51], v0 offset:45056
 v_max3_f32 v30, v30, v22, v23
 v_max3_f32 v30, v30, v24, v25
 v_max3_f32 v31, v30, v26, v27
 v_max3_f32 v29, v30, v26, v27
 s_waitcnt lgkmcnt(4)
 v_smfmac_f32_16x16x64_bf16 v[64:67], v[56:59], a[160:167], v5
 v_cndmask_b32 v20, v20, v24, s[48:49]
 v_smfmac_f32_16x16x64_bf16 v[68:71], v[56:59], a[168:175], v5
 v_cndmask_b32 v21, v21, v25, s[48:49]
 v_permlane16_swap_b32 v31, v29
 v_max_f32 v30, v31, v29
 v_max_f32 v6, v31, v29
 v_cndmask_b32 v22, v22, v26, s[48:49]
 v_cndmask_b32 v23, v23, v27, s[48:49]
 v_permlane32_swap_b32 v30, v6
 v_max_f32 v30, v30, v6
 v_mul_f32 v30, -s55, v30
 v_fma_f32 v28, v28, s55, v30
 v_fma_f32 v20, v20, s55, v30
 v_fma_f32 v21, v21, s55, v30
 v_fma_f32 v22, v22, s55, v30
 v_fma_f32 v23, v23, s55, v30
 v_exp_f32 v28, v28
 v_add_f32 v64, v64, v66
 v_add_f32 v65, v65, v67
 v_cndmask_b32 v29, 0, v28, s[48:49]
 v_cndmask_b32 v28, v28, 0, s[48:49]
 v_cvt_pk_bf16_f32 v6, v28, v29
 v_add_f32 v68, v68, v70
 v_add_f32 v69, v69, v71
 v_mfma_f32_16x16x16_bf16 v[60:63], v[6:7], v[32:33], 0
 v_cvt_pk_bf16_f32 v2, v64, v65
 v_cvt_pk_bf16_f32 v4, v68, v69
 v_exp_f32 v20, v20
 v_exp_f32 v21, v21
 v_mfma_f32_16x16x16_bf16 v[52:55], v[6:7], v[2:3], 0
 s_waitcnt vmcnt(3)
 v_exp_f32 v22, v22
 v_mfma_f32_16x16x16_bf16 v[56:59], v[6:7], v[4:5], 0
 s_cmp_eq_u32 s36, 63
 v_exp_f32 v23, v23
 v_cvt_pk_bf16_f32 v30, v20, v21
 v_cvt_pk_bf16_f32 v31, v22, v23
 v_mov_b64 v[64:65], 0
 v_mov_b64 v[66:67], 0
 v_smfmac_f32_16x16x32_bf16 v[60:63], v[30:31], v[32:35], v5
 v_mov_b64 v[68:69], 0
 v_mov_b64 v[70:71], 0
 v_smfmac_f32_16x16x32_bf16 v[52:55], v[30:31], v[12:15], v5
 v_mov_b64 v[20:21], 0
 v_mov_b64 v[22:23], 0
 v_smfmac_f32_16x16x32_bf16 v[56:59], v[30:31], v[16:19], v5
 s_nop 0
 v_add_f32 v60, v60, v62
 v_add_f32 v61, v61, v63
 v_rcp_f32 v60, v60
 v_rcp_f32 v61, v61
 v_add_f32 v52, v52, v54
 v_add_f32 v53, v53, v55
 v_mul_f32 v52, v52, v60
 v_mul_f32 v53, v53, v61
 v_add_f32 v56, v56, v58
 v_add_f32 v57, v57, v59
 v_mul_f32 v56, v56, v60
 v_mul_f32 v57, v57, v61
 v_cvt_pk_bf16_f32 v52, v52, v53
 v_cvt_pk_bf16_f32 v53, v56, v57
 ds_write_b64 v8, v[52:53] offset:21632
 s_cbranch_scc1 Lchexit_51
 v_bfe_u32 v6, v0, 7, 5
 v_mul_u32_u24 v6, 10496, v6
 v_bfe_u32 v60, v3, 4, 3
 v_lshl_add_u32 v6, v60, 3, v6
 s_xor_b32 s46, s46, 0x1
 v_mov_b64 v[24:25], 0
 s_add_u32 s67, s67, 0x80000
 v_mov_b64 v[26:27], 0
 s_add_u32 s59, s59, 0x80000
 v_mov_b64 v[28:29], 0
 s_add_u32 s38, s38, 0x20000
 v_mov_b64 v[30:31], 0
 s_waitcnt lgkmcnt(0)
 s_barrier
 ds_read_b64_tr_b16 v[52:53], v9 offset:21632
 ds_read_b64_tr_b16 v[54:55], v9 offset:21664
 v_mov_b64 v[32:33], 0
 ds_read_b64_tr_b16 v[56:57], v9 offset:22720
 ds_read_b64_tr_b16 v[58:59], v9 offset:22752
 v_mov_b64 v[34:35], 0
 s_cmp_lt_u32 s36, 61
 v_mov_b64 v[12:13], 0
 s_cselect_b32 s47, 0x80000, 0
 v_mov_b64 v[14:15], 0
 s_add_u32 s68, s68, s47
 v_mov_b64 v[16:17], 0
 s_add_u32 s36, s36, 1
 v_mov_b64 v[18:19], 0
 s_waitcnt lgkmcnt(2)
 v_smfmac_f32_16x16x64_bf16 v[64:67], v[52:55], a[248:255], v5
 s_add_u32 s58, s36, 2
 s_min_u32 s58, s58, 64
 v_mov_b64 v[60:61], 0
 v_smfmac_f32_16x16x64_bf16 v[68:71], v[52:55], a[176:183], v5
 buffer_load_dwordx4 v3, s[20:23], s67 offen offset:0 sc1 lds
 v_mov_b64 v[62:63], 0
 s_waitcnt lgkmcnt(0)
 v_smfmac_f32_16x16x64_bf16 v[64:67], v[56:59], v[36:43], v5
 ds_read_b128 v[36:39], v0 offset:49152
 ds_read_b128 v[40:43], v0 offset:53248
 v_smfmac_f32_16x16x64_bf16 v[20:23], v[52:55], a[184:191], v5
 buffer_load_dwordx4 v3, s[20:23], s67 offen offset:1024 sc1 lds
 v_smfmac_f32_16x16x64_bf16 v[68:71], v[56:59], v[44:51], v5
 ds_read_b128 v[44:47], v0 offset:57344
 ds_read_b128 v[48:51], v0 offset:61440
 v_add_f32 v64, v64, v66
 v_add_f32 v65, v65, v67
 v_smfmac_f32_16x16x64_bf16 v[24:27], v[52:55], a[192:199], v5
 s_xor_b32 s44, s44, 0x80000
 s_xor_b32 s45, s45, 0x80000
 v_cvt_pk_bf16_f32 v65, v65, v65
 v_cvt_pk_bf16_f32 v64, v64, v64
 s_waitcnt lgkmcnt(2)
 v_add_u32 v0, 0x10000, v0
 v_smfmac_f32_16x16x64_bf16 v[20:23], v[56:59], v[36:43], v5
 ds_read_b128 v[36:39], v0 offset:0
 ds_read_b128 v[40:43], v0 offset:4096
 v_and_or_b32 v65, v65, -2, s46
 v_smfmac_f32_16x16x64_bf16 v[28:31], v[52:55], a[200:207], v5
 buffer_store_dwordx2 v[64:65], v6, s[20:23], s62 offen
 v_add_f32 v68, v68, v70
 v_add_f32 v69, v69, v71
 s_waitcnt lgkmcnt(2)
 v_smfmac_f32_16x16x64_bf16 v[24:27], v[56:59], v[44:51], v5
 ds_read_b128 v[44:47], v0 offset:8192
 ds_read_b128 v[48:51], v0 offset:12288
 v_add_f32 v20, v20, v22
 v_add_f32 v21, v21, v23
 v_smfmac_f32_16x16x64_bf16 v[32:35], v[52:55], a[208:215], v5
 s_xor_b32 s65, s65, 0x80000
 s_xor_b32 s66, s66, 0x80000
 v_cvt_pk_bf16_f32 v69, v69, v21
 v_cvt_pk_bf16_f32 v68, v68, v20
 s_waitcnt lgkmcnt(2)
 v_smfmac_f32_16x16x64_bf16 v[28:31], v[56:59], v[36:43], v5
 ds_read_b128 v[36:39], v0 offset:16384
 ds_read_b128 v[40:43], v0 offset:20480
 v_and_or_b32 v69, v69, -2, s46
 v_smfmac_f32_16x16x64_bf16 v[12:15], v[52:55], a[216:223], v5
 buffer_store_dwordx2 v[68:69], v6, s[20:23], s60 offen offset:0
 v_add_f32 v24, v24, v26
 v_add_f32 v25, v25, v27
 s_waitcnt lgkmcnt(2)
 v_smfmac_f32_16x16x64_bf16 v[32:35], v[56:59], v[44:51], v5
 ds_read_b128 v[44:47], v0 offset:24576
 ds_read_b128 v[48:51], v0 offset:28672
 v_add_f32 v28, v28, v30
 v_add_f32 v29, v29, v31
 v_smfmac_f32_16x16x64_bf16 v[16:19], v[52:55], a[224:231], v5
 s_xor_b32 s41, s41, 0x80000
 s_xor_b32 s43, s43, 0x80000
 v_cvt_pk_bf16_f32 v25, v25, v29
 v_cvt_pk_bf16_f32 v24, v24, v28
 s_waitcnt lgkmcnt(2)
 v_smfmac_f32_16x16x64_bf16 v[12:15], v[56:59], v[36:43], v5
 v_and_or_b32 v25, v25, -2, s46
 v_smfmac_f32_16x16x64_bf16 v[60:63], v[52:55], a[232:239], v5
 buffer_store_dwordx2 v[24:25], v6, s[20:23], s60 offen offset:2048
 v_add_f32 v32, v32, v34
 v_add_f32 v33, v33, v35
 s_waitcnt lgkmcnt(0)
 v_smfmac_f32_16x16x64_bf16 v[16:19], v[56:59], v[44:51], v5
 s_nop 0
 v_add_f32 v12, v12, v14
 v_add_f32 v13, v13, v15
 v_smfmac_f32_16x16x64_bf16 v[60:63], v[56:59], a[240:247], v5
 v_cvt_pk_bf16_f32 v33, v33, v13
 v_cvt_pk_bf16_f32 v32, v32, v12
 v_and_or_b32 v33, v33, -2, s46
 buffer_store_dwordx2 v[32:33], v6, s[20:23], s61 offen offset:0
 v_add_f32 v16, v16, v18
 v_add_f32 v17, v17, v19
 s_cmp_eq_u32 s4, 0
 s_nop 0
 v_add_f32 v60, v60, v62
 v_add_f32 v61, v61, v63
 v_cvt_pk_bf16_f32 v17, v17, v61
 v_cvt_pk_bf16_f32 v16, v16, v60
 v_and_or_b32 v17, v17, -2, s46
 buffer_store_dwordx2 v[16:17], v6, s[20:23], s61 offen offset:2048
 s_cbranch_scc1 LwH_54
 v_mov_b32 v47, 0x3f80
 v_cndmask_b32 v47, v47, 1.0, s[32:33]
 v_cndmask_b32 v44, 0, v47, s[24:25]
 v_cndmask_b32 v45, 0, v47, s[26:27]
 v_cndmask_b32 v46, 0, v47, s[28:29]
 v_cndmask_b32 v47, 0, v47, s[30:31]
 v_bfe_u32 v52, v3, 8, 2
 v_bfe_u32 v58, v3, 2, 4
 v_lshl_or_b32 v52, v52, 4, v58
 v_and_b32 v58, 0xc0, v3
 v_lshl_or_b32 v52, v58, 24, v52
 v_subrev_u32 v0, 0x20000, v0
 v_mov_b32 v59, -1
 v_add_u32 v54, s42, v3
 v_add_u32 v58, s69, v9
 ds_read_b64_tr_b16 v[64:65], v58 offset:19456
 v_mov_b32 v66, v2
 v_mov_b32 v67, v4
 ds_read_b128 v[20:23], v0 offset:24576
 ds_read_b128 v[24:27], v0 offset:28672
 ds_read_b128 v[28:31], v0 offset:32768
 ds_read_b128 v[32:35], v0 offset:36864
 s_cmp_eq_u32 s4, 1
 s_waitcnt vmcnt(2)
 s_cbranch_scc1 Lq1_55
 s_cmp_eq_u32 s4, 2
 s_waitcnt vmcnt(1)
 s_cbranch_scc1 Lq1_55
 s_waitcnt vmcnt(0)
Lq1_55:
 buffer_load_dwordx4 v[36:39], v3, s[20:23], s39 offen offset:0 sc1
 buffer_load_dwordx4 v[40:43], v3, s[20:23], s39 offen offset:1024 sc1
 s_nop 15
 s_nop 11
 buffer_load_dwordx4 v[12:15], v3, s[20:23], s39 offen offset:0 sc1
 buffer_load_dwordx4 v[16:19], v3, s[20:23], s39 offen offset:1024 sc1
 s_waitcnt vmcnt(3)
 v_mfma_f32_16x16x32_bf16 v[48:51], v[44:47], v[36:39], 0
 s_waitcnt vmcnt(2)
 v_mfma_f32_16x16x32_bf16 v[48:51], v[44:47], v[40:43], v[48:51]
 v_bitop3_b32 v55, v37, v39, s46 bitop3:0x7e
 v_bitop3_b32 v56, v41, v43, s46 bitop3:0x7e
 v_bitop3_b32 v55, v55, 1, v56 bitop3:0xc8
 v_cmp_ne_u32 vcc, 0, v55
 s_nop 3
 v_add_f32_dpp v48, v48, v48 row_ror:4 row_mask:0xf bank_mask:0xf
 v_add_f32_dpp v49, v49, v49 row_ror:4 row_mask:0xf bank_mask:0xf
 s_cbranch_vccnz Lr2_57
 v_add_f32_dpp v48, v48, v48 row_ror:8 row_mask:0xf bank_mask:0xf
 v_add_f32_dpp v49, v49, v49 row_ror:8 row_mask:0xf bank_mask:0xf
 v_cvt_pk_bf16_f32 v48, v48, v49
 buffer_store_dword v48, v52, s[20:23], s44 offen
Lb1_58:
 buffer_store_dword v59, v52, s[20:23], s45 offen
 v_cmp_gt_u32 vcc, s58, v1
 v_mov_b64 v[36:37], 0
 v_mov_b64 v[38:39], 0
 v_mov_b64 v[40:41], 0
 v_mov_b64 v[42:43], 0
 v_mov_b64 v[44:45], 0
 v_mov_b64 v[46:47], 0
 v_mov_b64 v[48:49], 0
 v_mov_b64 v[50:51], 0
 s_cmp_lg_u32 vcc_hi, 0
 s_cbranch_scc1 Lfw_60
Lfok_59:
 v_lshl_add_u32 v1, v3, 3, s68
 v_mov_b32 v6, s56
 v_cndmask_b32 v1, v6, v1, s[70:71]
 s_nop 15
 s_nop 3
 buffer_load_dwordx4 v[12:15], v3, s[20:23], s41 offen offset:0 sc1
 buffer_load_dwordx4 v[16:19], v3, s[20:23], s41 offen offset:1024 sc1
 s_nop 15
 s_nop 7
Lp2_61:
 buffer_load_dwordx4 v[12:15], v3, s[20:23], s41 offen offset:0 sc1
 buffer_load_dwordx4 v[16:19], v3, s[20:23], s41 offen offset:1024 sc1
 s_waitcnt vmcnt(2)
 v_max3_u32 v55, v12, v13, v14
 v_max3_u32 v55, v55, v15, v16
 v_max3_u32 v55, v55, v17, v18
 v_max_u32 v55, v55, v19
 ds_write_b128 v54, v[12:15] offset:0
 ds_write_b128 v54, v[16:19] offset:1024
 v_cmpx_eq_u32 vcc, -1, v55
 s_cbranch_execz Lstep_52
 buffer_load_dwordx4 v[12:15], v3, s[20:23], s41 offen offset:0 sc1
 buffer_load_dwordx4 v[16:19], v3, s[20:23], s41 offen offset:1024 sc1
 s_waitcnt vmcnt(2)
 v_max3_u32 v55, v12, v13, v14
 v_max3_u32 v55, v55, v15, v16
 v_max3_u32 v55, v55, v17, v18
 v_max_u32 v55, v55, v19
 ds_write_b128 v54, v[12:15] offset:0
 ds_write_b128 v54, v[16:19] offset:1024
 v_cmpx_eq_u32 vcc, -1, v55
 s_cbranch_execz Lstep_52
 buffer_load_dwordx4 v[12:15], v3, s[20:23], s41 offen offset:0 sc1
 buffer_load_dwordx4 v[16:19], v3, s[20:23], s41 offen offset:1024 sc1
 s_waitcnt vmcnt(2)
 v_max3_u32 v55, v12, v13, v14
 v_max3_u32 v55, v55, v15, v16
 v_max3_u32 v55, v55, v17, v18
 v_max_u32 v55, v55, v19
 ds_write_b128 v54, v[12:15] offset:0
 ds_write_b128 v54, v[16:19] offset:1024
 v_cmpx_eq_u32 vcc, -1, v55
 s_cbranch_execz Lstep_52
 s_sub_u32 s54, s54, 1
 s_cbranch_scc0 Lp2_61
 s_endpgm
LwH_54:
 v_bfe_u32 v53, v3, 8, 1
 v_bfe_u32 v58, v3, 9, 1
 v_lshl_or_b32 v53, v53, 1, v58
 v_bfe_u32 v58, v3, 5, 1
 v_lshl_or_b32 v53, v53, 1, v58
 v_and_b32 v58, 0xd0, v3
 v_lshlrev_b32 v58, 24, v58
 v_lshl_or_b32 v53, v53, 2, v58
 s_waitcnt vmcnt(2)
 buffer_load_dwordx4 v[20:23], v3, s[20:23], s40 offen offset:0 sc1
 buffer_load_dwordx4 v[24:27], v3, s[20:23], s40 offen offset:1024 sc1
 buffer_load_dwordx4 v[36:39], v3, s[20:23], s39 offen offset:0 sc1
 buffer_load_dwordx4 v[40:43], v3, s[20:23], s39 offen offset:1024 sc1
 v_mov_b32 v47, 0x3f80
 v_cndmask_b32 v47, v47, 1.0, s[32:33]
 v_cndmask_b32 v44, 0, v47, s[24:25]
 v_cndmask_b32 v45, 0, v47, s[26:27]
 v_cndmask_b32 v46, 0, v47, s[28:29]
 v_cndmask_b32 v47, 0, v47, s[30:31]
 v_bfe_u32 v52, v3, 8, 2
 v_bfe_u32 v58, v3, 2, 4
 v_lshl_or_b32 v52, v52, 4, v58
 v_and_b32 v58, 0xc0, v3
 v_lshl_or_b32 v52, v58, 24, v52
 v_subrev_u32 v0, 0x20000, v0
 v_mov_b32 v59, -1
 v_add_u32 v54, s42, v3
 v_add_u32 v58, s69, v9
 ds_read_b64_tr_b16 v[64:65], v58 offset:19456
 v_mov_b32 v66, v2
 v_mov_b32 v67, v4
 s_waitcnt vmcnt(2)
 v_mfma_f32_16x16x32_bf16 v[28:31], v[44:47], v[20:23], 0
 v_mfma_f32_16x16x32_bf16 v[28:31], v[44:47], v[24:27], v[28:31]
 s_waitcnt vmcnt(1)
 v_mfma_f32_16x16x32_bf16 v[48:51], v[44:47], v[36:39], 0
 s_waitcnt vmcnt(0)
 v_mfma_f32_16x16x32_bf16 v[48:51], v[44:47], v[40:43], v[48:51]
 v_bitop3_b32 v55, v37, v39, s46 bitop3:0x7e
 v_bitop3_b32 v56, v41, v43, s46 bitop3:0x7e
 v_bitop3_b32 v57, v21, v23, s46 bitop3:0x7e
 v_or3_b32 v55, v55, v56, v57
 v_bitop3_b32 v56, v25, v27, s46 bitop3:0x7e
 v_bitop3_b32 v55, v55, 1, v56 bitop3:0xc8
 v_cmp_ne_u32 vcc, 0, v55
 v_add_f32_dpp v29, v29, v29 row_ror:4 row_mask:0xf bank_mask:0xf
 v_add_f32_dpp v48, v48, v48 row_ror:4 row_mask:0xf bank_mask:0xf
 v_add_f32_dpp v49, v49, v49 row_ror:4 row_mask:0xf bank_mask:0xf
 v_add_f32_dpp v29, v29, v29 row_ror:8 row_mask:0xf bank_mask:0xf
 v_add_f32_dpp v48, v48, v48 row_ror:8 row_mask:0xf bank_mask:0xf
 v_add_f32_dpp v49, v49, v49 row_ror:8 row_mask:0xf bank_mask:0xf
 s_cbranch_vccnz Lr1_62
 v_cvt_pk_bf16_f32 v48, v48, v49
 buffer_store_dword v48, v52, s[20:23], s44 offen
 v_mov_b32_dpp v30, v29 quad_perm:[1,0,3,2] row_mask:0xf bank_mask:0xf
 v_cvt_pk_bf16_f32 v29, v29, v30
 buffer_store_dword v29, v53, s[20:23], s65 offen
Lb1_63:
 buffer_store_dword v59, v52, s[20:23], s45 offen
 buffer_store_dword v59, v53, s[20:23], s66 offen
 v_cmp_gt_u32 vcc, s58, v1
 ds_read_b128 v[20:23], v0 offset:24576
 ds_read_b128 v[24:27], v0 offset:28672
 ds_read_b128 v[28:31], v0 offset:32768
 ds_read_b128 v[32:35], v0 offset:36864
 v_mov_b64 v[36:37], 0
 v_mov_b64 v[38:39], 0
 v_mov_b64 v[40:41], 0
 v_mov_b64 v[42:43], 0
 v_mov_b64 v[44:45], 0
 v_mov_b64 v[46:47], 0
 v_mov_b64 v[48:49], 0
 v_mov_b64 v[50:51], 0
 s_cmp_lg_u32 vcc_hi, 0
 s_cbranch_scc1 Lfw_65
Lfok_64:
 v_lshl_add_u32 v1, v3, 3, s68
 v_mov_b32 v6, s56
 v_cndmask_b32 v1, v6, v1, s[70:71]
 s_nop 13
 buffer_load_dwordx4 v[12:15], v3, s[20:23], s41 offen offset:0 sc1
 buffer_load_dwordx4 v[16:19], v3, s[20:23], s41 offen offset:1024 sc1
 buffer_load_dwordx4 v[68:71], v3, s[20:23], s43 offen offset:0 sc1
 s_nop 15
 s_nop 7
Lp2_66:
 buffer_load_dwordx4 v[12:15], v3, s[20:23], s41 offen offset:0 sc1
 buffer_load_dwordx4 v[16:19], v3, s[20:23], s41 offen offset:1024 sc1
 buffer_load_dwordx4 v[68:71], v3, s[20:23], s43 offen offset:0 sc1
 s_waitcnt vmcnt(3)
 v_max3_u32 v55, v12, v13, v14
 v_max3_u32 v55, v55, v15, v16
 v_max3_u32 v55, v55, v17, v18
 v_max3_u32 v55, v55, v19, v68
 v_max3_u32 v55, v55, v69, v70
 v_max_u32 v55, v55, v71
 ds_write_b128 v54, v[12:15] offset:0
 ds_write_b128 v54, v[16:19] offset:1024
 ds_write_b128 v54, v[68:71] offset:8192
 v_cmpx_eq_u32 vcc, -1, v55
 s_cbranch_execz Lstep_52
 buffer_load_dwordx4 v[12:15], v3, s[20:23], s41 offen offset:0 sc1
 buffer_load_dwordx4 v[16:19], v3, s[20:23], s41 offen offset:1024 sc1
 buffer_load_dwordx4 v[68:71], v3, s[20:23], s43 offen offset:0 sc1
 s_waitcnt vmcnt(3)
 v_max3_u32 v55, v12, v13, v14
 v_max3_u32 v55, v55, v15, v16
 v_max3_u32 v55, v55, v17, v18
 v_max3_u32 v55, v55, v19, v68
 v_max3_u32 v55, v55, v69, v70
 v_max_u32 v55, v55, v71
 ds_write_b128 v54, v[12:15] offset:0
 ds_write_b128 v54, v[16:19] offset:1024
 ds_write_b128 v54, v[68:71] offset:8192
 v_cmpx_eq_u32 vcc, -1, v55
 s_cbranch_execz Lstep_52
 buffer_load_dwordx4 v[12:15], v3, s[20:23], s41 offen offset:0 sc1
 buffer_load_dwordx4 v[16:19], v3, s[20:23], s41 offen offset:1024 sc1
 buffer_load_dwordx4 v[68:71], v3, s[20:23], s43 offen offset:0 sc1
 s_waitcnt vmcnt(3)
 v_max3_u32 v55, v12, v13, v14
 v_max3_u32 v55, v55, v15, v16
 v_max3_u32 v55, v55, v17, v18
 v_max3_u32 v55, v55, v19, v68
 v_max3_u32 v55, v55, v69, v70
 v_max_u32 v55, v55, v71
 ds_write_b128 v54, v[12:15] offset:0
 ds_write_b128 v54, v[16:19] offset:1024
 ds_write_b128 v54, v[68:71] offset:8192
 v_cmpx_eq_u32 vcc, -1, v55
 s_cbranch_execz Lstep_52
 s_sub_u32 s54, s54, 1
 s_cbranch_scc0 Lp2_66
 s_endpgm
Lr1_62:
 s_mov_b64 exec, vcc
Lrt_67:
 buffer_load_dwordx4 v[20:23], v3, s[20:23], s40 offen offset:0 sc1
 buffer_load_dwordx4 v[24:27], v3, s[20:23], s40 offen offset:1024 sc1
 buffer_load_dwordx4 v[36:39], v3, s[20:23], s39 offen offset:0 sc1
 buffer_load_dwordx4 v[40:43], v3, s[20:23], s39 offen offset:1024 sc1
 s_waitcnt vmcnt(4)
 v_bitop3_b32 v55, v37, v39, s46 bitop3:0x7e
 v_bitop3_b32 v56, v41, v43, s46 bitop3:0x7e
 v_bitop3_b32 v57, v21, v23, s46 bitop3:0x7e
 v_or3_b32 v55, v55, v56, v57
 v_bitop3_b32 v56, v25, v27, s46 bitop3:0x7e
 v_bitop3_b32 v55, v55, 1, v56 bitop3:0xc8
 v_cmpx_ne_u32 vcc, 0, v55
 s_cbranch_execz Lrte_68
 buffer_load_dwordx4 v[20:23], v3, s[20:23], s40 offen offset:0 sc1
 buffer_load_dwordx4 v[24:27], v3, s[20:23], s40 offen offset:1024 sc1
 buffer_load_dwordx4 v[36:39], v3, s[20:23], s39 offen offset:0 sc1
 buffer_load_dwordx4 v[40:43], v3, s[20:23], s39 offen offset:1024 sc1
 s_waitcnt vmcnt(4)
 v_bitop3_b32 v55, v37, v39, s46 bitop3:0x7e
 v_bitop3_b32 v56, v41, v43, s46 bitop3:0x7e
 v_bitop3_b32 v57, v21, v23, s46 bitop3:0x7e
 v_or3_b32 v55, v55, v56, v57
 v_bitop3_b32 v56, v25, v27, s46 bitop3:0x7e
 v_bitop3_b32 v55, v55, 1, v56 bitop3:0xc8
 v_cmpx_ne_u32 vcc, 0, v55
 s_cbranch_execz Lrte_68
 buffer_load_dwordx4 v[20:23], v3, s[20:23], s40 offen offset:0 sc1
 buffer_load_dwordx4 v[24:27], v3, s[20:23], s40 offen offset:1024 sc1
 buffer_load_dwordx4 v[36:39], v3, s[20:23], s39 offen offset:0 sc1
 buffer_load_dwordx4 v[40:43], v3, s[20:23], s39 offen offset:1024 sc1
 s_waitcnt vmcnt(4)
 v_bitop3_b32 v55, v37, v39, s46 bitop3:0x7e
 v_bitop3_b32 v56, v41, v43, s46 bitop3:0x7e
 v_bitop3_b32 v57, v21, v23, s46 bitop3:0x7e
 v_or3_b32 v55, v55, v56, v57
 v_bitop3_b32 v56, v25, v27, s46 bitop3:0x7e
 v_bitop3_b32 v55, v55, 1, v56 bitop3:0xc8
 v_cmpx_ne_u32 vcc, 0, v55
 s_cbranch_execz Lrte_68
 s_sub_u32 s54, s54, 1
 s_cbranch_scc0 Lrt_67
 s_endpgm
Lrte_68:
 s_mov_b64 exec, -1
 s_nop 2
 v_mfma_f32_16x16x32_bf16 v[28:31], v[44:47], v[20:23], 0
 v_mfma_f32_16x16x32_bf16 v[28:31], v[44:47], v[24:27], v[28:31]
 v_mfma_f32_16x16x32_bf16 v[48:51], v[44:47], v[36:39], 0
 v_mfma_f32_16x16x32_bf16 v[48:51], v[44:47], v[40:43], v[48:51]
 s_nop 6
 v_add_f32_dpp v29, v29, v29 row_ror:4 row_mask:0xf bank_mask:0xf
 v_add_f32_dpp v48, v48, v48 row_ror:4 row_mask:0xf bank_mask:0xf
 v_add_f32_dpp v49, v49, v49 row_ror:4 row_mask:0xf bank_mask:0xf
 v_add_f32_dpp v29, v29, v29 row_ror:8 row_mask:0xf bank_mask:0xf
 v_add_f32_dpp v48, v48, v48 row_ror:8 row_mask:0xf bank_mask:0xf
 v_add_f32_dpp v49, v49, v49 row_ror:8 row_mask:0xf bank_mask:0xf
 v_cvt_pk_bf16_f32 v48, v48, v49
 buffer_store_dword v48, v52, s[20:23], s44 offen
 v_mov_b32_dpp v30, v29 quad_perm:[1,0,3,2] row_mask:0xf bank_mask:0xf
 v_cvt_pk_bf16_f32 v29, v29, v30
 buffer_store_dword v29, v53, s[20:23], s65 offen
 s_waitcnt vmcnt(2)
 s_branch Lb1_63
Lr2_57:
 s_waitcnt vmcnt(1)
 v_mfma_f32_16x16x32_bf16 v[48:51], v[44:47], v[12:15], 0
 s_waitcnt vmcnt(0)
 v_mfma_f32_16x16x32_bf16 v[48:51], v[44:47], v[16:19], v[48:51]
 v_bitop3_b32 v55, v13, v15, s46 bitop3:0x7e
 v_bitop3_b32 v56, v17, v19, s46 bitop3:0x7e
 v_bitop3_b32 v55, v55, 1, v56 bitop3:0xc8
 v_cmp_ne_u32 vcc, 0, v55
 s_nop 3
 v_add_f32_dpp v48, v48, v48 row_ror:4 row_mask:0xf bank_mask:0xf
 v_add_f32_dpp v49, v49, v49 row_ror:4 row_mask:0xf bank_mask:0xf
 s_cbranch_vccnz Lr1_56
 v_add_f32_dpp v48, v48, v48 row_ror:8 row_mask:0xf bank_mask:0xf
 v_add_f32_dpp v49, v49, v49 row_ror:8 row_mask:0xf bank_mask:0xf
 v_cvt_pk_bf16_f32 v48, v48, v49
 buffer_store_dword v48, v52, s[20:23], s44 offen
 s_branch Lb1_58
Lr1_56:
 s_mov_b64 exec, vcc
Lrt_69:
 buffer_load_dwordx4 v[12:15], v3, s[20:23], s39 offen offset:0 sc1
 buffer_load_dwordx4 v[16:19], v3, s[20:23], s39 offen offset:1024 sc1
 s_waitcnt vmcnt(2)
 v_bitop3_b32 v55, v13, v15, s46 bitop3:0x7e
 v_bitop3_b32 v56, v17, v19, s46 bitop3:0x7e
 v_bitop3_b32 v55, v55, 1, v56 bitop3:0xc8
 v_cmpx_ne_u32 vcc, 0, v55
 s_cbranch_execz Lrte_70
 buffer_load_dwordx4 v[12:15], v3, s[20:23], s39 offen offset:0 sc1
 buffer_load_dwordx4 v[16:19], v3, s[20:23], s39 offen offset:1024 sc1
 s_waitcnt vmcnt(2)
 v_bitop3_b32 v55, v13, v15, s46 bitop3:0x7e
 v_bitop3_b32 v56, v17, v19, s46 bitop3:0x7e
 v_bitop3_b32 v55, v55, 1, v56 bitop3:0xc8
 v_cmpx_ne_u32 vcc, 0, v55
 s_cbranch_execz Lrte_70
 buffer_load_dwordx4 v[12:15], v3, s[20:23], s39 offen offset:0 sc1
 buffer_load_dwordx4 v[16:19], v3, s[20:23], s39 offen offset:1024 sc1
 s_waitcnt vmcnt(2)
 v_bitop3_b32 v55, v13, v15, s46 bitop3:0x7e
 v_bitop3_b32 v56, v17, v19, s46 bitop3:0x7e
 v_bitop3_b32 v55, v55, 1, v56 bitop3:0xc8
 v_cmpx_ne_u32 vcc, 0, v55
 s_cbranch_execz Lrte_70
 s_sub_u32 s54, s54, 1
 s_cbranch_scc0 Lrt_69
 s_endpgm
Lrte_70:
 s_mov_b64 exec, -1
 s_nop 2
 v_mfma_f32_16x16x32_bf16 v[48:51], v[44:47], v[12:15], 0
 v_mfma_f32_16x16x32_bf16 v[48:51], v[44:47], v[16:19], v[48:51]
 s_nop 7
 v_add_f32_dpp v48, v48, v48 row_ror:4 row_mask:0xf bank_mask:0xf
 v_add_f32_dpp v49, v49, v49 row_ror:4 row_mask:0xf bank_mask:0xf
 s_nop 0
 v_add_f32_dpp v48, v48, v48 row_ror:8 row_mask:0xf bank_mask:0xf
 v_add_f32_dpp v49, v49, v49 row_ror:8 row_mask:0xf bank_mask:0xf
 v_cvt_pk_bf16_f32 v48, v48, v49
 buffer_store_dword v48, v52, s[20:23], s44 offen
 s_branch Lb1_58
Lfw_60:
Lpb_71:
 buffer_load_dword v1, v7, s[20:23], s56 offen sc1
 s_waitcnt vmcnt(0)
 v_cmp_le_u32 vcc, s58, v1
 s_cbranch_vccnz Lpbok_72
 s_sub_u32 s54, s54, 1
 s_cbranch_scc0 Lpb_71
 s_endpgm
Lpbok_72:
 s_branch Lfok_59
Lfw_65:
Lpb_73:
 buffer_load_dword v1, v7, s[20:23], s56 offen sc1
 s_waitcnt vmcnt(0)
 v_cmp_le_u32 vcc, s58, v1
 s_cbranch_vccnz Lpbok_74
 s_sub_u32 s54, s54, 1
 s_cbranch_scc0 Lpb_73
 s_endpgm
Lpbok_74:
 s_branch Lfok_64
Lfail_53:
 s_endpgm
Lslow_50:
 .p2align 3
Lstep_75:
 s_mov_b64 exec, -1
 s_waitcnt lgkmcnt(0)
 s_barrier
 ds_read_b128 v[52:55], v3 offset:0
 ds_read_b128 v[56:59], v3 offset:1024
 ds_read_b128 v[60:63], v3 offset:2048
 buffer_load_dwordx4 v[12:15], v3, s[20:23], s59 offen offset:0 sc1
 s_waitcnt lgkmcnt(2)
 v_smfmac_f32_16x16x64_bf16 v[36:39], v[52:55], v[72:79], v5
 v_smfmac_f32_16x16x64_bf16 v[40:43], v[52:55], v[80:87], v5
 buffer_load_dwordx4 v[16:19], v3, s[20:23], s59 offen offset:1024 sc1
 v_smfmac_f32_16x16x64_bf16 v[44:47], v[52:55], v[88:95], v5
 s_waitcnt lgkmcnt(1)
 v_smfmac_f32_16x16x64_bf16 v[48:51], v[52:55], v[20:27], v5
 v_smfmac_f32_16x16x64_bf16 v[36:39], v[56:59], v[112:119], v5
 ds_read_b128 v[20:23], v0 offset:40960
 v_smfmac_f32_16x16x64_bf16 v[40:43], v[56:59], v[120:127], v5
 ds_read_b128 v[24:27], v0 offset:45056
 v_smfmac_f32_16x16x64_bf16 v[44:47], v[56:59], v[128:135], v5
 ds_read_b128 v[52:55], v3 offset:3072
 s_waitcnt lgkmcnt(3)
 v_smfmac_f32_16x16x64_bf16 v[48:51], v[56:59], v[28:35], v5
 buffer_load_dword v1, v1, s[20:23], 0 offen sc1
 v_smfmac_f32_16x16x64_bf16 v[36:39], v[60:63], v[152:159], v5
 ds_read_b128 v[28:31], v0 offset:49152
 s_max_u32 s47, s36, 1
 v_smfmac_f32_16x16x64_bf16 v[40:43], v[60:63], v[160:167], v5
 ds_read_b128 v[32:35], v0 offset:53248
 s_sub_u32 s47, s47, 1
 v_smfmac_f32_16x16x64_bf16 v[44:47], v[60:63], v[168:175], v5
 ds_read_b128 v[56:59], v3 offset:4096
 s_waitcnt lgkmcnt(3)
 v_smfmac_f32_16x16x64_bf16 v[48:51], v[60:63], v[20:27], v5
 v_smfmac_f32_16x16x64_bf16 v[36:39], v[52:55], v[192:199], v5
 ds_read_b128 v[20:23], v0 offset:57344
 v_min_u32 v6, 16, v0
 v_smfmac_f32_16x16x64_bf16 v[40:43], v[52:55], v[200:207], v5
 ds_read_b128 v[24:27], v0 offset:61440
 v_lshlrev_b32 v6, 24, v6
 v_smfmac_f32_16x16x64_bf16 v[44:47], v[52:55], v[208:215], v5
 ds_read_b128 v[60:63], v3 offset:5120
 s_waitcnt lgkmcnt(3)
 v_add_u32 v0, 0x10000, v0
 v_smfmac_f32_16x16x64_bf16 v[48:51], v[52:55], v[28:35], v5
 buffer_store_dwordx4 v[64:67], v0, s[20:23], s38 offen sc1
 v_smfmac_f32_16x16x64_bf16 v[36:39], v[56:59], v[232:239], v5
 ds_read_b128 v[28:31], v0 offset:0
 v_smfmac_f32_16x16x64_bf16 v[40:43], v[56:59], v[240:247], v5
 ds_read_b128 v[32:35], v0 offset:4096
 v_smfmac_f32_16x16x64_bf16 v[44:47], v[56:59], v[248:255], v5
 ds_read_b128 v[52:55], v3 offset:6144
 s_waitcnt lgkmcnt(3)
 v_smfmac_f32_16x16x64_bf16 v[48:51], v[56:59], v[20:27], v5
 v_smfmac_f32_16x16x64_bf16 v[36:39], v[60:63], a[16:23], v5
 ds_read_b128 v[20:23], v0 offset:8192
 v_mov_b32 v64, s47
 v_smfmac_f32_16x16x64_bf16 v[40:43], v[60:63], a[24:31], v5
 ds_read_b128 v[24:27], v0 offset:12288
 v_smfmac_f32_16x16x64_bf16 v[44:47], v[60:63], a[32:39], v5
 ds_read_b128 v[56:59], v3 offset:7168
 s_waitcnt lgkmcnt(3)
 v_smfmac_f32_16x16x64_bf16 v[48:51], v[60:63], v[28:35], v5
 buffer_store_dword v64, v6, s[20:23], s57 offen sc1
 v_smfmac_f32_16x16x64_bf16 v[36:39], v[52:55], a[56:63], v5
 ds_read_b128 v[28:31], v0 offset:16384
 v_smfmac_f32_16x16x64_bf16 v[40:43], v[52:55], a[64:71], v5
 ds_read_b128 v[32:35], v0 offset:20480
 v_smfmac_f32_16x16x64_bf16 v[44:47], v[52:55], a[72:79], v5
 ds_read_b128 v[60:63], v3 offset:8192
 s_waitcnt lgkmcnt(3)
 v_smfmac_f32_16x16x64_bf16 v[48:51], v[52:55], v[20:27], v5
 s_waitcnt vmcnt(5)
 v_smfmac_f32_16x16x64_bf16 v[36:39], v[56:59], a[96:103], v5
 ds_read_b128 v[20:23], v0 offset:24576
 v_mov_b64 v[64:65], 0
 v_smfmac_f32_16x16x64_bf16 v[40:43], v[56:59], a[104:111], v5
 ds_read_b128 v[24:27], v0 offset:28672
 v_mov_b64 v[66:67], 0
 v_smfmac_f32_16x16x64_bf16 v[44:47], v[56:59], a[112:119], v5
 ds_read_b128 v[52:55], v3 offset:0
 s_waitcnt lgkmcnt(3)
 v_mov_b64 v[68:69], 0
 v_smfmac_f32_16x16x64_bf16 v[48:51], v[56:59], v[28:35], v5
 v_mov_b64 v[70:71], 0
 v_smfmac_f32_16x16x64_bf16 v[36:39], v[60:63], a[136:143], v5
 ds_read_b128 v[32:35], v3 offset:11264
 v_mov_b64 v[28:29], 0
 v_smfmac_f32_16x16x64_bf16 v[40:43], v[60:63], a[144:151], v5
 v_mov_b64 v[30:31], 0
 v_smfmac_f32_16x16x64_bf16 v[44:47], v[60:63], a[152:159], v5
 ds_read_b128 v[56:59], v3 offset:1024
 s_waitcnt lgkmcnt(2)
 v_add_f32 v36, v36, v38
 v_smfmac_f32_16x16x64_bf16 v[48:51], v[60:63], v[20:27], v5
 ds_read_b128 v[60:63], v3 offset:2048
 ds_read_b128 v[20:23], v3 offset:9216
 v_add_f32 v37, v37, v39
 v_cvt_pk_bf16_f32 v36, v36, v37
 v_smfmac_f32_16x16x64_bf16 v[64:67], v[52:55], v[96:103], v5
 ds_write_b16 v10, v36 offset:17408
 ds_write_b16_d16_hi v10, v36 offset:17472
 v_add_f32 v40, v40, v42
 v_add_f32 v41, v41, v43
 v_cvt_pk_bf16_f32 v40, v40, v41
 v_smfmac_f32_16x16x64_bf16 v[68:71], v[52:55], v[104:111], v5
 ds_write_b16 v10, v40 offset:17412
 ds_write_b16_d16_hi v10, v40 offset:17476
 v_add_f32 v44, v44, v46
 v_add_f32 v45, v45, v47
 v_add_f32 v48, v48, v50
 v_add_f32 v49, v49, v51
 v_cvt_pk_bf16_f32 v44, v44, v45
 v_cvt_pk_bf16_f32 v45, v48, v49
 ds_write_b64 v8, v[44:45] offset:19456
 s_waitcnt lgkmcnt(7)
 v_smfmac_f32_16x16x64_bf16 v[64:67], v[56:59], v[136:143], v5
 ds_read_b128 v[52:55], v3 offset:3072
 ds_read_b128 v[24:27], v3 offset:10240
 v_smfmac_f32_16x16x64_bf16 v[68:71], v[56:59], v[144:151], v5
 ds_read_b128 v[56:59], v3 offset:4096
 s_waitcnt lgkmcnt(9)
 v_smfmac_f32_16x16x64_bf16 v[64:67], v[60:63], v[176:183], v5
 v_smfmac_f32_16x16x64_bf16 v[68:71], v[60:63], v[184:191], v5
 s_waitcnt lgkmcnt(3)
 s_barrier
 ds_read_b128 v[36:39], v11 offset:17408
 ds_read_b128 v[40:43], v11 offset:17920
 s_waitcnt lgkmcnt(4)
 v_smfmac_f32_16x16x64_bf16 v[64:67], v[52:55], v[216:223], v5
 ds_read_b64_tr_b16 v[60:61], v9 offset:19456
 ds_read_b64_tr_b16 v[62:63], v9 offset:19488
 v_smfmac_f32_16x16x64_bf16 v[68:71], v[52:55], v[224:231], v5
 ds_read_b128 v[52:55], v3 offset:5120
 ds_read_b128 v[44:47], v11 offset:18432
 s_waitcnt lgkmcnt(6)
 v_smfmac_f32_16x16x64_bf16 v[64:67], v[56:59], a[0:7], v5
 ds_read_b128 v[48:51], v11 offset:18944
 v_smfmac_f32_16x16x64_bf16 v[68:71], v[56:59], a[8:15], v5
 ds_read_b128 v[56:59], v3 offset:6144
 s_waitcnt lgkmcnt(7)
 v_mfma_f32_16x16x32_bf16 v[20:23], v[20:23], v[36:39], 0
 v_mfma_f32_16x16x32_bf16 v[24:27], v[24:27], v[36:39], 0
 s_waitcnt lgkmcnt(6)
 v_mfma_f32_16x16x32_bf16 v[20:23], v[32:35], v[40:43], v[20:23]
 ds_read_b128 v[32:35], v3 offset:12288
 s_waitcnt lgkmcnt(5)
 v_smfmac_f32_16x16x64_bf16 v[28:31], v[60:63], v[36:43], v5
 ds_read_b64_tr_b16 v[60:61], v9 offset:20544
 ds_read_b64_tr_b16 v[62:63], v9 offset:20576
 ds_read_b128 v[36:39], v3 offset:13312
 s_waitcnt lgkmcnt(7)
 v_smfmac_f32_16x16x64_bf16 v[64:67], v[52:55], a[40:47], v5
 v_smfmac_f32_16x16x64_bf16 v[68:71], v[52:55], a[48:55], v5
 ds_read_b128 v[52:55], v3 offset:7168
 s_waitcnt lgkmcnt(4)
 v_mfma_f32_16x16x32_bf16 v[24:27], v[32:35], v[40:43], v[24:27]
 ds_read_b128 v[40:43], v3 offset:14336
 ds_read_b128 v[32:35], v3 offset:15360
 s_waitcnt lgkmcnt(4)
 v_smfmac_f32_16x16x64_bf16 v[28:31], v[60:63], v[44:51], v5
 ds_read_b128 v[60:63], v3 offset:16384
 s_waitcnt lgkmcnt(4)
 v_mfma_f32_16x16x32_bf16 v[20:23], v[36:39], v[44:47], v[20:23]
 v_smfmac_f32_16x16x64_bf16 v[64:67], v[56:59], a[80:87], v5
 v_smfmac_f32_16x16x64_bf16 v[68:71], v[56:59], a[88:95], v5
 ds_read_b128 v[56:59], v3 offset:8192
 v_add_f32 v28, v28, v30
 s_waitcnt lgkmcnt(3)
 v_mfma_f32_16x16x32_bf16 v[24:27], v[40:43], v[44:47], v[24:27]
 v_add_f32 v29, v29, v31
 v_max_f32 v30, v28, v29
 s_waitcnt lgkmcnt(2)
 v_mfma_f32_16x16x32_bf16 v[20:23], v[32:35], v[48:51], v[20:23]
 v_cndmask_b32 v28, v28, v29, s[48:49]
 s_waitcnt lgkmcnt(1)
 v_mfma_f32_16x16x32_bf16 v[24:27], v[60:63], v[48:51], v[24:27]
 v_mov_b64 v[32:33], s[34:35]
 v_mov_b64 v[34:35], s[34:35]
 v_smfmac_f32_16x16x64_bf16 v[64:67], v[52:55], a[120:127], v5
 ds_read_b128 v[36:39], v0 offset:32768
 ds_read_b128 v[40:43], v0 offset:36864
 v_max3_f32 v30, v30, v20, v21
 v_smfmac_f32_16x16x64_bf16 v[68:71], v[52:55], a[128:135], v5
 ds_read_b128 v[44:47], v0 offset:40960
 ds_read_b128 v[48:51], v0 offset:45056
 v_max3_f32 v30, v30, v22, v23
 v_max3_f32 v30, v30, v24, v25
 v_max3_f32 v31, v30, v26, v27
 v_max3_f32 v29, v30, v26, v27
 s_waitcnt lgkmcnt(4)
 v_smfmac_f32_16x16x64_bf16 v[64:67], v[56:59], a[160:167], v5
 v_cndmask_b32 v20, v20, v24, s[48:49]
 v_smfmac_f32_16x16x64_bf16 v[68:71], v[56:59], a[168:175], v5
 v_cndmask_b32 v21, v21, v25, s[48:49]
 v_permlane16_swap_b32 v31, v29
 v_max_f32 v30, v31, v29
 v_max_f32 v6, v31, v29
 v_cndmask_b32 v22, v22, v26, s[48:49]
 v_cndmask_b32 v23, v23, v27, s[48:49]
 v_permlane32_swap_b32 v30, v6
 v_max_f32 v30, v30, v6
 v_mul_f32 v30, -s55, v30
 v_fma_f32 v28, v28, s55, v30
 v_fma_f32 v20, v20, s55, v30
 v_fma_f32 v21, v21, s55, v30
 v_fma_f32 v22, v22, s55, v30
 v_fma_f32 v23, v23, s55, v30
 v_exp_f32 v28, v28
 v_add_f32 v64, v64, v66
 v_add_f32 v65, v65, v67
 v_cndmask_b32 v29, 0, v28, s[48:49]
 v_cndmask_b32 v28, v28, 0, s[48:49]
 v_cvt_pk_bf16_f32 v6, v28, v29
 v_add_f32 v68, v68, v70
 v_add_f32 v69, v69, v71
 v_mfma_f32_16x16x16_bf16 v[60:63], v[6:7], v[32:33], 0
 v_cvt_pk_bf16_f32 v2, v64, v65
 v_cvt_pk_bf16_f32 v4, v68, v69
 v_exp_f32 v20, v20
 v_exp_f32 v21, v21
 v_mfma_f32_16x16x16_bf16 v[52:55], v[6:7], v[2:3], 0
 s_waitcnt vmcnt(3)
 v_exp_f32 v22, v22
 v_mfma_f32_16x16x16_bf16 v[56:59], v[6:7], v[4:5], 0
 s_cmp_eq_u32 s36, 63
 v_exp_f32 v23, v23
 v_cvt_pk_bf16_f32 v30, v20, v21
 v_cvt_pk_bf16_f32 v31, v22, v23
 v_mov_b64 v[64:65], 0
 v_mov_b64 v[66:67], 0
 v_smfmac_f32_16x16x32_bf16 v[60:63], v[30:31], v[32:35], v5
 v_mov_b64 v[68:69], 0
 v_mov_b64 v[70:71], 0
 v_smfmac_f32_16x16x32_bf16 v[52:55], v[30:31], v[12:15], v5
 v_mov_b64 v[20:21], 0
 v_mov_b64 v[22:23], 0
 v_smfmac_f32_16x16x32_bf16 v[56:59], v[30:31], v[16:19], v5
 s_nop 0
 v_add_f32 v60, v60, v62
 v_add_f32 v61, v61, v63
 v_rcp_f32 v60, v60
 v_rcp_f32 v61, v61
 v_add_f32 v52, v52, v54
 v_add_f32 v53, v53, v55
 v_mul_f32 v52, v52, v60
 v_mul_f32 v53, v53, v61
 v_add_f32 v56, v56, v58
 v_add_f32 v57, v57, v59
 v_mul_f32 v56, v56, v60
 v_mul_f32 v57, v57, v61
 v_cvt_pk_bf16_f32 v52, v52, v53
 v_cvt_pk_bf16_f32 v53, v56, v57
 ds_write_b64 v8, v[52:53] offset:21632
 s_cbranch_scc1 Lchexit_51
 v_bfe_u32 v6, v0, 7, 5
 v_mul_u32_u24 v6, 10496, v6
 v_bfe_u32 v60, v3, 4, 3
 v_lshl_add_u32 v6, v60, 3, v6
 s_xor_b32 s46, s46, 0x1
 v_mov_b64 v[24:25], 0
 s_add_u32 s67, s67, 0x80000
 v_mov_b64 v[26:27], 0
 s_add_u32 s59, s59, 0x80000
 v_mov_b64 v[28:29], 0
 s_add_u32 s38, s38, 0x20000
 v_mov_b64 v[30:31], 0
 s_waitcnt lgkmcnt(0)
 s_barrier
 ds_read_b64_tr_b16 v[52:53], v9 offset:21632
 ds_read_b64_tr_b16 v[54:55], v9 offset:21664
 v_mov_b64 v[32:33], 0
 ds_read_b64_tr_b16 v[56:57], v9 offset:22720
 ds_read_b64_tr_b16 v[58:59], v9 offset:22752
 v_mov_b64 v[34:35], 0
 s_cmp_lt_u32 s36, 61
 v_mov_b64 v[12:13], 0
 s_cselect_b32 s47, 0x80000, 0
 v_mov_b64 v[14:15], 0
 s_add_u32 s68, s68, s47
 v_mov_b64 v[16:17], 0
 s_add_u32 s36, s36, 1
 v_mov_b64 v[18:19], 0
 s_waitcnt lgkmcnt(2)
 v_smfmac_f32_16x16x64_bf16 v[64:67], v[52:55], a[248:255], v5
 s_add_u32 s58, s36, 2
 s_min_u32 s58, s58, 64
 v_mov_b64 v[60:61], 0
 v_smfmac_f32_16x16x64_bf16 v[68:71], v[52:55], a[176:183], v5
 buffer_load_dwordx4 v3, s[20:23], s67 offen offset:0 sc1 lds
 v_mov_b64 v[62:63], 0
 s_waitcnt lgkmcnt(0)
 v_smfmac_f32_16x16x64_bf16 v[64:67], v[56:59], v[36:43], v5
 ds_read_b128 v[36:39], v0 offset:49152
 ds_read_b128 v[40:43], v0 offset:53248
 v_smfmac_f32_16x16x64_bf16 v[20:23], v[52:55], a[184:191], v5
 buffer_load_dwordx4 v3, s[20:23], s67 offen offset:1024 sc1 lds
 v_smfmac_f32_16x16x64_bf16 v[68:71], v[56:59], v[44:51], v5
 ds_read_b128 v[44:47], v0 offset:57344
 ds_read_b128 v[48:51], v0 offset:61440
 v_add_f32 v64, v64, v66
 v_add_f32 v65, v65, v67
 v_smfmac_f32_16x16x64_bf16 v[24:27], v[52:55], a[192:199], v5
 s_xor_b32 s44, s44, 0x80000
 s_xor_b32 s45, s45, 0x80000
 v_cvt_pk_bf16_f32 v65, v65, v65
 v_cvt_pk_bf16_f32 v64, v64, v64
 s_waitcnt lgkmcnt(2)
 v_add_u32 v0, 0x10000, v0
 v_smfmac_f32_16x16x64_bf16 v[20:23], v[56:59], v[36:43], v5
 ds_read_b128 v[36:39], v0 offset:0
 ds_read_b128 v[40:43], v0 offset:4096
 v_and_or_b32 v65, v65, -2, s46
 v_smfmac_f32_16x16x64_bf16 v[28:31], v[52:55], a[200:207], v5
 buffer_store_dwordx2 v[64:65], v6, s[20:23], s62 offen sc1
 v_add_f32 v68, v68, v70
 v_add_f32 v69, v69, v71
 s_waitcnt lgkmcnt(2)
 v_smfmac_f32_16x16x64_bf16 v[24:27], v[56:59], v[44:51], v5
 ds_read_b128 v[44:47], v0 offset:8192
 ds_read_b128 v[48:51], v0 offset:12288
 v_add_f32 v20, v20, v22
 v_add_f32 v21, v21, v23
 v_smfmac_f32_16x16x64_bf16 v[32:35], v[52:55], a[208:215], v5
 s_xor_b32 s65, s65, 0x80000
 s_xor_b32 s66, s66, 0x80000
 v_cvt_pk_bf16_f32 v69, v69, v21
 v_cvt_pk_bf16_f32 v68, v68, v20
 s_waitcnt lgkmcnt(2)
 v_smfmac_f32_16x16x64_bf16 v[28:31], v[56:59], v[36:43], v5
 ds_read_b128 v[36:39], v0 offset:16384
 ds_read_b128 v[40:43], v0 offset:20480
 v_and_or_b32 v69, v69, -2, s46
 v_smfmac_f32_16x16x64_bf16 v[12:15], v[52:55], a[216:223], v5
 buffer_store_dwordx2 v[68:69], v6, s[20:23], s60 offen offset:0 sc1
 v_add_f32 v24, v24, v26
 v_add_f32 v25, v25, v27
 s_waitcnt lgkmcnt(2)
 v_smfmac_f32_16x16x64_bf16 v[32:35], v[56:59], v[44:51], v5
 ds_read_b128 v[44:47], v0 offset:24576
 ds_read_b128 v[48:51], v0 offset:28672
 v_add_f32 v28, v28, v30
 v_add_f32 v29, v29, v31
 v_smfmac_f32_16x16x64_bf16 v[16:19], v[52:55], a[224:231], v5
 s_xor_b32 s41, s41, 0x80000
 s_xor_b32 s43, s43, 0x80000
 v_cvt_pk_bf16_f32 v25, v25, v29
 v_cvt_pk_bf16_f32 v24, v24, v28
 s_waitcnt lgkmcnt(2)
 v_smfmac_f32_16x16x64_bf16 v[12:15], v[56:59], v[36:43], v5
 v_and_or_b32 v25, v25, -2, s46
 v_smfmac_f32_16x16x64_bf16 v[60:63], v[52:55], a[232:239], v5
 buffer_store_dwordx2 v[24:25], v6, s[20:23], s60 offen offset:2048 sc1
 v_add_f32 v32, v32, v34
 v_add_f32 v33, v33, v35
 s_waitcnt lgkmcnt(0)
 v_smfmac_f32_16x16x64_bf16 v[16:19], v[56:59], v[44:51], v5
 s_nop 0
 v_add_f32 v12, v12, v14
 v_add_f32 v13, v13, v15
 v_smfmac_f32_16x16x64_bf16 v[60:63], v[56:59], a[240:247], v5
 v_cvt_pk_bf16_f32 v33, v33, v13
 v_cvt_pk_bf16_f32 v32, v32, v12
 v_and_or_b32 v33, v33, -2, s46
 buffer_store_dwordx2 v[32:33], v6, s[20:23], s61 offen offset:0 sc1
 v_add_f32 v16, v16, v18
 v_add_f32 v17, v17, v19
 s_cmp_eq_u32 s4, 0
 s_nop 0
 v_add_f32 v60, v60, v62
 v_add_f32 v61, v61, v63
 v_cvt_pk_bf16_f32 v17, v17, v61
 v_cvt_pk_bf16_f32 v16, v16, v60
 v_and_or_b32 v17, v17, -2, s46
 buffer_store_dwordx2 v[16:17], v6, s[20:23], s61 offen offset:2048 sc1
 s_cbranch_scc1 LwH_77
 v_mov_b32 v47, 0x3f80
 v_cndmask_b32 v47, v47, 1.0, s[32:33]
 v_cndmask_b32 v44, 0, v47, s[24:25]
 v_cndmask_b32 v45, 0, v47, s[26:27]
 v_cndmask_b32 v46, 0, v47, s[28:29]
 v_cndmask_b32 v47, 0, v47, s[30:31]
 v_bfe_u32 v52, v3, 8, 2
 v_bfe_u32 v58, v3, 2, 4
 v_lshl_or_b32 v52, v52, 4, v58
 v_and_b32 v58, 0xc0, v3
 v_lshl_or_b32 v52, v58, 24, v52
 v_subrev_u32 v0, 0x20000, v0
 v_mov_b32 v59, -1
 v_add_u32 v54, s42, v3
 v_add_u32 v58, s69, v9
 ds_read_b64_tr_b16 v[64:65], v58 offset:19456
 v_mov_b32 v66, v2
 v_mov_b32 v67, v4
 ds_read_b128 v[20:23], v0 offset:24576
 ds_read_b128 v[24:27], v0 offset:28672
 ds_read_b128 v[28:31], v0 offset:32768
 ds_read_b128 v[32:35], v0 offset:36864
 s_cmp_eq_u32 s4, 1
 s_waitcnt vmcnt(2)
 s_cbranch_scc1 Lq1_78
 s_cmp_eq_u32 s4, 2
 s_waitcnt vmcnt(1)
 s_cbranch_scc1 Lq1_78
 s_waitcnt vmcnt(0)
Lq1_78:
 buffer_load_dwordx4 v[36:39], v3, s[20:23], s39 offen offset:0 sc1
 buffer_load_dwordx4 v[40:43], v3, s[20:23], s39 offen offset:1024 sc1
 s_nop 15
 s_nop 11
 buffer_load_dwordx4 v[12:15], v3, s[20:23], s39 offen offset:0 sc1
 buffer_load_dwordx4 v[16:19], v3, s[20:23], s39 offen offset:1024 sc1
 s_waitcnt vmcnt(3)
 v_mfma_f32_16x16x32_bf16 v[48:51], v[44:47], v[36:39], 0
 s_waitcnt vmcnt(2)
 v_mfma_f32_16x16x32_bf16 v[48:51], v[44:47], v[40:43], v[48:51]
 v_bitop3_b32 v55, v37, v39, s46 bitop3:0x7e
 v_bitop3_b32 v56, v41, v43, s46 bitop3:0x7e
 v_bitop3_b32 v55, v55, 1, v56 bitop3:0xc8
 v_cmp_ne_u32 vcc, 0, v55
 s_nop 3
 v_add_f32_dpp v48, v48, v48 row_ror:4 row_mask:0xf bank_mask:0xf
 v_add_f32_dpp v49, v49, v49 row_ror:4 row_mask:0xf bank_mask:0xf
 s_cbranch_vccnz Lr2_80
 v_add_f32_dpp v48, v48, v48 row_ror:8 row_mask:0xf bank_mask:0xf
 v_add_f32_dpp v49, v49, v49 row_ror:8 row_mask:0xf bank_mask:0xf
 v_cvt_pk_bf16_f32 v48, v48, v49
 buffer_store_dword v48, v52, s[20:23], s44 offen sc1
Lb1_81:
 buffer_store_dword v59, v52, s[20:23], s45 offen sc1
 v_cmp_gt_u32 vcc, s58, v1
 v_mov_b64 v[36:37], 0
 v_mov_b64 v[38:39], 0
 v_mov_b64 v[40:41], 0
 v_mov_b64 v[42:43], 0
 v_mov_b64 v[44:45], 0
 v_mov_b64 v[46:47], 0
 v_mov_b64 v[48:49], 0
 v_mov_b64 v[50:51], 0
 s_cmp_lg_u32 vcc_hi, 0
 s_cbranch_scc1 Lfw_83
Lfok_82:
 v_lshl_add_u32 v1, v3, 3, s68
 v_mov_b32 v6, s56
 v_cndmask_b32 v1, v6, v1, s[70:71]
 s_nop 15
 s_nop 3
 buffer_load_dwordx4 v[12:15], v3, s[20:23], s41 offen offset:0 sc1
 buffer_load_dwordx4 v[16:19], v3, s[20:23], s41 offen offset:1024 sc1
 s_nop 15
 s_nop 7
Lp2_84:
 buffer_load_dwordx4 v[12:15], v3, s[20:23], s41 offen offset:0 sc1
 buffer_load_dwordx4 v[16:19], v3, s[20:23], s41 offen offset:1024 sc1
 s_waitcnt vmcnt(2)
 v_max3_u32 v55, v12, v13, v14
 v_max3_u32 v55, v55, v15, v16
 v_max3_u32 v55, v55, v17, v18
 v_max_u32 v55, v55, v19
 ds_write_b128 v54, v[12:15] offset:0
 ds_write_b128 v54, v[16:19] offset:1024
 v_cmpx_eq_u32 vcc, -1, v55
 s_cbranch_execz Lstep_75
 buffer_load_dwordx4 v[12:15], v3, s[20:23], s41 offen offset:0 sc1
 buffer_load_dwordx4 v[16:19], v3, s[20:23], s41 offen offset:1024 sc1
 s_waitcnt vmcnt(2)
 v_max3_u32 v55, v12, v13, v14
 v_max3_u32 v55, v55, v15, v16
 v_max3_u32 v55, v55, v17, v18
 v_max_u32 v55, v55, v19
 ds_write_b128 v54, v[12:15] offset:0
 ds_write_b128 v54, v[16:19] offset:1024
 v_cmpx_eq_u32 vcc, -1, v55
 s_cbranch_execz Lstep_75
 buffer_load_dwordx4 v[12:15], v3, s[20:23], s41 offen offset:0 sc1
 buffer_load_dwordx4 v[16:19], v3, s[20:23], s41 offen offset:1024 sc1
 s_waitcnt vmcnt(2)
 v_max3_u32 v55, v12, v13, v14
 v_max3_u32 v55, v55, v15, v16
 v_max3_u32 v55, v55, v17, v18
 v_max_u32 v55, v55, v19
 ds_write_b128 v54, v[12:15] offset:0
 ds_write_b128 v54, v[16:19] offset:1024
 v_cmpx_eq_u32 vcc, -1, v55
 s_cbranch_execz Lstep_75
 s_sub_u32 s54, s54, 1
 s_cbranch_scc0 Lp2_84
 s_endpgm
LwH_77:
 v_bfe_u32 v53, v3, 8, 1
 v_bfe_u32 v58, v3, 9, 1
 v_lshl_or_b32 v53, v53, 1, v58
 v_bfe_u32 v58, v3, 5, 1
 v_lshl_or_b32 v53, v53, 1, v58
 v_and_b32 v58, 0xd0, v3
 v_lshlrev_b32 v58, 24, v58
 v_lshl_or_b32 v53, v53, 2, v58
 s_waitcnt vmcnt(2)
 buffer_load_dwordx4 v[20:23], v3, s[20:23], s40 offen offset:0 sc1
 buffer_load_dwordx4 v[24:27], v3, s[20:23], s40 offen offset:1024 sc1
 buffer_load_dwordx4 v[36:39], v3, s[20:23], s39 offen offset:0 sc1
 buffer_load_dwordx4 v[40:43], v3, s[20:23], s39 offen offset:1024 sc1
 v_mov_b32 v47, 0x3f80
 v_cndmask_b32 v47, v47, 1.0, s[32:33]
 v_cndmask_b32 v44, 0, v47, s[24:25]
 v_cndmask_b32 v45, 0, v47, s[26:27]
 v_cndmask_b32 v46, 0, v47, s[28:29]
 v_cndmask_b32 v47, 0, v47, s[30:31]
 v_bfe_u32 v52, v3, 8, 2
 v_bfe_u32 v58, v3, 2, 4
 v_lshl_or_b32 v52, v52, 4, v58
 v_and_b32 v58, 0xc0, v3
 v_lshl_or_b32 v52, v58, 24, v52
 v_subrev_u32 v0, 0x20000, v0
 v_mov_b32 v59, -1
 v_add_u32 v54, s42, v3
 v_add_u32 v58, s69, v9
 ds_read_b64_tr_b16 v[64:65], v58 offset:19456
 v_mov_b32 v66, v2
 v_mov_b32 v67, v4
 s_waitcnt vmcnt(2)
 v_mfma_f32_16x16x32_bf16 v[28:31], v[44:47], v[20:23], 0
 v_mfma_f32_16x16x32_bf16 v[28:31], v[44:47], v[24:27], v[28:31]
 s_waitcnt vmcnt(1)
 v_mfma_f32_16x16x32_bf16 v[48:51], v[44:47], v[36:39], 0
 s_waitcnt vmcnt(0)
 v_mfma_f32_16x16x32_bf16 v[48:51], v[44:47], v[40:43], v[48:51]
 v_bitop3_b32 v55, v37, v39, s46 bitop3:0x7e
 v_bitop3_b32 v56, v41, v43, s46 bitop3:0x7e
 v_bitop3_b32 v57, v21, v23, s46 bitop3:0x7e
 v_or3_b32 v55, v55, v56, v57
 v_bitop3_b32 v56, v25, v27, s46 bitop3:0x7e
 v_bitop3_b32 v55, v55, 1, v56 bitop3:0xc8
 v_cmp_ne_u32 vcc, 0, v55
 v_add_f32_dpp v29, v29, v29 row_ror:4 row_mask:0xf bank_mask:0xf
 v_add_f32_dpp v48, v48, v48 row_ror:4 row_mask:0xf bank_mask:0xf
 v_add_f32_dpp v49, v49, v49 row_ror:4 row_mask:0xf bank_mask:0xf
 v_add_f32_dpp v29, v29, v29 row_ror:8 row_mask:0xf bank_mask:0xf
 v_add_f32_dpp v48, v48, v48 row_ror:8 row_mask:0xf bank_mask:0xf
 v_add_f32_dpp v49, v49, v49 row_ror:8 row_mask:0xf bank_mask:0xf
 s_cbranch_vccnz Lr1_85
 v_cvt_pk_bf16_f32 v48, v48, v49
 buffer_store_dword v48, v52, s[20:23], s44 offen sc1
 v_mov_b32_dpp v30, v29 quad_perm:[1,0,3,2] row_mask:0xf bank_mask:0xf
 v_cvt_pk_bf16_f32 v29, v29, v30
 buffer_store_dword v29, v53, s[20:23], s65 offen sc1
Lb1_86:
 buffer_store_dword v59, v52, s[20:23], s45 offen sc1
 buffer_store_dword v59, v53, s[20:23], s66 offen sc1
 v_cmp_gt_u32 vcc, s58, v1
 ds_read_b128 v[20:23], v0 offset:24576
 ds_read_b128 v[24:27], v0 offset:28672
 ds_read_b128 v[28:31], v0 offset:32768
 ds_read_b128 v[32:35], v0 offset:36864
 v_mov_b64 v[36:37], 0
 v_mov_b64 v[38:39], 0
 v_mov_b64 v[40:41], 0
 v_mov_b64 v[42:43], 0
 v_mov_b64 v[44:45], 0
 v_mov_b64 v[46:47], 0
 v_mov_b64 v[48:49], 0
 v_mov_b64 v[50:51], 0
 s_cmp_lg_u32 vcc_hi, 0
 s_cbranch_scc1 Lfw_88
Lfok_87:
 v_lshl_add_u32 v1, v3, 3, s68
 v_mov_b32 v6, s56
 v_cndmask_b32 v1, v6, v1, s[70:71]
 s_nop 13
 buffer_load_dwordx4 v[12:15], v3, s[20:23], s41 offen offset:0 sc1
 buffer_load_dwordx4 v[16:19], v3, s[20:23], s41 offen offset:1024 sc1
 buffer_load_dwordx4 v[68:71], v3, s[20:23], s43 offen offset:0 sc1
 s_nop 15
 s_nop 7
Lp2_89:
 buffer_load_dwordx4 v[12:15], v3, s[20:23], s41 offen offset:0 sc1
 buffer_load_dwordx4 v[16:19], v3, s[20:23], s41 offen offset:1024 sc1
 buffer_load_dwordx4 v[68:71], v3, s[20:23], s43 offen offset:0 sc1
 s_waitcnt vmcnt(3)
 v_max3_u32 v55, v12, v13, v14
 v_max3_u32 v55, v55, v15, v16
 v_max3_u32 v55, v55, v17, v18
 v_max3_u32 v55, v55, v19, v68
 v_max3_u32 v55, v55, v69, v70
 v_max_u32 v55, v55, v71
 ds_write_b128 v54, v[12:15] offset:0
 ds_write_b128 v54, v[16:19] offset:1024
 ds_write_b128 v54, v[68:71] offset:8192
 v_cmpx_eq_u32 vcc, -1, v55
 s_cbranch_execz Lstep_75
 buffer_load_dwordx4 v[12:15], v3, s[20:23], s41 offen offset:0 sc1
 buffer_load_dwordx4 v[16:19], v3, s[20:23], s41 offen offset:1024 sc1
 buffer_load_dwordx4 v[68:71], v3, s[20:23], s43 offen offset:0 sc1
 s_waitcnt vmcnt(3)
 v_max3_u32 v55, v12, v13, v14
 v_max3_u32 v55, v55, v15, v16
 v_max3_u32 v55, v55, v17, v18
 v_max3_u32 v55, v55, v19, v68
 v_max3_u32 v55, v55, v69, v70
 v_max_u32 v55, v55, v71
 ds_write_b128 v54, v[12:15] offset:0
 ds_write_b128 v54, v[16:19] offset:1024
 ds_write_b128 v54, v[68:71] offset:8192
 v_cmpx_eq_u32 vcc, -1, v55
 s_cbranch_execz Lstep_75
 buffer_load_dwordx4 v[12:15], v3, s[20:23], s41 offen offset:0 sc1
 buffer_load_dwordx4 v[16:19], v3, s[20:23], s41 offen offset:1024 sc1
 buffer_load_dwordx4 v[68:71], v3, s[20:23], s43 offen offset:0 sc1
 s_waitcnt vmcnt(3)
 v_max3_u32 v55, v12, v13, v14
 v_max3_u32 v55, v55, v15, v16
 v_max3_u32 v55, v55, v17, v18
 v_max3_u32 v55, v55, v19, v68
 v_max3_u32 v55, v55, v69, v70
 v_max_u32 v55, v55, v71
 ds_write_b128 v54, v[12:15] offset:0
 ds_write_b128 v54, v[16:19] offset:1024
 ds_write_b128 v54, v[68:71] offset:8192
 v_cmpx_eq_u32 vcc, -1, v55
 s_cbranch_execz Lstep_75
 s_sub_u32 s54, s54, 1
 s_cbranch_scc0 Lp2_89
 s_endpgm
Lr1_85:
 s_mov_b64 exec, vcc
Lrt_90:
 buffer_load_dwordx4 v[20:23], v3, s[20:23], s40 offen offset:0 sc1
 buffer_load_dwordx4 v[24:27], v3, s[20:23], s40 offen offset:1024 sc1
 buffer_load_dwordx4 v[36:39], v3, s[20:23], s39 offen offset:0 sc1
 buffer_load_dwordx4 v[40:43], v3, s[20:23], s39 offen offset:1024 sc1
 s_waitcnt vmcnt(4)
 v_bitop3_b32 v55, v37, v39, s46 bitop3:0x7e
 v_bitop3_b32 v56, v41, v43, s46 bitop3:0x7e
 v_bitop3_b32 v57, v21, v23, s46 bitop3:0x7e
 v_or3_b32 v55, v55, v56, v57
 v_bitop3_b32 v56, v25, v27, s46 bitop3:0x7e
 v_bitop3_b32 v55, v55, 1, v56 bitop3:0xc8
 v_cmpx_ne_u32 vcc, 0, v55
 s_cbranch_execz Lrte_91
 buffer_load_dwordx4 v[20:23], v3, s[20:23], s40 offen offset:0 sc1
 buffer_load_dwordx4 v[24:27], v3, s[20:23], s40 offen offset:1024 sc1
 buffer_load_dwordx4 v[36:39], v3, s[20:23], s39 offen offset:0 sc1
 buffer_load_dwordx4 v[40:43], v3, s[20:23], s39 offen offset:1024 sc1
 s_waitcnt vmcnt(4)
 v_bitop3_b32 v55, v37, v39, s46 bitop3:0x7e
 v_bitop3_b32 v56, v41, v43, s46 bitop3:0x7e
 v_bitop3_b32 v57, v21, v23, s46 bitop3:0x7e
 v_or3_b32 v55, v55, v56, v57
 v_bitop3_b32 v56, v25, v27, s46 bitop3:0x7e
 v_bitop3_b32 v55, v55, 1, v56 bitop3:0xc8
 v_cmpx_ne_u32 vcc, 0, v55
 s_cbranch_execz Lrte_91
 buffer_load_dwordx4 v[20:23], v3, s[20:23], s40 offen offset:0 sc1
 buffer_load_dwordx4 v[24:27], v3, s[20:23], s40 offen offset:1024 sc1
 buffer_load_dwordx4 v[36:39], v3, s[20:23], s39 offen offset:0 sc1
 buffer_load_dwordx4 v[40:43], v3, s[20:23], s39 offen offset:1024 sc1
 s_waitcnt vmcnt(4)
 v_bitop3_b32 v55, v37, v39, s46 bitop3:0x7e
 v_bitop3_b32 v56, v41, v43, s46 bitop3:0x7e
 v_bitop3_b32 v57, v21, v23, s46 bitop3:0x7e
 v_or3_b32 v55, v55, v56, v57
 v_bitop3_b32 v56, v25, v27, s46 bitop3:0x7e
 v_bitop3_b32 v55, v55, 1, v56 bitop3:0xc8
 v_cmpx_ne_u32 vcc, 0, v55
 s_cbranch_execz Lrte_91
 s_sub_u32 s54, s54, 1
 s_cbranch_scc0 Lrt_90
 s_endpgm
Lrte_91:
 s_mov_b64 exec, -1
 s_nop 2
 v_mfma_f32_16x16x32_bf16 v[28:31], v[44:47], v[20:23], 0
 v_mfma_f32_16x16x32_bf16 v[28:31], v[44:47], v[24:27], v[28:31]
 v_mfma_f32_16x16x32_bf16 v[48:51], v[44:47], v[36:39], 0
 v_mfma_f32_16x16x32_bf16 v[48:51], v[44:47], v[40:43], v[48:51]
 s_nop 6
 v_add_f32_dpp v29, v29, v29 row_ror:4 row_mask:0xf bank_mask:0xf
 v_add_f32_dpp v48, v48, v48 row_ror:4 row_mask:0xf bank_mask:0xf
 v_add_f32_dpp v49, v49, v49 row_ror:4 row_mask:0xf bank_mask:0xf
 v_add_f32_dpp v29, v29, v29 row_ror:8 row_mask:0xf bank_mask:0xf
 v_add_f32_dpp v48, v48, v48 row_ror:8 row_mask:0xf bank_mask:0xf
 v_add_f32_dpp v49, v49, v49 row_ror:8 row_mask:0xf bank_mask:0xf
 v_cvt_pk_bf16_f32 v48, v48, v49
 buffer_store_dword v48, v52, s[20:23], s44 offen sc1
 v_mov_b32_dpp v30, v29 quad_perm:[1,0,3,2] row_mask:0xf bank_mask:0xf
 v_cvt_pk_bf16_f32 v29, v29, v30
 buffer_store_dword v29, v53, s[20:23], s65 offen sc1
 s_waitcnt vmcnt(2)
 s_branch Lb1_86
Lr2_80:
 s_waitcnt vmcnt(1)
 v_mfma_f32_16x16x32_bf16 v[48:51], v[44:47], v[12:15], 0
 s_waitcnt vmcnt(0)
 v_mfma_f32_16x16x32_bf16 v[48:51], v[44:47], v[16:19], v[48:51]
 v_bitop3_b32 v55, v13, v15, s46 bitop3:0x7e
 v_bitop3_b32 v56, v17, v19, s46 bitop3:0x7e
 v_bitop3_b32 v55, v55, 1, v56 bitop3:0xc8
 v_cmp_ne_u32 vcc, 0, v55
 s_nop 3
 v_add_f32_dpp v48, v48, v48 row_ror:4 row_mask:0xf bank_mask:0xf
 v_add_f32_dpp v49, v49, v49 row_ror:4 row_mask:0xf bank_mask:0xf
 s_cbranch_vccnz Lr1_79
 v_add_f32_dpp v48, v48, v48 row_ror:8 row_mask:0xf bank_mask:0xf
 v_add_f32_dpp v49, v49, v49 row_ror:8 row_mask:0xf bank_mask:0xf
 v_cvt_pk_bf16_f32 v48, v48, v49
 buffer_store_dword v48, v52, s[20:23], s44 offen sc1
 s_branch Lb1_81
Lr1_79:
 s_mov_b64 exec, vcc
Lrt_92:
 buffer_load_dwordx4 v[12:15], v3, s[20:23], s39 offen offset:0 sc1
 buffer_load_dwordx4 v[16:19], v3, s[20:23], s39 offen offset:1024 sc1
 s_waitcnt vmcnt(2)
 v_bitop3_b32 v55, v13, v15, s46 bitop3:0x7e
 v_bitop3_b32 v56, v17, v19, s46 bitop3:0x7e
 v_bitop3_b32 v55, v55, 1, v56 bitop3:0xc8
 v_cmpx_ne_u32 vcc, 0, v55
 s_cbranch_execz Lrte_93
 buffer_load_dwordx4 v[12:15], v3, s[20:23], s39 offen offset:0 sc1
 buffer_load_dwordx4 v[16:19], v3, s[20:23], s39 offen offset:1024 sc1
 s_waitcnt vmcnt(2)
 v_bitop3_b32 v55, v13, v15, s46 bitop3:0x7e
 v_bitop3_b32 v56, v17, v19, s46 bitop3:0x7e
 v_bitop3_b32 v55, v55, 1, v56 bitop3:0xc8
 v_cmpx_ne_u32 vcc, 0, v55
 s_cbranch_execz Lrte_93
 buffer_load_dwordx4 v[12:15], v3, s[20:23], s39 offen offset:0 sc1
 buffer_load_dwordx4 v[16:19], v3, s[20:23], s39 offen offset:1024 sc1
 s_waitcnt vmcnt(2)
 v_bitop3_b32 v55, v13, v15, s46 bitop3:0x7e
 v_bitop3_b32 v56, v17, v19, s46 bitop3:0x7e
 v_bitop3_b32 v55, v55, 1, v56 bitop3:0xc8
 v_cmpx_ne_u32 vcc, 0, v55
 s_cbranch_execz Lrte_93
 s_sub_u32 s54, s54, 1
 s_cbranch_scc0 Lrt_92
 s_endpgm
Lrte_93:
 s_mov_b64 exec, -1
 s_nop 2
 v_mfma_f32_16x16x32_bf16 v[48:51], v[44:47], v[12:15], 0
 v_mfma_f32_16x16x32_bf16 v[48:51], v[44:47], v[16:19], v[48:51]
 s_nop 7
 v_add_f32_dpp v48, v48, v48 row_ror:4 row_mask:0xf bank_mask:0xf
 v_add_f32_dpp v49, v49, v49 row_ror:4 row_mask:0xf bank_mask:0xf
 s_nop 0
 v_add_f32_dpp v48, v48, v48 row_ror:8 row_mask:0xf bank_mask:0xf
 v_add_f32_dpp v49, v49, v49 row_ror:8 row_mask:0xf bank_mask:0xf
 v_cvt_pk_bf16_f32 v48, v48, v49
 buffer_store_dword v48, v52, s[20:23], s44 offen sc1
 s_branch Lb1_81
Lfw_83:
Lpb_94:
 buffer_load_dword v1, v7, s[20:23], s56 offen sc1
 s_waitcnt vmcnt(0)
 v_cmp_le_u32 vcc, s58, v1
 s_cbranch_vccnz Lpbok_95
 s_sub_u32 s54, s54, 1
 s_cbranch_scc0 Lpb_94
 s_endpgm
Lpbok_95:
 s_branch Lfok_82
Lfw_88:
Lpb_96:
 buffer_load_dword v1, v7, s[20:23], s56 offen sc1
 s_waitcnt vmcnt(0)
 v_cmp_le_u32 vcc, s58, v1
 s_cbranch_vccnz Lpbok_97
 s_sub_u32 s54, s54, 1
 s_cbranch_scc0 Lpb_96
 s_endpgm
Lpbok_97:
 s_branch Lfok_87
Lfail_76:
 s_endpgm
Lchexit_51:
 s_add_u32 s38, s38, 0x20000
 v_add_u32 v6, s69, v9
 ds_read_b64_tr_b16 v[64:65], v6 offset:19456
 v_mov_b32 v66, v2
 v_mov_b32 v67, v4
 s_waitcnt lgkmcnt(0)
 buffer_store_dwordx4 v[64:67], v0, s[20:23], s38 offen sc1
 s_waitcnt vmcnt(0) lgkmcnt(0)
 s_barrier
 v_subrev_u32 v0, 0x10000, v0
 v_min_u32 v0, 16, v0
 v_lshlrev_b32 v0, 24, v0
 v_mov_b32 v6, 64
 buffer_store_dword v6, v0, s[20:23], s57 offen sc1
Lfin:
Lend:
 s_endpgm
.section .rodata,"a"
.p2align 6
.amdhsa_kernel concat_heads__compressed_kv_cla__memory_aug_recurrent_mem_tr__prompt_kernel
  .amdhsa_next_free_vgpr 512
  .amdhsa_next_free_sgpr 102
  .amdhsa_accum_offset 256
  .amdhsa_group_segment_fixed_size 0
  .amdhsa_kernarg_size 128
  .amdhsa_user_sgpr_count 2
  .amdhsa_user_sgpr_kernarg_segment_ptr 1
  .amdhsa_system_sgpr_workgroup_id_x 1
  .amdhsa_float_denorm_mode_32 3
.end_amdhsa_kernel
```

```asm
; @launch grid=(256,1,1) block=(256,1,1) lds=163840
.amdgcn_target "amdgcn-amd-amdhsa--gfx950"
.text
.globl concat_heads__compressed_kv_cla__memory_aug_recurrent_mem_tr__prompt_kernel
.p2align 8
.type concat_heads__compressed_kv_cla__memory_aug_recurrent_mem_tr__prompt_kernel,@function
concat_heads__compressed_kv_cla__memory_aug_recurrent_mem_tr__prompt_kernel:
 s_cmp_ge_u32 s2, 256
 s_cbranch_scc1 Lend
 s_load_dwordx2 s[20:21], s[0:1], 120
 s_mov_b32 s22, 0x10000000
 s_mov_b32 s23, 0x20000
 s_load_dwordx2 s[28:29], s[0:1], 112
 s_mov_b32 s30, 0x100
 s_mov_b32 s31, 0x20000
 v_lshrrev_b32 v1, 6, v0
 s_and_b32 s5, s2, 7
 s_lshr_b32 s6, s2, 3
 v_readfirstlane_b32 s4, v1
 s_lshl_b32 s5, s5, 2
 s_lshr_b32 s5, 0x37654120, s5
 s_and_b32 s5, s5, 7
 s_waitcnt lgkmcnt(0)
 s_cmp_eq_u32 s5, 0
 s_cbranch_scc1 Lchain
 s_cmp_eq_u32 s5, 1
 s_cbranch_scc1 Lpb
 s_cmp_lt_u32 s5, 4
 s_cbranch_scc1 Lqa
 s_load_dwordx2 s[8:9], s[0:1], 8
 s_mov_b32 s10, 0x200000
 s_mov_b32 s11, 0x20000
 s_load_dwordx2 s[12:13], s[0:1], 24
 s_mov_b32 s14, 0x400000
 s_mov_b32 s15, 0x20000
 s_load_dwordx2 s[16:17], s[0:1], 32
 s_mov_b32 s18, 0x400000
 s_mov_b32 s19, 0x20000
 s_sub_u32 s3, s5, 4
 s_lshl_b32 s3, s3, 3
 s_lshr_b32 s7, s6, 2
 s_add_u32 s3, s3, s7
 s_lshl_b32 s32, s3, 8
 s_mov_b32 s33, s32
 s_lshl_b32 s34, s3, 14
 s_add_u32 s34, s34, 0x1000000
 s_add_u32 s35, s34, 8192
 s_mov_b32 s36, 16
 s_and_b32 s37, s6, 3
 s_lshl_b32 s7, s3, 5
 s_add_u32 s7, s7, s37
 s_lshl_b32 s7, s7, 2
 s_add_u32 s7, s7, 0x2000
 v_min_u32 v1, 1, v0
 v_lshlrev_b32 v1, 28, v1
 v_add_u32 v13, s7, v1
 s_waitcnt lgkmcnt(0)
 v_and_b32 v1, 63, v0
 v_lshrrev_b32 v2, 3, v0
 v_mul_u32_u24 v10, 1024, v2
 v_lshrrev_b32 v2, 4, v0
 v_xor_b32 v2, v2, v0
 v_and_b32 v2, 7, v2
 v_lshl_add_u32 v10, v2, 4, v10
 v_lshrrev_b32 v2, 4, v1
 v_bfe_u32 v3, v1, 1, 3
 v_xor_b32 v2, v2, v3
 v_and_b32 v3, 15, v1
 v_lshlrev_b32 v3, 7, v3
 v_lshl_add_u32 v4, v2, 4, v3
 v_xor_b32 v5, 64, v4
 v_lshrrev_b32 v2, 4, v0
 v_lshlrev_b32 v11, 13, v2
 v_lshrrev_b32 v2, 7, v0
 v_lshrrev_b32 v3, 4, v1
 v_lshl_add_u32 v3, v2, 2, v3
 v_bfe_u32 v2, v1, 1, 3
 v_xor_b32 v2, v2, v3
 v_lshl_add_u32 v11, v2, 5, v11
 v_and_b32 v2, 1, v1
 v_lshl_add_u32 v11, v2, 4, v11
 v_bfe_u32 v2, v1, 2, 3
 v_xor_b32 v3, s4, v2
 v_lshlrev_b32 v3, 5, v3
 v_and_b32 v2, 3, v2
 v_lshl_add_u32 v3, v2, 8, v3
 v_lshrrev_b32 v2, 4, v1
 v_lshl_add_u32 v3, v2, 11, v3
 v_and_b32 v2, 3, v1
 v_lshl_add_u32 v3, v2, 3, v3
 v_add_u32 v8, 65536, v3
 v_xor_b32 v3, 0x80, v3
 v_add_u32 v9, 65536, v3
 s_lshl_b32 s45, s4, 11
 v_lshl_add_u32 v12, v1, 4, s45
 s_mov_b32 s39, s37
 s_add_u32 s40, s39, 4
 s_lshl_b32 s49, s4, 10
 s_mul_i32 s46, s39, 32768
 s_add_u32 m0, s49, 0
 s_nop 0
 buffer_load_dwordx4 v10, s[8:11], s46 offen offset:0  lds
 s_add_u32 m0, s49, 3968
 s_nop 0
 buffer_load_dwordx4 v10, s[8:11], s46 offen offset:128  lds
 s_add_u32 m0, s49, 7936
 s_nop 0
 buffer_load_dwordx4 v10, s[8:11], s46 offen offset:256  lds
 s_add_u32 m0, s49, 11904
 s_nop 0
 buffer_load_dwordx4 v10, s[8:11], s46 offen offset:384  lds
 s_add_u32 m0, s49, 15872
 s_nop 0
 buffer_load_dwordx4 v10, s[8:11], s46 offen offset:512  lds
 s_add_u32 m0, s49, 19840
 s_nop 0
 buffer_load_dwordx4 v10, s[8:11], s46 offen offset:640  lds
 s_add_u32 m0, s49, 23808
 s_nop 0
 buffer_load_dwordx4 v10, s[8:11], s46 offen offset:768  lds
 s_add_u32 m0, s49, 27776
 s_nop 0
 buffer_load_dwordx4 v10, s[8:11], s46 offen offset:896  lds
 s_lshl_b32 s49, s4, 10
 s_add_u32 s49, s49, 32768
 s_mul_i32 s46, s40, 32768
 s_add_u32 m0, s49, 0
 s_nop 0
 buffer_load_dwordx4 v10, s[8:11], s46 offen offset:0  lds
 s_add_u32 m0, s49, 3968
 s_nop 0
 buffer_load_dwordx4 v10, s[8:11], s46 offen offset:128  lds
 s_add_u32 m0, s49, 7936
 s_nop 0
 buffer_load_dwordx4 v10, s[8:11], s46 offen offset:256  lds
 s_add_u32 m0, s49, 11904
 s_nop 0
 buffer_load_dwordx4 v10, s[8:11], s46 offen offset:384  lds
 s_add_u32 m0, s49, 15872
 s_nop 0
 buffer_load_dwordx4 v10, s[8:11], s46 offen offset:512  lds
 s_add_u32 m0, s49, 19840
 s_nop 0
 buffer_load_dwordx4 v10, s[8:11], s46 offen offset:640  lds
 s_add_u32 m0, s49, 23808
 s_nop 0
 buffer_load_dwordx4 v10, s[8:11], s46 offen offset:768  lds
 s_add_u32 m0, s49, 27776
 s_nop 0
 buffer_load_dwordx4 v10, s[8:11], s46 offen offset:896  lds
 s_lshl_b32 s49, s4, 10
 s_add_u32 m0, s49, 65536
 s_add_u32 s45, s32, 0
 buffer_load_dwordx4 v11, s[12:15], s45 offen  lds
 s_add_u32 m0, s49, 69632
 s_add_u32 s45, s32, 131072
 buffer_load_dwordx4 v11, s[12:15], s45 offen  lds
 s_add_u32 m0, s49, 73728
 s_add_u32 s45, s33, 0
 buffer_load_dwordx4 v11, s[16:19], s45 offen  lds
 s_add_u32 m0, s49, 77824
 s_add_u32 s45, s33, 131072
 buffer_load_dwordx4 v11, s[16:19], s45 offen  lds
 s_add_u32 m0, s49, 81920
 s_add_u32 s45, s32, 262144
 buffer_load_dwordx4 v11, s[12:15], s45 offen  lds
 s_add_u32 m0, s49, 86016
 s_add_u32 s45, s32, 393216
 buffer_load_dwordx4 v11, s[12:15], s45 offen  lds
 s_add_u32 m0, s49, 90112
 s_add_u32 s45, s33, 262144
 buffer_load_dwordx4 v11, s[16:19], s45 offen  lds
 s_add_u32 m0, s49, 94208
 s_add_u32 s45, s33, 393216
 buffer_load_dwordx4 v11, s[16:19], s45 offen  lds
 s_add_u32 m0, s49, 98304
 s_add_u32 s45, s32, 524288
 buffer_load_dwordx4 v11, s[12:15], s45 offen  lds
 s_add_u32 m0, s49, 102400
 s_add_u32 s45, s32, 655360
 buffer_load_dwordx4 v11, s[12:15], s45 offen  lds
 s_add_u32 m0, s49, 106496
 s_add_u32 s45, s33, 524288
 buffer_load_dwordx4 v11, s[16:19], s45 offen  lds
 s_add_u32 m0, s49, 110592
 s_add_u32 s45, s33, 655360
 buffer_load_dwordx4 v11, s[16:19], s45 offen  lds
 s_waitcnt vmcnt(8) lgkmcnt(0)
 s_barrier
 s_add_u32 m0, s49, 114688
 s_add_u32 s45, s32, 786432
 buffer_load_dwordx4 v11, s[12:15], s45 offen  lds
 s_add_u32 m0, s49, 118784
 s_add_u32 s45, s32, 917504
 buffer_load_dwordx4 v11, s[12:15], s45 offen  lds
 s_add_u32 m0, s49, 122880
 s_add_u32 s45, s33, 786432
 buffer_load_dwordx4 v11, s[16:19], s45 offen  lds
 s_add_u32 m0, s49, 126976
 s_add_u32 s45, s33, 917504
 buffer_load_dwordx4 v11, s[16:19], s45 offen  lds
 ds_read_b64_tr_b16 a[0:1], v8 offset:0
 ds_read_b64_tr_b16 a[2:3], v8 offset:1024
 ds_read_b64_tr_b16 a[64:65], v9 offset:0
 ds_read_b64_tr_b16 a[66:67], v9 offset:1024
 ds_read_b64_tr_b16 a[128:129], v8 offset:8192
 ds_read_b64_tr_b16 a[130:131], v8 offset:9216
 ds_read_b64_tr_b16 a[192:193], v9 offset:8192
 ds_read_b64_tr_b16 a[194:195], v9 offset:9216
 s_waitcnt vmcnt(8) lgkmcnt(0)
 s_barrier
 s_add_u32 m0, s49, 65536
 s_add_u32 s45, s32, 1048576
 buffer_load_dwordx4 v11, s[12:15], s45 offen  lds
 s_add_u32 m0, s49, 69632
 s_add_u32 s45, s32, 1179648
 buffer_load_dwordx4 v11, s[12:15], s45 offen  lds
 s_add_u32 m0, s49, 73728
 s_add_u32 s45, s33, 1048576
 buffer_load_dwordx4 v11, s[16:19], s45 offen  lds
 s_add_u32 m0, s49, 77824
 s_add_u32 s45, s33, 1179648
 buffer_load_dwordx4 v11, s[16:19], s45 offen  lds
 ds_read_b64_tr_b16 a[4:5], v8 offset:16384
 ds_read_b64_tr_b16 a[6:7], v8 offset:17408
 ds_read_b64_tr_b16 a[68:69], v9 offset:16384
 ds_read_b64_tr_b16 a[70:71], v9 offset:17408
 ds_read_b64_tr_b16 a[132:133], v8 offset:24576
 ds_read_b64_tr_b16 a[134:135], v8 offset:25600
 ds_read_b64_tr_b16 a[196:197], v9 offset:24576
 ds_read_b64_tr_b16 a[198:199], v9 offset:25600
 s_waitcnt vmcnt(8) lgkmcnt(0)
 s_barrier
 s_add_u32 m0, s49, 81920
 s_add_u32 s45, s32, 1310720
 buffer_load_dwordx4 v11, s[12:15], s45 offen  lds
 s_add_u32 m0, s49, 86016
 s_add_u32 s45, s32, 1441792
 buffer_load_dwordx4 v11, s[12:15], s45 offen  lds
 s_add_u32 m0, s49, 90112
 s_add_u32 s45, s33, 1310720
 buffer_load_dwordx4 v11, s[16:19], s45 offen  lds
 s_add_u32 m0, s49, 94208
 s_add_u32 s45, s33, 1441792
 buffer_load_dwordx4 v11, s[16:19], s45 offen  lds
 ds_read_b64_tr_b16 a[8:9], v8 offset:32768
 ds_read_b64_tr_b16 a[10:11], v8 offset:33792
 ds_read_b64_tr_b16 a[72:73], v9 offset:32768
 ds_read_b64_tr_b16 a[74:75], v9 offset:33792
 ds_read_b64_tr_b16 a[136:137], v8 offset:40960
 ds_read_b64_tr_b16 a[138:139], v8 offset:41984
 ds_read_b64_tr_b16 a[200:201], v9 offset:40960
 ds_read_b64_tr_b16 a[202:203], v9 offset:41984
 s_waitcnt vmcnt(8) lgkmcnt(0)
 s_barrier
 s_add_u32 m0, s49, 98304
 s_add_u32 s45, s32, 1572864
 buffer_load_dwordx4 v11, s[12:15], s45 offen  lds
 s_add_u32 m0, s49, 102400
 s_add_u32 s45, s32, 1703936
 buffer_load_dwordx4 v11, s[12:15], s45 offen  lds
 s_add_u32 m0, s49, 106496
 s_add_u32 s45, s33, 1572864
 buffer_load_dwordx4 v11, s[16:19], s45 offen  lds
 s_add_u32 m0, s49, 110592
 s_add_u32 s45, s33, 1703936
 buffer_load_dwordx4 v11, s[16:19], s45 offen  lds
 ds_read_b64_tr_b16 a[12:13], v8 offset:49152
 ds_read_b64_tr_b16 a[14:15], v8 offset:50176
 ds_read_b64_tr_b16 a[76:77], v9 offset:49152
 ds_read_b64_tr_b16 a[78:79], v9 offset:50176
 ds_read_b64_tr_b16 a[140:141], v8 offset:57344
 ds_read_b64_tr_b16 a[142:143], v8 offset:58368
 ds_read_b64_tr_b16 a[204:205], v9 offset:57344
 ds_read_b64_tr_b16 a[206:207], v9 offset:58368
 s_waitcnt vmcnt(8) lgkmcnt(0)
 s_barrier
 s_add_u32 m0, s49, 114688
 s_add_u32 s45, s32, 1835008
 buffer_load_dwordx4 v11, s[12:15], s45 offen  lds
 s_add_u32 m0, s49, 118784
 s_add_u32 s45, s32, 1966080
 buffer_load_dwordx4 v11, s[12:15], s45 offen  lds
 s_add_u32 m0, s49, 122880
 s_add_u32 s45, s33, 1835008
 buffer_load_dwordx4 v11, s[16:19], s45 offen  lds
 s_add_u32 m0, s49, 126976
 s_add_u32 s45, s33, 1966080
 buffer_load_dwordx4 v11, s[16:19], s45 offen  lds
 ds_read_b64_tr_b16 a[16:17], v8 offset:0
 ds_read_b64_tr_b16 a[18:19], v8 offset:1024
 ds_read_b64_tr_b16 a[80:81], v9 offset:0
 ds_read_b64_tr_b16 a[82:83], v9 offset:1024
 ds_read_b64_tr_b16 a[144:145], v8 offset:8192
 ds_read_b64_tr_b16 a[146:147], v8 offset:9216
 ds_read_b64_tr_b16 a[208:209], v9 offset:8192
 ds_read_b64_tr_b16 a[210:211], v9 offset:9216
 s_waitcnt vmcnt(8) lgkmcnt(0)
 s_barrier
 s_add_u32 m0, s49, 65536
 s_add_u32 s45, s32, 2097152
 buffer_load_dwordx4 v11, s[12:15], s45 offen  lds
 s_add_u32 m0, s49, 69632
 s_add_u32 s45, s32, 2228224
 buffer_load_dwordx4 v11, s[12:15], s45 offen  lds
 s_add_u32 m0, s49, 73728
 s_add_u32 s45, s33, 2097152
 buffer_load_dwordx4 v11, s[16:19], s45 offen  lds
 s_add_u32 m0, s49, 77824
 s_add_u32 s45, s33, 2228224
 buffer_load_dwordx4 v11, s[16:19], s45 offen  lds
 ds_read_b64_tr_b16 a[20:21], v8 offset:16384
 ds_read_b64_tr_b16 a[22:23], v8 offset:17408
 ds_read_b64_tr_b16 a[84:85], v9 offset:16384
 ds_read_b64_tr_b16 a[86:87], v9 offset:17408
 ds_read_b64_tr_b16 a[148:149], v8 offset:24576
 ds_read_b64_tr_b16 a[150:151], v8 offset:25600
 ds_read_b64_tr_b16 a[212:213], v9 offset:24576
 ds_read_b64_tr_b16 a[214:215], v9 offset:25600
 s_waitcnt vmcnt(8) lgkmcnt(0)
 s_barrier
 s_add_u32 m0, s49, 81920
 s_add_u32 s45, s32, 2359296
 buffer_load_dwordx4 v11, s[12:15], s45 offen  lds
 s_add_u32 m0, s49, 86016
 s_add_u32 s45, s32, 2490368
 buffer_load_dwordx4 v11, s[12:15], s45 offen  lds
 s_add_u32 m0, s49, 90112
 s_add_u32 s45, s33, 2359296
 buffer_load_dwordx4 v11, s[16:19], s45 offen  lds
 s_add_u32 m0, s49, 94208
 s_add_u32 s45, s33, 2490368
 buffer_load_dwordx4 v11, s[16:19], s45 offen  lds
 ds_read_b64_tr_b16 a[24:25], v8 offset:32768
 ds_read_b64_tr_b16 a[26:27], v8 offset:33792
 ds_read_b64_tr_b16 a[88:89], v9 offset:32768
 ds_read_b64_tr_b16 a[90:91], v9 offset:33792
 ds_read_b64_tr_b16 a[152:153], v8 offset:40960
 ds_read_b64_tr_b16 a[154:155], v8 offset:41984
 ds_read_b64_tr_b16 a[216:217], v9 offset:40960
 ds_read_b64_tr_b16 a[218:219], v9 offset:41984
 s_waitcnt vmcnt(8) lgkmcnt(0)
 s_barrier
 s_add_u32 m0, s49, 98304
 s_add_u32 s45, s32, 2621440
 buffer_load_dwordx4 v11, s[12:15], s45 offen  lds
 s_add_u32 m0, s49, 102400
 s_add_u32 s45, s32, 2752512
 buffer_load_dwordx4 v11, s[12:15], s45 offen  lds
 s_add_u32 m0, s49, 106496
 s_add_u32 s45, s33, 2621440
 buffer_load_dwordx4 v11, s[16:19], s45 offen  lds
 s_add_u32 m0, s49, 110592
 s_add_u32 s45, s33, 2752512
 buffer_load_dwordx4 v11, s[16:19], s45 offen  lds
 ds_read_b64_tr_b16 a[28:29], v8 offset:49152
 ds_read_b64_tr_b16 a[30:31], v8 offset:50176
 ds_read_b64_tr_b16 a[92:93], v9 offset:49152
 ds_read_b64_tr_b16 a[94:95], v9 offset:50176
 ds_read_b64_tr_b16 a[156:157], v8 offset:57344
 ds_read_b64_tr_b16 a[158:159], v8 offset:58368
 ds_read_b64_tr_b16 a[220:221], v9 offset:57344
 ds_read_b64_tr_b16 a[222:223], v9 offset:58368
 s_waitcnt vmcnt(8) lgkmcnt(0)
 s_barrier
 s_add_u32 m0, s49, 114688
 s_add_u32 s45, s32, 2883584
 buffer_load_dwordx4 v11, s[12:15], s45 offen  lds
 s_add_u32 m0, s49, 118784
 s_add_u32 s45, s32, 3014656
 buffer_load_dwordx4 v11, s[12:15], s45 offen  lds
 s_add_u32 m0, s49, 122880
 s_add_u32 s45, s33, 2883584
 buffer_load_dwordx4 v11, s[16:19], s45 offen  lds
 s_add_u32 m0, s49, 126976
 s_add_u32 s45, s33, 3014656
 buffer_load_dwordx4 v11, s[16:19], s45 offen  lds
 ds_read_b64_tr_b16 a[32:33], v8 offset:0
 ds_read_b64_tr_b16 a[34:35], v8 offset:1024
 ds_read_b64_tr_b16 a[96:97], v9 offset:0
 ds_read_b64_tr_b16 a[98:99], v9 offset:1024
 ds_read_b64_tr_b16 a[160:161], v8 offset:8192
 ds_read_b64_tr_b16 a[162:163], v8 offset:9216
 ds_read_b64_tr_b16 a[224:225], v9 offset:8192
 ds_read_b64_tr_b16 a[226:227], v9 offset:9216
 s_waitcnt vmcnt(8) lgkmcnt(0)
 s_barrier
 s_add_u32 m0, s49, 65536
 s_add_u32 s45, s32, 3145728
 buffer_load_dwordx4 v11, s[12:15], s45 offen  lds
 s_add_u32 m0, s49, 69632
 s_add_u32 s45, s32, 3276800
 buffer_load_dwordx4 v11, s[12:15], s45 offen  lds
 s_add_u32 m0, s49, 73728
 s_add_u32 s45, s33, 3145728
 buffer_load_dwordx4 v11, s[16:19], s45 offen  lds
 s_add_u32 m0, s49, 77824
 s_add_u32 s45, s33, 3276800
 buffer_load_dwordx4 v11, s[16:19], s45 offen  lds
 ds_read_b64_tr_b16 a[36:37], v8 offset:16384
 ds_read_b64_tr_b16 a[38:39], v8 offset:17408
 ds_read_b64_tr_b16 a[100:101], v9 offset:16384
 ds_read_b64_tr_b16 a[102:103], v9 offset:17408
 ds_read_b64_tr_b16 a[164:165], v8 offset:24576
 ds_read_b64_tr_b16 a[166:167], v8 offset:25600
 ds_read_b64_tr_b16 a[228:229], v9 offset:24576
 ds_read_b64_tr_b16 a[230:231], v9 offset:25600
 s_waitcnt vmcnt(8) lgkmcnt(0)
 s_barrier
 s_add_u32 m0, s49, 81920
 s_add_u32 s45, s32, 3407872
 buffer_load_dwordx4 v11, s[12:15], s45 offen  lds
 s_add_u32 m0, s49, 86016
 s_add_u32 s45, s32, 3538944
 buffer_load_dwordx4 v11, s[12:15], s45 offen  lds
 s_add_u32 m0, s49, 90112
 s_add_u32 s45, s33, 3407872
 buffer_load_dwordx4 v11, s[16:19], s45 offen  lds
 s_add_u32 m0, s49, 94208
 s_add_u32 s45, s33, 3538944
 buffer_load_dwordx4 v11, s[16:19], s45 offen  lds
 ds_read_b64_tr_b16 a[40:41], v8 offset:32768
 ds_read_b64_tr_b16 a[42:43], v8 offset:33792
 ds_read_b64_tr_b16 a[104:105], v9 offset:32768
 ds_read_b64_tr_b16 a[106:107], v9 offset:33792
 ds_read_b64_tr_b16 a[168:169], v8 offset:40960
 ds_read_b64_tr_b16 a[170:171], v8 offset:41984
 ds_read_b64_tr_b16 a[232:233], v9 offset:40960
 ds_read_b64_tr_b16 a[234:235], v9 offset:41984
 s_waitcnt vmcnt(8) lgkmcnt(0)
 s_barrier
 s_add_u32 m0, s49, 98304
 s_add_u32 s45, s32, 3670016
 buffer_load_dwordx4 v11, s[12:15], s45 offen  lds
 s_add_u32 m0, s49, 102400
 s_add_u32 s45, s32, 3801088
 buffer_load_dwordx4 v11, s[12:15], s45 offen  lds
 s_add_u32 m0, s49, 106496
 s_add_u32 s45, s33, 3670016
 buffer_load_dwordx4 v11, s[16:19], s45 offen  lds
 s_add_u32 m0, s49, 110592
 s_add_u32 s45, s33, 3801088
 buffer_load_dwordx4 v11, s[16:19], s45 offen  lds
 ds_read_b64_tr_b16 a[44:45], v8 offset:49152
 ds_read_b64_tr_b16 a[46:47], v8 offset:50176
 ds_read_b64_tr_b16 a[108:109], v9 offset:49152
 ds_read_b64_tr_b16 a[110:111], v9 offset:50176
 ds_read_b64_tr_b16 a[172:173], v8 offset:57344
 ds_read_b64_tr_b16 a[174:175], v8 offset:58368
 ds_read_b64_tr_b16 a[236:237], v9 offset:57344
 ds_read_b64_tr_b16 a[238:239], v9 offset:58368
 s_waitcnt vmcnt(8) lgkmcnt(0)
 s_barrier
 s_add_u32 m0, s49, 114688
 s_add_u32 s45, s32, 3932160
 buffer_load_dwordx4 v11, s[12:15], s45 offen  lds
 s_add_u32 m0, s49, 118784
 s_add_u32 s45, s32, 4063232
 buffer_load_dwordx4 v11, s[12:15], s45 offen  lds
 s_add_u32 m0, s49, 122880
 s_add_u32 s45, s33, 3932160
 buffer_load_dwordx4 v11, s[16:19], s45 offen  lds
 s_add_u32 m0, s49, 126976
 s_add_u32 s45, s33, 4063232
 buffer_load_dwordx4 v11, s[16:19], s45 offen  lds
 ds_read_b64_tr_b16 a[48:49], v8 offset:0
 ds_read_b64_tr_b16 a[50:51], v8 offset:1024
 ds_read_b64_tr_b16 a[112:113], v9 offset:0
 ds_read_b64_tr_b16 a[114:115], v9 offset:1024
 ds_read_b64_tr_b16 a[176:177], v8 offset:8192
 ds_read_b64_tr_b16 a[178:179], v8 offset:9216
 ds_read_b64_tr_b16 a[240:241], v9 offset:8192
 ds_read_b64_tr_b16 a[242:243], v9 offset:9216
 s_waitcnt vmcnt(8) lgkmcnt(0)
 s_barrier
 ds_read_b64_tr_b16 a[52:53], v8 offset:16384
 ds_read_b64_tr_b16 a[54:55], v8 offset:17408
 ds_read_b64_tr_b16 a[116:117], v9 offset:16384
 ds_read_b64_tr_b16 a[118:119], v9 offset:17408
 ds_read_b64_tr_b16 a[180:181], v8 offset:24576
 ds_read_b64_tr_b16 a[182:183], v8 offset:25600
 ds_read_b64_tr_b16 a[244:245], v9 offset:24576
 ds_read_b64_tr_b16 a[246:247], v9 offset:25600
 s_waitcnt vmcnt(4) lgkmcnt(0)
 s_barrier
 ds_read_b64_tr_b16 a[56:57], v8 offset:32768
 ds_read_b64_tr_b16 a[58:59], v8 offset:33792
 ds_read_b64_tr_b16 a[120:121], v9 offset:32768
 ds_read_b64_tr_b16 a[122:123], v9 offset:33792
 ds_read_b64_tr_b16 a[184:185], v8 offset:40960
 ds_read_b64_tr_b16 a[186:187], v8 offset:41984
 ds_read_b64_tr_b16 a[248:249], v9 offset:40960
 ds_read_b64_tr_b16 a[250:251], v9 offset:41984
 s_waitcnt vmcnt(0) lgkmcnt(0)
 s_barrier
 ds_read_b64_tr_b16 a[60:61], v8 offset:49152
 ds_read_b64_tr_b16 a[62:63], v8 offset:50176
 ds_read_b64_tr_b16 a[124:125], v9 offset:49152
 ds_read_b64_tr_b16 a[126:127], v9 offset:50176
 ds_read_b64_tr_b16 a[188:189], v8 offset:57344
 ds_read_b64_tr_b16 a[190:191], v8 offset:58368
 ds_read_b64_tr_b16 a[252:253], v9 offset:57344
 ds_read_b64_tr_b16 a[254:255], v9 offset:58368
 s_mov_b32 s50, 0x3e0293ee
 s_mov_b32 s42, 0
 s_mov_b32 s43, 0
 s_mov_b32 s44, 65536
 v_mov_b32 v6, v4
 v_mov_b32 v7, v5
 s_mov_b32 s95, 0x40000
 s_cmp_lg_u32 s4, 0
 s_cbranch_scc1 Lfrk_2
 v_min_u32 v21, 1, v0
 v_lshlrev_b32 v21, 28, v21
Lfr_1:
 buffer_load_dword v20, v21, s[28:31], 0 offen offset:0 sc1
 s_waitcnt vmcnt(0)
 v_cmp_eq_u32 vcc, 1, v20
 s_cbranch_vccnz Lfrk_2
 s_sub_u32 s95, s95, 1
 s_cbranch_scc0 Lfr_1
 s_endpgm
Lfrk_2:
 s_lshl_b32 s47, s2, 13
 s_add_u32 s47, s47, 0x8000000
 s_mov_b32 s48, s47
 v_mov_b32 v14, 0
 s_waitcnt vmcnt(0) lgkmcnt(0)
 s_barrier
 ds_read_b128 v[32:35], v6 offset:0
 ds_read_b128 v[36:39], v6 offset:2048
 ds_read_b128 v[40:43], v7 offset:0
 ds_read_b128 v[44:47], v7 offset:2048
 v_lshlrev_b32 v1, 12, v0
 s_lshl_b32 s45, s6, 7
 buffer_load_dword v15, v1, s[8:11], s45 offen
 v_add_u32 v1, 0x100000, v1
 buffer_load_dword v15, v1, s[8:11], s45 offen
 v_add_u32 v1, 0x100000, v1
 s_waitcnt lgkmcnt(2)
Lps_loop_3:
 v_mfma_f32_16x16x32_bf16 v[64:67], a[0:3], v[32:35], 0
 ds_read_b128 v[48:51], v6 offset:4096
 v_mfma_f32_16x16x32_bf16 v[72:75], a[64:67], v[32:35], 0
 ds_read_b128 v[52:55], v6 offset:6144
 v_mfma_f32_16x16x32_bf16 v[80:83], v[32:35], a[128:131], 0
 s_add_u32 s41, s40, 4
 v_mfma_f32_16x16x32_bf16 v[88:91], v[32:35], a[192:195], 0
 s_add_u32 s45, s42, 2
 s_mul_i32 s46, s41, 32768
 v_mfma_f32_16x16x32_bf16 v[68:71], a[0:3], v[36:39], 0
 s_cmp_lt_u32 s45, s36
 s_cselect_b32 s46, s46, 0
 v_mfma_f32_16x16x32_bf16 v[76:79], a[64:67], v[36:39], 0
 s_lshl_b32 s49, s4, 10
 s_add_u32 s49, s49, s44
 v_mfma_f32_16x16x32_bf16 v[84:87], v[36:39], a[128:131], 0
 v_mfma_f32_16x16x32_bf16 v[92:95], v[36:39], a[192:195], 0
 s_waitcnt lgkmcnt(2)
 v_mfma_f32_16x16x32_bf16 v[64:67], a[4:7], v[40:43], v[64:67]
 ds_read_b128 v[56:59], v7 offset:4096
 v_mfma_f32_16x16x32_bf16 v[72:75], a[68:71], v[40:43], v[72:75]
 ds_read_b128 v[60:63], v7 offset:6144
 v_mfma_f32_16x16x32_bf16 v[80:83], v[40:43], a[132:135], v[80:83]
 s_add_u32 m0, s49, 0
 v_mfma_f32_16x16x32_bf16 v[88:91], v[40:43], a[196:199], v[88:91]
 buffer_load_dwordx4 v10, s[8:11], s46 offen offset:0  lds
 v_mfma_f32_16x16x32_bf16 v[68:71], a[4:7], v[44:47], v[68:71]
 s_add_u32 m0, s49, 3968
 v_mfma_f32_16x16x32_bf16 v[76:79], a[68:71], v[44:47], v[76:79]
 buffer_load_dwordx4 v10, s[8:11], s46 offen offset:128  lds
 v_mfma_f32_16x16x32_bf16 v[84:87], v[44:47], a[132:135], v[84:87]
 v_mfma_f32_16x16x32_bf16 v[92:95], v[44:47], a[196:199], v[92:95]
 s_waitcnt lgkmcnt(2)
 v_mfma_f32_16x16x32_bf16 v[64:67], a[8:11], v[48:51], v[64:67]
 ds_read_b128 v[32:35], v6 offset:8192
 v_mfma_f32_16x16x32_bf16 v[72:75], a[72:75], v[48:51], v[72:75]
 ds_read_b128 v[36:39], v6 offset:10240
 v_mfma_f32_16x16x32_bf16 v[80:83], v[48:51], a[136:139], v[80:83]
 s_add_u32 m0, s49, 7936
 v_mfma_f32_16x16x32_bf16 v[88:91], v[48:51], a[200:203], v[88:91]
 buffer_load_dwordx4 v10, s[8:11], s46 offen offset:256  lds
 v_mfma_f32_16x16x32_bf16 v[68:71], a[8:11], v[52:55], v[68:71]
 s_add_u32 m0, s49, 11904
 v_mfma_f32_16x16x32_bf16 v[76:79], a[72:75], v[52:55], v[76:79]
 buffer_load_dwordx4 v10, s[8:11], s46 offen offset:384  lds
 v_mfma_f32_16x16x32_bf16 v[84:87], v[52:55], a[136:139], v[84:87]
 v_mfma_f32_16x16x32_bf16 v[92:95], v[52:55], a[200:203], v[92:95]
 s_waitcnt lgkmcnt(2)
 v_mfma_f32_16x16x32_bf16 v[64:67], a[12:15], v[56:59], v[64:67]
 ds_read_b128 v[40:43], v7 offset:8192
 v_mfma_f32_16x16x32_bf16 v[72:75], a[76:79], v[56:59], v[72:75]
 ds_read_b128 v[44:47], v7 offset:10240
 v_mfma_f32_16x16x32_bf16 v[80:83], v[56:59], a[140:143], v[80:83]
 s_add_u32 m0, s49, 15872
 v_mfma_f32_16x16x32_bf16 v[88:91], v[56:59], a[204:207], v[88:91]
 buffer_load_dwordx4 v10, s[8:11], s46 offen offset:512  lds
 v_mfma_f32_16x16x32_bf16 v[68:71], a[12:15], v[60:63], v[68:71]
 s_add_u32 m0, s49, 19840
 v_mfma_f32_16x16x32_bf16 v[76:79], a[76:79], v[60:63], v[76:79]
 buffer_load_dwordx4 v10, s[8:11], s46 offen offset:640  lds
 v_mfma_f32_16x16x32_bf16 v[84:87], v[60:63], a[140:143], v[84:87]
 v_mfma_f32_16x16x32_bf16 v[92:95], v[60:63], a[204:207], v[92:95]
 s_waitcnt lgkmcnt(2)
 v_mfma_f32_16x16x32_bf16 v[64:67], a[16:19], v[32:35], v[64:67]
 ds_read_b128 v[48:51], v6 offset:12288
 v_mfma_f32_16x16x32_bf16 v[72:75], a[80:83], v[32:35], v[72:75]
 ds_read_b128 v[52:55], v6 offset:14336
 v_mfma_f32_16x16x32_bf16 v[80:83], v[32:35], a[144:147], v[80:83]
 s_add_u32 m0, s49, 23808
 v_mfma_f32_16x16x32_bf16 v[88:91], v[32:35], a[208:211], v[88:91]
 buffer_load_dwordx4 v10, s[8:11], s46 offen offset:768  lds
 v_mfma_f32_16x16x32_bf16 v[68:71], a[16:19], v[36:39], v[68:71]
 s_add_u32 m0, s49, 27776
 v_mfma_f32_16x16x32_bf16 v[76:79], a[80:83], v[36:39], v[76:79]
 buffer_load_dwordx4 v10, s[8:11], s46 offen offset:896  lds
 v_mfma_f32_16x16x32_bf16 v[84:87], v[36:39], a[144:147], v[84:87]
 v_mfma_f32_16x16x32_bf16 v[92:95], v[36:39], a[208:211], v[92:95]
 s_waitcnt lgkmcnt(2)
 v_mfma_f32_16x16x32_bf16 v[64:67], a[20:23], v[40:43], v[64:67]
 ds_read_b128 v[56:59], v7 offset:12288
 v_mfma_f32_16x16x32_bf16 v[72:75], a[84:87], v[40:43], v[72:75]
 ds_read_b128 v[60:63], v7 offset:14336
 v_mfma_f32_16x16x32_bf16 v[80:83], v[40:43], a[148:151], v[80:83]
 v_mfma_f32_16x16x32_bf16 v[88:91], v[40:43], a[212:215], v[88:91]
 v_mfma_f32_16x16x32_bf16 v[68:71], a[20:23], v[44:47], v[68:71]
 v_mfma_f32_16x16x32_bf16 v[76:79], a[84:87], v[44:47], v[76:79]
 v_mfma_f32_16x16x32_bf16 v[84:87], v[44:47], a[148:151], v[84:87]
 v_mfma_f32_16x16x32_bf16 v[92:95], v[44:47], a[212:215], v[92:95]
 s_waitcnt lgkmcnt(2)
 v_mfma_f32_16x16x32_bf16 v[64:67], a[24:27], v[48:51], v[64:67]
 ds_read_b128 v[32:35], v6 offset:16384
 v_mfma_f32_16x16x32_bf16 v[72:75], a[88:91], v[48:51], v[72:75]
 ds_read_b128 v[36:39], v6 offset:18432
 v_mfma_f32_16x16x32_bf16 v[80:83], v[48:51], a[152:155], v[80:83]
 v_cvt_pk_bf16_f32 v16, v96, v97
 v_mfma_f32_16x16x32_bf16 v[88:91], v[48:51], a[216:219], v[88:91]
 v_cvt_pk_bf16_f32 v17, v104, v105
 v_mfma_f32_16x16x32_bf16 v[68:71], a[24:27], v[52:55], v[68:71]
 v_mfma_f32_16x16x32_bf16 v[76:79], a[88:91], v[52:55], v[76:79]
 v_cvt_pk_bf16_f32 v18, v98, v99
 v_mfma_f32_16x16x32_bf16 v[84:87], v[52:55], a[152:155], v[84:87]
 v_mfma_f32_16x16x32_bf16 v[92:95], v[52:55], a[216:219], v[92:95]
 s_waitcnt lgkmcnt(2)
 v_mfma_f32_16x16x32_bf16 v[64:67], a[28:31], v[56:59], v[64:67]
 ds_read_b128 v[40:43], v7 offset:16384
 v_mfma_f32_16x16x32_bf16 v[72:75], a[92:95], v[56:59], v[72:75]
 ds_read_b128 v[44:47], v7 offset:18432
 v_mfma_f32_16x16x32_bf16 v[80:83], v[56:59], a[156:159], v[80:83]
 v_cvt_pk_bf16_f32 v19, v106, v107
 v_mfma_f32_16x16x32_bf16 v[88:91], v[56:59], a[220:223], v[88:91]
 v_mfma_f32_16x16x32_bf16 v[68:71], a[28:31], v[60:63], v[68:71]
 buffer_store_dwordx4 v[16:19], v12, s[20:23], s47 offen offset:0 sc1
 v_mfma_f32_16x16x32_bf16 v[76:79], a[92:95], v[60:63], v[76:79]
 v_cvt_pk_bf16_f32 v20, v100, v101
 v_mfma_f32_16x16x32_bf16 v[84:87], v[60:63], a[156:159], v[84:87]
 v_mfma_f32_16x16x32_bf16 v[92:95], v[60:63], a[220:223], v[92:95]
 s_waitcnt lgkmcnt(2)
 v_mfma_f32_16x16x32_bf16 v[64:67], a[32:35], v[32:35], v[64:67]
 ds_read_b128 v[48:51], v6 offset:20480
 v_mfma_f32_16x16x32_bf16 v[72:75], a[96:99], v[32:35], v[72:75]
 ds_read_b128 v[52:55], v6 offset:22528
 v_mfma_f32_16x16x32_bf16 v[80:83], v[32:35], a[160:163], v[80:83]
 v_cvt_pk_bf16_f32 v21, v108, v109
 v_mfma_f32_16x16x32_bf16 v[88:91], v[32:35], a[224:227], v[88:91]
 v_mfma_f32_16x16x32_bf16 v[68:71], a[32:35], v[36:39], v[68:71]
 v_cvt_pk_bf16_f32 v22, v102, v103
 v_mfma_f32_16x16x32_bf16 v[76:79], a[96:99], v[36:39], v[76:79]
 v_mfma_f32_16x16x32_bf16 v[84:87], v[36:39], a[160:163], v[84:87]
 v_cvt_pk_bf16_f32 v23, v110, v111
 v_mfma_f32_16x16x32_bf16 v[92:95], v[36:39], a[224:227], v[92:95]
 s_waitcnt lgkmcnt(2)
 v_mfma_f32_16x16x32_bf16 v[64:67], a[36:39], v[40:43], v[64:67]
 ds_read_b128 v[56:59], v7 offset:20480
 v_mfma_f32_16x16x32_bf16 v[72:75], a[100:103], v[40:43], v[72:75]
 ds_read_b128 v[60:63], v7 offset:22528
 v_mfma_f32_16x16x32_bf16 v[80:83], v[40:43], a[164:167], v[80:83]
 buffer_store_dwordx4 v[20:23], v12, s[20:23], s47 offen offset:1024 sc1
 v_mfma_f32_16x16x32_bf16 v[88:91], v[40:43], a[228:231], v[88:91]
 v_mfma_f32_16x16x32_bf16 v[68:71], a[36:39], v[44:47], v[68:71]
 v_cvt_pk_bf16_f32 v24, v112, v113
 v_mfma_f32_16x16x32_bf16 v[76:79], a[100:103], v[44:47], v[76:79]
 v_mfma_f32_16x16x32_bf16 v[84:87], v[44:47], a[164:167], v[84:87]
 v_cvt_pk_bf16_f32 v25, v116, v117
 v_mfma_f32_16x16x32_bf16 v[92:95], v[44:47], a[228:231], v[92:95]
 s_waitcnt lgkmcnt(2)
 v_mfma_f32_16x16x32_bf16 v[64:67], a[40:43], v[48:51], v[64:67]
 ds_read_b128 v[32:35], v6 offset:24576
 v_mfma_f32_16x16x32_bf16 v[72:75], a[104:107], v[48:51], v[72:75]
 ds_read_b128 v[36:39], v6 offset:26624
 v_mfma_f32_16x16x32_bf16 v[80:83], v[48:51], a[168:171], v[80:83]
 v_mfma_f32_16x16x32_bf16 v[88:91], v[48:51], a[232:235], v[88:91]
 v_cvt_pk_bf16_f32 v26, v114, v115
 v_mfma_f32_16x16x32_bf16 v[68:71], a[40:43], v[52:55], v[68:71]
 v_cvt_pk_bf16_f32 v27, v118, v119
 v_mfma_f32_16x16x32_bf16 v[76:79], a[104:107], v[52:55], v[76:79]
 v_mfma_f32_16x16x32_bf16 v[84:87], v[52:55], a[168:171], v[84:87]
 buffer_store_dwordx4 v[24:27], v12, s[20:23], s48 offen offset:0 sc1
 v_mfma_f32_16x16x32_bf16 v[92:95], v[52:55], a[232:235], v[92:95]
 s_waitcnt lgkmcnt(2)
 v_mfma_f32_16x16x32_bf16 v[64:67], a[44:47], v[56:59], v[64:67]
 ds_read_b128 v[40:43], v7 offset:24576
 v_mfma_f32_16x16x32_bf16 v[72:75], a[108:111], v[56:59], v[72:75]
 ds_read_b128 v[44:47], v7 offset:26624
 v_mfma_f32_16x16x32_bf16 v[80:83], v[56:59], a[172:175], v[80:83]
 s_add_u32 s43, s43, 32768
 s_cmp_eq_u32 s43, 131072
 v_mfma_f32_16x16x32_bf16 v[88:91], v[56:59], a[236:239], v[88:91]
 s_cselect_b32 s43, 0, s43
 s_add_u32 s44, s44, 32768
 v_mfma_f32_16x16x32_bf16 v[68:71], a[44:47], v[60:63], v[68:71]
 s_cmp_eq_u32 s44, 131072
 s_cselect_b32 s44, 0, s44
 v_mfma_f32_16x16x32_bf16 v[76:79], a[108:111], v[60:63], v[76:79]
 v_mfma_f32_16x16x32_bf16 v[84:87], v[60:63], a[172:175], v[84:87]
 v_cvt_pk_bf16_f32 v28, v120, v121
 v_mfma_f32_16x16x32_bf16 v[92:95], v[60:63], a[236:239], v[92:95]
 s_waitcnt lgkmcnt(2)
 v_mfma_f32_16x16x32_bf16 v[64:67], a[48:51], v[32:35], v[64:67]
 ds_read_b128 v[48:51], v6 offset:28672
 v_mfma_f32_16x16x32_bf16 v[72:75], a[112:115], v[32:35], v[72:75]
 ds_read_b128 v[52:55], v6 offset:30720
 v_mfma_f32_16x16x32_bf16 v[80:83], v[32:35], a[176:179], v[80:83]
 v_add_u32 v6, s43, v4
 v_mfma_f32_16x16x32_bf16 v[88:91], v[32:35], a[240:243], v[88:91]
 v_mfma_f32_16x16x32_bf16 v[68:71], a[48:51], v[36:39], v[68:71]
 v_cvt_pk_bf16_f32 v29, v124, v125
 v_mfma_f32_16x16x32_bf16 v[76:79], a[112:115], v[36:39], v[76:79]
 v_cvt_pk_bf16_f32 v30, v122, v123
 v_mfma_f32_16x16x32_bf16 v[84:87], v[36:39], a[176:179], v[84:87]
 v_mfma_f32_16x16x32_bf16 v[92:95], v[36:39], a[240:243], v[92:95]
 s_waitcnt lgkmcnt(2)
 v_mfma_f32_16x16x32_bf16 v[64:67], a[52:55], v[40:43], v[64:67]
 ds_read_b128 v[56:59], v7 offset:28672
 v_mfma_f32_16x16x32_bf16 v[72:75], a[116:119], v[40:43], v[72:75]
 ds_read_b128 v[60:63], v7 offset:30720
 v_mfma_f32_16x16x32_bf16 v[80:83], v[40:43], a[180:183], v[80:83]
 v_add_u32 v7, s43, v5
 v_mfma_f32_16x16x32_bf16 v[88:91], v[40:43], a[244:247], v[88:91]
 v_cvt_pk_bf16_f32 v31, v126, v127
 v_mfma_f32_16x16x32_bf16 v[68:71], a[52:55], v[44:47], v[68:71]
 v_mfma_f32_16x16x32_bf16 v[76:79], a[116:119], v[44:47], v[76:79]
 buffer_store_dwordx4 v[28:31], v12, s[20:23], s48 offen offset:1024 sc1
 v_mfma_f32_16x16x32_bf16 v[84:87], v[44:47], a[180:183], v[84:87]
 v_mfma_f32_16x16x32_bf16 v[92:95], v[44:47], a[244:247], v[92:95]
 s_waitcnt lgkmcnt(2)
 v_mfma_f32_16x16x32_bf16 v[64:67], a[56:59], v[48:51], v[64:67]
 s_waitcnt vmcnt(12)
 s_barrier
 ds_read_b128 v[32:35], v6 offset:0
 v_mfma_f32_16x16x32_bf16 v[72:75], a[120:123], v[48:51], v[72:75]
 ds_read_b128 v[36:39], v6 offset:2048
 v_mfma_f32_16x16x32_bf16 v[80:83], v[48:51], a[184:187], v[80:83]
 v_mfma_f32_16x16x32_bf16 v[88:91], v[48:51], a[248:251], v[88:91]
 v_mfma_f32_16x16x32_bf16 v[68:71], a[56:59], v[52:55], v[68:71]
 v_mfma_f32_16x16x32_bf16 v[76:79], a[120:123], v[52:55], v[76:79]
 v_mfma_f32_16x16x32_bf16 v[84:87], v[52:55], a[184:187], v[84:87]
 v_mfma_f32_16x16x32_bf16 v[92:95], v[52:55], a[248:251], v[92:95]
 s_waitcnt lgkmcnt(2)
 v_mfma_f32_16x16x32_bf16 v[64:67], a[60:63], v[56:59], v[64:67]
 ds_read_b128 v[40:43], v7 offset:0
 v_mfma_f32_16x16x32_bf16 v[72:75], a[124:127], v[56:59], v[72:75]
 ds_read_b128 v[44:47], v7 offset:2048
 v_mfma_f32_16x16x32_bf16 v[80:83], v[56:59], a[188:191], v[80:83]
 s_mul_i32 s45, s39, 524288
 s_add_u32 s47, s34, s45
 v_mfma_f32_16x16x32_bf16 v[88:91], v[56:59], a[252:255], v[88:91]
 s_add_u32 s48, s35, s45
 v_mov_b32 v14, s42
 v_mfma_f32_16x16x32_bf16 v[68:71], a[60:63], v[60:63], v[68:71]
 s_mov_b32 s39, s40
 s_mov_b32 s40, s41
 v_mfma_f32_16x16x32_bf16 v[76:79], a[124:127], v[60:63], v[76:79]
 s_add_u32 s42, s42, 1
 v_mfma_f32_16x16x32_bf16 v[84:87], v[60:63], a[188:191], v[84:87]
 v_mfma_f32_16x16x32_bf16 v[92:95], v[60:63], a[252:255], v[92:95]
 s_waitcnt lgkmcnt(2)
 v_mfma_f32_16x16x32_bf16 v[96:99], a[0:3], v[32:35], 0
 ds_read_b128 v[48:51], v6 offset:4096
 v_mfma_f32_16x16x32_bf16 v[104:107], a[64:67], v[32:35], 0
 ds_read_b128 v[52:55], v6 offset:6144
 v_mfma_f32_16x16x32_bf16 v[112:115], v[32:35], a[128:131], 0
 s_add_u32 s41, s40, 4
 v_mfma_f32_16x16x32_bf16 v[120:123], v[32:35], a[192:195], 0
 s_add_u32 s45, s42, 2
 s_mul_i32 s46, s41, 32768
 v_mfma_f32_16x16x32_bf16 v[100:103], a[0:3], v[36:39], 0
 s_cmp_lt_u32 s45, s36
 s_cselect_b32 s46, s46, 0
 v_mfma_f32_16x16x32_bf16 v[108:111], a[64:67], v[36:39], 0
 s_lshl_b32 s49, s4, 10
 s_add_u32 s49, s49, s44
 v_mfma_f32_16x16x32_bf16 v[116:119], v[36:39], a[128:131], 0
 v_mfma_f32_16x16x32_bf16 v[124:127], v[36:39], a[192:195], 0
 s_waitcnt lgkmcnt(2)
 v_mfma_f32_16x16x32_bf16 v[96:99], a[4:7], v[40:43], v[96:99]
 ds_read_b128 v[56:59], v7 offset:4096
 v_mfma_f32_16x16x32_bf16 v[104:107], a[68:71], v[40:43], v[104:107]
 ds_read_b128 v[60:63], v7 offset:6144
 v_mfma_f32_16x16x32_bf16 v[112:115], v[40:43], a[132:135], v[112:115]
 s_add_u32 m0, s49, 0
 v_mfma_f32_16x16x32_bf16 v[120:123], v[40:43], a[196:199], v[120:123]
 buffer_load_dwordx4 v10, s[8:11], s46 offen offset:0  lds
 v_mfma_f32_16x16x32_bf16 v[100:103], a[4:7], v[44:47], v[100:103]
 s_add_u32 m0, s49, 3968
 v_mfma_f32_16x16x32_bf16 v[108:111], a[68:71], v[44:47], v[108:111]
 buffer_load_dwordx4 v10, s[8:11], s46 offen offset:128  lds
 v_mfma_f32_16x16x32_bf16 v[116:119], v[44:47], a[132:135], v[116:119]
 v_mfma_f32_16x16x32_bf16 v[124:127], v[44:47], a[196:199], v[124:127]
 s_waitcnt lgkmcnt(2)
 v_mfma_f32_16x16x32_bf16 v[96:99], a[8:11], v[48:51], v[96:99]
 ds_read_b128 v[32:35], v6 offset:8192
 v_mfma_f32_16x16x32_bf16 v[104:107], a[72:75], v[48:51], v[104:107]
 ds_read_b128 v[36:39], v6 offset:10240
 v_mfma_f32_16x16x32_bf16 v[112:115], v[48:51], a[136:139], v[112:115]
 s_add_u32 m0, s49, 7936
 v_mfma_f32_16x16x32_bf16 v[120:123], v[48:51], a[200:203], v[120:123]
 buffer_load_dwordx4 v10, s[8:11], s46 offen offset:256  lds
 v_mfma_f32_16x16x32_bf16 v[100:103], a[8:11], v[52:55], v[100:103]
 s_add_u32 m0, s49, 11904
 v_mfma_f32_16x16x32_bf16 v[108:111], a[72:75], v[52:55], v[108:111]
 buffer_load_dwordx4 v10, s[8:11], s46 offen offset:384  lds
 v_mfma_f32_16x16x32_bf16 v[116:119], v[52:55], a[136:139], v[116:119]
 v_mfma_f32_16x16x32_bf16 v[124:127], v[52:55], a[200:203], v[124:127]
 s_waitcnt lgkmcnt(2)
 v_mfma_f32_16x16x32_bf16 v[96:99], a[12:15], v[56:59], v[96:99]
 ds_read_b128 v[40:43], v7 offset:8192
 v_mfma_f32_16x16x32_bf16 v[104:107], a[76:79], v[56:59], v[104:107]
 ds_read_b128 v[44:47], v7 offset:10240
 v_mfma_f32_16x16x32_bf16 v[112:115], v[56:59], a[140:143], v[112:115]
 s_add_u32 m0, s49, 15872
 v_mfma_f32_16x16x32_bf16 v[120:123], v[56:59], a[204:207], v[120:123]
 buffer_load_dwordx4 v10, s[8:11], s46 offen offset:512  lds
 v_mfma_f32_16x16x32_bf16 v[100:103], a[12:15], v[60:63], v[100:103]
 s_add_u32 m0, s49, 19840
 v_mfma_f32_16x16x32_bf16 v[108:111], a[76:79], v[60:63], v[108:111]
 buffer_load_dwordx4 v10, s[8:11], s46 offen offset:640  lds
 v_mfma_f32_16x16x32_bf16 v[116:119], v[60:63], a[140:143], v[116:119]
 v_mfma_f32_16x16x32_bf16 v[124:127], v[60:63], a[204:207], v[124:127]
 s_waitcnt lgkmcnt(2)
 v_mfma_f32_16x16x32_bf16 v[96:99], a[16:19], v[32:35], v[96:99]
 ds_read_b128 v[48:51], v6 offset:12288
 v_mfma_f32_16x16x32_bf16 v[104:107], a[80:83], v[32:35], v[104:107]
 ds_read_b128 v[52:55], v6 offset:14336
 v_mfma_f32_16x16x32_bf16 v[112:115], v[32:35], a[144:147], v[112:115]
 s_add_u32 m0, s49, 23808
 v_mfma_f32_16x16x32_bf16 v[120:123], v[32:35], a[208:211], v[120:123]
 buffer_load_dwordx4 v10, s[8:11], s46 offen offset:768  lds
 v_mfma_f32_16x16x32_bf16 v[100:103], a[16:19], v[36:39], v[100:103]
 s_add_u32 m0, s49, 27776
 v_mfma_f32_16x16x32_bf16 v[108:111], a[80:83], v[36:39], v[108:111]
 buffer_load_dwordx4 v10, s[8:11], s46 offen offset:896  lds
 v_mfma_f32_16x16x32_bf16 v[116:119], v[36:39], a[144:147], v[116:119]
 v_mfma_f32_16x16x32_bf16 v[124:127], v[36:39], a[208:211], v[124:127]
 s_waitcnt lgkmcnt(2)
 v_mfma_f32_16x16x32_bf16 v[96:99], a[20:23], v[40:43], v[96:99]
 ds_read_b128 v[56:59], v7 offset:12288
 v_mfma_f32_16x16x32_bf16 v[104:107], a[84:87], v[40:43], v[104:107]
 ds_read_b128 v[60:63], v7 offset:14336
 v_mfma_f32_16x16x32_bf16 v[112:115], v[40:43], a[148:151], v[112:115]
 v_mfma_f32_16x16x32_bf16 v[120:123], v[40:43], a[212:215], v[120:123]
 v_mfma_f32_16x16x32_bf16 v[100:103], a[20:23], v[44:47], v[100:103]
 v_mfma_f32_16x16x32_bf16 v[108:111], a[84:87], v[44:47], v[108:111]
 v_mfma_f32_16x16x32_bf16 v[116:119], v[44:47], a[148:151], v[116:119]
 v_mfma_f32_16x16x32_bf16 v[124:127], v[44:47], a[212:215], v[124:127]
 s_waitcnt lgkmcnt(2)
 v_mfma_f32_16x16x32_bf16 v[96:99], a[24:27], v[48:51], v[96:99]
 ds_read_b128 v[32:35], v6 offset:16384
 v_mfma_f32_16x16x32_bf16 v[104:107], a[88:91], v[48:51], v[104:107]
 ds_read_b128 v[36:39], v6 offset:18432
 v_mfma_f32_16x16x32_bf16 v[112:115], v[48:51], a[152:155], v[112:115]
 v_cvt_pk_bf16_f32 v16, v64, v65
 v_mfma_f32_16x16x32_bf16 v[120:123], v[48:51], a[216:219], v[120:123]
 v_cvt_pk_bf16_f32 v17, v72, v73
 v_mfma_f32_16x16x32_bf16 v[100:103], a[24:27], v[52:55], v[100:103]
 v_mfma_f32_16x16x32_bf16 v[108:111], a[88:91], v[52:55], v[108:111]
 v_cvt_pk_bf16_f32 v18, v66, v67
 v_mfma_f32_16x16x32_bf16 v[116:119], v[52:55], a[152:155], v[116:119]
 v_mfma_f32_16x16x32_bf16 v[124:127], v[52:55], a[216:219], v[124:127]
 s_waitcnt lgkmcnt(2)
 v_mfma_f32_16x16x32_bf16 v[96:99], a[28:31], v[56:59], v[96:99]
 ds_read_b128 v[40:43], v7 offset:16384
 v_mfma_f32_16x16x32_bf16 v[104:107], a[92:95], v[56:59], v[104:107]
 ds_read_b128 v[44:47], v7 offset:18432
 v_mfma_f32_16x16x32_bf16 v[112:115], v[56:59], a[156:159], v[112:115]
 v_cvt_pk_bf16_f32 v19, v74, v75
 v_mfma_f32_16x16x32_bf16 v[120:123], v[56:59], a[220:223], v[120:123]
 v_mfma_f32_16x16x32_bf16 v[100:103], a[28:31], v[60:63], v[100:103]
 buffer_store_dwordx4 v[16:19], v12, s[20:23], s47 offen offset:0 sc1
 v_mfma_f32_16x16x32_bf16 v[108:111], a[92:95], v[60:63], v[108:111]
 v_cvt_pk_bf16_f32 v20, v68, v69
 v_mfma_f32_16x16x32_bf16 v[116:119], v[60:63], a[156:159], v[116:119]
 v_mfma_f32_16x16x32_bf16 v[124:127], v[60:63], a[220:223], v[124:127]
 s_waitcnt lgkmcnt(2)
 v_mfma_f32_16x16x32_bf16 v[96:99], a[32:35], v[32:35], v[96:99]
 ds_read_b128 v[48:51], v6 offset:20480
 v_mfma_f32_16x16x32_bf16 v[104:107], a[96:99], v[32:35], v[104:107]
 ds_read_b128 v[52:55], v6 offset:22528
 v_mfma_f32_16x16x32_bf16 v[112:115], v[32:35], a[160:163], v[112:115]
 v_cvt_pk_bf16_f32 v21, v76, v77
 v_mfma_f32_16x16x32_bf16 v[120:123], v[32:35], a[224:227], v[120:123]
 v_mfma_f32_16x16x32_bf16 v[100:103], a[32:35], v[36:39], v[100:103]
 v_cvt_pk_bf16_f32 v22, v70, v71
 v_mfma_f32_16x16x32_bf16 v[108:111], a[96:99], v[36:39], v[108:111]
 v_mfma_f32_16x16x32_bf16 v[116:119], v[36:39], a[160:163], v[116:119]
 v_cvt_pk_bf16_f32 v23, v78, v79
 v_mfma_f32_16x16x32_bf16 v[124:127], v[36:39], a[224:227], v[124:127]
 s_waitcnt lgkmcnt(2)
 v_mfma_f32_16x16x32_bf16 v[96:99], a[36:39], v[40:43], v[96:99]
 ds_read_b128 v[56:59], v7 offset:20480
 v_mfma_f32_16x16x32_bf16 v[104:107], a[100:103], v[40:43], v[104:107]
 ds_read_b128 v[60:63], v7 offset:22528
 v_mfma_f32_16x16x32_bf16 v[112:115], v[40:43], a[164:167], v[112:115]
 buffer_store_dwordx4 v[20:23], v12, s[20:23], s47 offen offset:1024 sc1
 v_mfma_f32_16x16x32_bf16 v[120:123], v[40:43], a[228:231], v[120:123]
 v_mfma_f32_16x16x32_bf16 v[100:103], a[36:39], v[44:47], v[100:103]
 v_cvt_pk_bf16_f32 v24, v80, v81
 v_mfma_f32_16x16x32_bf16 v[108:111], a[100:103], v[44:47], v[108:111]
 v_mfma_f32_16x16x32_bf16 v[116:119], v[44:47], a[164:167], v[116:119]
 v_cvt_pk_bf16_f32 v25, v84, v85
 v_mfma_f32_16x16x32_bf16 v[124:127], v[44:47], a[228:231], v[124:127]
 s_waitcnt lgkmcnt(2)
 v_mfma_f32_16x16x32_bf16 v[96:99], a[40:43], v[48:51], v[96:99]
 ds_read_b128 v[32:35], v6 offset:24576
 v_mfma_f32_16x16x32_bf16 v[104:107], a[104:107], v[48:51], v[104:107]
 ds_read_b128 v[36:39], v6 offset:26624
 v_mfma_f32_16x16x32_bf16 v[112:115], v[48:51], a[168:171], v[112:115]
 v_mfma_f32_16x16x32_bf16 v[120:123], v[48:51], a[232:235], v[120:123]
 v_cvt_pk_bf16_f32 v26, v82, v83
 v_mfma_f32_16x16x32_bf16 v[100:103], a[40:43], v[52:55], v[100:103]
 v_cvt_pk_bf16_f32 v27, v86, v87
 v_mfma_f32_16x16x32_bf16 v[108:111], a[104:107], v[52:55], v[108:111]
 v_mfma_f32_16x16x32_bf16 v[116:119], v[52:55], a[168:171], v[116:119]
 buffer_store_dwordx4 v[24:27], v12, s[20:23], s48 offen offset:0 sc1
 v_mfma_f32_16x16x32_bf16 v[124:127], v[52:55], a[232:235], v[124:127]
 s_waitcnt lgkmcnt(2)
 v_mfma_f32_16x16x32_bf16 v[96:99], a[44:47], v[56:59], v[96:99]
 ds_read_b128 v[40:43], v7 offset:24576
 v_mfma_f32_16x16x32_bf16 v[104:107], a[108:111], v[56:59], v[104:107]
 ds_read_b128 v[44:47], v7 offset:26624
 v_mfma_f32_16x16x32_bf16 v[112:115], v[56:59], a[172:175], v[112:115]
 s_add_u32 s43, s43, 32768
 s_cmp_eq_u32 s43, 131072
 v_mfma_f32_16x16x32_bf16 v[120:123], v[56:59], a[236:239], v[120:123]
 s_cselect_b32 s43, 0, s43
 s_add_u32 s44, s44, 32768
 v_mfma_f32_16x16x32_bf16 v[100:103], a[44:47], v[60:63], v[100:103]
 s_cmp_eq_u32 s44, 131072
 s_cselect_b32 s44, 0, s44
 v_mfma_f32_16x16x32_bf16 v[108:111], a[108:111], v[60:63], v[108:111]
 v_mfma_f32_16x16x32_bf16 v[116:119], v[60:63], a[172:175], v[116:119]
 v_cvt_pk_bf16_f32 v28, v88, v89
 v_mfma_f32_16x16x32_bf16 v[124:127], v[60:63], a[236:239], v[124:127]
 s_waitcnt lgkmcnt(2)
 v_mfma_f32_16x16x32_bf16 v[96:99], a[48:51], v[32:35], v[96:99]
 ds_read_b128 v[48:51], v6 offset:28672
 v_mfma_f32_16x16x32_bf16 v[104:107], a[112:115], v[32:35], v[104:107]
 ds_read_b128 v[52:55], v6 offset:30720
 v_mfma_f32_16x16x32_bf16 v[112:115], v[32:35], a[176:179], v[112:115]
 v_add_u32 v6, s43, v4
 v_mfma_f32_16x16x32_bf16 v[120:123], v[32:35], a[240:243], v[120:123]
 v_mfma_f32_16x16x32_bf16 v[100:103], a[48:51], v[36:39], v[100:103]
 v_cvt_pk_bf16_f32 v29, v92, v93
 v_mfma_f32_16x16x32_bf16 v[108:111], a[112:115], v[36:39], v[108:111]
 v_cvt_pk_bf16_f32 v30, v90, v91
 v_mfma_f32_16x16x32_bf16 v[116:119], v[36:39], a[176:179], v[116:119]
 v_mfma_f32_16x16x32_bf16 v[124:127], v[36:39], a[240:243], v[124:127]
 s_waitcnt lgkmcnt(2)
 v_mfma_f32_16x16x32_bf16 v[96:99], a[52:55], v[40:43], v[96:99]
 ds_read_b128 v[56:59], v7 offset:28672
 v_mfma_f32_16x16x32_bf16 v[104:107], a[116:119], v[40:43], v[104:107]
 ds_read_b128 v[60:63], v7 offset:30720
 v_mfma_f32_16x16x32_bf16 v[112:115], v[40:43], a[180:183], v[112:115]
 v_add_u32 v7, s43, v5
 v_mfma_f32_16x16x32_bf16 v[120:123], v[40:43], a[244:247], v[120:123]
 v_cvt_pk_bf16_f32 v31, v94, v95
 v_mfma_f32_16x16x32_bf16 v[100:103], a[52:55], v[44:47], v[100:103]
 v_mfma_f32_16x16x32_bf16 v[108:111], a[116:119], v[44:47], v[108:111]
 buffer_store_dwordx4 v[28:31], v12, s[20:23], s48 offen offset:1024 sc1
 v_mfma_f32_16x16x32_bf16 v[116:119], v[44:47], a[180:183], v[116:119]
 v_mfma_f32_16x16x32_bf16 v[124:127], v[44:47], a[244:247], v[124:127]
 s_waitcnt lgkmcnt(2)
 v_mfma_f32_16x16x32_bf16 v[96:99], a[56:59], v[48:51], v[96:99]
 s_waitcnt vmcnt(12)
 s_barrier
 ds_read_b128 v[32:35], v6 offset:0
 v_mfma_f32_16x16x32_bf16 v[104:107], a[120:123], v[48:51], v[104:107]
 ds_read_b128 v[36:39], v6 offset:2048
 v_mfma_f32_16x16x32_bf16 v[112:115], v[48:51], a[184:187], v[112:115]
 v_mfma_f32_16x16x32_bf16 v[120:123], v[48:51], a[248:251], v[120:123]
 v_mfma_f32_16x16x32_bf16 v[100:103], a[56:59], v[52:55], v[100:103]
 v_mfma_f32_16x16x32_bf16 v[108:111], a[120:123], v[52:55], v[108:111]
 v_mfma_f32_16x16x32_bf16 v[116:119], v[52:55], a[184:187], v[116:119]
 v_mfma_f32_16x16x32_bf16 v[124:127], v[52:55], a[248:251], v[124:127]
 s_waitcnt lgkmcnt(2)
 v_mfma_f32_16x16x32_bf16 v[96:99], a[60:63], v[56:59], v[96:99]
 ds_read_b128 v[40:43], v7 offset:0
 v_mfma_f32_16x16x32_bf16 v[104:107], a[124:127], v[56:59], v[104:107]
 ds_read_b128 v[44:47], v7 offset:2048
 v_mfma_f32_16x16x32_bf16 v[112:115], v[56:59], a[188:191], v[112:115]
 s_mul_i32 s45, s39, 524288
 s_add_u32 s47, s34, s45
 v_mfma_f32_16x16x32_bf16 v[120:123], v[56:59], a[252:255], v[120:123]
 s_add_u32 s48, s35, s45
 v_mov_b32 v14, s42
 v_mfma_f32_16x16x32_bf16 v[100:103], a[60:63], v[60:63], v[100:103]
 s_mov_b32 s39, s40
 s_mov_b32 s40, s41
 v_mfma_f32_16x16x32_bf16 v[108:111], a[124:127], v[60:63], v[108:111]
 s_add_u32 s42, s42, 1
 s_cmp_lt_u32 s42, s36
 v_mfma_f32_16x16x32_bf16 v[116:119], v[60:63], a[188:191], v[116:119]
 v_mfma_f32_16x16x32_bf16 v[124:127], v[60:63], a[252:255], v[124:127]
 s_waitcnt lgkmcnt(2)
 s_cbranch_scc1 Lps_loop_3
 s_nop 7
 v_cvt_pk_bf16_f32 v16, v96, v97
 v_cvt_pk_bf16_f32 v17, v104, v105
 v_cvt_pk_bf16_f32 v18, v98, v99
 v_cvt_pk_bf16_f32 v19, v106, v107
 buffer_store_dwordx4 v[16:19], v12, s[20:23], s47 offen offset:0 sc1
 v_cvt_pk_bf16_f32 v20, v100, v101
 v_cvt_pk_bf16_f32 v21, v108, v109
 v_cvt_pk_bf16_f32 v22, v102, v103
 v_cvt_pk_bf16_f32 v23, v110, v111
 buffer_store_dwordx4 v[20:23], v12, s[20:23], s47 offen offset:1024 sc1
 v_cvt_pk_bf16_f32 v24, v112, v113
 v_cvt_pk_bf16_f32 v25, v116, v117
 v_cvt_pk_bf16_f32 v26, v114, v115
 v_cvt_pk_bf16_f32 v27, v118, v119
 buffer_store_dwordx4 v[24:27], v12, s[20:23], s48 offen offset:0 sc1
 v_cvt_pk_bf16_f32 v28, v120, v121
 v_cvt_pk_bf16_f32 v29, v124, v125
 v_cvt_pk_bf16_f32 v30, v122, v123
 v_cvt_pk_bf16_f32 v31, v126, v127
 buffer_store_dwordx4 v[28:31], v12, s[20:23], s48 offen offset:1024 sc1
 s_waitcnt vmcnt(0) lgkmcnt(0)
 s_barrier
 v_mov_b32 v14, s36
 buffer_store_dword v14, v13, s[20:23], 0 offen sc1
 s_mov_b32 s32, s3
 s_and_b32 s33, s6, 3
 s_sub_u32 s34, 7, s33
 v_and_b32 v1, 63, v0
 v_lshlrev_b32 v1, 4, v1
 v_mov_b32 v4, 0xff800000
 v_min_u32 v5, 1, v0
 v_lshlrev_b32 v5, 28, v5
 v_mov_b32 v6, 0x3f803f80
 v_accvgpr_write_b32 a192, v6
 v_accvgpr_write_b32 a193, v6
 v_accvgpr_write_b32 a194, v6
 v_accvgpr_write_b32 a195, v6
 s_mov_b32 s52, 0xfff0ffff
 s_mov_b32 s53, 0xf000ff00
 s_mov_b32 s54, 0xffe0fffe
 s_mov_b32 s55, 0xe000fe00
 s_mov_b32 s56, 0xffc0fffc
 s_mov_b32 s57, 0xc000fc00
 s_mov_b32 s58, 0xff80fff8
 s_mov_b32 s59, 0x8000f800
 s_mov_b32 s73, 0x53800000
 s_mov_b32 s74, 0x21800000
 s_lshl_b32 s50, s4, 12
 s_lshl_b32 s45, s32, 14
 s_add_u32 s45, s45, s50
 s_add_u32 s45, s45, 0x1000000
 s_lshl_b32 s36, s33, 3
 s_add_u32 s36, s36, 8
 s_lshl_b32 s47, s34, 3
 s_add_u32 s47, s47, 8
 s_mov_b32 s35, 0
 s_mov_b32 s38, 0
 s_mov_b32 s46, 0
 s_lshl_b32 s7, s3, 7
 s_add_u32 s7, s7, 0x2000
 s_lshr_b32 s94, s3, 1
 s_lshl_b32 s94, s94, 7
 s_add_u32 s94, s94, 0x3000
 v_mov_b32 v8, 0
Law_4:
 buffer_load_dwordx4 v[16:19], v8, s[20:23], s7 offen sc1
 buffer_load_dwordx4 v[20:23], v8, s[20:23], s94 offen sc1
 s_waitcnt vmcnt(0)
 v_min3_u32 v16, v16, v17, v18
 v_min3_u32 v16, v16, v19, v20
 v_min3_u32 v16, v16, v21, v22
 v_min_u32 v16, v16, v23
 v_cmp_le_u32 vcc, 16, v16
 s_cbranch_vccnz Lawk_5
 s_sleep 2
 s_sub_u32 s95, s95, 1
 s_cbranch_scc0 Law_4
 s_endpgm
Lawk_5:
 s_lshl_b32 s37, s35, 19
 s_add_u32 m0, s38, s50
 s_add_u32 s37, s37, s45
 buffer_load_dwordx4 v1, s[20:23], s37 offen offset:0 sc1 lds
 buffer_load_dwordx4 v1, s[20:23], s37 offen offset:1024 sc1 lds
 buffer_load_dwordx4 v1, s[20:23], s37 offen offset:2048 sc1 lds
 buffer_load_dwordx4 v1, s[20:23], s37 offen offset:3072 sc1 lds
 s_add_u32 s38, s38, 0x4000
 s_and_b32 s38, s38, 0x1ffff
 s_add_u32 s35, s35, 1
 s_cmp_eq_u32 s35, s36
 s_cselect_b32 s36, s47, s36
 s_cselect_b32 s35, 0, s35
 s_lshl_b32 s44, s33, 3
 s_add_u32 s44, s44, s4
 s_lshl_b32 s44, s44, 5
 s_add_u32 s44, s44, s32
 s_lshl_b32 s44, s44, 13
 s_add_u32 s44, s44, 0x5000000
 buffer_load_dwordx4 a[0:3], v1, s[20:23], s44 offen offset:0 sc1
 buffer_load_dwordx4 a[16:19], v1, s[20:23], s44 offen offset:1024 sc1
 buffer_load_dwordx4 a[4:7], v1, s[20:23], s44 offen offset:2048 sc1
 buffer_load_dwordx4 a[20:23], v1, s[20:23], s44 offen offset:3072 sc1
 s_add_u32 s44, s44, 4096
 buffer_load_dwordx4 a[8:11], v1, s[20:23], s44 offen offset:0 sc1
 buffer_load_dwordx4 a[24:27], v1, s[20:23], s44 offen offset:1024 sc1
 buffer_load_dwordx4 a[12:15], v1, s[20:23], s44 offen offset:2048 sc1
 buffer_load_dwordx4 a[28:31], v1, s[20:23], s44 offen offset:3072 sc1
 s_lshl_b32 s44, s33, 3
 s_add_u32 s44, s44, 7
 s_sub_u32 s44, s44, s4
 s_lshl_b32 s44, s44, 5
 s_add_u32 s44, s44, s32
 s_lshl_b32 s44, s44, 13
 s_add_u32 s44, s44, 0x5000000
 buffer_load_dwordx4 a[32:35], v1, s[20:23], s44 offen offset:0 sc1
 buffer_load_dwordx4 a[48:51], v1, s[20:23], s44 offen offset:1024 sc1
 buffer_load_dwordx4 a[36:39], v1, s[20:23], s44 offen offset:2048 sc1
 buffer_load_dwordx4 a[52:55], v1, s[20:23], s44 offen offset:3072 sc1
 s_add_u32 s44, s44, 4096
 buffer_load_dwordx4 a[40:43], v1, s[20:23], s44 offen offset:0 sc1
 buffer_load_dwordx4 a[56:59], v1, s[20:23], s44 offen offset:1024 sc1
 buffer_load_dwordx4 a[44:47], v1, s[20:23], s44 offen offset:2048 sc1
 buffer_load_dwordx4 a[60:63], v1, s[20:23], s44 offen offset:3072 sc1
 s_lshl_b32 s37, s35, 19
 s_add_u32 m0, s38, s50
 s_add_u32 s37, s37, s45
 buffer_load_dwordx4 v1, s[20:23], s37 offen offset:0 sc1 lds
 buffer_load_dwordx4 v1, s[20:23], s37 offen offset:1024 sc1 lds
 buffer_load_dwordx4 v1, s[20:23], s37 offen offset:2048 sc1 lds
 buffer_load_dwordx4 v1, s[20:23], s37 offen offset:3072 sc1 lds
 s_add_u32 s38, s38, 0x4000
 s_and_b32 s38, s38, 0x1ffff
 s_add_u32 s35, s35, 1
 s_cmp_eq_u32 s35, s36
 s_cselect_b32 s36, s47, s36
 s_cselect_b32 s35, 0, s35
 s_lshl_b32 s37, s35, 19
 s_add_u32 m0, s38, s50
 s_add_u32 s37, s37, s45
 buffer_load_dwordx4 v1, s[20:23], s37 offen offset:0 sc1 lds
 buffer_load_dwordx4 v1, s[20:23], s37 offen offset:1024 sc1 lds
 buffer_load_dwordx4 v1, s[20:23], s37 offen offset:2048 sc1 lds
 buffer_load_dwordx4 v1, s[20:23], s37 offen offset:3072 sc1 lds
 s_add_u32 s38, s38, 0x4000
 s_and_b32 s38, s38, 0x1ffff
 s_add_u32 s35, s35, 1
 s_cmp_eq_u32 s35, s36
 s_cselect_b32 s36, s47, s36
 s_cselect_b32 s35, 0, s35
 s_lshl_b32 s37, s35, 19
 s_add_u32 m0, s38, s50
 s_add_u32 s37, s37, s45
 buffer_load_dwordx4 v1, s[20:23], s37 offen offset:0 sc1 lds
 buffer_load_dwordx4 v1, s[20:23], s37 offen offset:1024 sc1 lds
 buffer_load_dwordx4 v1, s[20:23], s37 offen offset:2048 sc1 lds
 buffer_load_dwordx4 v1, s[20:23], s37 offen offset:3072 sc1 lds
 s_add_u32 s38, s38, 0x4000
 s_and_b32 s38, s38, 0x1ffff
 s_add_u32 s35, s35, 1
 s_cmp_eq_u32 s35, s36
 s_cselect_b32 s36, s47, s36
 s_cselect_b32 s35, 0, s35
 s_lshl_b32 s37, s35, 19
 s_add_u32 m0, s38, s50
 s_add_u32 s37, s37, s45
 buffer_load_dwordx4 v1, s[20:23], s37 offen offset:0 sc1 lds
 buffer_load_dwordx4 v1, s[20:23], s37 offen offset:1024 sc1 lds
 buffer_load_dwordx4 v1, s[20:23], s37 offen offset:2048 sc1 lds
 buffer_load_dwordx4 v1, s[20:23], s37 offen offset:3072 sc1 lds
 s_add_u32 s38, s38, 0x4000
 s_and_b32 s38, s38, 0x1ffff
 s_add_u32 s35, s35, 1
 s_cmp_eq_u32 s35, s36
 s_cselect_b32 s36, s47, s36
 s_cselect_b32 s35, 0, s35
 s_lshl_b32 s37, s35, 19
 s_add_u32 m0, s38, s50
 s_add_u32 s37, s37, s45
 buffer_load_dwordx4 v1, s[20:23], s37 offen offset:0 sc1 lds
 buffer_load_dwordx4 v1, s[20:23], s37 offen offset:1024 sc1 lds
 buffer_load_dwordx4 v1, s[20:23], s37 offen offset:2048 sc1 lds
 buffer_load_dwordx4 v1, s[20:23], s37 offen offset:3072 sc1 lds
 s_add_u32 s38, s38, 0x4000
 s_and_b32 s38, s38, 0x1ffff
 s_add_u32 s35, s35, 1
 s_cmp_eq_u32 s35, s36
 s_cselect_b32 s36, s47, s36
 s_cselect_b32 s35, 0, s35
 s_lshl_b32 s37, s35, 19
 s_add_u32 m0, s38, s50
 s_add_u32 s37, s37, s45
 buffer_load_dwordx4 v1, s[20:23], s37 offen offset:0 sc1 lds
 buffer_load_dwordx4 v1, s[20:23], s37 offen offset:1024 sc1 lds
 buffer_load_dwordx4 v1, s[20:23], s37 offen offset:2048 sc1 lds
 buffer_load_dwordx4 v1, s[20:23], s37 offen offset:3072 sc1 lds
 s_add_u32 s38, s38, 0x4000
 s_and_b32 s38, s38, 0x1ffff
 s_add_u32 s35, s35, 1
 s_cmp_eq_u32 s35, s36
 s_cselect_b32 s36, s47, s36
 s_cselect_b32 s35, 0, s35
 s_lshl_b32 s44, s34, 3
 s_add_u32 s44, s44, s4
 s_lshl_b32 s44, s44, 5
 s_add_u32 s44, s44, s32
 s_lshl_b32 s44, s44, 13
 s_add_u32 s44, s44, 0x5000000
 buffer_load_dwordx4 a[64:67], v1, s[20:23], s44 offen offset:0 sc1
 buffer_load_dwordx4 a[80:83], v1, s[20:23], s44 offen offset:1024 sc1
 buffer_load_dwordx4 a[68:71], v1, s[20:23], s44 offen offset:2048 sc1
 buffer_load_dwordx4 a[84:87], v1, s[20:23], s44 offen offset:3072 sc1
 s_add_u32 s44, s44, 4096
 buffer_load_dwordx4 a[72:75], v1, s[20:23], s44 offen offset:0 sc1
 buffer_load_dwordx4 a[88:91], v1, s[20:23], s44 offen offset:1024 sc1
 buffer_load_dwordx4 a[76:79], v1, s[20:23], s44 offen offset:2048 sc1
 buffer_load_dwordx4 a[92:95], v1, s[20:23], s44 offen offset:3072 sc1
 s_lshl_b32 s44, s34, 3
 s_add_u32 s44, s44, 7
 s_sub_u32 s44, s44, s4
 s_lshl_b32 s44, s44, 5
 s_add_u32 s44, s44, s32
 s_lshl_b32 s44, s44, 13
 s_add_u32 s44, s44, 0x5000000
 buffer_load_dwordx4 a[96:99], v1, s[20:23], s44 offen offset:0 sc1
 buffer_load_dwordx4 a[112:115], v1, s[20:23], s44 offen offset:1024 sc1
 buffer_load_dwordx4 a[100:103], v1, s[20:23], s44 offen offset:2048 sc1
 buffer_load_dwordx4 a[116:119], v1, s[20:23], s44 offen offset:3072 sc1
 s_add_u32 s44, s44, 4096
 buffer_load_dwordx4 a[104:107], v1, s[20:23], s44 offen offset:0 sc1
 buffer_load_dwordx4 a[120:123], v1, s[20:23], s44 offen offset:1024 sc1
 buffer_load_dwordx4 a[108:111], v1, s[20:23], s44 offen offset:2048 sc1
 buffer_load_dwordx4 a[124:127], v1, s[20:23], s44 offen offset:3072 sc1
 s_waitcnt vmcnt(40)
 s_barrier
 v_mov_b32 v2, v1
 ds_read_b128 a[128:131], v2 offset:0
 ds_read_b128 a[132:135], v2 offset:1024
 ds_read_b128 a[136:139], v2 offset:2048
 ds_read_b128 a[140:143], v2 offset:3072
 ds_read_b128 a[144:147], v2 offset:4096
 ds_read_b128 a[148:151], v2 offset:5120
 ds_read_b128 a[152:155], v2 offset:6144
 ds_read_b128 a[156:159], v2 offset:7168
 s_mov_b32 s39, 0
 s_add_u32 s39, s39, 0x4000
 s_and_b32 s39, s39, 0x1ffff
 v_mov_b32 v3, v2
 v_add_u32 v2, s39, v1
 s_mov_b32 s72, 0x8000000
Lablk_6:
 s_lshl_b32 s43, s33, 3
 s_add_u32 s41, s43, s4
 s_add_u32 s42, s43, 7
 s_sub_u32 s42, s42, s4
 s_mov_b32 s49, 0
 s_waitcnt lgkmcnt(0)
 v_mfma_f32_16x16x32_bf16 v[48:51], a[128:131], a[0:3], 0
 s_cmp_lt_u32 s49, s41
 v_mov_b64 v[176:177], 0
 v_mov_b64 v[178:179], 0
 v_mfma_f32_16x16x32_bf16 v[56:59], a[128:131], a[16:19], 0
 s_cselect_b64 s[68:69], -1, 0
 v_mov_b64 v[180:181], 0
 v_mov_b64 v[182:183], 0
 v_mfma_f32_16x16x32_bf16 v[64:67], a[128:131], a[32:35], 0
 v_mfma_f32_16x16x32_bf16 v[72:75], a[128:131], a[48:51], 0
 s_cmp_le_u32 s49, s41
 v_mov_b64 v[184:185], 0
 v_mov_b64 v[186:187], 0
 v_mfma_f32_16x16x32_bf16 v[48:51], a[136:139], a[4:7], v[48:51]
 v_mfma_f32_16x16x32_bf16 v[56:59], a[136:139], a[20:23], v[56:59]
 s_cselect_b64 s[70:71], -1, 0
 v_mov_b64 v[188:189], 0
 v_mov_b64 v[190:191], 0
 v_mfma_f32_16x16x32_bf16 v[64:67], a[136:139], a[36:39], v[64:67]
 v_mfma_f32_16x16x32_bf16 v[72:75], a[136:139], a[52:55], v[72:75]
 s_cmp_eq_u32 s49, s41
 v_mov_b64 v[192:193], 0
 v_mov_b64 v[194:195], 0
 v_mfma_f32_16x16x32_bf16 v[48:51], a[144:147], a[8:11], v[48:51]
 s_cselect_b64 s[60:61], s[52:53], s[68:69]
 v_mfma_f32_16x16x32_bf16 v[56:59], a[144:147], a[24:27], v[56:59]
 v_mov_b64 v[196:197], 0
 v_mov_b64 v[198:199], 0
 v_mfma_f32_16x16x32_bf16 v[64:67], a[144:147], a[40:43], v[64:67]
 s_cselect_b64 s[62:63], s[54:55], s[68:69]
 v_mfma_f32_16x16x32_bf16 v[72:75], a[144:147], a[56:59], v[72:75]
 v_mov_b64 v[200:201], 0
 v_mov_b64 v[202:203], 0
 v_mfma_f32_16x16x32_bf16 v[48:51], a[152:155], a[12:15], v[48:51]
 s_cselect_b64 s[64:65], s[56:57], s[68:69]
 v_mfma_f32_16x16x32_bf16 v[56:59], a[152:155], a[28:31], v[56:59]
 v_mov_b64 v[204:205], 0
 v_mov_b64 v[206:207], 0
 v_mfma_f32_16x16x32_bf16 v[64:67], a[152:155], a[44:47], v[64:67]
 s_cselect_b64 s[66:67], s[58:59], s[68:69]
 v_mfma_f32_16x16x32_bf16 v[72:75], a[152:155], a[60:63], v[72:75]
 s_nop 4
 v_max3_f32 v12, v48, v49, v50
 v_max3_f32 v13, v56, v57, v58
 v_max3_f32 v14, v64, v65, v66
 v_max3_f32 v15, v72, v73, v74
 v_max_f32 v12, v12, v51
 v_max_f32 v13, v13, v59
 v_max_f32 v14, v14, v67
 v_max_f32 v15, v15, v75
 v_mov_b32 v6, v12
 v_mov_b32 v7, v13
 v_mov_b32 v8, v14
 v_mov_b32 v9, v15
 v_permlane16_swap_b32 v12, v6
 v_permlane16_swap_b32 v13, v7
 v_permlane16_swap_b32 v14, v8
 v_permlane16_swap_b32 v15, v9
 v_max_f32 v12, v12, v6
 v_max_f32 v13, v13, v7
 v_max_f32 v14, v14, v8
 v_max_f32 v15, v15, v9
 v_mov_b32 v6, v12
 v_mov_b32 v7, v13
 v_mov_b32 v8, v14
 v_mov_b32 v9, v15
 v_permlane32_swap_b32 v12, v6
 v_permlane32_swap_b32 v13, v7
 v_permlane32_swap_b32 v14, v8
 v_permlane32_swap_b32 v15, v9
 v_max_f32 v12, v12, v6
 v_max_f32 v13, v13, v7
 v_max_f32 v14, v14, v8
 v_max_f32 v15, v15, v9
 v_sub_f32 v12, 0, v12
 v_sub_f32 v13, 0, v13
 v_sub_f32 v14, 0, v14
 v_sub_f32 v15, 0, v15
 v_cndmask_b32 v80, v4, v12, s[60:61]
 v_cndmask_b32 v81, v4, v12, s[62:63]
 v_cndmask_b32 v82, v4, v12, s[64:65]
 v_cndmask_b32 v83, v4, v12, s[66:67]
 v_cndmask_b32 v84, v4, v12, s[68:69]
 v_cndmask_b32 v85, v4, v12, s[68:69]
 v_cndmask_b32 v86, v4, v12, s[68:69]
 v_cndmask_b32 v87, v4, v12, s[68:69]
 v_cndmask_b32 v88, v4, v13, s[70:71]
 v_cndmask_b32 v89, v4, v13, s[70:71]
 v_cndmask_b32 v90, v4, v13, s[70:71]
 v_cndmask_b32 v91, v4, v13, s[70:71]
 v_cndmask_b32 v92, v4, v13, s[60:61]
 v_cndmask_b32 v93, v4, v13, s[62:63]
 v_cndmask_b32 v94, v4, v13, s[64:65]
 v_cndmask_b32 v95, v4, v13, s[66:67]
 v_mov_b32 v96, v14
 v_mov_b32 v97, v14
 v_mov_b32 v98, v14
 v_mov_b32 v99, v14
 v_mov_b32 v100, v14
 v_mov_b32 v101, v14
 v_mov_b32 v102, v14
 v_mov_b32 v103, v14
 v_mov_b32 v104, v15
 v_mov_b32 v105, v15
 v_mov_b32 v106, v15
 v_mov_b32 v107, v15
 v_mov_b32 v108, v15
 v_mov_b32 v109, v15
 v_mov_b32 v110, v15
 v_mov_b32 v111, v15
 v_mov_b32 v6, 1
 s_waitcnt lgkmcnt(0)
 v_mfma_f32_16x16x32_bf16 v[48:51], a[128:131], a[0:3], v[80:83]
 ds_read_b128 a[160:163], v3 offset:8192
 v_mov_b64 v[208:209], 0
 v_mov_b64 v[210:211], 0
 v_mfma_f32_16x16x32_bf16 v[56:59], a[128:131], a[16:19], v[88:91]
 v_mov_b64 v[212:213], 0
 v_mov_b64 v[214:215], 0
 v_mfma_f32_16x16x32_bf16 v[52:55], a[132:135], a[0:3], v[84:87]
 ds_read_b128 a[164:167], v3 offset:9216
 v_mfma_f32_16x16x32_bf16 v[60:63], a[132:135], a[16:19], v[92:95]
 v_mov_b64 v[216:217], 0
 v_mov_b64 v[218:219], 0
 v_mfma_f32_16x16x32_bf16 v[48:51], a[136:139], a[4:7], v[48:51]
 ds_read_b128 a[168:171], v3 offset:10240
 v_mov_b64 v[220:221], 0
 v_mov_b64 v[222:223], 0
 v_mfma_f32_16x16x32_bf16 v[56:59], a[136:139], a[20:23], v[56:59]
 v_mfma_f32_16x16x32_bf16 v[52:55], a[140:143], a[4:7], v[52:55]
 ds_read_b128 a[172:175], v3 offset:11264
 v_mov_b64 v[224:225], 0
 v_mov_b64 v[226:227], 0
 v_mfma_f32_16x16x32_bf16 v[60:63], a[140:143], a[20:23], v[60:63]
 v_mov_b64 v[228:229], 0
 v_mov_b64 v[230:231], 0
 v_mfma_f32_16x16x32_bf16 v[48:51], a[144:147], a[8:11], v[48:51]
 ds_read_b128 a[176:179], v3 offset:12288
 v_mfma_f32_16x16x32_bf16 v[56:59], a[144:147], a[24:27], v[56:59]
 v_mov_b64 v[232:233], 0
 v_mov_b64 v[234:235], 0
 v_mfma_f32_16x16x32_bf16 v[52:55], a[148:151], a[8:11], v[52:55]
 ds_read_b128 a[180:183], v3 offset:13312
 v_mov_b64 v[236:237], 0
 v_mov_b64 v[238:239], 0
 v_mfma_f32_16x16x32_bf16 v[60:63], a[148:151], a[24:27], v[60:63]
 v_mfma_f32_16x16x32_bf16 v[48:51], a[152:155], a[12:15], v[48:51]
 ds_read_b128 a[184:187], v3 offset:14336
 v_mov_b64 v[40:41], 0
 v_mov_b64 v[42:43], 0
 v_mfma_f32_16x16x32_bf16 v[56:59], a[152:155], a[28:31], v[56:59]
 v_mov_b64 v[44:45], 0
 v_mov_b64 v[46:47], 0
 v_mfma_f32_16x16x32_bf16 v[52:55], a[156:159], a[12:15], v[52:55]
 ds_read_b128 a[188:191], v3 offset:15360
 v_mfma_f32_16x16x32_bf16 v[60:63], a[156:159], a[28:31], v[60:63]
 v_mfma_f32_16x16x32_bf16 v[64:67], a[128:131], a[32:35], v[96:99]
 s_waitcnt vmcnt(0)
 s_barrier
 buffer_store_dword v6, v5, s[20:23], s72 offen sc1
 v_mfma_f32_16x16x32_bf16 v[72:75], a[128:131], a[48:51], v[104:107]
 ds_read_b128 a[128:131], v2 offset:0
 v_mfma_f32_16x16x32_bf16 v[68:71], a[132:135], a[32:35], v[100:103]
 s_add_u32 s49, s49, 1
 v_mfma_f32_16x16x32_bf16 v[76:79], a[132:135], a[48:51], v[108:111]
 ds_read_b128 a[132:135], v2 offset:1024
 v_exp_f32 v48, v48
 v_exp_f32 v49, v49
 v_mfma_f32_16x16x32_bf16 v[64:67], a[136:139], a[36:39], v[64:67]
 s_cmp_lt_u32 s49, s41
 v_exp_f32 v52, v52
 v_exp_f32 v53, v53
 v_mfma_f32_16x16x32_bf16 v[72:75], a[136:139], a[52:55], v[72:75]
 ds_read_b128 a[136:139], v2 offset:2048
 v_exp_f32 v50, v50
 v_mfma_f32_16x16x32_bf16 v[68:71], a[140:143], a[36:39], v[68:71]
 s_cselect_b64 s[68:69], -1, 0
 v_cvt_pk_bf16_f32 v16, v48, v49
 v_cvt_pk_bf16_f32 v17, v52, v53
 v_exp_f32 v51, v51
 v_mfma_f32_16x16x32_bf16 v[76:79], a[140:143], a[52:55], v[76:79]
 ds_read_b128 a[140:143], v2 offset:3072
 v_exp_f32 v54, v54
 v_exp_f32 v55, v55
 v_mfma_f32_16x16x32_bf16 v[64:67], a[144:147], a[40:43], v[64:67]
 v_cvt_pk_bf16_f32 v18, v50, v51
 v_cvt_pk_bf16_f32 v19, v54, v55
 v_mfma_f32_16x16x32_bf16 v[72:75], a[144:147], a[56:59], v[72:75]
 ds_read_b128 a[144:147], v2 offset:4096
 v_exp_f32 v56, v56
 v_exp_f32 v57, v57
 v_mfma_f32_16x16x32_bf16 v[68:71], a[148:151], a[40:43], v[68:71]
 s_cmp_le_u32 s49, s41
 v_exp_f32 v60, v60
 v_exp_f32 v61, v61
 v_mfma_f32_16x16x32_bf16 v[76:79], a[148:151], a[56:59], v[76:79]
 ds_read_b128 a[148:151], v2 offset:5120
 v_exp_f32 v58, v58
 v_mfma_f32_16x16x32_bf16 v[64:67], a[152:155], a[44:47], v[64:67]
 s_cselect_b64 s[70:71], -1, 0
 v_cvt_pk_bf16_f32 v20, v56, v57
 v_cvt_pk_bf16_f32 v21, v60, v61
 v_exp_f32 v59, v59
 v_mfma_f32_16x16x32_bf16 v[72:75], a[152:155], a[60:63], v[72:75]
 ds_read_b128 a[152:155], v2 offset:6144
 v_exp_f32 v62, v62
 v_exp_f32 v63, v63
 v_mfma_f32_16x16x32_bf16 v[68:71], a[156:159], a[44:47], v[68:71]
 v_cvt_pk_bf16_f32 v22, v58, v59
 v_cvt_pk_bf16_f32 v23, v62, v63
 v_mfma_f32_16x16x32_bf16 v[76:79], a[156:159], a[60:63], v[76:79]
 ds_read_b128 a[156:159], v2 offset:7168
 s_waitcnt lgkmcnt(8)
 v_mfma_f32_16x16x32_bf16 v[112:115], a[160:163], v[16:19], 0
 s_add_u32 s39, s39, 0x4000
 s_and_b32 s39, s39, 0x1ffff
 v_mfma_f32_16x16x32_bf16 v[144:147], a[160:163], v[20:23], 0
 s_cmp_eq_u32 s49, s41
 v_mfma_f32_16x16x32_bf16 v[116:119], a[164:167], v[16:19], 0
 s_cselect_b64 s[60:61], s[52:53], s[68:69]
 v_mfma_f32_16x16x32_bf16 v[148:151], a[164:167], v[20:23], 0
 s_cselect_b64 s[62:63], s[54:55], s[68:69]
 v_mov_b32 v3, v2
 v_add_u32 v2, s39, v1
 v_exp_f32 v64, v64
 v_mfma_f32_16x16x32_bf16 v[120:123], a[168:171], v[16:19], 0
 s_cselect_b64 s[64:65], s[56:57], s[68:69]
 v_exp_f32 v65, v65
 v_mfma_f32_16x16x32_bf16 v[152:155], a[168:171], v[20:23], 0
 s_cselect_b64 s[66:67], s[58:59], s[68:69]
 v_exp_f32 v68, v68
 v_mfma_f32_16x16x32_bf16 v[124:127], a[172:175], v[16:19], 0
 s_lshl_b32 s37, s35, 19
 v_exp_f32 v69, v69
 v_exp_f32 v66, v66
 v_mfma_f32_16x16x32_bf16 v[156:159], a[172:175], v[20:23], 0
 s_add_u32 m0, s38, s50
 v_cvt_pk_bf16_f32 v24, v64, v65
 v_cvt_pk_bf16_f32 v25, v68, v69
 v_mfma_f32_16x16x32_bf16 v[128:131], a[176:179], v[16:19], 0
 s_add_u32 s37, s37, s45
 v_exp_f32 v67, v67
 v_mfma_f32_16x16x32_bf16 v[160:163], a[176:179], v[20:23], 0
 buffer_load_dwordx4 v1, s[20:23], s37 offen offset:0 sc1 lds
 buffer_load_dwordx4 v1, s[20:23], s37 offen offset:1024 sc1 lds
 v_exp_f32 v70, v70
 v_mfma_f32_16x16x32_bf16 v[132:135], a[180:183], v[16:19], 0
 buffer_load_dwordx4 v1, s[20:23], s37 offen offset:2048 sc1 lds
 v_exp_f32 v71, v71
 v_cvt_pk_bf16_f32 v26, v66, v67
 v_cvt_pk_bf16_f32 v27, v70, v71
 v_mfma_f32_16x16x32_bf16 v[164:167], a[180:183], v[20:23], 0
 buffer_load_dwordx4 v1, s[20:23], s37 offen offset:3072 sc1 lds
 v_cndmask_b32 v80, v4, v12, s[60:61]
 v_cndmask_b32 v81, v4, v12, s[62:63]
 v_mfma_f32_16x16x32_bf16 v[136:139], a[184:187], v[16:19], 0
 s_add_u32 s38, s38, 0x4000
 v_cndmask_b32 v82, v4, v12, s[64:65]
 v_cndmask_b32 v83, v4, v12, s[66:67]
 v_mfma_f32_16x16x32_bf16 v[168:171], a[184:187], v[20:23], 0
 s_and_b32 s38, s38, 0x1ffff
 v_cndmask_b32 v84, v4, v12, s[68:69]
 v_cndmask_b32 v85, v4, v12, s[68:69]
 v_mfma_f32_16x16x32_bf16 v[140:143], a[188:191], v[16:19], 0
 s_add_u32 s35, s35, 1
 v_cndmask_b32 v86, v4, v12, s[68:69]
 v_cndmask_b32 v87, v4, v12, s[68:69]
 v_cndmask_b32 v88, v4, v13, s[70:71]
 v_cndmask_b32 v89, v4, v13, s[70:71]
 v_mfma_f32_16x16x32_bf16 v[172:175], a[188:191], v[20:23], 0
 s_cmp_eq_u32 s35, s36
 v_cndmask_b32 v90, v4, v13, s[70:71]
 v_cndmask_b32 v91, v4, v13, s[70:71]
 v_mfma_f32_16x16x32_bf16 v[32:35], a[192:195], v[16:19], 0
 s_cselect_b32 s36, s47, s36
 v_cndmask_b32 v92, v4, v13, s[60:61]
 v_cndmask_b32 v93, v4, v13, s[62:63]
 v_mfma_f32_16x16x32_bf16 v[36:39], a[192:195], v[20:23], 0
 s_cselect_b32 s35, 0, s35
 v_cndmask_b32 v94, v4, v13, s[64:65]
 v_cndmask_b32 v95, v4, v13, s[66:67]
 s_cmp_eq_u32 s43, 0
 s_cbranch_scc1 Lamk_11
 s_sub_u32 s40, s43, 1
 .p2align 3
Lapl_10:
 s_waitcnt lgkmcnt(0)
 v_mfma_f32_16x16x32_bf16 v[48:51], a[128:131], a[0:3], v[80:83]
 v_exp_f32 v72, v72
 v_mfma_f32_16x16x32_bf16 v[56:59], a[128:131], a[16:19], v[88:91]
 v_exp_f32 v73, v73
 v_mfma_f32_16x16x32_bf16 v[52:55], a[132:135], a[0:3], v[84:87]
 v_mfma_f32_16x16x32_bf16 v[60:63], a[132:135], a[16:19], v[92:95]
 v_exp_f32 v76, v76
 v_mfma_f32_16x16x32_bf16 v[48:51], a[136:139], a[4:7], v[48:51]
 v_exp_f32 v77, v77
 v_mfma_f32_16x16x32_bf16 v[56:59], a[136:139], a[20:23], v[56:59]
 v_mfma_f32_16x16x32_bf16 v[52:55], a[140:143], a[4:7], v[52:55]
 v_exp_f32 v74, v74
 v_mfma_f32_16x16x32_bf16 v[60:63], a[140:143], a[20:23], v[60:63]
 v_cvt_pk_bf16_f32 v28, v72, v73
 v_cvt_pk_bf16_f32 v29, v76, v77
 v_mfma_f32_16x16x32_bf16 v[48:51], a[144:147], a[8:11], v[48:51]
 v_mfma_f32_16x16x32_bf16 v[56:59], a[144:147], a[24:27], v[56:59]
 v_exp_f32 v75, v75
 v_mfma_f32_16x16x32_bf16 v[52:55], a[148:151], a[8:11], v[52:55]
 v_exp_f32 v78, v78
 v_mfma_f32_16x16x32_bf16 v[60:63], a[148:151], a[24:27], v[60:63]
 v_mfma_f32_16x16x32_bf16 v[48:51], a[152:155], a[12:15], v[48:51]
 v_exp_f32 v79, v79
 v_mfma_f32_16x16x32_bf16 v[56:59], a[152:155], a[28:31], v[56:59]
 v_cvt_pk_bf16_f32 v30, v74, v75
 v_cvt_pk_bf16_f32 v31, v78, v79
 v_mfma_f32_16x16x32_bf16 v[52:55], a[156:159], a[12:15], v[52:55]
 v_mfma_f32_16x16x32_bf16 v[60:63], a[156:159], a[28:31], v[60:63]
 v_mfma_f32_16x16x32_bf16 v[176:179], a[160:163], v[24:27], v[176:179]
 v_mfma_f32_16x16x32_bf16 v[208:211], a[160:163], v[28:31], v[208:211]
 ds_read_b128 a[160:163], v3 offset:8192
 v_mfma_f32_16x16x32_bf16 v[180:183], a[164:167], v[24:27], v[180:183]
 v_mfma_f32_16x16x32_bf16 v[212:215], a[164:167], v[28:31], v[212:215]
 ds_read_b128 a[164:167], v3 offset:9216
 v_exp_f32 v48, v48
 v_mfma_f32_16x16x32_bf16 v[184:187], a[168:171], v[24:27], v[184:187]
 v_exp_f32 v49, v49
 v_mfma_f32_16x16x32_bf16 v[216:219], a[168:171], v[28:31], v[216:219]
 ds_read_b128 a[168:171], v3 offset:10240
 v_exp_f32 v52, v52
 v_mfma_f32_16x16x32_bf16 v[188:191], a[172:175], v[24:27], v[188:191]
 v_mfma_f32_16x16x32_bf16 v[220:223], a[172:175], v[28:31], v[220:223]
 ds_read_b128 a[172:175], v3 offset:11264
 v_exp_f32 v53, v53
 v_mfma_f32_16x16x32_bf16 v[192:195], a[176:179], v[24:27], v[192:195]
 v_exp_f32 v50, v50
 v_mfma_f32_16x16x32_bf16 v[224:227], a[176:179], v[28:31], v[224:227]
 ds_read_b128 a[176:179], v3 offset:12288
 v_mfma_f32_16x16x32_bf16 v[196:199], a[180:183], v[24:27], v[196:199]
 v_cvt_pk_bf16_f32 v16, v48, v49
 v_cvt_pk_bf16_f32 v17, v52, v53
 v_mfma_f32_16x16x32_bf16 v[228:231], a[180:183], v[28:31], v[228:231]
 ds_read_b128 a[180:183], v3 offset:13312
 v_exp_f32 v51, v51
 v_mfma_f32_16x16x32_bf16 v[200:203], a[184:187], v[24:27], v[200:203]
 v_exp_f32 v54, v54
 v_mfma_f32_16x16x32_bf16 v[232:235], a[184:187], v[28:31], v[232:235]
 ds_read_b128 a[184:187], v3 offset:14336
 v_mfma_f32_16x16x32_bf16 v[204:207], a[188:191], v[24:27], v[204:207]
 v_exp_f32 v55, v55
 v_mfma_f32_16x16x32_bf16 v[236:239], a[188:191], v[28:31], v[236:239]
 ds_read_b128 a[188:191], v3 offset:15360
 v_cvt_pk_bf16_f32 v18, v50, v51
 v_cvt_pk_bf16_f32 v19, v54, v55
 v_mfma_f32_16x16x32_bf16 v[40:43], a[192:195], v[24:27], v[40:43]
 v_mfma_f32_16x16x32_bf16 v[44:47], a[192:195], v[28:31], v[44:47]
 v_mfma_f32_16x16x32_bf16 v[64:67], a[128:131], a[32:35], v[96:99]
 s_waitcnt vmcnt(20)
 s_barrier
 v_exp_f32 v56, v56
 v_mfma_f32_16x16x32_bf16 v[72:75], a[128:131], a[48:51], v[104:107]
 ds_read_b128 a[128:131], v2 offset:0
 v_exp_f32 v57, v57
 v_mfma_f32_16x16x32_bf16 v[68:71], a[132:135], a[32:35], v[100:103]
 s_add_u32 s39, s39, 0x4000
 v_mfma_f32_16x16x32_bf16 v[76:79], a[132:135], a[48:51], v[108:111]
 ds_read_b128 a[132:135], v2 offset:1024
 v_exp_f32 v60, v60
 v_mfma_f32_16x16x32_bf16 v[64:67], a[136:139], a[36:39], v[64:67]
 v_exp_f32 v61, v61
 v_mfma_f32_16x16x32_bf16 v[72:75], a[136:139], a[52:55], v[72:75]
 ds_read_b128 a[136:139], v2 offset:2048
 v_mfma_f32_16x16x32_bf16 v[68:71], a[140:143], a[36:39], v[68:71]
 v_exp_f32 v58, v58
 v_mfma_f32_16x16x32_bf16 v[76:79], a[140:143], a[52:55], v[76:79]
 ds_read_b128 a[140:143], v2 offset:3072
 v_cvt_pk_bf16_f32 v20, v56, v57
 v_cvt_pk_bf16_f32 v21, v60, v61
 v_mfma_f32_16x16x32_bf16 v[64:67], a[144:147], a[40:43], v[64:67]
 s_and_b32 s39, s39, 0x1ffff
 v_mfma_f32_16x16x32_bf16 v[72:75], a[144:147], a[56:59], v[72:75]
 ds_read_b128 a[144:147], v2 offset:4096
 v_exp_f32 v59, v59
 v_mfma_f32_16x16x32_bf16 v[68:71], a[148:151], a[40:43], v[68:71]
 v_exp_f32 v62, v62
 v_mfma_f32_16x16x32_bf16 v[76:79], a[148:151], a[56:59], v[76:79]
 ds_read_b128 a[148:151], v2 offset:5120
 v_mfma_f32_16x16x32_bf16 v[64:67], a[152:155], a[44:47], v[64:67]
 v_exp_f32 v63, v63
 v_mfma_f32_16x16x32_bf16 v[72:75], a[152:155], a[60:63], v[72:75]
 ds_read_b128 a[152:155], v2 offset:6144
 v_cvt_pk_bf16_f32 v22, v58, v59
 v_cvt_pk_bf16_f32 v23, v62, v63
 v_mfma_f32_16x16x32_bf16 v[68:71], a[156:159], a[44:47], v[68:71]
 v_mfma_f32_16x16x32_bf16 v[76:79], a[156:159], a[60:63], v[76:79]
 ds_read_b128 a[156:159], v2 offset:7168
 s_waitcnt lgkmcnt(8)
 v_mfma_f32_16x16x32_bf16 v[112:115], a[160:163], v[16:19], v[112:115]
 s_lshl_b32 s37, s35, 19
 v_mov_b32 v3, v2
 v_add_u32 v2, s39, v1
 v_mfma_f32_16x16x32_bf16 v[144:147], a[160:163], v[20:23], v[144:147]
 s_add_u32 m0, s38, s50
 v_mfma_f32_16x16x32_bf16 v[116:119], a[164:167], v[16:19], v[116:119]
 s_add_u32 s37, s37, s45
 v_mfma_f32_16x16x32_bf16 v[148:151], a[164:167], v[20:23], v[148:151]
 buffer_load_dwordx4 v1, s[20:23], s37 offen offset:0 sc1 lds
 v_exp_f32 v64, v64
 v_mfma_f32_16x16x32_bf16 v[120:123], a[168:171], v[16:19], v[120:123]
 buffer_load_dwordx4 v1, s[20:23], s37 offen offset:1024 sc1 lds
 v_mfma_f32_16x16x32_bf16 v[152:155], a[168:171], v[20:23], v[152:155]
 v_exp_f32 v65, v65
 v_mfma_f32_16x16x32_bf16 v[124:127], a[172:175], v[16:19], v[124:127]
 buffer_load_dwordx4 v1, s[20:23], s37 offen offset:2048 sc1 lds
 v_exp_f32 v68, v68
 v_mfma_f32_16x16x32_bf16 v[156:159], a[172:175], v[20:23], v[156:159]
 buffer_load_dwordx4 v1, s[20:23], s37 offen offset:3072 sc1 lds
 v_exp_f32 v69, v69
 v_mfma_f32_16x16x32_bf16 v[128:131], a[176:179], v[16:19], v[128:131]
 s_add_u32 s38, s38, 0x4000
 v_mfma_f32_16x16x32_bf16 v[160:163], a[176:179], v[20:23], v[160:163]
 s_and_b32 s38, s38, 0x1ffff
 v_exp_f32 v66, v66
 v_mfma_f32_16x16x32_bf16 v[132:135], a[180:183], v[16:19], v[132:135]
 s_add_u32 s35, s35, 1
 v_cvt_pk_bf16_f32 v24, v64, v65
 v_cvt_pk_bf16_f32 v25, v68, v69
 v_mfma_f32_16x16x32_bf16 v[164:167], a[180:183], v[20:23], v[164:167]
 v_exp_f32 v67, v67
 v_mfma_f32_16x16x32_bf16 v[136:139], a[184:187], v[16:19], v[136:139]
 s_cmp_eq_u32 s35, s36
 v_mfma_f32_16x16x32_bf16 v[168:171], a[184:187], v[20:23], v[168:171]
 s_cselect_b32 s36, s47, s36
 v_exp_f32 v70, v70
 v_mfma_f32_16x16x32_bf16 v[140:143], a[188:191], v[16:19], v[140:143]
 s_cselect_b32 s35, 0, s35
 v_exp_f32 v71, v71
 v_mfma_f32_16x16x32_bf16 v[172:175], a[188:191], v[20:23], v[172:175]
 s_add_u32 s49, s49, 1
 v_cvt_pk_bf16_f32 v26, v66, v67
 v_cvt_pk_bf16_f32 v27, v70, v71
 v_mfma_f32_16x16x32_bf16 v[32:35], a[192:195], v[16:19], v[32:35]
 s_cmp_lt_u32 s49, s40
 v_mfma_f32_16x16x32_bf16 v[36:39], a[192:195], v[20:23], v[36:39]
 s_cbranch_scc1 Lapl_10
Lamk_11:
 s_add_u32 s40, s43, 4
 .p2align 3
Lamk_13:
 s_waitcnt lgkmcnt(0)
 v_mfma_f32_16x16x32_bf16 v[48:51], a[128:131], a[0:3], v[80:83]
 s_add_u32 s49, s49, 1
 v_exp_f32 v72, v72
 v_mfma_f32_16x16x32_bf16 v[56:59], a[128:131], a[16:19], v[88:91]
 s_cmp_lt_u32 s49, s41
 v_exp_f32 v73, v73
 v_mfma_f32_16x16x32_bf16 v[52:55], a[132:135], a[0:3], v[84:87]
 v_mfma_f32_16x16x32_bf16 v[60:63], a[132:135], a[16:19], v[92:95]
 s_cselect_b64 s[68:69], -1, 0
 v_exp_f32 v76, v76
 v_mfma_f32_16x16x32_bf16 v[48:51], a[136:139], a[4:7], v[48:51]
 s_cmp_le_u32 s49, s41
 v_exp_f32 v77, v77
 v_mfma_f32_16x16x32_bf16 v[56:59], a[136:139], a[20:23], v[56:59]
 v_mfma_f32_16x16x32_bf16 v[52:55], a[140:143], a[4:7], v[52:55]
 s_cselect_b64 s[70:71], -1, 0
 v_exp_f32 v74, v74
 v_mfma_f32_16x16x32_bf16 v[60:63], a[140:143], a[20:23], v[60:63]
 v_cvt_pk_bf16_f32 v28, v72, v73
 v_cvt_pk_bf16_f32 v29, v76, v77
 v_mfma_f32_16x16x32_bf16 v[48:51], a[144:147], a[8:11], v[48:51]
 s_cmp_eq_u32 s49, s41
 v_mfma_f32_16x16x32_bf16 v[56:59], a[144:147], a[24:27], v[56:59]
 s_cselect_b64 s[60:61], s[52:53], s[68:69]
 v_exp_f32 v75, v75
 v_mfma_f32_16x16x32_bf16 v[52:55], a[148:151], a[8:11], v[52:55]
 v_exp_f32 v78, v78
 v_mfma_f32_16x16x32_bf16 v[60:63], a[148:151], a[24:27], v[60:63]
 s_cselect_b64 s[62:63], s[54:55], s[68:69]
 v_mfma_f32_16x16x32_bf16 v[48:51], a[152:155], a[12:15], v[48:51]
 s_cselect_b64 s[64:65], s[56:57], s[68:69]
 v_exp_f32 v79, v79
 v_mfma_f32_16x16x32_bf16 v[56:59], a[152:155], a[28:31], v[56:59]
 v_cvt_pk_bf16_f32 v30, v74, v75
 v_cvt_pk_bf16_f32 v31, v78, v79
 v_mfma_f32_16x16x32_bf16 v[52:55], a[156:159], a[12:15], v[52:55]
 s_cselect_b64 s[66:67], s[58:59], s[68:69]
 v_mfma_f32_16x16x32_bf16 v[60:63], a[156:159], a[28:31], v[60:63]
 v_mfma_f32_16x16x32_bf16 v[176:179], a[160:163], v[24:27], v[176:179]
 v_mfma_f32_16x16x32_bf16 v[208:211], a[160:163], v[28:31], v[208:211]
 ds_read_b128 a[160:163], v3 offset:8192
 v_mfma_f32_16x16x32_bf16 v[180:183], a[164:167], v[24:27], v[180:183]
 v_mfma_f32_16x16x32_bf16 v[212:215], a[164:167], v[28:31], v[212:215]
 ds_read_b128 a[164:167], v3 offset:9216
 v_exp_f32 v48, v48
 v_mfma_f32_16x16x32_bf16 v[184:187], a[168:171], v[24:27], v[184:187]
 v_exp_f32 v49, v49
 v_mfma_f32_16x16x32_bf16 v[216:219], a[168:171], v[28:31], v[216:219]
 ds_read_b128 a[168:171], v3 offset:10240
 v_exp_f32 v52, v52
 v_mfma_f32_16x16x32_bf16 v[188:191], a[172:175], v[24:27], v[188:191]
 v_exp_f32 v53, v53
 v_mfma_f32_16x16x32_bf16 v[220:223], a[172:175], v[28:31], v[220:223]
 ds_read_b128 a[172:175], v3 offset:11264
 v_exp_f32 v50, v50
 v_mfma_f32_16x16x32_bf16 v[192:195], a[176:179], v[24:27], v[192:195]
 v_cvt_pk_bf16_f32 v16, v48, v49
 v_cvt_pk_bf16_f32 v17, v52, v53
 v_mfma_f32_16x16x32_bf16 v[224:227], a[176:179], v[28:31], v[224:227]
 ds_read_b128 a[176:179], v3 offset:12288
 v_exp_f32 v51, v51
 v_mfma_f32_16x16x32_bf16 v[196:199], a[180:183], v[24:27], v[196:199]
 v_exp_f32 v54, v54
 v_mfma_f32_16x16x32_bf16 v[228:231], a[180:183], v[28:31], v[228:231]
 ds_read_b128 a[180:183], v3 offset:13312
 v_exp_f32 v55, v55
 v_mfma_f32_16x16x32_bf16 v[200:203], a[184:187], v[24:27], v[200:203]
 v_cvt_pk_bf16_f32 v18, v50, v51
 v_cvt_pk_bf16_f32 v19, v54, v55
 v_mfma_f32_16x16x32_bf16 v[232:235], a[184:187], v[28:31], v[232:235]
 ds_read_b128 a[184:187], v3 offset:14336
 v_cndmask_b32 v80, v4, v12, s[60:61]
 v_cndmask_b32 v81, v4, v12, s[62:63]
 v_mfma_f32_16x16x32_bf16 v[204:207], a[188:191], v[24:27], v[204:207]
 v_cndmask_b32 v82, v4, v12, s[64:65]
 v_cndmask_b32 v83, v4, v12, s[66:67]
 v_mfma_f32_16x16x32_bf16 v[236:239], a[188:191], v[28:31], v[236:239]
 ds_read_b128 a[188:191], v3 offset:15360
 v_cndmask_b32 v84, v4, v12, s[68:69]
 v_cndmask_b32 v85, v4, v12, s[68:69]
 v_mfma_f32_16x16x32_bf16 v[40:43], a[192:195], v[24:27], v[40:43]
 v_cndmask_b32 v86, v4, v12, s[68:69]
 v_cndmask_b32 v87, v4, v12, s[68:69]
 v_mfma_f32_16x16x32_bf16 v[44:47], a[192:195], v[28:31], v[44:47]
 v_mfma_f32_16x16x32_bf16 v[64:67], a[128:131], a[32:35], v[96:99]
 s_waitcnt vmcnt(20)
 s_barrier
 v_exp_f32 v56, v56
 v_mfma_f32_16x16x32_bf16 v[72:75], a[128:131], a[48:51], v[104:107]
 ds_read_b128 a[128:131], v2 offset:0
 v_exp_f32 v57, v57
 v_mfma_f32_16x16x32_bf16 v[68:71], a[132:135], a[32:35], v[100:103]
 s_add_u32 s39, s39, 0x4000
 v_exp_f32 v60, v60
 v_mfma_f32_16x16x32_bf16 v[76:79], a[132:135], a[48:51], v[108:111]
 ds_read_b128 a[132:135], v2 offset:1024
 v_exp_f32 v61, v61
 v_mfma_f32_16x16x32_bf16 v[64:67], a[136:139], a[36:39], v[64:67]
 v_exp_f32 v58, v58
 v_mfma_f32_16x16x32_bf16 v[72:75], a[136:139], a[52:55], v[72:75]
 ds_read_b128 a[136:139], v2 offset:2048
 v_cvt_pk_bf16_f32 v20, v56, v57
 v_cvt_pk_bf16_f32 v21, v60, v61
 v_mfma_f32_16x16x32_bf16 v[68:71], a[140:143], a[36:39], v[68:71]
 v_exp_f32 v59, v59
 v_mfma_f32_16x16x32_bf16 v[76:79], a[140:143], a[52:55], v[76:79]
 ds_read_b128 a[140:143], v2 offset:3072
 v_exp_f32 v62, v62
 v_mfma_f32_16x16x32_bf16 v[64:67], a[144:147], a[40:43], v[64:67]
 s_and_b32 s39, s39, 0x1ffff
 v_exp_f32 v63, v63
 v_mfma_f32_16x16x32_bf16 v[72:75], a[144:147], a[56:59], v[72:75]
 ds_read_b128 a[144:147], v2 offset:4096
 v_cvt_pk_bf16_f32 v22, v58, v59
 v_cvt_pk_bf16_f32 v23, v62, v63
 v_mfma_f32_16x16x32_bf16 v[68:71], a[148:151], a[40:43], v[68:71]
 v_cndmask_b32 v88, v4, v13, s[70:71]
 v_cndmask_b32 v89, v4, v13, s[70:71]
 v_mfma_f32_16x16x32_bf16 v[76:79], a[148:151], a[56:59], v[76:79]
 ds_read_b128 a[148:151], v2 offset:5120
 v_cndmask_b32 v90, v4, v13, s[70:71]
 v_cndmask_b32 v91, v4, v13, s[70:71]
 v_mfma_f32_16x16x32_bf16 v[64:67], a[152:155], a[44:47], v[64:67]
 v_cndmask_b32 v92, v4, v13, s[60:61]
 v_cndmask_b32 v93, v4, v13, s[62:63]
 v_mfma_f32_16x16x32_bf16 v[72:75], a[152:155], a[60:63], v[72:75]
 ds_read_b128 a[152:155], v2 offset:6144
 v_cndmask_b32 v94, v4, v13, s[64:65]
 v_cndmask_b32 v95, v4, v13, s[66:67]
 v_mfma_f32_16x16x32_bf16 v[68:71], a[156:159], a[44:47], v[68:71]
 v_mfma_f32_16x16x32_bf16 v[76:79], a[156:159], a[60:63], v[76:79]
 ds_read_b128 a[156:159], v2 offset:7168
 s_waitcnt lgkmcnt(8)
 v_mfma_f32_16x16x32_bf16 v[112:115], a[160:163], v[16:19], v[112:115]
 s_lshl_b32 s37, s35, 19
 v_mov_b32 v3, v2
 v_add_u32 v2, s39, v1
 v_mfma_f32_16x16x32_bf16 v[144:147], a[160:163], v[20:23], v[144:147]
 s_add_u32 m0, s38, s50
 v_mfma_f32_16x16x32_bf16 v[116:119], a[164:167], v[16:19], v[116:119]
 s_add_u32 s37, s37, s45
 v_mfma_f32_16x16x32_bf16 v[148:151], a[164:167], v[20:23], v[148:151]
 buffer_load_dwordx4 v1, s[20:23], s37 offen offset:0 sc1 lds
 v_exp_f32 v64, v64
 v_mfma_f32_16x16x32_bf16 v[120:123], a[168:171], v[16:19], v[120:123]
 v_mfma_f32_16x16x32_bf16 v[152:155], a[168:171], v[20:23], v[152:155]
 buffer_load_dwordx4 v1, s[20:23], s37 offen offset:1024 sc1 lds
 v_exp_f32 v65, v65
 v_mfma_f32_16x16x32_bf16 v[124:127], a[172:175], v[16:19], v[124:127]
 buffer_load_dwordx4 v1, s[20:23], s37 offen offset:2048 sc1 lds
 v_exp_f32 v68, v68
 v_mfma_f32_16x16x32_bf16 v[156:159], a[172:175], v[20:23], v[156:159]
 buffer_load_dwordx4 v1, s[20:23], s37 offen offset:3072 sc1 lds
 v_exp_f32 v69, v69
 v_mfma_f32_16x16x32_bf16 v[128:131], a[176:179], v[16:19], v[128:131]
 v_mfma_f32_16x16x32_bf16 v[160:163], a[176:179], v[20:23], v[160:163]
 s_add_u32 s38, s38, 0x4000
 v_exp_f32 v66, v66
 v_mfma_f32_16x16x32_bf16 v[132:135], a[180:183], v[16:19], v[132:135]
 s_and_b32 s38, s38, 0x1ffff
 v_cvt_pk_bf16_f32 v24, v64, v65
 v_cvt_pk_bf16_f32 v25, v68, v69
 v_mfma_f32_16x16x32_bf16 v[164:167], a[180:183], v[20:23], v[164:167]
 s_add_u32 s35, s35, 1
 v_exp_f32 v67, v67
 v_mfma_f32_16x16x32_bf16 v[136:139], a[184:187], v[16:19], v[136:139]
 s_cmp_eq_u32 s35, s36
 v_mfma_f32_16x16x32_bf16 v[168:171], a[184:187], v[20:23], v[168:171]
 v_exp_f32 v70, v70
 v_mfma_f32_16x16x32_bf16 v[140:143], a[188:191], v[16:19], v[140:143]
 s_cselect_b32 s36, s47, s36
 v_exp_f32 v71, v71
 v_mfma_f32_16x16x32_bf16 v[172:175], a[188:191], v[20:23], v[172:175]
 s_cselect_b32 s35, 0, s35
 v_cvt_pk_bf16_f32 v26, v66, v67
 v_cvt_pk_bf16_f32 v27, v70, v71
 v_mfma_f32_16x16x32_bf16 v[32:35], a[192:195], v[16:19], v[32:35]
 s_cmp_lt_u32 s49, s40
 v_mfma_f32_16x16x32_bf16 v[36:39], a[192:195], v[20:23], v[36:39]
 s_cbranch_scc1 Lamk_13
 s_add_u32 s40, s43, 8
 s_cmp_lt_u32 s49, s42
 s_cselect_b64 s[68:69], -1, 0
 s_cmp_le_u32 s49, s42
 s_cselect_b64 s[70:71], -1, 0
 s_cmp_eq_u32 s49, s42
 s_cselect_b64 s[60:61], s[52:53], s[68:69]
 s_cselect_b64 s[62:63], s[54:55], s[68:69]
 s_cselect_b64 s[64:65], s[56:57], s[68:69]
 s_cselect_b64 s[66:67], s[58:59], s[68:69]
 v_mfma_f32_16x16x32_bf16 v[176:179], a[160:163], v[24:27], v[176:179]
 v_cndmask_b32 v96, v4, v14, s[60:61]
 v_cndmask_b32 v97, v4, v14, s[62:63]
 v_mfma_f32_16x16x32_bf16 v[180:183], a[164:167], v[24:27], v[180:183]
 v_cndmask_b32 v98, v4, v14, s[64:65]
 v_cndmask_b32 v99, v4, v14, s[66:67]
 v_mfma_f32_16x16x32_bf16 v[184:187], a[168:171], v[24:27], v[184:187]
 v_cndmask_b32 v100, v4, v14, s[68:69]
 v_cndmask_b32 v101, v4, v14, s[68:69]
 v_mfma_f32_16x16x32_bf16 v[188:191], a[172:175], v[24:27], v[188:191]
 v_exp_f32 v72, v72
 v_mfma_f32_16x16x32_bf16 v[192:195], a[176:179], v[24:27], v[192:195]
 v_exp_f32 v73, v73
 v_mfma_f32_16x16x32_bf16 v[196:199], a[180:183], v[24:27], v[196:199]
 v_exp_f32 v76, v76
 v_mfma_f32_16x16x32_bf16 v[200:203], a[184:187], v[24:27], v[200:203]
 v_exp_f32 v77, v77
 v_mfma_f32_16x16x32_bf16 v[204:207], a[188:191], v[24:27], v[204:207]
 v_exp_f32 v74, v74
 v_mfma_f32_16x16x32_bf16 v[40:43], a[192:195], v[24:27], v[40:43]
 v_cndmask_b32 v102, v4, v14, s[68:69]
 v_cndmask_b32 v103, v4, v14, s[68:69]
 s_nop 0
 .p2align 3
Lam1_12:
 s_waitcnt lgkmcnt(0)
 v_mfma_f32_16x16x32_bf16 v[64:67], a[128:131], a[32:35], v[96:99]
 v_cvt_pk_bf16_f32 v28, v72, v73
 v_cvt_pk_bf16_f32 v29, v76, v77
 v_mfma_f32_16x16x32_bf16 v[68:71], a[132:135], a[32:35], v[100:103]
 v_exp_f32 v75, v75
 v_mfma_f32_16x16x32_bf16 v[64:67], a[136:139], a[36:39], v[64:67]
 v_exp_f32 v78, v78
 v_mfma_f32_16x16x32_bf16 v[68:71], a[140:143], a[36:39], v[68:71]
 v_exp_f32 v79, v79
 v_mfma_f32_16x16x32_bf16 v[64:67], a[144:147], a[40:43], v[64:67]
 v_cvt_pk_bf16_f32 v30, v74, v75
 v_cvt_pk_bf16_f32 v31, v78, v79
 v_mfma_f32_16x16x32_bf16 v[68:71], a[148:151], a[40:43], v[68:71]
 v_cndmask_b32 v104, v4, v15, s[70:71]
 v_cndmask_b32 v105, v4, v15, s[70:71]
 v_mfma_f32_16x16x32_bf16 v[64:67], a[152:155], a[44:47], v[64:67]
 v_mfma_f32_16x16x32_bf16 v[68:71], a[156:159], a[44:47], v[68:71]
 v_mfma_f32_16x16x32_bf16 v[208:211], a[160:163], v[28:31], v[208:211]
 ds_read_b128 a[160:163], v3 offset:8192
 v_cndmask_b32 v106, v4, v15, s[70:71]
 v_cndmask_b32 v107, v4, v15, s[70:71]
 v_mfma_f32_16x16x32_bf16 v[212:215], a[164:167], v[28:31], v[212:215]
 ds_read_b128 a[164:167], v3 offset:9216
 v_cndmask_b32 v108, v4, v15, s[60:61]
 v_cndmask_b32 v109, v4, v15, s[62:63]
 v_mfma_f32_16x16x32_bf16 v[216:219], a[168:171], v[28:31], v[216:219]
 ds_read_b128 a[168:171], v3 offset:10240
 v_cndmask_b32 v110, v4, v15, s[64:65]
 v_cndmask_b32 v111, v4, v15, s[66:67]
 v_mfma_f32_16x16x32_bf16 v[220:223], a[172:175], v[28:31], v[220:223]
 ds_read_b128 a[172:175], v3 offset:11264
 v_exp_f32 v64, v64
 v_mfma_f32_16x16x32_bf16 v[224:227], a[176:179], v[28:31], v[224:227]
 ds_read_b128 a[176:179], v3 offset:12288
 v_exp_f32 v65, v65
 v_mfma_f32_16x16x32_bf16 v[228:231], a[180:183], v[28:31], v[228:231]
 ds_read_b128 a[180:183], v3 offset:13312
 v_exp_f32 v68, v68
 v_mfma_f32_16x16x32_bf16 v[232:235], a[184:187], v[28:31], v[232:235]
 ds_read_b128 a[184:187], v3 offset:14336
 v_exp_f32 v69, v69
 v_mfma_f32_16x16x32_bf16 v[236:239], a[188:191], v[28:31], v[236:239]
 ds_read_b128 a[188:191], v3 offset:15360
 v_exp_f32 v66, v66
 v_mfma_f32_16x16x32_bf16 v[44:47], a[192:195], v[28:31], v[44:47]
 v_mfma_f32_16x16x32_bf16 v[72:75], a[128:131], a[48:51], v[104:107]
 s_waitcnt vmcnt(20)
 s_barrier
 ds_read_b128 a[128:131], v2 offset:0
 s_add_u32 s39, s39, 0x4000
 v_cvt_pk_bf16_f32 v24, v64, v65
 v_cvt_pk_bf16_f32 v25, v68, v69
 v_mfma_f32_16x16x32_bf16 v[76:79], a[132:135], a[48:51], v[108:111]
 ds_read_b128 a[132:135], v2 offset:1024
 v_exp_f32 v67, v67
 v_mfma_f32_16x16x32_bf16 v[72:75], a[136:139], a[52:55], v[72:75]
 ds_read_b128 a[136:139], v2 offset:2048
 v_exp_f32 v70, v70
 v_mfma_f32_16x16x32_bf16 v[76:79], a[140:143], a[52:55], v[76:79]
 ds_read_b128 a[140:143], v2 offset:3072
 v_mfma_f32_16x16x32_bf16 v[72:75], a[144:147], a[56:59], v[72:75]
 ds_read_b128 a[144:147], v2 offset:4096
 s_and_b32 s39, s39, 0x1ffff
 v_exp_f32 v71, v71
 v_mfma_f32_16x16x32_bf16 v[76:79], a[148:151], a[56:59], v[76:79]
 ds_read_b128 a[148:151], v2 offset:5120
 v_cvt_pk_bf16_f32 v26, v66, v67
 v_cvt_pk_bf16_f32 v27, v70, v71
 v_mfma_f32_16x16x32_bf16 v[72:75], a[152:155], a[60:63], v[72:75]
 ds_read_b128 a[152:155], v2 offset:6144
 v_mfma_f32_16x16x32_bf16 v[76:79], a[156:159], a[60:63], v[76:79]
 ds_read_b128 a[156:159], v2 offset:7168
 s_waitcnt lgkmcnt(8)
 s_add_u32 s49, s49, 1
 s_cmp_lt_u32 s49, s42
 s_cselect_b64 s[68:69], -1, 0
 s_cmp_le_u32 s49, s42
 s_cselect_b64 s[70:71], -1, 0
 s_cmp_eq_u32 s49, s42
 s_cselect_b64 s[60:61], s[52:53], s[68:69]
 s_cselect_b64 s[62:63], s[54:55], s[68:69]
 s_cselect_b64 s[64:65], s[56:57], s[68:69]
 s_cselect_b64 s[66:67], s[58:59], s[68:69]
 v_mfma_f32_16x16x32_bf16 v[176:179], a[160:163], v[24:27], v[176:179]
 s_lshl_b32 s37, s35, 19
 s_add_u32 m0, s38, s50
 v_mov_b32 v3, v2
 v_add_u32 v2, s39, v1
 v_cndmask_b32 v96, v4, v14, s[60:61]
 v_cndmask_b32 v97, v4, v14, s[62:63]
 v_mfma_f32_16x16x32_bf16 v[180:183], a[164:167], v[24:27], v[180:183]
 s_add_u32 s37, s37, s45
 buffer_load_dwordx4 v1, s[20:23], s37 offen offset:0 sc1 lds
 v_cndmask_b32 v98, v4, v14, s[64:65]
 v_cndmask_b32 v99, v4, v14, s[66:67]
 v_mfma_f32_16x16x32_bf16 v[184:187], a[168:171], v[24:27], v[184:187]
 buffer_load_dwordx4 v1, s[20:23], s37 offen offset:1024 sc1 lds
 v_exp_f32 v72, v72
 v_mfma_f32_16x16x32_bf16 v[188:191], a[172:175], v[24:27], v[188:191]
 buffer_load_dwordx4 v1, s[20:23], s37 offen offset:2048 sc1 lds
 buffer_load_dwordx4 v1, s[20:23], s37 offen offset:3072 sc1 lds
 v_exp_f32 v73, v73
 v_mfma_f32_16x16x32_bf16 v[192:195], a[176:179], v[24:27], v[192:195]
 s_add_u32 s38, s38, 0x4000
 v_exp_f32 v76, v76
 v_mfma_f32_16x16x32_bf16 v[196:199], a[180:183], v[24:27], v[196:199]
 s_and_b32 s38, s38, 0x1ffff
 s_add_u32 s35, s35, 1
 v_exp_f32 v77, v77
 v_mfma_f32_16x16x32_bf16 v[200:203], a[184:187], v[24:27], v[200:203]
 s_cmp_eq_u32 s35, s36
 v_exp_f32 v74, v74
 v_mfma_f32_16x16x32_bf16 v[204:207], a[188:191], v[24:27], v[204:207]
 s_cselect_b32 s36, s47, s36
 s_cselect_b32 s35, 0, s35
 v_cndmask_b32 v100, v4, v14, s[68:69]
 v_cndmask_b32 v101, v4, v14, s[68:69]
 v_mfma_f32_16x16x32_bf16 v[40:43], a[192:195], v[24:27], v[40:43]
 s_cmp_lt_u32 s49, s40
 v_cndmask_b32 v102, v4, v14, s[68:69]
 v_cndmask_b32 v103, v4, v14, s[68:69]
 s_cbranch_scc1 Lam1_12
 v_cvt_pk_bf16_f32 v28, v72, v73
 v_cvt_pk_bf16_f32 v29, v76, v77
 v_exp_f32 v75, v75
 v_exp_f32 v78, v78
 v_exp_f32 v79, v79
 v_cvt_pk_bf16_f32 v30, v74, v75
 v_cvt_pk_bf16_f32 v31, v78, v79
 s_nop 1
 v_mfma_f32_16x16x32_bf16 v[44:47], a[192:195], v[28:31], v[44:47]
 v_mfma_f32_16x16x32_bf16 v[208:211], a[160:163], v[28:31], v[208:211]
 v_mfma_f32_16x16x32_bf16 v[212:215], a[164:167], v[28:31], v[212:215]
 v_mfma_f32_16x16x32_bf16 v[216:219], a[168:171], v[28:31], v[216:219]
 v_mfma_f32_16x16x32_bf16 v[220:223], a[172:175], v[28:31], v[220:223]
 v_mfma_f32_16x16x32_bf16 v[224:227], a[176:179], v[28:31], v[224:227]
 v_mfma_f32_16x16x32_bf16 v[228:231], a[180:183], v[28:31], v[228:231]
 v_mfma_f32_16x16x32_bf16 v[232:235], a[184:187], v[28:31], v[232:235]
 v_mfma_f32_16x16x32_bf16 v[236:239], a[188:191], v[28:31], v[236:239]
 v_cmp_ngt_f32 s[60:61], s73, v32
 v_cmp_nlt_f32 vcc, s74, v32
 s_or_b64 s[60:61], s[60:61], vcc
 v_cmp_ngt_f32 s[62:63], s73, v36
 v_cmp_nlt_f32 vcc, s74, v36
 s_or_b64 s[62:63], s[62:63], vcc
 v_cmp_ngt_f32 s[64:65], s73, v40
 v_cmp_nlt_f32 vcc, s74, v40
 s_or_b64 s[64:65], s[64:65], vcc
 v_cmp_ngt_f32 s[66:67], s73, v44
 v_cmp_nlt_f32 vcc, s74, v44
 s_or_b64 s[66:67], s[66:67], vcc
 s_or_b64 s[60:61], s[60:61], s[62:63]
 s_or_b64 s[64:65], s[64:65], s[66:67]
 s_or_b64 s[60:61], s[60:61], s[64:65]
 s_cbranch_scc1 Laslow_7
Laback_8:
 v_rcp_f32 v32, v32
 v_rcp_f32 v36, v36
 v_rcp_f32 v40, v40
 v_rcp_f32 v44, v44
 s_lshl_b32 s40, s41, 5
 s_add_u32 s40, s40, s32
 s_lshl_b32 s40, s40, 13
 s_add_u32 s40, s40, 0x6000000
 s_add_u32 s44, s40, 4096
 v_pk_mul_f32 v[112:113], v[112:113], v[32:33] op_sel_hi:[1,0]
 v_pk_mul_f32 v[114:115], v[114:115], v[32:33] op_sel_hi:[1,0]
 v_pk_mul_f32 v[116:117], v[116:117], v[32:33] op_sel_hi:[1,0]
 v_pk_mul_f32 v[118:119], v[118:119], v[32:33] op_sel_hi:[1,0]
 v_cvt_pk_bf16_f32 v240, v112, v113
 v_cvt_pk_bf16_f32 v241, v116, v117
 v_cvt_pk_bf16_f32 v242, v114, v115
 v_cvt_pk_bf16_f32 v243, v118, v119
 buffer_store_dwordx4 v[240:243], v1, s[20:23], s40 offen offset:0 sc1
 v_pk_mul_f32 v[120:121], v[120:121], v[32:33] op_sel_hi:[1,0]
 v_pk_mul_f32 v[122:123], v[122:123], v[32:33] op_sel_hi:[1,0]
 v_pk_mul_f32 v[124:125], v[124:125], v[32:33] op_sel_hi:[1,0]
 v_pk_mul_f32 v[126:127], v[126:127], v[32:33] op_sel_hi:[1,0]
 v_cvt_pk_bf16_f32 v244, v120, v121
 v_cvt_pk_bf16_f32 v245, v124, v125
 v_cvt_pk_bf16_f32 v246, v122, v123
 v_cvt_pk_bf16_f32 v247, v126, v127
 buffer_store_dwordx4 v[244:247], v1, s[20:23], s40 offen offset:2048 sc1
 v_pk_mul_f32 v[128:129], v[128:129], v[32:33] op_sel_hi:[1,0]
 v_pk_mul_f32 v[130:131], v[130:131], v[32:33] op_sel_hi:[1,0]
 v_pk_mul_f32 v[132:133], v[132:133], v[32:33] op_sel_hi:[1,0]
 v_pk_mul_f32 v[134:135], v[134:135], v[32:33] op_sel_hi:[1,0]
 v_cvt_pk_bf16_f32 v248, v128, v129
 v_cvt_pk_bf16_f32 v249, v132, v133
 v_cvt_pk_bf16_f32 v250, v130, v131
 v_cvt_pk_bf16_f32 v251, v134, v135
 buffer_store_dwordx4 v[248:251], v1, s[20:23], s44 offen offset:0 sc1
 v_pk_mul_f32 v[136:137], v[136:137], v[32:33] op_sel_hi:[1,0]
 v_pk_mul_f32 v[138:139], v[138:139], v[32:33] op_sel_hi:[1,0]
 v_pk_mul_f32 v[140:141], v[140:141], v[32:33] op_sel_hi:[1,0]
 v_pk_mul_f32 v[142:143], v[142:143], v[32:33] op_sel_hi:[1,0]
 v_cvt_pk_bf16_f32 v252, v136, v137
 v_cvt_pk_bf16_f32 v253, v140, v141
 v_cvt_pk_bf16_f32 v254, v138, v139
 v_cvt_pk_bf16_f32 v255, v142, v143
 buffer_store_dwordx4 v[252:255], v1, s[20:23], s44 offen offset:2048 sc1
 v_pk_mul_f32 v[144:145], v[144:145], v[36:37] op_sel_hi:[1,0]
 v_pk_mul_f32 v[146:147], v[146:147], v[36:37] op_sel_hi:[1,0]
 v_pk_mul_f32 v[148:149], v[148:149], v[36:37] op_sel_hi:[1,0]
 v_pk_mul_f32 v[150:151], v[150:151], v[36:37] op_sel_hi:[1,0]
 v_cvt_pk_bf16_f32 v240, v144, v145
 v_cvt_pk_bf16_f32 v241, v148, v149
 v_cvt_pk_bf16_f32 v242, v146, v147
 v_cvt_pk_bf16_f32 v243, v150, v151
 buffer_store_dwordx4 v[240:243], v1, s[20:23], s40 offen offset:1024 sc1
 v_pk_mul_f32 v[152:153], v[152:153], v[36:37] op_sel_hi:[1,0]
 v_pk_mul_f32 v[154:155], v[154:155], v[36:37] op_sel_hi:[1,0]
 v_pk_mul_f32 v[156:157], v[156:157], v[36:37] op_sel_hi:[1,0]
 v_pk_mul_f32 v[158:159], v[158:159], v[36:37] op_sel_hi:[1,0]
 v_cvt_pk_bf16_f32 v244, v152, v153
 v_cvt_pk_bf16_f32 v245, v156, v157
 v_cvt_pk_bf16_f32 v246, v154, v155
 v_cvt_pk_bf16_f32 v247, v158, v159
 buffer_store_dwordx4 v[244:247], v1, s[20:23], s40 offen offset:3072 sc1
 v_pk_mul_f32 v[160:161], v[160:161], v[36:37] op_sel_hi:[1,0]
 v_pk_mul_f32 v[162:163], v[162:163], v[36:37] op_sel_hi:[1,0]
 v_pk_mul_f32 v[164:165], v[164:165], v[36:37] op_sel_hi:[1,0]
 v_pk_mul_f32 v[166:167], v[166:167], v[36:37] op_sel_hi:[1,0]
 v_cvt_pk_bf16_f32 v248, v160, v161
 v_cvt_pk_bf16_f32 v249, v164, v165
 v_cvt_pk_bf16_f32 v250, v162, v163
 v_cvt_pk_bf16_f32 v251, v166, v167
 buffer_store_dwordx4 v[248:251], v1, s[20:23], s44 offen offset:1024 sc1
 v_pk_mul_f32 v[168:169], v[168:169], v[36:37] op_sel_hi:[1,0]
 v_pk_mul_f32 v[170:171], v[170:171], v[36:37] op_sel_hi:[1,0]
 v_pk_mul_f32 v[172:173], v[172:173], v[36:37] op_sel_hi:[1,0]
 v_pk_mul_f32 v[174:175], v[174:175], v[36:37] op_sel_hi:[1,0]
 v_cvt_pk_bf16_f32 v252, v168, v169
 v_cvt_pk_bf16_f32 v253, v172, v173
 v_cvt_pk_bf16_f32 v254, v170, v171
 v_cvt_pk_bf16_f32 v255, v174, v175
 buffer_store_dwordx4 v[252:255], v1, s[20:23], s44 offen offset:3072 sc1
 s_lshl_b32 s40, s42, 5
 s_add_u32 s40, s40, s32
 s_lshl_b32 s40, s40, 13
 s_add_u32 s40, s40, 0x6000000
 s_add_u32 s44, s40, 4096
 v_pk_mul_f32 v[176:177], v[176:177], v[40:41] op_sel_hi:[1,0]
 v_pk_mul_f32 v[178:179], v[178:179], v[40:41] op_sel_hi:[1,0]
 v_pk_mul_f32 v[180:181], v[180:181], v[40:41] op_sel_hi:[1,0]
 v_pk_mul_f32 v[182:183], v[182:183], v[40:41] op_sel_hi:[1,0]
 v_cvt_pk_bf16_f32 v240, v176, v177
 v_cvt_pk_bf16_f32 v241, v180, v181
 v_cvt_pk_bf16_f32 v242, v178, v179
 v_cvt_pk_bf16_f32 v243, v182, v183
 buffer_store_dwordx4 v[240:243], v1, s[20:23], s40 offen offset:0 sc1
 v_pk_mul_f32 v[184:185], v[184:185], v[40:41] op_sel_hi:[1,0]
 v_pk_mul_f32 v[186:187], v[186:187], v[40:41] op_sel_hi:[1,0]
 v_pk_mul_f32 v[188:189], v[188:189], v[40:41] op_sel_hi:[1,0]
 v_pk_mul_f32 v[190:191], v[190:191], v[40:41] op_sel_hi:[1,0]
 v_cvt_pk_bf16_f32 v244, v184, v185
 v_cvt_pk_bf16_f32 v245, v188, v189
 v_cvt_pk_bf16_f32 v246, v186, v187
 v_cvt_pk_bf16_f32 v247, v190, v191
 buffer_store_dwordx4 v[244:247], v1, s[20:23], s40 offen offset:2048 sc1
 v_pk_mul_f32 v[192:193], v[192:193], v[40:41] op_sel_hi:[1,0]
 v_pk_mul_f32 v[194:195], v[194:195], v[40:41] op_sel_hi:[1,0]
 v_pk_mul_f32 v[196:197], v[196:197], v[40:41] op_sel_hi:[1,0]
 v_pk_mul_f32 v[198:199], v[198:199], v[40:41] op_sel_hi:[1,0]
 v_cvt_pk_bf16_f32 v248, v192, v193
 v_cvt_pk_bf16_f32 v249, v196, v197
 v_cvt_pk_bf16_f32 v250, v194, v195
 v_cvt_pk_bf16_f32 v251, v198, v199
 buffer_store_dwordx4 v[248:251], v1, s[20:23], s44 offen offset:0 sc1
 v_pk_mul_f32 v[200:201], v[200:201], v[40:41] op_sel_hi:[1,0]
 v_pk_mul_f32 v[202:203], v[202:203], v[40:41] op_sel_hi:[1,0]
 v_pk_mul_f32 v[204:205], v[204:205], v[40:41] op_sel_hi:[1,0]
 v_pk_mul_f32 v[206:207], v[206:207], v[40:41] op_sel_hi:[1,0]
 v_cvt_pk_bf16_f32 v252, v200, v201
 v_cvt_pk_bf16_f32 v253, v204, v205
 v_cvt_pk_bf16_f32 v254, v202, v203
 v_cvt_pk_bf16_f32 v255, v206, v207
 buffer_store_dwordx4 v[252:255], v1, s[20:23], s44 offen offset:2048 sc1
 v_pk_mul_f32 v[208:209], v[208:209], v[44:45] op_sel_hi:[1,0]
 v_pk_mul_f32 v[210:211], v[210:211], v[44:45] op_sel_hi:[1,0]
 v_pk_mul_f32 v[212:213], v[212:213], v[44:45] op_sel_hi:[1,0]
 v_pk_mul_f32 v[214:215], v[214:215], v[44:45] op_sel_hi:[1,0]
 v_cvt_pk_bf16_f32 v240, v208, v209
 v_cvt_pk_bf16_f32 v241, v212, v213
 v_cvt_pk_bf16_f32 v242, v210, v211
 v_cvt_pk_bf16_f32 v243, v214, v215
 buffer_store_dwordx4 v[240:243], v1, s[20:23], s40 offen offset:1024 sc1
 v_pk_mul_f32 v[216:217], v[216:217], v[44:45] op_sel_hi:[1,0]
 v_pk_mul_f32 v[218:219], v[218:219], v[44:45] op_sel_hi:[1,0]
 v_pk_mul_f32 v[220:221], v[220:221], v[44:45] op_sel_hi:[1,0]
 v_pk_mul_f32 v[222:223], v[222:223], v[44:45] op_sel_hi:[1,0]
 v_cvt_pk_bf16_f32 v244, v216, v217
 v_cvt_pk_bf16_f32 v245, v220, v221
 v_cvt_pk_bf16_f32 v246, v218, v219
 v_cvt_pk_bf16_f32 v247, v222, v223
 buffer_store_dwordx4 v[244:247], v1, s[20:23], s40 offen offset:3072 sc1
 v_pk_mul_f32 v[224:225], v[224:225], v[44:45] op_sel_hi:[1,0]
 v_pk_mul_f32 v[226:227], v[226:227], v[44:45] op_sel_hi:[1,0]
 v_pk_mul_f32 v[228:229], v[228:229], v[44:45] op_sel_hi:[1,0]
 v_pk_mul_f32 v[230:231], v[230:231], v[44:45] op_sel_hi:[1,0]
 v_cvt_pk_bf16_f32 v248, v224, v225
 v_cvt_pk_bf16_f32 v249, v228, v229
 v_cvt_pk_bf16_f32 v250, v226, v227
 v_cvt_pk_bf16_f32 v251, v230, v231
 buffer_store_dwordx4 v[248:251], v1, s[20:23], s44 offen offset:1024 sc1
 v_pk_mul_f32 v[232:233], v[232:233], v[44:45] op_sel_hi:[1,0]
 v_pk_mul_f32 v[234:235], v[234:235], v[44:45] op_sel_hi:[1,0]
 v_pk_mul_f32 v[236:237], v[236:237], v[44:45] op_sel_hi:[1,0]
 v_pk_mul_f32 v[238:239], v[238:239], v[44:45] op_sel_hi:[1,0]
 v_cvt_pk_bf16_f32 v252, v232, v233
 v_cvt_pk_bf16_f32 v253, v236, v237
 v_cvt_pk_bf16_f32 v254, v234, v235
 v_cvt_pk_bf16_f32 v255, v238, v239
 buffer_store_dwordx4 v[252:255], v1, s[20:23], s44 offen offset:3072 sc1
 s_lshl_b32 s72, s33, 5
 s_add_u32 s72, s72, s32
 s_lshl_b32 s72, s72, 2
 s_add_u32 s72, s72, 0x3c00
 s_cmp_eq_u32 s46, 1
 s_cbranch_scc1 Ladone_9
 s_mov_b32 s46, 1
 s_mov_b32 s33, s34
 v_accvgpr_mov_b32 a0, a64
 v_accvgpr_mov_b32 a1, a65
 v_accvgpr_mov_b32 a2, a66
 v_accvgpr_mov_b32 a3, a67
 v_accvgpr_mov_b32 a4, a68
 v_accvgpr_mov_b32 a5, a69
 v_accvgpr_mov_b32 a6, a70
 v_accvgpr_mov_b32 a7, a71
 v_accvgpr_mov_b32 a8, a72
 v_accvgpr_mov_b32 a9, a73
 v_accvgpr_mov_b32 a10, a74
 v_accvgpr_mov_b32 a11, a75
 v_accvgpr_mov_b32 a12, a76
 v_accvgpr_mov_b32 a13, a77
 v_accvgpr_mov_b32 a14, a78
 v_accvgpr_mov_b32 a15, a79
 v_accvgpr_mov_b32 a16, a80
 v_accvgpr_mov_b32 a17, a81
 v_accvgpr_mov_b32 a18, a82
 v_accvgpr_mov_b32 a19, a83
 v_accvgpr_mov_b32 a20, a84
 v_accvgpr_mov_b32 a21, a85
 v_accvgpr_mov_b32 a22, a86
 v_accvgpr_mov_b32 a23, a87
 v_accvgpr_mov_b32 a24, a88
 v_accvgpr_mov_b32 a25, a89
 v_accvgpr_mov_b32 a26, a90
 v_accvgpr_mov_b32 a27, a91
 v_accvgpr_mov_b32 a28, a92
 v_accvgpr_mov_b32 a29, a93
 v_accvgpr_mov_b32 a30, a94
 v_accvgpr_mov_b32 a31, a95
 v_accvgpr_mov_b32 a32, a96
 v_accvgpr_mov_b32 a33, a97
 v_accvgpr_mov_b32 a34, a98
 v_accvgpr_mov_b32 a35, a99
 v_accvgpr_mov_b32 a36, a100
 v_accvgpr_mov_b32 a37, a101
 v_accvgpr_mov_b32 a38, a102
 v_accvgpr_mov_b32 a39, a103
 v_accvgpr_mov_b32 a40, a104
 v_accvgpr_mov_b32 a41, a105
 v_accvgpr_mov_b32 a42, a106
 v_accvgpr_mov_b32 a43, a107
 v_accvgpr_mov_b32 a44, a108
 v_accvgpr_mov_b32 a45, a109
 v_accvgpr_mov_b32 a46, a110
 v_accvgpr_mov_b32 a47, a111
 v_accvgpr_mov_b32 a48, a112
 v_accvgpr_mov_b32 a49, a113
 v_accvgpr_mov_b32 a50, a114
 v_accvgpr_mov_b32 a51, a115
 v_accvgpr_mov_b32 a52, a116
 v_accvgpr_mov_b32 a53, a117
 v_accvgpr_mov_b32 a54, a118
 v_accvgpr_mov_b32 a55, a119
 v_accvgpr_mov_b32 a56, a120
 v_accvgpr_mov_b32 a57, a121
 v_accvgpr_mov_b32 a58, a122
 v_accvgpr_mov_b32 a59, a123
 v_accvgpr_mov_b32 a60, a124
 v_accvgpr_mov_b32 a61, a125
 v_accvgpr_mov_b32 a62, a126
 v_accvgpr_mov_b32 a63, a127
 s_branch Lablk_6
Laslow_7:
 s_waitcnt vmcnt(0) lgkmcnt(0)
 v_mov_b32 v12, 0
 v_mov_b32 v240, v4
 v_mov_b32 v13, 0
 v_mov_b32 v241, v4
 v_mov_b32 v14, 0
 v_mov_b32 v242, v4
 v_mov_b32 v15, 0
 v_mov_b32 v243, v4
 s_mov_b32 s49, 0
Lsl_14:
 s_lshl_b32 s37, s49, 19
 s_add_u32 s37, s37, s45
 s_sub_u32 s37, s37, s50
 s_add_u32 s44, s37, 0
 buffer_load_dwordx4 a[128:131], v1, s[20:23], s44 offen offset:0 sc1
 buffer_load_dwordx4 a[132:135], v1, s[20:23], s44 offen offset:1024 sc1
 buffer_load_dwordx4 a[136:139], v1, s[20:23], s44 offen offset:2048 sc1
 buffer_load_dwordx4 a[140:143], v1, s[20:23], s44 offen offset:3072 sc1
 s_add_u32 s44, s37, 4096
 buffer_load_dwordx4 a[144:147], v1, s[20:23], s44 offen offset:0 sc1
 buffer_load_dwordx4 a[148:151], v1, s[20:23], s44 offen offset:1024 sc1
 buffer_load_dwordx4 a[152:155], v1, s[20:23], s44 offen offset:2048 sc1
 buffer_load_dwordx4 a[156:159], v1, s[20:23], s44 offen offset:3072 sc1
 s_cmp_lt_u32 s49, s41
 s_cselect_b64 s[68:69], -1, 0
 s_cmp_le_u32 s49, s41
 s_cselect_b64 s[70:71], -1, 0
 s_cmp_eq_u32 s49, s41
 s_cselect_b64 s[60:61], s[52:53], s[68:69]
 s_cselect_b64 s[62:63], s[54:55], s[68:69]
 s_cselect_b64 s[64:65], s[56:57], s[68:69]
 s_cselect_b64 s[66:67], s[58:59], s[68:69]
 v_cndmask_b32 v80, v4, v12, s[60:61]
 v_cndmask_b32 v81, v4, v12, s[62:63]
 v_cndmask_b32 v82, v4, v12, s[64:65]
 v_cndmask_b32 v83, v4, v12, s[66:67]
 v_cndmask_b32 v84, v4, v12, s[68:69]
 v_cndmask_b32 v85, v4, v12, s[68:69]
 v_cndmask_b32 v86, v4, v12, s[68:69]
 v_cndmask_b32 v87, v4, v12, s[68:69]
 v_cndmask_b32 v88, v4, v13, s[70:71]
 v_cndmask_b32 v89, v4, v13, s[70:71]
 v_cndmask_b32 v90, v4, v13, s[70:71]
 v_cndmask_b32 v91, v4, v13, s[70:71]
 v_cndmask_b32 v92, v4, v13, s[60:61]
 v_cndmask_b32 v93, v4, v13, s[62:63]
 v_cndmask_b32 v94, v4, v13, s[64:65]
 v_cndmask_b32 v95, v4, v13, s[66:67]
 s_cmp_lt_u32 s49, s42
 s_cselect_b64 s[68:69], -1, 0
 s_cmp_le_u32 s49, s42
 s_cselect_b64 s[70:71], -1, 0
 s_cmp_eq_u32 s49, s42
 s_cselect_b64 s[60:61], s[52:53], s[68:69]
 s_cselect_b64 s[62:63], s[54:55], s[68:69]
 s_cselect_b64 s[64:65], s[56:57], s[68:69]
 s_cselect_b64 s[66:67], s[58:59], s[68:69]
 v_cndmask_b32 v96, v4, v14, s[60:61]
 v_cndmask_b32 v97, v4, v14, s[62:63]
 v_cndmask_b32 v98, v4, v14, s[64:65]
 v_cndmask_b32 v99, v4, v14, s[66:67]
 v_cndmask_b32 v100, v4, v14, s[68:69]
 v_cndmask_b32 v101, v4, v14, s[68:69]
 v_cndmask_b32 v102, v4, v14, s[68:69]
 v_cndmask_b32 v103, v4, v14, s[68:69]
 v_cndmask_b32 v104, v4, v15, s[70:71]
 v_cndmask_b32 v105, v4, v15, s[70:71]
 v_cndmask_b32 v106, v4, v15, s[70:71]
 v_cndmask_b32 v107, v4, v15, s[70:71]
 v_cndmask_b32 v108, v4, v15, s[60:61]
 v_cndmask_b32 v109, v4, v15, s[62:63]
 v_cndmask_b32 v110, v4, v15, s[64:65]
 v_cndmask_b32 v111, v4, v15, s[66:67]
 s_waitcnt vmcnt(0)
 s_nop 0
 v_mfma_f32_16x16x32_bf16 v[48:51], a[128:131], a[0:3], v[80:83]
 v_mfma_f32_16x16x32_bf16 v[56:59], a[128:131], a[16:19], v[88:91]
 v_mfma_f32_16x16x32_bf16 v[64:67], a[128:131], a[32:35], v[96:99]
 v_mfma_f32_16x16x32_bf16 v[72:75], a[128:131], a[48:51], v[104:107]
 v_mfma_f32_16x16x32_bf16 v[52:55], a[132:135], a[0:3], v[84:87]
 v_mfma_f32_16x16x32_bf16 v[60:63], a[132:135], a[16:19], v[92:95]
 v_mfma_f32_16x16x32_bf16 v[68:71], a[132:135], a[32:35], v[100:103]
 v_mfma_f32_16x16x32_bf16 v[76:79], a[132:135], a[48:51], v[108:111]
 v_mfma_f32_16x16x32_bf16 v[48:51], a[136:139], a[4:7], v[48:51]
 v_mfma_f32_16x16x32_bf16 v[56:59], a[136:139], a[20:23], v[56:59]
 v_mfma_f32_16x16x32_bf16 v[64:67], a[136:139], a[36:39], v[64:67]
 v_mfma_f32_16x16x32_bf16 v[72:75], a[136:139], a[52:55], v[72:75]
 v_mfma_f32_16x16x32_bf16 v[52:55], a[140:143], a[4:7], v[52:55]
 v_mfma_f32_16x16x32_bf16 v[60:63], a[140:143], a[20:23], v[60:63]
 v_mfma_f32_16x16x32_bf16 v[68:71], a[140:143], a[36:39], v[68:71]
 v_mfma_f32_16x16x32_bf16 v[76:79], a[140:143], a[52:55], v[76:79]
 v_mfma_f32_16x16x32_bf16 v[48:51], a[144:147], a[8:11], v[48:51]
 v_mfma_f32_16x16x32_bf16 v[56:59], a[144:147], a[24:27], v[56:59]
 v_mfma_f32_16x16x32_bf16 v[64:67], a[144:147], a[40:43], v[64:67]
 v_mfma_f32_16x16x32_bf16 v[72:75], a[144:147], a[56:59], v[72:75]
 v_mfma_f32_16x16x32_bf16 v[52:55], a[148:151], a[8:11], v[52:55]
 v_mfma_f32_16x16x32_bf16 v[60:63], a[148:151], a[24:27], v[60:63]
 v_mfma_f32_16x16x32_bf16 v[68:71], a[148:151], a[40:43], v[68:71]
 v_mfma_f32_16x16x32_bf16 v[76:79], a[148:151], a[56:59], v[76:79]
 v_mfma_f32_16x16x32_bf16 v[48:51], a[152:155], a[12:15], v[48:51]
 v_mfma_f32_16x16x32_bf16 v[56:59], a[152:155], a[28:31], v[56:59]
 v_mfma_f32_16x16x32_bf16 v[64:67], a[152:155], a[44:47], v[64:67]
 v_mfma_f32_16x16x32_bf16 v[72:75], a[152:155], a[60:63], v[72:75]
 v_mfma_f32_16x16x32_bf16 v[52:55], a[156:159], a[12:15], v[52:55]
 v_mfma_f32_16x16x32_bf16 v[60:63], a[156:159], a[28:31], v[60:63]
 v_mfma_f32_16x16x32_bf16 v[68:71], a[156:159], a[44:47], v[68:71]
 v_mfma_f32_16x16x32_bf16 v[76:79], a[156:159], a[60:63], v[76:79]
 s_nop 7
 v_max3_f32 v240, v240, v48, v49
 v_max3_f32 v240, v240, v50, v51
 v_max3_f32 v240, v240, v52, v53
 v_max3_f32 v240, v240, v54, v55
 v_max3_f32 v241, v241, v56, v57
 v_max3_f32 v241, v241, v58, v59
 v_max3_f32 v241, v241, v60, v61
 v_max3_f32 v241, v241, v62, v63
 v_max3_f32 v242, v242, v64, v65
 v_max3_f32 v242, v242, v66, v67
 v_max3_f32 v242, v242, v68, v69
 v_max3_f32 v242, v242, v70, v71
 v_max3_f32 v243, v243, v72, v73
 v_max3_f32 v243, v243, v74, v75
 v_max3_f32 v243, v243, v76, v77
 v_max3_f32 v243, v243, v78, v79
 s_add_u32 s49, s49, 1
 s_cmp_le_u32 s49, s42
 s_cbranch_scc1 Lsl_14
 v_mov_b32 v244, v240
 v_mov_b32 v245, v241
 v_mov_b32 v246, v242
 v_mov_b32 v247, v243
 v_permlane16_swap_b32 v240, v244
 v_permlane16_swap_b32 v241, v245
 v_permlane16_swap_b32 v242, v246
 v_permlane16_swap_b32 v243, v247
 v_max_f32 v240, v240, v244
 v_max_f32 v241, v241, v245
 v_max_f32 v242, v242, v246
 v_max_f32 v243, v243, v247
 v_mov_b32 v244, v240
 v_mov_b32 v245, v241
 v_mov_b32 v246, v242
 v_mov_b32 v247, v243
 v_permlane32_swap_b32 v240, v244
 v_permlane32_swap_b32 v241, v245
 v_permlane32_swap_b32 v242, v246
 v_permlane32_swap_b32 v243, v247
 v_max_f32 v240, v240, v244
 v_max_f32 v241, v241, v245
 v_max_f32 v242, v242, v246
 v_max_f32 v243, v243, v247
 v_sub_f32 v12, 0, v240
 v_sub_f32 v13, 0, v241
 v_sub_f32 v14, 0, v242
 v_sub_f32 v15, 0, v243
 v_mov_b64 v[112:113], 0
 v_mov_b64 v[114:115], 0
 v_mov_b64 v[116:117], 0
 v_mov_b64 v[118:119], 0
 v_mov_b64 v[120:121], 0
 v_mov_b64 v[122:123], 0
 v_mov_b64 v[124:125], 0
 v_mov_b64 v[126:127], 0
 v_mov_b64 v[128:129], 0
 v_mov_b64 v[130:131], 0
 v_mov_b64 v[132:133], 0
 v_mov_b64 v[134:135], 0
 v_mov_b64 v[136:137], 0
 v_mov_b64 v[138:139], 0
 v_mov_b64 v[140:141], 0
 v_mov_b64 v[142:143], 0
 v_mov_b64 v[144:145], 0
 v_mov_b64 v[146:147], 0
 v_mov_b64 v[148:149], 0
 v_mov_b64 v[150:151], 0
 v_mov_b64 v[152:153], 0
 v_mov_b64 v[154:155], 0
 v_mov_b64 v[156:157], 0
 v_mov_b64 v[158:159], 0
 v_mov_b64 v[160:161], 0
 v_mov_b64 v[162:163], 0
 v_mov_b64 v[164:165], 0
 v_mov_b64 v[166:167], 0
 v_mov_b64 v[168:169], 0
 v_mov_b64 v[170:171], 0
 v_mov_b64 v[172:173], 0
 v_mov_b64 v[174:175], 0
 v_mov_b64 v[176:177], 0
 v_mov_b64 v[178:179], 0
 v_mov_b64 v[180:181], 0
 v_mov_b64 v[182:183], 0
 v_mov_b64 v[184:185], 0
 v_mov_b64 v[186:187], 0
 v_mov_b64 v[188:189], 0
 v_mov_b64 v[190:191], 0
 v_mov_b64 v[192:193], 0
 v_mov_b64 v[194:195], 0
 v_mov_b64 v[196:197], 0
 v_mov_b64 v[198:199], 0
 v_mov_b64 v[200:201], 0
 v_mov_b64 v[202:203], 0
 v_mov_b64 v[204:205], 0
 v_mov_b64 v[206:207], 0
 v_mov_b64 v[208:209], 0
 v_mov_b64 v[210:211], 0
 v_mov_b64 v[212:213], 0
 v_mov_b64 v[214:215], 0
 v_mov_b64 v[216:217], 0
 v_mov_b64 v[218:219], 0
 v_mov_b64 v[220:221], 0
 v_mov_b64 v[222:223], 0
 v_mov_b64 v[224:225], 0
 v_mov_b64 v[226:227], 0
 v_mov_b64 v[228:229], 0
 v_mov_b64 v[230:231], 0
 v_mov_b64 v[232:233], 0
 v_mov_b64 v[234:235], 0
 v_mov_b64 v[236:237], 0
 v_mov_b64 v[238:239], 0
 v_mov_b64 v[32:33], 0
 v_mov_b64 v[34:35], 0
 v_mov_b64 v[36:37], 0
 v_mov_b64 v[38:39], 0
 v_mov_b64 v[40:41], 0
 v_mov_b64 v[42:43], 0
 v_mov_b64 v[44:45], 0
 v_mov_b64 v[46:47], 0
 s_mov_b32 s49, 0
Lsl_15:
 s_lshl_b32 s37, s49, 19
 s_add_u32 s37, s37, s45
 s_sub_u32 s37, s37, s50
 s_add_u32 s44, s37, 0
 buffer_load_dwordx4 a[128:131], v1, s[20:23], s44 offen offset:0 sc1
 buffer_load_dwordx4 a[132:135], v1, s[20:23], s44 offen offset:1024 sc1
 buffer_load_dwordx4 a[136:139], v1, s[20:23], s44 offen offset:2048 sc1
 buffer_load_dwordx4 a[140:143], v1, s[20:23], s44 offen offset:3072 sc1
 s_add_u32 s44, s37, 4096
 buffer_load_dwordx4 a[144:147], v1, s[20:23], s44 offen offset:0 sc1
 buffer_load_dwordx4 a[148:151], v1, s[20:23], s44 offen offset:1024 sc1
 buffer_load_dwordx4 a[152:155], v1, s[20:23], s44 offen offset:2048 sc1
 buffer_load_dwordx4 a[156:159], v1, s[20:23], s44 offen offset:3072 sc1
 s_add_u32 s44, s37, 8192
 buffer_load_dwordx4 a[160:163], v1, s[20:23], s44 offen offset:0 sc1
 buffer_load_dwordx4 a[164:167], v1, s[20:23], s44 offen offset:1024 sc1
 buffer_load_dwordx4 a[168:171], v1, s[20:23], s44 offen offset:2048 sc1
 buffer_load_dwordx4 a[172:175], v1, s[20:23], s44 offen offset:3072 sc1
 s_add_u32 s44, s37, 12288
 buffer_load_dwordx4 a[176:179], v1, s[20:23], s44 offen offset:0 sc1
 buffer_load_dwordx4 a[180:183], v1, s[20:23], s44 offen offset:1024 sc1
 buffer_load_dwordx4 a[184:187], v1, s[20:23], s44 offen offset:2048 sc1
 buffer_load_dwordx4 a[188:191], v1, s[20:23], s44 offen offset:3072 sc1
 s_cmp_lt_u32 s49, s41
 s_cselect_b64 s[68:69], -1, 0
 s_cmp_le_u32 s49, s41
 s_cselect_b64 s[70:71], -1, 0
 s_cmp_eq_u32 s49, s41
 s_cselect_b64 s[60:61], s[52:53], s[68:69]
 s_cselect_b64 s[62:63], s[54:55], s[68:69]
 s_cselect_b64 s[64:65], s[56:57], s[68:69]
 s_cselect_b64 s[66:67], s[58:59], s[68:69]
 v_cndmask_b32 v80, v4, v12, s[60:61]
 v_cndmask_b32 v81, v4, v12, s[62:63]
 v_cndmask_b32 v82, v4, v12, s[64:65]
 v_cndmask_b32 v83, v4, v12, s[66:67]
 v_cndmask_b32 v84, v4, v12, s[68:69]
 v_cndmask_b32 v85, v4, v12, s[68:69]
 v_cndmask_b32 v86, v4, v12, s[68:69]
 v_cndmask_b32 v87, v4, v12, s[68:69]
 v_cndmask_b32 v88, v4, v13, s[70:71]
 v_cndmask_b32 v89, v4, v13, s[70:71]
 v_cndmask_b32 v90, v4, v13, s[70:71]
 v_cndmask_b32 v91, v4, v13, s[70:71]
 v_cndmask_b32 v92, v4, v13, s[60:61]
 v_cndmask_b32 v93, v4, v13, s[62:63]
 v_cndmask_b32 v94, v4, v13, s[64:65]
 v_cndmask_b32 v95, v4, v13, s[66:67]
 s_cmp_lt_u32 s49, s42
 s_cselect_b64 s[68:69], -1, 0
 s_cmp_le_u32 s49, s42
 s_cselect_b64 s[70:71], -1, 0
 s_cmp_eq_u32 s49, s42
 s_cselect_b64 s[60:61], s[52:53], s[68:69]
 s_cselect_b64 s[62:63], s[54:55], s[68:69]
 s_cselect_b64 s[64:65], s[56:57], s[68:69]
 s_cselect_b64 s[66:67], s[58:59], s[68:69]
 v_cndmask_b32 v96, v4, v14, s[60:61]
 v_cndmask_b32 v97, v4, v14, s[62:63]
 v_cndmask_b32 v98, v4, v14, s[64:65]
 v_cndmask_b32 v99, v4, v14, s[66:67]
 v_cndmask_b32 v100, v4, v14, s[68:69]
 v_cndmask_b32 v101, v4, v14, s[68:69]
 v_cndmask_b32 v102, v4, v14, s[68:69]
 v_cndmask_b32 v103, v4, v14, s[68:69]
 v_cndmask_b32 v104, v4, v15, s[70:71]
 v_cndmask_b32 v105, v4, v15, s[70:71]
 v_cndmask_b32 v106, v4, v15, s[70:71]
 v_cndmask_b32 v107, v4, v15, s[70:71]
 v_cndmask_b32 v108, v4, v15, s[60:61]
 v_cndmask_b32 v109, v4, v15, s[62:63]
 v_cndmask_b32 v110, v4, v15, s[64:65]
 v_cndmask_b32 v111, v4, v15, s[66:67]
 s_waitcnt vmcnt(0)
 s_nop 0
 v_mfma_f32_16x16x32_bf16 v[48:51], a[128:131], a[0:3], v[80:83]
 v_mfma_f32_16x16x32_bf16 v[56:59], a[128:131], a[16:19], v[88:91]
 v_mfma_f32_16x16x32_bf16 v[64:67], a[128:131], a[32:35], v[96:99]
 v_mfma_f32_16x16x32_bf16 v[72:75], a[128:131], a[48:51], v[104:107]
 v_mfma_f32_16x16x32_bf16 v[52:55], a[132:135], a[0:3], v[84:87]
 v_mfma_f32_16x16x32_bf16 v[60:63], a[132:135], a[16:19], v[92:95]
 v_mfma_f32_16x16x32_bf16 v[68:71], a[132:135], a[32:35], v[100:103]
 v_mfma_f32_16x16x32_bf16 v[76:79], a[132:135], a[48:51], v[108:111]
 v_mfma_f32_16x16x32_bf16 v[48:51], a[136:139], a[4:7], v[48:51]
 v_mfma_f32_16x16x32_bf16 v[56:59], a[136:139], a[20:23], v[56:59]
 v_mfma_f32_16x16x32_bf16 v[64:67], a[136:139], a[36:39], v[64:67]
 v_mfma_f32_16x16x32_bf16 v[72:75], a[136:139], a[52:55], v[72:75]
 v_mfma_f32_16x16x32_bf16 v[52:55], a[140:143], a[4:7], v[52:55]
 v_mfma_f32_16x16x32_bf16 v[60:63], a[140:143], a[20:23], v[60:63]
 v_mfma_f32_16x16x32_bf16 v[68:71], a[140:143], a[36:39], v[68:71]
 v_mfma_f32_16x16x32_bf16 v[76:79], a[140:143], a[52:55], v[76:79]
 v_mfma_f32_16x16x32_bf16 v[48:51], a[144:147], a[8:11], v[48:51]
 v_mfma_f32_16x16x32_bf16 v[56:59], a[144:147], a[24:27], v[56:59]
 v_mfma_f32_16x16x32_bf16 v[64:67], a[144:147], a[40:43], v[64:67]
 v_mfma_f32_16x16x32_bf16 v[72:75], a[144:147], a[56:59], v[72:75]
 v_mfma_f32_16x16x32_bf16 v[52:55], a[148:151], a[8:11], v[52:55]
 v_mfma_f32_16x16x32_bf16 v[60:63], a[148:151], a[24:27], v[60:63]
 v_mfma_f32_16x16x32_bf16 v[68:71], a[148:151], a[40:43], v[68:71]
 v_mfma_f32_16x16x32_bf16 v[76:79], a[148:151], a[56:59], v[76:79]
 v_mfma_f32_16x16x32_bf16 v[48:51], a[152:155], a[12:15], v[48:51]
 v_mfma_f32_16x16x32_bf16 v[56:59], a[152:155], a[28:31], v[56:59]
 v_mfma_f32_16x16x32_bf16 v[64:67], a[152:155], a[44:47], v[64:67]
 v_mfma_f32_16x16x32_bf16 v[72:75], a[152:155], a[60:63], v[72:75]
 v_mfma_f32_16x16x32_bf16 v[52:55], a[156:159], a[12:15], v[52:55]
 v_mfma_f32_16x16x32_bf16 v[60:63], a[156:159], a[28:31], v[60:63]
 v_mfma_f32_16x16x32_bf16 v[68:71], a[156:159], a[44:47], v[68:71]
 v_mfma_f32_16x16x32_bf16 v[76:79], a[156:159], a[60:63], v[76:79]
 s_nop 7
 v_exp_f32 v48, v48
 v_exp_f32 v49, v49
 v_exp_f32 v52, v52
 v_exp_f32 v53, v53
 v_exp_f32 v50, v50
 v_cvt_pk_bf16_f32 v16, v48, v49
 v_cvt_pk_bf16_f32 v17, v52, v53
 v_exp_f32 v51, v51
 v_exp_f32 v54, v54
 v_exp_f32 v55, v55
 v_cvt_pk_bf16_f32 v18, v50, v51
 v_cvt_pk_bf16_f32 v19, v54, v55
 v_exp_f32 v56, v56
 v_exp_f32 v57, v57
 v_exp_f32 v60, v60
 v_exp_f32 v61, v61
 v_exp_f32 v58, v58
 v_cvt_pk_bf16_f32 v20, v56, v57
 v_cvt_pk_bf16_f32 v21, v60, v61
 v_exp_f32 v59, v59
 v_exp_f32 v62, v62
 v_exp_f32 v63, v63
 v_cvt_pk_bf16_f32 v22, v58, v59
 v_cvt_pk_bf16_f32 v23, v62, v63
 v_exp_f32 v64, v64
 v_exp_f32 v65, v65
 v_exp_f32 v68, v68
 v_exp_f32 v69, v69
 v_exp_f32 v66, v66
 v_cvt_pk_bf16_f32 v24, v64, v65
 v_cvt_pk_bf16_f32 v25, v68, v69
 v_exp_f32 v67, v67
 v_exp_f32 v70, v70
 v_exp_f32 v71, v71
 v_cvt_pk_bf16_f32 v26, v66, v67
 v_cvt_pk_bf16_f32 v27, v70, v71
 v_exp_f32 v72, v72
 v_exp_f32 v73, v73
 v_exp_f32 v76, v76
 v_exp_f32 v77, v77
 v_exp_f32 v74, v74
 v_cvt_pk_bf16_f32 v28, v72, v73
 v_cvt_pk_bf16_f32 v29, v76, v77
 v_exp_f32 v75, v75
 v_exp_f32 v78, v78
 v_exp_f32 v79, v79
 v_cvt_pk_bf16_f32 v30, v74, v75
 v_cvt_pk_bf16_f32 v31, v78, v79
 s_nop 1
 v_mfma_f32_16x16x32_bf16 v[112:115], a[160:163], v[16:19], v[112:115]
 v_mfma_f32_16x16x32_bf16 v[144:147], a[160:163], v[20:23], v[144:147]
 v_mfma_f32_16x16x32_bf16 v[176:179], a[160:163], v[24:27], v[176:179]
 v_mfma_f32_16x16x32_bf16 v[208:211], a[160:163], v[28:31], v[208:211]
 v_mfma_f32_16x16x32_bf16 v[116:119], a[164:167], v[16:19], v[116:119]
 v_mfma_f32_16x16x32_bf16 v[148:151], a[164:167], v[20:23], v[148:151]
 v_mfma_f32_16x16x32_bf16 v[180:183], a[164:167], v[24:27], v[180:183]
 v_mfma_f32_16x16x32_bf16 v[212:215], a[164:167], v[28:31], v[212:215]
 v_mfma_f32_16x16x32_bf16 v[120:123], a[168:171], v[16:19], v[120:123]
 v_mfma_f32_16x16x32_bf16 v[152:155], a[168:171], v[20:23], v[152:155]
 v_mfma_f32_16x16x32_bf16 v[184:187], a[168:171], v[24:27], v[184:187]
 v_mfma_f32_16x16x32_bf16 v[216:219], a[168:171], v[28:31], v[216:219]
 v_mfma_f32_16x16x32_bf16 v[124:127], a[172:175], v[16:19], v[124:127]
 v_mfma_f32_16x16x32_bf16 v[156:159], a[172:175], v[20:23], v[156:159]
 v_mfma_f32_16x16x32_bf16 v[188:191], a[172:175], v[24:27], v[188:191]
 v_mfma_f32_16x16x32_bf16 v[220:223], a[172:175], v[28:31], v[220:223]
 v_mfma_f32_16x16x32_bf16 v[128:131], a[176:179], v[16:19], v[128:131]
 v_mfma_f32_16x16x32_bf16 v[160:163], a[176:179], v[20:23], v[160:163]
 v_mfma_f32_16x16x32_bf16 v[192:195], a[176:179], v[24:27], v[192:195]
 v_mfma_f32_16x16x32_bf16 v[224:227], a[176:179], v[28:31], v[224:227]
 v_mfma_f32_16x16x32_bf16 v[132:135], a[180:183], v[16:19], v[132:135]
 v_mfma_f32_16x16x32_bf16 v[164:167], a[180:183], v[20:23], v[164:167]
 v_mfma_f32_16x16x32_bf16 v[196:199], a[180:183], v[24:27], v[196:199]
 v_mfma_f32_16x16x32_bf16 v[228:231], a[180:183], v[28:31], v[228:231]
 v_mfma_f32_16x16x32_bf16 v[136:139], a[184:187], v[16:19], v[136:139]
 v_mfma_f32_16x16x32_bf16 v[168:171], a[184:187], v[20:23], v[168:171]
 v_mfma_f32_16x16x32_bf16 v[200:203], a[184:187], v[24:27], v[200:203]
 v_mfma_f32_16x16x32_bf16 v[232:235], a[184:187], v[28:31], v[232:235]
 v_mfma_f32_16x16x32_bf16 v[140:143], a[188:191], v[16:19], v[140:143]
 v_mfma_f32_16x16x32_bf16 v[172:175], a[188:191], v[20:23], v[172:175]
 v_mfma_f32_16x16x32_bf16 v[204:207], a[188:191], v[24:27], v[204:207]
 v_mfma_f32_16x16x32_bf16 v[236:239], a[188:191], v[28:31], v[236:239]
 v_mfma_f32_16x16x32_bf16 v[32:35], a[192:195], v[16:19], v[32:35]
 v_mfma_f32_16x16x32_bf16 v[36:39], a[192:195], v[20:23], v[36:39]
 v_mfma_f32_16x16x32_bf16 v[40:43], a[192:195], v[24:27], v[40:43]
 v_mfma_f32_16x16x32_bf16 v[44:47], a[192:195], v[28:31], v[44:47]
 s_add_u32 s49, s49, 1
 s_cmp_le_u32 s49, s42
 s_cbranch_scc1 Lsl_15
 ds_read_b128 a[128:131], v3 offset:0
 ds_read_b128 a[132:135], v3 offset:1024
 ds_read_b128 a[136:139], v3 offset:2048
 ds_read_b128 a[140:143], v3 offset:3072
 ds_read_b128 a[144:147], v3 offset:4096
 ds_read_b128 a[148:151], v3 offset:5120
 ds_read_b128 a[152:155], v3 offset:6144
 ds_read_b128 a[156:159], v3 offset:7168
 s_branch Laback_8
Ladone_9:
 s_waitcnt vmcnt(0) lgkmcnt(0)
 s_barrier
 v_mov_b32 v6, 1
 buffer_store_dword v6, v5, s[20:23], s72 offen sc1
 s_cmp_ge_u32 s6, 27
 s_cbranch_scc1 Lfin
 s_load_dwordx2 s[8:9], s[0:1], 40
 s_mov_b32 s10, 0x480000
 s_mov_b32 s11, 0x20000
 s_mul_i32 s7, s6, 29
 s_lshr_b32 s7, s7, 8
 s_mul_i32 s94, s7, 9
 s_sub_u32 s32, s6, s94
 s_mul_i32 s40, s7, 3
 s_lshl_b32 s7, s7, 2
 s_add_u32 s7, s7, s5
 s_sub_u32 s33, s7, 4
 s_mov_b32 s34, 12
 s_cmp_lt_u32 s33, 4
 s_cselect_b32 s35, 6, 5
 s_mov_b32 s36, 0x6000000
 s_mov_b32 s37, 0
 s_lshl_b32 s38, s4, 5
 s_add_u32 s38, s38, 0x3c00
 s_mov_b32 s39, 0
 s_mov_b32 s93, 0x38
 s_mov_b32 s92, 7
 s_mov_b32 s91, 4
 s_mov_b32 s90, 31
 s_branch Los
Lpb:
 s_load_dwordx2 s[8:9], s[0:1], 48
 s_mov_b32 s10, 0x240000
 s_mov_b32 s11, 0x20000
 s_load_dwordx2 s[12:13], s[0:1], 72
 s_mov_b32 s14, 0x480000
 s_mov_b32 s15, 0x20000
 s_load_dwordx2 s[16:17], s[0:1], 80
 s_mov_b32 s18, 0x480000
 s_mov_b32 s19, 0x20000
 s_lshl_b32 s32, s6, 8
 s_mov_b32 s33, s32
 s_lshl_b32 s34, s6, 14
 s_add_u32 s34, s34, 0x3000000
 s_add_u32 s35, s34, 8192
 s_mov_b32 s36, 64
 s_mov_b32 s37, 0
 s_lshl_b32 s7, s6, 7
 s_add_u32 s7, s7, 0x0
 v_min_u32 v1, 1, v0
 v_lshlrev_b32 v1, 28, v1
 v_add_u32 v13, s7, v1
 s_waitcnt lgkmcnt(0)
 v_and_b32 v1, 63, v0
 v_lshrrev_b32 v2, 3, v0
 v_mul_u32_u24 v10, 1152, v2
 v_lshrrev_b32 v2, 4, v0
 v_xor_b32 v2, v2, v0
 v_and_b32 v2, 7, v2
 v_lshl_add_u32 v10, v2, 4, v10
 v_lshrrev_b32 v2, 4, v1
 v_bfe_u32 v3, v1, 1, 3
 v_xor_b32 v2, v2, v3
 v_and_b32 v3, 15, v1
 v_lshlrev_b32 v3, 7, v3
 v_lshl_add_u32 v4, v2, 4, v3
 v_xor_b32 v5, 64, v4
 v_lshrrev_b32 v2, 4, v0
 v_lshlrev_b32 v11, 13, v2
 v_lshrrev_b32 v2, 7, v0
 v_lshrrev_b32 v3, 4, v1
 v_lshl_add_u32 v3, v2, 2, v3
 v_bfe_u32 v2, v1, 1, 3
 v_xor_b32 v2, v2, v3
 v_lshl_add_u32 v11, v2, 5, v11
 v_and_b32 v2, 1, v1
 v_lshl_add_u32 v11, v2, 4, v11
 v_bfe_u32 v2, v1, 2, 3
 v_xor_b32 v3, s4, v2
 v_lshlrev_b32 v3, 5, v3
 v_and_b32 v2, 3, v2
 v_lshl_add_u32 v3, v2, 8, v3
 v_lshrrev_b32 v2, 4, v1
 v_lshl_add_u32 v3, v2, 11, v3
 v_and_b32 v2, 3, v1
 v_lshl_add_u32 v3, v2, 3, v3
 v_add_u32 v8, 73728, v3
 v_xor_b32 v3, 0x80, v3
 v_add_u32 v9, 73728, v3
 s_lshl_b32 s45, s4, 11
 v_lshl_add_u32 v12, v1, 4, s45
 s_mov_b32 s39, s37
 s_add_u32 s40, s39, 1
 s_lshl_b32 s49, s4, 10
 s_mul_i32 s46, s39, 36864
 s_add_u32 m0, s49, 0
 s_nop 0
 buffer_load_dwordx4 v10, s[8:11], s46 offen offset:0  lds
 s_add_u32 m0, s49, 3968
 s_nop 0
 buffer_load_dwordx4 v10, s[8:11], s46 offen offset:128  lds
 s_add_u32 m0, s49, 7936
 s_nop 0
 buffer_load_dwordx4 v10, s[8:11], s46 offen offset:256  lds
 s_add_u32 m0, s49, 11904
 s_nop 0
 buffer_load_dwordx4 v10, s[8:11], s46 offen offset:384  lds
 s_add_u32 m0, s49, 15872
 s_nop 0
 buffer_load_dwordx4 v10, s[8:11], s46 offen offset:512  lds
 s_add_u32 m0, s49, 19840
 s_nop 0
 buffer_load_dwordx4 v10, s[8:11], s46 offen offset:640  lds
 s_add_u32 m0, s49, 23808
 s_nop 0
 buffer_load_dwordx4 v10, s[8:11], s46 offen offset:768  lds
 s_add_u32 m0, s49, 27776
 s_nop 0
 buffer_load_dwordx4 v10, s[8:11], s46 offen offset:896  lds
 s_add_u32 m0, s49, 31744
 s_nop 0
 buffer_load_dwordx4 v10, s[8:11], s46 offen offset:1024  lds
 s_lshl_b32 s49, s4, 10
 s_add_u32 s49, s49, 36864
 s_mul_i32 s46, s40, 36864
 s_add_u32 m0, s49, 0
 s_nop 0
 buffer_load_dwordx4 v10, s[8:11], s46 offen offset:0  lds
 s_add_u32 m0, s49, 3968
 s_nop 0
 buffer_load_dwordx4 v10, s[8:11], s46 offen offset:128  lds
 s_add_u32 m0, s49, 7936
 s_nop 0
 buffer_load_dwordx4 v10, s[8:11], s46 offen offset:256  lds
 s_add_u32 m0, s49, 11904
 s_nop 0
 buffer_load_dwordx4 v10, s[8:11], s46 offen offset:384  lds
 s_add_u32 m0, s49, 15872
 s_nop 0
 buffer_load_dwordx4 v10, s[8:11], s46 offen offset:512  lds
 s_add_u32 m0, s49, 19840
 s_nop 0
 buffer_load_dwordx4 v10, s[8:11], s46 offen offset:640  lds
 s_add_u32 m0, s49, 23808
 s_nop 0
 buffer_load_dwordx4 v10, s[8:11], s46 offen offset:768  lds
 s_add_u32 m0, s49, 27776
 s_nop 0
 buffer_load_dwordx4 v10, s[8:11], s46 offen offset:896  lds
 s_add_u32 m0, s49, 31744
 s_nop 0
 buffer_load_dwordx4 v10, s[8:11], s46 offen offset:1024  lds
 s_lshl_b32 s49, s4, 10
 s_add_u32 m0, s49, 73728
 s_add_u32 s45, s32, 0
 buffer_load_dwordx4 v11, s[12:15], s45 offen  lds
 s_add_u32 m0, s49, 77824
 s_add_u32 s45, s32, 131072
 buffer_load_dwordx4 v11, s[12:15], s45 offen  lds
 s_add_u32 m0, s49, 81920
 s_add_u32 s45, s33, 0
 buffer_load_dwordx4 v11, s[16:19], s45 offen  lds
 s_add_u32 m0, s49, 86016
 s_add_u32 s45, s33, 131072
 buffer_load_dwordx4 v11, s[16:19], s45 offen  lds
 s_add_u32 m0, s49, 90112
 s_add_u32 s45, s32, 262144
 buffer_load_dwordx4 v11, s[12:15], s45 offen  lds
 s_add_u32 m0, s49, 94208
 s_add_u32 s45, s32, 393216
 buffer_load_dwordx4 v11, s[12:15], s45 offen  lds
 s_add_u32 m0, s49, 98304
 s_add_u32 s45, s33, 262144
 buffer_load_dwordx4 v11, s[16:19], s45 offen  lds
 s_add_u32 m0, s49, 102400
 s_add_u32 s45, s33, 393216
 buffer_load_dwordx4 v11, s[16:19], s45 offen  lds
 s_add_u32 m0, s49, 106496
 s_add_u32 s45, s32, 524288
 buffer_load_dwordx4 v11, s[12:15], s45 offen  lds
 s_add_u32 m0, s49, 110592
 s_add_u32 s45, s32, 655360
 buffer_load_dwordx4 v11, s[12:15], s45 offen  lds
 s_add_u32 m0, s49, 114688
 s_add_u32 s45, s33, 524288
 buffer_load_dwordx4 v11, s[16:19], s45 offen  lds
 s_add_u32 m0, s49, 118784
 s_add_u32 s45, s33, 655360
 buffer_load_dwordx4 v11, s[16:19], s45 offen  lds
 s_waitcnt vmcnt(8) lgkmcnt(0)
 s_barrier
 s_add_u32 m0, s49, 122880
 s_add_u32 s45, s32, 786432
 buffer_load_dwordx4 v11, s[12:15], s45 offen  lds
 s_add_u32 m0, s49, 126976
 s_add_u32 s45, s32, 917504
 buffer_load_dwordx4 v11, s[12:15], s45 offen  lds
 s_add_u32 m0, s49, 131072
 s_add_u32 s45, s33, 786432
 buffer_load_dwordx4 v11, s[16:19], s45 offen  lds
 s_add_u32 m0, s49, 135168
 s_add_u32 s45, s33, 917504
 buffer_load_dwordx4 v11, s[16:19], s45 offen  lds
 ds_read_b64_tr_b16 a[0:1], v8 offset:0
 ds_read_b64_tr_b16 a[2:3], v8 offset:1024
 ds_read_b64_tr_b16 a[72:73], v9 offset:0
 ds_read_b64_tr_b16 a[74:75], v9 offset:1024
 ds_read_b64_tr_b16 a[144:145], v8 offset:8192
 ds_read_b64_tr_b16 a[146:147], v8 offset:9216
 ds_read_b64_tr_b16 a[216:217], v9 offset:8192
 ds_read_b64_tr_b16 a[218:219], v9 offset:9216
 s_waitcnt vmcnt(8) lgkmcnt(0)
 s_barrier
 s_add_u32 m0, s49, 73728
 s_add_u32 s45, s32, 1048576
 buffer_load_dwordx4 v11, s[12:15], s45 offen  lds
 s_add_u32 m0, s49, 77824
 s_add_u32 s45, s32, 1179648
 buffer_load_dwordx4 v11, s[12:15], s45 offen  lds
 s_add_u32 m0, s49, 81920
 s_add_u32 s45, s33, 1048576
 buffer_load_dwordx4 v11, s[16:19], s45 offen  lds
 s_add_u32 m0, s49, 86016
 s_add_u32 s45, s33, 1179648
 buffer_load_dwordx4 v11, s[16:19], s45 offen  lds
 ds_read_b64_tr_b16 a[4:5], v8 offset:16384
 ds_read_b64_tr_b16 a[6:7], v8 offset:17408
 ds_read_b64_tr_b16 a[76:77], v9 offset:16384
 ds_read_b64_tr_b16 a[78:79], v9 offset:17408
 ds_read_b64_tr_b16 a[148:149], v8 offset:24576
 ds_read_b64_tr_b16 a[150:151], v8 offset:25600
 ds_read_b64_tr_b16 a[220:221], v9 offset:24576
 ds_read_b64_tr_b16 a[222:223], v9 offset:25600
 s_waitcnt vmcnt(8) lgkmcnt(0)
 s_barrier
 s_add_u32 m0, s49, 90112
 s_add_u32 s45, s32, 1310720
 buffer_load_dwordx4 v11, s[12:15], s45 offen  lds
 s_add_u32 m0, s49, 94208
 s_add_u32 s45, s32, 1441792
 buffer_load_dwordx4 v11, s[12:15], s45 offen  lds
 s_add_u32 m0, s49, 98304
 s_add_u32 s45, s33, 1310720
 buffer_load_dwordx4 v11, s[16:19], s45 offen  lds
 s_add_u32 m0, s49, 102400
 s_add_u32 s45, s33, 1441792
 buffer_load_dwordx4 v11, s[16:19], s45 offen  lds
 ds_read_b64_tr_b16 a[8:9], v8 offset:32768
 ds_read_b64_tr_b16 a[10:11], v8 offset:33792
 ds_read_b64_tr_b16 a[80:81], v9 offset:32768
 ds_read_b64_tr_b16 a[82:83], v9 offset:33792
 ds_read_b64_tr_b16 a[152:153], v8 offset:40960
 ds_read_b64_tr_b16 a[154:155], v8 offset:41984
 ds_read_b64_tr_b16 a[224:225], v9 offset:40960
 ds_read_b64_tr_b16 a[226:227], v9 offset:41984
 s_waitcnt vmcnt(8) lgkmcnt(0)
 s_barrier
 s_add_u32 m0, s49, 106496
 s_add_u32 s45, s32, 1572864
 buffer_load_dwordx4 v11, s[12:15], s45 offen  lds
 s_add_u32 m0, s49, 110592
 s_add_u32 s45, s32, 1703936
 buffer_load_dwordx4 v11, s[12:15], s45 offen  lds
 s_add_u32 m0, s49, 114688
 s_add_u32 s45, s33, 1572864
 buffer_load_dwordx4 v11, s[16:19], s45 offen  lds
 s_add_u32 m0, s49, 118784
 s_add_u32 s45, s33, 1703936
 buffer_load_dwordx4 v11, s[16:19], s45 offen  lds
 ds_read_b64_tr_b16 a[12:13], v8 offset:49152
 ds_read_b64_tr_b16 a[14:15], v8 offset:50176
 ds_read_b64_tr_b16 a[84:85], v9 offset:49152
 ds_read_b64_tr_b16 a[86:87], v9 offset:50176
 ds_read_b64_tr_b16 a[156:157], v8 offset:57344
 ds_read_b64_tr_b16 a[158:159], v8 offset:58368
 ds_read_b64_tr_b16 a[228:229], v9 offset:57344
 ds_read_b64_tr_b16 a[230:231], v9 offset:58368
 s_waitcnt vmcnt(8) lgkmcnt(0)
 s_barrier
 s_add_u32 m0, s49, 122880
 s_add_u32 s45, s32, 1835008
 buffer_load_dwordx4 v11, s[12:15], s45 offen  lds
 s_add_u32 m0, s49, 126976
 s_add_u32 s45, s32, 1966080
 buffer_load_dwordx4 v11, s[12:15], s45 offen  lds
 s_add_u32 m0, s49, 131072
 s_add_u32 s45, s33, 1835008
 buffer_load_dwordx4 v11, s[16:19], s45 offen  lds
 s_add_u32 m0, s49, 135168
 s_add_u32 s45, s33, 1966080
 buffer_load_dwordx4 v11, s[16:19], s45 offen  lds
 ds_read_b64_tr_b16 a[16:17], v8 offset:0
 ds_read_b64_tr_b16 a[18:19], v8 offset:1024
 ds_read_b64_tr_b16 a[88:89], v9 offset:0
 ds_read_b64_tr_b16 a[90:91], v9 offset:1024
 ds_read_b64_tr_b16 a[160:161], v8 offset:8192
 ds_read_b64_tr_b16 a[162:163], v8 offset:9216
 ds_read_b64_tr_b16 a[232:233], v9 offset:8192
 ds_read_b64_tr_b16 a[234:235], v9 offset:9216
 s_waitcnt vmcnt(8) lgkmcnt(0)
 s_barrier
 s_add_u32 m0, s49, 73728
 s_add_u32 s45, s32, 2097152
 buffer_load_dwordx4 v11, s[12:15], s45 offen  lds
 s_add_u32 m0, s49, 77824
 s_add_u32 s45, s32, 2228224
 buffer_load_dwordx4 v11, s[12:15], s45 offen  lds
 s_add_u32 m0, s49, 81920
 s_add_u32 s45, s33, 2097152
 buffer_load_dwordx4 v11, s[16:19], s45 offen  lds
 s_add_u32 m0, s49, 86016
 s_add_u32 s45, s33, 2228224
 buffer_load_dwordx4 v11, s[16:19], s45 offen  lds
 ds_read_b64_tr_b16 a[20:21], v8 offset:16384
 ds_read_b64_tr_b16 a[22:23], v8 offset:17408
 ds_read_b64_tr_b16 a[92:93], v9 offset:16384
 ds_read_b64_tr_b16 a[94:95], v9 offset:17408
 ds_read_b64_tr_b16 a[164:165], v8 offset:24576
 ds_read_b64_tr_b16 a[166:167], v8 offset:25600
 ds_read_b64_tr_b16 a[236:237], v9 offset:24576
 ds_read_b64_tr_b16 a[238:239], v9 offset:25600
 s_waitcnt vmcnt(8) lgkmcnt(0)
 s_barrier
 s_add_u32 m0, s49, 90112
 s_add_u32 s45, s32, 2359296
 buffer_load_dwordx4 v11, s[12:15], s45 offen  lds
 s_add_u32 m0, s49, 94208
 s_add_u32 s45, s32, 2490368
 buffer_load_dwordx4 v11, s[12:15], s45 offen  lds
 s_add_u32 m0, s49, 98304
 s_add_u32 s45, s33, 2359296
 buffer_load_dwordx4 v11, s[16:19], s45 offen  lds
 s_add_u32 m0, s49, 102400
 s_add_u32 s45, s33, 2490368
 buffer_load_dwordx4 v11, s[16:19], s45 offen  lds
 ds_read_b64_tr_b16 a[24:25], v8 offset:32768
 ds_read_b64_tr_b16 a[26:27], v8 offset:33792
 ds_read_b64_tr_b16 a[96:97], v9 offset:32768
 ds_read_b64_tr_b16 a[98:99], v9 offset:33792
 ds_read_b64_tr_b16 a[168:169], v8 offset:40960
 ds_read_b64_tr_b16 a[170:171], v8 offset:41984
 ds_read_b64_tr_b16 a[240:241], v9 offset:40960
 ds_read_b64_tr_b16 a[242:243], v9 offset:41984
 s_waitcnt vmcnt(8) lgkmcnt(0)
 s_barrier
 s_add_u32 m0, s49, 106496
 s_add_u32 s45, s32, 2621440
 buffer_load_dwordx4 v11, s[12:15], s45 offen  lds
 s_add_u32 m0, s49, 110592
 s_add_u32 s45, s32, 2752512
 buffer_load_dwordx4 v11, s[12:15], s45 offen  lds
 s_add_u32 m0, s49, 114688
 s_add_u32 s45, s33, 2621440
 buffer_load_dwordx4 v11, s[16:19], s45 offen  lds
 s_add_u32 m0, s49, 118784
 s_add_u32 s45, s33, 2752512
 buffer_load_dwordx4 v11, s[16:19], s45 offen  lds
 ds_read_b64_tr_b16 a[28:29], v8 offset:49152
 ds_read_b64_tr_b16 a[30:31], v8 offset:50176
 ds_read_b64_tr_b16 a[100:101], v9 offset:49152
 ds_read_b64_tr_b16 a[102:103], v9 offset:50176
 ds_read_b64_tr_b16 a[172:173], v8 offset:57344
 ds_read_b64_tr_b16 a[174:175], v8 offset:58368
 ds_read_b64_tr_b16 a[244:245], v9 offset:57344
 ds_read_b64_tr_b16 a[246:247], v9 offset:58368
 s_waitcnt vmcnt(8) lgkmcnt(0)
 s_barrier
 s_add_u32 m0, s49, 122880
 s_add_u32 s45, s32, 2883584
 buffer_load_dwordx4 v11, s[12:15], s45 offen  lds
 s_add_u32 m0, s49, 126976
 s_add_u32 s45, s32, 3014656
 buffer_load_dwordx4 v11, s[12:15], s45 offen  lds
 s_add_u32 m0, s49, 131072
 s_add_u32 s45, s33, 2883584
 buffer_load_dwordx4 v11, s[16:19], s45 offen  lds
 s_add_u32 m0, s49, 135168
 s_add_u32 s45, s33, 3014656
 buffer_load_dwordx4 v11, s[16:19], s45 offen  lds
 ds_read_b64_tr_b16 a[32:33], v8 offset:0
 ds_read_b64_tr_b16 a[34:35], v8 offset:1024
 ds_read_b64_tr_b16 a[104:105], v9 offset:0
 ds_read_b64_tr_b16 a[106:107], v9 offset:1024
 ds_read_b64_tr_b16 a[176:177], v8 offset:8192
 ds_read_b64_tr_b16 a[178:179], v8 offset:9216
 ds_read_b64_tr_b16 a[248:249], v9 offset:8192
 ds_read_b64_tr_b16 a[250:251], v9 offset:9216
 s_waitcnt vmcnt(8) lgkmcnt(0)
 s_barrier
 s_add_u32 m0, s49, 73728
 s_add_u32 s45, s32, 3145728
 buffer_load_dwordx4 v11, s[12:15], s45 offen  lds
 s_add_u32 m0, s49, 77824
 s_add_u32 s45, s32, 3276800
 buffer_load_dwordx4 v11, s[12:15], s45 offen  lds
 s_add_u32 m0, s49, 81920
 s_add_u32 s45, s33, 3145728
 buffer_load_dwordx4 v11, s[16:19], s45 offen  lds
 s_add_u32 m0, s49, 86016
 s_add_u32 s45, s33, 3276800
 buffer_load_dwordx4 v11, s[16:19], s45 offen  lds
 ds_read_b64_tr_b16 a[36:37], v8 offset:16384
 ds_read_b64_tr_b16 a[38:39], v8 offset:17408
 ds_read_b64_tr_b16 a[108:109], v9 offset:16384
 ds_read_b64_tr_b16 a[110:111], v9 offset:17408
 ds_read_b64_tr_b16 a[180:181], v8 offset:24576
 ds_read_b64_tr_b16 a[182:183], v8 offset:25600
 ds_read_b64_tr_b16 a[252:253], v9 offset:24576
 ds_read_b64_tr_b16 a[254:255], v9 offset:25600
 s_waitcnt vmcnt(8) lgkmcnt(0)
 s_barrier
 s_add_u32 m0, s49, 90112
 s_add_u32 s45, s32, 3407872
 buffer_load_dwordx4 v11, s[12:15], s45 offen  lds
 s_add_u32 m0, s49, 94208
 s_add_u32 s45, s32, 3538944
 buffer_load_dwordx4 v11, s[12:15], s45 offen  lds
 s_add_u32 m0, s49, 98304
 s_add_u32 s45, s33, 3407872
 buffer_load_dwordx4 v11, s[16:19], s45 offen  lds
 s_add_u32 m0, s49, 102400
 s_add_u32 s45, s33, 3538944
 buffer_load_dwordx4 v11, s[16:19], s45 offen  lds
 ds_read_b64_tr_b16 a[40:41], v8 offset:32768
 ds_read_b64_tr_b16 a[42:43], v8 offset:33792
 ds_read_b64_tr_b16 a[112:113], v9 offset:32768
 ds_read_b64_tr_b16 a[114:115], v9 offset:33792
 ds_read_b64_tr_b16 a[184:185], v8 offset:40960
 ds_read_b64_tr_b16 a[186:187], v8 offset:41984
 ds_read_b64_tr_b16 v[224:225], v9 offset:40960
 ds_read_b64_tr_b16 v[226:227], v9 offset:41984
 s_waitcnt vmcnt(8) lgkmcnt(0)
 s_barrier
 s_add_u32 m0, s49, 106496
 s_add_u32 s45, s32, 3670016
 buffer_load_dwordx4 v11, s[12:15], s45 offen  lds
 s_add_u32 m0, s49, 110592
 s_add_u32 s45, s32, 3801088
 buffer_load_dwordx4 v11, s[12:15], s45 offen  lds
 s_add_u32 m0, s49, 114688
 s_add_u32 s45, s33, 3670016
 buffer_load_dwordx4 v11, s[16:19], s45 offen  lds
 s_add_u32 m0, s49, 118784
 s_add_u32 s45, s33, 3801088
 buffer_load_dwordx4 v11, s[16:19], s45 offen  lds
 ds_read_b64_tr_b16 a[44:45], v8 offset:49152
 ds_read_b64_tr_b16 a[46:47], v8 offset:50176
 ds_read_b64_tr_b16 a[116:117], v9 offset:49152
 ds_read_b64_tr_b16 a[118:119], v9 offset:50176
 ds_read_b64_tr_b16 a[188:189], v8 offset:57344
 ds_read_b64_tr_b16 a[190:191], v8 offset:58368
 ds_read_b64_tr_b16 v[228:229], v9 offset:57344
 ds_read_b64_tr_b16 v[230:231], v9 offset:58368
 s_waitcnt vmcnt(8) lgkmcnt(0)
 s_barrier
 s_add_u32 m0, s49, 122880
 s_add_u32 s45, s32, 3932160
 buffer_load_dwordx4 v11, s[12:15], s45 offen  lds
 s_add_u32 m0, s49, 126976
 s_add_u32 s45, s32, 4063232
 buffer_load_dwordx4 v11, s[12:15], s45 offen  lds
 s_add_u32 m0, s49, 131072
 s_add_u32 s45, s33, 3932160
 buffer_load_dwordx4 v11, s[16:19], s45 offen  lds
 s_add_u32 m0, s49, 135168
 s_add_u32 s45, s33, 4063232
 buffer_load_dwordx4 v11, s[16:19], s45 offen  lds
 ds_read_b64_tr_b16 a[48:49], v8 offset:0
 ds_read_b64_tr_b16 a[50:51], v8 offset:1024
 ds_read_b64_tr_b16 a[120:121], v9 offset:0
 ds_read_b64_tr_b16 a[122:123], v9 offset:1024
 ds_read_b64_tr_b16 a[192:193], v8 offset:8192
 ds_read_b64_tr_b16 a[194:195], v8 offset:9216
 ds_read_b64_tr_b16 v[232:233], v9 offset:8192
 ds_read_b64_tr_b16 v[234:235], v9 offset:9216
 s_waitcnt vmcnt(8) lgkmcnt(0)
 s_barrier
 s_add_u32 m0, s49, 73728
 s_add_u32 s45, s32, 4194304
 buffer_load_dwordx4 v11, s[12:15], s45 offen  lds
 s_add_u32 m0, s49, 77824
 s_add_u32 s45, s32, 4325376
 buffer_load_dwordx4 v11, s[12:15], s45 offen  lds
 s_add_u32 m0, s49, 81920
 s_add_u32 s45, s33, 4194304
 buffer_load_dwordx4 v11, s[16:19], s45 offen  lds
 s_add_u32 m0, s49, 86016
 s_add_u32 s45, s33, 4325376
 buffer_load_dwordx4 v11, s[16:19], s45 offen  lds
 ds_read_b64_tr_b16 a[52:53], v8 offset:16384
 ds_read_b64_tr_b16 a[54:55], v8 offset:17408
 ds_read_b64_tr_b16 a[124:125], v9 offset:16384
 ds_read_b64_tr_b16 a[126:127], v9 offset:17408
 ds_read_b64_tr_b16 a[196:197], v8 offset:24576
 ds_read_b64_tr_b16 a[198:199], v8 offset:25600
 ds_read_b64_tr_b16 v[236:237], v9 offset:24576
 ds_read_b64_tr_b16 v[238:239], v9 offset:25600
 s_waitcnt vmcnt(8) lgkmcnt(0)
 s_barrier
 s_add_u32 m0, s49, 90112
 s_add_u32 s45, s32, 4456448
 buffer_load_dwordx4 v11, s[12:15], s45 offen  lds
 s_add_u32 m0, s49, 94208
 s_add_u32 s45, s32, 4587520
 buffer_load_dwordx4 v11, s[12:15], s45 offen  lds
 s_add_u32 m0, s49, 98304
 s_add_u32 s45, s33, 4456448
 buffer_load_dwordx4 v11, s[16:19], s45 offen  lds
 s_add_u32 m0, s49, 102400
 s_add_u32 s45, s33, 4587520
 buffer_load_dwordx4 v11, s[16:19], s45 offen  lds
 ds_read_b64_tr_b16 a[56:57], v8 offset:32768
 ds_read_b64_tr_b16 a[58:59], v8 offset:33792
 ds_read_b64_tr_b16 a[128:129], v9 offset:32768
 ds_read_b64_tr_b16 a[130:131], v9 offset:33792
 ds_read_b64_tr_b16 a[200:201], v8 offset:40960
 ds_read_b64_tr_b16 a[202:203], v8 offset:41984
 ds_read_b64_tr_b16 v[240:241], v9 offset:40960
 ds_read_b64_tr_b16 v[242:243], v9 offset:41984
 s_waitcnt vmcnt(8) lgkmcnt(0)
 s_barrier
 ds_read_b64_tr_b16 a[60:61], v8 offset:49152
 ds_read_b64_tr_b16 a[62:63], v8 offset:50176
 ds_read_b64_tr_b16 a[132:133], v9 offset:49152
 ds_read_b64_tr_b16 a[134:135], v9 offset:50176
 ds_read_b64_tr_b16 a[204:205], v8 offset:57344
 ds_read_b64_tr_b16 a[206:207], v8 offset:58368
 ds_read_b64_tr_b16 v[244:245], v9 offset:57344
 ds_read_b64_tr_b16 v[246:247], v9 offset:58368
 s_waitcnt vmcnt(4) lgkmcnt(0)
 s_barrier
 ds_read_b64_tr_b16 a[64:65], v8 offset:0
 ds_read_b64_tr_b16 a[66:67], v8 offset:1024
 ds_read_b64_tr_b16 a[136:137], v9 offset:0
 ds_read_b64_tr_b16 a[138:139], v9 offset:1024
 ds_read_b64_tr_b16 a[208:209], v8 offset:8192
 ds_read_b64_tr_b16 a[210:211], v8 offset:9216
 ds_read_b64_tr_b16 v[248:249], v9 offset:8192
 ds_read_b64_tr_b16 v[250:251], v9 offset:9216
 s_waitcnt vmcnt(0) lgkmcnt(0)
 s_barrier
 ds_read_b64_tr_b16 a[68:69], v8 offset:16384
 ds_read_b64_tr_b16 a[70:71], v8 offset:17408
 ds_read_b64_tr_b16 a[140:141], v9 offset:16384
 ds_read_b64_tr_b16 a[142:143], v9 offset:17408
 ds_read_b64_tr_b16 a[212:213], v8 offset:24576
 ds_read_b64_tr_b16 a[214:215], v8 offset:25600
 ds_read_b64_tr_b16 v[252:253], v9 offset:24576
 ds_read_b64_tr_b16 v[254:255], v9 offset:25600
 s_mov_b32 s50, 0x3e0293ee
 s_mov_b32 s42, 0
 s_mov_b32 s43, 0
 s_mov_b32 s44, 73728
 v_mov_b32 v6, v4
 v_mov_b32 v7, v5
 s_mov_b32 s95, 0x40000
 s_cmp_lg_u32 s4, 0
 s_cbranch_scc1 Lfrk_17
 v_min_u32 v21, 1, v0
 v_lshlrev_b32 v21, 28, v21
Lfr_16:
 buffer_load_dword v20, v21, s[28:31], 0 offen offset:0 sc1
 s_waitcnt vmcnt(0)
 v_cmp_eq_u32 vcc, 1, v20
 s_cbranch_vccnz Lfrk_17
 s_sub_u32 s95, s95, 1
 s_cbranch_scc0 Lfr_16
 s_endpgm
Lfrk_17:
 s_lshl_b32 s47, s2, 13
 s_add_u32 s47, s47, 0x8000000
 s_mov_b32 s48, s47
 v_mov_b32 v14, 0
 s_waitcnt vmcnt(0) lgkmcnt(0)
 s_barrier
 ds_read_b128 v[32:35], v6 offset:0
 ds_read_b128 v[36:39], v6 offset:2048
 ds_read_b128 v[40:43], v7 offset:0
 ds_read_b128 v[44:47], v7 offset:2048
 v_lshlrev_b32 v1, 12, v0
 s_lshl_b32 s45, s6, 7
 buffer_load_dword v15, v1, s[8:11], s45 offen
 v_add_u32 v1, 0x100000, v1
 buffer_load_dword v15, v1, s[8:11], s45 offen
 v_add_u32 v1, 0x100000, v1
 buffer_load_dword v15, v1, s[8:11], s45 offen
 v_add_u32 v1, 0x100000, v1
 s_waitcnt lgkmcnt(2)
Lps_loop_18:
 v_mfma_f32_16x16x32_bf16 v[64:67], a[0:3], v[32:35], 0
 ds_read_b128 v[48:51], v6 offset:4096
 v_mfma_f32_16x16x32_bf16 v[72:75], a[72:75], v[32:35], 0
 ds_read_b128 v[52:55], v6 offset:6144
 v_mfma_f32_16x16x32_bf16 v[80:83], v[32:35], a[144:147], 0
 s_add_u32 s41, s40, 1
 v_mfma_f32_16x16x32_bf16 v[88:91], v[32:35], a[216:219], 0
 s_add_u32 s45, s42, 2
 s_mul_i32 s46, s41, 36864
 v_mfma_f32_16x16x32_bf16 v[68:71], a[0:3], v[36:39], 0
 s_cmp_lt_u32 s45, s36
 s_cselect_b32 s46, s46, 0
 v_mfma_f32_16x16x32_bf16 v[76:79], a[72:75], v[36:39], 0
 s_lshl_b32 s49, s4, 10
 s_add_u32 s49, s49, s44
 v_mfma_f32_16x16x32_bf16 v[84:87], v[36:39], a[144:147], 0
 v_mul_f32 v96, s50, v96
 v_mul_f32 v97, s50, v97
 v_mfma_f32_16x16x32_bf16 v[92:95], v[36:39], a[216:219], 0
 s_waitcnt lgkmcnt(2)
 v_mfma_f32_16x16x32_bf16 v[64:67], a[4:7], v[40:43], v[64:67]
 ds_read_b128 v[56:59], v7 offset:4096
 v_mul_f32 v98, s50, v98
 v_mfma_f32_16x16x32_bf16 v[72:75], a[76:79], v[40:43], v[72:75]
 ds_read_b128 v[60:63], v7 offset:6144
 v_mul_f32 v99, s50, v99
 v_mfma_f32_16x16x32_bf16 v[80:83], v[40:43], a[148:151], v[80:83]
 v_mul_f32 v104, s50, v104
 v_mfma_f32_16x16x32_bf16 v[88:91], v[40:43], a[220:223], v[88:91]
 v_mul_f32 v105, s50, v105
 v_mfma_f32_16x16x32_bf16 v[68:71], a[4:7], v[44:47], v[68:71]
 v_mul_f32 v106, s50, v106
 v_mul_f32 v107, s50, v107
 v_mfma_f32_16x16x32_bf16 v[76:79], a[76:79], v[44:47], v[76:79]
 v_cvt_pk_bf16_f32 v16, v96, v97
 v_mfma_f32_16x16x32_bf16 v[84:87], v[44:47], a[148:151], v[84:87]
 v_cvt_pk_bf16_f32 v17, v104, v105
 v_mfma_f32_16x16x32_bf16 v[92:95], v[44:47], a[220:223], v[92:95]
 s_waitcnt lgkmcnt(2)
 v_cvt_pk_bf16_f32 v18, v98, v99
 v_mfma_f32_16x16x32_bf16 v[64:67], a[8:11], v[48:51], v[64:67]
 ds_read_b128 v[32:35], v6 offset:8192
 v_cvt_pk_bf16_f32 v19, v106, v107
 v_mfma_f32_16x16x32_bf16 v[72:75], a[80:83], v[48:51], v[72:75]
 ds_read_b128 v[36:39], v6 offset:10240
 v_mfma_f32_16x16x32_bf16 v[80:83], v[48:51], a[152:155], v[80:83]
 buffer_store_dwordx4 v[16:19], v12, s[20:23], s47 offen offset:0 sc1
 v_mul_f32 v100, s50, v100
 v_mfma_f32_16x16x32_bf16 v[88:91], v[48:51], a[224:227], v[88:91]
 v_mul_f32 v101, s50, v101
 v_mfma_f32_16x16x32_bf16 v[68:71], a[8:11], v[52:55], v[68:71]
 v_mul_f32 v102, s50, v102
 v_mfma_f32_16x16x32_bf16 v[76:79], a[80:83], v[52:55], v[76:79]
 v_mul_f32 v103, s50, v103
 v_mul_f32 v108, s50, v108
 v_mfma_f32_16x16x32_bf16 v[84:87], v[52:55], a[152:155], v[84:87]
 v_mul_f32 v109, s50, v109
 v_mfma_f32_16x16x32_bf16 v[92:95], v[52:55], a[224:227], v[92:95]
 s_waitcnt lgkmcnt(2)
 v_mfma_f32_16x16x32_bf16 v[64:67], a[12:15], v[56:59], v[64:67]
 ds_read_b128 v[40:43], v7 offset:8192
 v_mul_f32 v110, s50, v110
 v_mfma_f32_16x16x32_bf16 v[72:75], a[84:87], v[56:59], v[72:75]
 ds_read_b128 v[44:47], v7 offset:10240
 v_mul_f32 v111, s50, v111
 v_mfma_f32_16x16x32_bf16 v[80:83], v[56:59], a[156:159], v[80:83]
 v_cvt_pk_bf16_f32 v20, v100, v101
 v_mfma_f32_16x16x32_bf16 v[88:91], v[56:59], a[228:231], v[88:91]
 v_cvt_pk_bf16_f32 v21, v108, v109
 v_mfma_f32_16x16x32_bf16 v[68:71], a[12:15], v[60:63], v[68:71]
 v_cvt_pk_bf16_f32 v22, v102, v103
 v_cvt_pk_bf16_f32 v23, v110, v111
 v_mfma_f32_16x16x32_bf16 v[76:79], a[84:87], v[60:63], v[76:79]
 buffer_store_dwordx4 v[20:23], v12, s[20:23], s47 offen offset:1024 sc1
 v_mfma_f32_16x16x32_bf16 v[84:87], v[60:63], a[156:159], v[84:87]
 v_cvt_pk_bf16_f32 v24, v112, v113
 v_mfma_f32_16x16x32_bf16 v[92:95], v[60:63], a[228:231], v[92:95]
 s_waitcnt lgkmcnt(2)
 v_cvt_pk_bf16_f32 v25, v116, v117
 v_mfma_f32_16x16x32_bf16 v[64:67], a[16:19], v[32:35], v[64:67]
 ds_read_b128 v[48:51], v6 offset:12288
 v_cvt_pk_bf16_f32 v26, v114, v115
 v_mfma_f32_16x16x32_bf16 v[72:75], a[88:91], v[32:35], v[72:75]
 ds_read_b128 v[52:55], v6 offset:14336
 v_mfma_f32_16x16x32_bf16 v[80:83], v[32:35], a[160:163], v[80:83]
 v_cvt_pk_bf16_f32 v27, v118, v119
 buffer_store_dwordx4 v[24:27], v12, s[20:23], s48 offen offset:0 sc1
 v_mfma_f32_16x16x32_bf16 v[88:91], v[32:35], a[232:235], v[88:91]
 v_cvt_pk_bf16_f32 v28, v120, v121
 v_mfma_f32_16x16x32_bf16 v[68:71], a[16:19], v[36:39], v[68:71]
 v_cvt_pk_bf16_f32 v29, v124, v125
 v_mfma_f32_16x16x32_bf16 v[76:79], a[88:91], v[36:39], v[76:79]
 v_cvt_pk_bf16_f32 v30, v122, v123
 v_cvt_pk_bf16_f32 v31, v126, v127
 v_mfma_f32_16x16x32_bf16 v[84:87], v[36:39], a[160:163], v[84:87]
 buffer_store_dwordx4 v[28:31], v12, s[20:23], s48 offen offset:1024 sc1
 v_mfma_f32_16x16x32_bf16 v[92:95], v[36:39], a[232:235], v[92:95]
 s_waitcnt lgkmcnt(2)
 v_mfma_f32_16x16x32_bf16 v[64:67], a[20:23], v[40:43], v[64:67]
 ds_read_b128 v[56:59], v7 offset:12288
 v_mfma_f32_16x16x32_bf16 v[72:75], a[92:95], v[40:43], v[72:75]
 ds_read_b128 v[60:63], v7 offset:14336
 v_mfma_f32_16x16x32_bf16 v[80:83], v[40:43], a[164:167], v[80:83]
 s_add_u32 m0, s49, 0
 v_mfma_f32_16x16x32_bf16 v[88:91], v[40:43], a[236:239], v[88:91]
 buffer_load_dwordx4 v10, s[8:11], s46 offen offset:0  lds
 v_mfma_f32_16x16x32_bf16 v[68:71], a[20:23], v[44:47], v[68:71]
 s_add_u32 m0, s49, 3968
 v_mfma_f32_16x16x32_bf16 v[76:79], a[92:95], v[44:47], v[76:79]
 buffer_load_dwordx4 v10, s[8:11], s46 offen offset:128  lds
 v_mfma_f32_16x16x32_bf16 v[84:87], v[44:47], a[164:167], v[84:87]
 v_mfma_f32_16x16x32_bf16 v[92:95], v[44:47], a[236:239], v[92:95]
 s_waitcnt lgkmcnt(2)
 v_mfma_f32_16x16x32_bf16 v[64:67], a[24:27], v[48:51], v[64:67]
 ds_read_b128 v[32:35], v6 offset:16384
 v_mfma_f32_16x16x32_bf16 v[72:75], a[96:99], v[48:51], v[72:75]
 ds_read_b128 v[36:39], v6 offset:18432
 v_mfma_f32_16x16x32_bf16 v[80:83], v[48:51], a[168:171], v[80:83]
 s_add_u32 m0, s49, 7936
 v_mfma_f32_16x16x32_bf16 v[88:91], v[48:51], a[240:243], v[88:91]
 buffer_load_dwordx4 v10, s[8:11], s46 offen offset:256  lds
 v_mfma_f32_16x16x32_bf16 v[68:71], a[24:27], v[52:55], v[68:71]
 s_add_u32 m0, s49, 11904
 v_mfma_f32_16x16x32_bf16 v[76:79], a[96:99], v[52:55], v[76:79]
 buffer_load_dwordx4 v10, s[8:11], s46 offen offset:384  lds
 v_mfma_f32_16x16x32_bf16 v[84:87], v[52:55], a[168:171], v[84:87]
 v_mfma_f32_16x16x32_bf16 v[92:95], v[52:55], a[240:243], v[92:95]
 s_waitcnt lgkmcnt(2)
 v_mfma_f32_16x16x32_bf16 v[64:67], a[28:31], v[56:59], v[64:67]
 ds_read_b128 v[40:43], v7 offset:16384
 v_mfma_f32_16x16x32_bf16 v[72:75], a[100:103], v[56:59], v[72:75]
 ds_read_b128 v[44:47], v7 offset:18432
 v_mfma_f32_16x16x32_bf16 v[80:83], v[56:59], a[172:175], v[80:83]
 s_add_u32 m0, s49, 15872
 v_mfma_f32_16x16x32_bf16 v[88:91], v[56:59], a[244:247], v[88:91]
 buffer_load_dwordx4 v10, s[8:11], s46 offen offset:512  lds
 v_mfma_f32_16x16x32_bf16 v[68:71], a[28:31], v[60:63], v[68:71]
 s_add_u32 m0, s49, 19840
 v_mfma_f32_16x16x32_bf16 v[76:79], a[100:103], v[60:63], v[76:79]
 buffer_load_dwordx4 v10, s[8:11], s46 offen offset:640  lds
 v_mfma_f32_16x16x32_bf16 v[84:87], v[60:63], a[172:175], v[84:87]
 v_mfma_f32_16x16x32_bf16 v[92:95], v[60:63], a[244:247], v[92:95]
 s_waitcnt lgkmcnt(2)
 v_mfma_f32_16x16x32_bf16 v[64:67], a[32:35], v[32:35], v[64:67]
 ds_read_b128 v[48:51], v6 offset:20480
 v_mfma_f32_16x16x32_bf16 v[72:75], a[104:107], v[32:35], v[72:75]
 ds_read_b128 v[52:55], v6 offset:22528
 v_mfma_f32_16x16x32_bf16 v[80:83], v[32:35], a[176:179], v[80:83]
 s_add_u32 m0, s49, 23808
 v_mfma_f32_16x16x32_bf16 v[88:91], v[32:35], a[248:251], v[88:91]
 buffer_load_dwordx4 v10, s[8:11], s46 offen offset:768  lds
 v_mfma_f32_16x16x32_bf16 v[68:71], a[32:35], v[36:39], v[68:71]
 s_add_u32 m0, s49, 27776
 v_mfma_f32_16x16x32_bf16 v[76:79], a[104:107], v[36:39], v[76:79]
 buffer_load_dwordx4 v10, s[8:11], s46 offen offset:896  lds
 v_mfma_f32_16x16x32_bf16 v[84:87], v[36:39], a[176:179], v[84:87]
 v_mfma_f32_16x16x32_bf16 v[92:95], v[36:39], a[248:251], v[92:95]
 s_waitcnt lgkmcnt(2)
 v_mfma_f32_16x16x32_bf16 v[64:67], a[36:39], v[40:43], v[64:67]
 ds_read_b128 v[56:59], v7 offset:20480
 v_mfma_f32_16x16x32_bf16 v[72:75], a[108:111], v[40:43], v[72:75]
 ds_read_b128 v[60:63], v7 offset:22528
 v_mfma_f32_16x16x32_bf16 v[80:83], v[40:43], a[180:183], v[80:83]
 s_add_u32 m0, s49, 31744
 v_mfma_f32_16x16x32_bf16 v[88:91], v[40:43], a[252:255], v[88:91]
 buffer_load_dwordx4 v10, s[8:11], s46 offen offset:1024  lds
 v_mfma_f32_16x16x32_bf16 v[68:71], a[36:39], v[44:47], v[68:71]
 v_mfma_f32_16x16x32_bf16 v[76:79], a[108:111], v[44:47], v[76:79]
 v_mfma_f32_16x16x32_bf16 v[84:87], v[44:47], a[180:183], v[84:87]
 v_mfma_f32_16x16x32_bf16 v[92:95], v[44:47], a[252:255], v[92:95]
 s_waitcnt lgkmcnt(2)
 v_mfma_f32_16x16x32_bf16 v[64:67], a[40:43], v[48:51], v[64:67]
 ds_read_b128 v[32:35], v6 offset:24576
 v_mfma_f32_16x16x32_bf16 v[72:75], a[112:115], v[48:51], v[72:75]
 ds_read_b128 v[36:39], v6 offset:26624
 v_mfma_f32_16x16x32_bf16 v[80:83], v[48:51], a[184:187], v[80:83]
 v_mfma_f32_16x16x32_bf16 v[88:91], v[48:51], v[224:227], v[88:91]
 v_mfma_f32_16x16x32_bf16 v[68:71], a[40:43], v[52:55], v[68:71]
 v_mfma_f32_16x16x32_bf16 v[76:79], a[112:115], v[52:55], v[76:79]
 v_mfma_f32_16x16x32_bf16 v[84:87], v[52:55], a[184:187], v[84:87]
 v_mfma_f32_16x16x32_bf16 v[92:95], v[52:55], v[224:227], v[92:95]
 s_waitcnt lgkmcnt(2)
 v_mfma_f32_16x16x32_bf16 v[64:67], a[44:47], v[56:59], v[64:67]
 ds_read_b128 v[40:43], v7 offset:24576
 v_mfma_f32_16x16x32_bf16 v[72:75], a[116:119], v[56:59], v[72:75]
 ds_read_b128 v[44:47], v7 offset:26624
 v_mfma_f32_16x16x32_bf16 v[80:83], v[56:59], a[188:191], v[80:83]
 v_mfma_f32_16x16x32_bf16 v[88:91], v[56:59], v[228:231], v[88:91]
 v_mfma_f32_16x16x32_bf16 v[68:71], a[44:47], v[60:63], v[68:71]
 v_mfma_f32_16x16x32_bf16 v[76:79], a[116:119], v[60:63], v[76:79]
 v_mfma_f32_16x16x32_bf16 v[84:87], v[60:63], a[188:191], v[84:87]
 v_mfma_f32_16x16x32_bf16 v[92:95], v[60:63], v[228:231], v[92:95]
 s_waitcnt lgkmcnt(2)
 v_mfma_f32_16x16x32_bf16 v[64:67], a[48:51], v[32:35], v[64:67]
 ds_read_b128 v[48:51], v6 offset:28672
 v_mfma_f32_16x16x32_bf16 v[72:75], a[120:123], v[32:35], v[72:75]
 ds_read_b128 v[52:55], v6 offset:30720
 v_mfma_f32_16x16x32_bf16 v[80:83], v[32:35], a[192:195], v[80:83]
 v_mfma_f32_16x16x32_bf16 v[88:91], v[32:35], v[232:235], v[88:91]
 v_mfma_f32_16x16x32_bf16 v[68:71], a[48:51], v[36:39], v[68:71]
 v_mfma_f32_16x16x32_bf16 v[76:79], a[120:123], v[36:39], v[76:79]
 v_mfma_f32_16x16x32_bf16 v[84:87], v[36:39], a[192:195], v[84:87]
 v_mfma_f32_16x16x32_bf16 v[92:95], v[36:39], v[232:235], v[92:95]
 s_waitcnt lgkmcnt(2)
 v_mfma_f32_16x16x32_bf16 v[64:67], a[52:55], v[40:43], v[64:67]
 ds_read_b128 v[56:59], v7 offset:28672
 v_mfma_f32_16x16x32_bf16 v[72:75], a[124:127], v[40:43], v[72:75]
 ds_read_b128 v[60:63], v7 offset:30720
 v_mfma_f32_16x16x32_bf16 v[80:83], v[40:43], a[196:199], v[80:83]
 s_add_u32 s43, s43, 36864
 s_cmp_eq_u32 s43, 147456
 v_mfma_f32_16x16x32_bf16 v[88:91], v[40:43], v[236:239], v[88:91]
 s_cselect_b32 s43, 0, s43
 s_add_u32 s44, s44, 36864
 v_mfma_f32_16x16x32_bf16 v[68:71], a[52:55], v[44:47], v[68:71]
 s_cmp_eq_u32 s44, 147456
 s_cselect_b32 s44, 0, s44
 v_mfma_f32_16x16x32_bf16 v[76:79], a[124:127], v[44:47], v[76:79]
 v_mfma_f32_16x16x32_bf16 v[84:87], v[44:47], a[196:199], v[84:87]
 v_mfma_f32_16x16x32_bf16 v[92:95], v[44:47], v[236:239], v[92:95]
 s_waitcnt lgkmcnt(2)
 v_mfma_f32_16x16x32_bf16 v[64:67], a[56:59], v[48:51], v[64:67]
 ds_read_b128 v[32:35], v6 offset:32768
 v_mfma_f32_16x16x32_bf16 v[72:75], a[128:131], v[48:51], v[72:75]
 ds_read_b128 v[36:39], v6 offset:34816
 v_mfma_f32_16x16x32_bf16 v[80:83], v[48:51], a[200:203], v[80:83]
 v_add_u32 v6, s43, v4
 v_mfma_f32_16x16x32_bf16 v[88:91], v[48:51], v[240:243], v[88:91]
 v_mfma_f32_16x16x32_bf16 v[68:71], a[56:59], v[52:55], v[68:71]
 v_mfma_f32_16x16x32_bf16 v[76:79], a[128:131], v[52:55], v[76:79]
 v_mfma_f32_16x16x32_bf16 v[84:87], v[52:55], a[200:203], v[84:87]
 v_mfma_f32_16x16x32_bf16 v[92:95], v[52:55], v[240:243], v[92:95]
 s_waitcnt lgkmcnt(2)
 v_mfma_f32_16x16x32_bf16 v[64:67], a[60:63], v[56:59], v[64:67]
 ds_read_b128 v[40:43], v7 offset:32768
 v_mfma_f32_16x16x32_bf16 v[72:75], a[132:135], v[56:59], v[72:75]
 ds_read_b128 v[44:47], v7 offset:34816
 v_mfma_f32_16x16x32_bf16 v[80:83], v[56:59], a[204:207], v[80:83]
 v_add_u32 v7, s43, v5
 v_mfma_f32_16x16x32_bf16 v[88:91], v[56:59], v[244:247], v[88:91]
 v_mfma_f32_16x16x32_bf16 v[68:71], a[60:63], v[60:63], v[68:71]
 v_mfma_f32_16x16x32_bf16 v[76:79], a[132:135], v[60:63], v[76:79]
 v_mfma_f32_16x16x32_bf16 v[84:87], v[60:63], a[204:207], v[84:87]
 v_mfma_f32_16x16x32_bf16 v[92:95], v[60:63], v[244:247], v[92:95]
 s_waitcnt lgkmcnt(2)
 v_mfma_f32_16x16x32_bf16 v[64:67], a[64:67], v[32:35], v[64:67]
 s_waitcnt vmcnt(9)
 s_barrier
 ds_read_b128 v[48:51], v6 offset:0
 v_mfma_f32_16x16x32_bf16 v[72:75], a[136:139], v[32:35], v[72:75]
 ds_read_b128 v[52:55], v6 offset:2048
 v_mfma_f32_16x16x32_bf16 v[80:83], v[32:35], a[208:211], v[80:83]
 buffer_store_dword v14, v13, s[20:23], 0 offen sc1
 v_mfma_f32_16x16x32_bf16 v[88:91], v[32:35], v[248:251], v[88:91]
 v_mfma_f32_16x16x32_bf16 v[68:71], a[64:67], v[36:39], v[68:71]
 v_mfma_f32_16x16x32_bf16 v[76:79], a[136:139], v[36:39], v[76:79]
 v_mfma_f32_16x16x32_bf16 v[84:87], v[36:39], a[208:211], v[84:87]
 v_mfma_f32_16x16x32_bf16 v[92:95], v[36:39], v[248:251], v[92:95]
 s_waitcnt lgkmcnt(2)
 v_mfma_f32_16x16x32_bf16 v[64:67], a[68:71], v[40:43], v[64:67]
 ds_read_b128 v[56:59], v7 offset:0
 v_mfma_f32_16x16x32_bf16 v[72:75], a[140:143], v[40:43], v[72:75]
 ds_read_b128 v[60:63], v7 offset:2048
 v_mfma_f32_16x16x32_bf16 v[80:83], v[40:43], a[212:215], v[80:83]
 s_mul_i32 s45, s39, 524288
 s_add_u32 s47, s34, s45
 v_mfma_f32_16x16x32_bf16 v[88:91], v[40:43], v[252:255], v[88:91]
 s_add_u32 s48, s35, s45
 v_add_u32 v14, 1, v14
 v_mfma_f32_16x16x32_bf16 v[68:71], a[68:71], v[44:47], v[68:71]
 s_mov_b32 s39, s40
 s_mov_b32 s40, s41
 v_mfma_f32_16x16x32_bf16 v[76:79], a[140:143], v[44:47], v[76:79]
 s_add_u32 s42, s42, 1
 v_mfma_f32_16x16x32_bf16 v[84:87], v[44:47], a[212:215], v[84:87]
 v_mfma_f32_16x16x32_bf16 v[92:95], v[44:47], v[252:255], v[92:95]
 s_waitcnt lgkmcnt(2)
 v_mfma_f32_16x16x32_bf16 v[96:99], a[0:3], v[48:51], 0
 ds_read_b128 v[32:35], v6 offset:4096
 v_mfma_f32_16x16x32_bf16 v[104:107], a[72:75], v[48:51], 0
 ds_read_b128 v[36:39], v6 offset:6144
 v_mfma_f32_16x16x32_bf16 v[112:115], v[48:51], a[144:147], 0
 s_add_u32 s41, s40, 1
 v_mfma_f32_16x16x32_bf16 v[120:123], v[48:51], a[216:219], 0
 s_add_u32 s45, s42, 2
 s_mul_i32 s46, s41, 36864
 v_mfma_f32_16x16x32_bf16 v[100:103], a[0:3], v[52:55], 0
 s_cmp_lt_u32 s45, s36
 s_cselect_b32 s46, s46, 0
 v_mfma_f32_16x16x32_bf16 v[108:111], a[72:75], v[52:55], 0
 s_lshl_b32 s49, s4, 10
 s_add_u32 s49, s49, s44
 v_mfma_f32_16x16x32_bf16 v[116:119], v[52:55], a[144:147], 0
 v_mul_f32 v64, s50, v64
 v_mul_f32 v65, s50, v65
 v_mfma_f32_16x16x32_bf16 v[124:127], v[52:55], a[216:219], 0
 s_waitcnt lgkmcnt(2)
 v_mfma_f32_16x16x32_bf16 v[96:99], a[4:7], v[56:59], v[96:99]
 ds_read_b128 v[40:43], v7 offset:4096
 v_mul_f32 v66, s50, v66
 v_mfma_f32_16x16x32_bf16 v[104:107], a[76:79], v[56:59], v[104:107]
 ds_read_b128 v[44:47], v7 offset:6144
 v_mul_f32 v67, s50, v67
 v_mfma_f32_16x16x32_bf16 v[112:115], v[56:59], a[148:151], v[112:115]
 v_mul_f32 v72, s50, v72
 v_mfma_f32_16x16x32_bf16 v[120:123], v[56:59], a[220:223], v[120:123]
 v_mul_f32 v73, s50, v73
 v_mfma_f32_16x16x32_bf16 v[100:103], a[4:7], v[60:63], v[100:103]
 v_mul_f32 v74, s50, v74
 v_mul_f32 v75, s50, v75
 v_mfma_f32_16x16x32_bf16 v[108:111], a[76:79], v[60:63], v[108:111]
 v_cvt_pk_bf16_f32 v16, v64, v65
 v_mfma_f32_16x16x32_bf16 v[116:119], v[60:63], a[148:151], v[116:119]
 v_cvt_pk_bf16_f32 v17, v72, v73
 v_mfma_f32_16x16x32_bf16 v[124:127], v[60:63], a[220:223], v[124:127]
 s_waitcnt lgkmcnt(2)
 v_cvt_pk_bf16_f32 v18, v66, v67
 v_mfma_f32_16x16x32_bf16 v[96:99], a[8:11], v[32:35], v[96:99]
 ds_read_b128 v[48:51], v6 offset:8192
 v_cvt_pk_bf16_f32 v19, v74, v75
 v_mfma_f32_16x16x32_bf16 v[104:107], a[80:83], v[32:35], v[104:107]
 ds_read_b128 v[52:55], v6 offset:10240
 v_mfma_f32_16x16x32_bf16 v[112:115], v[32:35], a[152:155], v[112:115]
 buffer_store_dwordx4 v[16:19], v12, s[20:23], s47 offen offset:0 sc1
 v_mul_f32 v68, s50, v68
 v_mfma_f32_16x16x32_bf16 v[120:123], v[32:35], a[224:227], v[120:123]
 v_mul_f32 v69, s50, v69
 v_mfma_f32_16x16x32_bf16 v[100:103], a[8:11], v[36:39], v[100:103]
 v_mul_f32 v70, s50, v70
 v_mfma_f32_16x16x32_bf16 v[108:111], a[80:83], v[36:39], v[108:111]
 v_mul_f32 v71, s50, v71
 v_mul_f32 v76, s50, v76
 v_mfma_f32_16x16x32_bf16 v[116:119], v[36:39], a[152:155], v[116:119]
 v_mul_f32 v77, s50, v77
 v_mfma_f32_16x16x32_bf16 v[124:127], v[36:39], a[224:227], v[124:127]
 s_waitcnt lgkmcnt(2)
 v_mfma_f32_16x16x32_bf16 v[96:99], a[12:15], v[40:43], v[96:99]
 ds_read_b128 v[56:59], v7 offset:8192
 v_mul_f32 v78, s50, v78
 v_mfma_f32_16x16x32_bf16 v[104:107], a[84:87], v[40:43], v[104:107]
 ds_read_b128 v[60:63], v7 offset:10240
 v_mul_f32 v79, s50, v79
 v_mfma_f32_16x16x32_bf16 v[112:115], v[40:43], a[156:159], v[112:115]
 v_cvt_pk_bf16_f32 v20, v68, v69
 v_mfma_f32_16x16x32_bf16 v[120:123], v[40:43], a[228:231], v[120:123]
 v_cvt_pk_bf16_f32 v21, v76, v77
 v_mfma_f32_16x16x32_bf16 v[100:103], a[12:15], v[44:47], v[100:103]
 v_cvt_pk_bf16_f32 v22, v70, v71
 v_cvt_pk_bf16_f32 v23, v78, v79
 v_mfma_f32_16x16x32_bf16 v[108:111], a[84:87], v[44:47], v[108:111]
 buffer_store_dwordx4 v[20:23], v12, s[20:23], s47 offen offset:1024 sc1
 v_mfma_f32_16x16x32_bf16 v[116:119], v[44:47], a[156:159], v[116:119]
 v_cvt_pk_bf16_f32 v24, v80, v81
 v_mfma_f32_16x16x32_bf16 v[124:127], v[44:47], a[228:231], v[124:127]
 s_waitcnt lgkmcnt(2)
 v_cvt_pk_bf16_f32 v25, v84, v85
 v_mfma_f32_16x16x32_bf16 v[96:99], a[16:19], v[48:51], v[96:99]
 ds_read_b128 v[32:35], v6 offset:12288
 v_cvt_pk_bf16_f32 v26, v82, v83
 v_mfma_f32_16x16x32_bf16 v[104:107], a[88:91], v[48:51], v[104:107]
 ds_read_b128 v[36:39], v6 offset:14336
 v_mfma_f32_16x16x32_bf16 v[112:115], v[48:51], a[160:163], v[112:115]
 v_cvt_pk_bf16_f32 v27, v86, v87
 buffer_store_dwordx4 v[24:27], v12, s[20:23], s48 offen offset:0 sc1
 v_mfma_f32_16x16x32_bf16 v[120:123], v[48:51], a[232:235], v[120:123]
 v_cvt_pk_bf16_f32 v28, v88, v89
 v_mfma_f32_16x16x32_bf16 v[100:103], a[16:19], v[52:55], v[100:103]
 v_cvt_pk_bf16_f32 v29, v92, v93
 v_mfma_f32_16x16x32_bf16 v[108:111], a[88:91], v[52:55], v[108:111]
 v_cvt_pk_bf16_f32 v30, v90, v91
 v_cvt_pk_bf16_f32 v31, v94, v95
 v_mfma_f32_16x16x32_bf16 v[116:119], v[52:55], a[160:163], v[116:119]
 buffer_store_dwordx4 v[28:31], v12, s[20:23], s48 offen offset:1024 sc1
 v_mfma_f32_16x16x32_bf16 v[124:127], v[52:55], a[232:235], v[124:127]
 s_waitcnt lgkmcnt(2)
 v_mfma_f32_16x16x32_bf16 v[96:99], a[20:23], v[56:59], v[96:99]
 ds_read_b128 v[40:43], v7 offset:12288
 v_mfma_f32_16x16x32_bf16 v[104:107], a[92:95], v[56:59], v[104:107]
 ds_read_b128 v[44:47], v7 offset:14336
 v_mfma_f32_16x16x32_bf16 v[112:115], v[56:59], a[164:167], v[112:115]
 s_add_u32 m0, s49, 0
 v_mfma_f32_16x16x32_bf16 v[120:123], v[56:59], a[236:239], v[120:123]
 buffer_load_dwordx4 v10, s[8:11], s46 offen offset:0  lds
 v_mfma_f32_16x16x32_bf16 v[100:103], a[20:23], v[60:63], v[100:103]
 s_add_u32 m0, s49, 3968
 v_mfma_f32_16x16x32_bf16 v[108:111], a[92:95], v[60:63], v[108:111]
 buffer_load_dwordx4 v10, s[8:11], s46 offen offset:128  lds
 v_mfma_f32_16x16x32_bf16 v[116:119], v[60:63], a[164:167], v[116:119]
 v_mfma_f32_16x16x32_bf16 v[124:127], v[60:63], a[236:239], v[124:127]
 s_waitcnt lgkmcnt(2)
 v_mfma_f32_16x16x32_bf16 v[96:99], a[24:27], v[32:35], v[96:99]
 ds_read_b128 v[48:51], v6 offset:16384
 v_mfma_f32_16x16x32_bf16 v[104:107], a[96:99], v[32:35], v[104:107]
 ds_read_b128 v[52:55], v6 offset:18432
 v_mfma_f32_16x16x32_bf16 v[112:115], v[32:35], a[168:171], v[112:115]
 s_add_u32 m0, s49, 7936
 v_mfma_f32_16x16x32_bf16 v[120:123], v[32:35], a[240:243], v[120:123]
 buffer_load_dwordx4 v10, s[8:11], s46 offen offset:256  lds
 v_mfma_f32_16x16x32_bf16 v[100:103], a[24:27], v[36:39], v[100:103]
 s_add_u32 m0, s49, 11904
 v_mfma_f32_16x16x32_bf16 v[108:111], a[96:99], v[36:39], v[108:111]
 buffer_load_dwordx4 v10, s[8:11], s46 offen offset:384  lds
 v_mfma_f32_16x16x32_bf16 v[116:119], v[36:39], a[168:171], v[116:119]
 v_mfma_f32_16x16x32_bf16 v[124:127], v[36:39], a[240:243], v[124:127]
 s_waitcnt lgkmcnt(2)
 v_mfma_f32_16x16x32_bf16 v[96:99], a[28:31], v[40:43], v[96:99]
 ds_read_b128 v[56:59], v7 offset:16384
 v_mfma_f32_16x16x32_bf16 v[104:107], a[100:103], v[40:43], v[104:107]
 ds_read_b128 v[60:63], v7 offset:18432
 v_mfma_f32_16x16x32_bf16 v[112:115], v[40:43], a[172:175], v[112:115]
 s_add_u32 m0, s49, 15872
 v_mfma_f32_16x16x32_bf16 v[120:123], v[40:43], a[244:247], v[120:123]
 buffer_load_dwordx4 v10, s[8:11], s46 offen offset:512  lds
 v_mfma_f32_16x16x32_bf16 v[100:103], a[28:31], v[44:47], v[100:103]
 s_add_u32 m0, s49, 19840
 v_mfma_f32_16x16x32_bf16 v[108:111], a[100:103], v[44:47], v[108:111]
 buffer_load_dwordx4 v10, s[8:11], s46 offen offset:640  lds
 v_mfma_f32_16x16x32_bf16 v[116:119], v[44:47], a[172:175], v[116:119]
 v_mfma_f32_16x16x32_bf16 v[124:127], v[44:47], a[244:247], v[124:127]
 s_waitcnt lgkmcnt(2)
 v_mfma_f32_16x16x32_bf16 v[96:99], a[32:35], v[48:51], v[96:99]
 ds_read_b128 v[32:35], v6 offset:20480
 v_mfma_f32_16x16x32_bf16 v[104:107], a[104:107], v[48:51], v[104:107]
 ds_read_b128 v[36:39], v6 offset:22528
 v_mfma_f32_16x16x32_bf16 v[112:115], v[48:51], a[176:179], v[112:115]
 s_add_u32 m0, s49, 23808
 v_mfma_f32_16x16x32_bf16 v[120:123], v[48:51], a[248:251], v[120:123]
 buffer_load_dwordx4 v10, s[8:11], s46 offen offset:768  lds
 v_mfma_f32_16x16x32_bf16 v[100:103], a[32:35], v[52:55], v[100:103]
 s_add_u32 m0, s49, 27776
 v_mfma_f32_16x16x32_bf16 v[108:111], a[104:107], v[52:55], v[108:111]
 buffer_load_dwordx4 v10, s[8:11], s46 offen offset:896  lds
 v_mfma_f32_16x16x32_bf16 v[116:119], v[52:55], a[176:179], v[116:119]
 v_mfma_f32_16x16x32_bf16 v[124:127], v[52:55], a[248:251], v[124:127]
 s_waitcnt lgkmcnt(2)
 v_mfma_f32_16x16x32_bf16 v[96:99], a[36:39], v[56:59], v[96:99]
 ds_read_b128 v[40:43], v7 offset:20480
 v_mfma_f32_16x16x32_bf16 v[104:107], a[108:111], v[56:59], v[104:107]
 ds_read_b128 v[44:47], v7 offset:22528
 v_mfma_f32_16x16x32_bf16 v[112:115], v[56:59], a[180:183], v[112:115]
 s_add_u32 m0, s49, 31744
 v_mfma_f32_16x16x32_bf16 v[120:123], v[56:59], a[252:255], v[120:123]
 buffer_load_dwordx4 v10, s[8:11], s46 offen offset:1024  lds
 v_mfma_f32_16x16x32_bf16 v[100:103], a[36:39], v[60:63], v[100:103]
 v_mfma_f32_16x16x32_bf16 v[108:111], a[108:111], v[60:63], v[108:111]
 v_mfma_f32_16x16x32_bf16 v[116:119], v[60:63], a[180:183], v[116:119]
 v_mfma_f32_16x16x32_bf16 v[124:127], v[60:63], a[252:255], v[124:127]
 s_waitcnt lgkmcnt(2)
 v_mfma_f32_16x16x32_bf16 v[96:99], a[40:43], v[32:35], v[96:99]
 ds_read_b128 v[48:51], v6 offset:24576
 v_mfma_f32_16x16x32_bf16 v[104:107], a[112:115], v[32:35], v[104:107]
 ds_read_b128 v[52:55], v6 offset:26624
 v_mfma_f32_16x16x32_bf16 v[112:115], v[32:35], a[184:187], v[112:115]
 v_mfma_f32_16x16x32_bf16 v[120:123], v[32:35], v[224:227], v[120:123]
 v_mfma_f32_16x16x32_bf16 v[100:103], a[40:43], v[36:39], v[100:103]
 v_mfma_f32_16x16x32_bf16 v[108:111], a[112:115], v[36:39], v[108:111]
 v_mfma_f32_16x16x32_bf16 v[116:119], v[36:39], a[184:187], v[116:119]
 v_mfma_f32_16x16x32_bf16 v[124:127], v[36:39], v[224:227], v[124:127]
 s_waitcnt lgkmcnt(2)
 v_mfma_f32_16x16x32_bf16 v[96:99], a[44:47], v[40:43], v[96:99]
 ds_read_b128 v[56:59], v7 offset:24576
 v_mfma_f32_16x16x32_bf16 v[104:107], a[116:119], v[40:43], v[104:107]
 ds_read_b128 v[60:63], v7 offset:26624
 v_mfma_f32_16x16x32_bf16 v[112:115], v[40:43], a[188:191], v[112:115]
 v_mfma_f32_16x16x32_bf16 v[120:123], v[40:43], v[228:231], v[120:123]
 v_mfma_f32_16x16x32_bf16 v[100:103], a[44:47], v[44:47], v[100:103]
 v_mfma_f32_16x16x32_bf16 v[108:111], a[116:119], v[44:47], v[108:111]
 v_mfma_f32_16x16x32_bf16 v[116:119], v[44:47], a[188:191], v[116:119]
 v_mfma_f32_16x16x32_bf16 v[124:127], v[44:47], v[228:231], v[124:127]
 s_waitcnt lgkmcnt(2)
 v_mfma_f32_16x16x32_bf16 v[96:99], a[48:51], v[48:51], v[96:99]
 ds_read_b128 v[32:35], v6 offset:28672
 v_mfma_f32_16x16x32_bf16 v[104:107], a[120:123], v[48:51], v[104:107]
 ds_read_b128 v[36:39], v6 offset:30720
 v_mfma_f32_16x16x32_bf16 v[112:115], v[48:51], a[192:195], v[112:115]
 v_mfma_f32_16x16x32_bf16 v[120:123], v[48:51], v[232:235], v[120:123]
 v_mfma_f32_16x16x32_bf16 v[100:103], a[48:51], v[52:55], v[100:103]
 v_mfma_f32_16x16x32_bf16 v[108:111], a[120:123], v[52:55], v[108:111]
 v_mfma_f32_16x16x32_bf16 v[116:119], v[52:55], a[192:195], v[116:119]
 v_mfma_f32_16x16x32_bf16 v[124:127], v[52:55], v[232:235], v[124:127]
 s_waitcnt lgkmcnt(2)
 v_mfma_f32_16x16x32_bf16 v[96:99], a[52:55], v[56:59], v[96:99]
 ds_read_b128 v[40:43], v7 offset:28672
 v_mfma_f32_16x16x32_bf16 v[104:107], a[124:127], v[56:59], v[104:107]
 ds_read_b128 v[44:47], v7 offset:30720
 v_mfma_f32_16x16x32_bf16 v[112:115], v[56:59], a[196:199], v[112:115]
 s_add_u32 s43, s43, 36864
 s_cmp_eq_u32 s43, 147456
 v_mfma_f32_16x16x32_bf16 v[120:123], v[56:59], v[236:239], v[120:123]
 s_cselect_b32 s43, 0, s43
 s_add_u32 s44, s44, 36864
 v_mfma_f32_16x16x32_bf16 v[100:103], a[52:55], v[60:63], v[100:103]
 s_cmp_eq_u32 s44, 147456
 s_cselect_b32 s44, 0, s44
 v_mfma_f32_16x16x32_bf16 v[108:111], a[124:127], v[60:63], v[108:111]
 v_mfma_f32_16x16x32_bf16 v[116:119], v[60:63], a[196:199], v[116:119]
 v_mfma_f32_16x16x32_bf16 v[124:127], v[60:63], v[236:239], v[124:127]
 s_waitcnt lgkmcnt(2)
 v_mfma_f32_16x16x32_bf16 v[96:99], a[56:59], v[32:35], v[96:99]
 ds_read_b128 v[48:51], v6 offset:32768
 v_mfma_f32_16x16x32_bf16 v[104:107], a[128:131], v[32:35], v[104:107]
 ds_read_b128 v[52:55], v6 offset:34816
 v_mfma_f32_16x16x32_bf16 v[112:115], v[32:35], a[200:203], v[112:115]
 v_add_u32 v6, s43, v4
 v_mfma_f32_16x16x32_bf16 v[120:123], v[32:35], v[240:243], v[120:123]
 v_mfma_f32_16x16x32_bf16 v[100:103], a[56:59], v[36:39], v[100:103]
 v_mfma_f32_16x16x32_bf16 v[108:111], a[128:131], v[36:39], v[108:111]
 v_mfma_f32_16x16x32_bf16 v[116:119], v[36:39], a[200:203], v[116:119]
 v_mfma_f32_16x16x32_bf16 v[124:127], v[36:39], v[240:243], v[124:127]
 s_waitcnt lgkmcnt(2)
 v_mfma_f32_16x16x32_bf16 v[96:99], a[60:63], v[40:43], v[96:99]
 ds_read_b128 v[56:59], v7 offset:32768
 v_mfma_f32_16x16x32_bf16 v[104:107], a[132:135], v[40:43], v[104:107]
 ds_read_b128 v[60:63], v7 offset:34816
 v_mfma_f32_16x16x32_bf16 v[112:115], v[40:43], a[204:207], v[112:115]
 v_add_u32 v7, s43, v5
 v_mfma_f32_16x16x32_bf16 v[120:123], v[40:43], v[244:247], v[120:123]
 v_mfma_f32_16x16x32_bf16 v[100:103], a[60:63], v[44:47], v[100:103]
 v_mfma_f32_16x16x32_bf16 v[108:111], a[132:135], v[44:47], v[108:111]
 v_mfma_f32_16x16x32_bf16 v[116:119], v[44:47], a[204:207], v[116:119]
 v_mfma_f32_16x16x32_bf16 v[124:127], v[44:47], v[244:247], v[124:127]
 s_waitcnt lgkmcnt(2)
 v_mfma_f32_16x16x32_bf16 v[96:99], a[64:67], v[48:51], v[96:99]
 s_waitcnt vmcnt(9)
 s_barrier
 ds_read_b128 v[32:35], v6 offset:0
 v_mfma_f32_16x16x32_bf16 v[104:107], a[136:139], v[48:51], v[104:107]
 ds_read_b128 v[36:39], v6 offset:2048
 v_mfma_f32_16x16x32_bf16 v[112:115], v[48:51], a[208:211], v[112:115]
 buffer_store_dword v14, v13, s[20:23], 0 offen sc1
 v_mfma_f32_16x16x32_bf16 v[120:123], v[48:51], v[248:251], v[120:123]
 v_mfma_f32_16x16x32_bf16 v[100:103], a[64:67], v[52:55], v[100:103]
 v_mfma_f32_16x16x32_bf16 v[108:111], a[136:139], v[52:55], v[108:111]
 v_mfma_f32_16x16x32_bf16 v[116:119], v[52:55], a[208:211], v[116:119]
 v_mfma_f32_16x16x32_bf16 v[124:127], v[52:55], v[248:251], v[124:127]
 s_waitcnt lgkmcnt(2)
 v_mfma_f32_16x16x32_bf16 v[96:99], a[68:71], v[56:59], v[96:99]
 ds_read_b128 v[40:43], v7 offset:0
 v_mfma_f32_16x16x32_bf16 v[104:107], a[140:143], v[56:59], v[104:107]
 ds_read_b128 v[44:47], v7 offset:2048
 v_mfma_f32_16x16x32_bf16 v[112:115], v[56:59], a[212:215], v[112:115]
 s_mul_i32 s45, s39, 524288
 s_add_u32 s47, s34, s45
 v_mfma_f32_16x16x32_bf16 v[120:123], v[56:59], v[252:255], v[120:123]
 s_add_u32 s48, s35, s45
 v_add_u32 v14, 1, v14
 v_mfma_f32_16x16x32_bf16 v[100:103], a[68:71], v[60:63], v[100:103]
 s_mov_b32 s39, s40
 s_mov_b32 s40, s41
 v_mfma_f32_16x16x32_bf16 v[108:111], a[140:143], v[60:63], v[108:111]
 s_add_u32 s42, s42, 1
 s_cmp_lt_u32 s42, s36
 v_mfma_f32_16x16x32_bf16 v[116:119], v[60:63], a[212:215], v[116:119]
 v_mfma_f32_16x16x32_bf16 v[124:127], v[60:63], v[252:255], v[124:127]
 s_waitcnt lgkmcnt(2)
 s_cbranch_scc1 Lps_loop_18
 s_nop 7
 v_mul_f32 v96, s50, v96
 v_mul_f32 v97, s50, v97
 v_mul_f32 v98, s50, v98
 v_mul_f32 v99, s50, v99
 v_mul_f32 v104, s50, v104
 v_mul_f32 v105, s50, v105
 v_mul_f32 v106, s50, v106
 v_mul_f32 v107, s50, v107
 v_cvt_pk_bf16_f32 v16, v96, v97
 v_cvt_pk_bf16_f32 v17, v104, v105
 v_cvt_pk_bf16_f32 v18, v98, v99
 v_cvt_pk_bf16_f32 v19, v106, v107
 buffer_store_dwordx4 v[16:19], v12, s[20:23], s47 offen offset:0 sc1
 v_mul_f32 v100, s50, v100
 v_mul_f32 v101, s50, v101
 v_mul_f32 v102, s50, v102
 v_mul_f32 v103, s50, v103
 v_mul_f32 v108, s50, v108
 v_mul_f32 v109, s50, v109
 v_mul_f32 v110, s50, v110
 v_mul_f32 v111, s50, v111
 v_cvt_pk_bf16_f32 v20, v100, v101
 v_cvt_pk_bf16_f32 v21, v108, v109
 v_cvt_pk_bf16_f32 v22, v102, v103
 v_cvt_pk_bf16_f32 v23, v110, v111
 buffer_store_dwordx4 v[20:23], v12, s[20:23], s47 offen offset:1024 sc1
 v_cvt_pk_bf16_f32 v24, v112, v113
 v_cvt_pk_bf16_f32 v25, v116, v117
 v_cvt_pk_bf16_f32 v26, v114, v115
 v_cvt_pk_bf16_f32 v27, v118, v119
 buffer_store_dwordx4 v[24:27], v12, s[20:23], s48 offen offset:0 sc1
 v_cvt_pk_bf16_f32 v28, v120, v121
 v_cvt_pk_bf16_f32 v29, v124, v125
 v_cvt_pk_bf16_f32 v30, v122, v123
 v_cvt_pk_bf16_f32 v31, v126, v127
 buffer_store_dwordx4 v[28:31], v12, s[20:23], s48 offen offset:1024 sc1
 s_waitcnt vmcnt(0) lgkmcnt(0)
 s_barrier
 v_mov_b32 v14, s36
 buffer_store_dword v14, v13, s[20:23], 0 offen sc1
 s_branch Lfin
Lqa:
 s_load_dwordx2 s[8:9], s[0:1], 0
 s_mov_b32 s10, 0x240000
 s_mov_b32 s11, 0x20000
 s_load_dwordx2 s[12:13], s[0:1], 16
 s_mov_b32 s14, 0x480000
 s_mov_b32 s15, 0x20000
 s_load_dwordx2 s[16:17], s[0:1], 16
 s_mov_b32 s18, 0x480000
 s_mov_b32 s19, 0x20000
 s_cmp_eq_u32 s2, 255
 s_cbranch_scc0 Lqa1
 v_mov_b32 v4, 0
 v_mov_b32 v5, 0
 v_mov_b32 v6, 0
 v_mov_b32 v7, 0
 v_lshlrev_b32 v1, 4, v0
 s_mov_b32 s7, 0
 buffer_store_dwordx4 v[4:7], v1, s[20:23], s7 offen sc1
 s_mov_b32 s7, 4096
 buffer_store_dwordx4 v[4:7], v1, s[20:23], s7 offen sc1
 s_mov_b32 s7, 8192
 buffer_store_dwordx4 v[4:7], v1, s[20:23], s7 offen sc1
 s_mov_b32 s7, 12288
 buffer_store_dwordx4 v[4:7], v1, s[20:23], s7 offen sc1
 s_mov_b32 s7, 16384
 buffer_store_dwordx4 v[4:7], v1, s[20:23], s7 offen sc1
 v_min_u32 v1, 1, v0
 v_lshlrev_b32 v1, 28, v1
 v_mov_b32 v2, 1
 s_waitcnt vmcnt(0)
 s_barrier
 buffer_store_dword v2, v1, s[28:31], 0 offen sc1
Lqa1:
 s_sub_u32 s3, s5, 2
 s_lshl_b32 s3, s3, 3
 s_lshr_b32 s7, s6, 2
 s_add_u32 s3, s3, s7
 s_lshl_b32 s32, s3, 9
 s_add_u32 s33, s32, 256
 s_lshl_b32 s34, s3, 14
 s_add_u32 s34, s34, 0x5000000
 s_add_u32 s35, s34, 8192
 s_mov_b32 s36, 16
 s_and_b32 s37, s6, 3
 s_lshl_b32 s7, s3, 5
 s_add_u32 s7, s7, s37
 s_lshl_b32 s7, s7, 2
 s_add_u32 s7, s7, 0x3000
 v_min_u32 v1, 1, v0
 v_lshlrev_b32 v1, 28, v1
 v_add_u32 v13, s7, v1
 s_waitcnt lgkmcnt(0)
 v_and_b32 v1, 63, v0
 v_lshrrev_b32 v2, 3, v0
 v_mul_u32_u24 v10, 1152, v2
 v_lshrrev_b32 v2, 4, v0
 v_xor_b32 v2, v2, v0
 v_and_b32 v2, 7, v2
 v_lshl_add_u32 v10, v2, 4, v10
 v_lshrrev_b32 v2, 4, v1
 v_bfe_u32 v3, v1, 1, 3
 v_xor_b32 v2, v2, v3
 v_and_b32 v3, 15, v1
 v_lshlrev_b32 v3, 7, v3
 v_lshl_add_u32 v4, v2, 4, v3
 v_xor_b32 v5, 64, v4
 v_lshrrev_b32 v2, 4, v0
 v_lshlrev_b32 v11, 13, v2
 v_lshrrev_b32 v2, 7, v0
 v_lshrrev_b32 v3, 4, v1
 v_lshl_add_u32 v3, v2, 2, v3
 v_bfe_u32 v2, v1, 1, 3
 v_xor_b32 v2, v2, v3
 v_lshl_add_u32 v11, v2, 5, v11
 v_and_b32 v2, 1, v1
 v_lshl_add_u32 v11, v2, 4, v11
 v_bfe_u32 v2, v1, 2, 3
 v_xor_b32 v3, s4, v2
 v_lshlrev_b32 v3, 5, v3
 v_and_b32 v2, 3, v2
 v_lshl_add_u32 v3, v2, 8, v3
 v_lshrrev_b32 v2, 4, v1
 v_lshl_add_u32 v3, v2, 11, v3
 v_and_b32 v2, 3, v1
 v_lshl_add_u32 v3, v2, 3, v3
 v_add_u32 v8, 73728, v3
 v_xor_b32 v3, 0x80, v3
 v_add_u32 v9, 73728, v3
 s_lshl_b32 s45, s4, 11
 v_lshl_add_u32 v12, v1, 4, s45
 s_mov_b32 s39, s37
 s_add_u32 s40, s39, 4
 s_lshl_b32 s49, s4, 10
 s_mul_i32 s46, s39, 36864
 s_add_u32 m0, s49, 0
 s_nop 0
 buffer_load_dwordx4 v10, s[8:11], s46 offen offset:0  lds
 s_add_u32 m0, s49, 3968
 s_nop 0
 buffer_load_dwordx4 v10, s[8:11], s46 offen offset:128  lds
 s_add_u32 m0, s49, 7936
 s_nop 0
 buffer_load_dwordx4 v10, s[8:11], s46 offen offset:256  lds
 s_add_u32 m0, s49, 11904
 s_nop 0
 buffer_load_dwordx4 v10, s[8:11], s46 offen offset:384  lds
 s_add_u32 m0, s49, 15872
 s_nop 0
 buffer_load_dwordx4 v10, s[8:11], s46 offen offset:512  lds
 s_add_u32 m0, s49, 19840
 s_nop 0
 buffer_load_dwordx4 v10, s[8:11], s46 offen offset:640  lds
 s_add_u32 m0, s49, 23808
 s_nop 0
 buffer_load_dwordx4 v10, s[8:11], s46 offen offset:768  lds
 s_add_u32 m0, s49, 27776
 s_nop 0
 buffer_load_dwordx4 v10, s[8:11], s46 offen offset:896  lds
 s_add_u32 m0, s49, 31744
 s_nop 0
 buffer_load_dwordx4 v10, s[8:11], s46 offen offset:1024  lds
 s_lshl_b32 s49, s4, 10
 s_add_u32 s49, s49, 36864
 s_mul_i32 s46, s40, 36864
 s_add_u32 m0, s49, 0
 s_nop 0
 buffer_load_dwordx4 v10, s[8:11], s46 offen offset:0  lds
 s_add_u32 m0, s49, 3968
 s_nop 0
 buffer_load_dwordx4 v10, s[8:11], s46 offen offset:128  lds
 s_add_u32 m0, s49, 7936
 s_nop 0
 buffer_load_dwordx4 v10, s[8:11], s46 offen offset:256  lds
 s_add_u32 m0, s49, 11904
 s_nop 0
 buffer_load_dwordx4 v10, s[8:11], s46 offen offset:384  lds
 s_add_u32 m0, s49, 15872
 s_nop 0
 buffer_load_dwordx4 v10, s[8:11], s46 offen offset:512  lds
 s_add_u32 m0, s49, 19840
 s_nop 0
 buffer_load_dwordx4 v10, s[8:11], s46 offen offset:640  lds
 s_add_u32 m0, s49, 23808
 s_nop 0
 buffer_load_dwordx4 v10, s[8:11], s46 offen offset:768  lds
 s_add_u32 m0, s49, 27776
 s_nop 0
 buffer_load_dwordx4 v10, s[8:11], s46 offen offset:896  lds
 s_add_u32 m0, s49, 31744
 s_nop 0
 buffer_load_dwordx4 v10, s[8:11], s46 offen offset:1024  lds
 s_lshl_b32 s49, s4, 10
 s_add_u32 m0, s49, 73728
 s_add_u32 s45, s32, 0
 buffer_load_dwordx4 v11, s[12:15], s45 offen  lds
 s_add_u32 m0, s49, 77824
 s_add_u32 s45, s32, 131072
 buffer_load_dwordx4 v11, s[12:15], s45 offen  lds
 s_add_u32 m0, s49, 81920
 s_add_u32 s45, s33, 0
 buffer_load_dwordx4 v11, s[16:19], s45 offen  lds
 s_add_u32 m0, s49, 86016
 s_add_u32 s45, s33, 131072
 buffer_load_dwordx4 v11, s[16:19], s45 offen  lds
 s_add_u32 m0, s49, 90112
 s_add_u32 s45, s32, 262144
 buffer_load_dwordx4 v11, s[12:15], s45 offen  lds
 s_add_u32 m0, s49, 94208
 s_add_u32 s45, s32, 393216
 buffer_load_dwordx4 v11, s[12:15], s45 offen  lds
 s_add_u32 m0, s49, 98304
 s_add_u32 s45, s33, 262144
 buffer_load_dwordx4 v11, s[16:19], s45 offen  lds
 s_add_u32 m0, s49, 102400
 s_add_u32 s45, s33, 393216
 buffer_load_dwordx4 v11, s[16:19], s45 offen  lds
 s_add_u32 m0, s49, 106496
 s_add_u32 s45, s32, 524288
 buffer_load_dwordx4 v11, s[12:15], s45 offen  lds
 s_add_u32 m0, s49, 110592
 s_add_u32 s45, s32, 655360
 buffer_load_dwordx4 v11, s[12:15], s45 offen  lds
 s_add_u32 m0, s49, 114688
 s_add_u32 s45, s33, 524288
 buffer_load_dwordx4 v11, s[16:19], s45 offen  lds
 s_add_u32 m0, s49, 118784
 s_add_u32 s45, s33, 655360
 buffer_load_dwordx4 v11, s[16:19], s45 offen  lds
 s_waitcnt vmcnt(8) lgkmcnt(0)
 s_barrier
 s_add_u32 m0, s49, 122880
 s_add_u32 s45, s32, 786432
 buffer_load_dwordx4 v11, s[12:15], s45 offen  lds
 s_add_u32 m0, s49, 126976
 s_add_u32 s45, s32, 917504
 buffer_load_dwordx4 v11, s[12:15], s45 offen  lds
 s_add_u32 m0, s49, 131072
 s_add_u32 s45, s33, 786432
 buffer_load_dwordx4 v11, s[16:19], s45 offen  lds
 s_add_u32 m0, s49, 135168
 s_add_u32 s45, s33, 917504
 buffer_load_dwordx4 v11, s[16:19], s45 offen  lds
 ds_read_b64_tr_b16 a[0:1], v8 offset:0
 ds_read_b64_tr_b16 a[2:3], v8 offset:1024
 ds_read_b64_tr_b16 a[72:73], v9 offset:0
 ds_read_b64_tr_b16 a[74:75], v9 offset:1024
 ds_read_b64_tr_b16 a[144:145], v8 offset:8192
 ds_read_b64_tr_b16 a[146:147], v8 offset:9216
 ds_read_b64_tr_b16 a[216:217], v9 offset:8192
 ds_read_b64_tr_b16 a[218:219], v9 offset:9216
 s_waitcnt vmcnt(8) lgkmcnt(0)
 s_barrier
 s_add_u32 m0, s49, 73728
 s_add_u32 s45, s32, 1048576
 buffer_load_dwordx4 v11, s[12:15], s45 offen  lds
 s_add_u32 m0, s49, 77824
 s_add_u32 s45, s32, 1179648
 buffer_load_dwordx4 v11, s[12:15], s45 offen  lds
 s_add_u32 m0, s49, 81920
 s_add_u32 s45, s33, 1048576
 buffer_load_dwordx4 v11, s[16:19], s45 offen  lds
 s_add_u32 m0, s49, 86016
 s_add_u32 s45, s33, 1179648
 buffer_load_dwordx4 v11, s[16:19], s45 offen  lds
 ds_read_b64_tr_b16 a[4:5], v8 offset:16384
 ds_read_b64_tr_b16 a[6:7], v8 offset:17408
 ds_read_b64_tr_b16 a[76:77], v9 offset:16384
 ds_read_b64_tr_b16 a[78:79], v9 offset:17408
 ds_read_b64_tr_b16 a[148:149], v8 offset:24576
 ds_read_b64_tr_b16 a[150:151], v8 offset:25600
 ds_read_b64_tr_b16 a[220:221], v9 offset:24576
 ds_read_b64_tr_b16 a[222:223], v9 offset:25600
 s_waitcnt vmcnt(8) lgkmcnt(0)
 s_barrier
 s_add_u32 m0, s49, 90112
 s_add_u32 s45, s32, 1310720
 buffer_load_dwordx4 v11, s[12:15], s45 offen  lds
 s_add_u32 m0, s49, 94208
 s_add_u32 s45, s32, 1441792
 buffer_load_dwordx4 v11, s[12:15], s45 offen  lds
 s_add_u32 m0, s49, 98304
 s_add_u32 s45, s33, 1310720
 buffer_load_dwordx4 v11, s[16:19], s45 offen  lds
 s_add_u32 m0, s49, 102400
 s_add_u32 s45, s33, 1441792
 buffer_load_dwordx4 v11, s[16:19], s45 offen  lds
 ds_read_b64_tr_b16 a[8:9], v8 offset:32768
 ds_read_b64_tr_b16 a[10:11], v8 offset:33792
 ds_read_b64_tr_b16 a[80:81], v9 offset:32768
 ds_read_b64_tr_b16 a[82:83], v9 offset:33792
 ds_read_b64_tr_b16 a[152:153], v8 offset:40960
 ds_read_b64_tr_b16 a[154:155], v8 offset:41984
 ds_read_b64_tr_b16 a[224:225], v9 offset:40960
 ds_read_b64_tr_b16 a[226:227], v9 offset:41984
 s_waitcnt vmcnt(8) lgkmcnt(0)
 s_barrier
 s_add_u32 m0, s49, 106496
 s_add_u32 s45, s32, 1572864
 buffer_load_dwordx4 v11, s[12:15], s45 offen  lds
 s_add_u32 m0, s49, 110592
 s_add_u32 s45, s32, 1703936
 buffer_load_dwordx4 v11, s[12:15], s45 offen  lds
 s_add_u32 m0, s49, 114688
 s_add_u32 s45, s33, 1572864
 buffer_load_dwordx4 v11, s[16:19], s45 offen  lds
 s_add_u32 m0, s49, 118784
 s_add_u32 s45, s33, 1703936
 buffer_load_dwordx4 v11, s[16:19], s45 offen  lds
 ds_read_b64_tr_b16 a[12:13], v8 offset:49152
 ds_read_b64_tr_b16 a[14:15], v8 offset:50176
 ds_read_b64_tr_b16 a[84:85], v9 offset:49152
 ds_read_b64_tr_b16 a[86:87], v9 offset:50176
 ds_read_b64_tr_b16 a[156:157], v8 offset:57344
 ds_read_b64_tr_b16 a[158:159], v8 offset:58368
 ds_read_b64_tr_b16 a[228:229], v9 offset:57344
 ds_read_b64_tr_b16 a[230:231], v9 offset:58368
 s_waitcnt vmcnt(8) lgkmcnt(0)
 s_barrier
 s_add_u32 m0, s49, 122880
 s_add_u32 s45, s32, 1835008
 buffer_load_dwordx4 v11, s[12:15], s45 offen  lds
 s_add_u32 m0, s49, 126976
 s_add_u32 s45, s32, 1966080
 buffer_load_dwordx4 v11, s[12:15], s45 offen  lds
 s_add_u32 m0, s49, 131072
 s_add_u32 s45, s33, 1835008
 buffer_load_dwordx4 v11, s[16:19], s45 offen  lds
 s_add_u32 m0, s49, 135168
 s_add_u32 s45, s33, 1966080
 buffer_load_dwordx4 v11, s[16:19], s45 offen  lds
 ds_read_b64_tr_b16 a[16:17], v8 offset:0
 ds_read_b64_tr_b16 a[18:19], v8 offset:1024
 ds_read_b64_tr_b16 a[88:89], v9 offset:0
 ds_read_b64_tr_b16 a[90:91], v9 offset:1024
 ds_read_b64_tr_b16 a[160:161], v8 offset:8192
 ds_read_b64_tr_b16 a[162:163], v8 offset:9216
 ds_read_b64_tr_b16 a[232:233], v9 offset:8192
 ds_read_b64_tr_b16 a[234:235], v9 offset:9216
 s_waitcnt vmcnt(8) lgkmcnt(0)
 s_barrier
 s_add_u32 m0, s49, 73728
 s_add_u32 s45, s32, 2097152
 buffer_load_dwordx4 v11, s[12:15], s45 offen  lds
 s_add_u32 m0, s49, 77824
 s_add_u32 s45, s32, 2228224
 buffer_load_dwordx4 v11, s[12:15], s45 offen  lds
 s_add_u32 m0, s49, 81920
 s_add_u32 s45, s33, 2097152
 buffer_load_dwordx4 v11, s[16:19], s45 offen  lds
 s_add_u32 m0, s49, 86016
 s_add_u32 s45, s33, 2228224
 buffer_load_dwordx4 v11, s[16:19], s45 offen  lds
 ds_read_b64_tr_b16 a[20:21], v8 offset:16384
 ds_read_b64_tr_b16 a[22:23], v8 offset:17408
 ds_read_b64_tr_b16 a[92:93], v9 offset:16384
 ds_read_b64_tr_b16 a[94:95], v9 offset:17408
 ds_read_b64_tr_b16 a[164:165], v8 offset:24576
 ds_read_b64_tr_b16 a[166:167], v8 offset:25600
 ds_read_b64_tr_b16 a[236:237], v9 offset:24576
 ds_read_b64_tr_b16 a[238:239], v9 offset:25600
 s_waitcnt vmcnt(8) lgkmcnt(0)
 s_barrier
 s_add_u32 m0, s49, 90112
 s_add_u32 s45, s32, 2359296
 buffer_load_dwordx4 v11, s[12:15], s45 offen  lds
 s_add_u32 m0, s49, 94208
 s_add_u32 s45, s32, 2490368
 buffer_load_dwordx4 v11, s[12:15], s45 offen  lds
 s_add_u32 m0, s49, 98304
 s_add_u32 s45, s33, 2359296
 buffer_load_dwordx4 v11, s[16:19], s45 offen  lds
 s_add_u32 m0, s49, 102400
 s_add_u32 s45, s33, 2490368
 buffer_load_dwordx4 v11, s[16:19], s45 offen  lds
 ds_read_b64_tr_b16 a[24:25], v8 offset:32768
 ds_read_b64_tr_b16 a[26:27], v8 offset:33792
 ds_read_b64_tr_b16 a[96:97], v9 offset:32768
 ds_read_b64_tr_b16 a[98:99], v9 offset:33792
 ds_read_b64_tr_b16 a[168:169], v8 offset:40960
 ds_read_b64_tr_b16 a[170:171], v8 offset:41984
 ds_read_b64_tr_b16 a[240:241], v9 offset:40960
 ds_read_b64_tr_b16 a[242:243], v9 offset:41984
 s_waitcnt vmcnt(8) lgkmcnt(0)
 s_barrier
 s_add_u32 m0, s49, 106496
 s_add_u32 s45, s32, 2621440
 buffer_load_dwordx4 v11, s[12:15], s45 offen  lds
 s_add_u32 m0, s49, 110592
 s_add_u32 s45, s32, 2752512
 buffer_load_dwordx4 v11, s[12:15], s45 offen  lds
 s_add_u32 m0, s49, 114688
 s_add_u32 s45, s33, 2621440
 buffer_load_dwordx4 v11, s[16:19], s45 offen  lds
 s_add_u32 m0, s49, 118784
 s_add_u32 s45, s33, 2752512
 buffer_load_dwordx4 v11, s[16:19], s45 offen  lds
 ds_read_b64_tr_b16 a[28:29], v8 offset:49152
 ds_read_b64_tr_b16 a[30:31], v8 offset:50176
 ds_read_b64_tr_b16 a[100:101], v9 offset:49152
 ds_read_b64_tr_b16 a[102:103], v9 offset:50176
 ds_read_b64_tr_b16 a[172:173], v8 offset:57344
 ds_read_b64_tr_b16 a[174:175], v8 offset:58368
 ds_read_b64_tr_b16 a[244:245], v9 offset:57344
 ds_read_b64_tr_b16 a[246:247], v9 offset:58368
 s_waitcnt vmcnt(8) lgkmcnt(0)
 s_barrier
 s_add_u32 m0, s49, 122880
 s_add_u32 s45, s32, 2883584
 buffer_load_dwordx4 v11, s[12:15], s45 offen  lds
 s_add_u32 m0, s49, 126976
 s_add_u32 s45, s32, 3014656
 buffer_load_dwordx4 v11, s[12:15], s45 offen  lds
 s_add_u32 m0, s49, 131072
 s_add_u32 s45, s33, 2883584
 buffer_load_dwordx4 v11, s[16:19], s45 offen  lds
 s_add_u32 m0, s49, 135168
 s_add_u32 s45, s33, 3014656
 buffer_load_dwordx4 v11, s[16:19], s45 offen  lds
 ds_read_b64_tr_b16 a[32:33], v8 offset:0
 ds_read_b64_tr_b16 a[34:35], v8 offset:1024
 ds_read_b64_tr_b16 a[104:105], v9 offset:0
 ds_read_b64_tr_b16 a[106:107], v9 offset:1024
 ds_read_b64_tr_b16 a[176:177], v8 offset:8192
 ds_read_b64_tr_b16 a[178:179], v8 offset:9216
 ds_read_b64_tr_b16 a[248:249], v9 offset:8192
 ds_read_b64_tr_b16 a[250:251], v9 offset:9216
 s_waitcnt vmcnt(8) lgkmcnt(0)
 s_barrier
 s_add_u32 m0, s49, 73728
 s_add_u32 s45, s32, 3145728
 buffer_load_dwordx4 v11, s[12:15], s45 offen  lds
 s_add_u32 m0, s49, 77824
 s_add_u32 s45, s32, 3276800
 buffer_load_dwordx4 v11, s[12:15], s45 offen  lds
 s_add_u32 m0, s49, 81920
 s_add_u32 s45, s33, 3145728
 buffer_load_dwordx4 v11, s[16:19], s45 offen  lds
 s_add_u32 m0, s49, 86016
 s_add_u32 s45, s33, 3276800
 buffer_load_dwordx4 v11, s[16:19], s45 offen  lds
 ds_read_b64_tr_b16 a[36:37], v8 offset:16384
 ds_read_b64_tr_b16 a[38:39], v8 offset:17408
 ds_read_b64_tr_b16 a[108:109], v9 offset:16384
 ds_read_b64_tr_b16 a[110:111], v9 offset:17408
 ds_read_b64_tr_b16 a[180:181], v8 offset:24576
 ds_read_b64_tr_b16 a[182:183], v8 offset:25600
 ds_read_b64_tr_b16 a[252:253], v9 offset:24576
 ds_read_b64_tr_b16 a[254:255], v9 offset:25600
 s_waitcnt vmcnt(8) lgkmcnt(0)
 s_barrier
 s_add_u32 m0, s49, 90112
 s_add_u32 s45, s32, 3407872
 buffer_load_dwordx4 v11, s[12:15], s45 offen  lds
 s_add_u32 m0, s49, 94208
 s_add_u32 s45, s32, 3538944
 buffer_load_dwordx4 v11, s[12:15], s45 offen  lds
 s_add_u32 m0, s49, 98304
 s_add_u32 s45, s33, 3407872
 buffer_load_dwordx4 v11, s[16:19], s45 offen  lds
 s_add_u32 m0, s49, 102400
 s_add_u32 s45, s33, 3538944
 buffer_load_dwordx4 v11, s[16:19], s45 offen  lds
 ds_read_b64_tr_b16 a[40:41], v8 offset:32768
 ds_read_b64_tr_b16 a[42:43], v8 offset:33792
 ds_read_b64_tr_b16 a[112:113], v9 offset:32768
 ds_read_b64_tr_b16 a[114:115], v9 offset:33792
 ds_read_b64_tr_b16 a[184:185], v8 offset:40960
 ds_read_b64_tr_b16 a[186:187], v8 offset:41984
 ds_read_b64_tr_b16 v[224:225], v9 offset:40960
 ds_read_b64_tr_b16 v[226:227], v9 offset:41984
 s_waitcnt vmcnt(8) lgkmcnt(0)
 s_barrier
 s_add_u32 m0, s49, 106496
 s_add_u32 s45, s32, 3670016
 buffer_load_dwordx4 v11, s[12:15], s45 offen  lds
 s_add_u32 m0, s49, 110592
 s_add_u32 s45, s32, 3801088
 buffer_load_dwordx4 v11, s[12:15], s45 offen  lds
 s_add_u32 m0, s49, 114688
 s_add_u32 s45, s33, 3670016
 buffer_load_dwordx4 v11, s[16:19], s45 offen  lds
 s_add_u32 m0, s49, 118784
 s_add_u32 s45, s33, 3801088
 buffer_load_dwordx4 v11, s[16:19], s45 offen  lds
 ds_read_b64_tr_b16 a[44:45], v8 offset:49152
 ds_read_b64_tr_b16 a[46:47], v8 offset:50176
 ds_read_b64_tr_b16 a[116:117], v9 offset:49152
 ds_read_b64_tr_b16 a[118:119], v9 offset:50176
 ds_read_b64_tr_b16 a[188:189], v8 offset:57344
 ds_read_b64_tr_b16 a[190:191], v8 offset:58368
 ds_read_b64_tr_b16 v[228:229], v9 offset:57344
 ds_read_b64_tr_b16 v[230:231], v9 offset:58368
 s_waitcnt vmcnt(8) lgkmcnt(0)
 s_barrier
 s_add_u32 m0, s49, 122880
 s_add_u32 s45, s32, 3932160
 buffer_load_dwordx4 v11, s[12:15], s45 offen  lds
 s_add_u32 m0, s49, 126976
 s_add_u32 s45, s32, 4063232
 buffer_load_dwordx4 v11, s[12:15], s45 offen  lds
 s_add_u32 m0, s49, 131072
 s_add_u32 s45, s33, 3932160
 buffer_load_dwordx4 v11, s[16:19], s45 offen  lds
 s_add_u32 m0, s49, 135168
 s_add_u32 s45, s33, 4063232
 buffer_load_dwordx4 v11, s[16:19], s45 offen  lds
 ds_read_b64_tr_b16 a[48:49], v8 offset:0
 ds_read_b64_tr_b16 a[50:51], v8 offset:1024
 ds_read_b64_tr_b16 a[120:121], v9 offset:0
 ds_read_b64_tr_b16 a[122:123], v9 offset:1024
 ds_read_b64_tr_b16 a[192:193], v8 offset:8192
 ds_read_b64_tr_b16 a[194:195], v8 offset:9216
 ds_read_b64_tr_b16 v[232:233], v9 offset:8192
 ds_read_b64_tr_b16 v[234:235], v9 offset:9216
 s_waitcnt vmcnt(8) lgkmcnt(0)
 s_barrier
 s_add_u32 m0, s49, 73728
 s_add_u32 s45, s32, 4194304
 buffer_load_dwordx4 v11, s[12:15], s45 offen  lds
 s_add_u32 m0, s49, 77824
 s_add_u32 s45, s32, 4325376
 buffer_load_dwordx4 v11, s[12:15], s45 offen  lds
 s_add_u32 m0, s49, 81920
 s_add_u32 s45, s33, 4194304
 buffer_load_dwordx4 v11, s[16:19], s45 offen  lds
 s_add_u32 m0, s49, 86016
 s_add_u32 s45, s33, 4325376
 buffer_load_dwordx4 v11, s[16:19], s45 offen  lds
 ds_read_b64_tr_b16 a[52:53], v8 offset:16384
 ds_read_b64_tr_b16 a[54:55], v8 offset:17408
 ds_read_b64_tr_b16 a[124:125], v9 offset:16384
 ds_read_b64_tr_b16 a[126:127], v9 offset:17408
 ds_read_b64_tr_b16 a[196:197], v8 offset:24576
 ds_read_b64_tr_b16 a[198:199], v8 offset:25600
 ds_read_b64_tr_b16 v[236:237], v9 offset:24576
 ds_read_b64_tr_b16 v[238:239], v9 offset:25600
 s_waitcnt vmcnt(8) lgkmcnt(0)
 s_barrier
 s_add_u32 m0, s49, 90112
 s_add_u32 s45, s32, 4456448
 buffer_load_dwordx4 v11, s[12:15], s45 offen  lds
 s_add_u32 m0, s49, 94208
 s_add_u32 s45, s32, 4587520
 buffer_load_dwordx4 v11, s[12:15], s45 offen  lds
 s_add_u32 m0, s49, 98304
 s_add_u32 s45, s33, 4456448
 buffer_load_dwordx4 v11, s[16:19], s45 offen  lds
 s_add_u32 m0, s49, 102400
 s_add_u32 s45, s33, 4587520
 buffer_load_dwordx4 v11, s[16:19], s45 offen  lds
 ds_read_b64_tr_b16 a[56:57], v8 offset:32768
 ds_read_b64_tr_b16 a[58:59], v8 offset:33792
 ds_read_b64_tr_b16 a[128:129], v9 offset:32768
 ds_read_b64_tr_b16 a[130:131], v9 offset:33792
 ds_read_b64_tr_b16 a[200:201], v8 offset:40960
 ds_read_b64_tr_b16 a[202:203], v8 offset:41984
 ds_read_b64_tr_b16 v[240:241], v9 offset:40960
 ds_read_b64_tr_b16 v[242:243], v9 offset:41984
 s_waitcnt vmcnt(8) lgkmcnt(0)
 s_barrier
 ds_read_b64_tr_b16 a[60:61], v8 offset:49152
 ds_read_b64_tr_b16 a[62:63], v8 offset:50176
 ds_read_b64_tr_b16 a[132:133], v9 offset:49152
 ds_read_b64_tr_b16 a[134:135], v9 offset:50176
 ds_read_b64_tr_b16 a[204:205], v8 offset:57344
 ds_read_b64_tr_b16 a[206:207], v8 offset:58368
 ds_read_b64_tr_b16 v[244:245], v9 offset:57344
 ds_read_b64_tr_b16 v[246:247], v9 offset:58368
 s_waitcnt vmcnt(4) lgkmcnt(0)
 s_barrier
 ds_read_b64_tr_b16 a[64:65], v8 offset:0
 ds_read_b64_tr_b16 a[66:67], v8 offset:1024
 ds_read_b64_tr_b16 a[136:137], v9 offset:0
 ds_read_b64_tr_b16 a[138:139], v9 offset:1024
 ds_read_b64_tr_b16 a[208:209], v8 offset:8192
 ds_read_b64_tr_b16 a[210:211], v8 offset:9216
 ds_read_b64_tr_b16 v[248:249], v9 offset:8192
 ds_read_b64_tr_b16 v[250:251], v9 offset:9216
 s_waitcnt vmcnt(0) lgkmcnt(0)
 s_barrier
 ds_read_b64_tr_b16 a[68:69], v8 offset:16384
 ds_read_b64_tr_b16 a[70:71], v8 offset:17408
 ds_read_b64_tr_b16 a[140:141], v9 offset:16384
 ds_read_b64_tr_b16 a[142:143], v9 offset:17408
 ds_read_b64_tr_b16 a[212:213], v8 offset:24576
 ds_read_b64_tr_b16 a[214:215], v8 offset:25600
 ds_read_b64_tr_b16 v[252:253], v9 offset:24576
 ds_read_b64_tr_b16 v[254:255], v9 offset:25600
 s_mov_b32 s50, 0x3e0293ee
 s_mov_b32 s42, 0
 s_mov_b32 s43, 0
 s_mov_b32 s44, 73728
 v_mov_b32 v6, v4
 v_mov_b32 v7, v5
 s_mov_b32 s95, 0x40000
 s_cmp_lg_u32 s4, 0
 s_cbranch_scc1 Lfrk_20
 v_min_u32 v21, 1, v0
 v_lshlrev_b32 v21, 28, v21
Lfr_19:
 buffer_load_dword v20, v21, s[28:31], 0 offen offset:0 sc1
 s_waitcnt vmcnt(0)
 v_cmp_eq_u32 vcc, 1, v20
 s_cbranch_vccnz Lfrk_20
 s_sub_u32 s95, s95, 1
 s_cbranch_scc0 Lfr_19
 s_endpgm
Lfrk_20:
 s_lshl_b32 s47, s2, 13
 s_add_u32 s47, s47, 0x8000000
 s_mov_b32 s48, s47
 v_mov_b32 v14, 0
 s_waitcnt vmcnt(0) lgkmcnt(0)
 s_barrier
 ds_read_b128 v[32:35], v6 offset:0
 ds_read_b128 v[36:39], v6 offset:2048
 ds_read_b128 v[40:43], v7 offset:0
 ds_read_b128 v[44:47], v7 offset:2048
 v_lshlrev_b32 v1, 12, v0
 s_lshl_b32 s45, s6, 7
 buffer_load_dword v15, v1, s[8:11], s45 offen
 v_add_u32 v1, 0x100000, v1
 buffer_load_dword v15, v1, s[8:11], s45 offen
 v_add_u32 v1, 0x100000, v1
 buffer_load_dword v15, v1, s[8:11], s45 offen
 v_add_u32 v1, 0x100000, v1
 s_waitcnt lgkmcnt(2)
Lps_loop_21:
 v_mfma_f32_16x16x32_bf16 v[64:67], a[0:3], v[32:35], 0
 ds_read_b128 v[48:51], v6 offset:4096
 v_mfma_f32_16x16x32_bf16 v[72:75], a[72:75], v[32:35], 0
 ds_read_b128 v[52:55], v6 offset:6144
 v_mfma_f32_16x16x32_bf16 v[80:83], a[144:147], v[32:35], 0
 s_add_u32 s41, s40, 4
 v_mfma_f32_16x16x32_bf16 v[88:91], a[216:219], v[32:35], 0
 s_add_u32 s45, s42, 2
 s_mul_i32 s46, s41, 36864
 v_mfma_f32_16x16x32_bf16 v[68:71], a[0:3], v[36:39], 0
 s_cmp_lt_u32 s45, s36
 s_cselect_b32 s46, s46, 0
 v_mfma_f32_16x16x32_bf16 v[76:79], a[72:75], v[36:39], 0
 s_lshl_b32 s49, s4, 10
 s_add_u32 s49, s49, s44
 v_mfma_f32_16x16x32_bf16 v[84:87], a[144:147], v[36:39], 0
 v_mfma_f32_16x16x32_bf16 v[92:95], a[216:219], v[36:39], 0
 s_waitcnt lgkmcnt(2)
 v_mfma_f32_16x16x32_bf16 v[64:67], a[4:7], v[40:43], v[64:67]
 ds_read_b128 v[56:59], v7 offset:4096
 v_mfma_f32_16x16x32_bf16 v[72:75], a[76:79], v[40:43], v[72:75]
 ds_read_b128 v[60:63], v7 offset:6144
 v_mfma_f32_16x16x32_bf16 v[80:83], a[148:151], v[40:43], v[80:83]
 s_add_u32 m0, s49, 0
 v_mfma_f32_16x16x32_bf16 v[88:91], a[220:223], v[40:43], v[88:91]
 buffer_load_dwordx4 v10, s[8:11], s46 offen offset:0  lds
 v_mfma_f32_16x16x32_bf16 v[68:71], a[4:7], v[44:47], v[68:71]
 s_add_u32 m0, s49, 3968
 v_mfma_f32_16x16x32_bf16 v[76:79], a[76:79], v[44:47], v[76:79]
 buffer_load_dwordx4 v10, s[8:11], s46 offen offset:128  lds
 v_mfma_f32_16x16x32_bf16 v[84:87], a[148:151], v[44:47], v[84:87]
 v_mfma_f32_16x16x32_bf16 v[92:95], a[220:223], v[44:47], v[92:95]
 s_waitcnt lgkmcnt(2)
 v_mfma_f32_16x16x32_bf16 v[64:67], a[8:11], v[48:51], v[64:67]
 ds_read_b128 v[32:35], v6 offset:8192
 v_mfma_f32_16x16x32_bf16 v[72:75], a[80:83], v[48:51], v[72:75]
 ds_read_b128 v[36:39], v6 offset:10240
 v_mfma_f32_16x16x32_bf16 v[80:83], a[152:155], v[48:51], v[80:83]
 s_add_u32 m0, s49, 7936
 v_mfma_f32_16x16x32_bf16 v[88:91], a[224:227], v[48:51], v[88:91]
 buffer_load_dwordx4 v10, s[8:11], s46 offen offset:256  lds
 v_mfma_f32_16x16x32_bf16 v[68:71], a[8:11], v[52:55], v[68:71]
 s_add_u32 m0, s49, 11904
 v_mfma_f32_16x16x32_bf16 v[76:79], a[80:83], v[52:55], v[76:79]
 buffer_load_dwordx4 v10, s[8:11], s46 offen offset:384  lds
 v_mfma_f32_16x16x32_bf16 v[84:87], a[152:155], v[52:55], v[84:87]
 v_mfma_f32_16x16x32_bf16 v[92:95], a[224:227], v[52:55], v[92:95]
 s_waitcnt lgkmcnt(2)
 v_mfma_f32_16x16x32_bf16 v[64:67], a[12:15], v[56:59], v[64:67]
 ds_read_b128 v[40:43], v7 offset:8192
 v_mfma_f32_16x16x32_bf16 v[72:75], a[84:87], v[56:59], v[72:75]
 ds_read_b128 v[44:47], v7 offset:10240
 v_mfma_f32_16x16x32_bf16 v[80:83], a[156:159], v[56:59], v[80:83]
 s_add_u32 m0, s49, 15872
 v_mfma_f32_16x16x32_bf16 v[88:91], a[228:231], v[56:59], v[88:91]
 buffer_load_dwordx4 v10, s[8:11], s46 offen offset:512  lds
 v_mfma_f32_16x16x32_bf16 v[68:71], a[12:15], v[60:63], v[68:71]
 s_add_u32 m0, s49, 19840
 v_mfma_f32_16x16x32_bf16 v[76:79], a[84:87], v[60:63], v[76:79]
 buffer_load_dwordx4 v10, s[8:11], s46 offen offset:640  lds
 v_mfma_f32_16x16x32_bf16 v[84:87], a[156:159], v[60:63], v[84:87]
 v_mfma_f32_16x16x32_bf16 v[92:95], a[228:231], v[60:63], v[92:95]
 s_waitcnt lgkmcnt(2)
 v_mfma_f32_16x16x32_bf16 v[64:67], a[16:19], v[32:35], v[64:67]
 ds_read_b128 v[48:51], v6 offset:12288
 v_mfma_f32_16x16x32_bf16 v[72:75], a[88:91], v[32:35], v[72:75]
 ds_read_b128 v[52:55], v6 offset:14336
 v_mfma_f32_16x16x32_bf16 v[80:83], a[160:163], v[32:35], v[80:83]
 s_add_u32 m0, s49, 23808
 v_mfma_f32_16x16x32_bf16 v[88:91], a[232:235], v[32:35], v[88:91]
 buffer_load_dwordx4 v10, s[8:11], s46 offen offset:768  lds
 v_mfma_f32_16x16x32_bf16 v[68:71], a[16:19], v[36:39], v[68:71]
 s_add_u32 m0, s49, 27776
 v_mfma_f32_16x16x32_bf16 v[76:79], a[88:91], v[36:39], v[76:79]
 buffer_load_dwordx4 v10, s[8:11], s46 offen offset:896  lds
 v_mfma_f32_16x16x32_bf16 v[84:87], a[160:163], v[36:39], v[84:87]
 v_mfma_f32_16x16x32_bf16 v[92:95], a[232:235], v[36:39], v[92:95]
 s_waitcnt lgkmcnt(2)
 v_mfma_f32_16x16x32_bf16 v[64:67], a[20:23], v[40:43], v[64:67]
 ds_read_b128 v[56:59], v7 offset:12288
 v_mfma_f32_16x16x32_bf16 v[72:75], a[92:95], v[40:43], v[72:75]
 ds_read_b128 v[60:63], v7 offset:14336
 v_mfma_f32_16x16x32_bf16 v[80:83], a[164:167], v[40:43], v[80:83]
 s_add_u32 m0, s49, 31744
 v_mfma_f32_16x16x32_bf16 v[88:91], a[236:239], v[40:43], v[88:91]
 buffer_load_dwordx4 v10, s[8:11], s46 offen offset:1024  lds
 v_mfma_f32_16x16x32_bf16 v[68:71], a[20:23], v[44:47], v[68:71]
 v_mfma_f32_16x16x32_bf16 v[76:79], a[92:95], v[44:47], v[76:79]
 v_mfma_f32_16x16x32_bf16 v[84:87], a[164:167], v[44:47], v[84:87]
 v_mfma_f32_16x16x32_bf16 v[92:95], a[236:239], v[44:47], v[92:95]
 s_waitcnt lgkmcnt(2)
 v_mfma_f32_16x16x32_bf16 v[64:67], a[24:27], v[48:51], v[64:67]
 ds_read_b128 v[32:35], v6 offset:16384
 v_mul_f32 v96, s50, v96
 v_mfma_f32_16x16x32_bf16 v[72:75], a[96:99], v[48:51], v[72:75]
 ds_read_b128 v[36:39], v6 offset:18432
 v_mfma_f32_16x16x32_bf16 v[80:83], a[168:171], v[48:51], v[80:83]
 v_mul_f32 v97, s50, v97
 v_mfma_f32_16x16x32_bf16 v[88:91], a[240:243], v[48:51], v[88:91]
 v_mul_f32 v98, s50, v98
 v_mfma_f32_16x16x32_bf16 v[68:71], a[24:27], v[52:55], v[68:71]
 v_mul_f32 v99, s50, v99
 v_mfma_f32_16x16x32_bf16 v[76:79], a[96:99], v[52:55], v[76:79]
 v_mul_f32 v104, s50, v104
 v_mfma_f32_16x16x32_bf16 v[84:87], a[168:171], v[52:55], v[84:87]
 v_mul_f32 v105, s50, v105
 v_mfma_f32_16x16x32_bf16 v[92:95], a[240:243], v[52:55], v[92:95]
 s_waitcnt lgkmcnt(2)
 v_mfma_f32_16x16x32_bf16 v[64:67], a[28:31], v[56:59], v[64:67]
 ds_read_b128 v[40:43], v7 offset:16384
 v_mfma_f32_16x16x32_bf16 v[72:75], a[100:103], v[56:59], v[72:75]
 ds_read_b128 v[44:47], v7 offset:18432
 v_mul_f32 v106, s50, v106
 v_mfma_f32_16x16x32_bf16 v[80:83], a[172:175], v[56:59], v[80:83]
 v_mul_f32 v107, s50, v107
 v_mfma_f32_16x16x32_bf16 v[88:91], a[244:247], v[56:59], v[88:91]
 v_cvt_pk_bf16_f32 v16, v96, v97
 v_mfma_f32_16x16x32_bf16 v[68:71], a[28:31], v[60:63], v[68:71]
 v_mfma_f32_16x16x32_bf16 v[76:79], a[100:103], v[60:63], v[76:79]
 v_cvt_pk_bf16_f32 v17, v104, v105
 v_mfma_f32_16x16x32_bf16 v[84:87], a[172:175], v[60:63], v[84:87]
 v_cvt_pk_bf16_f32 v18, v98, v99
 v_mfma_f32_16x16x32_bf16 v[92:95], a[244:247], v[60:63], v[92:95]
 s_waitcnt lgkmcnt(2)
 v_cvt_pk_bf16_f32 v19, v106, v107
 v_mfma_f32_16x16x32_bf16 v[64:67], a[32:35], v[32:35], v[64:67]
 ds_read_b128 v[48:51], v6 offset:20480
 v_mfma_f32_16x16x32_bf16 v[72:75], a[104:107], v[32:35], v[72:75]
 ds_read_b128 v[52:55], v6 offset:22528
 v_mfma_f32_16x16x32_bf16 v[80:83], a[176:179], v[32:35], v[80:83]
 buffer_store_dwordx4 v[16:19], v12, s[20:23], s47 offen offset:0 sc1
 v_mfma_f32_16x16x32_bf16 v[88:91], a[248:251], v[32:35], v[88:91]
 v_mul_f32 v100, s50, v100
 v_mfma_f32_16x16x32_bf16 v[68:71], a[32:35], v[36:39], v[68:71]
 v_mul_f32 v101, s50, v101
 v_mfma_f32_16x16x32_bf16 v[76:79], a[104:107], v[36:39], v[76:79]
 v_mul_f32 v102, s50, v102
 v_mfma_f32_16x16x32_bf16 v[84:87], a[176:179], v[36:39], v[84:87]
 v_mul_f32 v103, s50, v103
 v_mfma_f32_16x16x32_bf16 v[92:95], a[248:251], v[36:39], v[92:95]
 s_waitcnt lgkmcnt(2)
 v_mfma_f32_16x16x32_bf16 v[64:67], a[36:39], v[40:43], v[64:67]
 ds_read_b128 v[56:59], v7 offset:20480
 v_mul_f32 v108, s50, v108
 v_mfma_f32_16x16x32_bf16 v[72:75], a[108:111], v[40:43], v[72:75]
 ds_read_b128 v[60:63], v7 offset:22528
 v_mfma_f32_16x16x32_bf16 v[80:83], a[180:183], v[40:43], v[80:83]
 v_mul_f32 v109, s50, v109
 v_mfma_f32_16x16x32_bf16 v[88:91], a[252:255], v[40:43], v[88:91]
 v_mul_f32 v110, s50, v110
 v_mfma_f32_16x16x32_bf16 v[68:71], a[36:39], v[44:47], v[68:71]
 v_mul_f32 v111, s50, v111
 v_mfma_f32_16x16x32_bf16 v[76:79], a[108:111], v[44:47], v[76:79]
 v_mfma_f32_16x16x32_bf16 v[84:87], a[180:183], v[44:47], v[84:87]
 v_cvt_pk_bf16_f32 v20, v100, v101
 v_mfma_f32_16x16x32_bf16 v[92:95], a[252:255], v[44:47], v[92:95]
 s_waitcnt lgkmcnt(2)
 v_cvt_pk_bf16_f32 v21, v108, v109
 v_mfma_f32_16x16x32_bf16 v[64:67], a[40:43], v[48:51], v[64:67]
 ds_read_b128 v[32:35], v6 offset:24576
 v_mfma_f32_16x16x32_bf16 v[72:75], a[112:115], v[48:51], v[72:75]
 ds_read_b128 v[36:39], v6 offset:26624
 v_cvt_pk_bf16_f32 v22, v102, v103
 v_mfma_f32_16x16x32_bf16 v[80:83], a[184:187], v[48:51], v[80:83]
 v_mfma_f32_16x16x32_bf16 v[88:91], v[224:227], v[48:51], v[88:91]
 v_cvt_pk_bf16_f32 v23, v110, v111
 v_mfma_f32_16x16x32_bf16 v[68:71], a[40:43], v[52:55], v[68:71]
 buffer_store_dwordx4 v[20:23], v12, s[20:23], s47 offen offset:1024 sc1
 v_mfma_f32_16x16x32_bf16 v[76:79], a[112:115], v[52:55], v[76:79]
 v_mul_f32 v112, s50, v112
 v_mfma_f32_16x16x32_bf16 v[84:87], a[184:187], v[52:55], v[84:87]
 v_mul_f32 v113, s50, v113
 v_mfma_f32_16x16x32_bf16 v[92:95], v[224:227], v[52:55], v[92:95]
 s_waitcnt lgkmcnt(2)
 v_mfma_f32_16x16x32_bf16 v[64:67], a[44:47], v[56:59], v[64:67]
 ds_read_b128 v[40:43], v7 offset:24576
 v_mul_f32 v114, s50, v114
 v_mfma_f32_16x16x32_bf16 v[72:75], a[116:119], v[56:59], v[72:75]
 ds_read_b128 v[44:47], v7 offset:26624
 v_mfma_f32_16x16x32_bf16 v[80:83], a[188:191], v[56:59], v[80:83]
 v_mul_f32 v115, s50, v115
 v_mfma_f32_16x16x32_bf16 v[88:91], v[228:231], v[56:59], v[88:91]
 v_mul_f32 v120, s50, v120
 v_mfma_f32_16x16x32_bf16 v[68:71], a[44:47], v[60:63], v[68:71]
 v_mul_f32 v121, s50, v121
 v_mfma_f32_16x16x32_bf16 v[76:79], a[116:119], v[60:63], v[76:79]
 v_mfma_f32_16x16x32_bf16 v[84:87], a[188:191], v[60:63], v[84:87]
 v_mul_f32 v122, s50, v122
 v_mfma_f32_16x16x32_bf16 v[92:95], v[228:231], v[60:63], v[92:95]
 s_waitcnt lgkmcnt(2)
 v_mul_f32 v123, s50, v123
 v_mfma_f32_16x16x32_bf16 v[64:67], a[48:51], v[32:35], v[64:67]
 ds_read_b128 v[48:51], v6 offset:28672
 v_mfma_f32_16x16x32_bf16 v[72:75], a[120:123], v[32:35], v[72:75]
 ds_read_b128 v[52:55], v6 offset:30720
 v_cvt_pk_bf16_f32 v24, v112, v113
 v_mfma_f32_16x16x32_bf16 v[80:83], a[192:195], v[32:35], v[80:83]
 v_mfma_f32_16x16x32_bf16 v[88:91], v[232:235], v[32:35], v[88:91]
 v_cvt_pk_bf16_f32 v25, v120, v121
 v_mfma_f32_16x16x32_bf16 v[68:71], a[48:51], v[36:39], v[68:71]
 v_cvt_pk_bf16_f32 v26, v114, v115
 v_mfma_f32_16x16x32_bf16 v[76:79], a[120:123], v[36:39], v[76:79]
 v_cvt_pk_bf16_f32 v27, v122, v123
 v_mfma_f32_16x16x32_bf16 v[84:87], a[192:195], v[36:39], v[84:87]
 buffer_store_dwordx4 v[24:27], v12, s[20:23], s48 offen offset:0 sc1
 v_mfma_f32_16x16x32_bf16 v[92:95], v[232:235], v[36:39], v[92:95]
 s_waitcnt lgkmcnt(2)
 v_mfma_f32_16x16x32_bf16 v[64:67], a[52:55], v[40:43], v[64:67]
 ds_read_b128 v[56:59], v7 offset:28672
 v_mul_f32 v116, s50, v116
 v_mfma_f32_16x16x32_bf16 v[72:75], a[124:127], v[40:43], v[72:75]
 ds_read_b128 v[60:63], v7 offset:30720
 v_mfma_f32_16x16x32_bf16 v[80:83], a[196:199], v[40:43], v[80:83]
 s_add_u32 s43, s43, 36864
 s_cmp_eq_u32 s43, 147456
 v_mfma_f32_16x16x32_bf16 v[88:91], v[236:239], v[40:43], v[88:91]
 s_cselect_b32 s43, 0, s43
 s_add_u32 s44, s44, 36864
 v_mfma_f32_16x16x32_bf16 v[68:71], a[52:55], v[44:47], v[68:71]
 s_cmp_eq_u32 s44, 147456
 s_cselect_b32 s44, 0, s44
 v_mfma_f32_16x16x32_bf16 v[76:79], a[124:127], v[44:47], v[76:79]
 v_mul_f32 v117, s50, v117
 v_mfma_f32_16x16x32_bf16 v[84:87], a[196:199], v[44:47], v[84:87]
 v_mul_f32 v118, s50, v118
 v_mfma_f32_16x16x32_bf16 v[92:95], v[236:239], v[44:47], v[92:95]
 s_waitcnt lgkmcnt(2)
 v_mfma_f32_16x16x32_bf16 v[64:67], a[56:59], v[48:51], v[64:67]
 ds_read_b128 v[32:35], v6 offset:32768
 v_mul_f32 v119, s50, v119
 v_mfma_f32_16x16x32_bf16 v[72:75], a[128:131], v[48:51], v[72:75]
 ds_read_b128 v[36:39], v6 offset:34816
 v_mfma_f32_16x16x32_bf16 v[80:83], a[200:203], v[48:51], v[80:83]
 v_add_u32 v6, s43, v4
 v_mul_f32 v124, s50, v124
 v_mfma_f32_16x16x32_bf16 v[88:91], v[240:243], v[48:51], v[88:91]
 v_mfma_f32_16x16x32_bf16 v[68:71], a[56:59], v[52:55], v[68:71]
 v_mul_f32 v125, s50, v125
 v_mfma_f32_16x16x32_bf16 v[76:79], a[128:131], v[52:55], v[76:79]
 v_mul_f32 v126, s50, v126
 v_mfma_f32_16x16x32_bf16 v[84:87], a[200:203], v[52:55], v[84:87]
 v_mul_f32 v127, s50, v127
 v_mfma_f32_16x16x32_bf16 v[92:95], v[240:243], v[52:55], v[92:95]
 s_waitcnt lgkmcnt(2)
 v_mfma_f32_16x16x32_bf16 v[64:67], a[60:63], v[56:59], v[64:67]
 ds_read_b128 v[40:43], v7 offset:32768
 v_cvt_pk_bf16_f32 v28, v116, v117
 v_mfma_f32_16x16x32_bf16 v[72:75], a[132:135], v[56:59], v[72:75]
 ds_read_b128 v[44:47], v7 offset:34816
 v_mfma_f32_16x16x32_bf16 v[80:83], a[204:207], v[56:59], v[80:83]
 v_add_u32 v7, s43, v5
 v_cvt_pk_bf16_f32 v29, v124, v125
 v_mfma_f32_16x16x32_bf16 v[88:91], v[244:247], v[56:59], v[88:91]
 v_cvt_pk_bf16_f32 v30, v118, v119
 v_mfma_f32_16x16x32_bf16 v[68:71], a[60:63], v[60:63], v[68:71]
 v_mfma_f32_16x16x32_bf16 v[76:79], a[132:135], v[60:63], v[76:79]
 v_cvt_pk_bf16_f32 v31, v126, v127
 v_mfma_f32_16x16x32_bf16 v[84:87], a[204:207], v[60:63], v[84:87]
 buffer_store_dwordx4 v[28:31], v12, s[20:23], s48 offen offset:1024 sc1
 v_mfma_f32_16x16x32_bf16 v[92:95], v[244:247], v[60:63], v[92:95]
 s_waitcnt lgkmcnt(2)
 v_mfma_f32_16x16x32_bf16 v[64:67], a[64:67], v[32:35], v[64:67]
 s_waitcnt vmcnt(13)
 s_barrier
 ds_read_b128 v[48:51], v6 offset:0
 v_mfma_f32_16x16x32_bf16 v[72:75], a[136:139], v[32:35], v[72:75]
 ds_read_b128 v[52:55], v6 offset:2048
 v_mfma_f32_16x16x32_bf16 v[80:83], a[208:211], v[32:35], v[80:83]
 v_mfma_f32_16x16x32_bf16 v[88:91], v[248:251], v[32:35], v[88:91]
 v_mfma_f32_16x16x32_bf16 v[68:71], a[64:67], v[36:39], v[68:71]
 v_mfma_f32_16x16x32_bf16 v[76:79], a[136:139], v[36:39], v[76:79]
 v_mfma_f32_16x16x32_bf16 v[84:87], a[208:211], v[36:39], v[84:87]
 v_mfma_f32_16x16x32_bf16 v[92:95], v[248:251], v[36:39], v[92:95]
 s_waitcnt lgkmcnt(2)
 v_mfma_f32_16x16x32_bf16 v[64:67], a[68:71], v[40:43], v[64:67]
 ds_read_b128 v[56:59], v7 offset:0
 v_mfma_f32_16x16x32_bf16 v[72:75], a[140:143], v[40:43], v[72:75]
 ds_read_b128 v[60:63], v7 offset:2048
 v_mfma_f32_16x16x32_bf16 v[80:83], a[212:215], v[40:43], v[80:83]
 s_mul_i32 s45, s39, 262144
 s_add_u32 s47, s34, s45
 v_mfma_f32_16x16x32_bf16 v[88:91], v[252:255], v[40:43], v[88:91]
 s_add_u32 s48, s35, s45
 v_mov_b32 v14, s42
 v_mfma_f32_16x16x32_bf16 v[68:71], a[68:71], v[44:47], v[68:71]
 s_mov_b32 s39, s40
 s_mov_b32 s40, s41
 v_mfma_f32_16x16x32_bf16 v[76:79], a[140:143], v[44:47], v[76:79]
 s_add_u32 s42, s42, 1
 v_mfma_f32_16x16x32_bf16 v[84:87], a[212:215], v[44:47], v[84:87]
 v_mfma_f32_16x16x32_bf16 v[92:95], v[252:255], v[44:47], v[92:95]
 s_waitcnt lgkmcnt(2)
 v_mfma_f32_16x16x32_bf16 v[96:99], a[0:3], v[48:51], 0
 ds_read_b128 v[32:35], v6 offset:4096
 v_mfma_f32_16x16x32_bf16 v[104:107], a[72:75], v[48:51], 0
 ds_read_b128 v[36:39], v6 offset:6144
 v_mfma_f32_16x16x32_bf16 v[112:115], a[144:147], v[48:51], 0
 s_add_u32 s41, s40, 4
 v_mfma_f32_16x16x32_bf16 v[120:123], a[216:219], v[48:51], 0
 s_add_u32 s45, s42, 2
 s_mul_i32 s46, s41, 36864
 v_mfma_f32_16x16x32_bf16 v[100:103], a[0:3], v[52:55], 0
 s_cmp_lt_u32 s45, s36
 s_cselect_b32 s46, s46, 0
 v_mfma_f32_16x16x32_bf16 v[108:111], a[72:75], v[52:55], 0
 s_lshl_b32 s49, s4, 10
 s_add_u32 s49, s49, s44
 v_mfma_f32_16x16x32_bf16 v[116:119], a[144:147], v[52:55], 0
 v_mfma_f32_16x16x32_bf16 v[124:127], a[216:219], v[52:55], 0
 s_waitcnt lgkmcnt(2)
 v_mfma_f32_16x16x32_bf16 v[96:99], a[4:7], v[56:59], v[96:99]
 ds_read_b128 v[40:43], v7 offset:4096
 v_mfma_f32_16x16x32_bf16 v[104:107], a[76:79], v[56:59], v[104:107]
 ds_read_b128 v[44:47], v7 offset:6144
 v_mfma_f32_16x16x32_bf16 v[112:115], a[148:151], v[56:59], v[112:115]
 s_add_u32 m0, s49, 0
 v_mfma_f32_16x16x32_bf16 v[120:123], a[220:223], v[56:59], v[120:123]
 buffer_load_dwordx4 v10, s[8:11], s46 offen offset:0  lds
 v_mfma_f32_16x16x32_bf16 v[100:103], a[4:7], v[60:63], v[100:103]
 s_add_u32 m0, s49, 3968
 v_mfma_f32_16x16x32_bf16 v[108:111], a[76:79], v[60:63], v[108:111]
 buffer_load_dwordx4 v10, s[8:11], s46 offen offset:128  lds
 v_mfma_f32_16x16x32_bf16 v[116:119], a[148:151], v[60:63], v[116:119]
 v_mfma_f32_16x16x32_bf16 v[124:127], a[220:223], v[60:63], v[124:127]
 s_waitcnt lgkmcnt(2)
 v_mfma_f32_16x16x32_bf16 v[96:99], a[8:11], v[32:35], v[96:99]
 ds_read_b128 v[48:51], v6 offset:8192
 v_mfma_f32_16x16x32_bf16 v[104:107], a[80:83], v[32:35], v[104:107]
 ds_read_b128 v[52:55], v6 offset:10240
 v_mfma_f32_16x16x32_bf16 v[112:115], a[152:155], v[32:35], v[112:115]
 s_add_u32 m0, s49, 7936
 v_mfma_f32_16x16x32_bf16 v[120:123], a[224:227], v[32:35], v[120:123]
 buffer_load_dwordx4 v10, s[8:11], s46 offen offset:256  lds
 v_mfma_f32_16x16x32_bf16 v[100:103], a[8:11], v[36:39], v[100:103]
 s_add_u32 m0, s49, 11904
 v_mfma_f32_16x16x32_bf16 v[108:111], a[80:83], v[36:39], v[108:111]
 buffer_load_dwordx4 v10, s[8:11], s46 offen offset:384  lds
 v_mfma_f32_16x16x32_bf16 v[116:119], a[152:155], v[36:39], v[116:119]
 v_mfma_f32_16x16x32_bf16 v[124:127], a[224:227], v[36:39], v[124:127]
 s_waitcnt lgkmcnt(2)
 v_mfma_f32_16x16x32_bf16 v[96:99], a[12:15], v[40:43], v[96:99]
 ds_read_b128 v[56:59], v7 offset:8192
 v_mfma_f32_16x16x32_bf16 v[104:107], a[84:87], v[40:43], v[104:107]
 ds_read_b128 v[60:63], v7 offset:10240
 v_mfma_f32_16x16x32_bf16 v[112:115], a[156:159], v[40:43], v[112:115]
 s_add_u32 m0, s49, 15872
 v_mfma_f32_16x16x32_bf16 v[120:123], a[228:231], v[40:43], v[120:123]
 buffer_load_dwordx4 v10, s[8:11], s46 offen offset:512  lds
 v_mfma_f32_16x16x32_bf16 v[100:103], a[12:15], v[44:47], v[100:103]
 s_add_u32 m0, s49, 19840
 v_mfma_f32_16x16x32_bf16 v[108:111], a[84:87], v[44:47], v[108:111]
 buffer_load_dwordx4 v10, s[8:11], s46 offen offset:640  lds
 v_mfma_f32_16x16x32_bf16 v[116:119], a[156:159], v[44:47], v[116:119]
 v_mfma_f32_16x16x32_bf16 v[124:127], a[228:231], v[44:47], v[124:127]
 s_waitcnt lgkmcnt(2)
 v_mfma_f32_16x16x32_bf16 v[96:99], a[16:19], v[48:51], v[96:99]
 ds_read_b128 v[32:35], v6 offset:12288
 v_mfma_f32_16x16x32_bf16 v[104:107], a[88:91], v[48:51], v[104:107]
 ds_read_b128 v[36:39], v6 offset:14336
 v_mfma_f32_16x16x32_bf16 v[112:115], a[160:163], v[48:51], v[112:115]
 s_add_u32 m0, s49, 23808
 v_mfma_f32_16x16x32_bf16 v[120:123], a[232:235], v[48:51], v[120:123]
 buffer_load_dwordx4 v10, s[8:11], s46 offen offset:768  lds
 v_mfma_f32_16x16x32_bf16 v[100:103], a[16:19], v[52:55], v[100:103]
 s_add_u32 m0, s49, 27776
 v_mfma_f32_16x16x32_bf16 v[108:111], a[88:91], v[52:55], v[108:111]
 buffer_load_dwordx4 v10, s[8:11], s46 offen offset:896  lds
 v_mfma_f32_16x16x32_bf16 v[116:119], a[160:163], v[52:55], v[116:119]
 v_mfma_f32_16x16x32_bf16 v[124:127], a[232:235], v[52:55], v[124:127]
 s_waitcnt lgkmcnt(2)
 v_mfma_f32_16x16x32_bf16 v[96:99], a[20:23], v[56:59], v[96:99]
 ds_read_b128 v[40:43], v7 offset:12288
 v_mfma_f32_16x16x32_bf16 v[104:107], a[92:95], v[56:59], v[104:107]
 ds_read_b128 v[44:47], v7 offset:14336
 v_mfma_f32_16x16x32_bf16 v[112:115], a[164:167], v[56:59], v[112:115]
 s_add_u32 m0, s49, 31744
 v_mfma_f32_16x16x32_bf16 v[120:123], a[236:239], v[56:59], v[120:123]
 buffer_load_dwordx4 v10, s[8:11], s46 offen offset:1024  lds
 v_mfma_f32_16x16x32_bf16 v[100:103], a[20:23], v[60:63], v[100:103]
 v_mfma_f32_16x16x32_bf16 v[108:111], a[92:95], v[60:63], v[108:111]
 v_mfma_f32_16x16x32_bf16 v[116:119], a[164:167], v[60:63], v[116:119]
 v_mfma_f32_16x16x32_bf16 v[124:127], a[236:239], v[60:63], v[124:127]
 s_waitcnt lgkmcnt(2)
 v_mfma_f32_16x16x32_bf16 v[96:99], a[24:27], v[32:35], v[96:99]
 ds_read_b128 v[48:51], v6 offset:16384
 v_mul_f32 v64, s50, v64
 v_mfma_f32_16x16x32_bf16 v[104:107], a[96:99], v[32:35], v[104:107]
 ds_read_b128 v[52:55], v6 offset:18432
 v_mfma_f32_16x16x32_bf16 v[112:115], a[168:171], v[32:35], v[112:115]
 v_mul_f32 v65, s50, v65
 v_mfma_f32_16x16x32_bf16 v[120:123], a[240:243], v[32:35], v[120:123]
 v_mul_f32 v66, s50, v66
 v_mfma_f32_16x16x32_bf16 v[100:103], a[24:27], v[36:39], v[100:103]
 v_mul_f32 v67, s50, v67
 v_mfma_f32_16x16x32_bf16 v[108:111], a[96:99], v[36:39], v[108:111]
 v_mul_f32 v72, s50, v72
 v_mfma_f32_16x16x32_bf16 v[116:119], a[168:171], v[36:39], v[116:119]
 v_mul_f32 v73, s50, v73
 v_mfma_f32_16x16x32_bf16 v[124:127], a[240:243], v[36:39], v[124:127]
 s_waitcnt lgkmcnt(2)
 v_mfma_f32_16x16x32_bf16 v[96:99], a[28:31], v[40:43], v[96:99]
 ds_read_b128 v[56:59], v7 offset:16384
 v_mfma_f32_16x16x32_bf16 v[104:107], a[100:103], v[40:43], v[104:107]
 ds_read_b128 v[60:63], v7 offset:18432
 v_mul_f32 v74, s50, v74
 v_mfma_f32_16x16x32_bf16 v[112:115], a[172:175], v[40:43], v[112:115]
 v_mul_f32 v75, s50, v75
 v_mfma_f32_16x16x32_bf16 v[120:123], a[244:247], v[40:43], v[120:123]
 v_cvt_pk_bf16_f32 v16, v64, v65
 v_mfma_f32_16x16x32_bf16 v[100:103], a[28:31], v[44:47], v[100:103]
 v_mfma_f32_16x16x32_bf16 v[108:111], a[100:103], v[44:47], v[108:111]
 v_cvt_pk_bf16_f32 v17, v72, v73
 v_mfma_f32_16x16x32_bf16 v[116:119], a[172:175], v[44:47], v[116:119]
 v_cvt_pk_bf16_f32 v18, v66, v67
 v_mfma_f32_16x16x32_bf16 v[124:127], a[244:247], v[44:47], v[124:127]
 s_waitcnt lgkmcnt(2)
 v_cvt_pk_bf16_f32 v19, v74, v75
 v_mfma_f32_16x16x32_bf16 v[96:99], a[32:35], v[48:51], v[96:99]
 ds_read_b128 v[32:35], v6 offset:20480
 v_mfma_f32_16x16x32_bf16 v[104:107], a[104:107], v[48:51], v[104:107]
 ds_read_b128 v[36:39], v6 offset:22528
 v_mfma_f32_16x16x32_bf16 v[112:115], a[176:179], v[48:51], v[112:115]
 buffer_store_dwordx4 v[16:19], v12, s[20:23], s47 offen offset:0 sc1
 v_mfma_f32_16x16x32_bf16 v[120:123], a[248:251], v[48:51], v[120:123]
 v_mul_f32 v68, s50, v68
 v_mfma_f32_16x16x32_bf16 v[100:103], a[32:35], v[52:55], v[100:103]
 v_mul_f32 v69, s50, v69
 v_mfma_f32_16x16x32_bf16 v[108:111], a[104:107], v[52:55], v[108:111]
 v_mul_f32 v70, s50, v70
 v_mfma_f32_16x16x32_bf16 v[116:119], a[176:179], v[52:55], v[116:119]
 v_mul_f32 v71, s50, v71
 v_mfma_f32_16x16x32_bf16 v[124:127], a[248:251], v[52:55], v[124:127]
 s_waitcnt lgkmcnt(2)
 v_mfma_f32_16x16x32_bf16 v[96:99], a[36:39], v[56:59], v[96:99]
 ds_read_b128 v[40:43], v7 offset:20480
 v_mul_f32 v76, s50, v76
 v_mfma_f32_16x16x32_bf16 v[104:107], a[108:111], v[56:59], v[104:107]
 ds_read_b128 v[44:47], v7 offset:22528
 v_mfma_f32_16x16x32_bf16 v[112:115], a[180:183], v[56:59], v[112:115]
 v_mul_f32 v77, s50, v77
 v_mfma_f32_16x16x32_bf16 v[120:123], a[252:255], v[56:59], v[120:123]
 v_mul_f32 v78, s50, v78
 v_mfma_f32_16x16x32_bf16 v[100:103], a[36:39], v[60:63], v[100:103]
 v_mul_f32 v79, s50, v79
 v_mfma_f32_16x16x32_bf16 v[108:111], a[108:111], v[60:63], v[108:111]
 v_mfma_f32_16x16x32_bf16 v[116:119], a[180:183], v[60:63], v[116:119]
 v_cvt_pk_bf16_f32 v20, v68, v69
 v_mfma_f32_16x16x32_bf16 v[124:127], a[252:255], v[60:63], v[124:127]
 s_waitcnt lgkmcnt(2)
 v_cvt_pk_bf16_f32 v21, v76, v77
 v_mfma_f32_16x16x32_bf16 v[96:99], a[40:43], v[32:35], v[96:99]
 ds_read_b128 v[48:51], v6 offset:24576
 v_mfma_f32_16x16x32_bf16 v[104:107], a[112:115], v[32:35], v[104:107]
 ds_read_b128 v[52:55], v6 offset:26624
 v_cvt_pk_bf16_f32 v22, v70, v71
 v_mfma_f32_16x16x32_bf16 v[112:115], a[184:187], v[32:35], v[112:115]
 v_mfma_f32_16x16x32_bf16 v[120:123], v[224:227], v[32:35], v[120:123]
 v_cvt_pk_bf16_f32 v23, v78, v79
 v_mfma_f32_16x16x32_bf16 v[100:103], a[40:43], v[36:39], v[100:103]
 buffer_store_dwordx4 v[20:23], v12, s[20:23], s47 offen offset:1024 sc1
 v_mfma_f32_16x16x32_bf16 v[108:111], a[112:115], v[36:39], v[108:111]
 v_mul_f32 v80, s50, v80
 v_mfma_f32_16x16x32_bf16 v[116:119], a[184:187], v[36:39], v[116:119]
 v_mul_f32 v81, s50, v81
 v_mfma_f32_16x16x32_bf16 v[124:127], v[224:227], v[36:39], v[124:127]
 s_waitcnt lgkmcnt(2)
 v_mfma_f32_16x16x32_bf16 v[96:99], a[44:47], v[40:43], v[96:99]
 ds_read_b128 v[56:59], v7 offset:24576
 v_mul_f32 v82, s50, v82
 v_mfma_f32_16x16x32_bf16 v[104:107], a[116:119], v[40:43], v[104:107]
 ds_read_b128 v[60:63], v7 offset:26624
 v_mfma_f32_16x16x32_bf16 v[112:115], a[188:191], v[40:43], v[112:115]
 v_mul_f32 v83, s50, v83
 v_mfma_f32_16x16x32_bf16 v[120:123], v[228:231], v[40:43], v[120:123]
 v_mul_f32 v88, s50, v88
 v_mfma_f32_16x16x32_bf16 v[100:103], a[44:47], v[44:47], v[100:103]
 v_mul_f32 v89, s50, v89
 v_mfma_f32_16x16x32_bf16 v[108:111], a[116:119], v[44:47], v[108:111]
 v_mfma_f32_16x16x32_bf16 v[116:119], a[188:191], v[44:47], v[116:119]
 v_mul_f32 v90, s50, v90
 v_mfma_f32_16x16x32_bf16 v[124:127], v[228:231], v[44:47], v[124:127]
 s_waitcnt lgkmcnt(2)
 v_mul_f32 v91, s50, v91
 v_mfma_f32_16x16x32_bf16 v[96:99], a[48:51], v[48:51], v[96:99]
 ds_read_b128 v[32:35], v6 offset:28672
 v_mfma_f32_16x16x32_bf16 v[104:107], a[120:123], v[48:51], v[104:107]
 ds_read_b128 v[36:39], v6 offset:30720
 v_cvt_pk_bf16_f32 v24, v80, v81
 v_mfma_f32_16x16x32_bf16 v[112:115], a[192:195], v[48:51], v[112:115]
 v_mfma_f32_16x16x32_bf16 v[120:123], v[232:235], v[48:51], v[120:123]
 v_cvt_pk_bf16_f32 v25, v88, v89
 v_mfma_f32_16x16x32_bf16 v[100:103], a[48:51], v[52:55], v[100:103]
 v_cvt_pk_bf16_f32 v26, v82, v83
 v_mfma_f32_16x16x32_bf16 v[108:111], a[120:123], v[52:55], v[108:111]
 v_cvt_pk_bf16_f32 v27, v90, v91
 v_mfma_f32_16x16x32_bf16 v[116:119], a[192:195], v[52:55], v[116:119]
 buffer_store_dwordx4 v[24:27], v12, s[20:23], s48 offen offset:0 sc1
 v_mfma_f32_16x16x32_bf16 v[124:127], v[232:235], v[52:55], v[124:127]
 s_waitcnt lgkmcnt(2)
 v_mfma_f32_16x16x32_bf16 v[96:99], a[52:55], v[56:59], v[96:99]
 ds_read_b128 v[40:43], v7 offset:28672
 v_mul_f32 v84, s50, v84
 v_mfma_f32_16x16x32_bf16 v[104:107], a[124:127], v[56:59], v[104:107]
 ds_read_b128 v[44:47], v7 offset:30720
 v_mfma_f32_16x16x32_bf16 v[112:115], a[196:199], v[56:59], v[112:115]
 s_add_u32 s43, s43, 36864
 s_cmp_eq_u32 s43, 147456
 v_mfma_f32_16x16x32_bf16 v[120:123], v[236:239], v[56:59], v[120:123]
 s_cselect_b32 s43, 0, s43
 s_add_u32 s44, s44, 36864
 v_mfma_f32_16x16x32_bf16 v[100:103], a[52:55], v[60:63], v[100:103]
 s_cmp_eq_u32 s44, 147456
 s_cselect_b32 s44, 0, s44
 v_mfma_f32_16x16x32_bf16 v[108:111], a[124:127], v[60:63], v[108:111]
 v_mul_f32 v85, s50, v85
 v_mfma_f32_16x16x32_bf16 v[116:119], a[196:199], v[60:63], v[116:119]
 v_mul_f32 v86, s50, v86
 v_mfma_f32_16x16x32_bf16 v[124:127], v[236:239], v[60:63], v[124:127]
 s_waitcnt lgkmcnt(2)
 v_mfma_f32_16x16x32_bf16 v[96:99], a[56:59], v[32:35], v[96:99]
 ds_read_b128 v[48:51], v6 offset:32768
 v_mul_f32 v87, s50, v87
 v_mfma_f32_16x16x32_bf16 v[104:107], a[128:131], v[32:35], v[104:107]
 ds_read_b128 v[52:55], v6 offset:34816
 v_mfma_f32_16x16x32_bf16 v[112:115], a[200:203], v[32:35], v[112:115]
 v_add_u32 v6, s43, v4
 v_mul_f32 v92, s50, v92
 v_mfma_f32_16x16x32_bf16 v[120:123], v[240:243], v[32:35], v[120:123]
 v_mfma_f32_16x16x32_bf16 v[100:103], a[56:59], v[36:39], v[100:103]
 v_mul_f32 v93, s50, v93
 v_mfma_f32_16x16x32_bf16 v[108:111], a[128:131], v[36:39], v[108:111]
 v_mul_f32 v94, s50, v94
 v_mfma_f32_16x16x32_bf16 v[116:119], a[200:203], v[36:39], v[116:119]
 v_mul_f32 v95, s50, v95
 v_mfma_f32_16x16x32_bf16 v[124:127], v[240:243], v[36:39], v[124:127]
 s_waitcnt lgkmcnt(2)
 v_mfma_f32_16x16x32_bf16 v[96:99], a[60:63], v[40:43], v[96:99]
 ds_read_b128 v[56:59], v7 offset:32768
 v_cvt_pk_bf16_f32 v28, v84, v85
 v_mfma_f32_16x16x32_bf16 v[104:107], a[132:135], v[40:43], v[104:107]
 ds_read_b128 v[60:63], v7 offset:34816
 v_mfma_f32_16x16x32_bf16 v[112:115], a[204:207], v[40:43], v[112:115]
 v_add_u32 v7, s43, v5
 v_cvt_pk_bf16_f32 v29, v92, v93
 v_mfma_f32_16x16x32_bf16 v[120:123], v[244:247], v[40:43], v[120:123]
 v_cvt_pk_bf16_f32 v30, v86, v87
 v_mfma_f32_16x16x32_bf16 v[100:103], a[60:63], v[44:47], v[100:103]
 v_mfma_f32_16x16x32_bf16 v[108:111], a[132:135], v[44:47], v[108:111]
 v_cvt_pk_bf16_f32 v31, v94, v95
 v_mfma_f32_16x16x32_bf16 v[116:119], a[204:207], v[44:47], v[116:119]
 buffer_store_dwordx4 v[28:31], v12, s[20:23], s48 offen offset:1024 sc1
 v_mfma_f32_16x16x32_bf16 v[124:127], v[244:247], v[44:47], v[124:127]
 s_waitcnt lgkmcnt(2)
 v_mfma_f32_16x16x32_bf16 v[96:99], a[64:67], v[48:51], v[96:99]
 s_waitcnt vmcnt(13)
 s_barrier
 ds_read_b128 v[32:35], v6 offset:0
 v_mfma_f32_16x16x32_bf16 v[104:107], a[136:139], v[48:51], v[104:107]
 ds_read_b128 v[36:39], v6 offset:2048
 v_mfma_f32_16x16x32_bf16 v[112:115], a[208:211], v[48:51], v[112:115]
 v_mfma_f32_16x16x32_bf16 v[120:123], v[248:251], v[48:51], v[120:123]
 v_mfma_f32_16x16x32_bf16 v[100:103], a[64:67], v[52:55], v[100:103]
 v_mfma_f32_16x16x32_bf16 v[108:111], a[136:139], v[52:55], v[108:111]
 v_mfma_f32_16x16x32_bf16 v[116:119], a[208:211], v[52:55], v[116:119]
 v_mfma_f32_16x16x32_bf16 v[124:127], v[248:251], v[52:55], v[124:127]
 s_waitcnt lgkmcnt(2)
 v_mfma_f32_16x16x32_bf16 v[96:99], a[68:71], v[56:59], v[96:99]
 ds_read_b128 v[40:43], v7 offset:0
 v_mfma_f32_16x16x32_bf16 v[104:107], a[140:143], v[56:59], v[104:107]
 ds_read_b128 v[44:47], v7 offset:2048
 v_mfma_f32_16x16x32_bf16 v[112:115], a[212:215], v[56:59], v[112:115]
 s_mul_i32 s45, s39, 262144
 s_add_u32 s47, s34, s45
 v_mfma_f32_16x16x32_bf16 v[120:123], v[252:255], v[56:59], v[120:123]
 s_add_u32 s48, s35, s45
 v_mov_b32 v14, s42
 v_mfma_f32_16x16x32_bf16 v[100:103], a[68:71], v[60:63], v[100:103]
 s_mov_b32 s39, s40
 s_mov_b32 s40, s41
 v_mfma_f32_16x16x32_bf16 v[108:111], a[140:143], v[60:63], v[108:111]
 s_add_u32 s42, s42, 1
 s_cmp_lt_u32 s42, s36
 v_mfma_f32_16x16x32_bf16 v[116:119], a[212:215], v[60:63], v[116:119]
 v_mfma_f32_16x16x32_bf16 v[124:127], v[252:255], v[60:63], v[124:127]
 s_waitcnt lgkmcnt(2)
 s_cbranch_scc1 Lps_loop_21
 s_nop 7
 v_mul_f32 v96, s50, v96
 v_mul_f32 v97, s50, v97
 v_mul_f32 v98, s50, v98
 v_mul_f32 v99, s50, v99
 v_mul_f32 v104, s50, v104
 v_mul_f32 v105, s50, v105
 v_mul_f32 v106, s50, v106
 v_mul_f32 v107, s50, v107
 v_cvt_pk_bf16_f32 v16, v96, v97
 v_cvt_pk_bf16_f32 v17, v104, v105
 v_cvt_pk_bf16_f32 v18, v98, v99
 v_cvt_pk_bf16_f32 v19, v106, v107
 buffer_store_dwordx4 v[16:19], v12, s[20:23], s47 offen offset:0 sc1
 v_mul_f32 v100, s50, v100
 v_mul_f32 v101, s50, v101
 v_mul_f32 v102, s50, v102
 v_mul_f32 v103, s50, v103
 v_mul_f32 v108, s50, v108
 v_mul_f32 v109, s50, v109
 v_mul_f32 v110, s50, v110
 v_mul_f32 v111, s50, v111
 v_cvt_pk_bf16_f32 v20, v100, v101
 v_cvt_pk_bf16_f32 v21, v108, v109
 v_cvt_pk_bf16_f32 v22, v102, v103
 v_cvt_pk_bf16_f32 v23, v110, v111
 buffer_store_dwordx4 v[20:23], v12, s[20:23], s47 offen offset:1024 sc1
 v_mul_f32 v112, s50, v112
 v_mul_f32 v113, s50, v113
 v_mul_f32 v114, s50, v114
 v_mul_f32 v115, s50, v115
 v_mul_f32 v120, s50, v120
 v_mul_f32 v121, s50, v121
 v_mul_f32 v122, s50, v122
 v_mul_f32 v123, s50, v123
 v_cvt_pk_bf16_f32 v24, v112, v113
 v_cvt_pk_bf16_f32 v25, v120, v121
 v_cvt_pk_bf16_f32 v26, v114, v115
 v_cvt_pk_bf16_f32 v27, v122, v123
 buffer_store_dwordx4 v[24:27], v12, s[20:23], s48 offen offset:0 sc1
 v_mul_f32 v116, s50, v116
 v_mul_f32 v117, s50, v117
 v_mul_f32 v118, s50, v118
 v_mul_f32 v119, s50, v119
 v_mul_f32 v124, s50, v124
 v_mul_f32 v125, s50, v125
 v_mul_f32 v126, s50, v126
 v_mul_f32 v127, s50, v127
 v_cvt_pk_bf16_f32 v28, v116, v117
 v_cvt_pk_bf16_f32 v29, v124, v125
 v_cvt_pk_bf16_f32 v30, v118, v119
 v_cvt_pk_bf16_f32 v31, v126, v127
 buffer_store_dwordx4 v[28:31], v12, s[20:23], s48 offen offset:1024 sc1
 s_waitcnt vmcnt(0) lgkmcnt(0)
 s_barrier
 v_mov_b32 v14, s36
 buffer_store_dword v14, v13, s[20:23], 0 offen sc1
 s_sub_u32 s3, s5, 2
 s_add_u32 s7, s6, s3
 s_cmp_ge_u32 s7, 30
 s_cbranch_scc1 Lfin
 s_cmp_ge_u32 s6, 16
 s_cbranch_scc1 Lob
 s_load_dwordx2 s[8:9], s[0:1], 48
 s_mov_b32 s10, 0x240000
 s_mov_b32 s11, 0x20000
 s_load_dwordx2 s[12:13], s[0:1], 64
 s_mov_b32 s14, 0x480000
 s_mov_b32 s15, 0x20000
 s_load_dwordx2 s[16:17], s[0:1], 64
 s_mov_b32 s18, 0x480000
 s_mov_b32 s19, 0x20000
 s_lshl_b32 s32, s6, 9
 s_add_u32 s33, s32, 256
 s_mov_b32 s36, 32
 s_mov_b32 s37, s3
 s_lshl_b32 s52, s6, 1
 s_lshl_b32 s7, s3, 4
 s_add_u32 s7, s7, s6
 s_and_b32 s94, s7, 3
 s_lshr_b32 s7, s7, 2
 s_lshl_b32 s7, s7, 5
 s_add_u32 s7, s7, s94
 s_lshl_b32 s7, s7, 2
 s_add_u32 s59, s7, 0x3800
 s_waitcnt lgkmcnt(0)
 v_and_b32 v1, 63, v0
 v_lshrrev_b32 v2, 3, v0
 v_mul_u32_u24 v10, 1152, v2
 v_lshrrev_b32 v2, 4, v0
 v_xor_b32 v2, v2, v0
 v_and_b32 v2, 7, v2
 v_lshl_add_u32 v10, v2, 4, v10
 v_lshrrev_b32 v2, 4, v1
 v_bfe_u32 v3, v1, 1, 3
 v_xor_b32 v2, v2, v3
 v_and_b32 v3, 15, v1
 v_lshlrev_b32 v3, 7, v3
 v_lshl_add_u32 v4, v2, 4, v3
 v_xor_b32 v5, 64, v4
 v_lshrrev_b32 v2, 4, v0
 v_lshlrev_b32 v11, 13, v2
 v_lshrrev_b32 v2, 7, v0
 v_lshrrev_b32 v3, 4, v1
 v_lshl_add_u32 v3, v2, 2, v3
 v_bfe_u32 v2, v1, 1, 3
 v_xor_b32 v2, v2, v3
 v_lshl_add_u32 v11, v2, 5, v11
 v_and_b32 v2, 1, v1
 v_lshl_add_u32 v11, v2, 4, v11
 v_bfe_u32 v2, v1, 2, 3
 v_xor_b32 v3, s4, v2
 v_lshlrev_b32 v3, 5, v3
 v_and_b32 v2, 3, v2
 v_lshl_add_u32 v3, v2, 8, v3
 v_lshrrev_b32 v2, 4, v1
 v_lshl_add_u32 v3, v2, 11, v3
 v_and_b32 v2, 3, v1
 v_lshl_add_u32 v3, v2, 3, v3
 v_add_u32 v8, 73728, v3
 v_xor_b32 v3, 0x80, v3
 v_add_u32 v9, 73728, v3
 s_lshl_b32 s45, s4, 11
 v_lshl_add_u32 v12, v1, 4, s45
 s_mov_b32 s39, s37
 s_add_u32 s40, s39, 2
 s_lshl_b32 s49, s4, 10
 s_mul_i32 s46, s39, 36864
 s_add_u32 m0, s49, 0
 s_nop 0
 buffer_load_dwordx4 v10, s[8:11], s46 offen offset:0  lds
 s_add_u32 m0, s49, 3968
 s_nop 0
 buffer_load_dwordx4 v10, s[8:11], s46 offen offset:128  lds
 s_add_u32 m0, s49, 7936
 s_nop 0
 buffer_load_dwordx4 v10, s[8:11], s46 offen offset:256  lds
 s_add_u32 m0, s49, 11904
 s_nop 0
 buffer_load_dwordx4 v10, s[8:11], s46 offen offset:384  lds
 s_add_u32 m0, s49, 15872
 s_nop 0
 buffer_load_dwordx4 v10, s[8:11], s46 offen offset:512  lds
 s_add_u32 m0, s49, 19840
 s_nop 0
 buffer_load_dwordx4 v10, s[8:11], s46 offen offset:640  lds
 s_add_u32 m0, s49, 23808
 s_nop 0
 buffer_load_dwordx4 v10, s[8:11], s46 offen offset:768  lds
 s_add_u32 m0, s49, 27776
 s_nop 0
 buffer_load_dwordx4 v10, s[8:11], s46 offen offset:896  lds
 s_add_u32 m0, s49, 31744
 s_nop 0
 buffer_load_dwordx4 v10, s[8:11], s46 offen offset:1024  lds
 s_lshl_b32 s49, s4, 10
 s_add_u32 s49, s49, 36864
 s_mul_i32 s46, s40, 36864
 s_add_u32 m0, s49, 0
 s_nop 0
 buffer_load_dwordx4 v10, s[8:11], s46 offen offset:0  lds
 s_add_u32 m0, s49, 3968
 s_nop 0
 buffer_load_dwordx4 v10, s[8:11], s46 offen offset:128  lds
 s_add_u32 m0, s49, 7936
 s_nop 0
 buffer_load_dwordx4 v10, s[8:11], s46 offen offset:256  lds
 s_add_u32 m0, s49, 11904
 s_nop 0
 buffer_load_dwordx4 v10, s[8:11], s46 offen offset:384  lds
 s_add_u32 m0, s49, 15872
 s_nop 0
 buffer_load_dwordx4 v10, s[8:11], s46 offen offset:512  lds
 s_add_u32 m0, s49, 19840
 s_nop 0
 buffer_load_dwordx4 v10, s[8:11], s46 offen offset:640  lds
 s_add_u32 m0, s49, 23808
 s_nop 0
 buffer_load_dwordx4 v10, s[8:11], s46 offen offset:768  lds
 s_add_u32 m0, s49, 27776
 s_nop 0
 buffer_load_dwordx4 v10, s[8:11], s46 offen offset:896  lds
 s_add_u32 m0, s49, 31744
 s_nop 0
 buffer_load_dwordx4 v10, s[8:11], s46 offen offset:1024  lds
 s_lshl_b32 s49, s4, 10
 s_add_u32 m0, s49, 73728
 s_add_u32 s45, s32, 0
 buffer_load_dwordx4 v11, s[12:15], s45 offen  lds
 s_add_u32 m0, s49, 77824
 s_add_u32 s45, s32, 131072
 buffer_load_dwordx4 v11, s[12:15], s45 offen  lds
 s_add_u32 m0, s49, 81920
 s_add_u32 s45, s33, 0
 buffer_load_dwordx4 v11, s[16:19], s45 offen  lds
 s_add_u32 m0, s49, 86016
 s_add_u32 s45, s33, 131072
 buffer_load_dwordx4 v11, s[16:19], s45 offen  lds
 s_add_u32 m0, s49, 90112
 s_add_u32 s45, s32, 262144
 buffer_load_dwordx4 v11, s[12:15], s45 offen  lds
 s_add_u32 m0, s49, 94208
 s_add_u32 s45, s32, 393216
 buffer_load_dwordx4 v11, s[12:15], s45 offen  lds
 s_add_u32 m0, s49, 98304
 s_add_u32 s45, s33, 262144
 buffer_load_dwordx4 v11, s[16:19], s45 offen  lds
 s_add_u32 m0, s49, 102400
 s_add_u32 s45, s33, 393216
 buffer_load_dwordx4 v11, s[16:19], s45 offen  lds
 s_add_u32 m0, s49, 106496
 s_add_u32 s45, s32, 524288
 buffer_load_dwordx4 v11, s[12:15], s45 offen  lds
 s_add_u32 m0, s49, 110592
 s_add_u32 s45, s32, 655360
 buffer_load_dwordx4 v11, s[12:15], s45 offen  lds
 s_add_u32 m0, s49, 114688
 s_add_u32 s45, s33, 524288
 buffer_load_dwordx4 v11, s[16:19], s45 offen  lds
 s_add_u32 m0, s49, 118784
 s_add_u32 s45, s33, 655360
 buffer_load_dwordx4 v11, s[16:19], s45 offen  lds
 s_waitcnt vmcnt(8) lgkmcnt(0)
 s_barrier
 s_add_u32 m0, s49, 122880
 s_add_u32 s45, s32, 786432
 buffer_load_dwordx4 v11, s[12:15], s45 offen  lds
 s_add_u32 m0, s49, 126976
 s_add_u32 s45, s32, 917504
 buffer_load_dwordx4 v11, s[12:15], s45 offen  lds
 s_add_u32 m0, s49, 131072
 s_add_u32 s45, s33, 786432
 buffer_load_dwordx4 v11, s[16:19], s45 offen  lds
 s_add_u32 m0, s49, 135168
 s_add_u32 s45, s33, 917504
 buffer_load_dwordx4 v11, s[16:19], s45 offen  lds
 ds_read_b64_tr_b16 a[0:1], v8 offset:0
 ds_read_b64_tr_b16 a[2:3], v8 offset:1024
 ds_read_b64_tr_b16 a[72:73], v9 offset:0
 ds_read_b64_tr_b16 a[74:75], v9 offset:1024
 ds_read_b64_tr_b16 a[144:145], v8 offset:8192
 ds_read_b64_tr_b16 a[146:147], v8 offset:9216
 ds_read_b64_tr_b16 a[216:217], v9 offset:8192
 ds_read_b64_tr_b16 a[218:219], v9 offset:9216
 s_waitcnt vmcnt(8) lgkmcnt(0)
 s_barrier
 s_add_u32 m0, s49, 73728
 s_add_u32 s45, s32, 1048576
 buffer_load_dwordx4 v11, s[12:15], s45 offen  lds
 s_add_u32 m0, s49, 77824
 s_add_u32 s45, s32, 1179648
 buffer_load_dwordx4 v11, s[12:15], s45 offen  lds
 s_add_u32 m0, s49, 81920
 s_add_u32 s45, s33, 1048576
 buffer_load_dwordx4 v11, s[16:19], s45 offen  lds
 s_add_u32 m0, s49, 86016
 s_add_u32 s45, s33, 1179648
 buffer_load_dwordx4 v11, s[16:19], s45 offen  lds
 ds_read_b64_tr_b16 a[4:5], v8 offset:16384
 ds_read_b64_tr_b16 a[6:7], v8 offset:17408
 ds_read_b64_tr_b16 a[76:77], v9 offset:16384
 ds_read_b64_tr_b16 a[78:79], v9 offset:17408
 ds_read_b64_tr_b16 a[148:149], v8 offset:24576
 ds_read_b64_tr_b16 a[150:151], v8 offset:25600
 ds_read_b64_tr_b16 a[220:221], v9 offset:24576
 ds_read_b64_tr_b16 a[222:223], v9 offset:25600
 s_waitcnt vmcnt(8) lgkmcnt(0)
 s_barrier
 s_add_u32 m0, s49, 90112
 s_add_u32 s45, s32, 1310720
 buffer_load_dwordx4 v11, s[12:15], s45 offen  lds
 s_add_u32 m0, s49, 94208
 s_add_u32 s45, s32, 1441792
 buffer_load_dwordx4 v11, s[12:15], s45 offen  lds
 s_add_u32 m0, s49, 98304
 s_add_u32 s45, s33, 1310720
 buffer_load_dwordx4 v11, s[16:19], s45 offen  lds
 s_add_u32 m0, s49, 102400
 s_add_u32 s45, s33, 1441792
 buffer_load_dwordx4 v11, s[16:19], s45 offen  lds
 ds_read_b64_tr_b16 a[8:9], v8 offset:32768
 ds_read_b64_tr_b16 a[10:11], v8 offset:33792
 ds_read_b64_tr_b16 a[80:81], v9 offset:32768
 ds_read_b64_tr_b16 a[82:83], v9 offset:33792
 ds_read_b64_tr_b16 a[152:153], v8 offset:40960
 ds_read_b64_tr_b16 a[154:155], v8 offset:41984
 ds_read_b64_tr_b16 a[224:225], v9 offset:40960
 ds_read_b64_tr_b16 a[226:227], v9 offset:41984
 s_waitcnt vmcnt(8) lgkmcnt(0)
 s_barrier
 s_add_u32 m0, s49, 106496
 s_add_u32 s45, s32, 1572864
 buffer_load_dwordx4 v11, s[12:15], s45 offen  lds
 s_add_u32 m0, s49, 110592
 s_add_u32 s45, s32, 1703936
 buffer_load_dwordx4 v11, s[12:15], s45 offen  lds
 s_add_u32 m0, s49, 114688
 s_add_u32 s45, s33, 1572864
 buffer_load_dwordx4 v11, s[16:19], s45 offen  lds
 s_add_u32 m0, s49, 118784
 s_add_u32 s45, s33, 1703936
 buffer_load_dwordx4 v11, s[16:19], s45 offen  lds
 ds_read_b64_tr_b16 a[12:13], v8 offset:49152
 ds_read_b64_tr_b16 a[14:15], v8 offset:50176
 ds_read_b64_tr_b16 a[84:85], v9 offset:49152
 ds_read_b64_tr_b16 a[86:87], v9 offset:50176
 ds_read_b64_tr_b16 a[156:157], v8 offset:57344
 ds_read_b64_tr_b16 a[158:159], v8 offset:58368
 ds_read_b64_tr_b16 a[228:229], v9 offset:57344
 ds_read_b64_tr_b16 a[230:231], v9 offset:58368
 s_waitcnt vmcnt(8) lgkmcnt(0)
 s_barrier
 s_add_u32 m0, s49, 122880
 s_add_u32 s45, s32, 1835008
 buffer_load_dwordx4 v11, s[12:15], s45 offen  lds
 s_add_u32 m0, s49, 126976
 s_add_u32 s45, s32, 1966080
 buffer_load_dwordx4 v11, s[12:15], s45 offen  lds
 s_add_u32 m0, s49, 131072
 s_add_u32 s45, s33, 1835008
 buffer_load_dwordx4 v11, s[16:19], s45 offen  lds
 s_add_u32 m0, s49, 135168
 s_add_u32 s45, s33, 1966080
 buffer_load_dwordx4 v11, s[16:19], s45 offen  lds
 ds_read_b64_tr_b16 a[16:17], v8 offset:0
 ds_read_b64_tr_b16 a[18:19], v8 offset:1024
 ds_read_b64_tr_b16 a[88:89], v9 offset:0
 ds_read_b64_tr_b16 a[90:91], v9 offset:1024
 ds_read_b64_tr_b16 a[160:161], v8 offset:8192
 ds_read_b64_tr_b16 a[162:163], v8 offset:9216
 ds_read_b64_tr_b16 a[232:233], v9 offset:8192
 ds_read_b64_tr_b16 a[234:235], v9 offset:9216
 s_waitcnt vmcnt(8) lgkmcnt(0)
 s_barrier
 s_add_u32 m0, s49, 73728
 s_add_u32 s45, s32, 2097152
 buffer_load_dwordx4 v11, s[12:15], s45 offen  lds
 s_add_u32 m0, s49, 77824
 s_add_u32 s45, s32, 2228224
 buffer_load_dwordx4 v11, s[12:15], s45 offen  lds
 s_add_u32 m0, s49, 81920
 s_add_u32 s45, s33, 2097152
 buffer_load_dwordx4 v11, s[16:19], s45 offen  lds
 s_add_u32 m0, s49, 86016
 s_add_u32 s45, s33, 2228224
 buffer_load_dwordx4 v11, s[16:19], s45 offen  lds
 ds_read_b64_tr_b16 a[20:21], v8 offset:16384
 ds_read_b64_tr_b16 a[22:23], v8 offset:17408
 ds_read_b64_tr_b16 a[92:93], v9 offset:16384
 ds_read_b64_tr_b16 a[94:95], v9 offset:17408
 ds_read_b64_tr_b16 a[164:165], v8 offset:24576
 ds_read_b64_tr_b16 a[166:167], v8 offset:25600
 ds_read_b64_tr_b16 a[236:237], v9 offset:24576
 ds_read_b64_tr_b16 a[238:239], v9 offset:25600
 s_waitcnt vmcnt(8) lgkmcnt(0)
 s_barrier
 s_add_u32 m0, s49, 90112
 s_add_u32 s45, s32, 2359296
 buffer_load_dwordx4 v11, s[12:15], s45 offen  lds
 s_add_u32 m0, s49, 94208
 s_add_u32 s45, s32, 2490368
 buffer_load_dwordx4 v11, s[12:15], s45 offen  lds
 s_add_u32 m0, s49, 98304
 s_add_u32 s45, s33, 2359296
 buffer_load_dwordx4 v11, s[16:19], s45 offen  lds
 s_add_u32 m0, s49, 102400
 s_add_u32 s45, s33, 2490368
 buffer_load_dwordx4 v11, s[16:19], s45 offen  lds
 ds_read_b64_tr_b16 a[24:25], v8 offset:32768
 ds_read_b64_tr_b16 a[26:27], v8 offset:33792
 ds_read_b64_tr_b16 a[96:97], v9 offset:32768
 ds_read_b64_tr_b16 a[98:99], v9 offset:33792
 ds_read_b64_tr_b16 a[168:169], v8 offset:40960
 ds_read_b64_tr_b16 a[170:171], v8 offset:41984
 ds_read_b64_tr_b16 a[240:241], v9 offset:40960
 ds_read_b64_tr_b16 a[242:243], v9 offset:41984
 s_waitcnt vmcnt(8) lgkmcnt(0)
 s_barrier
 s_add_u32 m0, s49, 106496
 s_add_u32 s45, s32, 2621440
 buffer_load_dwordx4 v11, s[12:15], s45 offen  lds
 s_add_u32 m0, s49, 110592
 s_add_u32 s45, s32, 2752512
 buffer_load_dwordx4 v11, s[12:15], s45 offen  lds
 s_add_u32 m0, s49, 114688
 s_add_u32 s45, s33, 2621440
 buffer_load_dwordx4 v11, s[16:19], s45 offen  lds
 s_add_u32 m0, s49, 118784
 s_add_u32 s45, s33, 2752512
 buffer_load_dwordx4 v11, s[16:19], s45 offen  lds
 ds_read_b64_tr_b16 a[28:29], v8 offset:49152
 ds_read_b64_tr_b16 a[30:31], v8 offset:50176
 ds_read_b64_tr_b16 a[100:101], v9 offset:49152
 ds_read_b64_tr_b16 a[102:103], v9 offset:50176
 ds_read_b64_tr_b16 a[172:173], v8 offset:57344
 ds_read_b64_tr_b16 a[174:175], v8 offset:58368
 ds_read_b64_tr_b16 a[244:245], v9 offset:57344
 ds_read_b64_tr_b16 a[246:247], v9 offset:58368
 s_waitcnt vmcnt(8) lgkmcnt(0)
 s_barrier
 s_add_u32 m0, s49, 122880
 s_add_u32 s45, s32, 2883584
 buffer_load_dwordx4 v11, s[12:15], s45 offen  lds
 s_add_u32 m0, s49, 126976
 s_add_u32 s45, s32, 3014656
 buffer_load_dwordx4 v11, s[12:15], s45 offen  lds
 s_add_u32 m0, s49, 131072
 s_add_u32 s45, s33, 2883584
 buffer_load_dwordx4 v11, s[16:19], s45 offen  lds
 s_add_u32 m0, s49, 135168
 s_add_u32 s45, s33, 3014656
 buffer_load_dwordx4 v11, s[16:19], s45 offen  lds
 ds_read_b64_tr_b16 a[32:33], v8 offset:0
 ds_read_b64_tr_b16 a[34:35], v8 offset:1024
 ds_read_b64_tr_b16 a[104:105], v9 offset:0
 ds_read_b64_tr_b16 a[106:107], v9 offset:1024
 ds_read_b64_tr_b16 a[176:177], v8 offset:8192
 ds_read_b64_tr_b16 a[178:179], v8 offset:9216
 ds_read_b64_tr_b16 a[248:249], v9 offset:8192
 ds_read_b64_tr_b16 a[250:251], v9 offset:9216
 s_waitcnt vmcnt(8) lgkmcnt(0)
 s_barrier
 s_add_u32 m0, s49, 73728
 s_add_u32 s45, s32, 3145728
 buffer_load_dwordx4 v11, s[12:15], s45 offen  lds
 s_add_u32 m0, s49, 77824
 s_add_u32 s45, s32, 3276800
 buffer_load_dwordx4 v11, s[12:15], s45 offen  lds
 s_add_u32 m0, s49, 81920
 s_add_u32 s45, s33, 3145728
 buffer_load_dwordx4 v11, s[16:19], s45 offen  lds
 s_add_u32 m0, s49, 86016
 s_add_u32 s45, s33, 3276800
 buffer_load_dwordx4 v11, s[16:19], s45 offen  lds
 ds_read_b64_tr_b16 a[36:37], v8 offset:16384
 ds_read_b64_tr_b16 a[38:39], v8 offset:17408
 ds_read_b64_tr_b16 a[108:109], v9 offset:16384
 ds_read_b64_tr_b16 a[110:111], v9 offset:17408
 ds_read_b64_tr_b16 a[180:181], v8 offset:24576
 ds_read_b64_tr_b16 a[182:183], v8 offset:25600
 ds_read_b64_tr_b16 a[252:253], v9 offset:24576
 ds_read_b64_tr_b16 a[254:255], v9 offset:25600
 s_waitcnt vmcnt(8) lgkmcnt(0)
 s_barrier
 s_add_u32 m0, s49, 90112
 s_add_u32 s45, s32, 3407872
 buffer_load_dwordx4 v11, s[12:15], s45 offen  lds
 s_add_u32 m0, s49, 94208
 s_add_u32 s45, s32, 3538944
 buffer_load_dwordx4 v11, s[12:15], s45 offen  lds
 s_add_u32 m0, s49, 98304
 s_add_u32 s45, s33, 3407872
 buffer_load_dwordx4 v11, s[16:19], s45 offen  lds
 s_add_u32 m0, s49, 102400
 s_add_u32 s45, s33, 3538944
 buffer_load_dwordx4 v11, s[16:19], s45 offen  lds
 ds_read_b64_tr_b16 a[40:41], v8 offset:32768
 ds_read_b64_tr_b16 a[42:43], v8 offset:33792
 ds_read_b64_tr_b16 a[112:113], v9 offset:32768
 ds_read_b64_tr_b16 a[114:115], v9 offset:33792
 ds_read_b64_tr_b16 a[184:185], v8 offset:40960
 ds_read_b64_tr_b16 a[186:187], v8 offset:41984
 ds_read_b64_tr_b16 v[224:225], v9 offset:40960
 ds_read_b64_tr_b16 v[226:227], v9 offset:41984
 s_waitcnt vmcnt(8) lgkmcnt(0)
 s_barrier
 s_add_u32 m0, s49, 106496
 s_add_u32 s45, s32, 3670016
 buffer_load_dwordx4 v11, s[12:15], s45 offen  lds
 s_add_u32 m0, s49, 110592
 s_add_u32 s45, s32, 3801088
 buffer_load_dwordx4 v11, s[12:15], s45 offen  lds
 s_add_u32 m0, s49, 114688
 s_add_u32 s45, s33, 3670016
 buffer_load_dwordx4 v11, s[16:19], s45 offen  lds
 s_add_u32 m0, s49, 118784
 s_add_u32 s45, s33, 3801088
 buffer_load_dwordx4 v11, s[16:19], s45 offen  lds
 ds_read_b64_tr_b16 a[44:45], v8 offset:49152
 ds_read_b64_tr_b16 a[46:47], v8 offset:50176
 ds_read_b64_tr_b16 a[116:117], v9 offset:49152
 ds_read_b64_tr_b16 a[118:119], v9 offset:50176
 ds_read_b64_tr_b16 a[188:189], v8 offset:57344
 ds_read_b64_tr_b16 a[190:191], v8 offset:58368
 ds_read_b64_tr_b16 v[228:229], v9 offset:57344
 ds_read_b64_tr_b16 v[230:231], v9 offset:58368
 s_waitcnt vmcnt(8) lgkmcnt(0)
 s_barrier
 s_add_u32 m0, s49, 122880
 s_add_u32 s45, s32, 3932160
 buffer_load_dwordx4 v11, s[12:15], s45 offen  lds
 s_add_u32 m0, s49, 126976
 s_add_u32 s45, s32, 4063232
 buffer_load_dwordx4 v11, s[12:15], s45 offen  lds
 s_add_u32 m0, s49, 131072
 s_add_u32 s45, s33, 3932160
 buffer_load_dwordx4 v11, s[16:19], s45 offen  lds
 s_add_u32 m0, s49, 135168
 s_add_u32 s45, s33, 4063232
 buffer_load_dwordx4 v11, s[16:19], s45 offen  lds
 ds_read_b64_tr_b16 a[48:49], v8 offset:0
 ds_read_b64_tr_b16 a[50:51], v8 offset:1024
 ds_read_b64_tr_b16 a[120:121], v9 offset:0
 ds_read_b64_tr_b16 a[122:123], v9 offset:1024
 ds_read_b64_tr_b16 a[192:193], v8 offset:8192
 ds_read_b64_tr_b16 a[194:195], v8 offset:9216
 ds_read_b64_tr_b16 v[232:233], v9 offset:8192
 ds_read_b64_tr_b16 v[234:235], v9 offset:9216
 s_waitcnt vmcnt(8) lgkmcnt(0)
 s_barrier
 s_add_u32 m0, s49, 73728
 s_add_u32 s45, s32, 4194304
 buffer_load_dwordx4 v11, s[12:15], s45 offen  lds
 s_add_u32 m0, s49, 77824
 s_add_u32 s45, s32, 4325376
 buffer_load_dwordx4 v11, s[12:15], s45 offen  lds
 s_add_u32 m0, s49, 81920
 s_add_u32 s45, s33, 4194304
 buffer_load_dwordx4 v11, s[16:19], s45 offen  lds
 s_add_u32 m0, s49, 86016
 s_add_u32 s45, s33, 4325376
 buffer_load_dwordx4 v11, s[16:19], s45 offen  lds
 ds_read_b64_tr_b16 a[52:53], v8 offset:16384
 ds_read_b64_tr_b16 a[54:55], v8 offset:17408
 ds_read_b64_tr_b16 a[124:125], v9 offset:16384
 ds_read_b64_tr_b16 a[126:127], v9 offset:17408
 ds_read_b64_tr_b16 a[196:197], v8 offset:24576
 ds_read_b64_tr_b16 a[198:199], v8 offset:25600
 ds_read_b64_tr_b16 v[236:237], v9 offset:24576
 ds_read_b64_tr_b16 v[238:239], v9 offset:25600
 s_waitcnt vmcnt(8) lgkmcnt(0)
 s_barrier
 s_add_u32 m0, s49, 90112
 s_add_u32 s45, s32, 4456448
 buffer_load_dwordx4 v11, s[12:15], s45 offen  lds
 s_add_u32 m0, s49, 94208
 s_add_u32 s45, s32, 4587520
 buffer_load_dwordx4 v11, s[12:15], s45 offen  lds
 s_add_u32 m0, s49, 98304
 s_add_u32 s45, s33, 4456448
 buffer_load_dwordx4 v11, s[16:19], s45 offen  lds
 s_add_u32 m0, s49, 102400
 s_add_u32 s45, s33, 4587520
 buffer_load_dwordx4 v11, s[16:19], s45 offen  lds
 ds_read_b64_tr_b16 a[56:57], v8 offset:32768
 ds_read_b64_tr_b16 a[58:59], v8 offset:33792
 ds_read_b64_tr_b16 a[128:129], v9 offset:32768
 ds_read_b64_tr_b16 a[130:131], v9 offset:33792
 ds_read_b64_tr_b16 a[200:201], v8 offset:40960
 ds_read_b64_tr_b16 a[202:203], v8 offset:41984
 ds_read_b64_tr_b16 v[240:241], v9 offset:40960
 ds_read_b64_tr_b16 v[242:243], v9 offset:41984
 s_waitcnt vmcnt(8) lgkmcnt(0)
 s_barrier
 ds_read_b64_tr_b16 a[60:61], v8 offset:49152
 ds_read_b64_tr_b16 a[62:63], v8 offset:50176
 ds_read_b64_tr_b16 a[132:133], v9 offset:49152
 ds_read_b64_tr_b16 a[134:135], v9 offset:50176
 ds_read_b64_tr_b16 a[204:205], v8 offset:57344
 ds_read_b64_tr_b16 a[206:207], v8 offset:58368
 ds_read_b64_tr_b16 v[244:245], v9 offset:57344
 ds_read_b64_tr_b16 v[246:247], v9 offset:58368
 s_waitcnt vmcnt(4) lgkmcnt(0)
 s_barrier
 ds_read_b64_tr_b16 a[64:65], v8 offset:0
 ds_read_b64_tr_b16 a[66:67], v8 offset:1024
 ds_read_b64_tr_b16 a[136:137], v9 offset:0
 ds_read_b64_tr_b16 a[138:139], v9 offset:1024
 ds_read_b64_tr_b16 a[208:209], v8 offset:8192
 ds_read_b64_tr_b16 a[210:211], v8 offset:9216
 ds_read_b64_tr_b16 v[248:249], v9 offset:8192
 ds_read_b64_tr_b16 v[250:251], v9 offset:9216
 s_waitcnt vmcnt(0) lgkmcnt(0)
 s_barrier
 ds_read_b64_tr_b16 a[68:69], v8 offset:16384
 ds_read_b64_tr_b16 a[70:71], v8 offset:17408
 ds_read_b64_tr_b16 a[140:141], v9 offset:16384
 ds_read_b64_tr_b16 a[142:143], v9 offset:17408
 ds_read_b64_tr_b16 a[212:213], v8 offset:24576
 ds_read_b64_tr_b16 a[214:215], v8 offset:25600
 ds_read_b64_tr_b16 v[252:253], v9 offset:24576
 ds_read_b64_tr_b16 v[254:255], v9 offset:25600
 s_mov_b32 s50, 0x3e0293ee
 s_mov_b32 s42, 0
 s_mov_b32 s43, 0
 s_mov_b32 s44, 73728
 v_mov_b32 v6, v4
 v_mov_b32 v7, v5
 v_and_b32 v17, 63, v0
 v_lshlrev_b32 v1, 4, v17
 s_lshl_b32 s45, s4, 11
 s_add_u32 s45, s45, 147456
 v_add_u32 v2, s45, v1
 s_lshr_b32 s53, s4, 1
 s_and_b32 s54, s4, 1
 s_add_u32 s52, s52, s53
 s_lshl_b32 s53, s53, 13
 s_lshl_b32 s54, s54, 10
 s_add_u32 s45, s53, s54
 s_add_u32 s45, s45, 147456
 v_add_u32 v3, s45, v1
 s_lshl_b32 s63, s52, 13
 s_add_u32 s63, s63, s54
 s_add_u32 s63, s63, 0x7000000
 s_lshl_b32 s61, s52, 14
 s_add_u32 s61, s61, 0x3000000
 s_lshl_b32 s62, s52, 12
 s_add_u32 s62, s62, 0x400000
 s_lshl_b32 s57, s52, 7
 s_add_u32 s57, s57, 0x1000
 s_waitcnt lgkmcnt(0)
 v_min_u32 v8, 1, v0
 v_lshlrev_b32 v8, 28, v8
 s_mov_b32 s58, 0x40000
 v_mov_b32 v13, 0
 v_mov_b32 v14, 0
 v_min_u32 v15, 1, v17
 v_lshlrev_b32 v15, 28, v15
 v_bfe_u32 v18, v17, 3, 2
 v_and_b32 v19, 7, v17
 v_lshlrev_b32 v19, 7, v19
 v_lshl_add_u32 v18, v18, 11, v19
 v_lshrrev_b32 v19, 5, v17
 v_lshl_or_b32 v11, v19, 28, v18
 s_mov_b32 s56, s61
 v_mov_b32 v18, 0x44444444
 v_mov_b32 v19, 0xeeeeeeee
 v_and_b32 v20, 2, v17
 v_cmp_eq_u32 vcc, 0, v20
 s_nop 1
 v_cndmask_b32 v12, v19, v18, vcc
 v_mov_b32 v217, 0
 v_mov_b32 v218, 0
 v_mov_b32 v220, 0x3f803f80
 v_mov_b32 v221, 0x3f803f80
 v_mov_b32 v222, 0x3f803f80
 v_mov_b32 v223, 0x3f803f80
 v_and_b32 v18, 15, v17
 v_lshrrev_b32 v19, 4, v17
 v_lshlrev_b32 v19, 2, v19
 v_sub_u32 v18, v18, v19
 s_lshr_b32 s45, s54, 6
 v_add_u32 v18, s45, v18
 v_mov_b32 v19, 0xff800000
 v_cmp_le_i32 vcc, 0, v18
 s_nop 1
 v_cndmask_b32 v208, v19, v13, vcc
 v_cmp_le_i32 vcc, 1, v18
 s_nop 1
 v_cndmask_b32 v209, v19, v13, vcc
 v_cmp_le_i32 vcc, 2, v18
 s_nop 1
 v_cndmask_b32 v210, v19, v13, vcc
 v_cmp_le_i32 vcc, 3, v18
 s_nop 1
 v_cndmask_b32 v211, v19, v13, vcc
 v_cmp_le_i32 vcc, 16, v18
 s_nop 1
 v_cndmask_b32 v212, v19, v13, vcc
 v_cmp_le_i32 vcc, 17, v18
 s_nop 1
 v_cndmask_b32 v213, v19, v13, vcc
 v_cmp_le_i32 vcc, 18, v18
 s_nop 1
 v_cndmask_b32 v214, v19, v13, vcc
 v_cmp_le_i32 vcc, 19, v18
 s_nop 1
 v_cndmask_b32 v215, v19, v13, vcc
Lqs_22:
 buffer_load_dword v16, v15, s[20:23], s57 offen sc1
 s_waitcnt vmcnt(0)
 v_cmp_le_u32 vcc, 1, v16
 s_cbranch_vccnz Lqsk_23
 s_sleep 2
 s_sub_u32 s58, s58, 1
 s_cbranch_scc0 Lqs_22
 s_endpgm
Lqsk_23:
 s_waitcnt vmcnt(0) lgkmcnt(0)
 s_barrier
 ds_read_b128 v[32:35], v6 offset:0
 ds_read_b128 v[36:39], v6 offset:2048
 ds_read_b128 v[40:43], v7 offset:0
 ds_read_b128 v[44:47], v7 offset:2048
 s_waitcnt lgkmcnt(2)
Lqb_loop_24:
 v_mfma_f32_16x16x32_bf16 v[64:67], a[0:3], v[32:35], 0
 ds_read_b128 v[48:51], v6 offset:4096
 v_mfma_f32_16x16x32_bf16 v[72:75], a[72:75], v[32:35], 0
 ds_read_b128 v[52:55], v6 offset:6144
 v_mfma_f32_16x16x32_bf16 v[80:83], a[144:147], v[32:35], 0
 s_add_u32 s41, s40, 2
 v_mfma_f32_16x16x32_bf16 v[88:91], a[216:219], v[32:35], 0
 s_add_u32 s45, s42, 2
 s_mul_i32 s46, s41, 36864
 v_mfma_f32_16x16x32_bf16 v[68:71], a[0:3], v[36:39], 0
 s_cmp_lt_u32 s45, s36
 s_cselect_b32 s46, s46, 0
 v_mfma_f32_16x16x32_bf16 v[76:79], a[72:75], v[36:39], 0
 s_lshl_b32 s49, s4, 10
 s_add_u32 s49, s49, s44
 v_mfma_f32_16x16x32_bf16 v[84:87], a[144:147], v[36:39], 0
 s_lshl_b32 s53, s39, 19
 s_add_u32 s53, s53, s61
 v_mfma_f32_16x16x32_bf16 v[92:95], a[216:219], v[36:39], 0
 s_waitcnt lgkmcnt(2)
 v_mfma_f32_16x16x32_bf16 v[64:67], a[4:7], v[40:43], v[64:67]
 ds_read_b128 v[56:59], v7 offset:4096
 v_mfma_f32_16x16x32_bf16 v[72:75], a[76:79], v[40:43], v[72:75]
 ds_read_b128 v[60:63], v7 offset:6144
 v_mfma_f32_16x16x32_bf16 v[80:83], a[148:151], v[40:43], v[80:83]
 s_add_u32 m0, s49, 0
 v_mfma_f32_16x16x32_bf16 v[88:91], a[220:223], v[40:43], v[88:91]
 buffer_load_dwordx4 v10, s[8:11], s46 offen offset:0  lds
 v_mfma_f32_16x16x32_bf16 v[68:71], a[4:7], v[44:47], v[68:71]
 s_add_u32 m0, s49, 3968
 v_mfma_f32_16x16x32_bf16 v[76:79], a[76:79], v[44:47], v[76:79]
 buffer_load_dwordx4 v10, s[8:11], s46 offen offset:128  lds
 v_mfma_f32_16x16x32_bf16 v[84:87], a[148:151], v[44:47], v[84:87]
 s_lshl_b32 s55, s39, 17
 s_add_u32 s55, s55, s62
 v_mfma_f32_16x16x32_bf16 v[92:95], a[220:223], v[44:47], v[92:95]
 s_waitcnt lgkmcnt(2)
 v_mfma_f32_16x16x32_bf16 v[64:67], a[8:11], v[48:51], v[64:67]
 ds_read_b128 v[32:35], v6 offset:8192
 v_mfma_f32_16x16x32_bf16 v[72:75], a[80:83], v[48:51], v[72:75]
 ds_read_b128 v[36:39], v6 offset:10240
 v_mfma_f32_16x16x32_bf16 v[80:83], a[152:155], v[48:51], v[80:83]
 s_add_u32 m0, s49, 7936
 v_mfma_f32_16x16x32_bf16 v[88:91], a[224:227], v[48:51], v[88:91]
 buffer_load_dwordx4 v10, s[8:11], s46 offen offset:256  lds
 v_mfma_f32_16x16x32_bf16 v[68:71], a[8:11], v[52:55], v[68:71]
 s_add_u32 m0, s49, 11904
 v_mfma_f32_16x16x32_bf16 v[76:79], a[80:83], v[52:55], v[76:79]
 buffer_load_dwordx4 v10, s[8:11], s46 offen offset:384  lds
 v_mfma_f32_16x16x32_bf16 v[84:87], a[152:155], v[52:55], v[84:87]
 v_mfma_f32_16x16x32_bf16 v[92:95], a[224:227], v[52:55], v[92:95]
 s_waitcnt lgkmcnt(2)
 v_mfma_f32_16x16x32_bf16 v[64:67], a[12:15], v[56:59], v[64:67]
 ds_read_b128 v[40:43], v7 offset:8192
 v_mfma_f32_16x16x32_bf16 v[72:75], a[84:87], v[56:59], v[72:75]
 ds_read_b128 v[44:47], v7 offset:10240
 v_mfma_f32_16x16x32_bf16 v[80:83], a[156:159], v[56:59], v[80:83]
 s_add_u32 m0, s49, 15872
 v_mfma_f32_16x16x32_bf16 v[88:91], a[228:231], v[56:59], v[88:91]
 buffer_load_dwordx4 v10, s[8:11], s46 offen offset:512  lds
 v_mfma_f32_16x16x32_bf16 v[68:71], a[12:15], v[60:63], v[68:71]
 s_add_u32 m0, s49, 19840
 v_mfma_f32_16x16x32_bf16 v[76:79], a[84:87], v[60:63], v[76:79]
 buffer_load_dwordx4 v10, s[8:11], s46 offen offset:640  lds
 v_mfma_f32_16x16x32_bf16 v[84:87], a[156:159], v[60:63], v[84:87]
 s_add_u32 s60, s39, 1
 v_mfma_f32_16x16x32_bf16 v[92:95], a[228:231], v[60:63], v[92:95]
 s_waitcnt lgkmcnt(2)
 v_mfma_f32_16x16x32_bf16 v[64:67], a[16:19], v[32:35], v[64:67]
 ds_read_b128 v[48:51], v6 offset:12288
 v_mfma_f32_16x16x32_bf16 v[72:75], a[88:91], v[32:35], v[72:75]
 ds_read_b128 v[52:55], v6 offset:14336
 v_mfma_f32_16x16x32_bf16 v[80:83], a[160:163], v[32:35], v[80:83]
 s_add_u32 m0, s49, 23808
 v_mfma_f32_16x16x32_bf16 v[88:91], a[232:235], v[32:35], v[88:91]
 buffer_load_dwordx4 v10, s[8:11], s46 offen offset:768  lds
 v_mfma_f32_16x16x32_bf16 v[68:71], a[16:19], v[36:39], v[68:71]
 s_add_u32 m0, s49, 27776
 v_mfma_f32_16x16x32_bf16 v[76:79], a[88:91], v[36:39], v[76:79]
 buffer_load_dwordx4 v10, s[8:11], s46 offen offset:896  lds
 v_mfma_f32_16x16x32_bf16 v[84:87], a[160:163], v[36:39], v[84:87]
 v_mfma_f32_16x16x32_bf16 v[92:95], a[232:235], v[36:39], v[92:95]
 s_waitcnt lgkmcnt(2)
 v_mfma_f32_16x16x32_bf16 v[64:67], a[20:23], v[40:43], v[64:67]
 ds_read_b128 v[56:59], v7 offset:12288
 v_mfma_f32_16x16x32_bf16 v[72:75], a[92:95], v[40:43], v[72:75]
 ds_read_b128 v[60:63], v7 offset:14336
 v_mfma_f32_16x16x32_bf16 v[80:83], a[164:167], v[40:43], v[80:83]
 s_add_u32 m0, s49, 31744
 v_mfma_f32_16x16x32_bf16 v[88:91], a[236:239], v[40:43], v[88:91]
 buffer_load_dwordx4 v10, s[8:11], s46 offen offset:1024  lds
 v_mfma_f32_16x16x32_bf16 v[68:71], a[20:23], v[44:47], v[68:71]
 v_mfma_f32_16x16x32_bf16 v[76:79], a[92:95], v[44:47], v[76:79]
 v_mfma_f32_16x16x32_bf16 v[84:87], a[164:167], v[44:47], v[84:87]
 v_mfma_f32_16x16x32_bf16 v[92:95], a[236:239], v[44:47], v[92:95]
 s_waitcnt lgkmcnt(2)
 v_mfma_f32_16x16x32_bf16 v[64:67], a[24:27], v[48:51], v[64:67]
 ds_read_b128 v[32:35], v6 offset:16384
 v_mfma_f32_16x16x32_bf16 v[72:75], a[96:99], v[48:51], v[72:75]
 ds_read_b128 v[36:39], v6 offset:18432
 v_mfma_f32_16x16x32_bf16 v[80:83], a[168:171], v[48:51], v[80:83]
 s_waitcnt vmcnt(9)
 buffer_load_dword v17, v11, s[20:23], s56 offen sc1
 v_mfma_f32_16x16x32_bf16 v[88:91], a[240:243], v[48:51], v[88:91]
 s_barrier
 buffer_store_dword v14, v8, s[20:23], s59 offen sc1
 v_mfma_f32_16x16x32_bf16 v[68:71], a[24:27], v[52:55], v[68:71]
 buffer_load_dword v16, v15, s[20:23], s57 offen sc1
 v_mfma_f32_16x16x32_bf16 v[76:79], a[96:99], v[52:55], v[76:79]
 v_mfma_f32_16x16x32_bf16 v[84:87], a[168:171], v[52:55], v[84:87]
 s_lshl_b32 s56, s39, 18
 s_add_u32 s56, s56, s63
 v_mfma_f32_16x16x32_bf16 v[92:95], a[240:243], v[52:55], v[92:95]
 s_waitcnt lgkmcnt(2)
 v_mfma_f32_16x16x32_bf16 v[64:67], a[28:31], v[56:59], v[64:67]
 ds_read_b128 v[40:43], v7 offset:16384
 v_mfma_f32_16x16x32_bf16 v[72:75], a[100:103], v[56:59], v[72:75]
 ds_read_b128 v[44:47], v7 offset:18432
 v_mfma_f32_16x16x32_bf16 v[80:83], a[172:175], v[56:59], v[80:83]
 buffer_load_dwordx4 v[128:131], v1, s[20:23], s53 offen offset:0 sc1
 v_mfma_f32_16x16x32_bf16 v[88:91], a[244:247], v[56:59], v[88:91]
 v_mfma_f32_16x16x32_bf16 v[68:71], a[28:31], v[60:63], v[68:71]
 buffer_load_dwordx4 v[132:135], v1, s[20:23], s53 offen offset:1024 sc1
 v_mfma_f32_16x16x32_bf16 v[76:79], a[100:103], v[60:63], v[76:79]
 v_mfma_f32_16x16x32_bf16 v[84:87], a[172:175], v[60:63], v[84:87]
 v_mfma_f32_16x16x32_bf16 v[92:95], a[244:247], v[60:63], v[92:95]
 s_waitcnt lgkmcnt(2)
 v_mfma_f32_16x16x32_bf16 v[64:67], a[32:35], v[32:35], v[64:67]
 ds_read_b128 v[48:51], v6 offset:20480
 v_mfma_f32_16x16x32_bf16 v[72:75], a[104:107], v[32:35], v[72:75]
 ds_read_b128 v[52:55], v6 offset:22528
 v_mfma_f32_16x16x32_bf16 v[80:83], a[176:179], v[32:35], v[80:83]
 buffer_load_dwordx4 v[136:139], v1, s[20:23], s53 offen offset:2048 sc1
 v_mfma_f32_16x16x32_bf16 v[88:91], a[248:251], v[32:35], v[88:91]
 v_mfma_f32_16x16x32_bf16 v[68:71], a[32:35], v[36:39], v[68:71]
 buffer_load_dwordx4 v[140:143], v1, s[20:23], s53 offen offset:3072 sc1
 v_mfma_f32_16x16x32_bf16 v[76:79], a[104:107], v[36:39], v[76:79]
 v_mfma_f32_16x16x32_bf16 v[84:87], a[176:179], v[36:39], v[84:87]
 s_add_u32 s53, s53, 4096
 v_mfma_f32_16x16x32_bf16 v[92:95], a[248:251], v[36:39], v[92:95]
 s_waitcnt lgkmcnt(2)
 v_mfma_f32_16x16x32_bf16 v[64:67], a[36:39], v[40:43], v[64:67]
 ds_read_b128 v[56:59], v7 offset:20480
 v_mfma_f32_16x16x32_bf16 v[72:75], a[108:111], v[40:43], v[72:75]
 ds_read_b128 v[60:63], v7 offset:22528
 v_mfma_f32_16x16x32_bf16 v[80:83], a[180:183], v[40:43], v[80:83]
 buffer_load_dwordx4 v[144:147], v1, s[20:23], s53 offen offset:0 sc1
 v_mfma_f32_16x16x32_bf16 v[88:91], a[252:255], v[40:43], v[88:91]
 v_mfma_f32_16x16x32_bf16 v[68:71], a[36:39], v[44:47], v[68:71]
 buffer_load_dwordx4 v[148:151], v1, s[20:23], s53 offen offset:1024 sc1
 v_mfma_f32_16x16x32_bf16 v[76:79], a[108:111], v[44:47], v[76:79]
 v_mfma_f32_16x16x32_bf16 v[84:87], a[180:183], v[44:47], v[84:87]
 v_mfma_f32_16x16x32_bf16 v[92:95], a[252:255], v[44:47], v[92:95]
 s_waitcnt lgkmcnt(2)
 v_mfma_f32_16x16x32_bf16 v[64:67], a[40:43], v[48:51], v[64:67]
 ds_read_b128 v[32:35], v6 offset:24576
 v_mfma_f32_16x16x32_bf16 v[72:75], a[112:115], v[48:51], v[72:75]
 ds_read_b128 v[36:39], v6 offset:26624
 v_mfma_f32_16x16x32_bf16 v[80:83], a[184:187], v[48:51], v[80:83]
 buffer_load_dwordx4 v[152:155], v1, s[20:23], s53 offen offset:2048 sc1
 v_mfma_f32_16x16x32_bf16 v[88:91], v[224:227], v[48:51], v[88:91]
 v_mfma_f32_16x16x32_bf16 v[68:71], a[40:43], v[52:55], v[68:71]
 buffer_load_dwordx4 v[156:159], v1, s[20:23], s53 offen offset:3072 sc1
 v_mfma_f32_16x16x32_bf16 v[76:79], a[112:115], v[52:55], v[76:79]
 v_mfma_f32_16x16x32_bf16 v[84:87], a[184:187], v[52:55], v[84:87]
 s_add_u32 s53, s53, 4096
 v_mfma_f32_16x16x32_bf16 v[92:95], v[224:227], v[52:55], v[92:95]
 s_waitcnt lgkmcnt(2)
 v_mfma_f32_16x16x32_bf16 v[64:67], a[44:47], v[56:59], v[64:67]
 ds_read_b128 v[40:43], v7 offset:24576
 v_mfma_f32_16x16x32_bf16 v[72:75], a[116:119], v[56:59], v[72:75]
 ds_read_b128 v[44:47], v7 offset:26624
 v_mfma_f32_16x16x32_bf16 v[80:83], a[188:191], v[56:59], v[80:83]
 buffer_load_dwordx4 v[160:163], v1, s[20:23], s53 offen offset:0 sc1
 v_mfma_f32_16x16x32_bf16 v[88:91], v[228:231], v[56:59], v[88:91]
 v_mfma_f32_16x16x32_bf16 v[68:71], a[44:47], v[60:63], v[68:71]
 buffer_load_dwordx4 v[164:167], v1, s[20:23], s53 offen offset:1024 sc1
 v_mfma_f32_16x16x32_bf16 v[76:79], a[116:119], v[60:63], v[76:79]
 v_mfma_f32_16x16x32_bf16 v[84:87], a[188:191], v[60:63], v[84:87]
 v_mfma_f32_16x16x32_bf16 v[92:95], v[228:231], v[60:63], v[92:95]
 s_waitcnt lgkmcnt(2)
 v_mfma_f32_16x16x32_bf16 v[64:67], a[48:51], v[32:35], v[64:67]
 ds_read_b128 v[48:51], v6 offset:28672
 v_mfma_f32_16x16x32_bf16 v[72:75], a[120:123], v[32:35], v[72:75]
 ds_read_b128 v[52:55], v6 offset:30720
 v_mfma_f32_16x16x32_bf16 v[80:83], a[192:195], v[32:35], v[80:83]
 buffer_load_dwordx4 v[168:171], v1, s[20:23], s53 offen offset:2048 sc1
 v_mfma_f32_16x16x32_bf16 v[88:91], v[232:235], v[32:35], v[88:91]
 v_mfma_f32_16x16x32_bf16 v[68:71], a[48:51], v[36:39], v[68:71]
 buffer_load_dwordx4 v[172:175], v1, s[20:23], s53 offen offset:3072 sc1
 v_mfma_f32_16x16x32_bf16 v[76:79], a[120:123], v[36:39], v[76:79]
 v_mfma_f32_16x16x32_bf16 v[84:87], a[192:195], v[36:39], v[84:87]
 s_add_u32 s53, s53, 4096
 v_mfma_f32_16x16x32_bf16 v[92:95], v[232:235], v[36:39], v[92:95]
 s_waitcnt lgkmcnt(2)
 v_mfma_f32_16x16x32_bf16 v[64:67], a[52:55], v[40:43], v[64:67]
 ds_read_b128 v[56:59], v7 offset:28672
 v_mfma_f32_16x16x32_bf16 v[72:75], a[124:127], v[40:43], v[72:75]
 ds_read_b128 v[60:63], v7 offset:30720
 v_mfma_f32_16x16x32_bf16 v[80:83], a[196:199], v[40:43], v[80:83]
 s_add_u32 s43, s43, 36864
 s_cmp_eq_u32 s43, 147456
 buffer_load_dwordx4 v[176:179], v1, s[20:23], s53 offen offset:0 sc1
 v_mfma_f32_16x16x32_bf16 v[88:91], v[236:239], v[40:43], v[88:91]
 s_cselect_b32 s43, 0, s43
 s_add_u32 s44, s44, 36864
 v_mfma_f32_16x16x32_bf16 v[68:71], a[52:55], v[44:47], v[68:71]
 s_cmp_eq_u32 s44, 147456
 s_cselect_b32 s44, 0, s44
 buffer_load_dwordx4 v[180:183], v1, s[20:23], s53 offen offset:1024 sc1
 v_mfma_f32_16x16x32_bf16 v[76:79], a[124:127], v[44:47], v[76:79]
 v_mfma_f32_16x16x32_bf16 v[84:87], a[196:199], v[44:47], v[84:87]
 v_mfma_f32_16x16x32_bf16 v[92:95], v[236:239], v[44:47], v[92:95]
 s_waitcnt lgkmcnt(2)
 v_mfma_f32_16x16x32_bf16 v[64:67], a[56:59], v[48:51], v[64:67]
 ds_read_b128 v[32:35], v6 offset:32768
 v_mfma_f32_16x16x32_bf16 v[72:75], a[128:131], v[48:51], v[72:75]
 ds_read_b128 v[36:39], v6 offset:34816
 v_mfma_f32_16x16x32_bf16 v[80:83], a[200:203], v[48:51], v[80:83]
 v_add_u32 v6, s43, v4
 buffer_load_dwordx4 v[184:187], v1, s[20:23], s53 offen offset:2048 sc1
 v_mfma_f32_16x16x32_bf16 v[88:91], v[240:243], v[48:51], v[88:91]
 v_mfma_f32_16x16x32_bf16 v[68:71], a[56:59], v[52:55], v[68:71]
 buffer_load_dwordx4 v[188:191], v1, s[20:23], s53 offen offset:3072 sc1
 v_mfma_f32_16x16x32_bf16 v[76:79], a[128:131], v[52:55], v[76:79]
 v_mfma_f32_16x16x32_bf16 v[84:87], a[200:203], v[52:55], v[84:87]
 v_mfma_f32_16x16x32_bf16 v[92:95], v[240:243], v[52:55], v[92:95]
 s_waitcnt lgkmcnt(2)
 v_mfma_f32_16x16x32_bf16 v[64:67], a[60:63], v[56:59], v[64:67]
 ds_read_b128 v[40:43], v7 offset:32768
 v_mfma_f32_16x16x32_bf16 v[72:75], a[132:135], v[56:59], v[72:75]
 ds_read_b128 v[44:47], v7 offset:34816
 v_mfma_f32_16x16x32_bf16 v[80:83], a[204:207], v[56:59], v[80:83]
 v_add_u32 v7, s43, v5
 v_mfma_f32_16x16x32_bf16 v[88:91], v[244:247], v[56:59], v[88:91]
 v_mfma_f32_16x16x32_bf16 v[68:71], a[60:63], v[60:63], v[68:71]
 v_mfma_f32_16x16x32_bf16 v[76:79], a[132:135], v[60:63], v[76:79]
 v_mfma_f32_16x16x32_bf16 v[84:87], a[204:207], v[60:63], v[84:87]
 v_mfma_f32_16x16x32_bf16 v[92:95], v[244:247], v[60:63], v[92:95]
 s_waitcnt lgkmcnt(2)
 v_mfma_f32_16x16x32_bf16 v[64:67], a[64:67], v[32:35], v[64:67]
 s_waitcnt vmcnt(28)
 s_barrier
 ds_read_b128 v[48:51], v6 offset:0
 v_mfma_f32_16x16x32_bf16 v[72:75], a[136:139], v[32:35], v[72:75]
 ds_read_b128 v[52:55], v6 offset:2048
 v_mfma_f32_16x16x32_bf16 v[80:83], a[208:211], v[32:35], v[80:83]
 v_mfma_f32_16x16x32_bf16 v[88:91], v[248:251], v[32:35], v[88:91]
 s_waitcnt vmcnt(16)
 v_cmp_le_u32 vcc, s60, v16
 v_mfma_f32_16x16x32_bf16 v[68:71], a[64:67], v[36:39], v[68:71]
 v_mfma_f32_16x16x32_bf16 v[76:79], a[136:139], v[36:39], v[76:79]
 s_and_b32 s64, vcc_lo, 1
 s_cbranch_scc0 Lqsk_25
 buffer_load_dwordx4 v[192:195], v1, s[20:23], s55 offen offset:0 sc1
 buffer_load_dwordx4 v[196:199], v1, s[20:23], s55 offen offset:1024 sc1
 buffer_load_dwordx4 v[200:203], v1, s[20:23], s55 offen offset:2048 sc1
 buffer_load_dwordx4 v[204:207], v1, s[20:23], s55 offen offset:3072 sc1
Lqsk_25:
 v_mfma_f32_16x16x32_bf16 v[84:87], a[208:211], v[36:39], v[84:87]
 v_mfma_f32_16x16x32_bf16 v[92:95], v[248:251], v[36:39], v[92:95]
 s_waitcnt lgkmcnt(2)
 v_mfma_f32_16x16x32_bf16 v[64:67], a[68:71], v[40:43], v[64:67]
 ds_read_b128 v[56:59], v7 offset:0
 v_mfma_f32_16x16x32_bf16 v[72:75], a[140:143], v[40:43], v[72:75]
 ds_read_b128 v[60:63], v7 offset:2048
 v_mfma_f32_16x16x32_bf16 v[80:83], a[212:215], v[40:43], v[80:83]
 v_mfma_f32_16x16x32_bf16 v[88:91], v[252:255], v[40:43], v[88:91]
 s_mov_b32 s39, s40
 s_mov_b32 s40, s41
 v_mfma_f32_16x16x32_bf16 v[68:71], a[68:71], v[44:47], v[68:71]
 s_add_u32 s42, s42, 1
 v_mov_b32 v14, s42
 v_mfma_f32_16x16x32_bf16 v[76:79], a[140:143], v[44:47], v[76:79]
 v_mfma_f32_16x16x32_bf16 v[84:87], a[212:215], v[44:47], v[84:87]
 v_mfma_f32_16x16x32_bf16 v[92:95], v[252:255], v[44:47], v[92:95]
 s_waitcnt lgkmcnt(2)
 s_nop 7
 v_cvt_pk_bf16_f32 v16, v64, v65
 v_cvt_pk_bf16_f32 v17, v72, v73
 v_cvt_pk_bf16_f32 v18, v66, v67
 v_cvt_pk_bf16_f32 v19, v74, v75
 ds_write_b128 v2, v[16:19] offset:0
 v_cvt_pk_bf16_f32 v20, v68, v69
 v_cvt_pk_bf16_f32 v21, v76, v77
 v_cvt_pk_bf16_f32 v22, v70, v71
 v_cvt_pk_bf16_f32 v23, v78, v79
 ds_write_b128 v2, v[20:23] offset:1024
 v_cvt_pk_bf16_f32 v24, v80, v81
 v_cvt_pk_bf16_f32 v25, v88, v89
 v_cvt_pk_bf16_f32 v26, v82, v83
 v_cvt_pk_bf16_f32 v27, v90, v91
 ds_write_b128 v2, v[24:27] offset:8192
 v_cvt_pk_bf16_f32 v28, v84, v85
 v_cvt_pk_bf16_f32 v29, v92, v93
 v_cvt_pk_bf16_f32 v30, v86, v87
 v_cvt_pk_bf16_f32 v31, v94, v95
 ds_write_b128 v2, v[28:31] offset:9216
 v_mov_b64 v[120:121], 0
 v_mov_b64 v[122:123], 0
 s_waitcnt lgkmcnt(0)
 s_barrier
 ds_read_b128 v[96:99], v3 offset:0
 ds_read_b128 v[100:103], v3 offset:2048
 ds_read_b128 v[104:107], v3 offset:4096
 ds_read_b128 v[108:111], v3 offset:6144
 s_cmp_lg_u32 s64, 0
 s_cbranch_scc1 Lqpre_26
Lqs_27:
 buffer_load_dword v16, v15, s[20:23], s57 offen sc1
 s_waitcnt vmcnt(0)
 v_cmp_le_u32 vcc, s60, v16
 s_cbranch_vccnz Lqsk_28
 s_sleep 2
 s_sub_u32 s58, s58, 1
 s_cbranch_scc0 Lqs_27
 s_endpgm
Lqsk_28:
 buffer_load_dwordx4 v[192:195], v1, s[20:23], s55 offen offset:0 sc1
 buffer_load_dwordx4 v[196:199], v1, s[20:23], s55 offen offset:1024 sc1
 buffer_load_dwordx4 v[200:203], v1, s[20:23], s55 offen offset:2048 sc1
 buffer_load_dwordx4 v[204:207], v1, s[20:23], s55 offen offset:3072 sc1
Lqpre_26:
 s_waitcnt vmcnt(4) lgkmcnt(0)
 v_mfma_f32_16x16x32_bf16 v[112:115], v[128:131], v[96:99], v[208:211]
 v_mfma_f32_16x16x32_bf16 v[116:119], v[132:135], v[96:99], v[212:215]
 v_mfma_f32_16x16x32_bf16 v[112:115], v[136:139], v[100:103], v[112:115]
 v_mfma_f32_16x16x32_bf16 v[116:119], v[140:143], v[100:103], v[116:119]
 v_mfma_f32_16x16x32_bf16 v[112:115], v[144:147], v[104:107], v[112:115]
 v_mfma_f32_16x16x32_bf16 v[116:119], v[148:151], v[104:107], v[116:119]
 v_mfma_f32_16x16x32_bf16 v[112:115], v[152:155], v[108:111], v[112:115]
 v_mfma_f32_16x16x32_bf16 v[116:119], v[156:159], v[108:111], v[116:119]
 s_nop 7
 v_max3_f32 v24, v112, v113, v114
 v_max3_f32 v24, v24, v115, v116
 v_max3_f32 v24, v24, v117, v118
 v_max_f32 v24, v24, v119
 s_waitcnt vmcnt(2)
 v_mov_b64 v[16:17], v[192:193]
 v_mov_b64 v[18:19], v[196:197]
 s_nop 1
 v_smfmac_f32_16x16x64_bf16 v[120:123], v[16:19], v[96:103], v12
 s_waitcnt vmcnt(0)
 v_mov_b64 v[20:21], v[200:201]
 v_mov_b64 v[22:23], v[204:205]
 s_nop 1
 v_smfmac_f32_16x16x64_bf16 v[120:123], v[20:23], v[104:111], v12
 s_nop 7
 v_add_f32 v120, v120, v122
 v_add_f32 v121, v121, v123
 v_mul_f32 v120, s50, v120
 v_mul_f32 v121, s50, v121
 v_max3_f32 v24, v24, v120, v121
 v_mov_b32 v25, v24
 s_nop 1
 v_permlane16_swap_b32 v24, v25
 v_max_f32 v24, v24, v25
 v_mov_b32 v25, v24
 s_nop 1
 v_permlane32_swap_b32 v24, v25
 v_max_f32 v24, v24, v25
 v_sub_f32 v112, v112, v24
 v_sub_f32 v113, v113, v24
 v_sub_f32 v114, v114, v24
 v_sub_f32 v115, v115, v24
 v_sub_f32 v116, v116, v24
 v_sub_f32 v117, v117, v24
 v_sub_f32 v118, v118, v24
 v_sub_f32 v119, v119, v24
 v_sub_f32 v120, v120, v24
 v_sub_f32 v121, v121, v24
 v_exp_f32 v120, v120
 v_exp_f32 v121, v121
 v_exp_f32 v112, v112
 v_exp_f32 v113, v113
 v_exp_f32 v114, v114
 v_exp_f32 v115, v115
 v_exp_f32 v116, v116
 v_exp_f32 v117, v117
 v_exp_f32 v118, v118
 v_exp_f32 v119, v119
 v_cvt_pk_bf16_f32 v216, v120, v121
 v_cvt_pk_bf16_f32 v219, v120, v121
 v_cvt_pk_bf16_f32 v28, v112, v113
 v_cvt_pk_bf16_f32 v29, v116, v117
 v_cvt_pk_bf16_f32 v30, v114, v115
 v_cvt_pk_bf16_f32 v31, v118, v119
 v_mfma_f32_16x16x16_bf16 v[124:127], v[220:221], v[216:217], 0
 v_mfma_f32_16x16x16_bf16 v[64:67], v[194:195], v[216:217], 0
 v_mfma_f32_16x16x16_bf16 v[68:71], v[194:195], v[218:219], 0
 v_mfma_f32_16x16x16_bf16 v[72:75], v[198:199], v[216:217], 0
 v_mfma_f32_16x16x16_bf16 v[76:79], v[198:199], v[218:219], 0
 v_mfma_f32_16x16x16_bf16 v[80:83], v[202:203], v[216:217], 0
 v_mfma_f32_16x16x16_bf16 v[84:87], v[202:203], v[218:219], 0
 v_mfma_f32_16x16x16_bf16 v[88:91], v[206:207], v[216:217], 0
 v_mfma_f32_16x16x16_bf16 v[92:95], v[206:207], v[218:219], 0
 v_mfma_f32_16x16x32_bf16 v[124:127], v[220:223], v[28:31], v[124:127]
 v_mfma_f32_16x16x32_bf16 v[64:67], v[160:163], v[28:31], v[64:67]
 v_mfma_f32_16x16x32_bf16 v[68:71], v[164:167], v[28:31], v[68:71]
 v_mfma_f32_16x16x32_bf16 v[72:75], v[168:171], v[28:31], v[72:75]
 v_mfma_f32_16x16x32_bf16 v[76:79], v[172:175], v[28:31], v[76:79]
 v_mfma_f32_16x16x32_bf16 v[80:83], v[176:179], v[28:31], v[80:83]
 v_mfma_f32_16x16x32_bf16 v[84:87], v[180:183], v[28:31], v[84:87]
 v_mfma_f32_16x16x32_bf16 v[88:91], v[184:187], v[28:31], v[88:91]
 v_mfma_f32_16x16x32_bf16 v[92:95], v[188:191], v[28:31], v[92:95]
 v_rcp_f32 v124, v124
 s_add_u32 s45, s56, 4096
 v_mul_f32 v64, v64, v124
 v_mul_f32 v65, v65, v124
 v_mul_f32 v66, v66, v124
 v_mul_f32 v67, v67, v124
 v_mul_f32 v68, v68, v124
 v_mul_f32 v69, v69, v124
 v_mul_f32 v70, v70, v124
 v_mul_f32 v71, v71, v124
 v_cvt_pk_bf16_f32 v96, v64, v65
 v_cvt_pk_bf16_f32 v97, v68, v69
 v_cvt_pk_bf16_f32 v98, v66, v67
 v_cvt_pk_bf16_f32 v99, v70, v71
 buffer_store_dwordx4 v[96:99], v1, s[20:23], s56 offen offset:0 sc1
 v_mul_f32 v72, v72, v124
 v_mul_f32 v73, v73, v124
 v_mul_f32 v74, v74, v124
 v_mul_f32 v75, v75, v124
 v_mul_f32 v76, v76, v124
 v_mul_f32 v77, v77, v124
 v_mul_f32 v78, v78, v124
 v_mul_f32 v79, v79, v124
 v_cvt_pk_bf16_f32 v100, v72, v73
 v_cvt_pk_bf16_f32 v101, v76, v77
 v_cvt_pk_bf16_f32 v102, v74, v75
 v_cvt_pk_bf16_f32 v103, v78, v79
 buffer_store_dwordx4 v[100:103], v1, s[20:23], s56 offen offset:2048 sc1
 v_mul_f32 v80, v80, v124
 v_mul_f32 v81, v81, v124
 v_mul_f32 v82, v82, v124
 v_mul_f32 v83, v83, v124
 v_mul_f32 v84, v84, v124
 v_mul_f32 v85, v85, v124
 v_mul_f32 v86, v86, v124
 v_mul_f32 v87, v87, v124
 v_cvt_pk_bf16_f32 v104, v80, v81
 v_cvt_pk_bf16_f32 v105, v84, v85
 v_cvt_pk_bf16_f32 v106, v82, v83
 v_cvt_pk_bf16_f32 v107, v86, v87
 buffer_store_dwordx4 v[104:107], v1, s[20:23], s45 offen offset:0 sc1
 v_mul_f32 v88, v88, v124
 v_mul_f32 v89, v89, v124
 v_mul_f32 v90, v90, v124
 v_mul_f32 v91, v91, v124
 v_mul_f32 v92, v92, v124
 v_mul_f32 v93, v93, v124
 v_mul_f32 v94, v94, v124
 v_mul_f32 v95, v95, v124
 v_cvt_pk_bf16_f32 v108, v88, v89
 v_cvt_pk_bf16_f32 v109, v92, v93
 v_cvt_pk_bf16_f32 v110, v90, v91
 v_cvt_pk_bf16_f32 v111, v94, v95
 buffer_store_dwordx4 v[108:111], v1, s[20:23], s45 offen offset:2048 sc1
 v_mfma_f32_16x16x32_bf16 v[64:67], a[0:3], v[48:51], 0
 ds_read_b128 v[32:35], v6 offset:4096
 v_mfma_f32_16x16x32_bf16 v[72:75], a[72:75], v[48:51], 0
 ds_read_b128 v[36:39], v6 offset:6144
 v_mfma_f32_16x16x32_bf16 v[80:83], a[144:147], v[48:51], 0
 s_add_u32 s41, s40, 2
 v_mfma_f32_16x16x32_bf16 v[88:91], a[216:219], v[48:51], 0
 s_add_u32 s45, s42, 2
 s_mul_i32 s46, s41, 36864
 v_mfma_f32_16x16x32_bf16 v[68:71], a[0:3], v[52:55], 0
 s_cmp_lt_u32 s45, s36
 s_cselect_b32 s46, s46, 0
 v_mfma_f32_16x16x32_bf16 v[76:79], a[72:75], v[52:55], 0
 s_lshl_b32 s49, s4, 10
 s_add_u32 s49, s49, s44
 v_mfma_f32_16x16x32_bf16 v[84:87], a[144:147], v[52:55], 0
 s_lshl_b32 s53, s39, 19
 s_add_u32 s53, s53, s61
 v_mfma_f32_16x16x32_bf16 v[92:95], a[216:219], v[52:55], 0
 s_waitcnt lgkmcnt(2)
 v_mfma_f32_16x16x32_bf16 v[64:67], a[4:7], v[56:59], v[64:67]
 ds_read_b128 v[40:43], v7 offset:4096
 v_mfma_f32_16x16x32_bf16 v[72:75], a[76:79], v[56:59], v[72:75]
 ds_read_b128 v[44:47], v7 offset:6144
 v_mfma_f32_16x16x32_bf16 v[80:83], a[148:151], v[56:59], v[80:83]
 s_add_u32 m0, s49, 0
 v_mfma_f32_16x16x32_bf16 v[88:91], a[220:223], v[56:59], v[88:91]
 buffer_load_dwordx4 v10, s[8:11], s46 offen offset:0  lds
 v_mfma_f32_16x16x32_bf16 v[68:71], a[4:7], v[60:63], v[68:71]
 s_add_u32 m0, s49, 3968
 v_mfma_f32_16x16x32_bf16 v[76:79], a[76:79], v[60:63], v[76:79]
 buffer_load_dwordx4 v10, s[8:11], s46 offen offset:128  lds
 v_mfma_f32_16x16x32_bf16 v[84:87], a[148:151], v[60:63], v[84:87]
 s_lshl_b32 s55, s39, 17
 s_add_u32 s55, s55, s62
 v_mfma_f32_16x16x32_bf16 v[92:95], a[220:223], v[60:63], v[92:95]
 s_waitcnt lgkmcnt(2)
 v_mfma_f32_16x16x32_bf16 v[64:67], a[8:11], v[32:35], v[64:67]
 ds_read_b128 v[48:51], v6 offset:8192
 v_mfma_f32_16x16x32_bf16 v[72:75], a[80:83], v[32:35], v[72:75]
 ds_read_b128 v[52:55], v6 offset:10240
 v_mfma_f32_16x16x32_bf16 v[80:83], a[152:155], v[32:35], v[80:83]
 s_add_u32 m0, s49, 7936
 v_mfma_f32_16x16x32_bf16 v[88:91], a[224:227], v[32:35], v[88:91]
 buffer_load_dwordx4 v10, s[8:11], s46 offen offset:256  lds
 v_mfma_f32_16x16x32_bf16 v[68:71], a[8:11], v[36:39], v[68:71]
 s_add_u32 m0, s49, 11904
 v_mfma_f32_16x16x32_bf16 v[76:79], a[80:83], v[36:39], v[76:79]
 buffer_load_dwordx4 v10, s[8:11], s46 offen offset:384  lds
 v_mfma_f32_16x16x32_bf16 v[84:87], a[152:155], v[36:39], v[84:87]
 v_mfma_f32_16x16x32_bf16 v[92:95], a[224:227], v[36:39], v[92:95]
 s_waitcnt lgkmcnt(2)
 v_mfma_f32_16x16x32_bf16 v[64:67], a[12:15], v[40:43], v[64:67]
 ds_read_b128 v[56:59], v7 offset:8192
 v_mfma_f32_16x16x32_bf16 v[72:75], a[84:87], v[40:43], v[72:75]
 ds_read_b128 v[60:63], v7 offset:10240
 v_mfma_f32_16x16x32_bf16 v[80:83], a[156:159], v[40:43], v[80:83]
 s_add_u32 m0, s49, 15872
 v_mfma_f32_16x16x32_bf16 v[88:91], a[228:231], v[40:43], v[88:91]
 buffer_load_dwordx4 v10, s[8:11], s46 offen offset:512  lds
 v_mfma_f32_16x16x32_bf16 v[68:71], a[12:15], v[44:47], v[68:71]
 s_add_u32 m0, s49, 19840
 v_mfma_f32_16x16x32_bf16 v[76:79], a[84:87], v[44:47], v[76:79]
 buffer_load_dwordx4 v10, s[8:11], s46 offen offset:640  lds
 v_mfma_f32_16x16x32_bf16 v[84:87], a[156:159], v[44:47], v[84:87]
 s_add_u32 s60, s39, 1
 v_mfma_f32_16x16x32_bf16 v[92:95], a[228:231], v[44:47], v[92:95]
 s_waitcnt lgkmcnt(2)
 v_mfma_f32_16x16x32_bf16 v[64:67], a[16:19], v[48:51], v[64:67]
 ds_read_b128 v[32:35], v6 offset:12288
 v_mfma_f32_16x16x32_bf16 v[72:75], a[88:91], v[48:51], v[72:75]
 ds_read_b128 v[36:39], v6 offset:14336
 v_mfma_f32_16x16x32_bf16 v[80:83], a[160:163], v[48:51], v[80:83]
 s_add_u32 m0, s49, 23808
 v_mfma_f32_16x16x32_bf16 v[88:91], a[232:235], v[48:51], v[88:91]
 buffer_load_dwordx4 v10, s[8:11], s46 offen offset:768  lds
 v_mfma_f32_16x16x32_bf16 v[68:71], a[16:19], v[52:55], v[68:71]
 s_add_u32 m0, s49, 27776
 v_mfma_f32_16x16x32_bf16 v[76:79], a[88:91], v[52:55], v[76:79]
 buffer_load_dwordx4 v10, s[8:11], s46 offen offset:896  lds
 v_mfma_f32_16x16x32_bf16 v[84:87], a[160:163], v[52:55], v[84:87]
 v_mfma_f32_16x16x32_bf16 v[92:95], a[232:235], v[52:55], v[92:95]
 s_waitcnt lgkmcnt(2)
 v_mfma_f32_16x16x32_bf16 v[64:67], a[20:23], v[56:59], v[64:67]
 ds_read_b128 v[40:43], v7 offset:12288
 v_mfma_f32_16x16x32_bf16 v[72:75], a[92:95], v[56:59], v[72:75]
 ds_read_b128 v[44:47], v7 offset:14336
 v_mfma_f32_16x16x32_bf16 v[80:83], a[164:167], v[56:59], v[80:83]
 s_add_u32 m0, s49, 31744
 v_mfma_f32_16x16x32_bf16 v[88:91], a[236:239], v[56:59], v[88:91]
 buffer_load_dwordx4 v10, s[8:11], s46 offen offset:1024  lds
 v_mfma_f32_16x16x32_bf16 v[68:71], a[20:23], v[60:63], v[68:71]
 v_mfma_f32_16x16x32_bf16 v[76:79], a[92:95], v[60:63], v[76:79]
 v_mfma_f32_16x16x32_bf16 v[84:87], a[164:167], v[60:63], v[84:87]
 v_mfma_f32_16x16x32_bf16 v[92:95], a[236:239], v[60:63], v[92:95]
 s_waitcnt lgkmcnt(2)
 v_mfma_f32_16x16x32_bf16 v[64:67], a[24:27], v[32:35], v[64:67]
 ds_read_b128 v[48:51], v6 offset:16384
 v_mfma_f32_16x16x32_bf16 v[72:75], a[96:99], v[32:35], v[72:75]
 ds_read_b128 v[52:55], v6 offset:18432
 v_mfma_f32_16x16x32_bf16 v[80:83], a[168:171], v[32:35], v[80:83]
 s_waitcnt vmcnt(9)
 buffer_load_dword v17, v11, s[20:23], s56 offen sc1
 v_mfma_f32_16x16x32_bf16 v[88:91], a[240:243], v[32:35], v[88:91]
 s_barrier
 buffer_store_dword v14, v8, s[20:23], s59 offen sc1
 v_mfma_f32_16x16x32_bf16 v[68:71], a[24:27], v[36:39], v[68:71]
 buffer_load_dword v16, v15, s[20:23], s57 offen sc1
 v_mfma_f32_16x16x32_bf16 v[76:79], a[96:99], v[36:39], v[76:79]
 v_mfma_f32_16x16x32_bf16 v[84:87], a[168:171], v[36:39], v[84:87]
 s_lshl_b32 s56, s39, 18
 s_add_u32 s56, s56, s63
 v_mfma_f32_16x16x32_bf16 v[92:95], a[240:243], v[36:39], v[92:95]
 s_waitcnt lgkmcnt(2)
 v_mfma_f32_16x16x32_bf16 v[64:67], a[28:31], v[40:43], v[64:67]
 ds_read_b128 v[56:59], v7 offset:16384
 v_mfma_f32_16x16x32_bf16 v[72:75], a[100:103], v[40:43], v[72:75]
 ds_read_b128 v[60:63], v7 offset:18432
 v_mfma_f32_16x16x32_bf16 v[80:83], a[172:175], v[40:43], v[80:83]
 buffer_load_dwordx4 v[128:131], v1, s[20:23], s53 offen offset:0 sc1
 v_mfma_f32_16x16x32_bf16 v[88:91], a[244:247], v[40:43], v[88:91]
 v_mfma_f32_16x16x32_bf16 v[68:71], a[28:31], v[44:47], v[68:71]
 buffer_load_dwordx4 v[132:135], v1, s[20:23], s53 offen offset:1024 sc1
 v_mfma_f32_16x16x32_bf16 v[76:79], a[100:103], v[44:47], v[76:79]
 v_mfma_f32_16x16x32_bf16 v[84:87], a[172:175], v[44:47], v[84:87]
 v_mfma_f32_16x16x32_bf16 v[92:95], a[244:247], v[44:47], v[92:95]
 s_waitcnt lgkmcnt(2)
 v_mfma_f32_16x16x32_bf16 v[64:67], a[32:35], v[48:51], v[64:67]
 ds_read_b128 v[32:35], v6 offset:20480
 v_mfma_f32_16x16x32_bf16 v[72:75], a[104:107], v[48:51], v[72:75]
 ds_read_b128 v[36:39], v6 offset:22528
 v_mfma_f32_16x16x32_bf16 v[80:83], a[176:179], v[48:51], v[80:83]
 buffer_load_dwordx4 v[136:139], v1, s[20:23], s53 offen offset:2048 sc1
 v_mfma_f32_16x16x32_bf16 v[88:91], a[248:251], v[48:51], v[88:91]
 v_mfma_f32_16x16x32_bf16 v[68:71], a[32:35], v[52:55], v[68:71]
 buffer_load_dwordx4 v[140:143], v1, s[20:23], s53 offen offset:3072 sc1
 v_mfma_f32_16x16x32_bf16 v[76:79], a[104:107], v[52:55], v[76:79]
 v_mfma_f32_16x16x32_bf16 v[84:87], a[176:179], v[52:55], v[84:87]
 s_add_u32 s53, s53, 4096
 v_mfma_f32_16x16x32_bf16 v[92:95], a[248:251], v[52:55], v[92:95]
 s_waitcnt lgkmcnt(2)
 v_mfma_f32_16x16x32_bf16 v[64:67], a[36:39], v[56:59], v[64:67]
 ds_read_b128 v[40:43], v7 offset:20480
 v_mfma_f32_16x16x32_bf16 v[72:75], a[108:111], v[56:59], v[72:75]
 ds_read_b128 v[44:47], v7 offset:22528
 v_mfma_f32_16x16x32_bf16 v[80:83], a[180:183], v[56:59], v[80:83]
 buffer_load_dwordx4 v[144:147], v1, s[20:23], s53 offen offset:0 sc1
 v_mfma_f32_16x16x32_bf16 v[88:91], a[252:255], v[56:59], v[88:91]
 v_mfma_f32_16x16x32_bf16 v[68:71], a[36:39], v[60:63], v[68:71]
 buffer_load_dwordx4 v[148:151], v1, s[20:23], s53 offen offset:1024 sc1
 v_mfma_f32_16x16x32_bf16 v[76:79], a[108:111], v[60:63], v[76:79]
 v_mfma_f32_16x16x32_bf16 v[84:87], a[180:183], v[60:63], v[84:87]
 v_mfma_f32_16x16x32_bf16 v[92:95], a[252:255], v[60:63], v[92:95]
 s_waitcnt lgkmcnt(2)
 v_mfma_f32_16x16x32_bf16 v[64:67], a[40:43], v[32:35], v[64:67]
 ds_read_b128 v[48:51], v6 offset:24576
 v_mfma_f32_16x16x32_bf16 v[72:75], a[112:115], v[32:35], v[72:75]
 ds_read_b128 v[52:55], v6 offset:26624
 v_mfma_f32_16x16x32_bf16 v[80:83], a[184:187], v[32:35], v[80:83]
 buffer_load_dwordx4 v[152:155], v1, s[20:23], s53 offen offset:2048 sc1
 v_mfma_f32_16x16x32_bf16 v[88:91], v[224:227], v[32:35], v[88:91]
 v_mfma_f32_16x16x32_bf16 v[68:71], a[40:43], v[36:39], v[68:71]
 buffer_load_dwordx4 v[156:159], v1, s[20:23], s53 offen offset:3072 sc1
 v_mfma_f32_16x16x32_bf16 v[76:79], a[112:115], v[36:39], v[76:79]
 v_mfma_f32_16x16x32_bf16 v[84:87], a[184:187], v[36:39], v[84:87]
 s_add_u32 s53, s53, 4096
 v_mfma_f32_16x16x32_bf16 v[92:95], v[224:227], v[36:39], v[92:95]
 s_waitcnt lgkmcnt(2)
 v_mfma_f32_16x16x32_bf16 v[64:67], a[44:47], v[40:43], v[64:67]
 ds_read_b128 v[56:59], v7 offset:24576
 v_mfma_f32_16x16x32_bf16 v[72:75], a[116:119], v[40:43], v[72:75]
 ds_read_b128 v[60:63], v7 offset:26624
 v_mfma_f32_16x16x32_bf16 v[80:83], a[188:191], v[40:43], v[80:83]
 buffer_load_dwordx4 v[160:163], v1, s[20:23], s53 offen offset:0 sc1
 v_mfma_f32_16x16x32_bf16 v[88:91], v[228:231], v[40:43], v[88:91]
 v_mfma_f32_16x16x32_bf16 v[68:71], a[44:47], v[44:47], v[68:71]
 buffer_load_dwordx4 v[164:167], v1, s[20:23], s53 offen offset:1024 sc1
 v_mfma_f32_16x16x32_bf16 v[76:79], a[116:119], v[44:47], v[76:79]
 v_mfma_f32_16x16x32_bf16 v[84:87], a[188:191], v[44:47], v[84:87]
 v_mfma_f32_16x16x32_bf16 v[92:95], v[228:231], v[44:47], v[92:95]
 s_waitcnt lgkmcnt(2)
 v_mfma_f32_16x16x32_bf16 v[64:67], a[48:51], v[48:51], v[64:67]
 ds_read_b128 v[32:35], v6 offset:28672
 v_mfma_f32_16x16x32_bf16 v[72:75], a[120:123], v[48:51], v[72:75]
 ds_read_b128 v[36:39], v6 offset:30720
 v_mfma_f32_16x16x32_bf16 v[80:83], a[192:195], v[48:51], v[80:83]
 buffer_load_dwordx4 v[168:171], v1, s[20:23], s53 offen offset:2048 sc1
 v_mfma_f32_16x16x32_bf16 v[88:91], v[232:235], v[48:51], v[88:91]
 v_mfma_f32_16x16x32_bf16 v[68:71], a[48:51], v[52:55], v[68:71]
 buffer_load_dwordx4 v[172:175], v1, s[20:23], s53 offen offset:3072 sc1
 v_mfma_f32_16x16x32_bf16 v[76:79], a[120:123], v[52:55], v[76:79]
 v_mfma_f32_16x16x32_bf16 v[84:87], a[192:195], v[52:55], v[84:87]
 s_add_u32 s53, s53, 4096
 v_mfma_f32_16x16x32_bf16 v[92:95], v[232:235], v[52:55], v[92:95]
 s_waitcnt lgkmcnt(2)
 v_mfma_f32_16x16x32_bf16 v[64:67], a[52:55], v[56:59], v[64:67]
 ds_read_b128 v[40:43], v7 offset:28672
 v_mfma_f32_16x16x32_bf16 v[72:75], a[124:127], v[56:59], v[72:75]
 ds_read_b128 v[44:47], v7 offset:30720
 v_mfma_f32_16x16x32_bf16 v[80:83], a[196:199], v[56:59], v[80:83]
 s_add_u32 s43, s43, 36864
 s_cmp_eq_u32 s43, 147456
 buffer_load_dwordx4 v[176:179], v1, s[20:23], s53 offen offset:0 sc1
 v_mfma_f32_16x16x32_bf16 v[88:91], v[236:239], v[56:59], v[88:91]
 s_cselect_b32 s43, 0, s43
 s_add_u32 s44, s44, 36864
 v_mfma_f32_16x16x32_bf16 v[68:71], a[52:55], v[60:63], v[68:71]
 s_cmp_eq_u32 s44, 147456
 s_cselect_b32 s44, 0, s44
 buffer_load_dwordx4 v[180:183], v1, s[20:23], s53 offen offset:1024 sc1
 v_mfma_f32_16x16x32_bf16 v[76:79], a[124:127], v[60:63], v[76:79]
 v_mfma_f32_16x16x32_bf16 v[84:87], a[196:199], v[60:63], v[84:87]
 v_mfma_f32_16x16x32_bf16 v[92:95], v[236:239], v[60:63], v[92:95]
 s_waitcnt lgkmcnt(2)
 v_mfma_f32_16x16x32_bf16 v[64:67], a[56:59], v[32:35], v[64:67]
 ds_read_b128 v[48:51], v6 offset:32768
 v_mfma_f32_16x16x32_bf16 v[72:75], a[128:131], v[32:35], v[72:75]
 ds_read_b128 v[52:55], v6 offset:34816
 v_mfma_f32_16x16x32_bf16 v[80:83], a[200:203], v[32:35], v[80:83]
 v_add_u32 v6, s43, v4
 buffer_load_dwordx4 v[184:187], v1, s[20:23], s53 offen offset:2048 sc1
 v_mfma_f32_16x16x32_bf16 v[88:91], v[240:243], v[32:35], v[88:91]
 v_mfma_f32_16x16x32_bf16 v[68:71], a[56:59], v[36:39], v[68:71]
 buffer_load_dwordx4 v[188:191], v1, s[20:23], s53 offen offset:3072 sc1
 v_mfma_f32_16x16x32_bf16 v[76:79], a[128:131], v[36:39], v[76:79]
 v_mfma_f32_16x16x32_bf16 v[84:87], a[200:203], v[36:39], v[84:87]
 v_mfma_f32_16x16x32_bf16 v[92:95], v[240:243], v[36:39], v[92:95]
 s_waitcnt lgkmcnt(2)
 v_mfma_f32_16x16x32_bf16 v[64:67], a[60:63], v[40:43], v[64:67]
 ds_read_b128 v[56:59], v7 offset:32768
 v_mfma_f32_16x16x32_bf16 v[72:75], a[132:135], v[40:43], v[72:75]
 ds_read_b128 v[60:63], v7 offset:34816
 v_mfma_f32_16x16x32_bf16 v[80:83], a[204:207], v[40:43], v[80:83]
 v_add_u32 v7, s43, v5
 v_mfma_f32_16x16x32_bf16 v[88:91], v[244:247], v[40:43], v[88:91]
 v_mfma_f32_16x16x32_bf16 v[68:71], a[60:63], v[44:47], v[68:71]
 v_mfma_f32_16x16x32_bf16 v[76:79], a[132:135], v[44:47], v[76:79]
 v_mfma_f32_16x16x32_bf16 v[84:87], a[204:207], v[44:47], v[84:87]
 v_mfma_f32_16x16x32_bf16 v[92:95], v[244:247], v[44:47], v[92:95]
 s_waitcnt lgkmcnt(2)
 v_mfma_f32_16x16x32_bf16 v[64:67], a[64:67], v[48:51], v[64:67]
 s_waitcnt vmcnt(28)
 s_barrier
 ds_read_b128 v[32:35], v6 offset:0
 v_mfma_f32_16x16x32_bf16 v[72:75], a[136:139], v[48:51], v[72:75]
 ds_read_b128 v[36:39], v6 offset:2048
 v_mfma_f32_16x16x32_bf16 v[80:83], a[208:211], v[48:51], v[80:83]
 v_mfma_f32_16x16x32_bf16 v[88:91], v[248:251], v[48:51], v[88:91]
 s_waitcnt vmcnt(16)
 v_cmp_le_u32 vcc, s60, v16
 v_mfma_f32_16x16x32_bf16 v[68:71], a[64:67], v[52:55], v[68:71]
 v_mfma_f32_16x16x32_bf16 v[76:79], a[136:139], v[52:55], v[76:79]
 s_and_b32 s64, vcc_lo, 1
 s_cbranch_scc0 Lqsk_29
 buffer_load_dwordx4 v[192:195], v1, s[20:23], s55 offen offset:0 sc1
 buffer_load_dwordx4 v[196:199], v1, s[20:23], s55 offen offset:1024 sc1
 buffer_load_dwordx4 v[200:203], v1, s[20:23], s55 offen offset:2048 sc1
 buffer_load_dwordx4 v[204:207], v1, s[20:23], s55 offen offset:3072 sc1
Lqsk_29:
 v_mfma_f32_16x16x32_bf16 v[84:87], a[208:211], v[52:55], v[84:87]
 v_mfma_f32_16x16x32_bf16 v[92:95], v[248:251], v[52:55], v[92:95]
 s_waitcnt lgkmcnt(2)
 v_mfma_f32_16x16x32_bf16 v[64:67], a[68:71], v[56:59], v[64:67]
 ds_read_b128 v[40:43], v7 offset:0
 v_mfma_f32_16x16x32_bf16 v[72:75], a[140:143], v[56:59], v[72:75]
 ds_read_b128 v[44:47], v7 offset:2048
 v_mfma_f32_16x16x32_bf16 v[80:83], a[212:215], v[56:59], v[80:83]
 v_mfma_f32_16x16x32_bf16 v[88:91], v[252:255], v[56:59], v[88:91]
 s_mov_b32 s39, s40
 s_mov_b32 s40, s41
 v_mfma_f32_16x16x32_bf16 v[68:71], a[68:71], v[60:63], v[68:71]
 s_add_u32 s42, s42, 1
 v_mov_b32 v14, s42
 v_mfma_f32_16x16x32_bf16 v[76:79], a[140:143], v[60:63], v[76:79]
 v_mfma_f32_16x16x32_bf16 v[84:87], a[212:215], v[60:63], v[84:87]
 v_mfma_f32_16x16x32_bf16 v[92:95], v[252:255], v[60:63], v[92:95]
 s_waitcnt lgkmcnt(2)
 s_nop 7
 v_cvt_pk_bf16_f32 v16, v64, v65
 v_cvt_pk_bf16_f32 v17, v72, v73
 v_cvt_pk_bf16_f32 v18, v66, v67
 v_cvt_pk_bf16_f32 v19, v74, v75
 ds_write_b128 v2, v[16:19] offset:0
 v_cvt_pk_bf16_f32 v20, v68, v69
 v_cvt_pk_bf16_f32 v21, v76, v77
 v_cvt_pk_bf16_f32 v22, v70, v71
 v_cvt_pk_bf16_f32 v23, v78, v79
 ds_write_b128 v2, v[20:23] offset:1024
 v_cvt_pk_bf16_f32 v24, v80, v81
 v_cvt_pk_bf16_f32 v25, v88, v89
 v_cvt_pk_bf16_f32 v26, v82, v83
 v_cvt_pk_bf16_f32 v27, v90, v91
 ds_write_b128 v2, v[24:27] offset:8192
 v_cvt_pk_bf16_f32 v28, v84, v85
 v_cvt_pk_bf16_f32 v29, v92, v93
 v_cvt_pk_bf16_f32 v30, v86, v87
 v_cvt_pk_bf16_f32 v31, v94, v95
 ds_write_b128 v2, v[28:31] offset:9216
 v_mov_b64 v[120:121], 0
 v_mov_b64 v[122:123], 0
 s_waitcnt lgkmcnt(0)
 s_barrier
 ds_read_b128 v[96:99], v3 offset:0
 ds_read_b128 v[100:103], v3 offset:2048
 ds_read_b128 v[104:107], v3 offset:4096
 ds_read_b128 v[108:111], v3 offset:6144
 s_cmp_lg_u32 s64, 0
 s_cbranch_scc1 Lqpre_30
Lqs_31:
 buffer_load_dword v16, v15, s[20:23], s57 offen sc1
 s_waitcnt vmcnt(0)
 v_cmp_le_u32 vcc, s60, v16
 s_cbranch_vccnz Lqsk_32
 s_sleep 2
 s_sub_u32 s58, s58, 1
 s_cbranch_scc0 Lqs_31
 s_endpgm
Lqsk_32:
 buffer_load_dwordx4 v[192:195], v1, s[20:23], s55 offen offset:0 sc1
 buffer_load_dwordx4 v[196:199], v1, s[20:23], s55 offen offset:1024 sc1
 buffer_load_dwordx4 v[200:203], v1, s[20:23], s55 offen offset:2048 sc1
 buffer_load_dwordx4 v[204:207], v1, s[20:23], s55 offen offset:3072 sc1
Lqpre_30:
 s_waitcnt vmcnt(4) lgkmcnt(0)
 v_mfma_f32_16x16x32_bf16 v[112:115], v[128:131], v[96:99], v[208:211]
 v_mfma_f32_16x16x32_bf16 v[116:119], v[132:135], v[96:99], v[212:215]
 v_mfma_f32_16x16x32_bf16 v[112:115], v[136:139], v[100:103], v[112:115]
 v_mfma_f32_16x16x32_bf16 v[116:119], v[140:143], v[100:103], v[116:119]
 v_mfma_f32_16x16x32_bf16 v[112:115], v[144:147], v[104:107], v[112:115]
 v_mfma_f32_16x16x32_bf16 v[116:119], v[148:151], v[104:107], v[116:119]
 v_mfma_f32_16x16x32_bf16 v[112:115], v[152:155], v[108:111], v[112:115]
 v_mfma_f32_16x16x32_bf16 v[116:119], v[156:159], v[108:111], v[116:119]
 s_nop 7
 v_max3_f32 v24, v112, v113, v114
 v_max3_f32 v24, v24, v115, v116
 v_max3_f32 v24, v24, v117, v118
 v_max_f32 v24, v24, v119
 s_waitcnt vmcnt(2)
 v_mov_b64 v[16:17], v[192:193]
 v_mov_b64 v[18:19], v[196:197]
 s_nop 1
 v_smfmac_f32_16x16x64_bf16 v[120:123], v[16:19], v[96:103], v12
 s_waitcnt vmcnt(0)
 v_mov_b64 v[20:21], v[200:201]
 v_mov_b64 v[22:23], v[204:205]
 s_nop 1
 v_smfmac_f32_16x16x64_bf16 v[120:123], v[20:23], v[104:111], v12
 s_nop 7
 v_add_f32 v120, v120, v122
 v_add_f32 v121, v121, v123
 v_mul_f32 v120, s50, v120
 v_mul_f32 v121, s50, v121
 v_max3_f32 v24, v24, v120, v121
 v_mov_b32 v25, v24
 s_nop 1
 v_permlane16_swap_b32 v24, v25
 v_max_f32 v24, v24, v25
 v_mov_b32 v25, v24
 s_nop 1
 v_permlane32_swap_b32 v24, v25
 v_max_f32 v24, v24, v25
 v_sub_f32 v112, v112, v24
 v_sub_f32 v113, v113, v24
 v_sub_f32 v114, v114, v24
 v_sub_f32 v115, v115, v24
 v_sub_f32 v116, v116, v24
 v_sub_f32 v117, v117, v24
 v_sub_f32 v118, v118, v24
 v_sub_f32 v119, v119, v24
 v_sub_f32 v120, v120, v24
 v_sub_f32 v121, v121, v24
 v_exp_f32 v120, v120
 v_exp_f32 v121, v121
 v_exp_f32 v112, v112
 v_exp_f32 v113, v113
 v_exp_f32 v114, v114
 v_exp_f32 v115, v115
 v_exp_f32 v116, v116
 v_exp_f32 v117, v117
 v_exp_f32 v118, v118
 v_exp_f32 v119, v119
 v_cvt_pk_bf16_f32 v216, v120, v121
 v_cvt_pk_bf16_f32 v219, v120, v121
 v_cvt_pk_bf16_f32 v28, v112, v113
 v_cvt_pk_bf16_f32 v29, v116, v117
 v_cvt_pk_bf16_f32 v30, v114, v115
 v_cvt_pk_bf16_f32 v31, v118, v119
 v_mfma_f32_16x16x16_bf16 v[124:127], v[220:221], v[216:217], 0
 v_mfma_f32_16x16x16_bf16 v[64:67], v[194:195], v[216:217], 0
 v_mfma_f32_16x16x16_bf16 v[68:71], v[194:195], v[218:219], 0
 v_mfma_f32_16x16x16_bf16 v[72:75], v[198:199], v[216:217], 0
 v_mfma_f32_16x16x16_bf16 v[76:79], v[198:199], v[218:219], 0
 v_mfma_f32_16x16x16_bf16 v[80:83], v[202:203], v[216:217], 0
 v_mfma_f32_16x16x16_bf16 v[84:87], v[202:203], v[218:219], 0
 v_mfma_f32_16x16x16_bf16 v[88:91], v[206:207], v[216:217], 0
 v_mfma_f32_16x16x16_bf16 v[92:95], v[206:207], v[218:219], 0
 v_mfma_f32_16x16x32_bf16 v[124:127], v[220:223], v[28:31], v[124:127]
 v_mfma_f32_16x16x32_bf16 v[64:67], v[160:163], v[28:31], v[64:67]
 v_mfma_f32_16x16x32_bf16 v[68:71], v[164:167], v[28:31], v[68:71]
 v_mfma_f32_16x16x32_bf16 v[72:75], v[168:171], v[28:31], v[72:75]
 v_mfma_f32_16x16x32_bf16 v[76:79], v[172:175], v[28:31], v[76:79]
 v_mfma_f32_16x16x32_bf16 v[80:83], v[176:179], v[28:31], v[80:83]
 v_mfma_f32_16x16x32_bf16 v[84:87], v[180:183], v[28:31], v[84:87]
 v_mfma_f32_16x16x32_bf16 v[88:91], v[184:187], v[28:31], v[88:91]
 v_mfma_f32_16x16x32_bf16 v[92:95], v[188:191], v[28:31], v[92:95]
 v_rcp_f32 v124, v124
 s_add_u32 s45, s56, 4096
 v_mul_f32 v64, v64, v124
 v_mul_f32 v65, v65, v124
 v_mul_f32 v66, v66, v124
 v_mul_f32 v67, v67, v124
 v_mul_f32 v68, v68, v124
 v_mul_f32 v69, v69, v124
 v_mul_f32 v70, v70, v124
 v_mul_f32 v71, v71, v124
 v_cvt_pk_bf16_f32 v96, v64, v65
 v_cvt_pk_bf16_f32 v97, v68, v69
 v_cvt_pk_bf16_f32 v98, v66, v67
 v_cvt_pk_bf16_f32 v99, v70, v71
 buffer_store_dwordx4 v[96:99], v1, s[20:23], s56 offen offset:0 sc1
 v_mul_f32 v72, v72, v124
 v_mul_f32 v73, v73, v124
 v_mul_f32 v74, v74, v124
 v_mul_f32 v75, v75, v124
 v_mul_f32 v76, v76, v124
 v_mul_f32 v77, v77, v124
 v_mul_f32 v78, v78, v124
 v_mul_f32 v79, v79, v124
 v_cvt_pk_bf16_f32 v100, v72, v73
 v_cvt_pk_bf16_f32 v101, v76, v77
 v_cvt_pk_bf16_f32 v102, v74, v75
 v_cvt_pk_bf16_f32 v103, v78, v79
 buffer_store_dwordx4 v[100:103], v1, s[20:23], s56 offen offset:2048 sc1
 v_mul_f32 v80, v80, v124
 v_mul_f32 v81, v81, v124
 v_mul_f32 v82, v82, v124
 v_mul_f32 v83, v83, v124
 v_mul_f32 v84, v84, v124
 v_mul_f32 v85, v85, v124
 v_mul_f32 v86, v86, v124
 v_mul_f32 v87, v87, v124
 v_cvt_pk_bf16_f32 v104, v80, v81
 v_cvt_pk_bf16_f32 v105, v84, v85
 v_cvt_pk_bf16_f32 v106, v82, v83
 v_cvt_pk_bf16_f32 v107, v86, v87
 buffer_store_dwordx4 v[104:107], v1, s[20:23], s45 offen offset:0 sc1
 v_mul_f32 v88, v88, v124
 v_mul_f32 v89, v89, v124
 v_mul_f32 v90, v90, v124
 v_mul_f32 v91, v91, v124
 v_mul_f32 v92, v92, v124
 v_mul_f32 v93, v93, v124
 v_mul_f32 v94, v94, v124
 v_mul_f32 v95, v95, v124
 v_cvt_pk_bf16_f32 v108, v88, v89
 v_cvt_pk_bf16_f32 v109, v92, v93
 v_cvt_pk_bf16_f32 v110, v90, v91
 v_cvt_pk_bf16_f32 v111, v94, v95
 buffer_store_dwordx4 v[108:111], v1, s[20:23], s45 offen offset:2048 sc1
 s_cmp_lt_u32 s42, s36
 s_cbranch_scc1 Lqb_loop_24
 s_waitcnt vmcnt(0)
 buffer_load_dword v17, v11, s[20:23], s56 offen sc1
 s_barrier
 buffer_store_dword v14, v8, s[20:23], s59 offen sc1
 s_branch Lfin
Lob:
 s_load_dwordx2 s[8:9], s[0:1], 88
 s_mov_b32 s10, 0x480000
 s_mov_b32 s11, 0x20000
 s_sub_u32 s32, s6, 16
 s_mul_i32 s7, s3, 5
 s_add_u32 s7, s7, s6
 s_sub_u32 s7, s7, 25
 s_cmp_lt_u32 s6, 25
 s_cselect_b32 s32, s32, s7
 s_cselect_b32 s33, s3, 4
 s_cselect_b32 s34, 2, 1
 s_cselect_b32 s39, 6, 4
 s_cselect_b32 s35, 22, 20
 s_cselect_b32 s40, 0, 4
 s_mov_b32 s36, 0x7000000
 s_mov_b32 s37, 1152
 s_lshl_b32 s7, s4, 7
 s_add_u32 s38, s7, 0x3800
 s_mov_b32 s93, 1
 s_mov_b32 s92, 3
 s_mov_b32 s91, 9
 s_mov_b32 s90, 1
Los:
 s_load_dwordx2 s[24:25], s[0:1], 104
 s_mov_b32 s26, 0x480000
 s_mov_b32 s27, 0x20000
 s_waitcnt lgkmcnt(0)
 v_and_b32 v15, 63, v0
 v_lshlrev_b32 v1, 4, v15
 v_and_b32 v3, s92, v15
 v_lshlrev_b32 v3, 2, v3
 v_lshrrev_b32 v14, 4, v15
 v_min_u32 v14, 1, v14
 v_lshl_or_b32 v3, v14, 28, v3
 s_add_u32 s44, s32, s40
 s_and_b32 s44, s44, 7
 s_mov_b32 s50, 0x40000
 s_mul_i32 s49, s4, 40960
 v_add_u32 v5, s49, v1
 v_bfe_u32 v14, v15, 5, 1
 v_bfe_u32 v16, v15, 3, 1
 v_lshl_add_u32 v14, v14, 1, v16
 v_bfe_u32 v16, v15, 4, 1
 v_lshl_add_u32 v14, v16, 6, v14
 v_mul_u32_u24 v14, 1152, v14
 v_bfe_u32 v17, v15, 1, 2
 v_xor_b32 v17, v17, v16
 v_lshlrev_b32 v17, 5, v17
 v_and_b32 v16, 1, v15
 v_lshl_add_u32 v17, v16, 4, v17
 v_add_u32 v8, v14, v17
 v_xor_b32 v17, 64, v17
 v_add_u32 v9, v14, v17
 v_lshrrev_b32 v14, 4, v15
 v_bfe_u32 v16, v15, 2, 2
 v_lshl_add_u32 v14, v14, 3, v16
 v_lshlrev_b32 v14, 7, v14
 v_bfe_u32 v16, v15, 3, 2
 v_lshl_add_u32 v14, v16, 5, v14
 v_and_b32 v16, 3, v15
 v_lshl_add_u32 v14, v16, 3, v14
 v_xor_b32 v16, 0, v14
 v_add_u32 v10, s49, v16
 v_xor_b32 v16, 32, v14
 v_add_u32 v11, s49, v16
 v_xor_b32 v16, 64, v14
 v_add_u32 v12, s49, v16
 v_xor_b32 v16, 96, v14
 v_add_u32 v13, s49, v16
 s_lshl_b32 s47, s32, 7
 s_add_u32 s46, s44, 0
 s_and_b32 s46, s46, 7
 s_lshl_b32 s45, s4, 3
 s_add_u32 s46, s46, s45
 s_mul_i32 s46, s46, 147456
 s_add_u32 s46, s46, s47
 s_add_u32 m0, s49, 8192
 s_add_u32 s45, s46, 0
 buffer_load_dwordx4 v8, s[8:11], s45 offen  lds
 s_add_u32 m0, s49, 9216
 s_add_u32 s45, s46, 4608
 buffer_load_dwordx4 v9, s[8:11], s45 offen  lds
 s_add_u32 m0, s49, 10240
 s_add_u32 s45, s46, 9216
 buffer_load_dwordx4 v8, s[8:11], s45 offen  lds
 s_add_u32 m0, s49, 11264
 s_add_u32 s45, s46, 13824
 buffer_load_dwordx4 v9, s[8:11], s45 offen  lds
 s_add_u32 m0, s49, 12288
 s_add_u32 s45, s46, 18432
 buffer_load_dwordx4 v8, s[8:11], s45 offen  lds
 s_add_u32 m0, s49, 13312
 s_add_u32 s45, s46, 23040
 buffer_load_dwordx4 v9, s[8:11], s45 offen  lds
 s_add_u32 m0, s49, 14336
 s_add_u32 s45, s46, 27648
 buffer_load_dwordx4 v8, s[8:11], s45 offen  lds
 s_add_u32 m0, s49, 15360
 s_add_u32 s45, s46, 32256
 buffer_load_dwordx4 v9, s[8:11], s45 offen  lds
 s_add_u32 m0, s49, 16384
 s_add_u32 s45, s46, 36864
 buffer_load_dwordx4 v8, s[8:11], s45 offen  lds
 s_add_u32 m0, s49, 17408
 s_add_u32 s45, s46, 41472
 buffer_load_dwordx4 v9, s[8:11], s45 offen  lds
 s_add_u32 m0, s49, 18432
 s_add_u32 s45, s46, 46080
 buffer_load_dwordx4 v8, s[8:11], s45 offen  lds
 s_add_u32 m0, s49, 19456
 s_add_u32 s45, s46, 50688
 buffer_load_dwordx4 v9, s[8:11], s45 offen  lds
 s_add_u32 m0, s49, 20480
 s_add_u32 s45, s46, 55296
 buffer_load_dwordx4 v8, s[8:11], s45 offen  lds
 s_add_u32 m0, s49, 21504
 s_add_u32 s45, s46, 59904
 buffer_load_dwordx4 v9, s[8:11], s45 offen  lds
 s_add_u32 m0, s49, 22528
 s_add_u32 s45, s46, 64512
 buffer_load_dwordx4 v8, s[8:11], s45 offen  lds
 s_add_u32 m0, s49, 23552
 s_add_u32 s45, s46, 69120
 buffer_load_dwordx4 v9, s[8:11], s45 offen  lds
 s_add_u32 s46, s44, 1
 s_and_b32 s46, s46, 7
 s_lshl_b32 s45, s4, 3
 s_add_u32 s46, s46, s45
 s_mul_i32 s46, s46, 147456
 s_add_u32 s46, s46, s47
 s_add_u32 m0, s49, 24576
 s_add_u32 s45, s46, 0
 buffer_load_dwordx4 v8, s[8:11], s45 offen  lds
 s_add_u32 m0, s49, 25600
 s_add_u32 s45, s46, 4608
 buffer_load_dwordx4 v9, s[8:11], s45 offen  lds
 s_add_u32 m0, s49, 26624
 s_add_u32 s45, s46, 9216
 buffer_load_dwordx4 v8, s[8:11], s45 offen  lds
 s_add_u32 m0, s49, 27648
 s_add_u32 s45, s46, 13824
 buffer_load_dwordx4 v9, s[8:11], s45 offen  lds
 s_add_u32 m0, s49, 28672
 s_add_u32 s45, s46, 18432
 buffer_load_dwordx4 v8, s[8:11], s45 offen  lds
 s_add_u32 m0, s49, 29696
 s_add_u32 s45, s46, 23040
 buffer_load_dwordx4 v9, s[8:11], s45 offen  lds
 s_add_u32 m0, s49, 30720
 s_add_u32 s45, s46, 27648
 buffer_load_dwordx4 v8, s[8:11], s45 offen  lds
 s_add_u32 m0, s49, 31744
 s_add_u32 s45, s46, 32256
 buffer_load_dwordx4 v9, s[8:11], s45 offen  lds
 s_waitcnt vmcnt(20) lgkmcnt(0)
 s_add_u32 m0, s49, 32768
 s_add_u32 s45, s46, 36864
 buffer_load_dwordx4 v8, s[8:11], s45 offen  lds
 s_add_u32 m0, s49, 33792
 s_add_u32 s45, s46, 41472
 buffer_load_dwordx4 v9, s[8:11], s45 offen  lds
 s_add_u32 m0, s49, 34816
 s_add_u32 s45, s46, 46080
 buffer_load_dwordx4 v8, s[8:11], s45 offen  lds
 s_add_u32 m0, s49, 35840
 s_add_u32 s45, s46, 50688
 buffer_load_dwordx4 v9, s[8:11], s45 offen  lds
 ds_read_b64_tr_b16 a[0:1], v10 offset:8192
 ds_read_b64_tr_b16 a[2:3], v10 offset:8704
 ds_read_b64_tr_b16 a[4:5], v11 offset:8192
 ds_read_b64_tr_b16 a[6:7], v11 offset:8704
 ds_read_b64_tr_b16 a[8:9], v12 offset:8192
 ds_read_b64_tr_b16 a[10:11], v12 offset:8704
 ds_read_b64_tr_b16 v[16:17], v13 offset:8192
 ds_read_b64_tr_b16 v[18:19], v13 offset:8704
 s_waitcnt vmcnt(20) lgkmcnt(0)
 s_add_u32 m0, s49, 36864
 s_add_u32 s45, s46, 55296
 buffer_load_dwordx4 v8, s[8:11], s45 offen  lds
 s_add_u32 m0, s49, 37888
 s_add_u32 s45, s46, 59904
 buffer_load_dwordx4 v9, s[8:11], s45 offen  lds
 s_add_u32 m0, s49, 38912
 s_add_u32 s45, s46, 64512
 buffer_load_dwordx4 v8, s[8:11], s45 offen  lds
 s_add_u32 m0, s49, 39936
 s_add_u32 s45, s46, 69120
 buffer_load_dwordx4 v9, s[8:11], s45 offen  lds
 ds_write_b128 v5, v[16:19] offset:0
 ds_read_b64_tr_b16 a[12:13], v10 offset:12288
 ds_read_b64_tr_b16 a[14:15], v10 offset:12800
 ds_read_b64_tr_b16 a[16:17], v11 offset:12288
 ds_read_b64_tr_b16 a[18:19], v11 offset:12800
 ds_read_b64_tr_b16 a[20:21], v12 offset:12288
 ds_read_b64_tr_b16 a[22:23], v12 offset:12800
 ds_read_b64_tr_b16 v[20:21], v13 offset:12288
 ds_read_b64_tr_b16 v[22:23], v13 offset:12800
 s_waitcnt vmcnt(20) lgkmcnt(0)
 s_add_u32 s46, s44, 2
 s_and_b32 s46, s46, 7
 s_lshl_b32 s45, s4, 3
 s_add_u32 s46, s46, s45
 s_mul_i32 s46, s46, 147456
 s_add_u32 s46, s46, s47
 s_add_u32 m0, s49, 8192
 s_add_u32 s45, s46, 0
 buffer_load_dwordx4 v8, s[8:11], s45 offen  lds
 s_add_u32 m0, s49, 9216
 s_add_u32 s45, s46, 4608
 buffer_load_dwordx4 v9, s[8:11], s45 offen  lds
 s_add_u32 m0, s49, 10240
 s_add_u32 s45, s46, 9216
 buffer_load_dwordx4 v8, s[8:11], s45 offen  lds
 s_add_u32 m0, s49, 11264
 s_add_u32 s45, s46, 13824
 buffer_load_dwordx4 v9, s[8:11], s45 offen  lds
 ds_write_b128 v5, v[20:23] offset:1024
 ds_read_b64_tr_b16 a[24:25], v10 offset:16384
 ds_read_b64_tr_b16 a[26:27], v10 offset:16896
 ds_read_b64_tr_b16 a[28:29], v11 offset:16384
 ds_read_b64_tr_b16 a[30:31], v11 offset:16896
 ds_read_b64_tr_b16 a[32:33], v12 offset:16384
 ds_read_b64_tr_b16 a[34:35], v12 offset:16896
 ds_read_b64_tr_b16 v[16:17], v13 offset:16384
 ds_read_b64_tr_b16 v[18:19], v13 offset:16896
 s_waitcnt vmcnt(20) lgkmcnt(0)
 s_add_u32 m0, s49, 12288
 s_add_u32 s45, s46, 18432
 buffer_load_dwordx4 v8, s[8:11], s45 offen  lds
 s_add_u32 m0, s49, 13312
 s_add_u32 s45, s46, 23040
 buffer_load_dwordx4 v9, s[8:11], s45 offen  lds
 s_add_u32 m0, s49, 14336
 s_add_u32 s45, s46, 27648
 buffer_load_dwordx4 v8, s[8:11], s45 offen  lds
 s_add_u32 m0, s49, 15360
 s_add_u32 s45, s46, 32256
 buffer_load_dwordx4 v9, s[8:11], s45 offen  lds
 ds_write_b128 v5, v[16:19] offset:2048
 ds_read_b64_tr_b16 a[36:37], v10 offset:20480
 ds_read_b64_tr_b16 a[38:39], v10 offset:20992
 ds_read_b64_tr_b16 a[40:41], v11 offset:20480
 ds_read_b64_tr_b16 a[42:43], v11 offset:20992
 ds_read_b64_tr_b16 a[44:45], v12 offset:20480
 ds_read_b64_tr_b16 a[46:47], v12 offset:20992
 ds_read_b64_tr_b16 v[20:21], v13 offset:20480
 ds_read_b64_tr_b16 v[22:23], v13 offset:20992
 s_waitcnt vmcnt(20) lgkmcnt(0)
 s_add_u32 m0, s49, 16384
 s_add_u32 s45, s46, 36864
 buffer_load_dwordx4 v8, s[8:11], s45 offen  lds
 s_add_u32 m0, s49, 17408
 s_add_u32 s45, s46, 41472
 buffer_load_dwordx4 v9, s[8:11], s45 offen  lds
 s_add_u32 m0, s49, 18432
 s_add_u32 s45, s46, 46080
 buffer_load_dwordx4 v8, s[8:11], s45 offen  lds
 s_add_u32 m0, s49, 19456
 s_add_u32 s45, s46, 50688
 buffer_load_dwordx4 v9, s[8:11], s45 offen  lds
 ds_write_b128 v5, v[20:23] offset:3072
 ds_read_b64_tr_b16 a[48:49], v10 offset:24576
 ds_read_b64_tr_b16 a[50:51], v10 offset:25088
 ds_read_b64_tr_b16 a[52:53], v11 offset:24576
 ds_read_b64_tr_b16 a[54:55], v11 offset:25088
 ds_read_b64_tr_b16 a[56:57], v12 offset:24576
 ds_read_b64_tr_b16 a[58:59], v12 offset:25088
 ds_read_b64_tr_b16 v[16:17], v13 offset:24576
 ds_read_b64_tr_b16 v[18:19], v13 offset:25088
 s_waitcnt vmcnt(20) lgkmcnt(0)
 s_add_u32 m0, s49, 20480
 s_add_u32 s45, s46, 55296
 buffer_load_dwordx4 v8, s[8:11], s45 offen  lds
 s_add_u32 m0, s49, 21504
 s_add_u32 s45, s46, 59904
 buffer_load_dwordx4 v9, s[8:11], s45 offen  lds
 s_add_u32 m0, s49, 22528
 s_add_u32 s45, s46, 64512
 buffer_load_dwordx4 v8, s[8:11], s45 offen  lds
 s_add_u32 m0, s49, 23552
 s_add_u32 s45, s46, 69120
 buffer_load_dwordx4 v9, s[8:11], s45 offen  lds
 ds_write_b128 v5, v[16:19] offset:4096
 ds_read_b64_tr_b16 a[60:61], v10 offset:28672
 ds_read_b64_tr_b16 a[62:63], v10 offset:29184
 ds_read_b64_tr_b16 a[64:65], v11 offset:28672
 ds_read_b64_tr_b16 a[66:67], v11 offset:29184
 ds_read_b64_tr_b16 a[68:69], v12 offset:28672
 ds_read_b64_tr_b16 a[70:71], v12 offset:29184
 ds_read_b64_tr_b16 v[20:21], v13 offset:28672
 ds_read_b64_tr_b16 v[22:23], v13 offset:29184
 s_waitcnt vmcnt(20) lgkmcnt(0)
 s_add_u32 s46, s44, 3
 s_and_b32 s46, s46, 7
 s_lshl_b32 s45, s4, 3
 s_add_u32 s46, s46, s45
 s_mul_i32 s46, s46, 147456
 s_add_u32 s46, s46, s47
 s_add_u32 m0, s49, 24576
 s_add_u32 s45, s46, 0
 buffer_load_dwordx4 v8, s[8:11], s45 offen  lds
 s_add_u32 m0, s49, 25600
 s_add_u32 s45, s46, 4608
 buffer_load_dwordx4 v9, s[8:11], s45 offen  lds
 s_add_u32 m0, s49, 26624
 s_add_u32 s45, s46, 9216
 buffer_load_dwordx4 v8, s[8:11], s45 offen  lds
 s_add_u32 m0, s49, 27648
 s_add_u32 s45, s46, 13824
 buffer_load_dwordx4 v9, s[8:11], s45 offen  lds
 ds_write_b128 v5, v[20:23] offset:5120
 ds_read_b64_tr_b16 a[72:73], v10 offset:32768
 ds_read_b64_tr_b16 a[74:75], v10 offset:33280
 ds_read_b64_tr_b16 a[76:77], v11 offset:32768
 ds_read_b64_tr_b16 a[78:79], v11 offset:33280
 ds_read_b64_tr_b16 a[80:81], v12 offset:32768
 ds_read_b64_tr_b16 a[82:83], v12 offset:33280
 ds_read_b64_tr_b16 v[16:17], v13 offset:32768
 ds_read_b64_tr_b16 v[18:19], v13 offset:33280
 s_waitcnt vmcnt(20) lgkmcnt(0)
 s_add_u32 m0, s49, 28672
 s_add_u32 s45, s46, 18432
 buffer_load_dwordx4 v8, s[8:11], s45 offen  lds
 s_add_u32 m0, s49, 29696
 s_add_u32 s45, s46, 23040
 buffer_load_dwordx4 v9, s[8:11], s45 offen  lds
 s_add_u32 m0, s49, 30720
 s_add_u32 s45, s46, 27648
 buffer_load_dwordx4 v8, s[8:11], s45 offen  lds
 s_add_u32 m0, s49, 31744
 s_add_u32 s45, s46, 32256
 buffer_load_dwordx4 v9, s[8:11], s45 offen  lds
 ds_write_b128 v5, v[16:19] offset:6144
 ds_read_b64_tr_b16 a[84:85], v10 offset:36864
 ds_read_b64_tr_b16 a[86:87], v10 offset:37376
 ds_read_b64_tr_b16 a[88:89], v11 offset:36864
 ds_read_b64_tr_b16 a[90:91], v11 offset:37376
 ds_read_b64_tr_b16 a[92:93], v12 offset:36864
 ds_read_b64_tr_b16 a[94:95], v12 offset:37376
 ds_read_b64_tr_b16 v[20:21], v13 offset:36864
 ds_read_b64_tr_b16 v[22:23], v13 offset:37376
 s_waitcnt vmcnt(20) lgkmcnt(0)
 s_add_u32 m0, s49, 32768
 s_add_u32 s45, s46, 36864
 buffer_load_dwordx4 v8, s[8:11], s45 offen  lds
 s_add_u32 m0, s49, 33792
 s_add_u32 s45, s46, 41472
 buffer_load_dwordx4 v9, s[8:11], s45 offen  lds
 s_add_u32 m0, s49, 34816
 s_add_u32 s45, s46, 46080
 buffer_load_dwordx4 v8, s[8:11], s45 offen  lds
 s_add_u32 m0, s49, 35840
 s_add_u32 s45, s46, 50688
 buffer_load_dwordx4 v9, s[8:11], s45 offen  lds
 ds_write_b128 v5, v[20:23] offset:7168
 ds_read_b64_tr_b16 a[96:97], v10 offset:8192
 ds_read_b64_tr_b16 a[98:99], v10 offset:8704
 ds_read_b64_tr_b16 a[100:101], v11 offset:8192
 ds_read_b64_tr_b16 a[102:103], v11 offset:8704
 ds_read_b64_tr_b16 a[104:105], v12 offset:8192
 ds_read_b64_tr_b16 a[106:107], v12 offset:8704
 ds_read_b64_tr_b16 v[32:33], v13 offset:8192
 ds_read_b64_tr_b16 v[34:35], v13 offset:8704
 s_waitcnt vmcnt(20) lgkmcnt(0)
 s_add_u32 m0, s49, 36864
 s_add_u32 s45, s46, 55296
 buffer_load_dwordx4 v8, s[8:11], s45 offen  lds
 s_add_u32 m0, s49, 37888
 s_add_u32 s45, s46, 59904
 buffer_load_dwordx4 v9, s[8:11], s45 offen  lds
 s_add_u32 m0, s49, 38912
 s_add_u32 s45, s46, 64512
 buffer_load_dwordx4 v8, s[8:11], s45 offen  lds
 s_add_u32 m0, s49, 39936
 s_add_u32 s45, s46, 69120
 buffer_load_dwordx4 v9, s[8:11], s45 offen  lds
 ds_read_b64_tr_b16 a[108:109], v10 offset:12288
 ds_read_b64_tr_b16 a[110:111], v10 offset:12800
 ds_read_b64_tr_b16 a[112:113], v11 offset:12288
 ds_read_b64_tr_b16 a[114:115], v11 offset:12800
 ds_read_b64_tr_b16 a[116:117], v12 offset:12288
 ds_read_b64_tr_b16 a[118:119], v12 offset:12800
 ds_read_b64_tr_b16 v[36:37], v13 offset:12288
 ds_read_b64_tr_b16 v[38:39], v13 offset:12800
 s_waitcnt vmcnt(20) lgkmcnt(0)
 s_add_u32 s46, s44, 4
 s_and_b32 s46, s46, 7
 s_lshl_b32 s45, s4, 3
 s_add_u32 s46, s46, s45
 s_mul_i32 s46, s46, 147456
 s_add_u32 s46, s46, s47
 s_add_u32 m0, s49, 8192
 s_add_u32 s45, s46, 0
 buffer_load_dwordx4 v8, s[8:11], s45 offen  lds
 s_add_u32 m0, s49, 9216
 s_add_u32 s45, s46, 4608
 buffer_load_dwordx4 v9, s[8:11], s45 offen  lds
 s_add_u32 m0, s49, 10240
 s_add_u32 s45, s46, 9216
 buffer_load_dwordx4 v8, s[8:11], s45 offen  lds
 s_add_u32 m0, s49, 11264
 s_add_u32 s45, s46, 13824
 buffer_load_dwordx4 v9, s[8:11], s45 offen  lds
 ds_read_b64_tr_b16 a[120:121], v10 offset:16384
 ds_read_b64_tr_b16 a[122:123], v10 offset:16896
 ds_read_b64_tr_b16 a[124:125], v11 offset:16384
 ds_read_b64_tr_b16 a[126:127], v11 offset:16896
 ds_read_b64_tr_b16 a[128:129], v12 offset:16384
 ds_read_b64_tr_b16 a[130:131], v12 offset:16896
 ds_read_b64_tr_b16 v[40:41], v13 offset:16384
 ds_read_b64_tr_b16 v[42:43], v13 offset:16896
 s_waitcnt vmcnt(20) lgkmcnt(0)
 s_add_u32 m0, s49, 12288
 s_add_u32 s45, s46, 18432
 buffer_load_dwordx4 v8, s[8:11], s45 offen  lds
 s_add_u32 m0, s49, 13312
 s_add_u32 s45, s46, 23040
 buffer_load_dwordx4 v9, s[8:11], s45 offen  lds
 s_add_u32 m0, s49, 14336
 s_add_u32 s45, s46, 27648
 buffer_load_dwordx4 v8, s[8:11], s45 offen  lds
 s_add_u32 m0, s49, 15360
 s_add_u32 s45, s46, 32256
 buffer_load_dwordx4 v9, s[8:11], s45 offen  lds
 ds_read_b64_tr_b16 a[132:133], v10 offset:20480
 ds_read_b64_tr_b16 a[134:135], v10 offset:20992
 ds_read_b64_tr_b16 a[136:137], v11 offset:20480
 ds_read_b64_tr_b16 a[138:139], v11 offset:20992
 ds_read_b64_tr_b16 a[140:141], v12 offset:20480
 ds_read_b64_tr_b16 a[142:143], v12 offset:20992
 ds_read_b64_tr_b16 v[44:45], v13 offset:20480
 ds_read_b64_tr_b16 v[46:47], v13 offset:20992
 s_waitcnt vmcnt(20) lgkmcnt(0)
 s_add_u32 m0, s49, 16384
 s_add_u32 s45, s46, 36864
 buffer_load_dwordx4 v8, s[8:11], s45 offen  lds
 s_add_u32 m0, s49, 17408
 s_add_u32 s45, s46, 41472
 buffer_load_dwordx4 v9, s[8:11], s45 offen  lds
 s_add_u32 m0, s49, 18432
 s_add_u32 s45, s46, 46080
 buffer_load_dwordx4 v8, s[8:11], s45 offen  lds
 s_add_u32 m0, s49, 19456
 s_add_u32 s45, s46, 50688
 buffer_load_dwordx4 v9, s[8:11], s45 offen  lds
 ds_read_b64_tr_b16 a[144:145], v10 offset:24576
 ds_read_b64_tr_b16 a[146:147], v10 offset:25088
 ds_read_b64_tr_b16 a[148:149], v11 offset:24576
 ds_read_b64_tr_b16 a[150:151], v11 offset:25088
 ds_read_b64_tr_b16 a[152:153], v12 offset:24576
 ds_read_b64_tr_b16 a[154:155], v12 offset:25088
 ds_read_b64_tr_b16 v[48:49], v13 offset:24576
 ds_read_b64_tr_b16 v[50:51], v13 offset:25088
 s_waitcnt vmcnt(20) lgkmcnt(0)
 s_add_u32 m0, s49, 20480
 s_add_u32 s45, s46, 55296
 buffer_load_dwordx4 v8, s[8:11], s45 offen  lds
 s_add_u32 m0, s49, 21504
 s_add_u32 s45, s46, 59904
 buffer_load_dwordx4 v9, s[8:11], s45 offen  lds
 s_add_u32 m0, s49, 22528
 s_add_u32 s45, s46, 64512
 buffer_load_dwordx4 v8, s[8:11], s45 offen  lds
 s_add_u32 m0, s49, 23552
 s_add_u32 s45, s46, 69120
 buffer_load_dwordx4 v9, s[8:11], s45 offen  lds
 ds_read_b64_tr_b16 a[156:157], v10 offset:28672
 ds_read_b64_tr_b16 a[158:159], v10 offset:29184
 ds_read_b64_tr_b16 a[160:161], v11 offset:28672
 ds_read_b64_tr_b16 a[162:163], v11 offset:29184
 ds_read_b64_tr_b16 a[164:165], v12 offset:28672
 ds_read_b64_tr_b16 a[166:167], v12 offset:29184
 ds_read_b64_tr_b16 v[52:53], v13 offset:28672
 ds_read_b64_tr_b16 v[54:55], v13 offset:29184
 s_waitcnt vmcnt(20) lgkmcnt(0)
 s_add_u32 s46, s44, 5
 s_and_b32 s46, s46, 7
 s_lshl_b32 s45, s4, 3
 s_add_u32 s46, s46, s45
 s_mul_i32 s46, s46, 147456
 s_add_u32 s46, s46, s47
 s_add_u32 m0, s49, 24576
 s_add_u32 s45, s46, 0
 buffer_load_dwordx4 v8, s[8:11], s45 offen  lds
 s_add_u32 m0, s49, 25600
 s_add_u32 s45, s46, 4608
 buffer_load_dwordx4 v9, s[8:11], s45 offen  lds
 s_add_u32 m0, s49, 26624
 s_add_u32 s45, s46, 9216
 buffer_load_dwordx4 v8, s[8:11], s45 offen  lds
 s_add_u32 m0, s49, 27648
 s_add_u32 s45, s46, 13824
 buffer_load_dwordx4 v9, s[8:11], s45 offen  lds
 ds_read_b64_tr_b16 a[168:169], v10 offset:32768
 ds_read_b64_tr_b16 a[170:171], v10 offset:33280
 ds_read_b64_tr_b16 a[172:173], v11 offset:32768
 ds_read_b64_tr_b16 a[174:175], v11 offset:33280
 ds_read_b64_tr_b16 a[176:177], v12 offset:32768
 ds_read_b64_tr_b16 a[178:179], v12 offset:33280
 ds_read_b64_tr_b16 v[56:57], v13 offset:32768
 ds_read_b64_tr_b16 v[58:59], v13 offset:33280
 s_waitcnt vmcnt(20) lgkmcnt(0)
 s_add_u32 m0, s49, 28672
 s_add_u32 s45, s46, 18432
 buffer_load_dwordx4 v8, s[8:11], s45 offen  lds
 s_add_u32 m0, s49, 29696
 s_add_u32 s45, s46, 23040
 buffer_load_dwordx4 v9, s[8:11], s45 offen  lds
 s_add_u32 m0, s49, 30720
 s_add_u32 s45, s46, 27648
 buffer_load_dwordx4 v8, s[8:11], s45 offen  lds
 s_add_u32 m0, s49, 31744
 s_add_u32 s45, s46, 32256
 buffer_load_dwordx4 v9, s[8:11], s45 offen  lds
 ds_read_b64_tr_b16 a[180:181], v10 offset:36864
 ds_read_b64_tr_b16 a[182:183], v10 offset:37376
 ds_read_b64_tr_b16 a[184:185], v11 offset:36864
 ds_read_b64_tr_b16 a[186:187], v11 offset:37376
 ds_read_b64_tr_b16 a[188:189], v12 offset:36864
 ds_read_b64_tr_b16 a[190:191], v12 offset:37376
 ds_read_b64_tr_b16 v[60:61], v13 offset:36864
 ds_read_b64_tr_b16 v[62:63], v13 offset:37376
 s_waitcnt vmcnt(20) lgkmcnt(0)
 s_add_u32 m0, s49, 32768
 s_add_u32 s45, s46, 36864
 buffer_load_dwordx4 v8, s[8:11], s45 offen  lds
 s_add_u32 m0, s49, 33792
 s_add_u32 s45, s46, 41472
 buffer_load_dwordx4 v9, s[8:11], s45 offen  lds
 s_add_u32 m0, s49, 34816
 s_add_u32 s45, s46, 46080
 buffer_load_dwordx4 v8, s[8:11], s45 offen  lds
 s_add_u32 m0, s49, 35840
 s_add_u32 s45, s46, 50688
 buffer_load_dwordx4 v9, s[8:11], s45 offen  lds
 ds_read_b64_tr_b16 a[192:193], v10 offset:8192
 ds_read_b64_tr_b16 a[194:195], v10 offset:8704
 ds_read_b64_tr_b16 a[196:197], v11 offset:8192
 ds_read_b64_tr_b16 a[198:199], v11 offset:8704
 ds_read_b64_tr_b16 a[200:201], v12 offset:8192
 ds_read_b64_tr_b16 a[202:203], v12 offset:8704
 ds_read_b64_tr_b16 v[64:65], v13 offset:8192
 ds_read_b64_tr_b16 v[66:67], v13 offset:8704
 s_waitcnt vmcnt(20) lgkmcnt(0)
 s_add_u32 m0, s49, 36864
 s_add_u32 s45, s46, 55296
 buffer_load_dwordx4 v8, s[8:11], s45 offen  lds
 s_add_u32 m0, s49, 37888
 s_add_u32 s45, s46, 59904
 buffer_load_dwordx4 v9, s[8:11], s45 offen  lds
 s_add_u32 m0, s49, 38912
 s_add_u32 s45, s46, 64512
 buffer_load_dwordx4 v8, s[8:11], s45 offen  lds
 s_add_u32 m0, s49, 39936
 s_add_u32 s45, s46, 69120
 buffer_load_dwordx4 v9, s[8:11], s45 offen  lds
 ds_read_b64_tr_b16 a[204:205], v10 offset:12288
 ds_read_b64_tr_b16 a[206:207], v10 offset:12800
 ds_read_b64_tr_b16 a[208:209], v11 offset:12288
 ds_read_b64_tr_b16 a[210:211], v11 offset:12800
 ds_read_b64_tr_b16 a[212:213], v12 offset:12288
 ds_read_b64_tr_b16 a[214:215], v12 offset:12800
 ds_read_b64_tr_b16 v[68:69], v13 offset:12288
 ds_read_b64_tr_b16 v[70:71], v13 offset:12800
 s_waitcnt vmcnt(20) lgkmcnt(0)
 s_add_u32 s46, s44, 6
 s_and_b32 s46, s46, 7
 s_lshl_b32 s45, s4, 3
 s_add_u32 s46, s46, s45
 s_mul_i32 s46, s46, 147456
 s_add_u32 s46, s46, s47
 s_add_u32 m0, s49, 8192
 s_add_u32 s45, s46, 0
 buffer_load_dwordx4 v8, s[8:11], s45 offen  lds
 s_add_u32 m0, s49, 9216
 s_add_u32 s45, s46, 4608
 buffer_load_dwordx4 v9, s[8:11], s45 offen  lds
 s_add_u32 m0, s49, 10240
 s_add_u32 s45, s46, 9216
 buffer_load_dwordx4 v8, s[8:11], s45 offen  lds
 s_add_u32 m0, s49, 11264
 s_add_u32 s45, s46, 13824
 buffer_load_dwordx4 v9, s[8:11], s45 offen  lds
 ds_read_b64_tr_b16 a[216:217], v10 offset:16384
 ds_read_b64_tr_b16 a[218:219], v10 offset:16896
 ds_read_b64_tr_b16 a[220:221], v11 offset:16384
 ds_read_b64_tr_b16 a[222:223], v11 offset:16896
 ds_read_b64_tr_b16 a[224:225], v12 offset:16384
 ds_read_b64_tr_b16 a[226:227], v12 offset:16896
 ds_read_b64_tr_b16 v[72:73], v13 offset:16384
 ds_read_b64_tr_b16 v[74:75], v13 offset:16896
 s_waitcnt vmcnt(20) lgkmcnt(0)
 s_add_u32 m0, s49, 12288
 s_add_u32 s45, s46, 18432
 buffer_load_dwordx4 v8, s[8:11], s45 offen  lds
 s_add_u32 m0, s49, 13312
 s_add_u32 s45, s46, 23040
 buffer_load_dwordx4 v9, s[8:11], s45 offen  lds
 s_add_u32 m0, s49, 14336
 s_add_u32 s45, s46, 27648
 buffer_load_dwordx4 v8, s[8:11], s45 offen  lds
 s_add_u32 m0, s49, 15360
 s_add_u32 s45, s46, 32256
 buffer_load_dwordx4 v9, s[8:11], s45 offen  lds
 ds_read_b64_tr_b16 a[228:229], v10 offset:20480
 ds_read_b64_tr_b16 a[230:231], v10 offset:20992
 ds_read_b64_tr_b16 a[232:233], v11 offset:20480
 ds_read_b64_tr_b16 a[234:235], v11 offset:20992
 ds_read_b64_tr_b16 a[236:237], v12 offset:20480
 ds_read_b64_tr_b16 a[238:239], v12 offset:20992
 ds_read_b64_tr_b16 v[76:77], v13 offset:20480
 ds_read_b64_tr_b16 v[78:79], v13 offset:20992
 s_waitcnt vmcnt(20) lgkmcnt(0)
 s_add_u32 m0, s49, 16384
 s_add_u32 s45, s46, 36864
 buffer_load_dwordx4 v8, s[8:11], s45 offen  lds
 s_add_u32 m0, s49, 17408
 s_add_u32 s45, s46, 41472
 buffer_load_dwordx4 v9, s[8:11], s45 offen  lds
 s_add_u32 m0, s49, 18432
 s_add_u32 s45, s46, 46080
 buffer_load_dwordx4 v8, s[8:11], s45 offen  lds
 s_add_u32 m0, s49, 19456
 s_add_u32 s45, s46, 50688
 buffer_load_dwordx4 v9, s[8:11], s45 offen  lds
 ds_read_b64_tr_b16 a[240:241], v10 offset:24576
 ds_read_b64_tr_b16 a[242:243], v10 offset:25088
 ds_read_b64_tr_b16 a[244:245], v11 offset:24576
 ds_read_b64_tr_b16 a[246:247], v11 offset:25088
 ds_read_b64_tr_b16 a[248:249], v12 offset:24576
 ds_read_b64_tr_b16 a[250:251], v12 offset:25088
 ds_read_b64_tr_b16 v[80:81], v13 offset:24576
 ds_read_b64_tr_b16 v[82:83], v13 offset:25088
 s_waitcnt vmcnt(20) lgkmcnt(0)
 s_add_u32 m0, s49, 20480
 s_add_u32 s45, s46, 55296
 buffer_load_dwordx4 v8, s[8:11], s45 offen  lds
 s_add_u32 m0, s49, 21504
 s_add_u32 s45, s46, 59904
 buffer_load_dwordx4 v9, s[8:11], s45 offen  lds
 s_add_u32 m0, s49, 22528
 s_add_u32 s45, s46, 64512
 buffer_load_dwordx4 v8, s[8:11], s45 offen  lds
 s_add_u32 m0, s49, 23552
 s_add_u32 s45, s46, 69120
 buffer_load_dwordx4 v9, s[8:11], s45 offen  lds
 ds_read_b64_tr_b16 a[252:253], v10 offset:28672
 ds_read_b64_tr_b16 a[254:255], v10 offset:29184
 ds_read_b64_tr_b16 v[128:129], v11 offset:28672
 ds_read_b64_tr_b16 v[130:131], v11 offset:29184
 ds_read_b64_tr_b16 v[132:133], v12 offset:28672
 ds_read_b64_tr_b16 v[134:135], v12 offset:29184
 ds_read_b64_tr_b16 v[84:85], v13 offset:28672
 ds_read_b64_tr_b16 v[86:87], v13 offset:29184
 s_waitcnt vmcnt(20) lgkmcnt(0)
 s_add_u32 s46, s44, 7
 s_and_b32 s46, s46, 7
 s_lshl_b32 s45, s4, 3
 s_add_u32 s46, s46, s45
 s_mul_i32 s46, s46, 147456
 s_add_u32 s46, s46, s47
 s_add_u32 m0, s49, 24576
 s_add_u32 s45, s46, 0
 buffer_load_dwordx4 v8, s[8:11], s45 offen  lds
 s_add_u32 m0, s49, 25600
 s_add_u32 s45, s46, 4608
 buffer_load_dwordx4 v9, s[8:11], s45 offen  lds
 s_add_u32 m0, s49, 26624
 s_add_u32 s45, s46, 9216
 buffer_load_dwordx4 v8, s[8:11], s45 offen  lds
 s_add_u32 m0, s49, 27648
 s_add_u32 s45, s46, 13824
 buffer_load_dwordx4 v9, s[8:11], s45 offen  lds
 ds_read_b64_tr_b16 v[136:137], v10 offset:32768
 ds_read_b64_tr_b16 v[138:139], v10 offset:33280
 ds_read_b64_tr_b16 v[140:141], v11 offset:32768
 ds_read_b64_tr_b16 v[142:143], v11 offset:33280
 ds_read_b64_tr_b16 v[144:145], v12 offset:32768
 ds_read_b64_tr_b16 v[146:147], v12 offset:33280
 ds_read_b64_tr_b16 v[88:89], v13 offset:32768
 ds_read_b64_tr_b16 v[90:91], v13 offset:33280
 s_waitcnt vmcnt(20) lgkmcnt(0)
 s_add_u32 m0, s49, 28672
 s_add_u32 s45, s46, 18432
 buffer_load_dwordx4 v8, s[8:11], s45 offen  lds
 s_add_u32 m0, s49, 29696
 s_add_u32 s45, s46, 23040
 buffer_load_dwordx4 v9, s[8:11], s45 offen  lds
 s_add_u32 m0, s49, 30720
 s_add_u32 s45, s46, 27648
 buffer_load_dwordx4 v8, s[8:11], s45 offen  lds
 s_add_u32 m0, s49, 31744
 s_add_u32 s45, s46, 32256
 buffer_load_dwordx4 v9, s[8:11], s45 offen  lds
 ds_read_b64_tr_b16 v[148:149], v10 offset:36864
 ds_read_b64_tr_b16 v[150:151], v10 offset:37376
 ds_read_b64_tr_b16 v[152:153], v11 offset:36864
 ds_read_b64_tr_b16 v[154:155], v11 offset:37376
 ds_read_b64_tr_b16 v[156:157], v12 offset:36864
 ds_read_b64_tr_b16 v[158:159], v12 offset:37376
 ds_read_b64_tr_b16 v[92:93], v13 offset:36864
 ds_read_b64_tr_b16 v[94:95], v13 offset:37376
 s_waitcnt vmcnt(20) lgkmcnt(0)
 s_add_u32 m0, s49, 32768
 s_add_u32 s45, s46, 36864
 buffer_load_dwordx4 v8, s[8:11], s45 offen  lds
 s_add_u32 m0, s49, 33792
 s_add_u32 s45, s46, 41472
 buffer_load_dwordx4 v9, s[8:11], s45 offen  lds
 s_add_u32 m0, s49, 34816
 s_add_u32 s45, s46, 46080
 buffer_load_dwordx4 v8, s[8:11], s45 offen  lds
 s_add_u32 m0, s49, 35840
 s_add_u32 s45, s46, 50688
 buffer_load_dwordx4 v9, s[8:11], s45 offen  lds
 ds_read_b64_tr_b16 v[160:161], v10 offset:8192
 ds_read_b64_tr_b16 v[162:163], v10 offset:8704
 ds_read_b64_tr_b16 v[164:165], v11 offset:8192
 ds_read_b64_tr_b16 v[166:167], v11 offset:8704
 ds_read_b64_tr_b16 v[168:169], v12 offset:8192
 ds_read_b64_tr_b16 v[170:171], v12 offset:8704
 ds_read_b64_tr_b16 v[96:97], v13 offset:8192
 ds_read_b64_tr_b16 v[98:99], v13 offset:8704
 s_waitcnt vmcnt(20) lgkmcnt(0)
 s_add_u32 m0, s49, 36864
 s_add_u32 s45, s46, 55296
 buffer_load_dwordx4 v8, s[8:11], s45 offen  lds
 s_add_u32 m0, s49, 37888
 s_add_u32 s45, s46, 59904
 buffer_load_dwordx4 v9, s[8:11], s45 offen  lds
 s_add_u32 m0, s49, 38912
 s_add_u32 s45, s46, 64512
 buffer_load_dwordx4 v8, s[8:11], s45 offen  lds
 s_add_u32 m0, s49, 39936
 s_add_u32 s45, s46, 69120
 buffer_load_dwordx4 v9, s[8:11], s45 offen  lds
 ds_read_b64_tr_b16 v[172:173], v10 offset:12288
 ds_read_b64_tr_b16 v[174:175], v10 offset:12800
 ds_read_b64_tr_b16 v[176:177], v11 offset:12288
 ds_read_b64_tr_b16 v[178:179], v11 offset:12800
 ds_read_b64_tr_b16 v[180:181], v12 offset:12288
 ds_read_b64_tr_b16 v[182:183], v12 offset:12800
 ds_read_b64_tr_b16 v[100:101], v13 offset:12288
 ds_read_b64_tr_b16 v[102:103], v13 offset:12800
 s_waitcnt vmcnt(20) lgkmcnt(0)
 ds_read_b64_tr_b16 v[184:185], v10 offset:16384
 ds_read_b64_tr_b16 v[186:187], v10 offset:16896
 ds_read_b64_tr_b16 v[188:189], v11 offset:16384
 ds_read_b64_tr_b16 v[190:191], v11 offset:16896
 ds_read_b64_tr_b16 v[192:193], v12 offset:16384
 ds_read_b64_tr_b16 v[194:195], v12 offset:16896
 ds_read_b64_tr_b16 v[104:105], v13 offset:16384
 ds_read_b64_tr_b16 v[106:107], v13 offset:16896
 s_waitcnt vmcnt(16) lgkmcnt(0)
 ds_read_b64_tr_b16 v[196:197], v10 offset:20480
 ds_read_b64_tr_b16 v[198:199], v10 offset:20992
 ds_read_b64_tr_b16 v[200:201], v11 offset:20480
 ds_read_b64_tr_b16 v[202:203], v11 offset:20992
 ds_read_b64_tr_b16 v[204:205], v12 offset:20480
 ds_read_b64_tr_b16 v[206:207], v12 offset:20992
 ds_read_b64_tr_b16 v[108:109], v13 offset:20480
 ds_read_b64_tr_b16 v[110:111], v13 offset:20992
 s_waitcnt vmcnt(12) lgkmcnt(0)
 ds_read_b64_tr_b16 v[208:209], v10 offset:24576
 ds_read_b64_tr_b16 v[210:211], v10 offset:25088
 ds_read_b64_tr_b16 v[212:213], v11 offset:24576
 ds_read_b64_tr_b16 v[214:215], v11 offset:25088
 ds_read_b64_tr_b16 v[216:217], v12 offset:24576
 ds_read_b64_tr_b16 v[218:219], v12 offset:25088
 ds_read_b64_tr_b16 v[112:113], v13 offset:24576
 ds_read_b64_tr_b16 v[114:115], v13 offset:25088
 s_waitcnt vmcnt(8) lgkmcnt(0)
 ds_read_b64_tr_b16 v[220:221], v10 offset:28672
 ds_read_b64_tr_b16 v[222:223], v10 offset:29184
 ds_read_b64_tr_b16 v[224:225], v11 offset:28672
 ds_read_b64_tr_b16 v[226:227], v11 offset:29184
 ds_read_b64_tr_b16 v[228:229], v12 offset:28672
 ds_read_b64_tr_b16 v[230:231], v12 offset:29184
 ds_read_b64_tr_b16 v[116:117], v13 offset:28672
 ds_read_b64_tr_b16 v[118:119], v13 offset:29184
 s_waitcnt vmcnt(4) lgkmcnt(0)
 ds_read_b64_tr_b16 v[232:233], v10 offset:32768
 ds_read_b64_tr_b16 v[234:235], v10 offset:33280
 ds_read_b64_tr_b16 v[236:237], v11 offset:32768
 ds_read_b64_tr_b16 v[238:239], v11 offset:33280
 ds_read_b64_tr_b16 v[240:241], v12 offset:32768
 ds_read_b64_tr_b16 v[242:243], v12 offset:33280
 ds_read_b64_tr_b16 v[120:121], v13 offset:32768
 ds_read_b64_tr_b16 v[122:123], v13 offset:33280
 s_waitcnt vmcnt(0) lgkmcnt(0)
 ds_read_b64_tr_b16 v[244:245], v10 offset:36864
 ds_read_b64_tr_b16 v[246:247], v10 offset:37376
 ds_read_b64_tr_b16 v[248:249], v11 offset:36864
 ds_read_b64_tr_b16 v[250:251], v11 offset:37376
 ds_read_b64_tr_b16 v[252:253], v12 offset:36864
 ds_read_b64_tr_b16 v[254:255], v12 offset:37376
 ds_read_b64_tr_b16 v[124:125], v13 offset:36864
 ds_read_b64_tr_b16 v[126:127], v13 offset:37376
 s_waitcnt lgkmcnt(0)
 ds_write_b128 v5, v[32:35] offset:8192
 ds_write_b128 v5, v[36:39] offset:9216
 ds_write_b128 v5, v[40:43] offset:10240
 ds_write_b128 v5, v[44:47] offset:11264
 ds_write_b128 v5, v[48:51] offset:12288
 ds_write_b128 v5, v[52:55] offset:13312
 ds_write_b128 v5, v[56:59] offset:14336
 ds_write_b128 v5, v[60:63] offset:15360
 ds_write_b128 v5, v[64:67] offset:16384
 ds_write_b128 v5, v[68:71] offset:17408
 ds_write_b128 v5, v[72:75] offset:18432
 ds_write_b128 v5, v[76:79] offset:19456
 ds_write_b128 v5, v[80:83] offset:20480
 ds_write_b128 v5, v[84:87] offset:21504
 ds_write_b128 v5, v[88:91] offset:22528
 ds_write_b128 v5, v[92:95] offset:23552
 ds_write_b128 v5, v[96:99] offset:24576
 ds_write_b128 v5, v[100:103] offset:25600
 ds_write_b128 v5, v[104:107] offset:26624
 ds_write_b128 v5, v[108:111] offset:27648
 ds_write_b128 v5, v[112:115] offset:28672
 ds_write_b128 v5, v[116:119] offset:29696
 ds_write_b128 v5, v[120:123] offset:30720
 ds_write_b128 v5, v[124:127] offset:31744
 s_waitcnt lgkmcnt(0)
 v_lshrrev_b32 v13, 2, v15
 v_and_b32 v14, 3, v15
 s_lshr_b32 s45, s4, 1
 s_mul_i32 s45, s45, 36864
 s_and_b32 s46, s4, 1
 s_lshl_b32 s46, s46, 6
 s_add_u32 s45, s45, s46
 s_add_u32 s37, s37, s45
 v_mul_u32_u24 v6, 2304, v13
 v_lshl_add_u32 v6, v14, 4, v6
 v_lshl_add_u32 v13, v14, 2, v13
 v_and_b32 v13, 15, v13
 v_lshlrev_b32 v13, 4, v13
 s_lshl_b32 s45, s4, 11
 v_lshl_add_u32 v12, v14, 9, v13
 v_add_u32 v12, s45, v12
 v_lshrrev_b32 v13, 5, v15
 v_lshl_add_u32 v13, v13, 2, v15
 v_and_b32 v13, 15, v13
 v_and_or_b32 v13, v15, 48, v13
 v_lshlrev_b32 v13, 4, v13
 v_xor_b32 v14, 0x80, v13
 v_add_u32 v15, s49, v14
 v_add_u32 v14, s49, v13
 v_add_u32 v4, 32768, v12
 v_add_u32 v7, 114688, v12
 s_lshl_b32 s45, s32, 7
 s_add_u32 s37, s37, s45
 s_lshl_b32 s45, s4, 16
 s_add_u32 s36, s36, s45
 s_mov_b32 s42, s33
 s_mov_b32 s43, 0
 s_and_b32 s53, s42, s93
 s_lshl_b32 s53, s53, s91
 s_add_u32 s53, s53, s38
 s_lshr_b32 s51, s42, s90
 s_add_u32 s51, s51, 1
 ds_read_b128 v[16:19], v5 offset:0
 ds_read_b128 v[20:23], v5 offset:1024
Los0_33:
 buffer_load_dword v2, v3, s[20:23], s53 offen sc1
 s_waitcnt vmcnt(0)
 v_cmp_gt_u32 vcc, s51, v2
 s_and_b32 s52, vcc_lo, 0xffff
 s_cbranch_scc0 Los0k_34
 s_sleep 4
 s_sub_u32 s50, s50, 1
 s_cbranch_scc0 Los0_33
 s_endpgm
Los0k_34:
 s_lshl_b32 s48, s42, 18
 s_add_u32 s48, s48, s36
 s_add_u32 s52, s44, 0
 s_and_b32 s52, s52, 7
 s_lshl_b32 s52, s52, 13
 s_add_u32 s46, s48, s52
 s_add_u32 s47, s46, 4096
 buffer_load_dwordx4 v[32:35], v1, s[20:23], s46 offen offset:0 sc1
 buffer_load_dwordx4 v[36:39], v1, s[20:23], s46 offen offset:1024 sc1
 buffer_load_dwordx4 v[40:43], v1, s[20:23], s46 offen offset:2048 sc1
 buffer_load_dwordx4 v[44:47], v1, s[20:23], s46 offen offset:3072 sc1
 buffer_load_dwordx4 v[48:51], v1, s[20:23], s47 offen offset:0 sc1
 buffer_load_dwordx4 v[52:55], v1, s[20:23], s47 offen offset:1024 sc1
 buffer_load_dwordx4 v[56:59], v1, s[20:23], s47 offen offset:2048 sc1
 buffer_load_dwordx4 v[60:63], v1, s[20:23], s47 offen offset:3072 sc1
 s_add_u32 s52, s44, 1
 s_and_b32 s52, s52, 7
 s_lshl_b32 s52, s52, 13
 s_add_u32 s46, s48, s52
 s_add_u32 s47, s46, 4096
 buffer_load_dwordx4 v[64:67], v1, s[20:23], s46 offen offset:0 sc1
 buffer_load_dwordx4 v[68:71], v1, s[20:23], s46 offen offset:1024 sc1
 buffer_load_dwordx4 v[72:75], v1, s[20:23], s46 offen offset:2048 sc1
 buffer_load_dwordx4 v[76:79], v1, s[20:23], s46 offen offset:3072 sc1
 buffer_load_dwordx4 v[80:83], v1, s[20:23], s47 offen offset:0 sc1
 buffer_load_dwordx4 v[84:87], v1, s[20:23], s47 offen offset:1024 sc1
 buffer_load_dwordx4 v[88:91], v1, s[20:23], s47 offen offset:2048 sc1
 buffer_load_dwordx4 v[92:95], v1, s[20:23], s47 offen offset:3072 sc1
 .p2align 3
Losl_35:
 s_waitcnt vmcnt(14) lgkmcnt(1)
 v_mfma_f32_16x16x32_bf16 v[96:99], a[0:3], v[32:35], 0
 s_add_u32 s52, s44, 2
 s_and_b32 s52, s52, 7
 v_mfma_f32_16x16x32_bf16 v[100:103], a[4:7], v[32:35], 0
 s_lshl_b32 s52, s52, 13
 s_add_u32 s46, s48, s52
 v_mfma_f32_16x16x32_bf16 v[104:107], a[8:11], v[32:35], 0
 s_add_u32 s47, s46, 4096
 v_mfma_f32_16x16x32_bf16 v[108:111], v[16:19], v[32:35], 0
 buffer_load_dwordx4 v[32:35], v1, s[20:23], s46 offen offset:0 sc1
 v_mfma_f32_16x16x32_bf16 v[112:115], a[0:3], v[36:39], 0
 ds_read_b128 v[24:27], v5 offset:2048
 v_mfma_f32_16x16x32_bf16 v[116:119], a[4:7], v[36:39], 0
 v_mfma_f32_16x16x32_bf16 v[120:123], a[8:11], v[36:39], 0
 v_mfma_f32_16x16x32_bf16 v[124:127], v[16:19], v[36:39], 0
 buffer_load_dwordx4 v[36:39], v1, s[20:23], s46 offen offset:1024 sc1
 s_waitcnt vmcnt(14) lgkmcnt(1)
 v_mfma_f32_16x16x32_bf16 v[96:99], a[12:15], v[40:43], v[96:99]
 s_mov_b32 s41, s42
 s_add_u32 s43, s43, 1
 v_mfma_f32_16x16x32_bf16 v[100:103], a[16:19], v[40:43], v[100:103]
 s_cmp_lt_u32 s43, s35
 s_cselect_b32 s45, s34, 0
 v_mfma_f32_16x16x32_bf16 v[104:107], a[20:23], v[40:43], v[104:107]
 s_xor_b32 s34, s34, s39
 s_add_u32 s42, s42, s45
 v_mfma_f32_16x16x32_bf16 v[108:111], v[20:23], v[40:43], v[108:111]
 buffer_load_dwordx4 v[40:43], v1, s[20:23], s46 offen offset:2048 sc1
 v_mfma_f32_16x16x32_bf16 v[112:115], a[12:15], v[44:47], v[112:115]
 ds_read_b128 v[28:31], v5 offset:3072
 v_mfma_f32_16x16x32_bf16 v[116:119], a[16:19], v[44:47], v[116:119]
 v_mfma_f32_16x16x32_bf16 v[120:123], a[20:23], v[44:47], v[120:123]
 v_mfma_f32_16x16x32_bf16 v[124:127], v[20:23], v[44:47], v[124:127]
 buffer_load_dwordx4 v[44:47], v1, s[20:23], s46 offen offset:3072 sc1
 s_waitcnt vmcnt(14) lgkmcnt(1)
 v_mfma_f32_16x16x32_bf16 v[96:99], a[24:27], v[48:51], v[96:99]
 s_and_b32 s53, s42, s93
 s_lshl_b32 s53, s53, s91
 v_mfma_f32_16x16x32_bf16 v[100:103], a[28:31], v[48:51], v[100:103]
 s_add_u32 s53, s53, s38
 s_lshr_b32 s51, s42, s90
 v_mfma_f32_16x16x32_bf16 v[104:107], a[32:35], v[48:51], v[104:107]
 s_add_u32 s51, s51, 1
 v_mfma_f32_16x16x32_bf16 v[108:111], v[24:27], v[48:51], v[108:111]
 buffer_load_dwordx4 v[48:51], v1, s[20:23], s47 offen offset:0 sc1
 v_mfma_f32_16x16x32_bf16 v[112:115], a[24:27], v[52:55], v[112:115]
 ds_read_b128 v[16:19], v5 offset:4096
 v_mfma_f32_16x16x32_bf16 v[116:119], a[28:31], v[52:55], v[116:119]
 v_mfma_f32_16x16x32_bf16 v[120:123], a[32:35], v[52:55], v[120:123]
 v_mfma_f32_16x16x32_bf16 v[124:127], v[24:27], v[52:55], v[124:127]
 buffer_load_dwordx4 v[52:55], v1, s[20:23], s47 offen offset:1024 sc1
 s_waitcnt vmcnt(14) lgkmcnt(1)
 v_mfma_f32_16x16x32_bf16 v[96:99], a[36:39], v[56:59], v[96:99]
 s_mul_i32 s54, s41, 73728
 s_add_u32 s54, s54, s37
 v_mfma_f32_16x16x32_bf16 v[100:103], a[40:43], v[56:59], v[100:103]
 v_mfma_f32_16x16x32_bf16 v[104:107], a[44:47], v[56:59], v[104:107]
 v_mfma_f32_16x16x32_bf16 v[108:111], v[28:31], v[56:59], v[108:111]
 buffer_load_dwordx4 v[56:59], v1, s[20:23], s47 offen offset:2048 sc1
 v_mfma_f32_16x16x32_bf16 v[112:115], a[36:39], v[60:63], v[112:115]
 ds_read_b128 v[20:23], v5 offset:5120
 v_mfma_f32_16x16x32_bf16 v[116:119], a[40:43], v[60:63], v[116:119]
 v_mfma_f32_16x16x32_bf16 v[120:123], a[44:47], v[60:63], v[120:123]
 v_mfma_f32_16x16x32_bf16 v[124:127], v[28:31], v[60:63], v[124:127]
 buffer_load_dwordx4 v[60:63], v1, s[20:23], s47 offen offset:3072 sc1
 s_waitcnt vmcnt(14) lgkmcnt(1)
 v_mfma_f32_16x16x32_bf16 v[96:99], a[48:51], v[64:67], v[96:99]
 s_add_u32 s52, s44, 3
 s_and_b32 s52, s52, 7
 v_mfma_f32_16x16x32_bf16 v[100:103], a[52:55], v[64:67], v[100:103]
 s_lshl_b32 s52, s52, 13
 s_add_u32 s46, s48, s52
 v_mfma_f32_16x16x32_bf16 v[104:107], a[56:59], v[64:67], v[104:107]
 s_add_u32 s47, s46, 4096
 v_mfma_f32_16x16x32_bf16 v[108:111], v[16:19], v[64:67], v[108:111]
 buffer_load_dwordx4 v[64:67], v1, s[20:23], s46 offen offset:0 sc1
 v_mfma_f32_16x16x32_bf16 v[112:115], a[48:51], v[68:71], v[112:115]
 ds_read_b128 v[24:27], v5 offset:6144
 v_mfma_f32_16x16x32_bf16 v[116:119], a[52:55], v[68:71], v[116:119]
 v_mfma_f32_16x16x32_bf16 v[120:123], a[56:59], v[68:71], v[120:123]
 v_mfma_f32_16x16x32_bf16 v[124:127], v[16:19], v[68:71], v[124:127]
 buffer_load_dwordx4 v[68:71], v1, s[20:23], s46 offen offset:1024 sc1
 s_waitcnt vmcnt(14) lgkmcnt(1)
 v_mfma_f32_16x16x32_bf16 v[96:99], a[60:63], v[72:75], v[96:99]
 v_mfma_f32_16x16x32_bf16 v[100:103], a[64:67], v[72:75], v[100:103]
 v_mfma_f32_16x16x32_bf16 v[104:107], a[68:71], v[72:75], v[104:107]
 v_mfma_f32_16x16x32_bf16 v[108:111], v[20:23], v[72:75], v[108:111]
 buffer_load_dwordx4 v[72:75], v1, s[20:23], s46 offen offset:2048 sc1
 v_mfma_f32_16x16x32_bf16 v[112:115], a[60:63], v[76:79], v[112:115]
 ds_read_b128 v[28:31], v5 offset:7168
 v_mfma_f32_16x16x32_bf16 v[116:119], a[64:67], v[76:79], v[116:119]
 v_mfma_f32_16x16x32_bf16 v[120:123], a[68:71], v[76:79], v[120:123]
 v_mfma_f32_16x16x32_bf16 v[124:127], v[20:23], v[76:79], v[124:127]
 buffer_load_dwordx4 v[76:79], v1, s[20:23], s46 offen offset:3072 sc1
 s_waitcnt vmcnt(14) lgkmcnt(1)
 v_mfma_f32_16x16x32_bf16 v[96:99], a[72:75], v[80:83], v[96:99]
 v_mfma_f32_16x16x32_bf16 v[100:103], a[76:79], v[80:83], v[100:103]
 v_mfma_f32_16x16x32_bf16 v[104:107], a[80:83], v[80:83], v[104:107]
 v_mfma_f32_16x16x32_bf16 v[108:111], v[24:27], v[80:83], v[108:111]
 buffer_load_dwordx4 v[80:83], v1, s[20:23], s47 offen offset:0 sc1
 v_mfma_f32_16x16x32_bf16 v[112:115], a[72:75], v[84:87], v[112:115]
 ds_read_b128 v[16:19], v5 offset:8192
 v_mfma_f32_16x16x32_bf16 v[116:119], a[76:79], v[84:87], v[116:119]
 v_mfma_f32_16x16x32_bf16 v[120:123], a[80:83], v[84:87], v[120:123]
 v_mfma_f32_16x16x32_bf16 v[124:127], v[24:27], v[84:87], v[124:127]
 buffer_load_dwordx4 v[84:87], v1, s[20:23], s47 offen offset:1024 sc1
 s_waitcnt vmcnt(14) lgkmcnt(1)
 v_mfma_f32_16x16x32_bf16 v[96:99], a[84:87], v[88:91], v[96:99]
 v_mfma_f32_16x16x32_bf16 v[100:103], a[88:91], v[88:91], v[100:103]
 v_mfma_f32_16x16x32_bf16 v[104:107], a[92:95], v[88:91], v[104:107]
 v_mfma_f32_16x16x32_bf16 v[108:111], v[28:31], v[88:91], v[108:111]
 buffer_load_dwordx4 v[88:91], v1, s[20:23], s47 offen offset:2048 sc1
 v_mfma_f32_16x16x32_bf16 v[112:115], a[84:87], v[92:95], v[112:115]
 ds_read_b128 v[20:23], v5 offset:9216
 v_mfma_f32_16x16x32_bf16 v[116:119], a[88:91], v[92:95], v[116:119]
 v_mfma_f32_16x16x32_bf16 v[120:123], a[92:95], v[92:95], v[120:123]
 v_mfma_f32_16x16x32_bf16 v[124:127], v[28:31], v[92:95], v[124:127]
 buffer_load_dwordx4 v[92:95], v1, s[20:23], s47 offen offset:3072 sc1
 s_waitcnt vmcnt(14) lgkmcnt(1)
 v_mfma_f32_16x16x32_bf16 v[96:99], a[96:99], v[32:35], v[96:99]
 s_add_u32 s52, s44, 4
 s_and_b32 s52, s52, 7
 v_mfma_f32_16x16x32_bf16 v[100:103], a[100:103], v[32:35], v[100:103]
 s_lshl_b32 s52, s52, 13
 s_add_u32 s46, s48, s52
 v_mfma_f32_16x16x32_bf16 v[104:107], a[104:107], v[32:35], v[104:107]
 s_add_u32 s47, s46, 4096
 v_mfma_f32_16x16x32_bf16 v[108:111], v[16:19], v[32:35], v[108:111]
 buffer_load_dwordx4 v[32:35], v1, s[20:23], s46 offen offset:0 sc1
 v_mfma_f32_16x16x32_bf16 v[112:115], a[96:99], v[36:39], v[112:115]
 ds_read_b128 v[24:27], v5 offset:10240
 v_mfma_f32_16x16x32_bf16 v[116:119], a[100:103], v[36:39], v[116:119]
 v_mfma_f32_16x16x32_bf16 v[120:123], a[104:107], v[36:39], v[120:123]
 v_mfma_f32_16x16x32_bf16 v[124:127], v[16:19], v[36:39], v[124:127]
 buffer_load_dwordx4 v[36:39], v1, s[20:23], s46 offen offset:1024 sc1
 s_waitcnt vmcnt(14) lgkmcnt(1)
 v_mfma_f32_16x16x32_bf16 v[96:99], a[108:111], v[40:43], v[96:99]
 v_mfma_f32_16x16x32_bf16 v[100:103], a[112:115], v[40:43], v[100:103]
 v_mfma_f32_16x16x32_bf16 v[104:107], a[116:119], v[40:43], v[104:107]
 v_mfma_f32_16x16x32_bf16 v[108:111], v[20:23], v[40:43], v[108:111]
 buffer_load_dwordx4 v[40:43], v1, s[20:23], s46 offen offset:2048 sc1
 v_mfma_f32_16x16x32_bf16 v[112:115], a[108:111], v[44:47], v[112:115]
 ds_read_b128 v[28:31], v5 offset:11264
 v_mfma_f32_16x16x32_bf16 v[116:119], a[112:115], v[44:47], v[116:119]
 v_mfma_f32_16x16x32_bf16 v[120:123], a[116:119], v[44:47], v[120:123]
 v_mfma_f32_16x16x32_bf16 v[124:127], v[20:23], v[44:47], v[124:127]
 buffer_load_dwordx4 v[44:47], v1, s[20:23], s46 offen offset:3072 sc1
 s_waitcnt vmcnt(14) lgkmcnt(1)
 v_mfma_f32_16x16x32_bf16 v[96:99], a[120:123], v[48:51], v[96:99]
 s_barrier
 v_mfma_f32_16x16x32_bf16 v[100:103], a[124:127], v[48:51], v[100:103]
 v_mfma_f32_16x16x32_bf16 v[104:107], a[128:131], v[48:51], v[104:107]
 v_mfma_f32_16x16x32_bf16 v[108:111], v[24:27], v[48:51], v[108:111]
 buffer_load_dwordx4 v[48:51], v1, s[20:23], s47 offen offset:0 sc1
 v_mfma_f32_16x16x32_bf16 v[112:115], a[120:123], v[52:55], v[112:115]
 ds_read_b128 v[16:19], v5 offset:12288
 v_mfma_f32_16x16x32_bf16 v[116:119], a[124:127], v[52:55], v[116:119]
 v_mfma_f32_16x16x32_bf16 v[120:123], a[128:131], v[52:55], v[120:123]
 v_mfma_f32_16x16x32_bf16 v[124:127], v[24:27], v[52:55], v[124:127]
 buffer_load_dwordx4 v[52:55], v1, s[20:23], s47 offen offset:1024 sc1
 s_waitcnt vmcnt(14) lgkmcnt(1)
 v_mfma_f32_16x16x32_bf16 v[96:99], a[132:135], v[56:59], v[96:99]
 v_mfma_f32_16x16x32_bf16 v[100:103], a[136:139], v[56:59], v[100:103]
 v_mfma_f32_16x16x32_bf16 v[104:107], a[140:143], v[56:59], v[104:107]
 v_mfma_f32_16x16x32_bf16 v[108:111], v[28:31], v[56:59], v[108:111]
 buffer_load_dwordx4 v[56:59], v1, s[20:23], s47 offen offset:2048 sc1
 v_mfma_f32_16x16x32_bf16 v[112:115], a[132:135], v[60:63], v[112:115]
 ds_read_b128 v[20:23], v5 offset:13312
 v_mfma_f32_16x16x32_bf16 v[116:119], a[136:139], v[60:63], v[116:119]
 v_mfma_f32_16x16x32_bf16 v[120:123], a[140:143], v[60:63], v[120:123]
 v_mfma_f32_16x16x32_bf16 v[124:127], v[28:31], v[60:63], v[124:127]
 buffer_load_dwordx4 v[60:63], v1, s[20:23], s47 offen offset:3072 sc1
 s_waitcnt vmcnt(14) lgkmcnt(1)
 v_mfma_f32_16x16x32_bf16 v[96:99], a[144:147], v[64:67], v[96:99]
 s_add_u32 s52, s44, 5
 s_and_b32 s52, s52, 7
 v_mfma_f32_16x16x32_bf16 v[100:103], a[148:151], v[64:67], v[100:103]
 s_lshl_b32 s52, s52, 13
 s_add_u32 s46, s48, s52
 v_mfma_f32_16x16x32_bf16 v[104:107], a[152:155], v[64:67], v[104:107]
 s_add_u32 s47, s46, 4096
 v_mfma_f32_16x16x32_bf16 v[108:111], v[16:19], v[64:67], v[108:111]
 buffer_load_dwordx4 v[64:67], v1, s[20:23], s46 offen offset:0 sc1
 v_mfma_f32_16x16x32_bf16 v[112:115], a[144:147], v[68:71], v[112:115]
 ds_read_b128 v[24:27], v5 offset:14336
 v_mfma_f32_16x16x32_bf16 v[116:119], a[148:151], v[68:71], v[116:119]
 v_mfma_f32_16x16x32_bf16 v[120:123], a[152:155], v[68:71], v[120:123]
 v_mfma_f32_16x16x32_bf16 v[124:127], v[16:19], v[68:71], v[124:127]
 buffer_load_dwordx4 v[68:71], v1, s[20:23], s46 offen offset:1024 sc1
 s_waitcnt vmcnt(14) lgkmcnt(1)
 v_mfma_f32_16x16x32_bf16 v[96:99], a[156:159], v[72:75], v[96:99]
 buffer_load_dword v2, v3, s[20:23], s53 offen sc1
 v_mfma_f32_16x16x32_bf16 v[100:103], a[160:163], v[72:75], v[100:103]
 v_mfma_f32_16x16x32_bf16 v[104:107], a[164:167], v[72:75], v[104:107]
 v_mfma_f32_16x16x32_bf16 v[108:111], v[20:23], v[72:75], v[108:111]
 buffer_load_dwordx4 v[72:75], v1, s[20:23], s46 offen offset:2048 sc1
 v_mfma_f32_16x16x32_bf16 v[112:115], a[156:159], v[76:79], v[112:115]
 ds_read_b128 v[28:31], v5 offset:15360
 v_mfma_f32_16x16x32_bf16 v[116:119], a[160:163], v[76:79], v[116:119]
 v_mfma_f32_16x16x32_bf16 v[120:123], a[164:167], v[76:79], v[120:123]
 v_mfma_f32_16x16x32_bf16 v[124:127], v[20:23], v[76:79], v[124:127]
 buffer_load_dwordx4 v[76:79], v1, s[20:23], s46 offen offset:3072 sc1
 s_waitcnt vmcnt(14) lgkmcnt(1)
 v_mfma_f32_16x16x32_bf16 v[96:99], a[168:171], v[80:83], v[96:99]
 v_mfma_f32_16x16x32_bf16 v[100:103], a[172:175], v[80:83], v[100:103]
 v_mfma_f32_16x16x32_bf16 v[104:107], a[176:179], v[80:83], v[104:107]
 v_mfma_f32_16x16x32_bf16 v[108:111], v[24:27], v[80:83], v[108:111]
 buffer_load_dwordx4 v[80:83], v1, s[20:23], s47 offen offset:0 sc1
 v_mfma_f32_16x16x32_bf16 v[112:115], a[168:171], v[84:87], v[112:115]
 ds_read_b128 v[16:19], v5 offset:16384
 v_mfma_f32_16x16x32_bf16 v[116:119], a[172:175], v[84:87], v[116:119]
 v_mfma_f32_16x16x32_bf16 v[120:123], a[176:179], v[84:87], v[120:123]
 v_mfma_f32_16x16x32_bf16 v[124:127], v[24:27], v[84:87], v[124:127]
 buffer_load_dwordx4 v[84:87], v1, s[20:23], s47 offen offset:1024 sc1
 s_waitcnt vmcnt(14) lgkmcnt(1)
 v_mfma_f32_16x16x32_bf16 v[96:99], a[180:183], v[88:91], v[96:99]
 v_mfma_f32_16x16x32_bf16 v[100:103], a[184:187], v[88:91], v[100:103]
 v_mfma_f32_16x16x32_bf16 v[104:107], a[188:191], v[88:91], v[104:107]
 v_mfma_f32_16x16x32_bf16 v[108:111], v[28:31], v[88:91], v[108:111]
 buffer_load_dwordx4 v[88:91], v1, s[20:23], s47 offen offset:2048 sc1
 v_mfma_f32_16x16x32_bf16 v[112:115], a[180:183], v[92:95], v[112:115]
 ds_read_b128 v[20:23], v5 offset:17408
 v_mfma_f32_16x16x32_bf16 v[116:119], a[184:187], v[92:95], v[116:119]
 v_mfma_f32_16x16x32_bf16 v[120:123], a[188:191], v[92:95], v[120:123]
 v_mfma_f32_16x16x32_bf16 v[124:127], v[28:31], v[92:95], v[124:127]
 buffer_load_dwordx4 v[92:95], v1, s[20:23], s47 offen offset:3072 sc1
 s_waitcnt vmcnt(14) lgkmcnt(1)
 v_mfma_f32_16x16x32_bf16 v[96:99], a[192:195], v[32:35], v[96:99]
 s_add_u32 s52, s44, 6
 s_and_b32 s52, s52, 7
 v_mfma_f32_16x16x32_bf16 v[100:103], a[196:199], v[32:35], v[100:103]
 s_lshl_b32 s52, s52, 13
 s_add_u32 s46, s48, s52
 v_mfma_f32_16x16x32_bf16 v[104:107], a[200:203], v[32:35], v[104:107]
 s_add_u32 s47, s46, 4096
 v_mfma_f32_16x16x32_bf16 v[108:111], v[16:19], v[32:35], v[108:111]
 buffer_load_dwordx4 v[32:35], v1, s[20:23], s46 offen offset:0 sc1
 v_mfma_f32_16x16x32_bf16 v[112:115], a[192:195], v[36:39], v[112:115]
 ds_read_b128 v[24:27], v5 offset:18432
 v_mfma_f32_16x16x32_bf16 v[116:119], a[196:199], v[36:39], v[116:119]
 v_mfma_f32_16x16x32_bf16 v[120:123], a[200:203], v[36:39], v[120:123]
 v_mfma_f32_16x16x32_bf16 v[124:127], v[16:19], v[36:39], v[124:127]
 buffer_load_dwordx4 v[36:39], v1, s[20:23], s46 offen offset:1024 sc1
 s_waitcnt vmcnt(14) lgkmcnt(1)
 v_mfma_f32_16x16x32_bf16 v[96:99], a[204:207], v[40:43], v[96:99]
 v_mfma_f32_16x16x32_bf16 v[100:103], a[208:211], v[40:43], v[100:103]
 v_mfma_f32_16x16x32_bf16 v[104:107], a[212:215], v[40:43], v[104:107]
 v_mfma_f32_16x16x32_bf16 v[108:111], v[20:23], v[40:43], v[108:111]
 buffer_load_dwordx4 v[40:43], v1, s[20:23], s46 offen offset:2048 sc1
 v_mfma_f32_16x16x32_bf16 v[112:115], a[204:207], v[44:47], v[112:115]
 ds_read_b128 v[28:31], v5 offset:19456
 v_mfma_f32_16x16x32_bf16 v[116:119], a[208:211], v[44:47], v[116:119]
 v_mfma_f32_16x16x32_bf16 v[120:123], a[212:215], v[44:47], v[120:123]
 v_mfma_f32_16x16x32_bf16 v[124:127], v[20:23], v[44:47], v[124:127]
 buffer_load_dwordx4 v[44:47], v1, s[20:23], s46 offen offset:3072 sc1
 s_waitcnt vmcnt(14) lgkmcnt(1)
 v_mfma_f32_16x16x32_bf16 v[96:99], a[216:219], v[48:51], v[96:99]
 v_mfma_f32_16x16x32_bf16 v[100:103], a[220:223], v[48:51], v[100:103]
 v_mfma_f32_16x16x32_bf16 v[104:107], a[224:227], v[48:51], v[104:107]
 v_mfma_f32_16x16x32_bf16 v[108:111], v[24:27], v[48:51], v[108:111]
 buffer_load_dwordx4 v[48:51], v1, s[20:23], s47 offen offset:0 sc1
 v_mfma_f32_16x16x32_bf16 v[112:115], a[216:219], v[52:55], v[112:115]
 ds_read_b128 v[16:19], v5 offset:20480
 v_mfma_f32_16x16x32_bf16 v[116:119], a[220:223], v[52:55], v[116:119]
 v_mfma_f32_16x16x32_bf16 v[120:123], a[224:227], v[52:55], v[120:123]
 v_mfma_f32_16x16x32_bf16 v[124:127], v[24:27], v[52:55], v[124:127]
 buffer_load_dwordx4 v[52:55], v1, s[20:23], s47 offen offset:1024 sc1
 s_waitcnt vmcnt(14) lgkmcnt(1)
 v_mfma_f32_16x16x32_bf16 v[96:99], a[228:231], v[56:59], v[96:99]
 v_mfma_f32_16x16x32_bf16 v[100:103], a[232:235], v[56:59], v[100:103]
 v_mfma_f32_16x16x32_bf16 v[104:107], a[236:239], v[56:59], v[104:107]
 v_mfma_f32_16x16x32_bf16 v[108:111], v[28:31], v[56:59], v[108:111]
 buffer_load_dwordx4 v[56:59], v1, s[20:23], s47 offen offset:2048 sc1
 v_mfma_f32_16x16x32_bf16 v[112:115], a[228:231], v[60:63], v[112:115]
 ds_read_b128 v[20:23], v5 offset:21504
 v_mfma_f32_16x16x32_bf16 v[116:119], a[232:235], v[60:63], v[116:119]
 v_mfma_f32_16x16x32_bf16 v[120:123], a[236:239], v[60:63], v[120:123]
 v_mfma_f32_16x16x32_bf16 v[124:127], v[28:31], v[60:63], v[124:127]
 buffer_load_dwordx4 v[60:63], v1, s[20:23], s47 offen offset:3072 sc1
 s_waitcnt vmcnt(14) lgkmcnt(1)
 v_mfma_f32_16x16x32_bf16 v[96:99], a[240:243], v[64:67], v[96:99]
 s_add_u32 s52, s44, 7
 s_and_b32 s52, s52, 7
 v_mfma_f32_16x16x32_bf16 v[100:103], a[244:247], v[64:67], v[100:103]
 s_lshl_b32 s52, s52, 13
 s_add_u32 s46, s48, s52
 v_mfma_f32_16x16x32_bf16 v[104:107], a[248:251], v[64:67], v[104:107]
 s_add_u32 s47, s46, 4096
 v_mfma_f32_16x16x32_bf16 v[108:111], v[16:19], v[64:67], v[108:111]
 buffer_load_dwordx4 v[64:67], v1, s[20:23], s46 offen offset:0 sc1
 v_mfma_f32_16x16x32_bf16 v[112:115], a[240:243], v[68:71], v[112:115]
 ds_read_b128 v[24:27], v5 offset:22528
 v_mfma_f32_16x16x32_bf16 v[116:119], a[244:247], v[68:71], v[116:119]
 v_mfma_f32_16x16x32_bf16 v[120:123], a[248:251], v[68:71], v[120:123]
 v_mfma_f32_16x16x32_bf16 v[124:127], v[16:19], v[68:71], v[124:127]
 buffer_load_dwordx4 v[68:71], v1, s[20:23], s46 offen offset:1024 sc1
 s_waitcnt vmcnt(14) lgkmcnt(1)
 v_mfma_f32_16x16x32_bf16 v[96:99], a[252:255], v[72:75], v[96:99]
 v_mfma_f32_16x16x32_bf16 v[100:103], v[128:131], v[72:75], v[100:103]
 v_mfma_f32_16x16x32_bf16 v[104:107], v[132:135], v[72:75], v[104:107]
 v_mfma_f32_16x16x32_bf16 v[108:111], v[20:23], v[72:75], v[108:111]
 buffer_load_dwordx4 v[72:75], v1, s[20:23], s46 offen offset:2048 sc1
 v_mfma_f32_16x16x32_bf16 v[112:115], a[252:255], v[76:79], v[112:115]
 ds_read_b128 v[28:31], v5 offset:23552
 v_mfma_f32_16x16x32_bf16 v[116:119], v[128:131], v[76:79], v[116:119]
 v_mfma_f32_16x16x32_bf16 v[120:123], v[132:135], v[76:79], v[120:123]
 v_mfma_f32_16x16x32_bf16 v[124:127], v[20:23], v[76:79], v[124:127]
 buffer_load_dwordx4 v[76:79], v1, s[20:23], s46 offen offset:3072 sc1
 s_waitcnt vmcnt(14) lgkmcnt(1)
 v_mfma_f32_16x16x32_bf16 v[96:99], v[136:139], v[80:83], v[96:99]
 v_cmp_gt_u32 vcc, s51, v2
 v_mfma_f32_16x16x32_bf16 v[100:103], v[140:143], v[80:83], v[100:103]
 v_mfma_f32_16x16x32_bf16 v[104:107], v[144:147], v[80:83], v[104:107]
 v_mfma_f32_16x16x32_bf16 v[108:111], v[24:27], v[80:83], v[108:111]
 buffer_load_dwordx4 v[80:83], v1, s[20:23], s47 offen offset:0 sc1
 v_mfma_f32_16x16x32_bf16 v[112:115], v[136:139], v[84:87], v[112:115]
 ds_read_b128 v[16:19], v5 offset:24576
 v_mfma_f32_16x16x32_bf16 v[116:119], v[140:143], v[84:87], v[116:119]
 v_mfma_f32_16x16x32_bf16 v[120:123], v[144:147], v[84:87], v[120:123]
 v_mfma_f32_16x16x32_bf16 v[124:127], v[24:27], v[84:87], v[124:127]
 buffer_load_dwordx4 v[84:87], v1, s[20:23], s47 offen offset:1024 sc1
 s_waitcnt vmcnt(14) lgkmcnt(1)
 v_mfma_f32_16x16x32_bf16 v[96:99], v[148:151], v[88:91], v[96:99]
 s_and_b32 s52, vcc_lo, 0xffff
 s_cbranch_scc1 Losw_36
Loswk_37:
 v_mfma_f32_16x16x32_bf16 v[100:103], v[152:155], v[88:91], v[100:103]
 s_lshl_b32 s48, s42, 18
 s_add_u32 s48, s48, s36
 v_mfma_f32_16x16x32_bf16 v[104:107], v[156:159], v[88:91], v[104:107]
 v_mfma_f32_16x16x32_bf16 v[108:111], v[28:31], v[88:91], v[108:111]
 buffer_load_dwordx4 v[88:91], v1, s[20:23], s47 offen offset:2048 sc1
 v_mfma_f32_16x16x32_bf16 v[112:115], v[148:151], v[92:95], v[112:115]
 ds_read_b128 v[20:23], v5 offset:25600
 v_mfma_f32_16x16x32_bf16 v[116:119], v[152:155], v[92:95], v[116:119]
 v_mfma_f32_16x16x32_bf16 v[120:123], v[156:159], v[92:95], v[120:123]
 v_mfma_f32_16x16x32_bf16 v[124:127], v[28:31], v[92:95], v[124:127]
 buffer_load_dwordx4 v[92:95], v1, s[20:23], s47 offen offset:3072 sc1
 s_waitcnt vmcnt(14) lgkmcnt(1)
 v_mfma_f32_16x16x32_bf16 v[96:99], v[160:163], v[32:35], v[96:99]
 s_add_u32 s52, s44, 0
 s_and_b32 s52, s52, 7
 v_mfma_f32_16x16x32_bf16 v[100:103], v[164:167], v[32:35], v[100:103]
 s_lshl_b32 s52, s52, 13
 s_add_u32 s46, s48, s52
 v_mfma_f32_16x16x32_bf16 v[104:107], v[168:171], v[32:35], v[104:107]
 s_add_u32 s47, s46, 4096
 v_mfma_f32_16x16x32_bf16 v[108:111], v[16:19], v[32:35], v[108:111]
 buffer_load_dwordx4 v[32:35], v1, s[20:23], s46 offen offset:0 sc1
 v_mfma_f32_16x16x32_bf16 v[112:115], v[160:163], v[36:39], v[112:115]
 ds_read_b128 v[24:27], v5 offset:26624
 v_mfma_f32_16x16x32_bf16 v[116:119], v[164:167], v[36:39], v[116:119]
 v_mfma_f32_16x16x32_bf16 v[120:123], v[168:171], v[36:39], v[120:123]
 v_mfma_f32_16x16x32_bf16 v[124:127], v[16:19], v[36:39], v[124:127]
 buffer_load_dwordx4 v[36:39], v1, s[20:23], s46 offen offset:1024 sc1
 s_waitcnt vmcnt(14) lgkmcnt(1)
 v_mfma_f32_16x16x32_bf16 v[96:99], v[172:175], v[40:43], v[96:99]
 v_mfma_f32_16x16x32_bf16 v[100:103], v[176:179], v[40:43], v[100:103]
 v_mfma_f32_16x16x32_bf16 v[104:107], v[180:183], v[40:43], v[104:107]
 v_mfma_f32_16x16x32_bf16 v[108:111], v[20:23], v[40:43], v[108:111]
 buffer_load_dwordx4 v[40:43], v1, s[20:23], s46 offen offset:2048 sc1
 v_mfma_f32_16x16x32_bf16 v[112:115], v[172:175], v[44:47], v[112:115]
 ds_read_b128 v[28:31], v5 offset:27648
 v_mfma_f32_16x16x32_bf16 v[116:119], v[176:179], v[44:47], v[116:119]
 v_mfma_f32_16x16x32_bf16 v[120:123], v[180:183], v[44:47], v[120:123]
 v_mfma_f32_16x16x32_bf16 v[124:127], v[20:23], v[44:47], v[124:127]
 buffer_load_dwordx4 v[44:47], v1, s[20:23], s46 offen offset:3072 sc1
 s_waitcnt vmcnt(14) lgkmcnt(1)
 v_mfma_f32_16x16x32_bf16 v[96:99], v[184:187], v[48:51], v[96:99]
 v_mfma_f32_16x16x32_bf16 v[100:103], v[188:191], v[48:51], v[100:103]
 v_mfma_f32_16x16x32_bf16 v[104:107], v[192:195], v[48:51], v[104:107]
 v_mfma_f32_16x16x32_bf16 v[108:111], v[24:27], v[48:51], v[108:111]
 buffer_load_dwordx4 v[48:51], v1, s[20:23], s47 offen offset:0 sc1
 v_mfma_f32_16x16x32_bf16 v[112:115], v[184:187], v[52:55], v[112:115]
 ds_read_b128 v[16:19], v5 offset:28672
 v_mfma_f32_16x16x32_bf16 v[116:119], v[188:191], v[52:55], v[116:119]
 v_mfma_f32_16x16x32_bf16 v[120:123], v[192:195], v[52:55], v[120:123]
 v_mfma_f32_16x16x32_bf16 v[124:127], v[24:27], v[52:55], v[124:127]
 buffer_load_dwordx4 v[52:55], v1, s[20:23], s47 offen offset:1024 sc1
 s_waitcnt vmcnt(14) lgkmcnt(1)
 v_mfma_f32_16x16x32_bf16 v[96:99], v[196:199], v[56:59], v[96:99]
 v_mfma_f32_16x16x32_bf16 v[100:103], v[200:203], v[56:59], v[100:103]
 v_mfma_f32_16x16x32_bf16 v[104:107], v[204:207], v[56:59], v[104:107]
 v_mfma_f32_16x16x32_bf16 v[108:111], v[28:31], v[56:59], v[108:111]
 buffer_load_dwordx4 v[56:59], v1, s[20:23], s47 offen offset:2048 sc1
 v_mfma_f32_16x16x32_bf16 v[112:115], v[196:199], v[60:63], v[112:115]
 ds_read_b128 v[20:23], v5 offset:29696
 v_mfma_f32_16x16x32_bf16 v[116:119], v[200:203], v[60:63], v[116:119]
 v_mfma_f32_16x16x32_bf16 v[120:123], v[204:207], v[60:63], v[120:123]
 v_mfma_f32_16x16x32_bf16 v[124:127], v[28:31], v[60:63], v[124:127]
 buffer_load_dwordx4 v[60:63], v1, s[20:23], s47 offen offset:3072 sc1
 s_waitcnt vmcnt(14) lgkmcnt(1)
 v_mfma_f32_16x16x32_bf16 v[96:99], v[208:211], v[64:67], v[96:99]
 s_add_u32 s52, s44, 1
 s_and_b32 s52, s52, 7
 v_mfma_f32_16x16x32_bf16 v[100:103], v[212:215], v[64:67], v[100:103]
 s_lshl_b32 s52, s52, 13
 s_add_u32 s46, s48, s52
 v_mfma_f32_16x16x32_bf16 v[104:107], v[216:219], v[64:67], v[104:107]
 s_add_u32 s47, s46, 4096
 v_mfma_f32_16x16x32_bf16 v[108:111], v[16:19], v[64:67], v[108:111]
 buffer_load_dwordx4 v[64:67], v1, s[20:23], s46 offen offset:0 sc1
 v_mfma_f32_16x16x32_bf16 v[112:115], v[208:211], v[68:71], v[112:115]
 ds_read_b128 v[24:27], v5 offset:30720
 v_mfma_f32_16x16x32_bf16 v[116:119], v[212:215], v[68:71], v[116:119]
 v_mfma_f32_16x16x32_bf16 v[120:123], v[216:219], v[68:71], v[120:123]
 v_mfma_f32_16x16x32_bf16 v[124:127], v[16:19], v[68:71], v[124:127]
 buffer_load_dwordx4 v[68:71], v1, s[20:23], s46 offen offset:1024 sc1
 s_waitcnt vmcnt(14) lgkmcnt(1)
 v_mfma_f32_16x16x32_bf16 v[96:99], v[220:223], v[72:75], v[96:99]
 v_mfma_f32_16x16x32_bf16 v[100:103], v[224:227], v[72:75], v[100:103]
 v_mfma_f32_16x16x32_bf16 v[104:107], v[228:231], v[72:75], v[104:107]
 v_mfma_f32_16x16x32_bf16 v[108:111], v[20:23], v[72:75], v[108:111]
 buffer_load_dwordx4 v[72:75], v1, s[20:23], s46 offen offset:2048 sc1
 v_mfma_f32_16x16x32_bf16 v[112:115], v[220:223], v[76:79], v[112:115]
 ds_read_b128 v[28:31], v5 offset:31744
 v_mfma_f32_16x16x32_bf16 v[116:119], v[224:227], v[76:79], v[116:119]
 v_mfma_f32_16x16x32_bf16 v[120:123], v[228:231], v[76:79], v[120:123]
 v_mfma_f32_16x16x32_bf16 v[124:127], v[20:23], v[76:79], v[124:127]
 buffer_load_dwordx4 v[76:79], v1, s[20:23], s46 offen offset:3072 sc1
 s_waitcnt vmcnt(14) lgkmcnt(1)
 v_mfma_f32_16x16x32_bf16 v[96:99], v[232:235], v[80:83], v[96:99]
 v_mfma_f32_16x16x32_bf16 v[100:103], v[236:239], v[80:83], v[100:103]
 v_mfma_f32_16x16x32_bf16 v[104:107], v[240:243], v[80:83], v[104:107]
 v_mfma_f32_16x16x32_bf16 v[108:111], v[24:27], v[80:83], v[108:111]
 buffer_load_dwordx4 v[80:83], v1, s[20:23], s47 offen offset:0 sc1
 v_mfma_f32_16x16x32_bf16 v[112:115], v[232:235], v[84:87], v[112:115]
 ds_read_b128 v[16:19], v5 offset:0
 v_mfma_f32_16x16x32_bf16 v[116:119], v[236:239], v[84:87], v[116:119]
 v_mfma_f32_16x16x32_bf16 v[120:123], v[240:243], v[84:87], v[120:123]
 v_mfma_f32_16x16x32_bf16 v[124:127], v[24:27], v[84:87], v[124:127]
 buffer_load_dwordx4 v[84:87], v1, s[20:23], s47 offen offset:1024 sc1
 s_waitcnt vmcnt(14) lgkmcnt(1)
 v_mfma_f32_16x16x32_bf16 v[96:99], v[244:247], v[88:91], v[96:99]
 v_mfma_f32_16x16x32_bf16 v[100:103], v[248:251], v[88:91], v[100:103]
 v_mfma_f32_16x16x32_bf16 v[104:107], v[252:255], v[88:91], v[104:107]
 v_mfma_f32_16x16x32_bf16 v[108:111], v[28:31], v[88:91], v[108:111]
 buffer_load_dwordx4 v[88:91], v1, s[20:23], s47 offen offset:2048 sc1
 v_mfma_f32_16x16x32_bf16 v[112:115], v[244:247], v[92:95], v[112:115]
 ds_read_b128 v[20:23], v5 offset:1024
 v_mfma_f32_16x16x32_bf16 v[116:119], v[248:251], v[92:95], v[116:119]
 v_mfma_f32_16x16x32_bf16 v[120:123], v[252:255], v[92:95], v[120:123]
 v_mfma_f32_16x16x32_bf16 v[124:127], v[28:31], v[92:95], v[124:127]
 buffer_load_dwordx4 v[92:95], v1, s[20:23], s47 offen offset:3072 sc1
 s_cmp_lt_u32 s43, s35
 ds_write_b128 v14, v[96:99] offset:32768
 ds_write_b128 v15, v[100:103] offset:33792
 ds_write_b128 v14, v[104:107] offset:34816
 ds_write_b128 v15, v[108:111] offset:35840
 ds_write_b128 v14, v[112:115] offset:36864
 ds_write_b128 v15, v[116:119] offset:37888
 ds_write_b128 v14, v[120:123] offset:38912
 ds_write_b128 v15, v[124:127] offset:39936
 s_waitcnt lgkmcnt(0)
 s_barrier
 ds_read_b128 v[96:99], v4 offset:0
 ds_read_b128 v[100:103], v4 offset:256
 ds_read_b128 v[104:107], v4 offset:40960
 ds_read_b128 v[108:111], v4 offset:41216
 ds_read_b128 v[112:115], v7 offset:0
 ds_read_b128 v[116:119], v7 offset:256
 ds_read_b128 v[120:123], v7 offset:40960
 ds_read_b128 v[124:127], v7 offset:41216
 s_waitcnt lgkmcnt(4)
 v_pk_add_f32 v[96:97], v[96:97], v[104:105]
 v_pk_add_f32 v[98:99], v[98:99], v[106:107]
 v_pk_add_f32 v[100:101], v[100:101], v[108:109]
 v_pk_add_f32 v[102:103], v[102:103], v[110:111]
 s_waitcnt lgkmcnt(2)
 v_pk_add_f32 v[96:97], v[96:97], v[112:113]
 v_pk_add_f32 v[98:99], v[98:99], v[114:115]
 v_pk_add_f32 v[100:101], v[100:101], v[116:117]
 v_pk_add_f32 v[102:103], v[102:103], v[118:119]
 s_waitcnt lgkmcnt(0)
 v_pk_add_f32 v[96:97], v[96:97], v[120:121]
 v_pk_add_f32 v[98:99], v[98:99], v[122:123]
 v_pk_add_f32 v[100:101], v[100:101], v[124:125]
 v_pk_add_f32 v[102:103], v[102:103], v[126:127]
 v_cvt_pk_bf16_f32 v8, v96, v97
 v_cvt_pk_bf16_f32 v9, v98, v99
 v_cvt_pk_bf16_f32 v10, v100, v101
 v_cvt_pk_bf16_f32 v11, v102, v103
 buffer_store_dwordx4 v[8:11], v6, s[24:27], s54 offen
 s_cbranch_scc1 Losl_35
 s_branch Lose_38
Losw_36:
 buffer_load_dword v2, v3, s[20:23], s53 offen sc1
 s_waitcnt vmcnt(0)
 v_cmp_gt_u32 vcc, s51, v2
 s_and_b32 s52, vcc_lo, 0xffff
 s_cbranch_scc0 Loswk_37
 s_sleep 4
 s_sub_u32 s50, s50, 1
 s_cbranch_scc0 Losw_36
 s_endpgm
Lose_38:
 s_waitcnt vmcnt(0)
 s_branch Lfin
Lchain:
 s_load_dwordx2 s[8:9], s[0:1], 64
 s_mov_b32 s10, 0x480000
 s_mov_b32 s11, 0x20000
 s_load_dwordx2 s[12:13], s[0:1], 72
 s_mov_b32 s14, 0x480000
 s_mov_b32 s15, 0x20000
 s_load_dwordx2 s[16:17], s[0:1], 80
 s_mov_b32 s18, 0x480000
 s_mov_b32 s19, 0x20000
 s_load_dwordx2 s[24:25], s[0:1], 88
 s_mov_b32 s26, 0x480000
 s_mov_b32 s27, 0x20000
 s_load_dwordx2 s[28:29], s[0:1], 112
 s_mov_b32 s30, 0x100
 s_mov_b32 s31, 0x20000
 s_load_dwordx2 s[32:33], s[0:1], 56
 s_mov_b32 s34, 0x2400
 s_mov_b32 s35, 0x20000
 v_and_b32 v20, 63, v0
 v_lshlrev_b32 v3, 4, v20
 v_mov_b32 v7, 0
 s_mov_b32 s48, 0xcccccccc
 s_mov_b32 s49, 0xcccccccc
 v_mov_b32 v21, 0x44444444
 v_mov_b32 v22, 0xeeeeeeee
 v_cndmask_b32 v5, v21, v22, s[48:49]
 s_mul_i32 s47, s4, 544
 v_lshrrev_b32 v21, 4, v20
 v_lshlrev_b32 v21, 7, v21
 v_and_b32 v22, 32, v20
 v_add3_u32 v21, v21, v22, s47
 v_and_b32 v22, 15, v20
 v_lshl_add_u32 v8, v22, 3, v21
 v_lshrrev_b32 v21, 5, v20
 v_mul_u32_u24 v21, 544, v21
 v_and_b32 v22, 3, v20
 v_lshl_add_u32 v21, v22, 7, v21
 v_and_b32 v22, 2, v20
 v_lshl_add_u32 v21, v22, 4, v21
 v_and_b32 v22, 16, v20
 v_lshl_add_u32 v21, v22, 2, v21
 v_and_b32 v22, 12, v20
 v_lshl_add_u32 v9, v22, 1, v21
 v_lshrrev_b32 v21, 4, v0
 v_lshlrev_b32 v21, 7, v21
 v_and_b32 v22, 14, v20
 v_lshl_add_u32 v21, v22, 2, v21
 v_and_b32 v22, 1, v20
 v_lshl_add_u32 v10, v22, 1, v21
 v_and_b32 v21, 12, v20
 v_lshlrev_b32 v21, 5, v21
 v_lshl_add_u32 v21, v22, 6, v21
 v_and_b32 v22, 48, v20
 v_add_u32 v11, v21, v22
 s_mov_b32 s55, 0x3e0293ee
 s_mov_b32 s54, 0x40000
 s_lshl_b32 s47, s6, 6
 s_add_u32 s60, s47, 0x100000
 s_add_u32 s61, s47, 0x101000
 s_add_u32 s62, s47, 0x102000
 s_lshl_b32 s47, s6, 7
 s_add_u32 s56, s47, 0x0
 s_add_u32 s57, s47, 0x1000
 s_mul_i32 s47, s6, 10496
 s_add_u32 s40, s47, 0x102000
 s_lshl_b32 s58, s4, 11
 s_add_u32 s47, s47, s58
 s_add_u32 s39, s47, 0x100000
 s_lshl_b32 s42, s4, 11
 s_add_u32 s41, s42, 0x1e0000
 s_mov_b32 s43, 0x1e2000
 s_lshr_b32 s69, s4, 1
 s_mul_i32 s69, s69, 1088
 s_and_b32 s47, s4, 1
 s_lshl_b32 s47, s47, 5
 s_add_u32 s69, s69, s47
 s_lshl_b32 s47, s6, 5
 s_add_u32 s65, s47, 0x1e2000
 s_add_u32 s66, s47, 0x162000
 s_lshr_b32 s47, s6, 3
 s_lshl_b32 s47, s47, 9
 s_and_b32 s58, s6, 1
 s_lshl_b32 s58, s58, 8
 s_add_u32 s47, s47, s58
 s_and_b32 s58, s6, 6
 s_lshl_b32 s58, s58, 5
 s_add_u32 s47, s47, s58
 s_lshl_b32 s58, s4, 11
 s_add_u32 s47, s47, s58
 s_add_u32 s44, s47, 0x1e0000
 s_add_u32 s45, s47, 0x160000
 s_lshl_b32 s47, s6, 14
 s_add_u32 s37, s47, 0x3000000
 s_add_u32 s67, s37, s58
 s_add_u32 s59, s67, 8192
 s_lshl_b32 s47, s6, 12
 s_add_u32 s38, s47, 0x3e0000
 s_mov_b32 s36, 0
 s_mov_b32 s46, 0
 s_waitcnt lgkmcnt(0)
 v_mov_b32 v20, 0
 v_mov_b32 v21, 0
 v_mov_b32 v22, 0
 v_mov_b32 v23, 0
 v_mov_b32 v27, -1
 v_bfe_u32 v24, v3, 8, 1
 v_bfe_u32 v25, v3, 9, 1
 v_lshl_or_b32 v24, v24, 1, v25
 v_bfe_u32 v25, v3, 5, 1
 v_lshl_or_b32 v24, v24, 1, v25
 v_and_b32 v25, 0xd0, v3
 v_lshlrev_b32 v25, 24, v25
 v_lshl_or_b32 v24, v24, 2, v25
 v_bfe_u32 v26, v3, 8, 2
 v_bfe_u32 v25, v3, 2, 4
 v_lshl_or_b32 v26, v26, 4, v25
 v_and_b32 v25, 0xc0, v3
 v_lshl_or_b32 v26, v25, 24, v26
 buffer_store_dwordx4 v[20:23], v3, s[20:23], s39 offen offset:0 sc1
 buffer_store_dwordx4 v[20:23], v3, s[20:23], s39 offen offset:1024 sc1
 buffer_store_dwordx4 v[20:23], v3, s[20:23], s40 offen offset:0 sc1
 buffer_store_dwordx4 v[20:23], v3, s[20:23], s40 offen offset:1024 sc1
 buffer_store_dword v27, v26, s[20:23], s44 offen sc1
 buffer_store_dword v27, v26, s[20:23], s45 offen sc1
 buffer_store_dword v27, v24, s[20:23], s65 offen sc1
 buffer_store_dword v27, v24, s[20:23], s66 offen sc1
 v_and_b32 v30, 63, v0
 v_bfe_u32 v31, v30, 1, 2
 v_lshrrev_b32 v32, 5, v30
 v_xor_b32 v31, v31, v32
 v_lshlrev_b32 v31, 5, v31
 v_and_b32 v32, 1, v30
 v_lshl_add_u32 v31, v32, 4, v31
 v_xor_b32 v33, 64, v31
 v_lshrrev_b32 v32, 3, v30
 s_lshl_b32 s47, s4, 4
 v_and_b32 v34, 3, v32
 v_lshrrev_b32 v35, 2, v32
 v_lshl_add_u32 v34, v34, 1, v35
 v_add_u32 v34, s47, v34
 v_lshl_add_u32 v12, v34, 13, v31
 v_add_u32 v34, 8, v34
 v_lshl_add_u32 v13, v34, 13, v33
 v_and_b32 v34, 1, v32
 v_lshlrev_b32 v34, 6, v34
 v_and_b32 v35, 6, v32
 s_lshl_b32 s47, s4, 3
 v_add3_u32 v34, v34, v35, s47
 v_lshl_add_u32 v56, v34, 13, v31
 v_add_u32 v34, 1, v34
 v_lshl_add_u32 v57, v34, 13, v33
 v_lshrrev_b32 v34, 3, v0
 v_mul_u32_u24 v34, 1152, v34
 v_add_u32 v14, v34, v31
 v_add_u32 v34, 73728, v34
 v_add_u32 v15, v34, v33
 v_bfe_u32 v31, v30, 4, 1
 v_bfe_u32 v32, v30, 3, 1
 v_lshl_add_u32 v33, v32, 1, v31
 v_xor_b32 v33, s4, v33
 v_lshlrev_b32 v33, 5, v33
 v_lshl_add_u32 v33, v31, 9, v33
 v_lshl_add_u32 v33, v32, 10, v33
 v_bfe_u32 v31, v30, 2, 1
 v_lshl_add_u32 v33, v31, 7, v33
 v_lshrrev_b32 v31, 5, v30
 v_lshl_add_u32 v33, v31, 11, v33
 v_and_b32 v31, 3, v30
 v_lshl_add_u32 v16, v31, 3, v33
 v_add_u32 v17, 0x10000, v16
 v_add_u32 v18, 0x20000, v16
 v_lshlrev_b32 v60, 4, v0
 v_add_u32 v61, 0x10000, v60
 v_add_u32 v62, 0x20000, v60
 s_lshl_b32 s70, s6, 8
 s_mul_i32 s71, s6, 147456
 s_lshl_b32 s72, s4, 11
 s_lshl_b32 s47, s4, 4
 v_add_u32 v31, s47, v30
 s_lshr_b32 s47, s4, 1
 s_lshl_b32 s47, s47, 5
 v_add_u32 v32, s47, v31
 v_lshrrev_b32 v33, 4, v30
 v_lshlrev_b32 v33, 28, v33
 v_lshl_or_b32 v58, v31, 13, v33
 v_lshl_or_b32 v19, v32, 13, v33
 v_mul_u32_u24 v32, 1152, v32
 v_or_b32 v59, v32, v33
 s_add_u32 m0, s72, 24576
 s_add_u32 s47, s70, 0
 buffer_load_dwordx4 v56, s[8:11], s47 offen  lds
 s_add_u32 m0, s72, 25600
 s_nop 0
 buffer_load_dwordx4 v57, s[8:11], s47 offen  lds
 s_add_u32 m0, s72, 32768
 s_add_u32 s47, s70, 128
 buffer_load_dwordx4 v56, s[8:11], s47 offen  lds
 s_add_u32 m0, s72, 33792
 s_nop 0
 buffer_load_dwordx4 v57, s[8:11], s47 offen  lds
 s_add_u32 m0, s72, 40960
 s_add_u32 s47, s70, 0
 buffer_load_dwordx4 v56, s[12:15], s47 offen  lds
 s_add_u32 m0, s72, 41984
 s_nop 0
 buffer_load_dwordx4 v57, s[12:15], s47 offen  lds
 s_add_u32 m0, s72, 49152
 s_add_u32 s47, s70, 0
 buffer_load_dwordx4 v56, s[16:19], s47 offen  lds
 s_add_u32 m0, s72, 50176
 s_nop 0
 buffer_load_dwordx4 v57, s[16:19], s47 offen  lds
 s_add_u32 m0, s72, 57344
 s_add_u32 s47, s70, 128
 buffer_load_dwordx4 v56, s[16:19], s47 offen  lds
 s_add_u32 m0, s72, 58368
 s_nop 0
 buffer_load_dwordx4 v57, s[16:19], s47 offen  lds
 s_add_u32 m0, s72, 65536
 s_add_u32 s47, s70, 262144
 buffer_load_dwordx4 v56, s[8:11], s47 offen  lds
 s_add_u32 m0, s72, 66560
 s_nop 0
 buffer_load_dwordx4 v57, s[8:11], s47 offen  lds
 s_add_u32 m0, s72, 73728
 s_add_u32 s47, s70, 262272
 buffer_load_dwordx4 v56, s[8:11], s47 offen  lds
 s_add_u32 m0, s72, 74752
 s_nop 0
 buffer_load_dwordx4 v57, s[8:11], s47 offen  lds
 s_add_u32 m0, s72, 81920
 s_add_u32 s47, s70, 262144
 buffer_load_dwordx4 v56, s[12:15], s47 offen  lds
 s_add_u32 m0, s72, 82944
 s_nop 0
 buffer_load_dwordx4 v57, s[12:15], s47 offen  lds
 s_waitcnt vmcnt(14)
 s_waitcnt lgkmcnt(0)
 s_barrier
 s_getreg_b32 s73, hwreg(HW_REG_XCC_ID, 0, 3)
 s_lshl_b32 s73, s73, 3
 s_lshl_b64 s[74:75], 1, s73
 v_mov_b32 v64, s74
 v_mov_b32 v65, s75
 v_mov_b32 v66, 0x7ff00000
 v_cmp_eq_u32 vcc, 0, v0
 s_nop 1
 v_cndmask_b32 v66, v66, v7, vcc
 buffer_atomic_add_x2 v[64:65], v66, s[28:31], 0 offen offset:8
 s_add_u32 m0, s72, 90112
 s_add_u32 s47, s70, 262144
 buffer_load_dwordx4 v56, s[16:19], s47 offen  lds
 s_add_u32 m0, s72, 91136
 s_nop 0
 buffer_load_dwordx4 v57, s[16:19], s47 offen  lds
 ds_read_b64_tr_b16 v[72:73], v16 offset:24576
 ds_read_b64_tr_b16 v[74:75], v16 offset:24832
 ds_read_b64_tr_b16 v[76:77], v16 offset:28672
 ds_read_b64_tr_b16 v[78:79], v16 offset:28928
 s_waitcnt vmcnt(15)
 s_waitcnt lgkmcnt(0)
 s_barrier
 s_add_u32 m0, s72, 98304
 s_add_u32 s47, s70, 262272
 buffer_load_dwordx4 v56, s[16:19], s47 offen  lds
 s_add_u32 m0, s72, 99328
 s_nop 0
 buffer_load_dwordx4 v57, s[16:19], s47 offen  lds
 ds_read_b64_tr_b16 v[80:81], v16 offset:32768
 ds_read_b64_tr_b16 v[82:83], v16 offset:33024
 ds_read_b64_tr_b16 v[84:85], v16 offset:36864
 ds_read_b64_tr_b16 v[86:87], v16 offset:37120
 s_waitcnt vmcnt(15)
 s_waitcnt lgkmcnt(0)
 s_barrier
 s_add_u32 m0, s72, 106496
 s_add_u32 s47, s70, 1048576
 buffer_load_dwordx4 v56, s[8:11], s47 offen  lds
 s_add_u32 m0, s72, 107520
 s_nop 0
 buffer_load_dwordx4 v57, s[8:11], s47 offen  lds
 ds_read_b64_tr_b16 v[88:89], v16 offset:40960
 ds_read_b64_tr_b16 v[90:91], v16 offset:41216
 ds_read_b64_tr_b16 v[92:93], v16 offset:45056
 ds_read_b64_tr_b16 v[94:95], v16 offset:45312
 s_waitcnt vmcnt(15)
 s_waitcnt lgkmcnt(0)
 s_barrier
 s_add_u32 m0, s72, 114688
 s_add_u32 s47, s70, 1048704
 buffer_load_dwordx4 v56, s[8:11], s47 offen  lds
 s_add_u32 m0, s72, 115712
 s_nop 0
 buffer_load_dwordx4 v57, s[8:11], s47 offen  lds
 ds_read_b64_tr_b16 v[96:97], v16 offset:49152
 ds_read_b64_tr_b16 v[98:99], v16 offset:49408
 ds_read_b64_tr_b16 v[100:101], v16 offset:53248
 ds_read_b64_tr_b16 v[102:103], v16 offset:53504
 s_waitcnt vmcnt(15)
 s_waitcnt lgkmcnt(0)
 s_barrier
 s_add_u32 m0, s72, 122880
 s_add_u32 s47, s70, 1048576
 buffer_load_dwordx4 v56, s[12:15], s47 offen  lds
 s_add_u32 m0, s72, 123904
 s_nop 0
 buffer_load_dwordx4 v57, s[12:15], s47 offen  lds
 v_lshrrev_b32 v68, 4, v3
 v_bfe_u32 v69, v68, 2, 2
 v_and_b32 v70, 1, v68
 v_lshl_add_u32 v69, v69, 1, v70
 v_mul_u32_u24 v69, 1152, v69
 v_and_b32 v70, 48, v68
 v_and_b32 v71, 2, v68
 v_lshl_add_u32 v71, v71, 2, v70
 v_lshl_add_u32 v71, v71, 1, v69
 v_add_u32 v69, v70, v69
 s_lshr_b32 s47, s4, 1
 s_lshl_b32 s47, s47, 8
 s_and_b32 s58, s4, 1
 s_lshl_b32 s58, s58, 6
 s_add_u32 s47, s47, s58
 buffer_load_dwordx4 v[20:23], v69, s[32:35], s47 offen offset:0
 buffer_load_dwordx4 v[24:27], v69, s[32:35], s47 offen offset:128
 buffer_load_dwordx4 v[28:31], v69, s[32:35], s47 offen offset:512
 buffer_load_dwordx4 v[32:35], v69, s[32:35], s47 offen offset:640
 buffer_load_dwordx4 v[36:39], v71, s[32:35], 0 offen offset:1024
 ds_read_b64_tr_b16 v[104:105], v16 offset:57344
 ds_read_b64_tr_b16 v[106:107], v16 offset:57600
 ds_read_b64_tr_b16 v[108:109], v16 offset:61440
 ds_read_b64_tr_b16 v[110:111], v16 offset:61696
 s_waitcnt vmcnt(20)
 s_waitcnt lgkmcnt(0)
 s_barrier
 s_add_u32 m0, s72, 131072
 s_add_u32 s47, s70, 1048576
 buffer_load_dwordx4 v56, s[16:19], s47 offen  lds
 s_add_u32 m0, s72, 132096
 s_nop 0
 buffer_load_dwordx4 v57, s[16:19], s47 offen  lds
 ds_read_b64_tr_b16 v[112:113], v17 offset:0
 ds_read_b64_tr_b16 v[114:115], v17 offset:256
 ds_read_b64_tr_b16 v[116:117], v17 offset:4096
 ds_read_b64_tr_b16 v[118:119], v17 offset:4352
 s_waitcnt vmcnt(20)
 s_waitcnt lgkmcnt(0)
 s_barrier
 s_add_u32 m0, s72, 139264
 s_add_u32 s47, s70, 1048704
 buffer_load_dwordx4 v56, s[16:19], s47 offen  lds
 s_add_u32 m0, s72, 140288
 s_nop 0
 buffer_load_dwordx4 v57, s[16:19], s47 offen  lds
 ds_read_b64_tr_b16 v[120:121], v17 offset:8192
 ds_read_b64_tr_b16 v[122:123], v17 offset:8448
 ds_read_b64_tr_b16 v[124:125], v17 offset:12288
 ds_read_b64_tr_b16 v[126:127], v17 offset:12544
 s_waitcnt vmcnt(20)
 s_waitcnt lgkmcnt(0)
 s_barrier
 s_add_u32 m0, s72, 147456
 s_add_u32 s47, s70, 1310720
 buffer_load_dwordx4 v56, s[8:11], s47 offen  lds
 s_add_u32 m0, s72, 148480
 s_nop 0
 buffer_load_dwordx4 v57, s[8:11], s47 offen  lds
 ds_read_b64_tr_b16 v[128:129], v17 offset:16384
 ds_read_b64_tr_b16 v[130:131], v17 offset:16640
 ds_read_b64_tr_b16 v[132:133], v17 offset:20480
 ds_read_b64_tr_b16 v[134:135], v17 offset:20736
 s_waitcnt vmcnt(19)
 s_waitcnt lgkmcnt(0)
 s_barrier
 s_add_u32 m0, s72, 155648
 s_add_u32 s47, s70, 1310848
 buffer_load_dwordx4 v56, s[8:11], s47 offen  lds
 s_add_u32 m0, s72, 156672
 s_nop 0
 buffer_load_dwordx4 v57, s[8:11], s47 offen  lds
 ds_read_b64_tr_b16 v[136:137], v17 offset:24576
 ds_read_b64_tr_b16 v[138:139], v17 offset:24832
 ds_read_b64_tr_b16 v[140:141], v17 offset:28672
 ds_read_b64_tr_b16 v[142:143], v17 offset:28928
 s_waitcnt vmcnt(19)
 s_waitcnt lgkmcnt(0)
 s_barrier
 s_add_u32 m0, s72, 24576
 s_add_u32 s47, s70, 1310720
 buffer_load_dwordx4 v56, s[12:15], s47 offen  lds
 s_add_u32 m0, s72, 25600
 s_nop 0
 buffer_load_dwordx4 v57, s[12:15], s47 offen  lds
 ds_read_b64_tr_b16 v[144:145], v17 offset:32768
 ds_read_b64_tr_b16 v[146:147], v17 offset:33024
 ds_read_b64_tr_b16 v[148:149], v17 offset:36864
 ds_read_b64_tr_b16 v[150:151], v17 offset:37120
 s_waitcnt vmcnt(19)
 s_waitcnt lgkmcnt(0)
 s_barrier
 s_add_u32 m0, s72, 32768
 s_add_u32 s47, s70, 1310720
 buffer_load_dwordx4 v56, s[16:19], s47 offen  lds
 s_add_u32 m0, s72, 33792
 s_nop 0
 buffer_load_dwordx4 v57, s[16:19], s47 offen  lds
 ds_read_b64_tr_b16 v[152:153], v17 offset:40960
 ds_read_b64_tr_b16 v[154:155], v17 offset:41216
 ds_read_b64_tr_b16 v[156:157], v17 offset:45056
 ds_read_b64_tr_b16 v[158:159], v17 offset:45312
 s_waitcnt vmcnt(19)
 s_waitcnt lgkmcnt(0)
 s_barrier
 s_add_u32 m0, s72, 40960
 s_add_u32 s47, s70, 1310848
 buffer_load_dwordx4 v56, s[16:19], s47 offen  lds
 s_add_u32 m0, s72, 41984
 s_nop 0
 buffer_load_dwordx4 v57, s[16:19], s47 offen  lds
 ds_read_b64_tr_b16 v[160:161], v17 offset:49152
 ds_read_b64_tr_b16 v[162:163], v17 offset:49408
 ds_read_b64_tr_b16 v[164:165], v17 offset:53248
 ds_read_b64_tr_b16 v[166:167], v17 offset:53504
 s_waitcnt vmcnt(19)
 s_waitcnt lgkmcnt(0)
 s_barrier
 s_add_u32 m0, s72, 49152
 s_add_u32 s47, s70, 2097152
 buffer_load_dwordx4 v56, s[8:11], s47 offen  lds
 s_add_u32 m0, s72, 50176
 s_nop 0
 buffer_load_dwordx4 v57, s[8:11], s47 offen  lds
 ds_read_b64_tr_b16 v[168:169], v17 offset:57344
 ds_read_b64_tr_b16 v[170:171], v17 offset:57600
 ds_read_b64_tr_b16 v[172:173], v17 offset:61440
 ds_read_b64_tr_b16 v[174:175], v17 offset:61696
 s_waitcnt vmcnt(14)
 s_waitcnt lgkmcnt(0)
 s_barrier
 s_add_u32 m0, s72, 57344
 s_add_u32 s47, s70, 2097280
 buffer_load_dwordx4 v56, s[8:11], s47 offen  lds
 s_add_u32 m0, s72, 58368
 s_nop 0
 buffer_load_dwordx4 v57, s[8:11], s47 offen  lds
 ds_read_b64_tr_b16 v[176:177], v18 offset:0
 ds_read_b64_tr_b16 v[178:179], v18 offset:256
 ds_read_b64_tr_b16 v[180:181], v18 offset:4096
 ds_read_b64_tr_b16 v[182:183], v18 offset:4352
 s_waitcnt vmcnt(14)
 s_waitcnt lgkmcnt(0)
 s_barrier
 s_add_u32 m0, s72, 65536
 s_add_u32 s47, s70, 2097152
 buffer_load_dwordx4 v56, s[12:15], s47 offen  lds
 s_add_u32 m0, s72, 66560
 s_nop 0
 buffer_load_dwordx4 v57, s[12:15], s47 offen  lds
 v_mov_b32 v68, 0x05040100
 v_mov_b32 v69, 0x07060302
 v_cndmask_b32 v70, v68, v69, s[48:49]
 v_perm_b32 v20, v24, v20, v70
 v_perm_b32 v21, v25, v21, v70
 v_perm_b32 v22, v26, v22, v70
 v_perm_b32 v23, v27, v23, v70
 v_perm_b32 v28, v32, v28, v70
 v_perm_b32 v29, v33, v29, v70
 v_perm_b32 v30, v34, v30, v70
 v_perm_b32 v31, v35, v31, v70
 v_perm_b32 v24, v37, v36, v68
 v_perm_b32 v25, v39, v38, v68
 v_perm_b32 v26, v37, v36, v69
 v_perm_b32 v27, v39, v38, v69
 ds_write_b128 v60, v[20:23]
 ds_write_b128 v60, v[28:31] offset:4096
 ds_write_b128 v3, v[24:27] offset:8192
 ds_read_b64_tr_b16 v[184:185], v18 offset:8192
 ds_read_b64_tr_b16 v[186:187], v18 offset:8448
 ds_read_b64_tr_b16 v[188:189], v18 offset:12288
 ds_read_b64_tr_b16 v[190:191], v18 offset:12544
 s_waitcnt vmcnt(14)
 s_waitcnt lgkmcnt(0)
 s_barrier
 s_add_u32 m0, s72, 73728
 s_add_u32 s47, s70, 2097152
 buffer_load_dwordx4 v56, s[16:19], s47 offen  lds
 s_add_u32 m0, s72, 74752
 s_nop 0
 buffer_load_dwordx4 v57, s[16:19], s47 offen  lds
 ds_read_b64_tr_b16 v[192:193], v18 offset:16384
 ds_read_b64_tr_b16 v[194:195], v18 offset:16640
 ds_read_b64_tr_b16 v[196:197], v18 offset:20480
 ds_read_b64_tr_b16 v[198:199], v18 offset:20736
 s_waitcnt vmcnt(14)
 s_waitcnt lgkmcnt(0)
 s_barrier
 s_add_u32 m0, s72, 81920
 s_add_u32 s47, s70, 2097280
 buffer_load_dwordx4 v56, s[16:19], s47 offen  lds
 s_add_u32 m0, s72, 82944
 s_nop 0
 buffer_load_dwordx4 v57, s[16:19], s47 offen  lds
 ds_read_b64_tr_b16 v[200:201], v18 offset:24576
 ds_read_b64_tr_b16 v[202:203], v18 offset:24832
 ds_read_b64_tr_b16 v[204:205], v18 offset:28672
 ds_read_b64_tr_b16 v[206:207], v18 offset:28928
 s_waitcnt vmcnt(14)
 s_waitcnt lgkmcnt(0)
 s_barrier
 s_add_u32 m0, s72, 90112
 s_add_u32 s47, s70, 2359296
 buffer_load_dwordx4 v56, s[8:11], s47 offen  lds
 s_add_u32 m0, s72, 91136
 s_nop 0
 buffer_load_dwordx4 v57, s[8:11], s47 offen  lds
 ds_read_b64_tr_b16 v[208:209], v16 offset:24576
 ds_read_b64_tr_b16 v[210:211], v16 offset:24832
 ds_read_b64_tr_b16 v[212:213], v16 offset:28672
 ds_read_b64_tr_b16 v[214:215], v16 offset:28928
 s_waitcnt vmcnt(14)
 s_waitcnt lgkmcnt(0)
 s_barrier
 s_add_u32 m0, s72, 98304
 s_add_u32 s47, s70, 2359424
 buffer_load_dwordx4 v56, s[8:11], s47 offen  lds
 s_add_u32 m0, s72, 99328
 s_nop 0
 buffer_load_dwordx4 v57, s[8:11], s47 offen  lds
 ds_read_b64_tr_b16 v[216:217], v16 offset:32768
 ds_read_b64_tr_b16 v[218:219], v16 offset:33024
 ds_read_b64_tr_b16 v[220:221], v16 offset:36864
 ds_read_b64_tr_b16 v[222:223], v16 offset:37120
 s_waitcnt vmcnt(14)
 s_waitcnt lgkmcnt(0)
 s_barrier
 s_add_u32 m0, s72, 106496
 s_add_u32 s47, s70, 2359296
 buffer_load_dwordx4 v56, s[12:15], s47 offen  lds
 s_add_u32 m0, s72, 107520
 s_nop 0
 buffer_load_dwordx4 v57, s[12:15], s47 offen  lds
 ds_read_b64_tr_b16 v[224:225], v16 offset:40960
 ds_read_b64_tr_b16 v[226:227], v16 offset:41216
 ds_read_b64_tr_b16 v[228:229], v16 offset:45056
 ds_read_b64_tr_b16 v[230:231], v16 offset:45312
 s_waitcnt vmcnt(14)
 s_waitcnt lgkmcnt(0)
 s_barrier
 s_add_u32 m0, s72, 114688
 s_add_u32 s47, s70, 2359296
 buffer_load_dwordx4 v56, s[16:19], s47 offen  lds
 s_add_u32 m0, s72, 115712
 s_nop 0
 buffer_load_dwordx4 v57, s[16:19], s47 offen  lds
 ds_read_b64_tr_b16 v[232:233], v16 offset:49152
 ds_read_b64_tr_b16 v[234:235], v16 offset:49408
 ds_read_b64_tr_b16 v[236:237], v16 offset:53248
 ds_read_b64_tr_b16 v[238:239], v16 offset:53504
 s_waitcnt vmcnt(14)
 s_waitcnt lgkmcnt(0)
 s_barrier
 s_add_u32 m0, s72, 122880
 s_add_u32 s47, s70, 2359424
 buffer_load_dwordx4 v56, s[16:19], s47 offen  lds
 s_add_u32 m0, s72, 123904
 s_nop 0
 buffer_load_dwordx4 v57, s[16:19], s47 offen  lds
 ds_read_b64_tr_b16 v[240:241], v16 offset:57344
 ds_read_b64_tr_b16 v[242:243], v16 offset:57600
 ds_read_b64_tr_b16 v[244:245], v16 offset:61440
 ds_read_b64_tr_b16 v[246:247], v16 offset:61696
 s_waitcnt vmcnt(14)
 s_waitcnt lgkmcnt(0)
 s_barrier
 s_add_u32 m0, s72, 131072
 s_add_u32 s47, s70, 3145728
 buffer_load_dwordx4 v56, s[8:11], s47 offen  lds
 s_add_u32 m0, s72, 132096
 s_nop 0
 buffer_load_dwordx4 v57, s[8:11], s47 offen  lds
 ds_read_b64_tr_b16 v[248:249], v17 offset:0
 ds_read_b64_tr_b16 v[250:251], v17 offset:256
 ds_read_b64_tr_b16 v[252:253], v17 offset:4096
 ds_read_b64_tr_b16 v[254:255], v17 offset:4352
 s_waitcnt vmcnt(14)
 s_waitcnt lgkmcnt(0)
 s_barrier
 s_add_u32 m0, s72, 139264
 s_add_u32 s47, s70, 3145856
 buffer_load_dwordx4 v56, s[8:11], s47 offen  lds
 s_add_u32 m0, s72, 140288
 s_nop 0
 buffer_load_dwordx4 v57, s[8:11], s47 offen  lds
 ds_read_b64_tr_b16 a[0:1], v17 offset:8192
 ds_read_b64_tr_b16 a[2:3], v17 offset:8448
 ds_read_b64_tr_b16 a[4:5], v17 offset:12288
 ds_read_b64_tr_b16 a[6:7], v17 offset:12544
 s_waitcnt vmcnt(14)
 s_waitcnt lgkmcnt(0)
 s_barrier
 s_add_u32 m0, s72, 147456
 s_add_u32 s47, s70, 3145728
 buffer_load_dwordx4 v56, s[12:15], s47 offen  lds
 s_add_u32 m0, s72, 148480
 s_nop 0
 buffer_load_dwordx4 v57, s[12:15], s47 offen  lds
 ds_read_b64_tr_b16 a[8:9], v17 offset:16384
 ds_read_b64_tr_b16 a[10:11], v17 offset:16640
 ds_read_b64_tr_b16 a[12:13], v17 offset:20480
 ds_read_b64_tr_b16 a[14:15], v17 offset:20736
 s_waitcnt vmcnt(14)
 s_waitcnt lgkmcnt(0)
 s_barrier
 s_add_u32 m0, s72, 155648
 s_add_u32 s47, s70, 3145728
 buffer_load_dwordx4 v56, s[16:19], s47 offen  lds
 s_add_u32 m0, s72, 156672
 s_nop 0
 buffer_load_dwordx4 v57, s[16:19], s47 offen  lds
 ds_read_b64_tr_b16 a[16:17], v17 offset:24576
 ds_read_b64_tr_b16 a[18:19], v17 offset:24832
 ds_read_b64_tr_b16 a[20:21], v17 offset:28672
 ds_read_b64_tr_b16 a[22:23], v17 offset:28928
 s_waitcnt vmcnt(14)
 s_waitcnt lgkmcnt(0)
 s_barrier
 s_add_u32 m0, s72, 24576
 s_add_u32 s47, s70, 3145856
 buffer_load_dwordx4 v56, s[16:19], s47 offen  lds
 s_add_u32 m0, s72, 25600
 s_nop 0
 buffer_load_dwordx4 v57, s[16:19], s47 offen  lds
 ds_read_b64_tr_b16 a[24:25], v17 offset:32768
 ds_read_b64_tr_b16 a[26:27], v17 offset:33024
 ds_read_b64_tr_b16 a[28:29], v17 offset:36864
 ds_read_b64_tr_b16 a[30:31], v17 offset:37120
 s_waitcnt vmcnt(14)
 s_waitcnt lgkmcnt(0)
 s_barrier
 s_add_u32 m0, s72, 32768
 s_add_u32 s47, s70, 3407872
 buffer_load_dwordx4 v56, s[8:11], s47 offen  lds
 s_add_u32 m0, s72, 33792
 s_nop 0
 buffer_load_dwordx4 v57, s[8:11], s47 offen  lds
 ds_read_b64_tr_b16 a[32:33], v17 offset:40960
 ds_read_b64_tr_b16 a[34:35], v17 offset:41216
 ds_read_b64_tr_b16 a[36:37], v17 offset:45056
 ds_read_b64_tr_b16 a[38:39], v17 offset:45312
 s_waitcnt vmcnt(14)
 s_waitcnt lgkmcnt(0)
 s_barrier
 s_add_u32 m0, s72, 40960
 s_add_u32 s47, s70, 3408000
 buffer_load_dwordx4 v56, s[8:11], s47 offen  lds
 s_add_u32 m0, s72, 41984
 s_nop 0
 buffer_load_dwordx4 v57, s[8:11], s47 offen  lds
 ds_read_b64_tr_b16 a[40:41], v17 offset:49152
 ds_read_b64_tr_b16 a[42:43], v17 offset:49408
 ds_read_b64_tr_b16 a[44:45], v17 offset:53248
 ds_read_b64_tr_b16 a[46:47], v17 offset:53504
 s_waitcnt vmcnt(14)
 s_waitcnt lgkmcnt(0)
 s_barrier
 s_add_u32 m0, s72, 49152
 s_add_u32 s47, s70, 3407872
 buffer_load_dwordx4 v56, s[12:15], s47 offen  lds
 s_add_u32 m0, s72, 50176
 s_nop 0
 buffer_load_dwordx4 v57, s[12:15], s47 offen  lds
 ds_read_b64_tr_b16 a[48:49], v17 offset:57344
 ds_read_b64_tr_b16 a[50:51], v17 offset:57600
 ds_read_b64_tr_b16 a[52:53], v17 offset:61440
 ds_read_b64_tr_b16 a[54:55], v17 offset:61696
 s_waitcnt vmcnt(14)
 s_waitcnt lgkmcnt(0)
 s_barrier
 s_add_u32 m0, s72, 57344
 s_add_u32 s47, s70, 3407872
 buffer_load_dwordx4 v56, s[16:19], s47 offen  lds
 s_add_u32 m0, s72, 58368
 s_nop 0
 buffer_load_dwordx4 v57, s[16:19], s47 offen  lds
 v_min_u32 v65, 16, v3
 v_lshlrev_b32 v65, 24, v65
 buffer_load_dwordx4 v[68:71], v65, s[28:31], 0 offen sc1
 ds_read_b64_tr_b16 a[56:57], v18 offset:0
 ds_read_b64_tr_b16 a[58:59], v18 offset:256
 ds_read_b64_tr_b16 a[60:61], v18 offset:4096
 ds_read_b64_tr_b16 a[62:63], v18 offset:4352
 s_waitcnt vmcnt(15)
 s_waitcnt lgkmcnt(0)
 s_barrier
 s_add_u32 m0, s72, 65536
 s_add_u32 s47, s70, 3408000
 buffer_load_dwordx4 v56, s[16:19], s47 offen  lds
 s_add_u32 m0, s72, 66560
 s_nop 0
 buffer_load_dwordx4 v57, s[16:19], s47 offen  lds
 ds_read_b64_tr_b16 a[64:65], v18 offset:8192
 ds_read_b64_tr_b16 a[66:67], v18 offset:8448
 ds_read_b64_tr_b16 a[68:69], v18 offset:12288
 ds_read_b64_tr_b16 a[70:71], v18 offset:12544
 s_waitcnt vmcnt(15)
 s_waitcnt lgkmcnt(0)
 s_barrier
 s_add_u32 m0, s72, 73728
 s_add_u32 s47, s70, 4194304
 buffer_load_dwordx4 v12, s[8:11], s47 offen  lds
 s_add_u32 m0, s72, 74752
 s_nop 0
 buffer_load_dwordx4 v13, s[8:11], s47 offen  lds
 ds_read_b64_tr_b16 a[72:73], v18 offset:16384
 ds_read_b64_tr_b16 a[74:75], v18 offset:16640
 ds_read_b64_tr_b16 a[76:77], v18 offset:20480
 ds_read_b64_tr_b16 a[78:79], v18 offset:20736
 s_waitcnt vmcnt(15)
 s_waitcnt lgkmcnt(0)
 s_barrier
 s_add_u32 m0, s72, 81920
 s_add_u32 s47, s70, 4194432
 buffer_load_dwordx4 v12, s[8:11], s47 offen  lds
 s_add_u32 m0, s72, 82944
 s_nop 0
 buffer_load_dwordx4 v13, s[8:11], s47 offen  lds
 ds_read_b64_tr_b16 a[80:81], v18 offset:24576
 ds_read_b64_tr_b16 a[82:83], v18 offset:24832
 ds_read_b64_tr_b16 a[84:85], v18 offset:28672
 ds_read_b64_tr_b16 a[86:87], v18 offset:28928
 s_waitcnt vmcnt(15)
 s_waitcnt lgkmcnt(0)
 s_barrier
 s_add_u32 m0, s72, 90112
 s_add_u32 s47, s70, 4194304
 buffer_load_dwordx4 v12, s[12:15], s47 offen  lds
 s_add_u32 m0, s72, 91136
 s_nop 0
 buffer_load_dwordx4 v13, s[12:15], s47 offen  lds
 ds_read_b64_tr_b16 a[88:89], v16 offset:24576
 ds_read_b64_tr_b16 a[90:91], v16 offset:24832
 ds_read_b64_tr_b16 a[92:93], v16 offset:28672
 ds_read_b64_tr_b16 a[94:95], v16 offset:28928
 s_waitcnt vmcnt(15)
 s_waitcnt lgkmcnt(0)
 s_barrier
 s_add_u32 m0, s72, 98304
 s_add_u32 s47, s70, 4194304
 buffer_load_dwordx4 v12, s[16:19], s47 offen  lds
 s_add_u32 m0, s72, 99328
 s_nop 0
 buffer_load_dwordx4 v13, s[16:19], s47 offen  lds
 ds_read_b64_tr_b16 a[96:97], v16 offset:32768
 ds_read_b64_tr_b16 a[98:99], v16 offset:33024
 ds_read_b64_tr_b16 a[100:101], v16 offset:36864
 ds_read_b64_tr_b16 a[102:103], v16 offset:37120
 s_waitcnt vmcnt(15)
 s_waitcnt lgkmcnt(0)
 s_barrier
 s_add_u32 m0, s72, 106496
 s_add_u32 s47, s70, 4194432
 buffer_load_dwordx4 v12, s[16:19], s47 offen  lds
 s_add_u32 m0, s72, 107520
 s_nop 0
 buffer_load_dwordx4 v13, s[16:19], s47 offen  lds
 ds_read_b64_tr_b16 a[104:105], v16 offset:40960
 ds_read_b64_tr_b16 a[106:107], v16 offset:41216
 ds_read_b64_tr_b16 a[108:109], v16 offset:45056
 ds_read_b64_tr_b16 a[110:111], v16 offset:45312
 s_waitcnt vmcnt(15)
 s_waitcnt lgkmcnt(0)
 s_barrier
 s_add_u32 m0, s72, 114688
 s_add_u32 s47, s71, 0
 buffer_load_dwordx4 v14, s[24:27], s47 offen  lds
 s_add_u32 m0, s72, 115712
 s_nop 0
 buffer_load_dwordx4 v15, s[24:27], s47 offen  lds
 ds_read_b64_tr_b16 a[112:113], v16 offset:49152
 ds_read_b64_tr_b16 a[114:115], v16 offset:49408
 ds_read_b64_tr_b16 a[116:117], v16 offset:53248
 ds_read_b64_tr_b16 a[118:119], v16 offset:53504
 s_waitcnt vmcnt(15)
 s_waitcnt lgkmcnt(0)
 s_barrier
 s_add_u32 m0, s72, 122880
 s_add_u32 s47, s71, 128
 buffer_load_dwordx4 v14, s[24:27], s47 offen  lds
 s_add_u32 m0, s72, 123904
 s_nop 0
 buffer_load_dwordx4 v15, s[24:27], s47 offen  lds
 ds_read_b64_tr_b16 a[120:121], v16 offset:57344
 ds_read_b64_tr_b16 a[122:123], v16 offset:57600
 ds_read_b64_tr_b16 a[124:125], v16 offset:61440
 ds_read_b64_tr_b16 a[126:127], v16 offset:61696
 s_waitcnt vmcnt(14)
 s_waitcnt lgkmcnt(0)
 s_barrier
 s_add_u32 m0, s72, 131072
 s_add_u32 s47, s71, 256
 buffer_load_dwordx4 v14, s[24:27], s47 offen  lds
 s_add_u32 m0, s72, 132096
 s_nop 0
 buffer_load_dwordx4 v15, s[24:27], s47 offen  lds
 ds_read_b64_tr_b16 a[128:129], v17 offset:0
 ds_read_b64_tr_b16 a[130:131], v17 offset:256
 ds_read_b64_tr_b16 a[132:133], v17 offset:4096
 ds_read_b64_tr_b16 a[134:135], v17 offset:4352
 s_waitcnt vmcnt(14)
 s_waitcnt lgkmcnt(0)
 s_barrier
 s_add_u32 m0, s72, 139264
 s_add_u32 s47, s71, 384
 buffer_load_dwordx4 v14, s[24:27], s47 offen  lds
 s_add_u32 m0, s72, 140288
 s_nop 0
 buffer_load_dwordx4 v15, s[24:27], s47 offen  lds
 s_branch Lhsc_41
Lhs_40:
 buffer_load_dwordx4 v[68:71], v65, s[28:31], 0 offen sc1
 s_waitcnt vmcnt(0)
Lhsc_41:
 v_sad_u8 v69, v70, 0, 0
 v_sad_u8 v69, v71, 0, v69
 v_lshrrev_b32 v69, 5, v69
 v_min_u32 v68, v68, v69
 v_cmp_ne_u32 vcc, 0, v68
 s_cbranch_vccnz Lhsok_42
 s_sub_u32 s54, s54, 1
 s_cbranch_scc0 Lhs_40
 s_endpgm
Lhsok_42:
 v_readfirstlane_b32 s74, v70
 v_readfirstlane_b32 s75, v71
 buffer_load_dwordx4 v[20:23], v3, s[20:23], s39 offen offset:0 sc1
 buffer_load_dwordx4 v[20:23], v3, s[20:23], s39 offen offset:1024 sc1
 buffer_load_dwordx4 v[20:23], v3, s[20:23], s40 offen offset:0 sc1
 buffer_load_dwordx4 v[20:23], v3, s[20:23], s40 offen offset:1024 sc1
 v_lshlrev_b32 v67, 6, v0
 ds_read_b64_tr_b16 a[136:137], v17 offset:8192
 ds_read_b64_tr_b16 a[138:139], v17 offset:8448
 ds_read_b64_tr_b16 a[140:141], v17 offset:12288
 ds_read_b64_tr_b16 a[142:143], v17 offset:12544
 s_waitcnt vmcnt(18)
 s_waitcnt lgkmcnt(0)
 s_barrier
 s_add_u32 m0, s72, 147456
 s_add_u32 s47, s71, 512
 buffer_load_dwordx4 v14, s[24:27], s47 offen  lds
 s_add_u32 m0, s72, 148480
 s_nop 0
 buffer_load_dwordx4 v15, s[24:27], s47 offen  lds
 ds_read_b64_tr_b16 a[144:145], v17 offset:16384
 ds_read_b64_tr_b16 a[146:147], v17 offset:16640
 ds_read_b64_tr_b16 a[148:149], v17 offset:20480
 ds_read_b64_tr_b16 a[150:151], v17 offset:20736
 s_waitcnt vmcnt(18)
 s_waitcnt lgkmcnt(0)
 s_barrier
 s_add_u32 m0, s72, 155648
 s_add_u32 s47, s71, 640
 buffer_load_dwordx4 v14, s[24:27], s47 offen  lds
 s_add_u32 m0, s72, 156672
 s_nop 0
 buffer_load_dwordx4 v15, s[24:27], s47 offen  lds
 ds_read_b64_tr_b16 a[152:153], v17 offset:24576
 ds_read_b64_tr_b16 a[154:155], v17 offset:24832
 ds_read_b64_tr_b16 a[156:157], v17 offset:28672
 ds_read_b64_tr_b16 a[158:159], v17 offset:28928
 s_waitcnt vmcnt(18)
 s_waitcnt lgkmcnt(0)
 s_barrier
 s_add_u32 m0, s72, 24576
 s_add_u32 s47, s71, 768
 buffer_load_dwordx4 v14, s[24:27], s47 offen  lds
 s_add_u32 m0, s72, 25600
 s_nop 0
 buffer_load_dwordx4 v15, s[24:27], s47 offen  lds
 ds_read_b64_tr_b16 a[160:161], v17 offset:32768
 ds_read_b64_tr_b16 a[162:163], v17 offset:33024
 ds_read_b64_tr_b16 a[164:165], v17 offset:36864
 ds_read_b64_tr_b16 a[166:167], v17 offset:37120
 s_waitcnt vmcnt(18)
 s_waitcnt lgkmcnt(0)
 s_barrier
 s_add_u32 m0, s72, 32768
 s_add_u32 s47, s71, 896
 buffer_load_dwordx4 v14, s[24:27], s47 offen  lds
 s_add_u32 m0, s72, 33792
 s_nop 0
 buffer_load_dwordx4 v15, s[24:27], s47 offen  lds
 ds_read_b64_tr_b16 a[168:169], v17 offset:40960
 ds_read_b64_tr_b16 a[170:171], v17 offset:41216
 ds_read_b64_tr_b16 a[172:173], v17 offset:45056
 ds_read_b64_tr_b16 a[174:175], v17 offset:45312
 s_waitcnt vmcnt(18)
 s_waitcnt lgkmcnt(0)
 s_barrier
 s_add_u32 m0, s72, 40960
 s_add_u32 s47, s71, 37760
 buffer_load_dwordx4 v14, s[24:27], s47 offen  lds
 s_add_u32 m0, s72, 41984
 s_nop 0
 buffer_load_dwordx4 v15, s[24:27], s47 offen  lds
 ds_read_b64_tr_b16 a[176:177], v17 offset:49152
 ds_read_b64_tr_b16 a[178:179], v17 offset:49408
 ds_read_b64_tr_b16 a[180:181], v17 offset:53248
 ds_read_b64_tr_b16 a[182:183], v17 offset:53504
 s_waitcnt vmcnt(18)
 s_waitcnt lgkmcnt(0)
 s_barrier
 s_add_u32 m0, s72, 49152
 s_add_u32 s47, s71, 1024
 buffer_load_dwordx4 v14, s[24:27], s47 offen  lds
 s_add_u32 m0, s72, 50176
 s_nop 0
 buffer_load_dwordx4 v15, s[24:27], s47 offen  lds
 ds_read_b64_tr_b16 a[184:185], v17 offset:57344
 ds_read_b64_tr_b16 a[186:187], v17 offset:57600
 ds_read_b64_tr_b16 a[188:189], v17 offset:61440
 ds_read_b64_tr_b16 a[190:191], v17 offset:61696
 s_waitcnt vmcnt(18)
 s_waitcnt lgkmcnt(0)
 s_barrier
 s_add_u32 m0, s72, 57344
 s_add_u32 s47, s70, 2097280
 buffer_load_dwordx4 v56, s[12:15], s47 offen  lds
 s_add_u32 m0, s72, 58368
 s_nop 0
 buffer_load_dwordx4 v57, s[12:15], s47 offen  lds
 ds_read_b64_tr_b16 a[192:193], v18 offset:0
 ds_read_b64_tr_b16 a[194:195], v18 offset:256
 ds_read_b64_tr_b16 a[196:197], v18 offset:4096
 ds_read_b64_tr_b16 a[198:199], v18 offset:4352
 s_waitcnt vmcnt(18)
 s_waitcnt lgkmcnt(0)
 s_barrier
 s_add_u32 m0, s72, 65536
 s_add_u32 s47, s70, 2359424
 buffer_load_dwordx4 v56, s[12:15], s47 offen  lds
 s_add_u32 m0, s72, 66560
 s_nop 0
 buffer_load_dwordx4 v57, s[12:15], s47 offen  lds
 s_lshl_b32 s47, s6, 2
 s_add_u32 s47, s47, 0x4000
 v_mov_b32 v64, 1
 buffer_store_dword v64, v66, s[20:23], s47 offen
 ds_read_b64_tr_b16 a[200:201], v18 offset:8192
 ds_read_b64_tr_b16 a[202:203], v18 offset:8448
 ds_read_b64_tr_b16 a[204:205], v18 offset:12288
 ds_read_b64_tr_b16 a[206:207], v18 offset:12544
 s_waitcnt vmcnt(15)
 s_waitcnt lgkmcnt(0)
 s_barrier
 s_add_u32 m0, s72, 73728
 s_add_u32 s47, s70, 3145856
 buffer_load_dwordx4 v56, s[12:15], s47 offen  lds
 s_add_u32 m0, s72, 74752
 s_nop 0
 buffer_load_dwordx4 v57, s[12:15], s47 offen  lds
 ds_read_b64_tr_b16 a[208:209], v18 offset:16384
 ds_read_b64_tr_b16 a[210:211], v18 offset:16640
 ds_read_b64_tr_b16 a[212:213], v18 offset:20480
 ds_read_b64_tr_b16 a[214:215], v18 offset:20736
 s_waitcnt vmcnt(15)
 s_waitcnt lgkmcnt(0)
 s_barrier
 s_add_u32 m0, s72, 81920
 s_add_u32 s47, s70, 3408000
 buffer_load_dwordx4 v56, s[12:15], s47 offen  lds
 s_add_u32 m0, s72, 82944
 s_nop 0
 buffer_load_dwordx4 v57, s[12:15], s47 offen  lds
 ds_read_b64_tr_b16 a[216:217], v18 offset:24576
 ds_read_b64_tr_b16 a[218:219], v18 offset:24832
 ds_read_b64_tr_b16 a[220:221], v18 offset:28672
 ds_read_b64_tr_b16 a[222:223], v18 offset:28928
 s_waitcnt vmcnt(15)
 s_waitcnt lgkmcnt(0)
 s_barrier
 s_add_u32 m0, s72, 90112
 s_add_u32 s47, s70, 4194432
 buffer_load_dwordx4 v12, s[12:15], s47 offen  lds
 s_add_u32 m0, s72, 91136
 s_nop 0
 buffer_load_dwordx4 v13, s[12:15], s47 offen  lds
 ds_read_b64_tr_b16 a[224:225], v16 offset:24576
 ds_read_b64_tr_b16 a[226:227], v16 offset:24832
 ds_read_b64_tr_b16 a[228:229], v16 offset:28672
 ds_read_b64_tr_b16 a[230:231], v16 offset:28928
 s_waitcnt vmcnt(15)
 s_waitcnt lgkmcnt(0)
 s_barrier
 s_add_u32 m0, s72, 98304
 s_add_u32 s47, s71, 37888
 buffer_load_dwordx4 v14, s[24:27], s47 offen  lds
 s_add_u32 m0, s72, 99328
 s_nop 0
 buffer_load_dwordx4 v15, s[24:27], s47 offen  lds
 ds_read_b64_tr_b16 a[232:233], v16 offset:32768
 ds_read_b64_tr_b16 a[234:235], v16 offset:33024
 ds_read_b64_tr_b16 a[236:237], v16 offset:36864
 ds_read_b64_tr_b16 a[238:239], v16 offset:37120
 s_waitcnt vmcnt(15)
 s_waitcnt lgkmcnt(0)
 s_barrier
 s_add_u32 m0, s72, 106496
 s_add_u32 s47, s71, 36864
 buffer_load_dwordx4 v14, s[24:27], s47 offen  lds
 s_add_u32 m0, s72, 107520
 s_nop 0
 buffer_load_dwordx4 v15, s[24:27], s47 offen  lds
 ds_read_b64_tr_b16 a[240:241], v16 offset:40960
 ds_read_b64_tr_b16 a[242:243], v16 offset:41216
 ds_read_b64_tr_b16 a[244:245], v16 offset:45056
 ds_read_b64_tr_b16 a[246:247], v16 offset:45312
 s_waitcnt vmcnt(15)
 s_waitcnt lgkmcnt(0)
 s_barrier
 s_add_u32 m0, s72, 114688
 s_add_u32 s47, s71, 36992
 buffer_load_dwordx4 v14, s[24:27], s47 offen  lds
 s_add_u32 m0, s72, 115712
 s_nop 0
 buffer_load_dwordx4 v15, s[24:27], s47 offen  lds
 ds_read_b64_tr_b16 a[248:249], v16 offset:49152
 ds_read_b64_tr_b16 a[250:251], v16 offset:49408
 ds_read_b64_tr_b16 a[252:253], v16 offset:53248
 ds_read_b64_tr_b16 a[254:255], v16 offset:53504
 s_waitcnt vmcnt(15)
 s_waitcnt lgkmcnt(0)
 s_barrier
 s_add_u32 m0, s72, 122880
 s_add_u32 s47, s71, 37120
 buffer_load_dwordx4 v14, s[24:27], s47 offen  lds
 s_add_u32 m0, s72, 123904
 s_nop 0
 buffer_load_dwordx4 v15, s[24:27], s47 offen  lds
 v_lshrrev_b32 v68, 2, v3
 s_mov_b32 s47, 0x4000
 buffer_load_dword v68, v68, s[20:23], s47 offen sc1
 ds_read_b64_tr_b16 v[48:49], v16 offset:57344
 ds_read_b64_tr_b16 v[50:51], v16 offset:57600
 ds_read_b64_tr_b16 v[52:53], v16 offset:61440
 ds_read_b64_tr_b16 v[54:55], v16 offset:61696
 s_waitcnt vmcnt(16)
 s_waitcnt lgkmcnt(0)
 s_barrier
 s_add_u32 m0, s72, 131072
 s_add_u32 s47, s71, 37248
 buffer_load_dwordx4 v14, s[24:27], s47 offen  lds
 s_add_u32 m0, s72, 132096
 s_nop 0
 buffer_load_dwordx4 v15, s[24:27], s47 offen  lds
 ds_write_b128 v60, v[48:51] offset:57344
 ds_write_b128 v60, v[52:55] offset:61440
 ds_read_b64_tr_b16 v[40:41], v17 offset:0
 ds_read_b64_tr_b16 v[42:43], v17 offset:256
 ds_read_b64_tr_b16 v[44:45], v17 offset:4096
 ds_read_b64_tr_b16 v[46:47], v17 offset:4352
 s_waitcnt vmcnt(15)
 s_waitcnt lgkmcnt(0)
 s_barrier
 s_add_u32 m0, s72, 139264
 s_add_u32 s47, s71, 37376
 buffer_load_dwordx4 v14, s[24:27], s47 offen  lds
 s_add_u32 m0, s72, 140288
 s_nop 0
 buffer_load_dwordx4 v15, s[24:27], s47 offen  lds
 ds_write_b128 v61, v[40:43] offset:0
 ds_write_b128 v61, v[44:47] offset:4096
 ds_read_b64_tr_b16 v[48:49], v17 offset:8192
 ds_read_b64_tr_b16 v[50:51], v17 offset:8448
 ds_read_b64_tr_b16 v[52:53], v17 offset:12288
 ds_read_b64_tr_b16 v[54:55], v17 offset:12544
 s_waitcnt vmcnt(15)
 s_waitcnt lgkmcnt(0)
 s_barrier
 s_add_u32 m0, s72, 147456
 s_add_u32 s47, s71, 37504
 buffer_load_dwordx4 v14, s[24:27], s47 offen  lds
 s_add_u32 m0, s72, 148480
 s_nop 0
 buffer_load_dwordx4 v15, s[24:27], s47 offen  lds
 ds_write_b128 v61, v[48:51] offset:8192
 ds_write_b128 v61, v[52:55] offset:12288
 ds_read_b64_tr_b16 v[40:41], v17 offset:16384
 ds_read_b64_tr_b16 v[42:43], v17 offset:16640
 ds_read_b64_tr_b16 v[44:45], v17 offset:20480
 ds_read_b64_tr_b16 v[46:47], v17 offset:20736
 s_waitcnt vmcnt(15)
 s_waitcnt lgkmcnt(0)
 s_barrier
 s_add_u32 m0, s72, 155648
 s_add_u32 s47, s71, 37632
 buffer_load_dwordx4 v14, s[24:27], s47 offen  lds
 s_add_u32 m0, s72, 156672
 s_nop 0
 buffer_load_dwordx4 v15, s[24:27], s47 offen  lds
 ds_write_b128 v61, v[40:43] offset:16384
 ds_write_b128 v61, v[44:47] offset:20480
 ds_read_b64_tr_b16 v[48:49], v17 offset:24576
 ds_read_b64_tr_b16 v[50:51], v17 offset:24832
 ds_read_b64_tr_b16 v[52:53], v17 offset:28672
 ds_read_b64_tr_b16 v[54:55], v17 offset:28928
 s_waitcnt vmcnt(15)
 s_waitcnt lgkmcnt(0)
 s_barrier
 s_add_u32 m0, s72, 24576
 s_add_u32 s47, s70, 128
 buffer_load_dwordx4 v56, s[12:15], s47 offen  lds
 s_add_u32 m0, s72, 25600
 s_nop 0
 buffer_load_dwordx4 v57, s[12:15], s47 offen  lds
 ds_write_b128 v61, v[48:51] offset:24576
 ds_write_b128 v61, v[52:55] offset:28672
 ds_read_b64_tr_b16 v[40:41], v17 offset:32768
 ds_read_b64_tr_b16 v[42:43], v17 offset:33024
 ds_read_b64_tr_b16 v[44:45], v17 offset:36864
 ds_read_b64_tr_b16 v[46:47], v17 offset:37120
 s_waitcnt vmcnt(15)
 s_waitcnt lgkmcnt(0)
 s_barrier
 s_add_u32 m0, s72, 32768
 s_add_u32 s47, s70, 262272
 buffer_load_dwordx4 v56, s[12:15], s47 offen  lds
 s_add_u32 m0, s72, 33792
 s_nop 0
 buffer_load_dwordx4 v57, s[12:15], s47 offen  lds
 ds_write_b128 v61, v[40:43] offset:32768
 ds_write_b128 v61, v[44:47] offset:36864
 ds_read_b64_tr_b16 v[48:49], v17 offset:40960
 ds_read_b64_tr_b16 v[50:51], v17 offset:41216
 ds_read_b64_tr_b16 v[52:53], v17 offset:45056
 ds_read_b64_tr_b16 v[54:55], v17 offset:45312
 s_waitcnt vmcnt(15)
 s_waitcnt lgkmcnt(0)
 s_barrier
 s_add_u32 m0, s72, 40960
 s_add_u32 s47, s70, 1048704
 buffer_load_dwordx4 v56, s[12:15], s47 offen  lds
 s_add_u32 m0, s72, 41984
 s_nop 0
 buffer_load_dwordx4 v57, s[12:15], s47 offen  lds
 ds_write_b128 v61, v[48:51] offset:40960
 ds_write_b128 v61, v[52:55] offset:45056
 ds_read_b64_tr_b16 v[40:41], v17 offset:49152
 ds_read_b64_tr_b16 v[42:43], v17 offset:49408
 ds_read_b64_tr_b16 v[44:45], v17 offset:53248
 ds_read_b64_tr_b16 v[46:47], v17 offset:53504
 s_waitcnt vmcnt(15)
 s_waitcnt lgkmcnt(0)
 s_barrier
 s_add_u32 m0, s72, 49152
 s_add_u32 s47, s70, 1310848
 buffer_load_dwordx4 v56, s[12:15], s47 offen  lds
 s_add_u32 m0, s72, 50176
 s_nop 0
 buffer_load_dwordx4 v57, s[12:15], s47 offen  lds
 buffer_load_dword v1, v65, s[20:23], s56 offen sc1
 ds_write_b128 v61, v[40:43] offset:49152
 ds_write_b128 v61, v[44:47] offset:53248
 ds_read_b64_tr_b16 v[48:49], v17 offset:57344
 ds_read_b64_tr_b16 v[50:51], v17 offset:57600
 ds_read_b64_tr_b16 v[52:53], v17 offset:61440
 ds_read_b64_tr_b16 v[54:55], v17 offset:61696
 s_waitcnt vmcnt(15)
 s_waitcnt lgkmcnt(0)
 s_barrier
 v_cmp_ne_u32 vcc, 0, v68
 s_mov_b32 s77, vcc_lo
 s_and_b32 s47, s6, 29
 s_cbranch_scc1 Lgt_43
 buffer_store_dword v64, v66, s[28:31], 0 offen offset:128 sc1
Lgt_43:
 s_add_u32 s58, s6, 1
 s_and_b32 s58, s58, 31
 s_bitcmp1_b32 s77, s58
 s_cbranch_scc1 Lhlp_44
 s_lshl_b32 s76, s58, 8
 s_mul_i32 s80, s58, 147456
 s_add_u32 s47, s76, 3145856
 buffer_load_dword v63, v19, s[12:15], s47 offen
 s_add_u32 s47, s80, 37888
 buffer_load_dword v63, v59, s[24:27], s47 offen
 s_add_u32 s47, s80, 37120
 buffer_load_dword v63, v59, s[24:27], s47 offen
 s_add_u32 s47, s80, 37504
 buffer_load_dword v63, v59, s[24:27], s47 offen
 s_add_u32 s47, s76, 262272
 buffer_load_dword v63, v19, s[12:15], s47 offen
Lhlp_44:
 s_add_u32 s58, s6, 2
 s_and_b32 s58, s58, 31
 s_bitcmp1_b32 s77, s58
 s_cbranch_scc1 Lhlp_45
 s_lshl_b32 s76, s58, 8
 s_mul_i32 s80, s58, 147456
 s_add_u32 s47, s76, 3408000
 buffer_load_dword v63, v19, s[12:15], s47 offen
 s_add_u32 s47, s80, 36864
 buffer_load_dword v63, v59, s[24:27], s47 offen
 s_add_u32 s47, s80, 37248
 buffer_load_dword v63, v59, s[24:27], s47 offen
 s_add_u32 s47, s80, 37632
 buffer_load_dword v63, v59, s[24:27], s47 offen
 s_add_u32 s47, s76, 1048704
 buffer_load_dword v63, v19, s[12:15], s47 offen
Lhlp_45:
 s_add_u32 s58, s6, 3
 s_and_b32 s58, s58, 31
 s_bitcmp1_b32 s77, s58
 s_cbranch_scc1 Lhlp_46
 s_lshl_b32 s76, s58, 8
 s_mul_i32 s80, s58, 147456
 s_add_u32 s47, s76, 4194432
 buffer_load_dword v63, v58, s[12:15], s47 offen
 s_add_u32 s47, s80, 36992
 buffer_load_dword v63, v59, s[24:27], s47 offen
 s_add_u32 s47, s80, 37376
 buffer_load_dword v63, v59, s[24:27], s47 offen
 s_add_u32 s47, s76, 128
 buffer_load_dword v63, v19, s[12:15], s47 offen
 s_add_u32 s47, s76, 1310848
 buffer_load_dword v63, v19, s[12:15], s47 offen
Lhlp_46:
 ds_write_b128 v61, v[48:51] offset:57344
 ds_write_b128 v61, v[52:55] offset:61440
 ds_read_b64_tr_b16 v[40:41], v18 offset:0
 ds_read_b64_tr_b16 v[42:43], v18 offset:256
 ds_read_b64_tr_b16 v[44:45], v18 offset:4096
 ds_read_b64_tr_b16 v[46:47], v18 offset:4352
 s_waitcnt vmcnt(13)
 s_waitcnt lgkmcnt(0)
 s_barrier
 ds_write_b128 v62, v[40:43] offset:0
 ds_write_b128 v62, v[44:47] offset:4096
 ds_read_b64_tr_b16 v[48:49], v18 offset:8192
 ds_read_b64_tr_b16 v[50:51], v18 offset:8448
 ds_read_b64_tr_b16 v[52:53], v18 offset:12288
 ds_read_b64_tr_b16 v[54:55], v18 offset:12544
 s_waitcnt vmcnt(11)
 s_waitcnt lgkmcnt(0)
 s_barrier
 ds_write_b128 v62, v[48:51] offset:8192
 ds_write_b128 v62, v[52:55] offset:12288
 ds_read_b64_tr_b16 v[40:41], v18 offset:16384
 ds_read_b64_tr_b16 v[42:43], v18 offset:16640
 ds_read_b64_tr_b16 v[44:45], v18 offset:20480
 ds_read_b64_tr_b16 v[46:47], v18 offset:20736
 s_waitcnt vmcnt(9)
 s_waitcnt lgkmcnt(0)
 s_barrier
 ds_write_b128 v62, v[40:43] offset:16384
 ds_write_b128 v62, v[44:47] offset:20480
 ds_read_b64_tr_b16 v[48:49], v18 offset:24576
 ds_read_b64_tr_b16 v[50:51], v18 offset:24832
 ds_read_b64_tr_b16 v[52:53], v18 offset:28672
 ds_read_b64_tr_b16 v[54:55], v18 offset:28928
 s_waitcnt vmcnt(7)
 s_waitcnt lgkmcnt(0)
 s_barrier
 ds_write_b128 v62, v[48:51] offset:24576
 ds_write_b128 v62, v[52:55] offset:28672
 ds_read_b64_tr_b16 v[40:41], v16 offset:24576
 ds_read_b64_tr_b16 v[42:43], v16 offset:24832
 ds_read_b64_tr_b16 v[44:45], v16 offset:28672
 ds_read_b64_tr_b16 v[46:47], v16 offset:28928
 s_waitcnt vmcnt(5)
 s_waitcnt lgkmcnt(0)
 s_barrier
 ds_write_b128 v60, v[40:43] offset:24576
 ds_write_b128 v60, v[44:47] offset:28672
 ds_read_b64_tr_b16 v[48:49], v16 offset:32768
 ds_read_b64_tr_b16 v[50:51], v16 offset:33024
 ds_read_b64_tr_b16 v[52:53], v16 offset:36864
 ds_read_b64_tr_b16 v[54:55], v16 offset:37120
 s_waitcnt vmcnt(3)
 s_waitcnt lgkmcnt(0)
 s_barrier
 ds_write_b128 v60, v[48:51] offset:32768
 ds_write_b128 v60, v[52:55] offset:36864
 ds_read_b64_tr_b16 v[40:41], v16 offset:40960
 ds_read_b64_tr_b16 v[42:43], v16 offset:41216
 ds_read_b64_tr_b16 v[44:45], v16 offset:45056
 ds_read_b64_tr_b16 v[46:47], v16 offset:45312
 s_waitcnt vmcnt(1)
 s_waitcnt lgkmcnt(0)
 s_barrier
 ds_write_b128 v60, v[40:43] offset:40960
 ds_write_b128 v60, v[44:47] offset:45056
 ds_read_b64_tr_b16 v[48:49], v16 offset:49152
 ds_read_b64_tr_b16 v[50:51], v16 offset:49408
 ds_read_b64_tr_b16 v[52:53], v16 offset:53248
 ds_read_b64_tr_b16 v[54:55], v16 offset:53504
 s_waitcnt lgkmcnt(0)
 s_barrier
 ds_write_b128 v60, v[48:51] offset:49152
 ds_write_b128 v60, v[52:55] offset:53248
 v_lshlrev_b32 v0, 4, v0
 s_waitcnt vmcnt(0)
 v_cmp_le_u32 vcc, 2, v1
 s_cbranch_vccnz Lpbk_47
Lpb0_48:
 buffer_load_dword v1, v7, s[20:23], s56 offen sc1
 s_waitcnt vmcnt(0)
 v_cmp_le_u32 vcc, 2, v1
 s_cbranch_vccnz Lpb0ok_49
 s_sub_u32 s54, s54, 1
 s_cbranch_scc0 Lpb0_48
 s_endpgm
Lpb0ok_49:
Lpbk_47:
 s_lshl_b32 s47, s4, 11
 s_add_u32 m0, s47, 9216
 s_add_u32 s68, s37, 0x80000
 buffer_load_dwordx4 v3, s[20:23], s67 offen offset:0 sc1 lds
 buffer_load_dwordx4 v3, s[20:23], s67 offen offset:1024 sc1 lds
 buffer_load_dword v68, v67, s[20:23], s37 offen sc1
 buffer_load_dword v68, v67, s[20:23], s68 offen sc1
 s_add_u32 s68, s68, 0x80000
 s_mov_b32 s24, 0xf000f
 s_mov_b32 s25, 0xf000f
 s_mov_b32 s26, 0xf000f0
 s_mov_b32 s27, 0xf000f0
 s_mov_b32 s28, 0xf000f00
 s_mov_b32 s29, 0xf000f00
 s_mov_b32 s30, 0xf000f000
 s_mov_b32 s31, 0xf000f000
 s_mov_b32 s32, 0xaaaaaaaa
 s_mov_b32 s33, 0xaaaaaaaa
 s_mov_b32 s34, 0x3f803f80
 s_mov_b32 s35, 0x3f803f80
 s_mov_b32 s70, -1
 s_mov_b32 s71, 0
 s_lshl_b32 s47, s4, 12
 s_add_u32 s68, s68, s47
 v_mov_b32 v2, 0
 v_mov_b32 v4, 0
 s_waitcnt lgkmcnt(0)
 ds_read_b128 v[20:23], v0 offset:24576
 ds_read_b128 v[24:27], v0 offset:28672
 ds_read_b128 v[28:31], v0 offset:32768
 ds_read_b128 v[32:35], v0 offset:36864
 v_mov_b64 v[36:37], 0
 v_mov_b64 v[38:39], 0
 v_mov_b64 v[40:41], 0
 v_mov_b64 v[42:43], 0
 v_mov_b64 v[44:45], 0
 v_mov_b64 v[46:47], 0
 v_mov_b64 v[48:49], 0
 v_mov_b64 v[50:51], 0
 v_lshl_add_u32 v1, v3, 3, s68
 v_mov_b32 v6, s56
 v_cndmask_b32 v1, v6, v1, s[70:71]
 v_min_u32 v6, 16, v0
 v_lshlrev_b32 v6, 24, v6
 s_max_u32 s47, s36, 1
 v_add_u32 v2, -1, s47
 s_xor_b32 s44, s44, 0x80000
 s_xor_b32 s45, s45, 0x80000
 s_xor_b32 s65, s65, 0x80000
 s_xor_b32 s66, s66, 0x80000
 s_xor_b32 s41, s41, 0x80000
 s_xor_b32 s43, s43, 0x80000
 s_lshr_b64 s[74:75], s[74:75], s73
 s_and_b32 s74, s74, 0xff
 s_cmp_eq_u32 s74, 32
 s_waitcnt vmcnt(2)
 s_cbranch_scc0 Lslow_50
 .p2align 3
Lstep_52:
 s_mov_b64 exec, -1
 s_waitcnt lgkmcnt(0)
 buffer_load_dwordx4 v[12:15], v3, s[20:23], s59 offen offset:0 sc1
 buffer_load_dwordx4 v[16:19], v3, s[20:23], s59 offen offset:1024 sc1
 s_barrier
 ds_read_b128 v[52:55], v3 offset:0
 ds_read_b128 v[56:59], v3 offset:1024
 ds_read_b128 v[60:63], v3 offset:2048
 buffer_store_dwordx4 v[64:67], v0, s[20:23], s38 offen sc1
 s_waitcnt lgkmcnt(2)
 v_smfmac_f32_16x16x64_bf16 v[36:39], v[52:55], v[72:79], v5
 v_smfmac_f32_16x16x64_bf16 v[40:43], v[52:55], v[80:87], v5
 buffer_load_dword v1, v1, s[20:23], 0 offen sc1
 v_smfmac_f32_16x16x64_bf16 v[44:47], v[52:55], v[88:95], v5
 s_waitcnt lgkmcnt(1)
 v_smfmac_f32_16x16x64_bf16 v[48:51], v[52:55], v[20:27], v5
 buffer_store_dword v2, v6, s[20:23], s57 offen sc1
 v_smfmac_f32_16x16x64_bf16 v[36:39], v[56:59], v[112:119], v5
 ds_read_b128 v[20:23], v0 offset:40960
 v_smfmac_f32_16x16x64_bf16 v[40:43], v[56:59], v[120:127], v5
 ds_read_b128 v[24:27], v0 offset:45056
 v_smfmac_f32_16x16x64_bf16 v[44:47], v[56:59], v[128:135], v5
 ds_read_b128 v[52:55], v3 offset:3072
 s_waitcnt lgkmcnt(3)
 v_smfmac_f32_16x16x64_bf16 v[48:51], v[56:59], v[28:35], v5
 v_smfmac_f32_16x16x64_bf16 v[36:39], v[60:63], v[152:159], v5
 ds_read_b128 v[28:31], v0 offset:49152
 v_smfmac_f32_16x16x64_bf16 v[40:43], v[60:63], v[160:167], v5
 ds_read_b128 v[32:35], v0 offset:53248
 v_smfmac_f32_16x16x64_bf16 v[44:47], v[60:63], v[168:175], v5
 ds_read_b128 v[56:59], v3 offset:4096
 s_waitcnt lgkmcnt(3)
 v_smfmac_f32_16x16x64_bf16 v[48:51], v[60:63], v[20:27], v5
 v_smfmac_f32_16x16x64_bf16 v[36:39], v[52:55], v[192:199], v5
 ds_read_b128 v[20:23], v0 offset:57344
 v_smfmac_f32_16x16x64_bf16 v[40:43], v[52:55], v[200:207], v5
 ds_read_b128 v[24:27], v0 offset:61440
 v_smfmac_f32_16x16x64_bf16 v[44:47], v[52:55], v[208:215], v5
 ds_read_b128 v[60:63], v3 offset:5120
 s_waitcnt lgkmcnt(3)
 v_add_u32 v0, 0x10000, v0
 v_smfmac_f32_16x16x64_bf16 v[48:51], v[52:55], v[28:35], v5
 v_smfmac_f32_16x16x64_bf16 v[36:39], v[56:59], v[232:239], v5
 ds_read_b128 v[28:31], v0 offset:0
 v_smfmac_f32_16x16x64_bf16 v[40:43], v[56:59], v[240:247], v5
 ds_read_b128 v[32:35], v0 offset:4096
 v_smfmac_f32_16x16x64_bf16 v[44:47], v[56:59], v[248:255], v5
 ds_read_b128 v[52:55], v3 offset:6144
 s_waitcnt lgkmcnt(3)
 v_smfmac_f32_16x16x64_bf16 v[48:51], v[56:59], v[20:27], v5
 v_smfmac_f32_16x16x64_bf16 v[36:39], v[60:63], a[16:23], v5
 ds_read_b128 v[20:23], v0 offset:8192
 v_smfmac_f32_16x16x64_bf16 v[40:43], v[60:63], a[24:31], v5
 ds_read_b128 v[24:27], v0 offset:12288
 v_smfmac_f32_16x16x64_bf16 v[44:47], v[60:63], a[32:39], v5
 ds_read_b128 v[56:59], v3 offset:7168
 s_waitcnt lgkmcnt(3)
 v_smfmac_f32_16x16x64_bf16 v[48:51], v[60:63], v[28:35], v5
 s_waitcnt vmcnt(5)
 v_smfmac_f32_16x16x64_bf16 v[36:39], v[52:55], a[56:63], v5
 ds_read_b128 v[28:31], v0 offset:16384
 v_mov_b64 v[64:65], 0
 v_smfmac_f32_16x16x64_bf16 v[40:43], v[52:55], a[64:71], v5
 ds_read_b128 v[32:35], v0 offset:20480
 v_mov_b64 v[66:67], 0
 v_smfmac_f32_16x16x64_bf16 v[44:47], v[52:55], a[72:79], v5
 ds_read_b128 v[60:63], v3 offset:8192
 s_waitcnt lgkmcnt(3)
 v_mov_b64 v[68:69], 0
 v_smfmac_f32_16x16x64_bf16 v[48:51], v[52:55], v[20:27], v5
 v_mov_b64 v[70:71], 0
 v_smfmac_f32_16x16x64_bf16 v[36:39], v[56:59], a[96:103], v5
 ds_read_b128 v[20:23], v0 offset:24576
 ds_read_b128 v[24:27], v0 offset:28672
 v_smfmac_f32_16x16x64_bf16 v[40:43], v[56:59], a[104:111], v5
 ds_read_b128 v[52:55], v3 offset:0
 s_waitcnt lgkmcnt(3)
 v_smfmac_f32_16x16x64_bf16 v[36:39], v[60:63], a[136:143], v5
 v_smfmac_f32_16x16x64_bf16 v[40:43], v[60:63], a[144:151], v5
 v_smfmac_f32_16x16x64_bf16 v[44:47], v[56:59], a[112:119], v5
 s_nop 0
 v_add_f32 v36, v36, v38
 v_add_f32 v37, v37, v39
 v_smfmac_f32_16x16x64_bf16 v[48:51], v[56:59], v[28:35], v5
 ds_read_b128 v[56:59], v3 offset:1024
 s_waitcnt lgkmcnt(1)
 v_cvt_pk_bf16_f32 v36, v36, v37
 v_add_f32 v40, v40, v42
 v_smfmac_f32_16x16x64_bf16 v[44:47], v[60:63], a[152:159], v5
 ds_write_b16 v10, v36 offset:17408
 ds_write_b16_d16_hi v10, v36 offset:17472
 v_add_f32 v41, v41, v43
 v_cvt_pk_bf16_f32 v40, v40, v41
 v_smfmac_f32_16x16x64_bf16 v[48:51], v[60:63], v[20:27], v5
 ds_write_b16 v10, v40 offset:17412
 ds_write_b16_d16_hi v10, v40 offset:17476
 v_mov_b64 v[28:29], 0
 v_smfmac_f32_16x16x64_bf16 v[64:67], v[52:55], v[96:103], v5
 ds_read_b128 v[60:63], v3 offset:2048
 ds_read_b128 v[20:23], v3 offset:9216
 v_add_f32 v44, v44, v46
 v_add_f32 v45, v45, v47
 v_smfmac_f32_16x16x64_bf16 v[68:71], v[52:55], v[104:111], v5
 s_waitcnt lgkmcnt(6)
 v_cvt_pk_bf16_f32 v44, v44, v45
 v_add_f32 v48, v48, v50
 v_add_f32 v49, v49, v51
 v_cvt_pk_bf16_f32 v45, v48, v49
 ds_write_b64 v8, v[44:45] offset:19456
 v_smfmac_f32_16x16x64_bf16 v[64:67], v[56:59], v[136:143], v5
 ds_read_b128 v[52:55], v3 offset:3072
 ds_read_b128 v[24:27], v3 offset:10240
 v_mov_b64 v[30:31], 0
 v_smfmac_f32_16x16x64_bf16 v[68:71], v[56:59], v[144:151], v5
 ds_read_b128 v[56:59], v3 offset:4096
 s_waitcnt lgkmcnt(5)
 v_smfmac_f32_16x16x64_bf16 v[64:67], v[60:63], v[176:183], v5
 ds_read_b128 v[32:35], v3 offset:11264
 v_smfmac_f32_16x16x64_bf16 v[68:71], v[60:63], v[184:191], v5
 s_waitcnt lgkmcnt(4)
 s_barrier
 ds_read_b128 v[36:39], v11 offset:17408
 ds_read_b128 v[40:43], v11 offset:17920
 s_waitcnt lgkmcnt(5)
 v_smfmac_f32_16x16x64_bf16 v[64:67], v[52:55], v[216:223], v5
 ds_read_b64_tr_b16 v[60:61], v9 offset:19456
 ds_read_b64_tr_b16 v[62:63], v9 offset:19488
 v_smfmac_f32_16x16x64_bf16 v[68:71], v[52:55], v[224:231], v5
 ds_read_b128 v[52:55], v3 offset:5120
 ds_read_b128 v[44:47], v11 offset:18432
 s_waitcnt lgkmcnt(7)
 v_smfmac_f32_16x16x64_bf16 v[64:67], v[56:59], a[0:7], v5
 ds_read_b128 v[48:51], v11 offset:18944
 v_smfmac_f32_16x16x64_bf16 v[68:71], v[56:59], a[8:15], v5
 ds_read_b128 v[56:59], v3 offset:6144
 s_waitcnt lgkmcnt(7)
 v_mfma_f32_16x16x32_bf16 v[20:23], v[20:23], v[36:39], 0
 v_mfma_f32_16x16x32_bf16 v[24:27], v[24:27], v[36:39], 0
 s_waitcnt lgkmcnt(6)
 v_mfma_f32_16x16x32_bf16 v[20:23], v[32:35], v[40:43], v[20:23]
 ds_read_b128 v[32:35], v3 offset:12288
 s_waitcnt lgkmcnt(5)
 v_smfmac_f32_16x16x64_bf16 v[28:31], v[60:63], v[36:43], v5
 ds_read_b64_tr_b16 v[60:61], v9 offset:20544
 ds_read_b64_tr_b16 v[62:63], v9 offset:20576
 s_waitcnt lgkmcnt(6)
 v_smfmac_f32_16x16x64_bf16 v[64:67], v[52:55], a[40:47], v5
 ds_read_b128 v[36:39], v3 offset:13312
 v_smfmac_f32_16x16x64_bf16 v[68:71], v[52:55], a[48:55], v5
 ds_read_b128 v[52:55], v3 offset:7168
 s_waitcnt lgkmcnt(4)
 v_mfma_f32_16x16x32_bf16 v[24:27], v[32:35], v[40:43], v[24:27]
 ds_read_b128 v[40:43], v3 offset:14336
 s_waitcnt lgkmcnt(3)
 v_smfmac_f32_16x16x64_bf16 v[28:31], v[60:63], v[44:51], v5
 ds_read_b128 v[32:35], v3 offset:15360
 ds_read_b128 v[60:63], v3 offset:16384
 v_smfmac_f32_16x16x64_bf16 v[64:67], v[56:59], a[80:87], v5
 v_smfmac_f32_16x16x64_bf16 v[68:71], v[56:59], a[88:95], v5
 ds_read_b128 v[56:59], v3 offset:8192
 s_waitcnt lgkmcnt(5)
 v_mfma_f32_16x16x32_bf16 v[20:23], v[36:39], v[44:47], v[20:23]
 v_add_f32 v28, v28, v30
 v_add_f32 v29, v29, v31
 s_waitcnt lgkmcnt(4)
 v_smfmac_f32_16x16x64_bf16 v[64:67], v[52:55], a[120:127], v5
 v_cndmask_b32 v28, v28, v29, s[48:49]
 v_smfmac_f32_16x16x64_bf16 v[68:71], v[52:55], a[128:135], v5
 ds_read_b128 v[36:39], v0 offset:32768
 v_mul_f32 v28, s55, v28
 s_waitcnt lgkmcnt(4)
 v_mfma_f32_16x16x32_bf16 v[24:27], v[40:43], v[44:47], v[24:27]
 v_exp_f32 v28, v28
 s_waitcnt lgkmcnt(1)
 v_smfmac_f32_16x16x64_bf16 v[64:67], v[56:59], a[160:167], v5
 ds_read_b128 v[40:43], v0 offset:36864
 v_cndmask_b32 v29, 0, v28, s[48:49]
 v_smfmac_f32_16x16x64_bf16 v[68:71], v[56:59], a[168:175], v5
 ds_read_b128 v[44:47], v0 offset:40960
 v_cndmask_b32 v28, v28, 0, s[48:49]
 v_mfma_f32_16x16x32_bf16 v[20:23], v[32:35], v[48:51], v[20:23]
 v_cvt_pk_bf16_f32 v6, v28, v29
 v_mov_b64 v[32:33], s[34:35]
 v_mfma_f32_16x16x32_bf16 v[24:27], v[60:63], v[48:51], v[24:27]
 ds_read_b128 v[48:51], v0 offset:45056
 v_mov_b64 v[34:35], s[34:35]
 v_add_f32 v64, v64, v66
 v_add_f32 v65, v65, v67
 v_cvt_pk_bf16_f32 v2, v64, v65
 v_add_f32 v68, v68, v70
 v_add_f32 v69, v69, v71
 v_cvt_pk_bf16_f32 v4, v68, v69
 v_cndmask_b32 v20, v20, v24, s[48:49]
 v_cndmask_b32 v21, v21, v25, s[48:49]
 v_cndmask_b32 v22, v22, v26, s[48:49]
 v_cndmask_b32 v23, v23, v27, s[48:49]
 v_mfma_f32_16x16x16_bf16 v[60:63], v[6:7], v[32:33], 0
 s_waitcnt vmcnt(3)
 v_exp_f32 v20, v20
 v_mfma_f32_16x16x16_bf16 v[52:55], v[6:7], v[2:3], 0
 s_cmp_eq_u32 s36, 63
 v_exp_f32 v21, v21
 v_mfma_f32_16x16x16_bf16 v[56:59], v[6:7], v[4:5], 0
 v_exp_f32 v22, v22
 v_exp_f32 v23, v23
 v_cvt_pk_bf16_f32 v30, v20, v21
 v_cvt_pk_bf16_f32 v31, v22, v23
 v_mov_b64 v[64:65], 0
 v_mov_b64 v[66:67], 0
 v_smfmac_f32_16x16x32_bf16 v[60:63], v[30:31], v[32:35], v5
 v_mov_b64 v[68:69], 0
 v_mov_b64 v[70:71], 0
 v_smfmac_f32_16x16x32_bf16 v[52:55], v[30:31], v[12:15], v5
 v_mov_b64 v[20:21], 0
 v_mov_b64 v[22:23], 0
 v_smfmac_f32_16x16x32_bf16 v[56:59], v[30:31], v[16:19], v5
 s_nop 0
 v_add_f32 v60, v60, v62
 v_add_f32 v61, v61, v63
 v_rcp_f32 v60, v60
 v_rcp_f32 v61, v61
 v_add_f32 v52, v52, v54
 v_add_f32 v53, v53, v55
 v_mul_f32 v52, v52, v60
 v_mul_f32 v53, v53, v61
 v_add_f32 v56, v56, v58
 v_add_f32 v57, v57, v59
 v_mul_f32 v56, v56, v60
 v_mul_f32 v57, v57, v61
 v_cvt_pk_bf16_f32 v52, v52, v53
 v_cvt_pk_bf16_f32 v53, v56, v57
 ds_write_b64 v8, v[52:53] offset:21632
 v_subrev_u32 v60, 0x21800000, v60
 v_subrev_u32 v61, 0x21800000, v61
 v_max_u32 v60, v60, v61
 v_cmp_lt_u32 vcc, 0x3c000000, v60
 s_cbranch_scc1 Lchexit_51
 v_mov_b64 v[24:25], 0
 v_mov_b64 v[26:27], 0
 v_mov_b64 v[28:29], 0
 v_mov_b64 v[30:31], 0
 s_cbranch_vccnz Lmx_54
Lmxb_55:
 s_waitcnt lgkmcnt(0)
 v_mov_b64 v[32:33], 0
 s_barrier
 ds_read_b64_tr_b16 v[52:53], v9 offset:21632
 v_mov_b64 v[34:35], 0
 ds_read_b64_tr_b16 v[54:55], v9 offset:21664
 ds_read_b64_tr_b16 v[56:57], v9 offset:22720
 v_bfe_u32 v6, v0, 7, 5
 ds_read_b64_tr_b16 v[58:59], v9 offset:22752
 ds_read_b128 v[12:15], v0 offset:49152
 v_mul_u32_u24 v6, 10496, v6
 ds_read_b128 v[16:19], v0 offset:53248
 s_add_u32 s67, s67, 0x80000
 v_bfe_u32 v60, v3, 4, 3
 s_xor_b32 s46, s46, 0x1
 v_lshl_add_u32 v6, v60, 3, v6
 s_add_u32 s59, s59, 0x80000
 v_mov_b64 v[60:61], 0
 s_waitcnt lgkmcnt(4)
 v_smfmac_f32_16x16x64_bf16 v[64:67], v[52:55], a[248:255], v5
 buffer_load_dwordx4 v3, s[20:23], s67 offen offset:0 sc1 lds
 v_mov_b64 v[62:63], 0
 v_smfmac_f32_16x16x64_bf16 v[68:71], v[52:55], a[176:183], v5
 s_waitcnt lgkmcnt(2)
 s_add_u32 s38, s38, 0x20000
 v_smfmac_f32_16x16x64_bf16 v[64:67], v[56:59], v[36:43], v5
 ds_read_b128 v[36:39], v0 offset:57344
 buffer_load_dwordx4 v3, s[20:23], s67 offen offset:1024 sc1 lds
 v_smfmac_f32_16x16x64_bf16 v[20:23], v[52:55], a[184:191], v5
 ds_read_b128 v[40:43], v0 offset:61440
 s_cmp_lt_u32 s36, 61
 v_add_u32 v0, 0x10000, v0
 v_smfmac_f32_16x16x64_bf16 v[68:71], v[56:59], v[44:51], v5
 ds_read_b128 v[44:47], v0 offset:0
 s_cselect_b32 s47, 0x80000, 0
 v_add_f32 v64, v64, v66
 v_add_f32 v65, v65, v67
 v_cvt_pk_bf16_f32 v65, v65, v65
 v_smfmac_f32_16x16x64_bf16 v[24:27], v[52:55], a[192:199], v5
 ds_read_b128 v[48:51], v0 offset:4096
 s_waitcnt lgkmcnt(4)
 v_cvt_pk_bf16_f32 v64, v64, v64
 v_and_or_b32 v65, v65, -2, s46
 v_smfmac_f32_16x16x64_bf16 v[20:23], v[56:59], v[12:19], v5
 ds_read_b128 v[12:15], v0 offset:8192
 buffer_store_dwordx2 v[64:65], v6, s[20:23], s62 offen
 v_add_f32 v68, v68, v70
 v_add_f32 v69, v69, v71
 v_smfmac_f32_16x16x64_bf16 v[28:31], v[52:55], a[200:207], v5
 ds_read_b128 v[16:19], v0 offset:12288
 s_waitcnt lgkmcnt(4)
 v_mov_b64 v[64:65], 0
 v_mov_b64 v[66:67], 0
 v_smfmac_f32_16x16x64_bf16 v[24:27], v[56:59], v[36:43], v5
 ds_read_b128 v[36:39], v0 offset:16384
 s_add_u32 s68, s68, s47
 v_add_f32 v20, v20, v22
 v_add_f32 v21, v21, v23
 v_cvt_pk_bf16_f32 v69, v69, v21
 v_smfmac_f32_16x16x64_bf16 v[32:35], v[52:55], a[208:215], v5
 ds_read_b128 v[40:43], v0 offset:20480
 s_waitcnt lgkmcnt(4)
 v_cvt_pk_bf16_f32 v68, v68, v20
 v_and_or_b32 v69, v69, -2, s46
 v_smfmac_f32_16x16x64_bf16 v[28:31], v[56:59], v[44:51], v5
 ds_read_b128 v[44:47], v0 offset:24576
 buffer_store_dwordx2 v[68:69], v6, s[20:23], s60 offen offset:0
 v_add_f32 v24, v24, v26
 v_add_f32 v25, v25, v27
 v_smfmac_f32_16x16x64_bf16 v[60:63], v[52:55], a[216:223], v5
 ds_read_b128 v[48:51], v0 offset:28672
 s_waitcnt lgkmcnt(4)
 v_mov_b64 v[20:21], 0
 v_mov_b64 v[22:23], 0
 v_smfmac_f32_16x16x64_bf16 v[32:35], v[56:59], v[12:19], v5
 s_add_u32 s36, s36, 1
 s_add_u32 s58, s36, 2
 v_add_f32 v28, v28, v30
 v_add_f32 v29, v29, v31
 v_cvt_pk_bf16_f32 v25, v25, v29
 v_smfmac_f32_16x16x64_bf16 v[64:67], v[52:55], a[224:231], v5
 s_waitcnt lgkmcnt(2)
 s_min_u32 s58, s58, 64
 v_cvt_pk_bf16_f32 v24, v24, v28
 v_and_or_b32 v25, v25, -2, s46
 v_smfmac_f32_16x16x64_bf16 v[60:63], v[56:59], v[36:43], v5
 buffer_store_dwordx2 v[24:25], v6, s[20:23], s60 offen offset:2048
 v_add_f32 v32, v32, v34
 v_smfmac_f32_16x16x64_bf16 v[20:23], v[52:55], a[232:239], v5
 s_waitcnt lgkmcnt(0)
 s_xor_b32 s44, s44, 0x80000
 v_add_f32 v33, v33, v35
 v_smfmac_f32_16x16x64_bf16 v[64:67], v[56:59], v[44:51], v5
 s_xor_b32 s45, s45, 0x80000
 s_xor_b32 s65, s65, 0x80000
 v_add_f32 v60, v60, v62
 v_add_f32 v61, v61, v63
 v_smfmac_f32_16x16x64_bf16 v[20:23], v[56:59], a[240:247], v5
 s_cmp_eq_u32 s4, 0
 v_cvt_pk_bf16_f32 v33, v33, v61
 v_cvt_pk_bf16_f32 v32, v32, v60
 v_and_or_b32 v33, v33, -2, s46
 buffer_store_dwordx2 v[32:33], v6, s[20:23], s61 offen offset:0
 v_add_f32 v64, v64, v66
 v_add_f32 v65, v65, v67
 s_nop 0
 v_add_f32 v20, v20, v22
 v_add_f32 v21, v21, v23
 v_cvt_pk_bf16_f32 v65, v65, v21
 v_cvt_pk_bf16_f32 v64, v64, v20
 v_and_or_b32 v65, v65, -2, s46
 buffer_store_dwordx2 v[64:65], v6, s[20:23], s61 offen offset:2048
 s_cbranch_scc1 LwH_56
 s_xor_b32 s66, s66, 0x80000
 s_xor_b32 s41, s41, 0x80000
 s_xor_b32 s43, s43, 0x80000
 v_mov_b32 v47, 0x3f80
 v_cndmask_b32 v47, v47, 1.0, s[32:33]
 v_cndmask_b32 v44, 0, v47, s[24:25]
 v_cndmask_b32 v45, 0, v47, s[26:27]
 v_cndmask_b32 v46, 0, v47, s[28:29]
 v_cndmask_b32 v47, 0, v47, s[30:31]
 v_bfe_u32 v52, v3, 8, 2
 v_bfe_u32 v58, v3, 2, 4
 v_lshl_or_b32 v52, v52, 4, v58
 v_and_b32 v58, 0xc0, v3
 v_lshl_or_b32 v52, v58, 24, v52
 v_subrev_u32 v0, 0x20000, v0
 v_mov_b32 v59, -1
 v_add_u32 v54, s42, v3
 v_add_u32 v58, s69, v9
 ds_read_b64_tr_b16 v[64:65], v58 offset:19456
 v_mov_b32 v66, v2
 v_mov_b32 v67, v4
 ds_read_b128 v[20:23], v0 offset:24576
 ds_read_b128 v[24:27], v0 offset:28672
 ds_read_b128 v[28:31], v0 offset:32768
 ds_read_b128 v[32:35], v0 offset:36864
 s_cmp_eq_u32 s4, 1
 s_waitcnt vmcnt(2)
 s_cbranch_scc1 Lq1_57
 s_cmp_eq_u32 s4, 2
 s_waitcnt vmcnt(1)
 s_cbranch_scc1 Lq1_57
 s_waitcnt vmcnt(0)
Lq1_57:
 buffer_load_dwordx4 v[36:39], v3, s[20:23], s39 offen offset:0 sc1
 buffer_load_dwordx4 v[40:43], v3, s[20:23], s39 offen offset:1024 sc1
 s_nop 15
 s_nop 11
 buffer_load_dwordx4 v[12:15], v3, s[20:23], s39 offen offset:0 sc1
 buffer_load_dwordx4 v[16:19], v3, s[20:23], s39 offen offset:1024 sc1
 s_waitcnt vmcnt(3)
 v_mfma_f32_16x16x32_bf16 v[48:51], v[44:47], v[36:39], 0
 s_waitcnt vmcnt(2)
 v_mfma_f32_16x16x32_bf16 v[48:51], v[44:47], v[40:43], v[48:51]
 v_bitop3_b32 v55, v37, v39, s46 bitop3:0x7e
 v_bitop3_b32 v56, v41, v43, s46 bitop3:0x7e
 v_bitop3_b32 v55, v55, 1, v56 bitop3:0xc8
 v_cmp_ne_u32 vcc, 0, v55
 s_nop 3
 v_add_f32_dpp v48, v48, v48 row_ror:4 row_mask:0xf bank_mask:0xf
 v_add_f32_dpp v49, v49, v49 row_ror:4 row_mask:0xf bank_mask:0xf
 s_cbranch_vccnz Lr2_59
 v_add_f32_dpp v48, v48, v48 row_ror:8 row_mask:0xf bank_mask:0xf
 v_add_f32_dpp v49, v49, v49 row_ror:8 row_mask:0xf bank_mask:0xf
 v_cvt_pk_bf16_f32 v48, v48, v49
 buffer_store_dword v48, v52, s[20:23], s44 offen
Lb1_60:
 buffer_store_dword v59, v52, s[20:23], s45 offen
 v_cmp_gt_u32 vcc, s58, v1
 v_mov_b64 v[36:37], 0
 v_mov_b64 v[38:39], 0
 v_mov_b64 v[40:41], 0
 v_mov_b64 v[42:43], 0
 v_mov_b64 v[44:45], 0
 v_mov_b64 v[46:47], 0
 v_mov_b64 v[48:49], 0
 v_mov_b64 v[50:51], 0
 s_cmp_lg_u32 vcc_hi, 0
 s_cbranch_scc1 Lfw_62
Lfok_61:
 v_lshl_add_u32 v1, v3, 3, s68
 v_mov_b32 v6, s56
 v_cndmask_b32 v1, v6, v1, s[70:71]
 v_min_u32 v6, 16, v0
 v_lshlrev_b32 v6, 24, v6
 s_max_u32 s47, s36, 1
 v_add_u32 v2, -1, s47
 s_waitcnt lgkmcnt(0)
 s_nop 15
 buffer_load_dwordx4 v[12:15], v3, s[20:23], s41 offen offset:0 sc1
 buffer_load_dwordx4 v[16:19], v3, s[20:23], s41 offen offset:1024 sc1
 s_nop 15
 s_nop 7
Lp2_63:
 buffer_load_dwordx4 v[12:15], v3, s[20:23], s41 offen offset:0 sc1
 buffer_load_dwordx4 v[16:19], v3, s[20:23], s41 offen offset:1024 sc1
 s_waitcnt vmcnt(2)
 v_max3_u32 v55, v12, v13, v14
 v_max3_u32 v55, v55, v15, v16
 v_max3_u32 v55, v55, v17, v18
 v_max_u32 v55, v55, v19
 ds_write_b128 v54, v[12:15] offset:0
 ds_write_b128 v54, v[16:19] offset:1024
 v_cmpx_eq_u32 vcc, -1, v55
 s_cbranch_execz Lstep_52
 buffer_load_dwordx4 v[12:15], v3, s[20:23], s41 offen offset:0 sc1
 buffer_load_dwordx4 v[16:19], v3, s[20:23], s41 offen offset:1024 sc1
 s_waitcnt vmcnt(2)
 v_max3_u32 v55, v12, v13, v14
 v_max3_u32 v55, v55, v15, v16
 v_max3_u32 v55, v55, v17, v18
 v_max_u32 v55, v55, v19
 ds_write_b128 v54, v[12:15] offset:0
 ds_write_b128 v54, v[16:19] offset:1024
 v_cmpx_eq_u32 vcc, -1, v55
 s_cbranch_execz Lstep_52
 buffer_load_dwordx4 v[12:15], v3, s[20:23], s41 offen offset:0 sc1
 buffer_load_dwordx4 v[16:19], v3, s[20:23], s41 offen offset:1024 sc1
 s_waitcnt vmcnt(2)
 v_max3_u32 v55, v12, v13, v14
 v_max3_u32 v55, v55, v15, v16
 v_max3_u32 v55, v55, v17, v18
 v_max_u32 v55, v55, v19
 ds_write_b128 v54, v[12:15] offset:0
 ds_write_b128 v54, v[16:19] offset:1024
 v_cmpx_eq_u32 vcc, -1, v55
 s_cbranch_execz Lstep_52
 s_sub_u32 s54, s54, 1
 s_cbranch_scc0 Lp2_63
 s_endpgm
LwH_56:
 v_bfe_u32 v53, v3, 8, 1
 v_bfe_u32 v58, v3, 9, 1
 v_lshl_or_b32 v53, v53, 1, v58
 v_bfe_u32 v58, v3, 5, 1
 v_lshl_or_b32 v53, v53, 1, v58
 v_and_b32 v58, 0xd0, v3
 v_lshlrev_b32 v58, 24, v58
 v_lshl_or_b32 v53, v53, 2, v58
 s_waitcnt vmcnt(2)
 buffer_load_dwordx4 v[20:23], v3, s[20:23], s40 offen offset:0 sc1
 buffer_load_dwordx4 v[24:27], v3, s[20:23], s40 offen offset:1024 sc1
 buffer_load_dwordx4 v[36:39], v3, s[20:23], s39 offen offset:0 sc1
 buffer_load_dwordx4 v[40:43], v3, s[20:23], s39 offen offset:1024 sc1
 s_xor_b32 s66, s66, 0x80000
 s_xor_b32 s41, s41, 0x80000
 s_xor_b32 s43, s43, 0x80000
 v_mov_b32 v47, 0x3f80
 v_cndmask_b32 v47, v47, 1.0, s[32:33]
 v_cndmask_b32 v44, 0, v47, s[24:25]
 v_cndmask_b32 v45, 0, v47, s[26:27]
 v_cndmask_b32 v46, 0, v47, s[28:29]
 v_cndmask_b32 v47, 0, v47, s[30:31]
 v_bfe_u32 v52, v3, 8, 2
 v_bfe_u32 v58, v3, 2, 4
 v_lshl_or_b32 v52, v52, 4, v58
 v_and_b32 v58, 0xc0, v3
 v_lshl_or_b32 v52, v58, 24, v52
 v_subrev_u32 v0, 0x20000, v0
 v_mov_b32 v59, -1
 v_add_u32 v54, s42, v3
 v_add_u32 v58, s69, v9
 ds_read_b64_tr_b16 v[64:65], v58 offset:19456
 v_mov_b32 v66, v2
 v_mov_b32 v67, v4
 s_waitcnt vmcnt(2)
 v_mfma_f32_16x16x32_bf16 v[28:31], v[44:47], v[20:23], 0
 v_mfma_f32_16x16x32_bf16 v[28:31], v[44:47], v[24:27], v[28:31]
 s_waitcnt vmcnt(1)
 v_mfma_f32_16x16x32_bf16 v[48:51], v[44:47], v[36:39], 0
 s_waitcnt vmcnt(0)
 v_mfma_f32_16x16x32_bf16 v[48:51], v[44:47], v[40:43], v[48:51]
 v_bitop3_b32 v55, v37, v39, s46 bitop3:0x7e
 v_bitop3_b32 v56, v41, v43, s46 bitop3:0x7e
 v_bitop3_b32 v57, v21, v23, s46 bitop3:0x7e
 v_or3_b32 v55, v55, v56, v57
 v_bitop3_b32 v56, v25, v27, s46 bitop3:0x7e
 v_bitop3_b32 v55, v55, 1, v56 bitop3:0xc8
 v_cmp_ne_u32 vcc, 0, v55
 v_add_f32_dpp v29, v29, v29 row_ror:4 row_mask:0xf bank_mask:0xf
 v_add_f32_dpp v48, v48, v48 row_ror:4 row_mask:0xf bank_mask:0xf
 v_add_f32_dpp v49, v49, v49 row_ror:4 row_mask:0xf bank_mask:0xf
 v_add_f32_dpp v29, v29, v29 row_ror:8 row_mask:0xf bank_mask:0xf
 v_add_f32_dpp v48, v48, v48 row_ror:8 row_mask:0xf bank_mask:0xf
 v_add_f32_dpp v49, v49, v49 row_ror:8 row_mask:0xf bank_mask:0xf
 s_cbranch_vccnz Lr1_64
 v_cvt_pk_bf16_f32 v48, v48, v49
 buffer_store_dword v48, v52, s[20:23], s44 offen
 v_mov_b32_dpp v30, v29 quad_perm:[1,0,3,2] row_mask:0xf bank_mask:0xf
 v_cvt_pk_bf16_f32 v29, v29, v30
 buffer_store_dword v29, v53, s[20:23], s65 offen
Lb1_65:
 buffer_store_dword v59, v52, s[20:23], s45 offen
 buffer_store_dword v59, v53, s[20:23], s66 offen
 v_cmp_gt_u32 vcc, s58, v1
 ds_read_b128 v[20:23], v0 offset:24576
 ds_read_b128 v[24:27], v0 offset:28672
 ds_read_b128 v[28:31], v0 offset:32768
 ds_read_b128 v[32:35], v0 offset:36864
 v_mov_b64 v[36:37], 0
 v_mov_b64 v[38:39], 0
 v_mov_b64 v[40:41], 0
 v_mov_b64 v[42:43], 0
 v_mov_b64 v[44:45], 0
 v_mov_b64 v[46:47], 0
 v_mov_b64 v[48:49], 0
 v_mov_b64 v[50:51], 0
 s_cmp_lg_u32 vcc_hi, 0
 s_cbranch_scc1 Lfw_67
Lfok_66:
 v_lshl_add_u32 v1, v3, 3, s68
 v_mov_b32 v6, s56
 v_cndmask_b32 v1, v6, v1, s[70:71]
 v_min_u32 v6, 16, v0
 v_lshlrev_b32 v6, 24, v6
 s_max_u32 s47, s36, 1
 v_add_u32 v2, -1, s47
 s_waitcnt lgkmcnt(0)
 s_nop 9
 buffer_load_dwordx4 v[12:15], v3, s[20:23], s41 offen offset:0 sc1
 buffer_load_dwordx4 v[16:19], v3, s[20:23], s41 offen offset:1024 sc1
 buffer_load_dwordx4 v[68:71], v3, s[20:23], s43 offen offset:0 sc1
 s_nop 15
 s_nop 7
Lp2_68:
 buffer_load_dwordx4 v[12:15], v3, s[20:23], s41 offen offset:0 sc1
 buffer_load_dwordx4 v[16:19], v3, s[20:23], s41 offen offset:1024 sc1
 buffer_load_dwordx4 v[68:71], v3, s[20:23], s43 offen offset:0 sc1
 s_waitcnt vmcnt(3)
 v_max3_u32 v55, v12, v13, v14
 v_max3_u32 v55, v55, v15, v16
 v_max3_u32 v55, v55, v17, v18
 v_max3_u32 v55, v55, v19, v68
 v_max3_u32 v55, v55, v69, v70
 v_max_u32 v55, v55, v71
 ds_write_b128 v54, v[12:15] offset:0
 ds_write_b128 v54, v[16:19] offset:1024
 ds_write_b128 v54, v[68:71] offset:8192
 v_cmpx_eq_u32 vcc, -1, v55
 s_cbranch_execz Lstep_52
 buffer_load_dwordx4 v[12:15], v3, s[20:23], s41 offen offset:0 sc1
 buffer_load_dwordx4 v[16:19], v3, s[20:23], s41 offen offset:1024 sc1
 buffer_load_dwordx4 v[68:71], v3, s[20:23], s43 offen offset:0 sc1
 s_waitcnt vmcnt(3)
 v_max3_u32 v55, v12, v13, v14
 v_max3_u32 v55, v55, v15, v16
 v_max3_u32 v55, v55, v17, v18
 v_max3_u32 v55, v55, v19, v68
 v_max3_u32 v55, v55, v69, v70
 v_max_u32 v55, v55, v71
 ds_write_b128 v54, v[12:15] offset:0
 ds_write_b128 v54, v[16:19] offset:1024
 ds_write_b128 v54, v[68:71] offset:8192
 v_cmpx_eq_u32 vcc, -1, v55
 s_cbranch_execz Lstep_52
 buffer_load_dwordx4 v[12:15], v3, s[20:23], s41 offen offset:0 sc1
 buffer_load_dwordx4 v[16:19], v3, s[20:23], s41 offen offset:1024 sc1
 buffer_load_dwordx4 v[68:71], v3, s[20:23], s43 offen offset:0 sc1
 s_waitcnt vmcnt(3)
 v_max3_u32 v55, v12, v13, v14
 v_max3_u32 v55, v55, v15, v16
 v_max3_u32 v55, v55, v17, v18
 v_max3_u32 v55, v55, v19, v68
 v_max3_u32 v55, v55, v69, v70
 v_max_u32 v55, v55, v71
 ds_write_b128 v54, v[12:15] offset:0
 ds_write_b128 v54, v[16:19] offset:1024
 ds_write_b128 v54, v[68:71] offset:8192
 v_cmpx_eq_u32 vcc, -1, v55
 s_cbranch_execz Lstep_52
 s_sub_u32 s54, s54, 1
 s_cbranch_scc0 Lp2_68
 s_endpgm
Lr1_64:
 s_mov_b64 exec, vcc
Lrt_69:
 buffer_load_dwordx4 v[20:23], v3, s[20:23], s40 offen offset:0 sc1
 buffer_load_dwordx4 v[24:27], v3, s[20:23], s40 offen offset:1024 sc1
 buffer_load_dwordx4 v[36:39], v3, s[20:23], s39 offen offset:0 sc1
 buffer_load_dwordx4 v[40:43], v3, s[20:23], s39 offen offset:1024 sc1
 s_waitcnt vmcnt(4)
 v_bitop3_b32 v55, v37, v39, s46 bitop3:0x7e
 v_bitop3_b32 v56, v41, v43, s46 bitop3:0x7e
 v_bitop3_b32 v57, v21, v23, s46 bitop3:0x7e
 v_or3_b32 v55, v55, v56, v57
 v_bitop3_b32 v56, v25, v27, s46 bitop3:0x7e
 v_bitop3_b32 v55, v55, 1, v56 bitop3:0xc8
 v_cmpx_ne_u32 vcc, 0, v55
 s_cbranch_execz Lrte_70
 buffer_load_dwordx4 v[20:23], v3, s[20:23], s40 offen offset:0 sc1
 buffer_load_dwordx4 v[24:27], v3, s[20:23], s40 offen offset:1024 sc1
 buffer_load_dwordx4 v[36:39], v3, s[20:23], s39 offen offset:0 sc1
 buffer_load_dwordx4 v[40:43], v3, s[20:23], s39 offen offset:1024 sc1
 s_waitcnt vmcnt(4)
 v_bitop3_b32 v55, v37, v39, s46 bitop3:0x7e
 v_bitop3_b32 v56, v41, v43, s46 bitop3:0x7e
 v_bitop3_b32 v57, v21, v23, s46 bitop3:0x7e
 v_or3_b32 v55, v55, v56, v57
 v_bitop3_b32 v56, v25, v27, s46 bitop3:0x7e
 v_bitop3_b32 v55, v55, 1, v56 bitop3:0xc8
 v_cmpx_ne_u32 vcc, 0, v55
 s_cbranch_execz Lrte_70
 buffer_load_dwordx4 v[20:23], v3, s[20:23], s40 offen offset:0 sc1
 buffer_load_dwordx4 v[24:27], v3, s[20:23], s40 offen offset:1024 sc1
 buffer_load_dwordx4 v[36:39], v3, s[20:23], s39 offen offset:0 sc1
 buffer_load_dwordx4 v[40:43], v3, s[20:23], s39 offen offset:1024 sc1
 s_waitcnt vmcnt(4)
 v_bitop3_b32 v55, v37, v39, s46 bitop3:0x7e
 v_bitop3_b32 v56, v41, v43, s46 bitop3:0x7e
 v_bitop3_b32 v57, v21, v23, s46 bitop3:0x7e
 v_or3_b32 v55, v55, v56, v57
 v_bitop3_b32 v56, v25, v27, s46 bitop3:0x7e
 v_bitop3_b32 v55, v55, 1, v56 bitop3:0xc8
 v_cmpx_ne_u32 vcc, 0, v55
 s_cbranch_execz Lrte_70
 s_sub_u32 s54, s54, 1
 s_cbranch_scc0 Lrt_69
 s_endpgm
Lrte_70:
 s_mov_b64 exec, -1
 s_nop 2
 v_mfma_f32_16x16x32_bf16 v[28:31], v[44:47], v[20:23], 0
 v_mfma_f32_16x16x32_bf16 v[28:31], v[44:47], v[24:27], v[28:31]
 v_mfma_f32_16x16x32_bf16 v[48:51], v[44:47], v[36:39], 0
 v_mfma_f32_16x16x32_bf16 v[48:51], v[44:47], v[40:43], v[48:51]
 s_nop 6
 v_add_f32_dpp v29, v29, v29 row_ror:4 row_mask:0xf bank_mask:0xf
 v_add_f32_dpp v48, v48, v48 row_ror:4 row_mask:0xf bank_mask:0xf
 v_add_f32_dpp v49, v49, v49 row_ror:4 row_mask:0xf bank_mask:0xf
 v_add_f32_dpp v29, v29, v29 row_ror:8 row_mask:0xf bank_mask:0xf
 v_add_f32_dpp v48, v48, v48 row_ror:8 row_mask:0xf bank_mask:0xf
 v_add_f32_dpp v49, v49, v49 row_ror:8 row_mask:0xf bank_mask:0xf
 v_cvt_pk_bf16_f32 v48, v48, v49
 buffer_store_dword v48, v52, s[20:23], s44 offen
 v_mov_b32_dpp v30, v29 quad_perm:[1,0,3,2] row_mask:0xf bank_mask:0xf
 v_cvt_pk_bf16_f32 v29, v29, v30
 buffer_store_dword v29, v53, s[20:23], s65 offen
 s_waitcnt vmcnt(2)
 s_branch Lb1_65
Lmx_54:
 s_waitcnt lgkmcnt(0)
 ds_read_b128 v[36:39], v11 offset:17408
 ds_read_b128 v[40:43], v11 offset:17920
 ds_read_b128 v[44:47], v11 offset:18432
 ds_read_b128 v[48:51], v11 offset:18944
 v_mov_b64 v[28:29], 0
 v_mov_b64 v[30:31], 0
 ds_read_b128 v[52:55], v3 offset:9216
 ds_read_b128 v[56:59], v3 offset:10240
 s_waitcnt lgkmcnt(0)
 v_mfma_f32_16x16x32_bf16 v[20:23], v[52:55], v[36:39], 0
 v_mfma_f32_16x16x32_bf16 v[24:27], v[56:59], v[36:39], 0
 ds_read_b128 v[52:55], v3 offset:11264
 ds_read_b128 v[56:59], v3 offset:12288
 s_waitcnt lgkmcnt(0)
 v_mfma_f32_16x16x32_bf16 v[20:23], v[52:55], v[40:43], v[20:23]
 v_mfma_f32_16x16x32_bf16 v[24:27], v[56:59], v[40:43], v[24:27]
 ds_read_b128 v[52:55], v3 offset:13312
 ds_read_b128 v[56:59], v3 offset:14336
 s_waitcnt lgkmcnt(0)
 v_mfma_f32_16x16x32_bf16 v[20:23], v[52:55], v[44:47], v[20:23]
 v_mfma_f32_16x16x32_bf16 v[24:27], v[56:59], v[44:47], v[24:27]
 ds_read_b128 v[52:55], v3 offset:15360
 ds_read_b128 v[56:59], v3 offset:16384
 s_waitcnt lgkmcnt(0)
 v_mfma_f32_16x16x32_bf16 v[20:23], v[52:55], v[48:51], v[20:23]
 v_mfma_f32_16x16x32_bf16 v[24:27], v[56:59], v[48:51], v[24:27]
 ds_read_b64_tr_b16 v[52:53], v9 offset:19456
 ds_read_b64_tr_b16 v[54:55], v9 offset:19488
 ds_read_b64_tr_b16 v[56:57], v9 offset:20544
 ds_read_b64_tr_b16 v[58:59], v9 offset:20576
 s_waitcnt lgkmcnt(0)
 v_smfmac_f32_16x16x64_bf16 v[28:31], v[52:55], v[36:43], v5
 v_smfmac_f32_16x16x64_bf16 v[28:31], v[56:59], v[44:51], v5
 ds_read_b128 v[36:39], v0 offset:32768
 ds_read_b128 v[40:43], v0 offset:36864
 ds_read_b128 v[44:47], v0 offset:40960
 ds_read_b128 v[48:51], v0 offset:45056
 v_mov_b64 v[32:33], s[34:35]
 v_mov_b64 v[34:35], s[34:35]
 s_nop 1
 v_add_f32 v28, v28, v30
 v_add_f32 v29, v29, v31
 v_mul_f32 v28, s55, v28
 v_mul_f32 v29, s55, v29
 v_max_f32 v30, v28, v29
 v_cndmask_b32 v28, v28, v29, s[48:49]
 v_max3_f32 v30, v30, v20, v21
 v_max3_f32 v30, v30, v22, v23
 v_max3_f32 v30, v30, v24, v25
 v_max3_f32 v31, v30, v26, v27
 v_max3_f32 v29, v30, v26, v27
 v_cndmask_b32 v20, v20, v24, s[48:49]
 v_cndmask_b32 v21, v21, v25, s[48:49]
 v_permlane16_swap_b32 v31, v29
 v_max_f32 v30, v31, v29
 v_max_f32 v6, v31, v29
 v_cndmask_b32 v22, v22, v26, s[48:49]
 v_cndmask_b32 v23, v23, v27, s[48:49]
 v_permlane32_swap_b32 v30, v6
 v_max_f32 v30, v30, v6
 v_sub_f32 v28, v28, v30
 v_sub_f32 v20, v20, v30
 v_sub_f32 v21, v21, v30
 v_sub_f32 v22, v22, v30
 v_sub_f32 v23, v23, v30
 v_exp_f32 v28, v28
 v_exp_f32 v20, v20
 v_exp_f32 v21, v21
 v_exp_f32 v22, v22
 v_exp_f32 v23, v23
 v_cndmask_b32 v29, 0, v28, s[48:49]
 v_cndmask_b32 v28, v28, 0, s[48:49]
 v_cvt_pk_bf16_f32 v6, v28, v29
 v_cvt_pk_bf16_f32 v30, v20, v21
 v_cvt_pk_bf16_f32 v31, v22, v23
 v_mfma_f32_16x16x16_bf16 v[60:63], v[6:7], v[32:33], 0
 v_mfma_f32_16x16x16_bf16 v[52:55], v[6:7], v[2:3], 0
 v_mfma_f32_16x16x16_bf16 v[56:59], v[6:7], v[4:5], 0
 v_smfmac_f32_16x16x32_bf16 v[60:63], v[30:31], v[32:35], v5
 v_smfmac_f32_16x16x32_bf16 v[52:55], v[30:31], v[12:15], v5
 v_smfmac_f32_16x16x32_bf16 v[56:59], v[30:31], v[16:19], v5
 s_nop 0
 v_add_f32 v60, v60, v62
 v_add_f32 v61, v61, v63
 v_rcp_f32 v60, v60
 v_rcp_f32 v61, v61
 v_add_f32 v52, v52, v54
 v_add_f32 v53, v53, v55
 v_mul_f32 v52, v52, v60
 v_mul_f32 v53, v53, v61
 v_add_f32 v56, v56, v58
 v_add_f32 v57, v57, v59
 v_mul_f32 v56, v56, v60
 v_mul_f32 v57, v57, v61
 v_cvt_pk_bf16_f32 v52, v52, v53
 v_cvt_pk_bf16_f32 v53, v56, v57
 ds_write_b64 v8, v[52:53] offset:21632
 v_mov_b64 v[20:21], 0
 v_mov_b64 v[22:23], 0
 v_mov_b64 v[24:25], 0
 v_mov_b64 v[26:27], 0
 v_mov_b64 v[28:29], 0
 v_mov_b64 v[30:31], 0
 v_mov_b64 v[32:33], 0
 v_mov_b64 v[34:35], 0
 s_waitcnt lgkmcnt(0)
 s_branch Lmxb_55
Lr2_59:
 s_waitcnt vmcnt(1)
 v_mfma_f32_16x16x32_bf16 v[48:51], v[44:47], v[12:15], 0
 s_waitcnt vmcnt(0)
 v_mfma_f32_16x16x32_bf16 v[48:51], v[44:47], v[16:19], v[48:51]
 v_bitop3_b32 v55, v13, v15, s46 bitop3:0x7e
 v_bitop3_b32 v56, v17, v19, s46 bitop3:0x7e
 v_bitop3_b32 v55, v55, 1, v56 bitop3:0xc8
 v_cmp_ne_u32 vcc, 0, v55
 s_nop 3
 v_add_f32_dpp v48, v48, v48 row_ror:4 row_mask:0xf bank_mask:0xf
 v_add_f32_dpp v49, v49, v49 row_ror:4 row_mask:0xf bank_mask:0xf
 s_cbranch_vccnz Lr1_58
 v_add_f32_dpp v48, v48, v48 row_ror:8 row_mask:0xf bank_mask:0xf
 v_add_f32_dpp v49, v49, v49 row_ror:8 row_mask:0xf bank_mask:0xf
 v_cvt_pk_bf16_f32 v48, v48, v49
 buffer_store_dword v48, v52, s[20:23], s44 offen
 s_branch Lb1_60
Lr1_58:
 s_mov_b64 exec, vcc
Lrt_71:
 buffer_load_dwordx4 v[12:15], v3, s[20:23], s39 offen offset:0 sc1
 buffer_load_dwordx4 v[16:19], v3, s[20:23], s39 offen offset:1024 sc1
 s_waitcnt vmcnt(2)
 v_bitop3_b32 v55, v13, v15, s46 bitop3:0x7e
 v_bitop3_b32 v56, v17, v19, s46 bitop3:0x7e
 v_bitop3_b32 v55, v55, 1, v56 bitop3:0xc8
 v_cmpx_ne_u32 vcc, 0, v55
 s_cbranch_execz Lrte_72
 buffer_load_dwordx4 v[12:15], v3, s[20:23], s39 offen offset:0 sc1
 buffer_load_dwordx4 v[16:19], v3, s[20:23], s39 offen offset:1024 sc1
 s_waitcnt vmcnt(2)
 v_bitop3_b32 v55, v13, v15, s46 bitop3:0x7e
 v_bitop3_b32 v56, v17, v19, s46 bitop3:0x7e
 v_bitop3_b32 v55, v55, 1, v56 bitop3:0xc8
 v_cmpx_ne_u32 vcc, 0, v55
 s_cbranch_execz Lrte_72
 buffer_load_dwordx4 v[12:15], v3, s[20:23], s39 offen offset:0 sc1
 buffer_load_dwordx4 v[16:19], v3, s[20:23], s39 offen offset:1024 sc1
 s_waitcnt vmcnt(2)
 v_bitop3_b32 v55, v13, v15, s46 bitop3:0x7e
 v_bitop3_b32 v56, v17, v19, s46 bitop3:0x7e
 v_bitop3_b32 v55, v55, 1, v56 bitop3:0xc8
 v_cmpx_ne_u32 vcc, 0, v55
 s_cbranch_execz Lrte_72
 s_sub_u32 s54, s54, 1
 s_cbranch_scc0 Lrt_71
 s_endpgm
Lrte_72:
 s_mov_b64 exec, -1
 s_nop 2
 v_mfma_f32_16x16x32_bf16 v[48:51], v[44:47], v[12:15], 0
 v_mfma_f32_16x16x32_bf16 v[48:51], v[44:47], v[16:19], v[48:51]
 s_nop 7
 v_add_f32_dpp v48, v48, v48 row_ror:4 row_mask:0xf bank_mask:0xf
 v_add_f32_dpp v49, v49, v49 row_ror:4 row_mask:0xf bank_mask:0xf
 s_nop 0
 v_add_f32_dpp v48, v48, v48 row_ror:8 row_mask:0xf bank_mask:0xf
 v_add_f32_dpp v49, v49, v49 row_ror:8 row_mask:0xf bank_mask:0xf
 v_cvt_pk_bf16_f32 v48, v48, v49
 buffer_store_dword v48, v52, s[20:23], s44 offen
 s_branch Lb1_60
Lfw_62:
Lpb_73:
 buffer_load_dword v1, v7, s[20:23], s56 offen sc1
 s_waitcnt vmcnt(0)
 v_cmp_le_u32 vcc, s58, v1
 s_cbranch_vccnz Lpbok_74
 s_sub_u32 s54, s54, 1
 s_cbranch_scc0 Lpb_73
 s_endpgm
Lpbok_74:
 s_branch Lfok_61
Lfw_67:
Lpb_75:
 buffer_load_dword v1, v7, s[20:23], s56 offen sc1
 s_waitcnt vmcnt(0)
 v_cmp_le_u32 vcc, s58, v1
 s_cbranch_vccnz Lpbok_76
 s_sub_u32 s54, s54, 1
 s_cbranch_scc0 Lpb_75
 s_endpgm
Lpbok_76:
 s_branch Lfok_66
Lfail_53:
 s_endpgm
Lslow_50:
 .p2align 3
Lstep_77:
 s_mov_b64 exec, -1
 s_waitcnt lgkmcnt(0)
 buffer_load_dwordx4 v[12:15], v3, s[20:23], s59 offen offset:0 sc1
 buffer_load_dwordx4 v[16:19], v3, s[20:23], s59 offen offset:1024 sc1
 s_barrier
 ds_read_b128 v[52:55], v3 offset:0
 ds_read_b128 v[56:59], v3 offset:1024
 ds_read_b128 v[60:63], v3 offset:2048
 buffer_store_dwordx4 v[64:67], v0, s[20:23], s38 offen sc1
 s_waitcnt lgkmcnt(2)
 v_smfmac_f32_16x16x64_bf16 v[36:39], v[52:55], v[72:79], v5
 v_smfmac_f32_16x16x64_bf16 v[40:43], v[52:55], v[80:87], v5
 buffer_load_dword v1, v1, s[20:23], 0 offen sc1
 v_smfmac_f32_16x16x64_bf16 v[44:47], v[52:55], v[88:95], v5
 s_waitcnt lgkmcnt(1)
 v_smfmac_f32_16x16x64_bf16 v[48:51], v[52:55], v[20:27], v5
 buffer_store_dword v2, v6, s[20:23], s57 offen sc1
 v_smfmac_f32_16x16x64_bf16 v[36:39], v[56:59], v[112:119], v5
 ds_read_b128 v[20:23], v0 offset:40960
 v_smfmac_f32_16x16x64_bf16 v[40:43], v[56:59], v[120:127], v5
 ds_read_b128 v[24:27], v0 offset:45056
 v_smfmac_f32_16x16x64_bf16 v[44:47], v[56:59], v[128:135], v5
 ds_read_b128 v[52:55], v3 offset:3072
 s_waitcnt lgkmcnt(3)
 v_smfmac_f32_16x16x64_bf16 v[48:51], v[56:59], v[28:35], v5
 v_smfmac_f32_16x16x64_bf16 v[36:39], v[60:63], v[152:159], v5
 ds_read_b128 v[28:31], v0 offset:49152
 v_smfmac_f32_16x16x64_bf16 v[40:43], v[60:63], v[160:167], v5
 ds_read_b128 v[32:35], v0 offset:53248
 v_smfmac_f32_16x16x64_bf16 v[44:47], v[60:63], v[168:175], v5
 ds_read_b128 v[56:59], v3 offset:4096
 s_waitcnt lgkmcnt(3)
 v_smfmac_f32_16x16x64_bf16 v[48:51], v[60:63], v[20:27], v5
 v_smfmac_f32_16x16x64_bf16 v[36:39], v[52:55], v[192:199], v5
 ds_read_b128 v[20:23], v0 offset:57344
 v_smfmac_f32_16x16x64_bf16 v[40:43], v[52:55], v[200:207], v5
 ds_read_b128 v[24:27], v0 offset:61440
 v_smfmac_f32_16x16x64_bf16 v[44:47], v[52:55], v[208:215], v5
 ds_read_b128 v[60:63], v3 offset:5120
 s_waitcnt lgkmcnt(3)
 v_add_u32 v0, 0x10000, v0
 v_smfmac_f32_16x16x64_bf16 v[48:51], v[52:55], v[28:35], v5
 v_smfmac_f32_16x16x64_bf16 v[36:39], v[56:59], v[232:239], v5
 ds_read_b128 v[28:31], v0 offset:0
 v_smfmac_f32_16x16x64_bf16 v[40:43], v[56:59], v[240:247], v5
 ds_read_b128 v[32:35], v0 offset:4096
 v_smfmac_f32_16x16x64_bf16 v[44:47], v[56:59], v[248:255], v5
 ds_read_b128 v[52:55], v3 offset:6144
 s_waitcnt lgkmcnt(3)
 v_smfmac_f32_16x16x64_bf16 v[48:51], v[56:59], v[20:27], v5
 v_smfmac_f32_16x16x64_bf16 v[36:39], v[60:63], a[16:23], v5
 ds_read_b128 v[20:23], v0 offset:8192
 v_smfmac_f32_16x16x64_bf16 v[40:43], v[60:63], a[24:31], v5
 ds_read_b128 v[24:27], v0 offset:12288
 v_smfmac_f32_16x16x64_bf16 v[44:47], v[60:63], a[32:39], v5
 ds_read_b128 v[56:59], v3 offset:7168
 s_waitcnt lgkmcnt(3)
 v_smfmac_f32_16x16x64_bf16 v[48:51], v[60:63], v[28:35], v5
 s_waitcnt vmcnt(5)
 v_smfmac_f32_16x16x64_bf16 v[36:39], v[52:55], a[56:63], v5
 ds_read_b128 v[28:31], v0 offset:16384
 v_mov_b64 v[64:65], 0
 v_smfmac_f32_16x16x64_bf16 v[40:43], v[52:55], a[64:71], v5
 ds_read_b128 v[32:35], v0 offset:20480
 v_mov_b64 v[66:67], 0
 v_smfmac_f32_16x16x64_bf16 v[44:47], v[52:55], a[72:79], v5
 ds_read_b128 v[60:63], v3 offset:8192
 s_waitcnt lgkmcnt(3)
 v_mov_b64 v[68:69], 0
 v_smfmac_f32_16x16x64_bf16 v[48:51], v[52:55], v[20:27], v5
 v_mov_b64 v[70:71], 0
 v_smfmac_f32_16x16x64_bf16 v[36:39], v[56:59], a[96:103], v5
 ds_read_b128 v[20:23], v0 offset:24576
 ds_read_b128 v[24:27], v0 offset:28672
 v_smfmac_f32_16x16x64_bf16 v[40:43], v[56:59], a[104:111], v5
 ds_read_b128 v[52:55], v3 offset:0
 s_waitcnt lgkmcnt(3)
 v_smfmac_f32_16x16x64_bf16 v[36:39], v[60:63], a[136:143], v5
 v_smfmac_f32_16x16x64_bf16 v[40:43], v[60:63], a[144:151], v5
 v_smfmac_f32_16x16x64_bf16 v[44:47], v[56:59], a[112:119], v5
 s_nop 0
 v_add_f32 v36, v36, v38
 v_add_f32 v37, v37, v39
 v_smfmac_f32_16x16x64_bf16 v[48:51], v[56:59], v[28:35], v5
 ds_read_b128 v[56:59], v3 offset:1024
 s_waitcnt lgkmcnt(1)
 v_cvt_pk_bf16_f32 v36, v36, v37
 v_add_f32 v40, v40, v42
 v_smfmac_f32_16x16x64_bf16 v[44:47], v[60:63], a[152:159], v5
 ds_write_b16 v10, v36 offset:17408
 ds_write_b16_d16_hi v10, v36 offset:17472
 v_add_f32 v41, v41, v43
 v_cvt_pk_bf16_f32 v40, v40, v41
 v_smfmac_f32_16x16x64_bf16 v[48:51], v[60:63], v[20:27], v5
 ds_write_b16 v10, v40 offset:17412
 ds_write_b16_d16_hi v10, v40 offset:17476
 v_mov_b64 v[28:29], 0
 v_smfmac_f32_16x16x64_bf16 v[64:67], v[52:55], v[96:103], v5
 ds_read_b128 v[60:63], v3 offset:2048
 ds_read_b128 v[20:23], v3 offset:9216
 v_add_f32 v44, v44, v46
 v_add_f32 v45, v45, v47
 v_smfmac_f32_16x16x64_bf16 v[68:71], v[52:55], v[104:111], v5
 s_waitcnt lgkmcnt(6)
 v_cvt_pk_bf16_f32 v44, v44, v45
 v_add_f32 v48, v48, v50
 v_add_f32 v49, v49, v51
 v_cvt_pk_bf16_f32 v45, v48, v49
 ds_write_b64 v8, v[44:45] offset:19456
 v_smfmac_f32_16x16x64_bf16 v[64:67], v[56:59], v[136:143], v5
 ds_read_b128 v[52:55], v3 offset:3072
 ds_read_b128 v[24:27], v3 offset:10240
 v_mov_b64 v[30:31], 0
 v_smfmac_f32_16x16x64_bf16 v[68:71], v[56:59], v[144:151], v5
 ds_read_b128 v[56:59], v3 offset:4096
 s_waitcnt lgkmcnt(5)
 v_smfmac_f32_16x16x64_bf16 v[64:67], v[60:63], v[176:183], v5
 ds_read_b128 v[32:35], v3 offset:11264
 v_smfmac_f32_16x16x64_bf16 v[68:71], v[60:63], v[184:191], v5
 s_waitcnt lgkmcnt(4)
 s_barrier
 ds_read_b128 v[36:39], v11 offset:17408
 ds_read_b128 v[40:43], v11 offset:17920
 s_waitcnt lgkmcnt(5)
 v_smfmac_f32_16x16x64_bf16 v[64:67], v[52:55], v[216:223], v5
 ds_read_b64_tr_b16 v[60:61], v9 offset:19456
 ds_read_b64_tr_b16 v[62:63], v9 offset:19488
 v_smfmac_f32_16x16x64_bf16 v[68:71], v[52:55], v[224:231], v5
 ds_read_b128 v[52:55], v3 offset:5120
 ds_read_b128 v[44:47], v11 offset:18432
 s_waitcnt lgkmcnt(7)
 v_smfmac_f32_16x16x64_bf16 v[64:67], v[56:59], a[0:7], v5
 ds_read_b128 v[48:51], v11 offset:18944
 v_smfmac_f32_16x16x64_bf16 v[68:71], v[56:59], a[8:15], v5
 ds_read_b128 v[56:59], v3 offset:6144
 s_waitcnt lgkmcnt(7)
 v_mfma_f32_16x16x32_bf16 v[20:23], v[20:23], v[36:39], 0
 v_mfma_f32_16x16x32_bf16 v[24:27], v[24:27], v[36:39], 0
 s_waitcnt lgkmcnt(6)
 v_mfma_f32_16x16x32_bf16 v[20:23], v[32:35], v[40:43], v[20:23]
 ds_read_b128 v[32:35], v3 offset:12288
 s_waitcnt lgkmcnt(5)
 v_smfmac_f32_16x16x64_bf16 v[28:31], v[60:63], v[36:43], v5
 ds_read_b64_tr_b16 v[60:61], v9 offset:20544
 ds_read_b64_tr_b16 v[62:63], v9 offset:20576
 s_waitcnt lgkmcnt(6)
 v_smfmac_f32_16x16x64_bf16 v[64:67], v[52:55], a[40:47], v5
 ds_read_b128 v[36:39], v3 offset:13312
 v_smfmac_f32_16x16x64_bf16 v[68:71], v[52:55], a[48:55], v5
 ds_read_b128 v[52:55], v3 offset:7168
 s_waitcnt lgkmcnt(4)
 v_mfma_f32_16x16x32_bf16 v[24:27], v[32:35], v[40:43], v[24:27]
 ds_read_b128 v[40:43], v3 offset:14336
 s_waitcnt lgkmcnt(3)
 v_smfmac_f32_16x16x64_bf16 v[28:31], v[60:63], v[44:51], v5
 ds_read_b128 v[32:35], v3 offset:15360
 ds_read_b128 v[60:63], v3 offset:16384
 v_smfmac_f32_16x16x64_bf16 v[64:67], v[56:59], a[80:87], v5
 v_smfmac_f32_16x16x64_bf16 v[68:71], v[56:59], a[88:95], v5
 ds_read_b128 v[56:59], v3 offset:8192
 s_waitcnt lgkmcnt(5)
 v_mfma_f32_16x16x32_bf16 v[20:23], v[36:39], v[44:47], v[20:23]
 v_add_f32 v28, v28, v30
 v_add_f32 v29, v29, v31
 s_waitcnt lgkmcnt(4)
 v_smfmac_f32_16x16x64_bf16 v[64:67], v[52:55], a[120:127], v5
 v_cndmask_b32 v28, v28, v29, s[48:49]
 v_smfmac_f32_16x16x64_bf16 v[68:71], v[52:55], a[128:135], v5
 ds_read_b128 v[36:39], v0 offset:32768
 v_mul_f32 v28, s55, v28
 s_waitcnt lgkmcnt(4)
 v_mfma_f32_16x16x32_bf16 v[24:27], v[40:43], v[44:47], v[24:27]
 v_exp_f32 v28, v28
 s_waitcnt lgkmcnt(1)
 v_smfmac_f32_16x16x64_bf16 v[64:67], v[56:59], a[160:167], v5
 ds_read_b128 v[40:43], v0 offset:36864
 v_cndmask_b32 v29, 0, v28, s[48:49]
 v_smfmac_f32_16x16x64_bf16 v[68:71], v[56:59], a[168:175], v5
 ds_read_b128 v[44:47], v0 offset:40960
 v_cndmask_b32 v28, v28, 0, s[48:49]
 v_mfma_f32_16x16x32_bf16 v[20:23], v[32:35], v[48:51], v[20:23]
 v_cvt_pk_bf16_f32 v6, v28, v29
 v_mov_b64 v[32:33], s[34:35]
 v_mfma_f32_16x16x32_bf16 v[24:27], v[60:63], v[48:51], v[24:27]
 ds_read_b128 v[48:51], v0 offset:45056
 v_mov_b64 v[34:35], s[34:35]
 v_add_f32 v64, v64, v66
 v_add_f32 v65, v65, v67
 v_cvt_pk_bf16_f32 v2, v64, v65
 v_add_f32 v68, v68, v70
 v_add_f32 v69, v69, v71
 v_cvt_pk_bf16_f32 v4, v68, v69
 v_cndmask_b32 v20, v20, v24, s[48:49]
 v_cndmask_b32 v21, v21, v25, s[48:49]
 v_cndmask_b32 v22, v22, v26, s[48:49]
 v_cndmask_b32 v23, v23, v27, s[48:49]
 v_mfma_f32_16x16x16_bf16 v[60:63], v[6:7], v[32:33], 0
 s_waitcnt vmcnt(3)
 v_exp_f32 v20, v20
 v_mfma_f32_16x16x16_bf16 v[52:55], v[6:7], v[2:3], 0
 s_cmp_eq_u32 s36, 63
 v_exp_f32 v21, v21
 v_mfma_f32_16x16x16_bf16 v[56:59], v[6:7], v[4:5], 0
 v_exp_f32 v22, v22
 v_exp_f32 v23, v23
 v_cvt_pk_bf16_f32 v30, v20, v21
 v_cvt_pk_bf16_f32 v31, v22, v23
 v_mov_b64 v[64:65], 0
 v_mov_b64 v[66:67], 0
 v_smfmac_f32_16x16x32_bf16 v[60:63], v[30:31], v[32:35], v5
 v_mov_b64 v[68:69], 0
 v_mov_b64 v[70:71], 0
 v_smfmac_f32_16x16x32_bf16 v[52:55], v[30:31], v[12:15], v5
 v_mov_b64 v[20:21], 0
 v_mov_b64 v[22:23], 0
 v_smfmac_f32_16x16x32_bf16 v[56:59], v[30:31], v[16:19], v5
 s_nop 0
 v_add_f32 v60, v60, v62
 v_add_f32 v61, v61, v63
 v_rcp_f32 v60, v60
 v_rcp_f32 v61, v61
 v_add_f32 v52, v52, v54
 v_add_f32 v53, v53, v55
 v_mul_f32 v52, v52, v60
 v_mul_f32 v53, v53, v61
 v_add_f32 v56, v56, v58
 v_add_f32 v57, v57, v59
 v_mul_f32 v56, v56, v60
 v_mul_f32 v57, v57, v61
 v_cvt_pk_bf16_f32 v52, v52, v53
 v_cvt_pk_bf16_f32 v53, v56, v57
 ds_write_b64 v8, v[52:53] offset:21632
 v_subrev_u32 v60, 0x21800000, v60
 v_subrev_u32 v61, 0x21800000, v61
 v_max_u32 v60, v60, v61
 v_cmp_lt_u32 vcc, 0x3c000000, v60
 s_cbranch_scc1 Lchexit_51
 v_mov_b64 v[24:25], 0
 v_mov_b64 v[26:27], 0
 v_mov_b64 v[28:29], 0
 v_mov_b64 v[30:31], 0
 s_cbranch_vccnz Lmx_79
Lmxb_80:
 s_waitcnt lgkmcnt(0)
 v_mov_b64 v[32:33], 0
 s_barrier
 ds_read_b64_tr_b16 v[52:53], v9 offset:21632
 v_mov_b64 v[34:35], 0
 ds_read_b64_tr_b16 v[54:55], v9 offset:21664
 ds_read_b64_tr_b16 v[56:57], v9 offset:22720
 v_bfe_u32 v6, v0, 7, 5
 ds_read_b64_tr_b16 v[58:59], v9 offset:22752
 ds_read_b128 v[12:15], v0 offset:49152
 v_mul_u32_u24 v6, 10496, v6
 ds_read_b128 v[16:19], v0 offset:53248
 s_add_u32 s67, s67, 0x80000
 v_bfe_u32 v60, v3, 4, 3
 s_xor_b32 s46, s46, 0x1
 v_lshl_add_u32 v6, v60, 3, v6
 s_add_u32 s59, s59, 0x80000
 v_mov_b64 v[60:61], 0
 s_waitcnt lgkmcnt(4)
 v_smfmac_f32_16x16x64_bf16 v[64:67], v[52:55], a[248:255], v5
 buffer_load_dwordx4 v3, s[20:23], s67 offen offset:0 sc1 lds
 v_mov_b64 v[62:63], 0
 v_smfmac_f32_16x16x64_bf16 v[68:71], v[52:55], a[176:183], v5
 s_waitcnt lgkmcnt(2)
 s_add_u32 s38, s38, 0x20000
 v_smfmac_f32_16x16x64_bf16 v[64:67], v[56:59], v[36:43], v5
 ds_read_b128 v[36:39], v0 offset:57344
 buffer_load_dwordx4 v3, s[20:23], s67 offen offset:1024 sc1 lds
 v_smfmac_f32_16x16x64_bf16 v[20:23], v[52:55], a[184:191], v5
 ds_read_b128 v[40:43], v0 offset:61440
 s_cmp_lt_u32 s36, 61
 v_add_u32 v0, 0x10000, v0
 v_smfmac_f32_16x16x64_bf16 v[68:71], v[56:59], v[44:51], v5
 ds_read_b128 v[44:47], v0 offset:0
 s_cselect_b32 s47, 0x80000, 0
 v_add_f32 v64, v64, v66
 v_add_f32 v65, v65, v67
 v_cvt_pk_bf16_f32 v65, v65, v65
 v_smfmac_f32_16x16x64_bf16 v[24:27], v[52:55], a[192:199], v5
 ds_read_b128 v[48:51], v0 offset:4096
 s_waitcnt lgkmcnt(4)
 v_cvt_pk_bf16_f32 v64, v64, v64
 v_and_or_b32 v65, v65, -2, s46
 v_smfmac_f32_16x16x64_bf16 v[20:23], v[56:59], v[12:19], v5
 ds_read_b128 v[12:15], v0 offset:8192
 buffer_store_dwordx2 v[64:65], v6, s[20:23], s62 offen sc1
 v_add_f32 v68, v68, v70
 v_add_f32 v69, v69, v71
 v_smfmac_f32_16x16x64_bf16 v[28:31], v[52:55], a[200:207], v5
 ds_read_b128 v[16:19], v0 offset:12288
 s_waitcnt lgkmcnt(4)
 v_mov_b64 v[64:65], 0
 v_mov_b64 v[66:67], 0
 v_smfmac_f32_16x16x64_bf16 v[24:27], v[56:59], v[36:43], v5
 ds_read_b128 v[36:39], v0 offset:16384
 s_add_u32 s68, s68, s47
 v_add_f32 v20, v20, v22
 v_add_f32 v21, v21, v23
 v_cvt_pk_bf16_f32 v69, v69, v21
 v_smfmac_f32_16x16x64_bf16 v[32:35], v[52:55], a[208:215], v5
 ds_read_b128 v[40:43], v0 offset:20480
 s_waitcnt lgkmcnt(4)
 v_cvt_pk_bf16_f32 v68, v68, v20
 v_and_or_b32 v69, v69, -2, s46
 v_smfmac_f32_16x16x64_bf16 v[28:31], v[56:59], v[44:51], v5
 ds_read_b128 v[44:47], v0 offset:24576
 buffer_store_dwordx2 v[68:69], v6, s[20:23], s60 offen offset:0 sc1
 v_add_f32 v24, v24, v26
 v_add_f32 v25, v25, v27
 v_smfmac_f32_16x16x64_bf16 v[60:63], v[52:55], a[216:223], v5
 ds_read_b128 v[48:51], v0 offset:28672
 s_waitcnt lgkmcnt(4)
 v_mov_b64 v[20:21], 0
 v_mov_b64 v[22:23], 0
 v_smfmac_f32_16x16x64_bf16 v[32:35], v[56:59], v[12:19], v5
 s_add_u32 s36, s36, 1
 s_add_u32 s58, s36, 2
 v_add_f32 v28, v28, v30
 v_add_f32 v29, v29, v31
 v_cvt_pk_bf16_f32 v25, v25, v29
 v_smfmac_f32_16x16x64_bf16 v[64:67], v[52:55], a[224:231], v5
 s_waitcnt lgkmcnt(2)
 s_min_u32 s58, s58, 64
 v_cvt_pk_bf16_f32 v24, v24, v28
 v_and_or_b32 v25, v25, -2, s46
 v_smfmac_f32_16x16x64_bf16 v[60:63], v[56:59], v[36:43], v5
 buffer_store_dwordx2 v[24:25], v6, s[20:23], s60 offen offset:2048 sc1
 v_add_f32 v32, v32, v34
 v_smfmac_f32_16x16x64_bf16 v[20:23], v[52:55], a[232:239], v5
 s_waitcnt lgkmcnt(0)
 s_xor_b32 s44, s44, 0x80000
 v_add_f32 v33, v33, v35
 v_smfmac_f32_16x16x64_bf16 v[64:67], v[56:59], v[44:51], v5
 s_xor_b32 s45, s45, 0x80000
 s_xor_b32 s65, s65, 0x80000
 v_add_f32 v60, v60, v62
 v_add_f32 v61, v61, v63
 v_smfmac_f32_16x16x64_bf16 v[20:23], v[56:59], a[240:247], v5
 s_cmp_eq_u32 s4, 0
 v_cvt_pk_bf16_f32 v33, v33, v61
 v_cvt_pk_bf16_f32 v32, v32, v60
 v_and_or_b32 v33, v33, -2, s46
 buffer_store_dwordx2 v[32:33], v6, s[20:23], s61 offen offset:0 sc1
 v_add_f32 v64, v64, v66
 v_add_f32 v65, v65, v67
 s_nop 0
 v_add_f32 v20, v20, v22
 v_add_f32 v21, v21, v23
 v_cvt_pk_bf16_f32 v65, v65, v21
 v_cvt_pk_bf16_f32 v64, v64, v20
 v_and_or_b32 v65, v65, -2, s46
 buffer_store_dwordx2 v[64:65], v6, s[20:23], s61 offen offset:2048 sc1
 s_cbranch_scc1 LwH_81
 s_xor_b32 s66, s66, 0x80000
 s_xor_b32 s41, s41, 0x80000
 s_xor_b32 s43, s43, 0x80000
 v_mov_b32 v47, 0x3f80
 v_cndmask_b32 v47, v47, 1.0, s[32:33]
 v_cndmask_b32 v44, 0, v47, s[24:25]
 v_cndmask_b32 v45, 0, v47, s[26:27]
 v_cndmask_b32 v46, 0, v47, s[28:29]
 v_cndmask_b32 v47, 0, v47, s[30:31]
 v_bfe_u32 v52, v3, 8, 2
 v_bfe_u32 v58, v3, 2, 4
 v_lshl_or_b32 v52, v52, 4, v58
 v_and_b32 v58, 0xc0, v3
 v_lshl_or_b32 v52, v58, 24, v52
 v_subrev_u32 v0, 0x20000, v0
 v_mov_b32 v59, -1
 v_add_u32 v54, s42, v3
 v_add_u32 v58, s69, v9
 ds_read_b64_tr_b16 v[64:65], v58 offset:19456
 v_mov_b32 v66, v2
 v_mov_b32 v67, v4
 ds_read_b128 v[20:23], v0 offset:24576
 ds_read_b128 v[24:27], v0 offset:28672
 ds_read_b128 v[28:31], v0 offset:32768
 ds_read_b128 v[32:35], v0 offset:36864
 s_cmp_eq_u32 s4, 1
 s_waitcnt vmcnt(2)
 s_cbranch_scc1 Lq1_82
 s_cmp_eq_u32 s4, 2
 s_waitcnt vmcnt(1)
 s_cbranch_scc1 Lq1_82
 s_waitcnt vmcnt(0)
Lq1_82:
 buffer_load_dwordx4 v[36:39], v3, s[20:23], s39 offen offset:0 sc1
 buffer_load_dwordx4 v[40:43], v3, s[20:23], s39 offen offset:1024 sc1
 s_nop 15
 s_nop 11
 buffer_load_dwordx4 v[12:15], v3, s[20:23], s39 offen offset:0 sc1
 buffer_load_dwordx4 v[16:19], v3, s[20:23], s39 offen offset:1024 sc1
 s_waitcnt vmcnt(3)
 v_mfma_f32_16x16x32_bf16 v[48:51], v[44:47], v[36:39], 0
 s_waitcnt vmcnt(2)
 v_mfma_f32_16x16x32_bf16 v[48:51], v[44:47], v[40:43], v[48:51]
 v_bitop3_b32 v55, v37, v39, s46 bitop3:0x7e
 v_bitop3_b32 v56, v41, v43, s46 bitop3:0x7e
 v_bitop3_b32 v55, v55, 1, v56 bitop3:0xc8
 v_cmp_ne_u32 vcc, 0, v55
 s_nop 3
 v_add_f32_dpp v48, v48, v48 row_ror:4 row_mask:0xf bank_mask:0xf
 v_add_f32_dpp v49, v49, v49 row_ror:4 row_mask:0xf bank_mask:0xf
 s_cbranch_vccnz Lr2_84
 v_add_f32_dpp v48, v48, v48 row_ror:8 row_mask:0xf bank_mask:0xf
 v_add_f32_dpp v49, v49, v49 row_ror:8 row_mask:0xf bank_mask:0xf
 v_cvt_pk_bf16_f32 v48, v48, v49
 buffer_store_dword v48, v52, s[20:23], s44 offen sc1
Lb1_85:
 buffer_store_dword v59, v52, s[20:23], s45 offen sc1
 v_cmp_gt_u32 vcc, s58, v1
 v_mov_b64 v[36:37], 0
 v_mov_b64 v[38:39], 0
 v_mov_b64 v[40:41], 0
 v_mov_b64 v[42:43], 0
 v_mov_b64 v[44:45], 0
 v_mov_b64 v[46:47], 0
 v_mov_b64 v[48:49], 0
 v_mov_b64 v[50:51], 0
 s_cmp_lg_u32 vcc_hi, 0
 s_cbranch_scc1 Lfw_87
Lfok_86:
 v_lshl_add_u32 v1, v3, 3, s68
 v_mov_b32 v6, s56
 v_cndmask_b32 v1, v6, v1, s[70:71]
 v_min_u32 v6, 16, v0
 v_lshlrev_b32 v6, 24, v6
 s_max_u32 s47, s36, 1
 v_add_u32 v2, -1, s47
 s_waitcnt lgkmcnt(0)
 s_nop 15
 buffer_load_dwordx4 v[12:15], v3, s[20:23], s41 offen offset:0 sc1
 buffer_load_dwordx4 v[16:19], v3, s[20:23], s41 offen offset:1024 sc1
 s_nop 15
 s_nop 7
Lp2_88:
 buffer_load_dwordx4 v[12:15], v3, s[20:23], s41 offen offset:0 sc1
 buffer_load_dwordx4 v[16:19], v3, s[20:23], s41 offen offset:1024 sc1
 s_waitcnt vmcnt(2)
 v_max3_u32 v55, v12, v13, v14
 v_max3_u32 v55, v55, v15, v16
 v_max3_u32 v55, v55, v17, v18
 v_max_u32 v55, v55, v19
 ds_write_b128 v54, v[12:15] offset:0
 ds_write_b128 v54, v[16:19] offset:1024
 v_cmpx_eq_u32 vcc, -1, v55
 s_cbranch_execz Lstep_77
 buffer_load_dwordx4 v[12:15], v3, s[20:23], s41 offen offset:0 sc1
 buffer_load_dwordx4 v[16:19], v3, s[20:23], s41 offen offset:1024 sc1
 s_waitcnt vmcnt(2)
 v_max3_u32 v55, v12, v13, v14
 v_max3_u32 v55, v55, v15, v16
 v_max3_u32 v55, v55, v17, v18
 v_max_u32 v55, v55, v19
 ds_write_b128 v54, v[12:15] offset:0
 ds_write_b128 v54, v[16:19] offset:1024
 v_cmpx_eq_u32 vcc, -1, v55
 s_cbranch_execz Lstep_77
 buffer_load_dwordx4 v[12:15], v3, s[20:23], s41 offen offset:0 sc1
 buffer_load_dwordx4 v[16:19], v3, s[20:23], s41 offen offset:1024 sc1
 s_waitcnt vmcnt(2)
 v_max3_u32 v55, v12, v13, v14
 v_max3_u32 v55, v55, v15, v16
 v_max3_u32 v55, v55, v17, v18
 v_max_u32 v55, v55, v19
 ds_write_b128 v54, v[12:15] offset:0
 ds_write_b128 v54, v[16:19] offset:1024
 v_cmpx_eq_u32 vcc, -1, v55
 s_cbranch_execz Lstep_77
 s_sub_u32 s54, s54, 1
 s_cbranch_scc0 Lp2_88
 s_endpgm
LwH_81:
 v_bfe_u32 v53, v3, 8, 1
 v_bfe_u32 v58, v3, 9, 1
 v_lshl_or_b32 v53, v53, 1, v58
 v_bfe_u32 v58, v3, 5, 1
 v_lshl_or_b32 v53, v53, 1, v58
 v_and_b32 v58, 0xd0, v3
 v_lshlrev_b32 v58, 24, v58
 v_lshl_or_b32 v53, v53, 2, v58
 s_waitcnt vmcnt(2)
 buffer_load_dwordx4 v[20:23], v3, s[20:23], s40 offen offset:0 sc1
 buffer_load_dwordx4 v[24:27], v3, s[20:23], s40 offen offset:1024 sc1
 buffer_load_dwordx4 v[36:39], v3, s[20:23], s39 offen offset:0 sc1
 buffer_load_dwordx4 v[40:43], v3, s[20:23], s39 offen offset:1024 sc1
 s_xor_b32 s66, s66, 0x80000
 s_xor_b32 s41, s41, 0x80000
 s_xor_b32 s43, s43, 0x80000
 v_mov_b32 v47, 0x3f80
 v_cndmask_b32 v47, v47, 1.0, s[32:33]
 v_cndmask_b32 v44, 0, v47, s[24:25]
 v_cndmask_b32 v45, 0, v47, s[26:27]
 v_cndmask_b32 v46, 0, v47, s[28:29]
 v_cndmask_b32 v47, 0, v47, s[30:31]
 v_bfe_u32 v52, v3, 8, 2
 v_bfe_u32 v58, v3, 2, 4
 v_lshl_or_b32 v52, v52, 4, v58
 v_and_b32 v58, 0xc0, v3
 v_lshl_or_b32 v52, v58, 24, v52
 v_subrev_u32 v0, 0x20000, v0
 v_mov_b32 v59, -1
 v_add_u32 v54, s42, v3
 v_add_u32 v58, s69, v9
 ds_read_b64_tr_b16 v[64:65], v58 offset:19456
 v_mov_b32 v66, v2
 v_mov_b32 v67, v4
 s_waitcnt vmcnt(2)
 v_mfma_f32_16x16x32_bf16 v[28:31], v[44:47], v[20:23], 0
 v_mfma_f32_16x16x32_bf16 v[28:31], v[44:47], v[24:27], v[28:31]
 s_waitcnt vmcnt(1)
 v_mfma_f32_16x16x32_bf16 v[48:51], v[44:47], v[36:39], 0
 s_waitcnt vmcnt(0)
 v_mfma_f32_16x16x32_bf16 v[48:51], v[44:47], v[40:43], v[48:51]
 v_bitop3_b32 v55, v37, v39, s46 bitop3:0x7e
 v_bitop3_b32 v56, v41, v43, s46 bitop3:0x7e
 v_bitop3_b32 v57, v21, v23, s46 bitop3:0x7e
 v_or3_b32 v55, v55, v56, v57
 v_bitop3_b32 v56, v25, v27, s46 bitop3:0x7e
 v_bitop3_b32 v55, v55, 1, v56 bitop3:0xc8
 v_cmp_ne_u32 vcc, 0, v55
 v_add_f32_dpp v29, v29, v29 row_ror:4 row_mask:0xf bank_mask:0xf
 v_add_f32_dpp v48, v48, v48 row_ror:4 row_mask:0xf bank_mask:0xf
 v_add_f32_dpp v49, v49, v49 row_ror:4 row_mask:0xf bank_mask:0xf
 v_add_f32_dpp v29, v29, v29 row_ror:8 row_mask:0xf bank_mask:0xf
 v_add_f32_dpp v48, v48, v48 row_ror:8 row_mask:0xf bank_mask:0xf
 v_add_f32_dpp v49, v49, v49 row_ror:8 row_mask:0xf bank_mask:0xf
 s_cbranch_vccnz Lr1_89
 v_cvt_pk_bf16_f32 v48, v48, v49
 buffer_store_dword v48, v52, s[20:23], s44 offen sc1
 v_mov_b32_dpp v30, v29 quad_perm:[1,0,3,2] row_mask:0xf bank_mask:0xf
 v_cvt_pk_bf16_f32 v29, v29, v30
 buffer_store_dword v29, v53, s[20:23], s65 offen sc1
Lb1_90:
 buffer_store_dword v59, v52, s[20:23], s45 offen sc1
 buffer_store_dword v59, v53, s[20:23], s66 offen sc1
 v_cmp_gt_u32 vcc, s58, v1
 ds_read_b128 v[20:23], v0 offset:24576
 ds_read_b128 v[24:27], v0 offset:28672
 ds_read_b128 v[28:31], v0 offset:32768
 ds_read_b128 v[32:35], v0 offset:36864
 v_mov_b64 v[36:37], 0
 v_mov_b64 v[38:39], 0
 v_mov_b64 v[40:41], 0
 v_mov_b64 v[42:43], 0
 v_mov_b64 v[44:45], 0
 v_mov_b64 v[46:47], 0
 v_mov_b64 v[48:49], 0
 v_mov_b64 v[50:51], 0
 s_cmp_lg_u32 vcc_hi, 0
 s_cbranch_scc1 Lfw_92
Lfok_91:
 v_lshl_add_u32 v1, v3, 3, s68
 v_mov_b32 v6, s56
 v_cndmask_b32 v1, v6, v1, s[70:71]
 v_min_u32 v6, 16, v0
 v_lshlrev_b32 v6, 24, v6
 s_max_u32 s47, s36, 1
 v_add_u32 v2, -1, s47
 s_waitcnt lgkmcnt(0)
 s_nop 9
 buffer_load_dwordx4 v[12:15], v3, s[20:23], s41 offen offset:0 sc1
 buffer_load_dwordx4 v[16:19], v3, s[20:23], s41 offen offset:1024 sc1
 buffer_load_dwordx4 v[68:71], v3, s[20:23], s43 offen offset:0 sc1
 s_nop 15
 s_nop 7
Lp2_93:
 buffer_load_dwordx4 v[12:15], v3, s[20:23], s41 offen offset:0 sc1
 buffer_load_dwordx4 v[16:19], v3, s[20:23], s41 offen offset:1024 sc1
 buffer_load_dwordx4 v[68:71], v3, s[20:23], s43 offen offset:0 sc1
 s_waitcnt vmcnt(3)
 v_max3_u32 v55, v12, v13, v14
 v_max3_u32 v55, v55, v15, v16
 v_max3_u32 v55, v55, v17, v18
 v_max3_u32 v55, v55, v19, v68
 v_max3_u32 v55, v55, v69, v70
 v_max_u32 v55, v55, v71
 ds_write_b128 v54, v[12:15] offset:0
 ds_write_b128 v54, v[16:19] offset:1024
 ds_write_b128 v54, v[68:71] offset:8192
 v_cmpx_eq_u32 vcc, -1, v55
 s_cbranch_execz Lstep_77
 buffer_load_dwordx4 v[12:15], v3, s[20:23], s41 offen offset:0 sc1
 buffer_load_dwordx4 v[16:19], v3, s[20:23], s41 offen offset:1024 sc1
 buffer_load_dwordx4 v[68:71], v3, s[20:23], s43 offen offset:0 sc1
 s_waitcnt vmcnt(3)
 v_max3_u32 v55, v12, v13, v14
 v_max3_u32 v55, v55, v15, v16
 v_max3_u32 v55, v55, v17, v18
 v_max3_u32 v55, v55, v19, v68
 v_max3_u32 v55, v55, v69, v70
 v_max_u32 v55, v55, v71
 ds_write_b128 v54, v[12:15] offset:0
 ds_write_b128 v54, v[16:19] offset:1024
 ds_write_b128 v54, v[68:71] offset:8192
 v_cmpx_eq_u32 vcc, -1, v55
 s_cbranch_execz Lstep_77
 buffer_load_dwordx4 v[12:15], v3, s[20:23], s41 offen offset:0 sc1
 buffer_load_dwordx4 v[16:19], v3, s[20:23], s41 offen offset:1024 sc1
 buffer_load_dwordx4 v[68:71], v3, s[20:23], s43 offen offset:0 sc1
 s_waitcnt vmcnt(3)
 v_max3_u32 v55, v12, v13, v14
 v_max3_u32 v55, v55, v15, v16
 v_max3_u32 v55, v55, v17, v18
 v_max3_u32 v55, v55, v19, v68
 v_max3_u32 v55, v55, v69, v70
 v_max_u32 v55, v55, v71
 ds_write_b128 v54, v[12:15] offset:0
 ds_write_b128 v54, v[16:19] offset:1024
 ds_write_b128 v54, v[68:71] offset:8192
 v_cmpx_eq_u32 vcc, -1, v55
 s_cbranch_execz Lstep_77
 s_sub_u32 s54, s54, 1
 s_cbranch_scc0 Lp2_93
 s_endpgm
Lr1_89:
 s_mov_b64 exec, vcc
Lrt_94:
 buffer_load_dwordx4 v[20:23], v3, s[20:23], s40 offen offset:0 sc1
 buffer_load_dwordx4 v[24:27], v3, s[20:23], s40 offen offset:1024 sc1
 buffer_load_dwordx4 v[36:39], v3, s[20:23], s39 offen offset:0 sc1
 buffer_load_dwordx4 v[40:43], v3, s[20:23], s39 offen offset:1024 sc1
 s_waitcnt vmcnt(4)
 v_bitop3_b32 v55, v37, v39, s46 bitop3:0x7e
 v_bitop3_b32 v56, v41, v43, s46 bitop3:0x7e
 v_bitop3_b32 v57, v21, v23, s46 bitop3:0x7e
 v_or3_b32 v55, v55, v56, v57
 v_bitop3_b32 v56, v25, v27, s46 bitop3:0x7e
 v_bitop3_b32 v55, v55, 1, v56 bitop3:0xc8
 v_cmpx_ne_u32 vcc, 0, v55
 s_cbranch_execz Lrte_95
 buffer_load_dwordx4 v[20:23], v3, s[20:23], s40 offen offset:0 sc1
 buffer_load_dwordx4 v[24:27], v3, s[20:23], s40 offen offset:1024 sc1
 buffer_load_dwordx4 v[36:39], v3, s[20:23], s39 offen offset:0 sc1
 buffer_load_dwordx4 v[40:43], v3, s[20:23], s39 offen offset:1024 sc1
 s_waitcnt vmcnt(4)
 v_bitop3_b32 v55, v37, v39, s46 bitop3:0x7e
 v_bitop3_b32 v56, v41, v43, s46 bitop3:0x7e
 v_bitop3_b32 v57, v21, v23, s46 bitop3:0x7e
 v_or3_b32 v55, v55, v56, v57
 v_bitop3_b32 v56, v25, v27, s46 bitop3:0x7e
 v_bitop3_b32 v55, v55, 1, v56 bitop3:0xc8
 v_cmpx_ne_u32 vcc, 0, v55
 s_cbranch_execz Lrte_95
 buffer_load_dwordx4 v[20:23], v3, s[20:23], s40 offen offset:0 sc1
 buffer_load_dwordx4 v[24:27], v3, s[20:23], s40 offen offset:1024 sc1
 buffer_load_dwordx4 v[36:39], v3, s[20:23], s39 offen offset:0 sc1
 buffer_load_dwordx4 v[40:43], v3, s[20:23], s39 offen offset:1024 sc1
 s_waitcnt vmcnt(4)
 v_bitop3_b32 v55, v37, v39, s46 bitop3:0x7e
 v_bitop3_b32 v56, v41, v43, s46 bitop3:0x7e
 v_bitop3_b32 v57, v21, v23, s46 bitop3:0x7e
 v_or3_b32 v55, v55, v56, v57
 v_bitop3_b32 v56, v25, v27, s46 bitop3:0x7e
 v_bitop3_b32 v55, v55, 1, v56 bitop3:0xc8
 v_cmpx_ne_u32 vcc, 0, v55
 s_cbranch_execz Lrte_95
 s_sub_u32 s54, s54, 1
 s_cbranch_scc0 Lrt_94
 s_endpgm
Lrte_95:
 s_mov_b64 exec, -1
 s_nop 2
 v_mfma_f32_16x16x32_bf16 v[28:31], v[44:47], v[20:23], 0
 v_mfma_f32_16x16x32_bf16 v[28:31], v[44:47], v[24:27], v[28:31]
 v_mfma_f32_16x16x32_bf16 v[48:51], v[44:47], v[36:39], 0
 v_mfma_f32_16x16x32_bf16 v[48:51], v[44:47], v[40:43], v[48:51]
 s_nop 6
 v_add_f32_dpp v29, v29, v29 row_ror:4 row_mask:0xf bank_mask:0xf
 v_add_f32_dpp v48, v48, v48 row_ror:4 row_mask:0xf bank_mask:0xf
 v_add_f32_dpp v49, v49, v49 row_ror:4 row_mask:0xf bank_mask:0xf
 v_add_f32_dpp v29, v29, v29 row_ror:8 row_mask:0xf bank_mask:0xf
 v_add_f32_dpp v48, v48, v48 row_ror:8 row_mask:0xf bank_mask:0xf
 v_add_f32_dpp v49, v49, v49 row_ror:8 row_mask:0xf bank_mask:0xf
 v_cvt_pk_bf16_f32 v48, v48, v49
 buffer_store_dword v48, v52, s[20:23], s44 offen sc1
 v_mov_b32_dpp v30, v29 quad_perm:[1,0,3,2] row_mask:0xf bank_mask:0xf
 v_cvt_pk_bf16_f32 v29, v29, v30
 buffer_store_dword v29, v53, s[20:23], s65 offen sc1
 s_waitcnt vmcnt(2)
 s_branch Lb1_90
Lmx_79:
 s_waitcnt lgkmcnt(0)
 ds_read_b128 v[36:39], v11 offset:17408
 ds_read_b128 v[40:43], v11 offset:17920
 ds_read_b128 v[44:47], v11 offset:18432
 ds_read_b128 v[48:51], v11 offset:18944
 v_mov_b64 v[28:29], 0
 v_mov_b64 v[30:31], 0
 ds_read_b128 v[52:55], v3 offset:9216
 ds_read_b128 v[56:59], v3 offset:10240
 s_waitcnt lgkmcnt(0)
 v_mfma_f32_16x16x32_bf16 v[20:23], v[52:55], v[36:39], 0
 v_mfma_f32_16x16x32_bf16 v[24:27], v[56:59], v[36:39], 0
 ds_read_b128 v[52:55], v3 offset:11264
 ds_read_b128 v[56:59], v3 offset:12288
 s_waitcnt lgkmcnt(0)
 v_mfma_f32_16x16x32_bf16 v[20:23], v[52:55], v[40:43], v[20:23]
 v_mfma_f32_16x16x32_bf16 v[24:27], v[56:59], v[40:43], v[24:27]
 ds_read_b128 v[52:55], v3 offset:13312
 ds_read_b128 v[56:59], v3 offset:14336
 s_waitcnt lgkmcnt(0)
 v_mfma_f32_16x16x32_bf16 v[20:23], v[52:55], v[44:47], v[20:23]
 v_mfma_f32_16x16x32_bf16 v[24:27], v[56:59], v[44:47], v[24:27]
 ds_read_b128 v[52:55], v3 offset:15360
 ds_read_b128 v[56:59], v3 offset:16384
 s_waitcnt lgkmcnt(0)
 v_mfma_f32_16x16x32_bf16 v[20:23], v[52:55], v[48:51], v[20:23]
 v_mfma_f32_16x16x32_bf16 v[24:27], v[56:59], v[48:51], v[24:27]
 ds_read_b64_tr_b16 v[52:53], v9 offset:19456
 ds_read_b64_tr_b16 v[54:55], v9 offset:19488
 ds_read_b64_tr_b16 v[56:57], v9 offset:20544
 ds_read_b64_tr_b16 v[58:59], v9 offset:20576
 s_waitcnt lgkmcnt(0)
 v_smfmac_f32_16x16x64_bf16 v[28:31], v[52:55], v[36:43], v5
 v_smfmac_f32_16x16x64_bf16 v[28:31], v[56:59], v[44:51], v5
 ds_read_b128 v[36:39], v0 offset:32768
 ds_read_b128 v[40:43], v0 offset:36864
 ds_read_b128 v[44:47], v0 offset:40960
 ds_read_b128 v[48:51], v0 offset:45056
 v_mov_b64 v[32:33], s[34:35]
 v_mov_b64 v[34:35], s[34:35]
 s_nop 1
 v_add_f32 v28, v28, v30
 v_add_f32 v29, v29, v31
 v_mul_f32 v28, s55, v28
 v_mul_f32 v29, s55, v29
 v_max_f32 v30, v28, v29
 v_cndmask_b32 v28, v28, v29, s[48:49]
 v_max3_f32 v30, v30, v20, v21
 v_max3_f32 v30, v30, v22, v23
 v_max3_f32 v30, v30, v24, v25
 v_max3_f32 v31, v30, v26, v27
 v_max3_f32 v29, v30, v26, v27
 v_cndmask_b32 v20, v20, v24, s[48:49]
 v_cndmask_b32 v21, v21, v25, s[48:49]
 v_permlane16_swap_b32 v31, v29
 v_max_f32 v30, v31, v29
 v_max_f32 v6, v31, v29
 v_cndmask_b32 v22, v22, v26, s[48:49]
 v_cndmask_b32 v23, v23, v27, s[48:49]
 v_permlane32_swap_b32 v30, v6
 v_max_f32 v30, v30, v6
 v_sub_f32 v28, v28, v30
 v_sub_f32 v20, v20, v30
 v_sub_f32 v21, v21, v30
 v_sub_f32 v22, v22, v30
 v_sub_f32 v23, v23, v30
 v_exp_f32 v28, v28
 v_exp_f32 v20, v20
 v_exp_f32 v21, v21
 v_exp_f32 v22, v22
 v_exp_f32 v23, v23
 v_cndmask_b32 v29, 0, v28, s[48:49]
 v_cndmask_b32 v28, v28, 0, s[48:49]
 v_cvt_pk_bf16_f32 v6, v28, v29
 v_cvt_pk_bf16_f32 v30, v20, v21
 v_cvt_pk_bf16_f32 v31, v22, v23
 v_mfma_f32_16x16x16_bf16 v[60:63], v[6:7], v[32:33], 0
 v_mfma_f32_16x16x16_bf16 v[52:55], v[6:7], v[2:3], 0
 v_mfma_f32_16x16x16_bf16 v[56:59], v[6:7], v[4:5], 0
 v_smfmac_f32_16x16x32_bf16 v[60:63], v[30:31], v[32:35], v5
 v_smfmac_f32_16x16x32_bf16 v[52:55], v[30:31], v[12:15], v5
 v_smfmac_f32_16x16x32_bf16 v[56:59], v[30:31], v[16:19], v5
 s_nop 0
 v_add_f32 v60, v60, v62
 v_add_f32 v61, v61, v63
 v_rcp_f32 v60, v60
 v_rcp_f32 v61, v61
 v_add_f32 v52, v52, v54
 v_add_f32 v53, v53, v55
 v_mul_f32 v52, v52, v60
 v_mul_f32 v53, v53, v61
 v_add_f32 v56, v56, v58
 v_add_f32 v57, v57, v59
 v_mul_f32 v56, v56, v60
 v_mul_f32 v57, v57, v61
 v_cvt_pk_bf16_f32 v52, v52, v53
 v_cvt_pk_bf16_f32 v53, v56, v57
 ds_write_b64 v8, v[52:53] offset:21632
 v_mov_b64 v[20:21], 0
 v_mov_b64 v[22:23], 0
 v_mov_b64 v[24:25], 0
 v_mov_b64 v[26:27], 0
 v_mov_b64 v[28:29], 0
 v_mov_b64 v[30:31], 0
 v_mov_b64 v[32:33], 0
 v_mov_b64 v[34:35], 0
 s_waitcnt lgkmcnt(0)
 s_branch Lmxb_80
Lr2_84:
 s_waitcnt vmcnt(1)
 v_mfma_f32_16x16x32_bf16 v[48:51], v[44:47], v[12:15], 0
 s_waitcnt vmcnt(0)
 v_mfma_f32_16x16x32_bf16 v[48:51], v[44:47], v[16:19], v[48:51]
 v_bitop3_b32 v55, v13, v15, s46 bitop3:0x7e
 v_bitop3_b32 v56, v17, v19, s46 bitop3:0x7e
 v_bitop3_b32 v55, v55, 1, v56 bitop3:0xc8
 v_cmp_ne_u32 vcc, 0, v55
 s_nop 3
 v_add_f32_dpp v48, v48, v48 row_ror:4 row_mask:0xf bank_mask:0xf
 v_add_f32_dpp v49, v49, v49 row_ror:4 row_mask:0xf bank_mask:0xf
 s_cbranch_vccnz Lr1_83
 v_add_f32_dpp v48, v48, v48 row_ror:8 row_mask:0xf bank_mask:0xf
 v_add_f32_dpp v49, v49, v49 row_ror:8 row_mask:0xf bank_mask:0xf
 v_cvt_pk_bf16_f32 v48, v48, v49
 buffer_store_dword v48, v52, s[20:23], s44 offen sc1
 s_branch Lb1_85
Lr1_83:
 s_mov_b64 exec, vcc
Lrt_96:
 buffer_load_dwordx4 v[12:15], v3, s[20:23], s39 offen offset:0 sc1
 buffer_load_dwordx4 v[16:19], v3, s[20:23], s39 offen offset:1024 sc1
 s_waitcnt vmcnt(2)
 v_bitop3_b32 v55, v13, v15, s46 bitop3:0x7e
 v_bitop3_b32 v56, v17, v19, s46 bitop3:0x7e
 v_bitop3_b32 v55, v55, 1, v56 bitop3:0xc8
 v_cmpx_ne_u32 vcc, 0, v55
 s_cbranch_execz Lrte_97
 buffer_load_dwordx4 v[12:15], v3, s[20:23], s39 offen offset:0 sc1
 buffer_load_dwordx4 v[16:19], v3, s[20:23], s39 offen offset:1024 sc1
 s_waitcnt vmcnt(2)
 v_bitop3_b32 v55, v13, v15, s46 bitop3:0x7e
 v_bitop3_b32 v56, v17, v19, s46 bitop3:0x7e
 v_bitop3_b32 v55, v55, 1, v56 bitop3:0xc8
 v_cmpx_ne_u32 vcc, 0, v55
 s_cbranch_execz Lrte_97
 buffer_load_dwordx4 v[12:15], v3, s[20:23], s39 offen offset:0 sc1
 buffer_load_dwordx4 v[16:19], v3, s[20:23], s39 offen offset:1024 sc1
 s_waitcnt vmcnt(2)
 v_bitop3_b32 v55, v13, v15, s46 bitop3:0x7e
 v_bitop3_b32 v56, v17, v19, s46 bitop3:0x7e
 v_bitop3_b32 v55, v55, 1, v56 bitop3:0xc8
 v_cmpx_ne_u32 vcc, 0, v55
 s_cbranch_execz Lrte_97
 s_sub_u32 s54, s54, 1
 s_cbranch_scc0 Lrt_96
 s_endpgm
Lrte_97:
 s_mov_b64 exec, -1
 s_nop 2
 v_mfma_f32_16x16x32_bf16 v[48:51], v[44:47], v[12:15], 0
 v_mfma_f32_16x16x32_bf16 v[48:51], v[44:47], v[16:19], v[48:51]
 s_nop 7
 v_add_f32_dpp v48, v48, v48 row_ror:4 row_mask:0xf bank_mask:0xf
 v_add_f32_dpp v49, v49, v49 row_ror:4 row_mask:0xf bank_mask:0xf
 s_nop 0
 v_add_f32_dpp v48, v48, v48 row_ror:8 row_mask:0xf bank_mask:0xf
 v_add_f32_dpp v49, v49, v49 row_ror:8 row_mask:0xf bank_mask:0xf
 v_cvt_pk_bf16_f32 v48, v48, v49
 buffer_store_dword v48, v52, s[20:23], s44 offen sc1
 s_branch Lb1_85
Lfw_87:
Lpb_98:
 buffer_load_dword v1, v7, s[20:23], s56 offen sc1
 s_waitcnt vmcnt(0)
 v_cmp_le_u32 vcc, s58, v1
 s_cbranch_vccnz Lpbok_99
 s_sub_u32 s54, s54, 1
 s_cbranch_scc0 Lpb_98
 s_endpgm
Lpbok_99:
 s_branch Lfok_86
Lfw_92:
Lpb_100:
 buffer_load_dword v1, v7, s[20:23], s56 offen sc1
 s_waitcnt vmcnt(0)
 v_cmp_le_u32 vcc, s58, v1
 s_cbranch_vccnz Lpbok_101
 s_sub_u32 s54, s54, 1
 s_cbranch_scc0 Lpb_100
 s_endpgm
Lpbok_101:
 s_branch Lfok_91
Lfail_78:
 s_endpgm
Lchexit_51:
 s_add_u32 s38, s38, 0x10000
 v_add_u32 v6, s69, v9
 ds_read_b64_tr_b16 v[64:65], v6 offset:19456
 v_mov_b32 v66, v2
 v_mov_b32 v67, v4
 s_waitcnt lgkmcnt(0)
 buffer_store_dwordx4 v[64:67], v0, s[20:23], s38 offen sc1
 s_waitcnt vmcnt(0) lgkmcnt(0)
 s_barrier
 v_subrev_u32 v0, 0x10000, v0
 v_min_u32 v0, 16, v0
 v_lshlrev_b32 v0, 24, v0
 v_mov_b32 v6, 64
 buffer_store_dword v6, v0, s[20:23], s57 offen sc1
Lfin:
Lend:
 s_endpgm
.section .rodata,"a"
.p2align 6
.amdhsa_kernel concat_heads__compressed_kv_cla__memory_aug_recurrent_mem_tr__prompt_kernel
  .amdhsa_next_free_vgpr 512
  .amdhsa_next_free_sgpr 102
  .amdhsa_accum_offset 256
  .amdhsa_group_segment_fixed_size 0
  .amdhsa_kernarg_size 128
  .amdhsa_user_sgpr_count 2
  .amdhsa_user_sgpr_kernarg_segment_ptr 1
  .amdhsa_system_sgpr_workgroup_id_x 1
  .amdhsa_float_denorm_mode_32 3
.end_amdhsa_kernel
```

```asm
; @launch grid=(256,1,1) block=(256,1,1) lds=163840
.amdgcn_target "amdgcn-amd-amdhsa--gfx950"
.text
.globl concat_heads__compressed_kv_cla__memory_aug_recurrent_mem_tr__prompt_kernel
.p2align 8
.type concat_heads__compressed_kv_cla__memory_aug_recurrent_mem_tr__prompt_kernel,@function
concat_heads__compressed_kv_cla__memory_aug_recurrent_mem_tr__prompt_kernel:
 s_cmp_ge_u32 s2, 256
 s_cbranch_scc1 Lend
 s_load_dwordx2 s[20:21], s[0:1], 120
 s_mov_b32 s22, 0x10000000
 s_mov_b32 s23, 0x20000
 s_load_dwordx2 s[28:29], s[0:1], 112
 s_mov_b32 s30, 0x100
 s_mov_b32 s31, 0x20000
 v_lshrrev_b32 v1, 6, v0
 s_and_b32 s5, s2, 7
 s_lshr_b32 s6, s2, 3
 v_readfirstlane_b32 s4, v1
 s_lshl_b32 s5, s5, 2
 s_lshr_b32 s5, 0x37654120, s5
 s_and_b32 s5, s5, 7
 s_waitcnt lgkmcnt(0)
 s_cmp_eq_u32 s5, 0
 s_cbranch_scc1 Lchain
 s_cmp_eq_u32 s5, 1
 s_cbranch_scc1 Lpb
 s_cmp_lt_u32 s5, 4
 s_cbranch_scc1 Lqa
 s_load_dwordx2 s[8:9], s[0:1], 8
 s_mov_b32 s10, 0x200000
 s_mov_b32 s11, 0x20000
 s_load_dwordx2 s[12:13], s[0:1], 24
 s_mov_b32 s14, 0x400000
 s_mov_b32 s15, 0x20000
 s_load_dwordx2 s[16:17], s[0:1], 32
 s_mov_b32 s18, 0x400000
 s_mov_b32 s19, 0x20000
 s_sub_u32 s3, s5, 4
 s_lshl_b32 s3, s3, 3
 s_lshr_b32 s7, s6, 2
 s_add_u32 s3, s3, s7
 s_lshl_b32 s32, s3, 8
 s_mov_b32 s33, s32
 s_lshl_b32 s34, s3, 14
 s_add_u32 s34, s34, 0x1000000
 s_add_u32 s35, s34, 8192
 s_mov_b32 s36, 16
 s_and_b32 s37, s6, 3
 s_lshl_b32 s7, s3, 5
 s_add_u32 s7, s7, s37
 s_lshl_b32 s7, s7, 2
 s_add_u32 s7, s7, 0x2000
 v_min_u32 v1, 1, v0
 v_lshlrev_b32 v1, 28, v1
 v_add_u32 v13, s7, v1
 s_waitcnt lgkmcnt(0)
 v_and_b32 v1, 63, v0
 v_lshrrev_b32 v2, 3, v0
 v_mul_u32_u24 v10, 1024, v2
 v_lshrrev_b32 v2, 4, v0
 v_xor_b32 v2, v2, v0
 v_and_b32 v2, 7, v2
 v_lshl_add_u32 v10, v2, 4, v10
 v_lshrrev_b32 v2, 4, v1
 v_bfe_u32 v3, v1, 1, 3
 v_xor_b32 v2, v2, v3
 v_and_b32 v3, 15, v1
 v_lshlrev_b32 v3, 7, v3
 v_lshl_add_u32 v4, v2, 4, v3
 v_xor_b32 v5, 64, v4
 v_lshrrev_b32 v2, 4, v0
 v_lshlrev_b32 v11, 13, v2
 v_lshrrev_b32 v2, 7, v0
 v_lshrrev_b32 v3, 4, v1
 v_lshl_add_u32 v3, v2, 2, v3
 v_bfe_u32 v2, v1, 1, 3
 v_xor_b32 v2, v2, v3
 v_lshl_add_u32 v11, v2, 5, v11
 v_and_b32 v2, 1, v1
 v_lshl_add_u32 v11, v2, 4, v11
 v_bfe_u32 v2, v1, 2, 3
 v_xor_b32 v3, s4, v2
 v_lshlrev_b32 v3, 5, v3
 v_and_b32 v2, 3, v2
 v_lshl_add_u32 v3, v2, 8, v3
 v_lshrrev_b32 v2, 4, v1
 v_lshl_add_u32 v3, v2, 11, v3
 v_and_b32 v2, 3, v1
 v_lshl_add_u32 v3, v2, 3, v3
 v_add_u32 v8, 65536, v3
 v_xor_b32 v3, 0x80, v3
 v_add_u32 v9, 65536, v3
 s_lshl_b32 s45, s4, 11
 v_lshl_add_u32 v12, v1, 4, s45
 s_mov_b32 s39, s37
 s_add_u32 s40, s39, 4
 s_lshl_b32 s49, s4, 10
 s_mul_i32 s46, s39, 32768
 s_add_u32 m0, s49, 0
 s_nop 0
 buffer_load_dwordx4 v10, s[8:11], s46 offen offset:0  lds
 s_add_u32 m0, s49, 3968
 s_nop 0
 buffer_load_dwordx4 v10, s[8:11], s46 offen offset:128  lds
 s_add_u32 m0, s49, 7936
 s_nop 0
 buffer_load_dwordx4 v10, s[8:11], s46 offen offset:256  lds
 s_add_u32 m0, s49, 11904
 s_nop 0
 buffer_load_dwordx4 v10, s[8:11], s46 offen offset:384  lds
 s_add_u32 m0, s49, 15872
 s_nop 0
 buffer_load_dwordx4 v10, s[8:11], s46 offen offset:512  lds
 s_add_u32 m0, s49, 19840
 s_nop 0
 buffer_load_dwordx4 v10, s[8:11], s46 offen offset:640  lds
 s_add_u32 m0, s49, 23808
 s_nop 0
 buffer_load_dwordx4 v10, s[8:11], s46 offen offset:768  lds
 s_add_u32 m0, s49, 27776
 s_nop 0
 buffer_load_dwordx4 v10, s[8:11], s46 offen offset:896  lds
 s_lshl_b32 s49, s4, 10
 s_add_u32 s49, s49, 32768
 s_mul_i32 s46, s40, 32768
 s_add_u32 m0, s49, 0
 s_nop 0
 buffer_load_dwordx4 v10, s[8:11], s46 offen offset:0  lds
 s_add_u32 m0, s49, 3968
 s_nop 0
 buffer_load_dwordx4 v10, s[8:11], s46 offen offset:128  lds
 s_add_u32 m0, s49, 7936
 s_nop 0
 buffer_load_dwordx4 v10, s[8:11], s46 offen offset:256  lds
 s_add_u32 m0, s49, 11904
 s_nop 0
 buffer_load_dwordx4 v10, s[8:11], s46 offen offset:384  lds
 s_add_u32 m0, s49, 15872
 s_nop 0
 buffer_load_dwordx4 v10, s[8:11], s46 offen offset:512  lds
 s_add_u32 m0, s49, 19840
 s_nop 0
 buffer_load_dwordx4 v10, s[8:11], s46 offen offset:640  lds
 s_add_u32 m0, s49, 23808
 s_nop 0
 buffer_load_dwordx4 v10, s[8:11], s46 offen offset:768  lds
 s_add_u32 m0, s49, 27776
 s_nop 0
 buffer_load_dwordx4 v10, s[8:11], s46 offen offset:896  lds
 s_lshl_b32 s49, s4, 10
 s_add_u32 m0, s49, 65536
 s_add_u32 s45, s32, 0
 buffer_load_dwordx4 v11, s[12:15], s45 offen  lds
 s_add_u32 m0, s49, 69632
 s_add_u32 s45, s32, 131072
 buffer_load_dwordx4 v11, s[12:15], s45 offen  lds
 s_add_u32 m0, s49, 73728
 s_add_u32 s45, s33, 0
 buffer_load_dwordx4 v11, s[16:19], s45 offen  lds
 s_add_u32 m0, s49, 77824
 s_add_u32 s45, s33, 131072
 buffer_load_dwordx4 v11, s[16:19], s45 offen  lds
 s_add_u32 m0, s49, 81920
 s_add_u32 s45, s32, 262144
 buffer_load_dwordx4 v11, s[12:15], s45 offen  lds
 s_add_u32 m0, s49, 86016
 s_add_u32 s45, s32, 393216
 buffer_load_dwordx4 v11, s[12:15], s45 offen  lds
 s_add_u32 m0, s49, 90112
 s_add_u32 s45, s33, 262144
 buffer_load_dwordx4 v11, s[16:19], s45 offen  lds
 s_add_u32 m0, s49, 94208
 s_add_u32 s45, s33, 393216
 buffer_load_dwordx4 v11, s[16:19], s45 offen  lds
 s_add_u32 m0, s49, 98304
 s_add_u32 s45, s32, 524288
 buffer_load_dwordx4 v11, s[12:15], s45 offen  lds
 s_add_u32 m0, s49, 102400
 s_add_u32 s45, s32, 655360
 buffer_load_dwordx4 v11, s[12:15], s45 offen  lds
 s_add_u32 m0, s49, 106496
 s_add_u32 s45, s33, 524288
 buffer_load_dwordx4 v11, s[16:19], s45 offen  lds
 s_add_u32 m0, s49, 110592
 s_add_u32 s45, s33, 655360
 buffer_load_dwordx4 v11, s[16:19], s45 offen  lds
 s_waitcnt vmcnt(8) lgkmcnt(0)
 s_barrier
 s_add_u32 m0, s49, 114688
 s_add_u32 s45, s32, 786432
 buffer_load_dwordx4 v11, s[12:15], s45 offen  lds
 s_add_u32 m0, s49, 118784
 s_add_u32 s45, s32, 917504
 buffer_load_dwordx4 v11, s[12:15], s45 offen  lds
 s_add_u32 m0, s49, 122880
 s_add_u32 s45, s33, 786432
 buffer_load_dwordx4 v11, s[16:19], s45 offen  lds
 s_add_u32 m0, s49, 126976
 s_add_u32 s45, s33, 917504
 buffer_load_dwordx4 v11, s[16:19], s45 offen  lds
 ds_read_b64_tr_b16 a[0:1], v8 offset:0
 ds_read_b64_tr_b16 a[2:3], v8 offset:1024
 ds_read_b64_tr_b16 a[64:65], v9 offset:0
 ds_read_b64_tr_b16 a[66:67], v9 offset:1024
 ds_read_b64_tr_b16 a[128:129], v8 offset:8192
 ds_read_b64_tr_b16 a[130:131], v8 offset:9216
 ds_read_b64_tr_b16 a[192:193], v9 offset:8192
 ds_read_b64_tr_b16 a[194:195], v9 offset:9216
 s_waitcnt vmcnt(8) lgkmcnt(0)
 s_barrier
 s_add_u32 m0, s49, 65536
 s_add_u32 s45, s32, 1048576
 buffer_load_dwordx4 v11, s[12:15], s45 offen  lds
 s_add_u32 m0, s49, 69632
 s_add_u32 s45, s32, 1179648
 buffer_load_dwordx4 v11, s[12:15], s45 offen  lds
 s_add_u32 m0, s49, 73728
 s_add_u32 s45, s33, 1048576
 buffer_load_dwordx4 v11, s[16:19], s45 offen  lds
 s_add_u32 m0, s49, 77824
 s_add_u32 s45, s33, 1179648
 buffer_load_dwordx4 v11, s[16:19], s45 offen  lds
 ds_read_b64_tr_b16 a[4:5], v8 offset:16384
 ds_read_b64_tr_b16 a[6:7], v8 offset:17408
 ds_read_b64_tr_b16 a[68:69], v9 offset:16384
 ds_read_b64_tr_b16 a[70:71], v9 offset:17408
 ds_read_b64_tr_b16 a[132:133], v8 offset:24576
 ds_read_b64_tr_b16 a[134:135], v8 offset:25600
 ds_read_b64_tr_b16 a[196:197], v9 offset:24576
 ds_read_b64_tr_b16 a[198:199], v9 offset:25600
 s_waitcnt vmcnt(8) lgkmcnt(0)
 s_barrier
 s_add_u32 m0, s49, 81920
 s_add_u32 s45, s32, 1310720
 buffer_load_dwordx4 v11, s[12:15], s45 offen  lds
 s_add_u32 m0, s49, 86016
 s_add_u32 s45, s32, 1441792
 buffer_load_dwordx4 v11, s[12:15], s45 offen  lds
 s_add_u32 m0, s49, 90112
 s_add_u32 s45, s33, 1310720
 buffer_load_dwordx4 v11, s[16:19], s45 offen  lds
 s_add_u32 m0, s49, 94208
 s_add_u32 s45, s33, 1441792
 buffer_load_dwordx4 v11, s[16:19], s45 offen  lds
 ds_read_b64_tr_b16 a[8:9], v8 offset:32768
 ds_read_b64_tr_b16 a[10:11], v8 offset:33792
 ds_read_b64_tr_b16 a[72:73], v9 offset:32768
 ds_read_b64_tr_b16 a[74:75], v9 offset:33792
 ds_read_b64_tr_b16 a[136:137], v8 offset:40960
 ds_read_b64_tr_b16 a[138:139], v8 offset:41984
 ds_read_b64_tr_b16 a[200:201], v9 offset:40960
 ds_read_b64_tr_b16 a[202:203], v9 offset:41984
 s_waitcnt vmcnt(8) lgkmcnt(0)
 s_barrier
 s_add_u32 m0, s49, 98304
 s_add_u32 s45, s32, 1572864
 buffer_load_dwordx4 v11, s[12:15], s45 offen  lds
 s_add_u32 m0, s49, 102400
 s_add_u32 s45, s32, 1703936
 buffer_load_dwordx4 v11, s[12:15], s45 offen  lds
 s_add_u32 m0, s49, 106496
 s_add_u32 s45, s33, 1572864
 buffer_load_dwordx4 v11, s[16:19], s45 offen  lds
 s_add_u32 m0, s49, 110592
 s_add_u32 s45, s33, 1703936
 buffer_load_dwordx4 v11, s[16:19], s45 offen  lds
 ds_read_b64_tr_b16 a[12:13], v8 offset:49152
 ds_read_b64_tr_b16 a[14:15], v8 offset:50176
 ds_read_b64_tr_b16 a[76:77], v9 offset:49152
 ds_read_b64_tr_b16 a[78:79], v9 offset:50176
 ds_read_b64_tr_b16 a[140:141], v8 offset:57344
 ds_read_b64_tr_b16 a[142:143], v8 offset:58368
 ds_read_b64_tr_b16 a[204:205], v9 offset:57344
 ds_read_b64_tr_b16 a[206:207], v9 offset:58368
 s_waitcnt vmcnt(8) lgkmcnt(0)
 s_barrier
 s_add_u32 m0, s49, 114688
 s_add_u32 s45, s32, 1835008
 buffer_load_dwordx4 v11, s[12:15], s45 offen  lds
 s_add_u32 m0, s49, 118784
 s_add_u32 s45, s32, 1966080
 buffer_load_dwordx4 v11, s[12:15], s45 offen  lds
 s_add_u32 m0, s49, 122880
 s_add_u32 s45, s33, 1835008
 buffer_load_dwordx4 v11, s[16:19], s45 offen  lds
 s_add_u32 m0, s49, 126976
 s_add_u32 s45, s33, 1966080
 buffer_load_dwordx4 v11, s[16:19], s45 offen  lds
 ds_read_b64_tr_b16 a[16:17], v8 offset:0
 ds_read_b64_tr_b16 a[18:19], v8 offset:1024
 ds_read_b64_tr_b16 a[80:81], v9 offset:0
 ds_read_b64_tr_b16 a[82:83], v9 offset:1024
 ds_read_b64_tr_b16 a[144:145], v8 offset:8192
 ds_read_b64_tr_b16 a[146:147], v8 offset:9216
 ds_read_b64_tr_b16 a[208:209], v9 offset:8192
 ds_read_b64_tr_b16 a[210:211], v9 offset:9216
 s_waitcnt vmcnt(8) lgkmcnt(0)
 s_barrier
 s_add_u32 m0, s49, 65536
 s_add_u32 s45, s32, 2097152
 buffer_load_dwordx4 v11, s[12:15], s45 offen  lds
 s_add_u32 m0, s49, 69632
 s_add_u32 s45, s32, 2228224
 buffer_load_dwordx4 v11, s[12:15], s45 offen  lds
 s_add_u32 m0, s49, 73728
 s_add_u32 s45, s33, 2097152
 buffer_load_dwordx4 v11, s[16:19], s45 offen  lds
 s_add_u32 m0, s49, 77824
 s_add_u32 s45, s33, 2228224
 buffer_load_dwordx4 v11, s[16:19], s45 offen  lds
 ds_read_b64_tr_b16 a[20:21], v8 offset:16384
 ds_read_b64_tr_b16 a[22:23], v8 offset:17408
 ds_read_b64_tr_b16 a[84:85], v9 offset:16384
 ds_read_b64_tr_b16 a[86:87], v9 offset:17408
 ds_read_b64_tr_b16 a[148:149], v8 offset:24576
 ds_read_b64_tr_b16 a[150:151], v8 offset:25600
 ds_read_b64_tr_b16 a[212:213], v9 offset:24576
 ds_read_b64_tr_b16 a[214:215], v9 offset:25600
 s_waitcnt vmcnt(8) lgkmcnt(0)
 s_barrier
 s_add_u32 m0, s49, 81920
 s_add_u32 s45, s32, 2359296
 buffer_load_dwordx4 v11, s[12:15], s45 offen  lds
 s_add_u32 m0, s49, 86016
 s_add_u32 s45, s32, 2490368
 buffer_load_dwordx4 v11, s[12:15], s45 offen  lds
 s_add_u32 m0, s49, 90112
 s_add_u32 s45, s33, 2359296
 buffer_load_dwordx4 v11, s[16:19], s45 offen  lds
 s_add_u32 m0, s49, 94208
 s_add_u32 s45, s33, 2490368
 buffer_load_dwordx4 v11, s[16:19], s45 offen  lds
 ds_read_b64_tr_b16 a[24:25], v8 offset:32768
 ds_read_b64_tr_b16 a[26:27], v8 offset:33792
 ds_read_b64_tr_b16 a[88:89], v9 offset:32768
 ds_read_b64_tr_b16 a[90:91], v9 offset:33792
 ds_read_b64_tr_b16 a[152:153], v8 offset:40960
 ds_read_b64_tr_b16 a[154:155], v8 offset:41984
 ds_read_b64_tr_b16 a[216:217], v9 offset:40960
 ds_read_b64_tr_b16 a[218:219], v9 offset:41984
 s_waitcnt vmcnt(8) lgkmcnt(0)
 s_barrier
 s_add_u32 m0, s49, 98304
 s_add_u32 s45, s32, 2621440
 buffer_load_dwordx4 v11, s[12:15], s45 offen  lds
 s_add_u32 m0, s49, 102400
 s_add_u32 s45, s32, 2752512
 buffer_load_dwordx4 v11, s[12:15], s45 offen  lds
 s_add_u32 m0, s49, 106496
 s_add_u32 s45, s33, 2621440
 buffer_load_dwordx4 v11, s[16:19], s45 offen  lds
 s_add_u32 m0, s49, 110592
 s_add_u32 s45, s33, 2752512
 buffer_load_dwordx4 v11, s[16:19], s45 offen  lds
 ds_read_b64_tr_b16 a[28:29], v8 offset:49152
 ds_read_b64_tr_b16 a[30:31], v8 offset:50176
 ds_read_b64_tr_b16 a[92:93], v9 offset:49152
 ds_read_b64_tr_b16 a[94:95], v9 offset:50176
 ds_read_b64_tr_b16 a[156:157], v8 offset:57344
 ds_read_b64_tr_b16 a[158:159], v8 offset:58368
 ds_read_b64_tr_b16 a[220:221], v9 offset:57344
 ds_read_b64_tr_b16 a[222:223], v9 offset:58368
 s_waitcnt vmcnt(8) lgkmcnt(0)
 s_barrier
 s_add_u32 m0, s49, 114688
 s_add_u32 s45, s32, 2883584
 buffer_load_dwordx4 v11, s[12:15], s45 offen  lds
 s_add_u32 m0, s49, 118784
 s_add_u32 s45, s32, 3014656
 buffer_load_dwordx4 v11, s[12:15], s45 offen  lds
 s_add_u32 m0, s49, 122880
 s_add_u32 s45, s33, 2883584
 buffer_load_dwordx4 v11, s[16:19], s45 offen  lds
 s_add_u32 m0, s49, 126976
 s_add_u32 s45, s33, 3014656
 buffer_load_dwordx4 v11, s[16:19], s45 offen  lds
 ds_read_b64_tr_b16 a[32:33], v8 offset:0
 ds_read_b64_tr_b16 a[34:35], v8 offset:1024
 ds_read_b64_tr_b16 a[96:97], v9 offset:0
 ds_read_b64_tr_b16 a[98:99], v9 offset:1024
 ds_read_b64_tr_b16 a[160:161], v8 offset:8192
 ds_read_b64_tr_b16 a[162:163], v8 offset:9216
 ds_read_b64_tr_b16 a[224:225], v9 offset:8192
 ds_read_b64_tr_b16 a[226:227], v9 offset:9216
 s_waitcnt vmcnt(8) lgkmcnt(0)
 s_barrier
 s_add_u32 m0, s49, 65536
 s_add_u32 s45, s32, 3145728
 buffer_load_dwordx4 v11, s[12:15], s45 offen  lds
 s_add_u32 m0, s49, 69632
 s_add_u32 s45, s32, 3276800
 buffer_load_dwordx4 v11, s[12:15], s45 offen  lds
 s_add_u32 m0, s49, 73728
 s_add_u32 s45, s33, 3145728
 buffer_load_dwordx4 v11, s[16:19], s45 offen  lds
 s_add_u32 m0, s49, 77824
 s_add_u32 s45, s33, 3276800
 buffer_load_dwordx4 v11, s[16:19], s45 offen  lds
 ds_read_b64_tr_b16 a[36:37], v8 offset:16384
 ds_read_b64_tr_b16 a[38:39], v8 offset:17408
 ds_read_b64_tr_b16 a[100:101], v9 offset:16384
 ds_read_b64_tr_b16 a[102:103], v9 offset:17408
 ds_read_b64_tr_b16 a[164:165], v8 offset:24576
 ds_read_b64_tr_b16 a[166:167], v8 offset:25600
 ds_read_b64_tr_b16 a[228:229], v9 offset:24576
 ds_read_b64_tr_b16 a[230:231], v9 offset:25600
 s_waitcnt vmcnt(8) lgkmcnt(0)
 s_barrier
 s_add_u32 m0, s49, 81920
 s_add_u32 s45, s32, 3407872
 buffer_load_dwordx4 v11, s[12:15], s45 offen  lds
 s_add_u32 m0, s49, 86016
 s_add_u32 s45, s32, 3538944
 buffer_load_dwordx4 v11, s[12:15], s45 offen  lds
 s_add_u32 m0, s49, 90112
 s_add_u32 s45, s33, 3407872
 buffer_load_dwordx4 v11, s[16:19], s45 offen  lds
 s_add_u32 m0, s49, 94208
 s_add_u32 s45, s33, 3538944
 buffer_load_dwordx4 v11, s[16:19], s45 offen  lds
 ds_read_b64_tr_b16 a[40:41], v8 offset:32768
 ds_read_b64_tr_b16 a[42:43], v8 offset:33792
 ds_read_b64_tr_b16 a[104:105], v9 offset:32768
 ds_read_b64_tr_b16 a[106:107], v9 offset:33792
 ds_read_b64_tr_b16 a[168:169], v8 offset:40960
 ds_read_b64_tr_b16 a[170:171], v8 offset:41984
 ds_read_b64_tr_b16 a[232:233], v9 offset:40960
 ds_read_b64_tr_b16 a[234:235], v9 offset:41984
 s_waitcnt vmcnt(8) lgkmcnt(0)
 s_barrier
 s_add_u32 m0, s49, 98304
 s_add_u32 s45, s32, 3670016
 buffer_load_dwordx4 v11, s[12:15], s45 offen  lds
 s_add_u32 m0, s49, 102400
 s_add_u32 s45, s32, 3801088
 buffer_load_dwordx4 v11, s[12:15], s45 offen  lds
 s_add_u32 m0, s49, 106496
 s_add_u32 s45, s33, 3670016
 buffer_load_dwordx4 v11, s[16:19], s45 offen  lds
 s_add_u32 m0, s49, 110592
 s_add_u32 s45, s33, 3801088
 buffer_load_dwordx4 v11, s[16:19], s45 offen  lds
 ds_read_b64_tr_b16 a[44:45], v8 offset:49152
 ds_read_b64_tr_b16 a[46:47], v8 offset:50176
 ds_read_b64_tr_b16 a[108:109], v9 offset:49152
 ds_read_b64_tr_b16 a[110:111], v9 offset:50176
 ds_read_b64_tr_b16 a[172:173], v8 offset:57344
 ds_read_b64_tr_b16 a[174:175], v8 offset:58368
 ds_read_b64_tr_b16 a[236:237], v9 offset:57344
 ds_read_b64_tr_b16 a[238:239], v9 offset:58368
 s_waitcnt vmcnt(8) lgkmcnt(0)
 s_barrier
 s_add_u32 m0, s49, 114688
 s_add_u32 s45, s32, 3932160
 buffer_load_dwordx4 v11, s[12:15], s45 offen  lds
 s_add_u32 m0, s49, 118784
 s_add_u32 s45, s32, 4063232
 buffer_load_dwordx4 v11, s[12:15], s45 offen  lds
 s_add_u32 m0, s49, 122880
 s_add_u32 s45, s33, 3932160
 buffer_load_dwordx4 v11, s[16:19], s45 offen  lds
 s_add_u32 m0, s49, 126976
 s_add_u32 s45, s33, 4063232
 buffer_load_dwordx4 v11, s[16:19], s45 offen  lds
 ds_read_b64_tr_b16 a[48:49], v8 offset:0
 ds_read_b64_tr_b16 a[50:51], v8 offset:1024
 ds_read_b64_tr_b16 a[112:113], v9 offset:0
 ds_read_b64_tr_b16 a[114:115], v9 offset:1024
 ds_read_b64_tr_b16 a[176:177], v8 offset:8192
 ds_read_b64_tr_b16 a[178:179], v8 offset:9216
 ds_read_b64_tr_b16 a[240:241], v9 offset:8192
 ds_read_b64_tr_b16 a[242:243], v9 offset:9216
 s_waitcnt vmcnt(8) lgkmcnt(0)
 s_barrier
 ds_read_b64_tr_b16 a[52:53], v8 offset:16384
 ds_read_b64_tr_b16 a[54:55], v8 offset:17408
 ds_read_b64_tr_b16 a[116:117], v9 offset:16384
 ds_read_b64_tr_b16 a[118:119], v9 offset:17408
 ds_read_b64_tr_b16 a[180:181], v8 offset:24576
 ds_read_b64_tr_b16 a[182:183], v8 offset:25600
 ds_read_b64_tr_b16 a[244:245], v9 offset:24576
 ds_read_b64_tr_b16 a[246:247], v9 offset:25600
 s_waitcnt vmcnt(4) lgkmcnt(0)
 s_barrier
 ds_read_b64_tr_b16 a[56:57], v8 offset:32768
 ds_read_b64_tr_b16 a[58:59], v8 offset:33792
 ds_read_b64_tr_b16 a[120:121], v9 offset:32768
 ds_read_b64_tr_b16 a[122:123], v9 offset:33792
 ds_read_b64_tr_b16 a[184:185], v8 offset:40960
 ds_read_b64_tr_b16 a[186:187], v8 offset:41984
 ds_read_b64_tr_b16 a[248:249], v9 offset:40960
 ds_read_b64_tr_b16 a[250:251], v9 offset:41984
 s_waitcnt vmcnt(0) lgkmcnt(0)
 s_barrier
 ds_read_b64_tr_b16 a[60:61], v8 offset:49152
 ds_read_b64_tr_b16 a[62:63], v8 offset:50176
 ds_read_b64_tr_b16 a[124:125], v9 offset:49152
 ds_read_b64_tr_b16 a[126:127], v9 offset:50176
 ds_read_b64_tr_b16 a[188:189], v8 offset:57344
 ds_read_b64_tr_b16 a[190:191], v8 offset:58368
 ds_read_b64_tr_b16 a[252:253], v9 offset:57344
 ds_read_b64_tr_b16 a[254:255], v9 offset:58368
 s_mov_b32 s50, 0x3e0293ee
 s_mov_b32 s42, 0
 s_mov_b32 s43, 0
 s_mov_b32 s44, 65536
 v_mov_b32 v6, v4
 v_mov_b32 v7, v5
 s_mov_b32 s95, 0x40000
 s_cmp_lg_u32 s4, 0
 s_cbranch_scc1 Lfrk_2
 v_min_u32 v21, 1, v0
 v_lshlrev_b32 v21, 28, v21
Lfr_1:
 buffer_load_dword v20, v21, s[28:31], 0 offen offset:128 sc1
 s_waitcnt vmcnt(0)
 v_cmp_eq_u32 vcc, 1, v20
 s_cbranch_vccnz Lfrk_2
 s_sleep 12
 s_sub_u32 s95, s95, 1
 s_cbranch_scc0 Lfr_1
 s_endpgm
Lfrk_2:
 s_lshl_b32 s47, s2, 13
 s_add_u32 s47, s47, 0x8000000
 s_mov_b32 s48, s47
 v_mov_b32 v14, 0
 s_waitcnt vmcnt(0) lgkmcnt(0)
 s_barrier
 ds_read_b128 v[32:35], v6 offset:0
 ds_read_b128 v[36:39], v6 offset:2048
 ds_read_b128 v[40:43], v7 offset:0
 ds_read_b128 v[44:47], v7 offset:2048
 v_lshlrev_b32 v1, 12, v0
 s_lshl_b32 s45, s6, 7
 buffer_load_dword v15, v1, s[8:11], s45 offen
 v_add_u32 v1, 0x100000, v1
 buffer_load_dword v15, v1, s[8:11], s45 offen
 v_add_u32 v1, 0x100000, v1
 s_waitcnt lgkmcnt(2)
Lps_loop_3:
 v_mfma_f32_16x16x32_bf16 v[64:67], a[0:3], v[32:35], 0
 ds_read_b128 v[48:51], v6 offset:4096
 v_mfma_f32_16x16x32_bf16 v[72:75], a[64:67], v[32:35], 0
 ds_read_b128 v[52:55], v6 offset:6144
 v_mfma_f32_16x16x32_bf16 v[80:83], v[32:35], a[128:131], 0
 s_add_u32 s41, s40, 4
 v_mfma_f32_16x16x32_bf16 v[88:91], v[32:35], a[192:195], 0
 s_add_u32 s45, s42, 2
 s_mul_i32 s46, s41, 32768
 v_mfma_f32_16x16x32_bf16 v[68:71], a[0:3], v[36:39], 0
 s_cmp_lt_u32 s45, s36
 s_cselect_b32 s46, s46, 0
 v_mfma_f32_16x16x32_bf16 v[76:79], a[64:67], v[36:39], 0
 s_lshl_b32 s49, s4, 10
 s_add_u32 s49, s49, s44
 v_mfma_f32_16x16x32_bf16 v[84:87], v[36:39], a[128:131], 0
 v_mfma_f32_16x16x32_bf16 v[92:95], v[36:39], a[192:195], 0
 s_waitcnt lgkmcnt(2)
 v_mfma_f32_16x16x32_bf16 v[64:67], a[4:7], v[40:43], v[64:67]
 ds_read_b128 v[56:59], v7 offset:4096
 v_mfma_f32_16x16x32_bf16 v[72:75], a[68:71], v[40:43], v[72:75]
 ds_read_b128 v[60:63], v7 offset:6144
 v_mfma_f32_16x16x32_bf16 v[80:83], v[40:43], a[132:135], v[80:83]
 s_add_u32 m0, s49, 0
 v_mfma_f32_16x16x32_bf16 v[88:91], v[40:43], a[196:199], v[88:91]
 buffer_load_dwordx4 v10, s[8:11], s46 offen offset:0  lds
 v_mfma_f32_16x16x32_bf16 v[68:71], a[4:7], v[44:47], v[68:71]
 s_add_u32 m0, s49, 3968
 v_mfma_f32_16x16x32_bf16 v[76:79], a[68:71], v[44:47], v[76:79]
 buffer_load_dwordx4 v10, s[8:11], s46 offen offset:128  lds
 v_mfma_f32_16x16x32_bf16 v[84:87], v[44:47], a[132:135], v[84:87]
 v_mfma_f32_16x16x32_bf16 v[92:95], v[44:47], a[196:199], v[92:95]
 s_waitcnt lgkmcnt(2)
 v_mfma_f32_16x16x32_bf16 v[64:67], a[8:11], v[48:51], v[64:67]
 ds_read_b128 v[32:35], v6 offset:8192
 v_mfma_f32_16x16x32_bf16 v[72:75], a[72:75], v[48:51], v[72:75]
 ds_read_b128 v[36:39], v6 offset:10240
 v_mfma_f32_16x16x32_bf16 v[80:83], v[48:51], a[136:139], v[80:83]
 s_add_u32 m0, s49, 7936
 v_mfma_f32_16x16x32_bf16 v[88:91], v[48:51], a[200:203], v[88:91]
 buffer_load_dwordx4 v10, s[8:11], s46 offen offset:256  lds
 v_mfma_f32_16x16x32_bf16 v[68:71], a[8:11], v[52:55], v[68:71]
 s_add_u32 m0, s49, 11904
 v_mfma_f32_16x16x32_bf16 v[76:79], a[72:75], v[52:55], v[76:79]
 buffer_load_dwordx4 v10, s[8:11], s46 offen offset:384  lds
 v_mfma_f32_16x16x32_bf16 v[84:87], v[52:55], a[136:139], v[84:87]
 v_mfma_f32_16x16x32_bf16 v[92:95], v[52:55], a[200:203], v[92:95]
 s_waitcnt lgkmcnt(2)
 v_mfma_f32_16x16x32_bf16 v[64:67], a[12:15], v[56:59], v[64:67]
 ds_read_b128 v[40:43], v7 offset:8192
 v_mfma_f32_16x16x32_bf16 v[72:75], a[76:79], v[56:59], v[72:75]
 ds_read_b128 v[44:47], v7 offset:10240
 v_mfma_f32_16x16x32_bf16 v[80:83], v[56:59], a[140:143], v[80:83]
 s_add_u32 m0, s49, 15872
 v_mfma_f32_16x16x32_bf16 v[88:91], v[56:59], a[204:207], v[88:91]
 buffer_load_dwordx4 v10, s[8:11], s46 offen offset:512  lds
 v_mfma_f32_16x16x32_bf16 v[68:71], a[12:15], v[60:63], v[68:71]
 s_add_u32 m0, s49, 19840
 v_mfma_f32_16x16x32_bf16 v[76:79], a[76:79], v[60:63], v[76:79]
 buffer_load_dwordx4 v10, s[8:11], s46 offen offset:640  lds
 v_mfma_f32_16x16x32_bf16 v[84:87], v[60:63], a[140:143], v[84:87]
 v_mfma_f32_16x16x32_bf16 v[92:95], v[60:63], a[204:207], v[92:95]
 s_waitcnt lgkmcnt(2)
 v_mfma_f32_16x16x32_bf16 v[64:67], a[16:19], v[32:35], v[64:67]
 ds_read_b128 v[48:51], v6 offset:12288
 v_mfma_f32_16x16x32_bf16 v[72:75], a[80:83], v[32:35], v[72:75]
 ds_read_b128 v[52:55], v6 offset:14336
 v_mfma_f32_16x16x32_bf16 v[80:83], v[32:35], a[144:147], v[80:83]
 s_add_u32 m0, s49, 23808
 v_mfma_f32_16x16x32_bf16 v[88:91], v[32:35], a[208:211], v[88:91]
 buffer_load_dwordx4 v10, s[8:11], s46 offen offset:768  lds
 v_mfma_f32_16x16x32_bf16 v[68:71], a[16:19], v[36:39], v[68:71]
 s_add_u32 m0, s49, 27776
 v_mfma_f32_16x16x32_bf16 v[76:79], a[80:83], v[36:39], v[76:79]
 buffer_load_dwordx4 v10, s[8:11], s46 offen offset:896  lds
 v_mfma_f32_16x16x32_bf16 v[84:87], v[36:39], a[144:147], v[84:87]
 v_mfma_f32_16x16x32_bf16 v[92:95], v[36:39], a[208:211], v[92:95]
 s_waitcnt lgkmcnt(2)
 v_mfma_f32_16x16x32_bf16 v[64:67], a[20:23], v[40:43], v[64:67]
 ds_read_b128 v[56:59], v7 offset:12288
 v_mfma_f32_16x16x32_bf16 v[72:75], a[84:87], v[40:43], v[72:75]
 ds_read_b128 v[60:63], v7 offset:14336
 v_mfma_f32_16x16x32_bf16 v[80:83], v[40:43], a[148:151], v[80:83]
 v_mfma_f32_16x16x32_bf16 v[88:91], v[40:43], a[212:215], v[88:91]
 v_mfma_f32_16x16x32_bf16 v[68:71], a[20:23], v[44:47], v[68:71]
 v_mfma_f32_16x16x32_bf16 v[76:79], a[84:87], v[44:47], v[76:79]
 v_mfma_f32_16x16x32_bf16 v[84:87], v[44:47], a[148:151], v[84:87]
 v_mfma_f32_16x16x32_bf16 v[92:95], v[44:47], a[212:215], v[92:95]
 s_waitcnt lgkmcnt(2)
 v_mfma_f32_16x16x32_bf16 v[64:67], a[24:27], v[48:51], v[64:67]
 ds_read_b128 v[32:35], v6 offset:16384
 v_mfma_f32_16x16x32_bf16 v[72:75], a[88:91], v[48:51], v[72:75]
 ds_read_b128 v[36:39], v6 offset:18432
 v_mfma_f32_16x16x32_bf16 v[80:83], v[48:51], a[152:155], v[80:83]
 v_cvt_pk_bf16_f32 v16, v96, v97
 v_mfma_f32_16x16x32_bf16 v[88:91], v[48:51], a[216:219], v[88:91]
 v_cvt_pk_bf16_f32 v17, v104, v105
 v_mfma_f32_16x16x32_bf16 v[68:71], a[24:27], v[52:55], v[68:71]
 v_mfma_f32_16x16x32_bf16 v[76:79], a[88:91], v[52:55], v[76:79]
 v_cvt_pk_bf16_f32 v18, v98, v99
 v_mfma_f32_16x16x32_bf16 v[84:87], v[52:55], a[152:155], v[84:87]
 v_mfma_f32_16x16x32_bf16 v[92:95], v[52:55], a[216:219], v[92:95]
 s_waitcnt lgkmcnt(2)
 v_mfma_f32_16x16x32_bf16 v[64:67], a[28:31], v[56:59], v[64:67]
 ds_read_b128 v[40:43], v7 offset:16384
 v_mfma_f32_16x16x32_bf16 v[72:75], a[92:95], v[56:59], v[72:75]
 ds_read_b128 v[44:47], v7 offset:18432
 v_mfma_f32_16x16x32_bf16 v[80:83], v[56:59], a[156:159], v[80:83]
 v_cvt_pk_bf16_f32 v19, v106, v107
 v_mfma_f32_16x16x32_bf16 v[88:91], v[56:59], a[220:223], v[88:91]
 v_mfma_f32_16x16x32_bf16 v[68:71], a[28:31], v[60:63], v[68:71]
 buffer_store_dwordx4 v[16:19], v12, s[20:23], s47 offen offset:0 sc1
 v_mfma_f32_16x16x32_bf16 v[76:79], a[92:95], v[60:63], v[76:79]
 v_cvt_pk_bf16_f32 v20, v100, v101
 v_mfma_f32_16x16x32_bf16 v[84:87], v[60:63], a[156:159], v[84:87]
 v_mfma_f32_16x16x32_bf16 v[92:95], v[60:63], a[220:223], v[92:95]
 s_waitcnt lgkmcnt(2)
 v_mfma_f32_16x16x32_bf16 v[64:67], a[32:35], v[32:35], v[64:67]
 ds_read_b128 v[48:51], v6 offset:20480
 v_mfma_f32_16x16x32_bf16 v[72:75], a[96:99], v[32:35], v[72:75]
 ds_read_b128 v[52:55], v6 offset:22528
 v_mfma_f32_16x16x32_bf16 v[80:83], v[32:35], a[160:163], v[80:83]
 v_cvt_pk_bf16_f32 v21, v108, v109
 v_mfma_f32_16x16x32_bf16 v[88:91], v[32:35], a[224:227], v[88:91]
 v_mfma_f32_16x16x32_bf16 v[68:71], a[32:35], v[36:39], v[68:71]
 v_cvt_pk_bf16_f32 v22, v102, v103
 v_mfma_f32_16x16x32_bf16 v[76:79], a[96:99], v[36:39], v[76:79]
 v_mfma_f32_16x16x32_bf16 v[84:87], v[36:39], a[160:163], v[84:87]
 v_cvt_pk_bf16_f32 v23, v110, v111
 v_mfma_f32_16x16x32_bf16 v[92:95], v[36:39], a[224:227], v[92:95]
 s_waitcnt lgkmcnt(2)
 v_mfma_f32_16x16x32_bf16 v[64:67], a[36:39], v[40:43], v[64:67]
 ds_read_b128 v[56:59], v7 offset:20480
 v_mfma_f32_16x16x32_bf16 v[72:75], a[100:103], v[40:43], v[72:75]
 ds_read_b128 v[60:63], v7 offset:22528
 v_mfma_f32_16x16x32_bf16 v[80:83], v[40:43], a[164:167], v[80:83]
 buffer_store_dwordx4 v[20:23], v12, s[20:23], s47 offen offset:1024 sc1
 v_mfma_f32_16x16x32_bf16 v[88:91], v[40:43], a[228:231], v[88:91]
 v_mfma_f32_16x16x32_bf16 v[68:71], a[36:39], v[44:47], v[68:71]
 v_cvt_pk_bf16_f32 v24, v112, v113
 v_mfma_f32_16x16x32_bf16 v[76:79], a[100:103], v[44:47], v[76:79]
 v_mfma_f32_16x16x32_bf16 v[84:87], v[44:47], a[164:167], v[84:87]
 v_cvt_pk_bf16_f32 v25, v116, v117
 v_mfma_f32_16x16x32_bf16 v[92:95], v[44:47], a[228:231], v[92:95]
 s_waitcnt lgkmcnt(2)
 v_mfma_f32_16x16x32_bf16 v[64:67], a[40:43], v[48:51], v[64:67]
 ds_read_b128 v[32:35], v6 offset:24576
 v_mfma_f32_16x16x32_bf16 v[72:75], a[104:107], v[48:51], v[72:75]
 ds_read_b128 v[36:39], v6 offset:26624
 v_mfma_f32_16x16x32_bf16 v[80:83], v[48:51], a[168:171], v[80:83]
 v_mfma_f32_16x16x32_bf16 v[88:91], v[48:51], a[232:235], v[88:91]
 v_cvt_pk_bf16_f32 v26, v114, v115
 v_mfma_f32_16x16x32_bf16 v[68:71], a[40:43], v[52:55], v[68:71]
 v_cvt_pk_bf16_f32 v27, v118, v119
 v_mfma_f32_16x16x32_bf16 v[76:79], a[104:107], v[52:55], v[76:79]
 v_mfma_f32_16x16x32_bf16 v[84:87], v[52:55], a[168:171], v[84:87]
 buffer_store_dwordx4 v[24:27], v12, s[20:23], s48 offen offset:0 sc1
 v_mfma_f32_16x16x32_bf16 v[92:95], v[52:55], a[232:235], v[92:95]
 s_waitcnt lgkmcnt(2)
 v_mfma_f32_16x16x32_bf16 v[64:67], a[44:47], v[56:59], v[64:67]
 ds_read_b128 v[40:43], v7 offset:24576
 v_mfma_f32_16x16x32_bf16 v[72:75], a[108:111], v[56:59], v[72:75]
 ds_read_b128 v[44:47], v7 offset:26624
 v_mfma_f32_16x16x32_bf16 v[80:83], v[56:59], a[172:175], v[80:83]
 s_add_u32 s43, s43, 32768
 s_cmp_eq_u32 s43, 131072
 v_mfma_f32_16x16x32_bf16 v[88:91], v[56:59], a[236:239], v[88:91]
 s_cselect_b32 s43, 0, s43
 s_add_u32 s44, s44, 32768
 v_mfma_f32_16x16x32_bf16 v[68:71], a[44:47], v[60:63], v[68:71]
 s_cmp_eq_u32 s44, 131072
 s_cselect_b32 s44, 0, s44
 v_mfma_f32_16x16x32_bf16 v[76:79], a[108:111], v[60:63], v[76:79]
 v_mfma_f32_16x16x32_bf16 v[84:87], v[60:63], a[172:175], v[84:87]
 v_cvt_pk_bf16_f32 v28, v120, v121
 v_mfma_f32_16x16x32_bf16 v[92:95], v[60:63], a[236:239], v[92:95]
 s_waitcnt lgkmcnt(2)
 v_mfma_f32_16x16x32_bf16 v[64:67], a[48:51], v[32:35], v[64:67]
 ds_read_b128 v[48:51], v6 offset:28672
 v_mfma_f32_16x16x32_bf16 v[72:75], a[112:115], v[32:35], v[72:75]
 ds_read_b128 v[52:55], v6 offset:30720
 v_mfma_f32_16x16x32_bf16 v[80:83], v[32:35], a[176:179], v[80:83]
 v_add_u32 v6, s43, v4
 v_mfma_f32_16x16x32_bf16 v[88:91], v[32:35], a[240:243], v[88:91]
 v_mfma_f32_16x16x32_bf16 v[68:71], a[48:51], v[36:39], v[68:71]
 v_cvt_pk_bf16_f32 v29, v124, v125
 v_mfma_f32_16x16x32_bf16 v[76:79], a[112:115], v[36:39], v[76:79]
 v_cvt_pk_bf16_f32 v30, v122, v123
 v_mfma_f32_16x16x32_bf16 v[84:87], v[36:39], a[176:179], v[84:87]
 v_mfma_f32_16x16x32_bf16 v[92:95], v[36:39], a[240:243], v[92:95]
 s_waitcnt lgkmcnt(2)
 v_mfma_f32_16x16x32_bf16 v[64:67], a[52:55], v[40:43], v[64:67]
 ds_read_b128 v[56:59], v7 offset:28672
 v_mfma_f32_16x16x32_bf16 v[72:75], a[116:119], v[40:43], v[72:75]
 ds_read_b128 v[60:63], v7 offset:30720
 v_mfma_f32_16x16x32_bf16 v[80:83], v[40:43], a[180:183], v[80:83]
 v_add_u32 v7, s43, v5
 v_mfma_f32_16x16x32_bf16 v[88:91], v[40:43], a[244:247], v[88:91]
 v_cvt_pk_bf16_f32 v31, v126, v127
 v_mfma_f32_16x16x32_bf16 v[68:71], a[52:55], v[44:47], v[68:71]
 v_mfma_f32_16x16x32_bf16 v[76:79], a[116:119], v[44:47], v[76:79]
 buffer_store_dwordx4 v[28:31], v12, s[20:23], s48 offen offset:1024 sc1
 v_mfma_f32_16x16x32_bf16 v[84:87], v[44:47], a[180:183], v[84:87]
 v_mfma_f32_16x16x32_bf16 v[92:95], v[44:47], a[244:247], v[92:95]
 s_waitcnt lgkmcnt(2)
 v_mfma_f32_16x16x32_bf16 v[64:67], a[56:59], v[48:51], v[64:67]
 s_waitcnt vmcnt(12)
 s_barrier
 ds_read_b128 v[32:35], v6 offset:0
 v_mfma_f32_16x16x32_bf16 v[72:75], a[120:123], v[48:51], v[72:75]
 ds_read_b128 v[36:39], v6 offset:2048
 v_mfma_f32_16x16x32_bf16 v[80:83], v[48:51], a[184:187], v[80:83]
 v_mfma_f32_16x16x32_bf16 v[88:91], v[48:51], a[248:251], v[88:91]
 v_mfma_f32_16x16x32_bf16 v[68:71], a[56:59], v[52:55], v[68:71]
 v_mfma_f32_16x16x32_bf16 v[76:79], a[120:123], v[52:55], v[76:79]
 v_mfma_f32_16x16x32_bf16 v[84:87], v[52:55], a[184:187], v[84:87]
 v_mfma_f32_16x16x32_bf16 v[92:95], v[52:55], a[248:251], v[92:95]
 s_waitcnt lgkmcnt(2)
 v_mfma_f32_16x16x32_bf16 v[64:67], a[60:63], v[56:59], v[64:67]
 ds_read_b128 v[40:43], v7 offset:0
 v_mfma_f32_16x16x32_bf16 v[72:75], a[124:127], v[56:59], v[72:75]
 ds_read_b128 v[44:47], v7 offset:2048
 v_mfma_f32_16x16x32_bf16 v[80:83], v[56:59], a[188:191], v[80:83]
 s_mul_i32 s45, s39, 524288
 s_add_u32 s47, s34, s45
 v_mfma_f32_16x16x32_bf16 v[88:91], v[56:59], a[252:255], v[88:91]
 s_add_u32 s48, s35, s45
 v_mov_b32 v14, s42
 v_mfma_f32_16x16x32_bf16 v[68:71], a[60:63], v[60:63], v[68:71]
 s_mov_b32 s39, s40
 s_mov_b32 s40, s41
 v_mfma_f32_16x16x32_bf16 v[76:79], a[124:127], v[60:63], v[76:79]
 s_add_u32 s42, s42, 1
 v_mfma_f32_16x16x32_bf16 v[84:87], v[60:63], a[188:191], v[84:87]
 v_mfma_f32_16x16x32_bf16 v[92:95], v[60:63], a[252:255], v[92:95]
 s_waitcnt lgkmcnt(2)
 v_mfma_f32_16x16x32_bf16 v[96:99], a[0:3], v[32:35], 0
 ds_read_b128 v[48:51], v6 offset:4096
 v_mfma_f32_16x16x32_bf16 v[104:107], a[64:67], v[32:35], 0
 ds_read_b128 v[52:55], v6 offset:6144
 v_mfma_f32_16x16x32_bf16 v[112:115], v[32:35], a[128:131], 0
 s_add_u32 s41, s40, 4
 v_mfma_f32_16x16x32_bf16 v[120:123], v[32:35], a[192:195], 0
 s_add_u32 s45, s42, 2
 s_mul_i32 s46, s41, 32768
 v_mfma_f32_16x16x32_bf16 v[100:103], a[0:3], v[36:39], 0
 s_cmp_lt_u32 s45, s36
 s_cselect_b32 s46, s46, 0
 v_mfma_f32_16x16x32_bf16 v[108:111], a[64:67], v[36:39], 0
 s_lshl_b32 s49, s4, 10
 s_add_u32 s49, s49, s44
 v_mfma_f32_16x16x32_bf16 v[116:119], v[36:39], a[128:131], 0
 v_mfma_f32_16x16x32_bf16 v[124:127], v[36:39], a[192:195], 0
 s_waitcnt lgkmcnt(2)
 v_mfma_f32_16x16x32_bf16 v[96:99], a[4:7], v[40:43], v[96:99]
 ds_read_b128 v[56:59], v7 offset:4096
 v_mfma_f32_16x16x32_bf16 v[104:107], a[68:71], v[40:43], v[104:107]
 ds_read_b128 v[60:63], v7 offset:6144
 v_mfma_f32_16x16x32_bf16 v[112:115], v[40:43], a[132:135], v[112:115]
 s_add_u32 m0, s49, 0
 v_mfma_f32_16x16x32_bf16 v[120:123], v[40:43], a[196:199], v[120:123]
 buffer_load_dwordx4 v10, s[8:11], s46 offen offset:0  lds
 v_mfma_f32_16x16x32_bf16 v[100:103], a[4:7], v[44:47], v[100:103]
 s_add_u32 m0, s49, 3968
 v_mfma_f32_16x16x32_bf16 v[108:111], a[68:71], v[44:47], v[108:111]
 buffer_load_dwordx4 v10, s[8:11], s46 offen offset:128  lds
 v_mfma_f32_16x16x32_bf16 v[116:119], v[44:47], a[132:135], v[116:119]
 v_mfma_f32_16x16x32_bf16 v[124:127], v[44:47], a[196:199], v[124:127]
 s_waitcnt lgkmcnt(2)
 v_mfma_f32_16x16x32_bf16 v[96:99], a[8:11], v[48:51], v[96:99]
 ds_read_b128 v[32:35], v6 offset:8192
 v_mfma_f32_16x16x32_bf16 v[104:107], a[72:75], v[48:51], v[104:107]
 ds_read_b128 v[36:39], v6 offset:10240
 v_mfma_f32_16x16x32_bf16 v[112:115], v[48:51], a[136:139], v[112:115]
 s_add_u32 m0, s49, 7936
 v_mfma_f32_16x16x32_bf16 v[120:123], v[48:51], a[200:203], v[120:123]
 buffer_load_dwordx4 v10, s[8:11], s46 offen offset:256  lds
 v_mfma_f32_16x16x32_bf16 v[100:103], a[8:11], v[52:55], v[100:103]
 s_add_u32 m0, s49, 11904
 v_mfma_f32_16x16x32_bf16 v[108:111], a[72:75], v[52:55], v[108:111]
 buffer_load_dwordx4 v10, s[8:11], s46 offen offset:384  lds
 v_mfma_f32_16x16x32_bf16 v[116:119], v[52:55], a[136:139], v[116:119]
 v_mfma_f32_16x16x32_bf16 v[124:127], v[52:55], a[200:203], v[124:127]
 s_waitcnt lgkmcnt(2)
 v_mfma_f32_16x16x32_bf16 v[96:99], a[12:15], v[56:59], v[96:99]
 ds_read_b128 v[40:43], v7 offset:8192
 v_mfma_f32_16x16x32_bf16 v[104:107], a[76:79], v[56:59], v[104:107]
 ds_read_b128 v[44:47], v7 offset:10240
 v_mfma_f32_16x16x32_bf16 v[112:115], v[56:59], a[140:143], v[112:115]
 s_add_u32 m0, s49, 15872
 v_mfma_f32_16x16x32_bf16 v[120:123], v[56:59], a[204:207], v[120:123]
 buffer_load_dwordx4 v10, s[8:11], s46 offen offset:512  lds
 v_mfma_f32_16x16x32_bf16 v[100:103], a[12:15], v[60:63], v[100:103]
 s_add_u32 m0, s49, 19840
 v_mfma_f32_16x16x32_bf16 v[108:111], a[76:79], v[60:63], v[108:111]
 buffer_load_dwordx4 v10, s[8:11], s46 offen offset:640  lds
 v_mfma_f32_16x16x32_bf16 v[116:119], v[60:63], a[140:143], v[116:119]
 v_mfma_f32_16x16x32_bf16 v[124:127], v[60:63], a[204:207], v[124:127]
 s_waitcnt lgkmcnt(2)
 v_mfma_f32_16x16x32_bf16 v[96:99], a[16:19], v[32:35], v[96:99]
 ds_read_b128 v[48:51], v6 offset:12288
 v_mfma_f32_16x16x32_bf16 v[104:107], a[80:83], v[32:35], v[104:107]
 ds_read_b128 v[52:55], v6 offset:14336
 v_mfma_f32_16x16x32_bf16 v[112:115], v[32:35], a[144:147], v[112:115]
 s_add_u32 m0, s49, 23808
 v_mfma_f32_16x16x32_bf16 v[120:123], v[32:35], a[208:211], v[120:123]
 buffer_load_dwordx4 v10, s[8:11], s46 offen offset:768  lds
 v_mfma_f32_16x16x32_bf16 v[100:103], a[16:19], v[36:39], v[100:103]
 s_add_u32 m0, s49, 27776
 v_mfma_f32_16x16x32_bf16 v[108:111], a[80:83], v[36:39], v[108:111]
 buffer_load_dwordx4 v10, s[8:11], s46 offen offset:896  lds
 v_mfma_f32_16x16x32_bf16 v[116:119], v[36:39], a[144:147], v[116:119]
 v_mfma_f32_16x16x32_bf16 v[124:127], v[36:39], a[208:211], v[124:127]
 s_waitcnt lgkmcnt(2)
 v_mfma_f32_16x16x32_bf16 v[96:99], a[20:23], v[40:43], v[96:99]
 ds_read_b128 v[56:59], v7 offset:12288
 v_mfma_f32_16x16x32_bf16 v[104:107], a[84:87], v[40:43], v[104:107]
 ds_read_b128 v[60:63], v7 offset:14336
 v_mfma_f32_16x16x32_bf16 v[112:115], v[40:43], a[148:151], v[112:115]
 v_mfma_f32_16x16x32_bf16 v[120:123], v[40:43], a[212:215], v[120:123]
 v_mfma_f32_16x16x32_bf16 v[100:103], a[20:23], v[44:47], v[100:103]
 v_mfma_f32_16x16x32_bf16 v[108:111], a[84:87], v[44:47], v[108:111]
 v_mfma_f32_16x16x32_bf16 v[116:119], v[44:47], a[148:151], v[116:119]
 v_mfma_f32_16x16x32_bf16 v[124:127], v[44:47], a[212:215], v[124:127]
 s_waitcnt lgkmcnt(2)
 v_mfma_f32_16x16x32_bf16 v[96:99], a[24:27], v[48:51], v[96:99]
 ds_read_b128 v[32:35], v6 offset:16384
 v_mfma_f32_16x16x32_bf16 v[104:107], a[88:91], v[48:51], v[104:107]
 ds_read_b128 v[36:39], v6 offset:18432
 v_mfma_f32_16x16x32_bf16 v[112:115], v[48:51], a[152:155], v[112:115]
 v_cvt_pk_bf16_f32 v16, v64, v65
 v_mfma_f32_16x16x32_bf16 v[120:123], v[48:51], a[216:219], v[120:123]
 v_cvt_pk_bf16_f32 v17, v72, v73
 v_mfma_f32_16x16x32_bf16 v[100:103], a[24:27], v[52:55], v[100:103]
 v_mfma_f32_16x16x32_bf16 v[108:111], a[88:91], v[52:55], v[108:111]
 v_cvt_pk_bf16_f32 v18, v66, v67
 v_mfma_f32_16x16x32_bf16 v[116:119], v[52:55], a[152:155], v[116:119]
 v_mfma_f32_16x16x32_bf16 v[124:127], v[52:55], a[216:219], v[124:127]
 s_waitcnt lgkmcnt(2)
 v_mfma_f32_16x16x32_bf16 v[96:99], a[28:31], v[56:59], v[96:99]
 ds_read_b128 v[40:43], v7 offset:16384
 v_mfma_f32_16x16x32_bf16 v[104:107], a[92:95], v[56:59], v[104:107]
 ds_read_b128 v[44:47], v7 offset:18432
 v_mfma_f32_16x16x32_bf16 v[112:115], v[56:59], a[156:159], v[112:115]
 v_cvt_pk_bf16_f32 v19, v74, v75
 v_mfma_f32_16x16x32_bf16 v[120:123], v[56:59], a[220:223], v[120:123]
 v_mfma_f32_16x16x32_bf16 v[100:103], a[28:31], v[60:63], v[100:103]
 buffer_store_dwordx4 v[16:19], v12, s[20:23], s47 offen offset:0 sc1
 v_mfma_f32_16x16x32_bf16 v[108:111], a[92:95], v[60:63], v[108:111]
 v_cvt_pk_bf16_f32 v20, v68, v69
 v_mfma_f32_16x16x32_bf16 v[116:119], v[60:63], a[156:159], v[116:119]
 v_mfma_f32_16x16x32_bf16 v[124:127], v[60:63], a[220:223], v[124:127]
 s_waitcnt lgkmcnt(2)
 v_mfma_f32_16x16x32_bf16 v[96:99], a[32:35], v[32:35], v[96:99]
 ds_read_b128 v[48:51], v6 offset:20480
 v_mfma_f32_16x16x32_bf16 v[104:107], a[96:99], v[32:35], v[104:107]
 ds_read_b128 v[52:55], v6 offset:22528
 v_mfma_f32_16x16x32_bf16 v[112:115], v[32:35], a[160:163], v[112:115]
 v_cvt_pk_bf16_f32 v21, v76, v77
 v_mfma_f32_16x16x32_bf16 v[120:123], v[32:35], a[224:227], v[120:123]
 v_mfma_f32_16x16x32_bf16 v[100:103], a[32:35], v[36:39], v[100:103]
 v_cvt_pk_bf16_f32 v22, v70, v71
 v_mfma_f32_16x16x32_bf16 v[108:111], a[96:99], v[36:39], v[108:111]
 v_mfma_f32_16x16x32_bf16 v[116:119], v[36:39], a[160:163], v[116:119]
 v_cvt_pk_bf16_f32 v23, v78, v79
 v_mfma_f32_16x16x32_bf16 v[124:127], v[36:39], a[224:227], v[124:127]
 s_waitcnt lgkmcnt(2)
 v_mfma_f32_16x16x32_bf16 v[96:99], a[36:39], v[40:43], v[96:99]
 ds_read_b128 v[56:59], v7 offset:20480
 v_mfma_f32_16x16x32_bf16 v[104:107], a[100:103], v[40:43], v[104:107]
 ds_read_b128 v[60:63], v7 offset:22528
 v_mfma_f32_16x16x32_bf16 v[112:115], v[40:43], a[164:167], v[112:115]
 buffer_store_dwordx4 v[20:23], v12, s[20:23], s47 offen offset:1024 sc1
 v_mfma_f32_16x16x32_bf16 v[120:123], v[40:43], a[228:231], v[120:123]
 v_mfma_f32_16x16x32_bf16 v[100:103], a[36:39], v[44:47], v[100:103]
 v_cvt_pk_bf16_f32 v24, v80, v81
 v_mfma_f32_16x16x32_bf16 v[108:111], a[100:103], v[44:47], v[108:111]
 v_mfma_f32_16x16x32_bf16 v[116:119], v[44:47], a[164:167], v[116:119]
 v_cvt_pk_bf16_f32 v25, v84, v85
 v_mfma_f32_16x16x32_bf16 v[124:127], v[44:47], a[228:231], v[124:127]
 s_waitcnt lgkmcnt(2)
 v_mfma_f32_16x16x32_bf16 v[96:99], a[40:43], v[48:51], v[96:99]
 ds_read_b128 v[32:35], v6 offset:24576
 v_mfma_f32_16x16x32_bf16 v[104:107], a[104:107], v[48:51], v[104:107]
 ds_read_b128 v[36:39], v6 offset:26624
 v_mfma_f32_16x16x32_bf16 v[112:115], v[48:51], a[168:171], v[112:115]
 v_mfma_f32_16x16x32_bf16 v[120:123], v[48:51], a[232:235], v[120:123]
 v_cvt_pk_bf16_f32 v26, v82, v83
 v_mfma_f32_16x16x32_bf16 v[100:103], a[40:43], v[52:55], v[100:103]
 v_cvt_pk_bf16_f32 v27, v86, v87
 v_mfma_f32_16x16x32_bf16 v[108:111], a[104:107], v[52:55], v[108:111]
 v_mfma_f32_16x16x32_bf16 v[116:119], v[52:55], a[168:171], v[116:119]
 buffer_store_dwordx4 v[24:27], v12, s[20:23], s48 offen offset:0 sc1
 v_mfma_f32_16x16x32_bf16 v[124:127], v[52:55], a[232:235], v[124:127]
 s_waitcnt lgkmcnt(2)
 v_mfma_f32_16x16x32_bf16 v[96:99], a[44:47], v[56:59], v[96:99]
 ds_read_b128 v[40:43], v7 offset:24576
 v_mfma_f32_16x16x32_bf16 v[104:107], a[108:111], v[56:59], v[104:107]
 ds_read_b128 v[44:47], v7 offset:26624
 v_mfma_f32_16x16x32_bf16 v[112:115], v[56:59], a[172:175], v[112:115]
 s_add_u32 s43, s43, 32768
 s_cmp_eq_u32 s43, 131072
 v_mfma_f32_16x16x32_bf16 v[120:123], v[56:59], a[236:239], v[120:123]
 s_cselect_b32 s43, 0, s43
 s_add_u32 s44, s44, 32768
 v_mfma_f32_16x16x32_bf16 v[100:103], a[44:47], v[60:63], v[100:103]
 s_cmp_eq_u32 s44, 131072
 s_cselect_b32 s44, 0, s44
 v_mfma_f32_16x16x32_bf16 v[108:111], a[108:111], v[60:63], v[108:111]
 v_mfma_f32_16x16x32_bf16 v[116:119], v[60:63], a[172:175], v[116:119]
 v_cvt_pk_bf16_f32 v28, v88, v89
 v_mfma_f32_16x16x32_bf16 v[124:127], v[60:63], a[236:239], v[124:127]
 s_waitcnt lgkmcnt(2)
 v_mfma_f32_16x16x32_bf16 v[96:99], a[48:51], v[32:35], v[96:99]
 ds_read_b128 v[48:51], v6 offset:28672
 v_mfma_f32_16x16x32_bf16 v[104:107], a[112:115], v[32:35], v[104:107]
 ds_read_b128 v[52:55], v6 offset:30720
 v_mfma_f32_16x16x32_bf16 v[112:115], v[32:35], a[176:179], v[112:115]
 v_add_u32 v6, s43, v4
 v_mfma_f32_16x16x32_bf16 v[120:123], v[32:35], a[240:243], v[120:123]
 v_mfma_f32_16x16x32_bf16 v[100:103], a[48:51], v[36:39], v[100:103]
 v_cvt_pk_bf16_f32 v29, v92, v93
 v_mfma_f32_16x16x32_bf16 v[108:111], a[112:115], v[36:39], v[108:111]
 v_cvt_pk_bf16_f32 v30, v90, v91
 v_mfma_f32_16x16x32_bf16 v[116:119], v[36:39], a[176:179], v[116:119]
 v_mfma_f32_16x16x32_bf16 v[124:127], v[36:39], a[240:243], v[124:127]
 s_waitcnt lgkmcnt(2)
 v_mfma_f32_16x16x32_bf16 v[96:99], a[52:55], v[40:43], v[96:99]
 ds_read_b128 v[56:59], v7 offset:28672
 v_mfma_f32_16x16x32_bf16 v[104:107], a[116:119], v[40:43], v[104:107]
 ds_read_b128 v[60:63], v7 offset:30720
 v_mfma_f32_16x16x32_bf16 v[112:115], v[40:43], a[180:183], v[112:115]
 v_add_u32 v7, s43, v5
 v_mfma_f32_16x16x32_bf16 v[120:123], v[40:43], a[244:247], v[120:123]
 v_cvt_pk_bf16_f32 v31, v94, v95
 v_mfma_f32_16x16x32_bf16 v[100:103], a[52:55], v[44:47], v[100:103]
 v_mfma_f32_16x16x32_bf16 v[108:111], a[116:119], v[44:47], v[108:111]
 buffer_store_dwordx4 v[28:31], v12, s[20:23], s48 offen offset:1024 sc1
 v_mfma_f32_16x16x32_bf16 v[116:119], v[44:47], a[180:183], v[116:119]
 v_mfma_f32_16x16x32_bf16 v[124:127], v[44:47], a[244:247], v[124:127]
 s_waitcnt lgkmcnt(2)
 v_mfma_f32_16x16x32_bf16 v[96:99], a[56:59], v[48:51], v[96:99]
 s_waitcnt vmcnt(12)
 s_barrier
 ds_read_b128 v[32:35], v6 offset:0
 v_mfma_f32_16x16x32_bf16 v[104:107], a[120:123], v[48:51], v[104:107]
 ds_read_b128 v[36:39], v6 offset:2048
 v_mfma_f32_16x16x32_bf16 v[112:115], v[48:51], a[184:187], v[112:115]
 v_mfma_f32_16x16x32_bf16 v[120:123], v[48:51], a[248:251], v[120:123]
 v_mfma_f32_16x16x32_bf16 v[100:103], a[56:59], v[52:55], v[100:103]
 v_mfma_f32_16x16x32_bf16 v[108:111], a[120:123], v[52:55], v[108:111]
 v_mfma_f32_16x16x32_bf16 v[116:119], v[52:55], a[184:187], v[116:119]
 v_mfma_f32_16x16x32_bf16 v[124:127], v[52:55], a[248:251], v[124:127]
 s_waitcnt lgkmcnt(2)
 v_mfma_f32_16x16x32_bf16 v[96:99], a[60:63], v[56:59], v[96:99]
 ds_read_b128 v[40:43], v7 offset:0
 v_mfma_f32_16x16x32_bf16 v[104:107], a[124:127], v[56:59], v[104:107]
 ds_read_b128 v[44:47], v7 offset:2048
 v_mfma_f32_16x16x32_bf16 v[112:115], v[56:59], a[188:191], v[112:115]
 s_mul_i32 s45, s39, 524288
 s_add_u32 s47, s34, s45
 v_mfma_f32_16x16x32_bf16 v[120:123], v[56:59], a[252:255], v[120:123]
 s_add_u32 s48, s35, s45
 v_mov_b32 v14, s42
 v_mfma_f32_16x16x32_bf16 v[100:103], a[60:63], v[60:63], v[100:103]
 s_mov_b32 s39, s40
 s_mov_b32 s40, s41
 v_mfma_f32_16x16x32_bf16 v[108:111], a[124:127], v[60:63], v[108:111]
 s_add_u32 s42, s42, 1
 s_cmp_lt_u32 s42, s36
 v_mfma_f32_16x16x32_bf16 v[116:119], v[60:63], a[188:191], v[116:119]
 v_mfma_f32_16x16x32_bf16 v[124:127], v[60:63], a[252:255], v[124:127]
 s_waitcnt lgkmcnt(2)
 s_cbranch_scc1 Lps_loop_3
 s_nop 7
 v_cvt_pk_bf16_f32 v16, v96, v97
 v_cvt_pk_bf16_f32 v17, v104, v105
 v_cvt_pk_bf16_f32 v18, v98, v99
 v_cvt_pk_bf16_f32 v19, v106, v107
 buffer_store_dwordx4 v[16:19], v12, s[20:23], s47 offen offset:0 sc1
 v_cvt_pk_bf16_f32 v20, v100, v101
 v_cvt_pk_bf16_f32 v21, v108, v109
 v_cvt_pk_bf16_f32 v22, v102, v103
 v_cvt_pk_bf16_f32 v23, v110, v111
 buffer_store_dwordx4 v[20:23], v12, s[20:23], s47 offen offset:1024 sc1
 v_cvt_pk_bf16_f32 v24, v112, v113
 v_cvt_pk_bf16_f32 v25, v116, v117
 v_cvt_pk_bf16_f32 v26, v114, v115
 v_cvt_pk_bf16_f32 v27, v118, v119
 buffer_store_dwordx4 v[24:27], v12, s[20:23], s48 offen offset:0 sc1
 v_cvt_pk_bf16_f32 v28, v120, v121
 v_cvt_pk_bf16_f32 v29, v124, v125
 v_cvt_pk_bf16_f32 v30, v122, v123
 v_cvt_pk_bf16_f32 v31, v126, v127
 buffer_store_dwordx4 v[28:31], v12, s[20:23], s48 offen offset:1024 sc1
 s_waitcnt vmcnt(0) lgkmcnt(0)
 s_barrier
 v_mov_b32 v14, s36
 buffer_store_dword v14, v13, s[20:23], 0 offen sc1
 s_mov_b32 s32, s3
 s_and_b32 s33, s6, 3
 s_sub_u32 s34, 7, s33
 v_and_b32 v1, 63, v0
 v_lshlrev_b32 v1, 4, v1
 v_mov_b32 v4, 0xff800000
 v_min_u32 v5, 1, v0
 v_lshlrev_b32 v5, 28, v5
 v_mov_b32 v6, 0x3f803f80
 v_accvgpr_write_b32 a192, v6
 v_accvgpr_write_b32 a193, v6
 v_accvgpr_write_b32 a194, v6
 v_accvgpr_write_b32 a195, v6
 s_mov_b32 s52, 0xfff0ffff
 s_mov_b32 s53, 0xf000ff00
 s_mov_b32 s54, 0xffe0fffe
 s_mov_b32 s55, 0xe000fe00
 s_mov_b32 s56, 0xffc0fffc
 s_mov_b32 s57, 0xc000fc00
 s_mov_b32 s58, 0xff80fff8
 s_mov_b32 s59, 0x8000f800
 s_mov_b32 s73, 0x53800000
 s_mov_b32 s74, 0x21800000
 s_lshl_b32 s50, s4, 12
 s_lshl_b32 s45, s32, 14
 s_add_u32 s45, s45, s50
 s_add_u32 s45, s45, 0x1000000
 s_lshl_b32 s36, s33, 3
 s_add_u32 s36, s36, 8
 s_lshl_b32 s47, s34, 3
 s_add_u32 s47, s47, 8
 s_mov_b32 s35, 0
 s_mov_b32 s38, 0
 s_mov_b32 s46, 0
 s_lshl_b32 s7, s3, 7
 s_add_u32 s7, s7, 0x2000
 s_lshr_b32 s94, s3, 1
 s_lshl_b32 s94, s94, 7
 s_add_u32 s94, s94, 0x3000
 v_mov_b32 v8, 0
Law_4:
 buffer_load_dwordx4 v[16:19], v8, s[20:23], s7 offen sc1
 buffer_load_dwordx4 v[20:23], v8, s[20:23], s94 offen sc1
 s_waitcnt vmcnt(0)
 v_min3_u32 v16, v16, v17, v18
 v_min3_u32 v16, v16, v19, v20
 v_min3_u32 v16, v16, v21, v22
 v_min_u32 v16, v16, v23
 v_cmp_le_u32 vcc, 16, v16
 s_cbranch_vccnz Lawk_5
 s_sleep 2
 s_sub_u32 s95, s95, 1
 s_cbranch_scc0 Law_4
 s_endpgm
Lawk_5:
 s_lshl_b32 s37, s35, 19
 s_add_u32 m0, s38, s50
 s_add_u32 s37, s37, s45
 buffer_load_dwordx4 v1, s[20:23], s37 offen offset:0 sc1 lds
 buffer_load_dwordx4 v1, s[20:23], s37 offen offset:1024 sc1 lds
 buffer_load_dwordx4 v1, s[20:23], s37 offen offset:2048 sc1 lds
 buffer_load_dwordx4 v1, s[20:23], s37 offen offset:3072 sc1 lds
 s_add_u32 s38, s38, 0x4000
 s_and_b32 s38, s38, 0x1ffff
 s_add_u32 s35, s35, 1
 s_cmp_eq_u32 s35, s36
 s_cselect_b32 s36, s47, s36
 s_cselect_b32 s35, 0, s35
 s_lshl_b32 s44, s33, 3
 s_add_u32 s44, s44, s4
 s_lshl_b32 s44, s44, 5
 s_add_u32 s44, s44, s32
 s_lshl_b32 s44, s44, 13
 s_add_u32 s44, s44, 0x5000000
 buffer_load_dwordx4 a[0:3], v1, s[20:23], s44 offen offset:0 sc1
 buffer_load_dwordx4 a[16:19], v1, s[20:23], s44 offen offset:1024 sc1
 buffer_load_dwordx4 a[4:7], v1, s[20:23], s44 offen offset:2048 sc1
 buffer_load_dwordx4 a[20:23], v1, s[20:23], s44 offen offset:3072 sc1
 s_add_u32 s44, s44, 4096
 buffer_load_dwordx4 a[8:11], v1, s[20:23], s44 offen offset:0 sc1
 buffer_load_dwordx4 a[24:27], v1, s[20:23], s44 offen offset:1024 sc1
 buffer_load_dwordx4 a[12:15], v1, s[20:23], s44 offen offset:2048 sc1
 buffer_load_dwordx4 a[28:31], v1, s[20:23], s44 offen offset:3072 sc1
 s_lshl_b32 s44, s33, 3
 s_add_u32 s44, s44, 7
 s_sub_u32 s44, s44, s4
 s_lshl_b32 s44, s44, 5
 s_add_u32 s44, s44, s32
 s_lshl_b32 s44, s44, 13
 s_add_u32 s44, s44, 0x5000000
 buffer_load_dwordx4 a[32:35], v1, s[20:23], s44 offen offset:0 sc1
 buffer_load_dwordx4 a[48:51], v1, s[20:23], s44 offen offset:1024 sc1
 buffer_load_dwordx4 a[36:39], v1, s[20:23], s44 offen offset:2048 sc1
 buffer_load_dwordx4 a[52:55], v1, s[20:23], s44 offen offset:3072 sc1
 s_add_u32 s44, s44, 4096
 buffer_load_dwordx4 a[40:43], v1, s[20:23], s44 offen offset:0 sc1
 buffer_load_dwordx4 a[56:59], v1, s[20:23], s44 offen offset:1024 sc1
 buffer_load_dwordx4 a[44:47], v1, s[20:23], s44 offen offset:2048 sc1
 buffer_load_dwordx4 a[60:63], v1, s[20:23], s44 offen offset:3072 sc1
 s_lshl_b32 s37, s35, 19
 s_add_u32 m0, s38, s50
 s_add_u32 s37, s37, s45
 buffer_load_dwordx4 v1, s[20:23], s37 offen offset:0 sc1 lds
 buffer_load_dwordx4 v1, s[20:23], s37 offen offset:1024 sc1 lds
 buffer_load_dwordx4 v1, s[20:23], s37 offen offset:2048 sc1 lds
 buffer_load_dwordx4 v1, s[20:23], s37 offen offset:3072 sc1 lds
 s_add_u32 s38, s38, 0x4000
 s_and_b32 s38, s38, 0x1ffff
 s_add_u32 s35, s35, 1
 s_cmp_eq_u32 s35, s36
 s_cselect_b32 s36, s47, s36
 s_cselect_b32 s35, 0, s35
 s_lshl_b32 s37, s35, 19
 s_add_u32 m0, s38, s50
 s_add_u32 s37, s37, s45
 buffer_load_dwordx4 v1, s[20:23], s37 offen offset:0 sc1 lds
 buffer_load_dwordx4 v1, s[20:23], s37 offen offset:1024 sc1 lds
 buffer_load_dwordx4 v1, s[20:23], s37 offen offset:2048 sc1 lds
 buffer_load_dwordx4 v1, s[20:23], s37 offen offset:3072 sc1 lds
 s_add_u32 s38, s38, 0x4000
 s_and_b32 s38, s38, 0x1ffff
 s_add_u32 s35, s35, 1
 s_cmp_eq_u32 s35, s36
 s_cselect_b32 s36, s47, s36
 s_cselect_b32 s35, 0, s35
 s_lshl_b32 s37, s35, 19
 s_add_u32 m0, s38, s50
 s_add_u32 s37, s37, s45
 buffer_load_dwordx4 v1, s[20:23], s37 offen offset:0 sc1 lds
 buffer_load_dwordx4 v1, s[20:23], s37 offen offset:1024 sc1 lds
 buffer_load_dwordx4 v1, s[20:23], s37 offen offset:2048 sc1 lds
 buffer_load_dwordx4 v1, s[20:23], s37 offen offset:3072 sc1 lds
 s_add_u32 s38, s38, 0x4000
 s_and_b32 s38, s38, 0x1ffff
 s_add_u32 s35, s35, 1
 s_cmp_eq_u32 s35, s36
 s_cselect_b32 s36, s47, s36
 s_cselect_b32 s35, 0, s35
 s_lshl_b32 s37, s35, 19
 s_add_u32 m0, s38, s50
 s_add_u32 s37, s37, s45
 buffer_load_dwordx4 v1, s[20:23], s37 offen offset:0 sc1 lds
 buffer_load_dwordx4 v1, s[20:23], s37 offen offset:1024 sc1 lds
 buffer_load_dwordx4 v1, s[20:23], s37 offen offset:2048 sc1 lds
 buffer_load_dwordx4 v1, s[20:23], s37 offen offset:3072 sc1 lds
 s_add_u32 s38, s38, 0x4000
 s_and_b32 s38, s38, 0x1ffff
 s_add_u32 s35, s35, 1
 s_cmp_eq_u32 s35, s36
 s_cselect_b32 s36, s47, s36
 s_cselect_b32 s35, 0, s35
 s_lshl_b32 s37, s35, 19
 s_add_u32 m0, s38, s50
 s_add_u32 s37, s37, s45
 buffer_load_dwordx4 v1, s[20:23], s37 offen offset:0 sc1 lds
 buffer_load_dwordx4 v1, s[20:23], s37 offen offset:1024 sc1 lds
 buffer_load_dwordx4 v1, s[20:23], s37 offen offset:2048 sc1 lds
 buffer_load_dwordx4 v1, s[20:23], s37 offen offset:3072 sc1 lds
 s_add_u32 s38, s38, 0x4000
 s_and_b32 s38, s38, 0x1ffff
 s_add_u32 s35, s35, 1
 s_cmp_eq_u32 s35, s36
 s_cselect_b32 s36, s47, s36
 s_cselect_b32 s35, 0, s35
 s_lshl_b32 s37, s35, 19
 s_add_u32 m0, s38, s50
 s_add_u32 s37, s37, s45
 buffer_load_dwordx4 v1, s[20:23], s37 offen offset:0 sc1 lds
 buffer_load_dwordx4 v1, s[20:23], s37 offen offset:1024 sc1 lds
 buffer_load_dwordx4 v1, s[20:23], s37 offen offset:2048 sc1 lds
 buffer_load_dwordx4 v1, s[20:23], s37 offen offset:3072 sc1 lds
 s_add_u32 s38, s38, 0x4000
 s_and_b32 s38, s38, 0x1ffff
 s_add_u32 s35, s35, 1
 s_cmp_eq_u32 s35, s36
 s_cselect_b32 s36, s47, s36
 s_cselect_b32 s35, 0, s35
 s_lshl_b32 s44, s34, 3
 s_add_u32 s44, s44, s4
 s_lshl_b32 s44, s44, 5
 s_add_u32 s44, s44, s32
 s_lshl_b32 s44, s44, 13
 s_add_u32 s44, s44, 0x5000000
 buffer_load_dwordx4 a[64:67], v1, s[20:23], s44 offen offset:0 sc1
 buffer_load_dwordx4 a[80:83], v1, s[20:23], s44 offen offset:1024 sc1
 buffer_load_dwordx4 a[68:71], v1, s[20:23], s44 offen offset:2048 sc1
 buffer_load_dwordx4 a[84:87], v1, s[20:23], s44 offen offset:3072 sc1
 s_add_u32 s44, s44, 4096
 buffer_load_dwordx4 a[72:75], v1, s[20:23], s44 offen offset:0 sc1
 buffer_load_dwordx4 a[88:91], v1, s[20:23], s44 offen offset:1024 sc1
 buffer_load_dwordx4 a[76:79], v1, s[20:23], s44 offen offset:2048 sc1
 buffer_load_dwordx4 a[92:95], v1, s[20:23], s44 offen offset:3072 sc1
 s_lshl_b32 s44, s34, 3
 s_add_u32 s44, s44, 7
 s_sub_u32 s44, s44, s4
 s_lshl_b32 s44, s44, 5
 s_add_u32 s44, s44, s32
 s_lshl_b32 s44, s44, 13
 s_add_u32 s44, s44, 0x5000000
 buffer_load_dwordx4 a[96:99], v1, s[20:23], s44 offen offset:0 sc1
 buffer_load_dwordx4 a[112:115], v1, s[20:23], s44 offen offset:1024 sc1
 buffer_load_dwordx4 a[100:103], v1, s[20:23], s44 offen offset:2048 sc1
 buffer_load_dwordx4 a[116:119], v1, s[20:23], s44 offen offset:3072 sc1
 s_add_u32 s44, s44, 4096
 buffer_load_dwordx4 a[104:107], v1, s[20:23], s44 offen offset:0 sc1
 buffer_load_dwordx4 a[120:123], v1, s[20:23], s44 offen offset:1024 sc1
 buffer_load_dwordx4 a[108:111], v1, s[20:23], s44 offen offset:2048 sc1
 buffer_load_dwordx4 a[124:127], v1, s[20:23], s44 offen offset:3072 sc1
 s_waitcnt vmcnt(40)
 s_barrier
 v_mov_b32 v2, v1
 ds_read_b128 a[128:131], v2 offset:0
 ds_read_b128 a[132:135], v2 offset:1024
 ds_read_b128 a[136:139], v2 offset:2048
 ds_read_b128 a[140:143], v2 offset:3072
 ds_read_b128 a[144:147], v2 offset:4096
 ds_read_b128 a[148:151], v2 offset:5120
 ds_read_b128 a[152:155], v2 offset:6144
 ds_read_b128 a[156:159], v2 offset:7168
 s_mov_b32 s39, 0
 s_add_u32 s39, s39, 0x4000
 s_and_b32 s39, s39, 0x1ffff
 v_mov_b32 v3, v2
 v_add_u32 v2, s39, v1
 s_mov_b32 s72, 0x8000000
Lablk_6:
 s_lshl_b32 s43, s33, 3
 s_add_u32 s41, s43, s4
 s_add_u32 s42, s43, 7
 s_sub_u32 s42, s42, s4
 s_mov_b32 s49, 0
 s_waitcnt lgkmcnt(0)
 v_mfma_f32_16x16x32_bf16 v[48:51], a[128:131], a[0:3], 0
 s_cmp_lt_u32 s49, s41
 v_mov_b64 v[176:177], 0
 v_mov_b64 v[178:179], 0
 v_mfma_f32_16x16x32_bf16 v[56:59], a[128:131], a[16:19], 0
 s_cselect_b64 s[68:69], -1, 0
 v_mov_b64 v[180:181], 0
 v_mov_b64 v[182:183], 0
 v_mfma_f32_16x16x32_bf16 v[64:67], a[128:131], a[32:35], 0
 v_mfma_f32_16x16x32_bf16 v[72:75], a[128:131], a[48:51], 0
 s_cmp_le_u32 s49, s41
 v_mov_b64 v[184:185], 0
 v_mov_b64 v[186:187], 0
 v_mfma_f32_16x16x32_bf16 v[48:51], a[136:139], a[4:7], v[48:51]
 v_mfma_f32_16x16x32_bf16 v[56:59], a[136:139], a[20:23], v[56:59]
 s_cselect_b64 s[70:71], -1, 0
 v_mov_b64 v[188:189], 0
 v_mov_b64 v[190:191], 0
 v_mfma_f32_16x16x32_bf16 v[64:67], a[136:139], a[36:39], v[64:67]
 v_mfma_f32_16x16x32_bf16 v[72:75], a[136:139], a[52:55], v[72:75]
 s_cmp_eq_u32 s49, s41
 v_mov_b64 v[192:193], 0
 v_mov_b64 v[194:195], 0
 v_mfma_f32_16x16x32_bf16 v[48:51], a[144:147], a[8:11], v[48:51]
 s_cselect_b64 s[60:61], s[52:53], s[68:69]
 v_mfma_f32_16x16x32_bf16 v[56:59], a[144:147], a[24:27], v[56:59]
 v_mov_b64 v[196:197], 0
 v_mov_b64 v[198:199], 0
 v_mfma_f32_16x16x32_bf16 v[64:67], a[144:147], a[40:43], v[64:67]
 s_cselect_b64 s[62:63], s[54:55], s[68:69]
 v_mfma_f32_16x16x32_bf16 v[72:75], a[144:147], a[56:59], v[72:75]
 v_mov_b64 v[200:201], 0
 v_mov_b64 v[202:203], 0
 v_mfma_f32_16x16x32_bf16 v[48:51], a[152:155], a[12:15], v[48:51]
 s_cselect_b64 s[64:65], s[56:57], s[68:69]
 v_mfma_f32_16x16x32_bf16 v[56:59], a[152:155], a[28:31], v[56:59]
 v_mov_b64 v[204:205], 0
 v_mov_b64 v[206:207], 0
 v_mfma_f32_16x16x32_bf16 v[64:67], a[152:155], a[44:47], v[64:67]
 s_cselect_b64 s[66:67], s[58:59], s[68:69]
 v_mfma_f32_16x16x32_bf16 v[72:75], a[152:155], a[60:63], v[72:75]
 s_nop 4
 v_max3_f32 v12, v48, v49, v50
 v_max3_f32 v13, v56, v57, v58
 v_max3_f32 v14, v64, v65, v66
 v_max3_f32 v15, v72, v73, v74
 v_max_f32 v12, v12, v51
 v_max_f32 v13, v13, v59
 v_max_f32 v14, v14, v67
 v_max_f32 v15, v15, v75
 v_mov_b32 v6, v12
 v_mov_b32 v7, v13
 v_mov_b32 v8, v14
 v_mov_b32 v9, v15
 v_permlane16_swap_b32 v12, v6
 v_permlane16_swap_b32 v13, v7
 v_permlane16_swap_b32 v14, v8
 v_permlane16_swap_b32 v15, v9
 v_max_f32 v12, v12, v6
 v_max_f32 v13, v13, v7
 v_max_f32 v14, v14, v8
 v_max_f32 v15, v15, v9
 v_mov_b32 v6, v12
 v_mov_b32 v7, v13
 v_mov_b32 v8, v14
 v_mov_b32 v9, v15
 v_permlane32_swap_b32 v12, v6
 v_permlane32_swap_b32 v13, v7
 v_permlane32_swap_b32 v14, v8
 v_permlane32_swap_b32 v15, v9
 v_max_f32 v12, v12, v6
 v_max_f32 v13, v13, v7
 v_max_f32 v14, v14, v8
 v_max_f32 v15, v15, v9
 v_sub_f32 v12, 0, v12
 v_sub_f32 v13, 0, v13
 v_sub_f32 v14, 0, v14
 v_sub_f32 v15, 0, v15
 v_cndmask_b32 v80, v4, v12, s[60:61]
 v_cndmask_b32 v81, v4, v12, s[62:63]
 v_cndmask_b32 v82, v4, v12, s[64:65]
 v_cndmask_b32 v83, v4, v12, s[66:67]
 v_cndmask_b32 v84, v4, v12, s[68:69]
 v_cndmask_b32 v85, v4, v12, s[68:69]
 v_cndmask_b32 v86, v4, v12, s[68:69]
 v_cndmask_b32 v87, v4, v12, s[68:69]
 v_cndmask_b32 v88, v4, v13, s[70:71]
 v_cndmask_b32 v89, v4, v13, s[70:71]
 v_cndmask_b32 v90, v4, v13, s[70:71]
 v_cndmask_b32 v91, v4, v13, s[70:71]
 v_cndmask_b32 v92, v4, v13, s[60:61]
 v_cndmask_b32 v93, v4, v13, s[62:63]
 v_cndmask_b32 v94, v4, v13, s[64:65]
 v_cndmask_b32 v95, v4, v13, s[66:67]
 v_mov_b32 v96, v14
 v_mov_b32 v97, v14
 v_mov_b32 v98, v14
 v_mov_b32 v99, v14
 v_mov_b32 v100, v14
 v_mov_b32 v101, v14
 v_mov_b32 v102, v14
 v_mov_b32 v103, v14
 v_mov_b32 v104, v15
 v_mov_b32 v105, v15
 v_mov_b32 v106, v15
 v_mov_b32 v107, v15
 v_mov_b32 v108, v15
 v_mov_b32 v109, v15
 v_mov_b32 v110, v15
 v_mov_b32 v111, v15
 v_mov_b32 v6, 1
 s_waitcnt lgkmcnt(0)
 v_mfma_f32_16x16x32_bf16 v[48:51], a[128:131], a[0:3], v[80:83]
 ds_read_b128 a[160:163], v3 offset:8192
 v_mov_b64 v[208:209], 0
 v_mov_b64 v[210:211], 0
 v_mfma_f32_16x16x32_bf16 v[56:59], a[128:131], a[16:19], v[88:91]
 v_mov_b64 v[212:213], 0
 v_mov_b64 v[214:215], 0
 v_mfma_f32_16x16x32_bf16 v[52:55], a[132:135], a[0:3], v[84:87]
 ds_read_b128 a[164:167], v3 offset:9216
 v_mfma_f32_16x16x32_bf16 v[60:63], a[132:135], a[16:19], v[92:95]
 v_mov_b64 v[216:217], 0
 v_mov_b64 v[218:219], 0
 v_mfma_f32_16x16x32_bf16 v[48:51], a[136:139], a[4:7], v[48:51]
 ds_read_b128 a[168:171], v3 offset:10240
 v_mov_b64 v[220:221], 0
 v_mov_b64 v[222:223], 0
 v_mfma_f32_16x16x32_bf16 v[56:59], a[136:139], a[20:23], v[56:59]
 v_mfma_f32_16x16x32_bf16 v[52:55], a[140:143], a[4:7], v[52:55]
 ds_read_b128 a[172:175], v3 offset:11264
 v_mov_b64 v[224:225], 0
 v_mov_b64 v[226:227], 0
 v_mfma_f32_16x16x32_bf16 v[60:63], a[140:143], a[20:23], v[60:63]
 v_mov_b64 v[228:229], 0
 v_mov_b64 v[230:231], 0
 v_mfma_f32_16x16x32_bf16 v[48:51], a[144:147], a[8:11], v[48:51]
 ds_read_b128 a[176:179], v3 offset:12288
 v_mfma_f32_16x16x32_bf16 v[56:59], a[144:147], a[24:27], v[56:59]
 v_mov_b64 v[232:233], 0
 v_mov_b64 v[234:235], 0
 v_mfma_f32_16x16x32_bf16 v[52:55], a[148:151], a[8:11], v[52:55]
 ds_read_b128 a[180:183], v3 offset:13312
 v_mov_b64 v[236:237], 0
 v_mov_b64 v[238:239], 0
 v_mfma_f32_16x16x32_bf16 v[60:63], a[148:151], a[24:27], v[60:63]
 v_mfma_f32_16x16x32_bf16 v[48:51], a[152:155], a[12:15], v[48:51]
 ds_read_b128 a[184:187], v3 offset:14336
 v_mov_b64 v[40:41], 0
 v_mov_b64 v[42:43], 0
 v_mfma_f32_16x16x32_bf16 v[56:59], a[152:155], a[28:31], v[56:59]
 v_mov_b64 v[44:45], 0
 v_mov_b64 v[46:47], 0
 v_mfma_f32_16x16x32_bf16 v[52:55], a[156:159], a[12:15], v[52:55]
 ds_read_b128 a[188:191], v3 offset:15360
 v_mfma_f32_16x16x32_bf16 v[60:63], a[156:159], a[28:31], v[60:63]
 v_mfma_f32_16x16x32_bf16 v[64:67], a[128:131], a[32:35], v[96:99]
 s_waitcnt vmcnt(0)
 s_barrier
 buffer_store_dword v6, v5, s[20:23], s72 offen sc1
 v_mfma_f32_16x16x32_bf16 v[72:75], a[128:131], a[48:51], v[104:107]
 ds_read_b128 a[128:131], v2 offset:0
 v_mfma_f32_16x16x32_bf16 v[68:71], a[132:135], a[32:35], v[100:103]
 s_add_u32 s49, s49, 1
 v_mfma_f32_16x16x32_bf16 v[76:79], a[132:135], a[48:51], v[108:111]
 ds_read_b128 a[132:135], v2 offset:1024
 v_exp_f32 v48, v48
 v_exp_f32 v49, v49
 v_mfma_f32_16x16x32_bf16 v[64:67], a[136:139], a[36:39], v[64:67]
 s_cmp_lt_u32 s49, s41
 v_exp_f32 v52, v52
 v_exp_f32 v53, v53
 v_mfma_f32_16x16x32_bf16 v[72:75], a[136:139], a[52:55], v[72:75]
 ds_read_b128 a[136:139], v2 offset:2048
 v_exp_f32 v50, v50
 v_mfma_f32_16x16x32_bf16 v[68:71], a[140:143], a[36:39], v[68:71]
 s_cselect_b64 s[68:69], -1, 0
 v_cvt_pk_bf16_f32 v16, v48, v49
 v_cvt_pk_bf16_f32 v17, v52, v53
 v_exp_f32 v51, v51
 v_mfma_f32_16x16x32_bf16 v[76:79], a[140:143], a[52:55], v[76:79]
 ds_read_b128 a[140:143], v2 offset:3072
 v_exp_f32 v54, v54
 v_exp_f32 v55, v55
 v_mfma_f32_16x16x32_bf16 v[64:67], a[144:147], a[40:43], v[64:67]
 v_cvt_pk_bf16_f32 v18, v50, v51
 v_cvt_pk_bf16_f32 v19, v54, v55
 v_mfma_f32_16x16x32_bf16 v[72:75], a[144:147], a[56:59], v[72:75]
 ds_read_b128 a[144:147], v2 offset:4096
 v_exp_f32 v56, v56
 v_exp_f32 v57, v57
 v_mfma_f32_16x16x32_bf16 v[68:71], a[148:151], a[40:43], v[68:71]
 s_cmp_le_u32 s49, s41
 v_exp_f32 v60, v60
 v_exp_f32 v61, v61
 v_mfma_f32_16x16x32_bf16 v[76:79], a[148:151], a[56:59], v[76:79]
 ds_read_b128 a[148:151], v2 offset:5120
 v_exp_f32 v58, v58
 v_mfma_f32_16x16x32_bf16 v[64:67], a[152:155], a[44:47], v[64:67]
 s_cselect_b64 s[70:71], -1, 0
 v_cvt_pk_bf16_f32 v20, v56, v57
 v_cvt_pk_bf16_f32 v21, v60, v61
 v_exp_f32 v59, v59
 v_mfma_f32_16x16x32_bf16 v[72:75], a[152:155], a[60:63], v[72:75]
 ds_read_b128 a[152:155], v2 offset:6144
 v_exp_f32 v62, v62
 v_exp_f32 v63, v63
 v_mfma_f32_16x16x32_bf16 v[68:71], a[156:159], a[44:47], v[68:71]
 v_cvt_pk_bf16_f32 v22, v58, v59
 v_cvt_pk_bf16_f32 v23, v62, v63
 v_mfma_f32_16x16x32_bf16 v[76:79], a[156:159], a[60:63], v[76:79]
 ds_read_b128 a[156:159], v2 offset:7168
 s_waitcnt lgkmcnt(8)
 v_mfma_f32_16x16x32_bf16 v[112:115], a[160:163], v[16:19], 0
 s_add_u32 s39, s39, 0x4000
 s_and_b32 s39, s39, 0x1ffff
 v_mfma_f32_16x16x32_bf16 v[144:147], a[160:163], v[20:23], 0
 s_cmp_eq_u32 s49, s41
 v_mfma_f32_16x16x32_bf16 v[116:119], a[164:167], v[16:19], 0
 s_cselect_b64 s[60:61], s[52:53], s[68:69]
 v_mfma_f32_16x16x32_bf16 v[148:151], a[164:167], v[20:23], 0
 s_cselect_b64 s[62:63], s[54:55], s[68:69]
 v_mov_b32 v3, v2
 v_add_u32 v2, s39, v1
 v_exp_f32 v64, v64
 v_mfma_f32_16x16x32_bf16 v[120:123], a[168:171], v[16:19], 0
 s_cselect_b64 s[64:65], s[56:57], s[68:69]
 v_exp_f32 v65, v65
 v_mfma_f32_16x16x32_bf16 v[152:155], a[168:171], v[20:23], 0
 s_cselect_b64 s[66:67], s[58:59], s[68:69]
 v_exp_f32 v68, v68
 v_mfma_f32_16x16x32_bf16 v[124:127], a[172:175], v[16:19], 0
 s_lshl_b32 s37, s35, 19
 v_exp_f32 v69, v69
 v_exp_f32 v66, v66
 v_mfma_f32_16x16x32_bf16 v[156:159], a[172:175], v[20:23], 0
 s_add_u32 m0, s38, s50
 v_cvt_pk_bf16_f32 v24, v64, v65
 v_cvt_pk_bf16_f32 v25, v68, v69
 v_mfma_f32_16x16x32_bf16 v[128:131], a[176:179], v[16:19], 0
 s_add_u32 s37, s37, s45
 v_exp_f32 v67, v67
 v_mfma_f32_16x16x32_bf16 v[160:163], a[176:179], v[20:23], 0
 buffer_load_dwordx4 v1, s[20:23], s37 offen offset:0 sc1 lds
 buffer_load_dwordx4 v1, s[20:23], s37 offen offset:1024 sc1 lds
 v_exp_f32 v70, v70
 v_mfma_f32_16x16x32_bf16 v[132:135], a[180:183], v[16:19], 0
 buffer_load_dwordx4 v1, s[20:23], s37 offen offset:2048 sc1 lds
 v_exp_f32 v71, v71
 v_cvt_pk_bf16_f32 v26, v66, v67
 v_cvt_pk_bf16_f32 v27, v70, v71
 v_mfma_f32_16x16x32_bf16 v[164:167], a[180:183], v[20:23], 0
 buffer_load_dwordx4 v1, s[20:23], s37 offen offset:3072 sc1 lds
 v_cndmask_b32 v80, v4, v12, s[60:61]
 v_cndmask_b32 v81, v4, v12, s[62:63]
 v_mfma_f32_16x16x32_bf16 v[136:139], a[184:187], v[16:19], 0
 s_add_u32 s38, s38, 0x4000
 v_cndmask_b32 v82, v4, v12, s[64:65]
 v_cndmask_b32 v83, v4, v12, s[66:67]
 v_mfma_f32_16x16x32_bf16 v[168:171], a[184:187], v[20:23], 0
 s_and_b32 s38, s38, 0x1ffff
 v_cndmask_b32 v84, v4, v12, s[68:69]
 v_cndmask_b32 v85, v4, v12, s[68:69]
 v_mfma_f32_16x16x32_bf16 v[140:143], a[188:191], v[16:19], 0
 s_add_u32 s35, s35, 1
 v_cndmask_b32 v86, v4, v12, s[68:69]
 v_cndmask_b32 v87, v4, v12, s[68:69]
 v_cndmask_b32 v88, v4, v13, s[70:71]
 v_cndmask_b32 v89, v4, v13, s[70:71]
 v_mfma_f32_16x16x32_bf16 v[172:175], a[188:191], v[20:23], 0
 s_cmp_eq_u32 s35, s36
 v_cndmask_b32 v90, v4, v13, s[70:71]
 v_cndmask_b32 v91, v4, v13, s[70:71]
 v_mfma_f32_16x16x32_bf16 v[32:35], a[192:195], v[16:19], 0
 s_cselect_b32 s36, s47, s36
 v_cndmask_b32 v92, v4, v13, s[60:61]
 v_cndmask_b32 v93, v4, v13, s[62:63]
 v_mfma_f32_16x16x32_bf16 v[36:39], a[192:195], v[20:23], 0
 s_cselect_b32 s35, 0, s35
 v_cndmask_b32 v94, v4, v13, s[64:65]
 v_cndmask_b32 v95, v4, v13, s[66:67]
 s_cmp_eq_u32 s43, 0
 s_cbranch_scc1 Lamk_11
 s_sub_u32 s40, s43, 1
 .p2align 3
Lapl_10:
 s_waitcnt lgkmcnt(0)
 v_mfma_f32_16x16x32_bf16 v[48:51], a[128:131], a[0:3], v[80:83]
 v_exp_f32 v72, v72
 v_mfma_f32_16x16x32_bf16 v[56:59], a[128:131], a[16:19], v[88:91]
 v_exp_f32 v73, v73
 v_mfma_f32_16x16x32_bf16 v[52:55], a[132:135], a[0:3], v[84:87]
 v_mfma_f32_16x16x32_bf16 v[60:63], a[132:135], a[16:19], v[92:95]
 v_exp_f32 v76, v76
 v_mfma_f32_16x16x32_bf16 v[48:51], a[136:139], a[4:7], v[48:51]
 v_exp_f32 v77, v77
 v_mfma_f32_16x16x32_bf16 v[56:59], a[136:139], a[20:23], v[56:59]
 v_mfma_f32_16x16x32_bf16 v[52:55], a[140:143], a[4:7], v[52:55]
 v_exp_f32 v74, v74
 v_mfma_f32_16x16x32_bf16 v[60:63], a[140:143], a[20:23], v[60:63]
 v_cvt_pk_bf16_f32 v28, v72, v73
 v_cvt_pk_bf16_f32 v29, v76, v77
 v_mfma_f32_16x16x32_bf16 v[48:51], a[144:147], a[8:11], v[48:51]
 v_mfma_f32_16x16x32_bf16 v[56:59], a[144:147], a[24:27], v[56:59]
 v_exp_f32 v75, v75
 v_mfma_f32_16x16x32_bf16 v[52:55], a[148:151], a[8:11], v[52:55]
 v_exp_f32 v78, v78
 v_mfma_f32_16x16x32_bf16 v[60:63], a[148:151], a[24:27], v[60:63]
 v_mfma_f32_16x16x32_bf16 v[48:51], a[152:155], a[12:15], v[48:51]
 v_exp_f32 v79, v79
 v_mfma_f32_16x16x32_bf16 v[56:59], a[152:155], a[28:31], v[56:59]
 v_cvt_pk_bf16_f32 v30, v74, v75
 v_cvt_pk_bf16_f32 v31, v78, v79
 v_mfma_f32_16x16x32_bf16 v[52:55], a[156:159], a[12:15], v[52:55]
 v_mfma_f32_16x16x32_bf16 v[60:63], a[156:159], a[28:31], v[60:63]
 v_mfma_f32_16x16x32_bf16 v[176:179], a[160:163], v[24:27], v[176:179]
 v_mfma_f32_16x16x32_bf16 v[208:211], a[160:163], v[28:31], v[208:211]
 ds_read_b128 a[160:163], v3 offset:8192
 v_mfma_f32_16x16x32_bf16 v[180:183], a[164:167], v[24:27], v[180:183]
 v_mfma_f32_16x16x32_bf16 v[212:215], a[164:167], v[28:31], v[212:215]
 ds_read_b128 a[164:167], v3 offset:9216
 v_exp_f32 v48, v48
 v_mfma_f32_16x16x32_bf16 v[184:187], a[168:171], v[24:27], v[184:187]
 v_exp_f32 v49, v49
 v_mfma_f32_16x16x32_bf16 v[216:219], a[168:171], v[28:31], v[216:219]
 ds_read_b128 a[168:171], v3 offset:10240
 v_exp_f32 v52, v52
 v_mfma_f32_16x16x32_bf16 v[188:191], a[172:175], v[24:27], v[188:191]
 v_mfma_f32_16x16x32_bf16 v[220:223], a[172:175], v[28:31], v[220:223]
 ds_read_b128 a[172:175], v3 offset:11264
 v_exp_f32 v53, v53
 v_mfma_f32_16x16x32_bf16 v[192:195], a[176:179], v[24:27], v[192:195]
 v_exp_f32 v50, v50
 v_mfma_f32_16x16x32_bf16 v[224:227], a[176:179], v[28:31], v[224:227]
 ds_read_b128 a[176:179], v3 offset:12288
 v_mfma_f32_16x16x32_bf16 v[196:199], a[180:183], v[24:27], v[196:199]
 v_cvt_pk_bf16_f32 v16, v48, v49
 v_cvt_pk_bf16_f32 v17, v52, v53
 v_mfma_f32_16x16x32_bf16 v[228:231], a[180:183], v[28:31], v[228:231]
 ds_read_b128 a[180:183], v3 offset:13312
 v_exp_f32 v51, v51
 v_mfma_f32_16x16x32_bf16 v[200:203], a[184:187], v[24:27], v[200:203]
 v_exp_f32 v54, v54
 v_mfma_f32_16x16x32_bf16 v[232:235], a[184:187], v[28:31], v[232:235]
 ds_read_b128 a[184:187], v3 offset:14336
 v_mfma_f32_16x16x32_bf16 v[204:207], a[188:191], v[24:27], v[204:207]
 v_exp_f32 v55, v55
 v_mfma_f32_16x16x32_bf16 v[236:239], a[188:191], v[28:31], v[236:239]
 ds_read_b128 a[188:191], v3 offset:15360
 v_cvt_pk_bf16_f32 v18, v50, v51
 v_cvt_pk_bf16_f32 v19, v54, v55
 v_mfma_f32_16x16x32_bf16 v[40:43], a[192:195], v[24:27], v[40:43]
 v_mfma_f32_16x16x32_bf16 v[44:47], a[192:195], v[28:31], v[44:47]
 v_mfma_f32_16x16x32_bf16 v[64:67], a[128:131], a[32:35], v[96:99]
 s_waitcnt vmcnt(20)
 s_barrier
 v_exp_f32 v56, v56
 v_mfma_f32_16x16x32_bf16 v[72:75], a[128:131], a[48:51], v[104:107]
 ds_read_b128 a[128:131], v2 offset:0
 v_exp_f32 v57, v57
 v_mfma_f32_16x16x32_bf16 v[68:71], a[132:135], a[32:35], v[100:103]
 s_add_u32 s39, s39, 0x4000
 v_mfma_f32_16x16x32_bf16 v[76:79], a[132:135], a[48:51], v[108:111]
 ds_read_b128 a[132:135], v2 offset:1024
 v_exp_f32 v60, v60
 v_mfma_f32_16x16x32_bf16 v[64:67], a[136:139], a[36:39], v[64:67]
 v_exp_f32 v61, v61
 v_mfma_f32_16x16x32_bf16 v[72:75], a[136:139], a[52:55], v[72:75]
 ds_read_b128 a[136:139], v2 offset:2048
 v_mfma_f32_16x16x32_bf16 v[68:71], a[140:143], a[36:39], v[68:71]
 v_exp_f32 v58, v58
 v_mfma_f32_16x16x32_bf16 v[76:79], a[140:143], a[52:55], v[76:79]
 ds_read_b128 a[140:143], v2 offset:3072
 v_cvt_pk_bf16_f32 v20, v56, v57
 v_cvt_pk_bf16_f32 v21, v60, v61
 v_mfma_f32_16x16x32_bf16 v[64:67], a[144:147], a[40:43], v[64:67]
 s_and_b32 s39, s39, 0x1ffff
 v_mfma_f32_16x16x32_bf16 v[72:75], a[144:147], a[56:59], v[72:75]
 ds_read_b128 a[144:147], v2 offset:4096
 v_exp_f32 v59, v59
 v_mfma_f32_16x16x32_bf16 v[68:71], a[148:151], a[40:43], v[68:71]
 v_exp_f32 v62, v62
 v_mfma_f32_16x16x32_bf16 v[76:79], a[148:151], a[56:59], v[76:79]
 ds_read_b128 a[148:151], v2 offset:5120
 v_mfma_f32_16x16x32_bf16 v[64:67], a[152:155], a[44:47], v[64:67]
 v_exp_f32 v63, v63
 v_mfma_f32_16x16x32_bf16 v[72:75], a[152:155], a[60:63], v[72:75]
 ds_read_b128 a[152:155], v2 offset:6144
 v_cvt_pk_bf16_f32 v22, v58, v59
 v_cvt_pk_bf16_f32 v23, v62, v63
 v_mfma_f32_16x16x32_bf16 v[68:71], a[156:159], a[44:47], v[68:71]
 v_mfma_f32_16x16x32_bf16 v[76:79], a[156:159], a[60:63], v[76:79]
 ds_read_b128 a[156:159], v2 offset:7168
 s_waitcnt lgkmcnt(8)
 v_mfma_f32_16x16x32_bf16 v[112:115], a[160:163], v[16:19], v[112:115]
 s_lshl_b32 s37, s35, 19
 v_mov_b32 v3, v2
 v_add_u32 v2, s39, v1
 v_mfma_f32_16x16x32_bf16 v[144:147], a[160:163], v[20:23], v[144:147]
 s_add_u32 m0, s38, s50
 v_mfma_f32_16x16x32_bf16 v[116:119], a[164:167], v[16:19], v[116:119]
 s_add_u32 s37, s37, s45
 v_mfma_f32_16x16x32_bf16 v[148:151], a[164:167], v[20:23], v[148:151]
 buffer_load_dwordx4 v1, s[20:23], s37 offen offset:0 sc1 lds
 v_exp_f32 v64, v64
 v_mfma_f32_16x16x32_bf16 v[120:123], a[168:171], v[16:19], v[120:123]
 buffer_load_dwordx4 v1, s[20:23], s37 offen offset:1024 sc1 lds
 v_mfma_f32_16x16x32_bf16 v[152:155], a[168:171], v[20:23], v[152:155]
 v_exp_f32 v65, v65
 v_mfma_f32_16x16x32_bf16 v[124:127], a[172:175], v[16:19], v[124:127]
 buffer_load_dwordx4 v1, s[20:23], s37 offen offset:2048 sc1 lds
 v_exp_f32 v68, v68
 v_mfma_f32_16x16x32_bf16 v[156:159], a[172:175], v[20:23], v[156:159]
 buffer_load_dwordx4 v1, s[20:23], s37 offen offset:3072 sc1 lds
 v_exp_f32 v69, v69
 v_mfma_f32_16x16x32_bf16 v[128:131], a[176:179], v[16:19], v[128:131]
 s_add_u32 s38, s38, 0x4000
 v_mfma_f32_16x16x32_bf16 v[160:163], a[176:179], v[20:23], v[160:163]
 s_and_b32 s38, s38, 0x1ffff
 v_exp_f32 v66, v66
 v_mfma_f32_16x16x32_bf16 v[132:135], a[180:183], v[16:19], v[132:135]
 s_add_u32 s35, s35, 1
 v_cvt_pk_bf16_f32 v24, v64, v65
 v_cvt_pk_bf16_f32 v25, v68, v69
 v_mfma_f32_16x16x32_bf16 v[164:167], a[180:183], v[20:23], v[164:167]
 v_exp_f32 v67, v67
 v_mfma_f32_16x16x32_bf16 v[136:139], a[184:187], v[16:19], v[136:139]
 s_cmp_eq_u32 s35, s36
 v_mfma_f32_16x16x32_bf16 v[168:171], a[184:187], v[20:23], v[168:171]
 s_cselect_b32 s36, s47, s36
 v_exp_f32 v70, v70
 v_mfma_f32_16x16x32_bf16 v[140:143], a[188:191], v[16:19], v[140:143]
 s_cselect_b32 s35, 0, s35
 v_exp_f32 v71, v71
 v_mfma_f32_16x16x32_bf16 v[172:175], a[188:191], v[20:23], v[172:175]
 s_add_u32 s49, s49, 1
 v_cvt_pk_bf16_f32 v26, v66, v67
 v_cvt_pk_bf16_f32 v27, v70, v71
 v_mfma_f32_16x16x32_bf16 v[32:35], a[192:195], v[16:19], v[32:35]
 s_cmp_lt_u32 s49, s40
 v_mfma_f32_16x16x32_bf16 v[36:39], a[192:195], v[20:23], v[36:39]
 s_cbranch_scc1 Lapl_10
Lamk_11:
 s_add_u32 s40, s43, 4
 .p2align 3
Lamk_13:
 s_waitcnt lgkmcnt(0)
 v_mfma_f32_16x16x32_bf16 v[48:51], a[128:131], a[0:3], v[80:83]
 s_add_u32 s49, s49, 1
 v_exp_f32 v72, v72
 v_mfma_f32_16x16x32_bf16 v[56:59], a[128:131], a[16:19], v[88:91]
 s_cmp_lt_u32 s49, s41
 v_exp_f32 v73, v73
 v_mfma_f32_16x16x32_bf16 v[52:55], a[132:135], a[0:3], v[84:87]
 v_mfma_f32_16x16x32_bf16 v[60:63], a[132:135], a[16:19], v[92:95]
 s_cselect_b64 s[68:69], -1, 0
 v_exp_f32 v76, v76
 v_mfma_f32_16x16x32_bf16 v[48:51], a[136:139], a[4:7], v[48:51]
 s_cmp_le_u32 s49, s41
 v_exp_f32 v77, v77
 v_mfma_f32_16x16x32_bf16 v[56:59], a[136:139], a[20:23], v[56:59]
 v_mfma_f32_16x16x32_bf16 v[52:55], a[140:143], a[4:7], v[52:55]
 s_cselect_b64 s[70:71], -1, 0
 v_exp_f32 v74, v74
 v_mfma_f32_16x16x32_bf16 v[60:63], a[140:143], a[20:23], v[60:63]
 v_cvt_pk_bf16_f32 v28, v72, v73
 v_cvt_pk_bf16_f32 v29, v76, v77
 v_mfma_f32_16x16x32_bf16 v[48:51], a[144:147], a[8:11], v[48:51]
 s_cmp_eq_u32 s49, s41
 v_mfma_f32_16x16x32_bf16 v[56:59], a[144:147], a[24:27], v[56:59]
 s_cselect_b64 s[60:61], s[52:53], s[68:69]
 v_exp_f32 v75, v75
 v_mfma_f32_16x16x32_bf16 v[52:55], a[148:151], a[8:11], v[52:55]
 v_exp_f32 v78, v78
 v_mfma_f32_16x16x32_bf16 v[60:63], a[148:151], a[24:27], v[60:63]
 s_cselect_b64 s[62:63], s[54:55], s[68:69]
 v_mfma_f32_16x16x32_bf16 v[48:51], a[152:155], a[12:15], v[48:51]
 s_cselect_b64 s[64:65], s[56:57], s[68:69]
 v_exp_f32 v79, v79
 v_mfma_f32_16x16x32_bf16 v[56:59], a[152:155], a[28:31], v[56:59]
 v_cvt_pk_bf16_f32 v30, v74, v75
 v_cvt_pk_bf16_f32 v31, v78, v79
 v_mfma_f32_16x16x32_bf16 v[52:55], a[156:159], a[12:15], v[52:55]
 s_cselect_b64 s[66:67], s[58:59], s[68:69]
 v_mfma_f32_16x16x32_bf16 v[60:63], a[156:159], a[28:31], v[60:63]
 v_mfma_f32_16x16x32_bf16 v[176:179], a[160:163], v[24:27], v[176:179]
 v_mfma_f32_16x16x32_bf16 v[208:211], a[160:163], v[28:31], v[208:211]
 ds_read_b128 a[160:163], v3 offset:8192
 v_mfma_f32_16x16x32_bf16 v[180:183], a[164:167], v[24:27], v[180:183]
 v_mfma_f32_16x16x32_bf16 v[212:215], a[164:167], v[28:31], v[212:215]
 ds_read_b128 a[164:167], v3 offset:9216
 v_exp_f32 v48, v48
 v_mfma_f32_16x16x32_bf16 v[184:187], a[168:171], v[24:27], v[184:187]
 v_exp_f32 v49, v49
 v_mfma_f32_16x16x32_bf16 v[216:219], a[168:171], v[28:31], v[216:219]
 ds_read_b128 a[168:171], v3 offset:10240
 v_exp_f32 v52, v52
 v_mfma_f32_16x16x32_bf16 v[188:191], a[172:175], v[24:27], v[188:191]
 v_exp_f32 v53, v53
 v_mfma_f32_16x16x32_bf16 v[220:223], a[172:175], v[28:31], v[220:223]
 ds_read_b128 a[172:175], v3 offset:11264
 v_exp_f32 v50, v50
 v_mfma_f32_16x16x32_bf16 v[192:195], a[176:179], v[24:27], v[192:195]
 v_cvt_pk_bf16_f32 v16, v48, v49
 v_cvt_pk_bf16_f32 v17, v52, v53
 v_mfma_f32_16x16x32_bf16 v[224:227], a[176:179], v[28:31], v[224:227]
 ds_read_b128 a[176:179], v3 offset:12288
 v_exp_f32 v51, v51
 v_mfma_f32_16x16x32_bf16 v[196:199], a[180:183], v[24:27], v[196:199]
 v_exp_f32 v54, v54
 v_mfma_f32_16x16x32_bf16 v[228:231], a[180:183], v[28:31], v[228:231]
 ds_read_b128 a[180:183], v3 offset:13312
 v_exp_f32 v55, v55
 v_mfma_f32_16x16x32_bf16 v[200:203], a[184:187], v[24:27], v[200:203]
 v_cvt_pk_bf16_f32 v18, v50, v51
 v_cvt_pk_bf16_f32 v19, v54, v55
 v_mfma_f32_16x16x32_bf16 v[232:235], a[184:187], v[28:31], v[232:235]
 ds_read_b128 a[184:187], v3 offset:14336
 v_cndmask_b32 v80, v4, v12, s[60:61]
 v_cndmask_b32 v81, v4, v12, s[62:63]
 v_mfma_f32_16x16x32_bf16 v[204:207], a[188:191], v[24:27], v[204:207]
 v_cndmask_b32 v82, v4, v12, s[64:65]
 v_cndmask_b32 v83, v4, v12, s[66:67]
 v_mfma_f32_16x16x32_bf16 v[236:239], a[188:191], v[28:31], v[236:239]
 ds_read_b128 a[188:191], v3 offset:15360
 v_cndmask_b32 v84, v4, v12, s[68:69]
 v_cndmask_b32 v85, v4, v12, s[68:69]
 v_mfma_f32_16x16x32_bf16 v[40:43], a[192:195], v[24:27], v[40:43]
 v_cndmask_b32 v86, v4, v12, s[68:69]
 v_cndmask_b32 v87, v4, v12, s[68:69]
 v_mfma_f32_16x16x32_bf16 v[44:47], a[192:195], v[28:31], v[44:47]
 v_mfma_f32_16x16x32_bf16 v[64:67], a[128:131], a[32:35], v[96:99]
 s_waitcnt vmcnt(20)
 s_barrier
 v_exp_f32 v56, v56
 v_mfma_f32_16x16x32_bf16 v[72:75], a[128:131], a[48:51], v[104:107]
 ds_read_b128 a[128:131], v2 offset:0
 v_exp_f32 v57, v57
 v_mfma_f32_16x16x32_bf16 v[68:71], a[132:135], a[32:35], v[100:103]
 s_add_u32 s39, s39, 0x4000
 v_exp_f32 v60, v60
 v_mfma_f32_16x16x32_bf16 v[76:79], a[132:135], a[48:51], v[108:111]
 ds_read_b128 a[132:135], v2 offset:1024
 v_exp_f32 v61, v61
 v_mfma_f32_16x16x32_bf16 v[64:67], a[136:139], a[36:39], v[64:67]
 v_exp_f32 v58, v58
 v_mfma_f32_16x16x32_bf16 v[72:75], a[136:139], a[52:55], v[72:75]
 ds_read_b128 a[136:139], v2 offset:2048
 v_cvt_pk_bf16_f32 v20, v56, v57
 v_cvt_pk_bf16_f32 v21, v60, v61
 v_mfma_f32_16x16x32_bf16 v[68:71], a[140:143], a[36:39], v[68:71]
 v_exp_f32 v59, v59
 v_mfma_f32_16x16x32_bf16 v[76:79], a[140:143], a[52:55], v[76:79]
 ds_read_b128 a[140:143], v2 offset:3072
 v_exp_f32 v62, v62
 v_mfma_f32_16x16x32_bf16 v[64:67], a[144:147], a[40:43], v[64:67]
 s_and_b32 s39, s39, 0x1ffff
 v_exp_f32 v63, v63
 v_mfma_f32_16x16x32_bf16 v[72:75], a[144:147], a[56:59], v[72:75]
 ds_read_b128 a[144:147], v2 offset:4096
 v_cvt_pk_bf16_f32 v22, v58, v59
 v_cvt_pk_bf16_f32 v23, v62, v63
 v_mfma_f32_16x16x32_bf16 v[68:71], a[148:151], a[40:43], v[68:71]
 v_cndmask_b32 v88, v4, v13, s[70:71]
 v_cndmask_b32 v89, v4, v13, s[70:71]
 v_mfma_f32_16x16x32_bf16 v[76:79], a[148:151], a[56:59], v[76:79]
 ds_read_b128 a[148:151], v2 offset:5120
 v_cndmask_b32 v90, v4, v13, s[70:71]
 v_cndmask_b32 v91, v4, v13, s[70:71]
 v_mfma_f32_16x16x32_bf16 v[64:67], a[152:155], a[44:47], v[64:67]
 v_cndmask_b32 v92, v4, v13, s[60:61]
 v_cndmask_b32 v93, v4, v13, s[62:63]
 v_mfma_f32_16x16x32_bf16 v[72:75], a[152:155], a[60:63], v[72:75]
 ds_read_b128 a[152:155], v2 offset:6144
 v_cndmask_b32 v94, v4, v13, s[64:65]
 v_cndmask_b32 v95, v4, v13, s[66:67]
 v_mfma_f32_16x16x32_bf16 v[68:71], a[156:159], a[44:47], v[68:71]
 v_mfma_f32_16x16x32_bf16 v[76:79], a[156:159], a[60:63], v[76:79]
 ds_read_b128 a[156:159], v2 offset:7168
 s_waitcnt lgkmcnt(8)
 v_mfma_f32_16x16x32_bf16 v[112:115], a[160:163], v[16:19], v[112:115]
 s_lshl_b32 s37, s35, 19
 v_mov_b32 v3, v2
 v_add_u32 v2, s39, v1
 v_mfma_f32_16x16x32_bf16 v[144:147], a[160:163], v[20:23], v[144:147]
 s_add_u32 m0, s38, s50
 v_mfma_f32_16x16x32_bf16 v[116:119], a[164:167], v[16:19], v[116:119]
 s_add_u32 s37, s37, s45
 v_mfma_f32_16x16x32_bf16 v[148:151], a[164:167], v[20:23], v[148:151]
 buffer_load_dwordx4 v1, s[20:23], s37 offen offset:0 sc1 lds
 v_exp_f32 v64, v64
 v_mfma_f32_16x16x32_bf16 v[120:123], a[168:171], v[16:19], v[120:123]
 v_mfma_f32_16x16x32_bf16 v[152:155], a[168:171], v[20:23], v[152:155]
 buffer_load_dwordx4 v1, s[20:23], s37 offen offset:1024 sc1 lds
 v_exp_f32 v65, v65
 v_mfma_f32_16x16x32_bf16 v[124:127], a[172:175], v[16:19], v[124:127]
 buffer_load_dwordx4 v1, s[20:23], s37 offen offset:2048 sc1 lds
 v_exp_f32 v68, v68
 v_mfma_f32_16x16x32_bf16 v[156:159], a[172:175], v[20:23], v[156:159]
 buffer_load_dwordx4 v1, s[20:23], s37 offen offset:3072 sc1 lds
 v_exp_f32 v69, v69
 v_mfma_f32_16x16x32_bf16 v[128:131], a[176:179], v[16:19], v[128:131]
 v_mfma_f32_16x16x32_bf16 v[160:163], a[176:179], v[20:23], v[160:163]
 s_add_u32 s38, s38, 0x4000
 v_exp_f32 v66, v66
 v_mfma_f32_16x16x32_bf16 v[132:135], a[180:183], v[16:19], v[132:135]
 s_and_b32 s38, s38, 0x1ffff
 v_cvt_pk_bf16_f32 v24, v64, v65
 v_cvt_pk_bf16_f32 v25, v68, v69
 v_mfma_f32_16x16x32_bf16 v[164:167], a[180:183], v[20:23], v[164:167]
 s_add_u32 s35, s35, 1
 v_exp_f32 v67, v67
 v_mfma_f32_16x16x32_bf16 v[136:139], a[184:187], v[16:19], v[136:139]
 s_cmp_eq_u32 s35, s36
 v_mfma_f32_16x16x32_bf16 v[168:171], a[184:187], v[20:23], v[168:171]
 v_exp_f32 v70, v70
 v_mfma_f32_16x16x32_bf16 v[140:143], a[188:191], v[16:19], v[140:143]
 s_cselect_b32 s36, s47, s36
 v_exp_f32 v71, v71
 v_mfma_f32_16x16x32_bf16 v[172:175], a[188:191], v[20:23], v[172:175]
 s_cselect_b32 s35, 0, s35
 v_cvt_pk_bf16_f32 v26, v66, v67
 v_cvt_pk_bf16_f32 v27, v70, v71
 v_mfma_f32_16x16x32_bf16 v[32:35], a[192:195], v[16:19], v[32:35]
 s_cmp_lt_u32 s49, s40
 v_mfma_f32_16x16x32_bf16 v[36:39], a[192:195], v[20:23], v[36:39]
 s_cbranch_scc1 Lamk_13
 s_add_u32 s40, s43, 8
 s_cmp_lt_u32 s49, s42
 s_cselect_b64 s[68:69], -1, 0
 s_cmp_le_u32 s49, s42
 s_cselect_b64 s[70:71], -1, 0
 s_cmp_eq_u32 s49, s42
 s_cselect_b64 s[60:61], s[52:53], s[68:69]
 s_cselect_b64 s[62:63], s[54:55], s[68:69]
 s_cselect_b64 s[64:65], s[56:57], s[68:69]
 s_cselect_b64 s[66:67], s[58:59], s[68:69]
 v_mfma_f32_16x16x32_bf16 v[176:179], a[160:163], v[24:27], v[176:179]
 v_cndmask_b32 v96, v4, v14, s[60:61]
 v_cndmask_b32 v97, v4, v14, s[62:63]
 v_mfma_f32_16x16x32_bf16 v[180:183], a[164:167], v[24:27], v[180:183]
 v_cndmask_b32 v98, v4, v14, s[64:65]
 v_cndmask_b32 v99, v4, v14, s[66:67]
 v_mfma_f32_16x16x32_bf16 v[184:187], a[168:171], v[24:27], v[184:187]
 v_cndmask_b32 v100, v4, v14, s[68:69]
 v_cndmask_b32 v101, v4, v14, s[68:69]
 v_mfma_f32_16x16x32_bf16 v[188:191], a[172:175], v[24:27], v[188:191]
 v_exp_f32 v72, v72
 v_mfma_f32_16x16x32_bf16 v[192:195], a[176:179], v[24:27], v[192:195]
 v_exp_f32 v73, v73
 v_mfma_f32_16x16x32_bf16 v[196:199], a[180:183], v[24:27], v[196:199]
 v_exp_f32 v76, v76
 v_mfma_f32_16x16x32_bf16 v[200:203], a[184:187], v[24:27], v[200:203]
 v_exp_f32 v77, v77
 v_mfma_f32_16x16x32_bf16 v[204:207], a[188:191], v[24:27], v[204:207]
 v_exp_f32 v74, v74
 v_mfma_f32_16x16x32_bf16 v[40:43], a[192:195], v[24:27], v[40:43]
 v_cndmask_b32 v102, v4, v14, s[68:69]
 v_cndmask_b32 v103, v4, v14, s[68:69]
 s_nop 0
 .p2align 3
Lam1_12:
 s_waitcnt lgkmcnt(0)
 v_mfma_f32_16x16x32_bf16 v[64:67], a[128:131], a[32:35], v[96:99]
 v_cvt_pk_bf16_f32 v28, v72, v73
 v_cvt_pk_bf16_f32 v29, v76, v77
 v_mfma_f32_16x16x32_bf16 v[68:71], a[132:135], a[32:35], v[100:103]
 v_exp_f32 v75, v75
 v_mfma_f32_16x16x32_bf16 v[64:67], a[136:139], a[36:39], v[64:67]
 v_exp_f32 v78, v78
 v_mfma_f32_16x16x32_bf16 v[68:71], a[140:143], a[36:39], v[68:71]
 v_exp_f32 v79, v79
 v_mfma_f32_16x16x32_bf16 v[64:67], a[144:147], a[40:43], v[64:67]
 v_cvt_pk_bf16_f32 v30, v74, v75
 v_cvt_pk_bf16_f32 v31, v78, v79
 v_mfma_f32_16x16x32_bf16 v[68:71], a[148:151], a[40:43], v[68:71]
 v_cndmask_b32 v104, v4, v15, s[70:71]
 v_cndmask_b32 v105, v4, v15, s[70:71]
 v_mfma_f32_16x16x32_bf16 v[64:67], a[152:155], a[44:47], v[64:67]
 v_mfma_f32_16x16x32_bf16 v[68:71], a[156:159], a[44:47], v[68:71]
 v_mfma_f32_16x16x32_bf16 v[208:211], a[160:163], v[28:31], v[208:211]
 ds_read_b128 a[160:163], v3 offset:8192
 v_cndmask_b32 v106, v4, v15, s[70:71]
 v_cndmask_b32 v107, v4, v15, s[70:71]
 v_mfma_f32_16x16x32_bf16 v[212:215], a[164:167], v[28:31], v[212:215]
 ds_read_b128 a[164:167], v3 offset:9216
 v_cndmask_b32 v108, v4, v15, s[60:61]
 v_cndmask_b32 v109, v4, v15, s[62:63]
 v_mfma_f32_16x16x32_bf16 v[216:219], a[168:171], v[28:31], v[216:219]
 ds_read_b128 a[168:171], v3 offset:10240
 v_cndmask_b32 v110, v4, v15, s[64:65]
 v_cndmask_b32 v111, v4, v15, s[66:67]
 v_mfma_f32_16x16x32_bf16 v[220:223], a[172:175], v[28:31], v[220:223]
 ds_read_b128 a[172:175], v3 offset:11264
 v_exp_f32 v64, v64
 v_mfma_f32_16x16x32_bf16 v[224:227], a[176:179], v[28:31], v[224:227]
 ds_read_b128 a[176:179], v3 offset:12288
 v_exp_f32 v65, v65
 v_mfma_f32_16x16x32_bf16 v[228:231], a[180:183], v[28:31], v[228:231]
 ds_read_b128 a[180:183], v3 offset:13312
 v_exp_f32 v68, v68
 v_mfma_f32_16x16x32_bf16 v[232:235], a[184:187], v[28:31], v[232:235]
 ds_read_b128 a[184:187], v3 offset:14336
 v_exp_f32 v69, v69
 v_mfma_f32_16x16x32_bf16 v[236:239], a[188:191], v[28:31], v[236:239]
 ds_read_b128 a[188:191], v3 offset:15360
 v_exp_f32 v66, v66
 v_mfma_f32_16x16x32_bf16 v[44:47], a[192:195], v[28:31], v[44:47]
 v_mfma_f32_16x16x32_bf16 v[72:75], a[128:131], a[48:51], v[104:107]
 s_waitcnt vmcnt(20)
 s_barrier
 ds_read_b128 a[128:131], v2 offset:0
 s_add_u32 s39, s39, 0x4000
 v_cvt_pk_bf16_f32 v24, v64, v65
 v_cvt_pk_bf16_f32 v25, v68, v69
 v_mfma_f32_16x16x32_bf16 v[76:79], a[132:135], a[48:51], v[108:111]
 ds_read_b128 a[132:135], v2 offset:1024
 v_exp_f32 v67, v67
 v_mfma_f32_16x16x32_bf16 v[72:75], a[136:139], a[52:55], v[72:75]
 ds_read_b128 a[136:139], v2 offset:2048
 v_exp_f32 v70, v70
 v_mfma_f32_16x16x32_bf16 v[76:79], a[140:143], a[52:55], v[76:79]
 ds_read_b128 a[140:143], v2 offset:3072
 v_mfma_f32_16x16x32_bf16 v[72:75], a[144:147], a[56:59], v[72:75]
 ds_read_b128 a[144:147], v2 offset:4096
 s_and_b32 s39, s39, 0x1ffff
 v_exp_f32 v71, v71
 v_mfma_f32_16x16x32_bf16 v[76:79], a[148:151], a[56:59], v[76:79]
 ds_read_b128 a[148:151], v2 offset:5120
 v_cvt_pk_bf16_f32 v26, v66, v67
 v_cvt_pk_bf16_f32 v27, v70, v71
 v_mfma_f32_16x16x32_bf16 v[72:75], a[152:155], a[60:63], v[72:75]
 ds_read_b128 a[152:155], v2 offset:6144
 v_mfma_f32_16x16x32_bf16 v[76:79], a[156:159], a[60:63], v[76:79]
 ds_read_b128 a[156:159], v2 offset:7168
 s_waitcnt lgkmcnt(8)
 s_add_u32 s49, s49, 1
 s_cmp_lt_u32 s49, s42
 s_cselect_b64 s[68:69], -1, 0
 s_cmp_le_u32 s49, s42
 s_cselect_b64 s[70:71], -1, 0
 s_cmp_eq_u32 s49, s42
 s_cselect_b64 s[60:61], s[52:53], s[68:69]
 s_cselect_b64 s[62:63], s[54:55], s[68:69]
 s_cselect_b64 s[64:65], s[56:57], s[68:69]
 s_cselect_b64 s[66:67], s[58:59], s[68:69]
 v_mfma_f32_16x16x32_bf16 v[176:179], a[160:163], v[24:27], v[176:179]
 s_lshl_b32 s37, s35, 19
 s_add_u32 m0, s38, s50
 v_mov_b32 v3, v2
 v_add_u32 v2, s39, v1
 v_cndmask_b32 v96, v4, v14, s[60:61]
 v_cndmask_b32 v97, v4, v14, s[62:63]
 v_mfma_f32_16x16x32_bf16 v[180:183], a[164:167], v[24:27], v[180:183]
 s_add_u32 s37, s37, s45
 buffer_load_dwordx4 v1, s[20:23], s37 offen offset:0 sc1 lds
 v_cndmask_b32 v98, v4, v14, s[64:65]
 v_cndmask_b32 v99, v4, v14, s[66:67]
 v_mfma_f32_16x16x32_bf16 v[184:187], a[168:171], v[24:27], v[184:187]
 buffer_load_dwordx4 v1, s[20:23], s37 offen offset:1024 sc1 lds
 v_exp_f32 v72, v72
 v_mfma_f32_16x16x32_bf16 v[188:191], a[172:175], v[24:27], v[188:191]
 buffer_load_dwordx4 v1, s[20:23], s37 offen offset:2048 sc1 lds
 buffer_load_dwordx4 v1, s[20:23], s37 offen offset:3072 sc1 lds
 v_exp_f32 v73, v73
 v_mfma_f32_16x16x32_bf16 v[192:195], a[176:179], v[24:27], v[192:195]
 s_add_u32 s38, s38, 0x4000
 v_exp_f32 v76, v76
 v_mfma_f32_16x16x32_bf16 v[196:199], a[180:183], v[24:27], v[196:199]
 s_and_b32 s38, s38, 0x1ffff
 s_add_u32 s35, s35, 1
 v_exp_f32 v77, v77
 v_mfma_f32_16x16x32_bf16 v[200:203], a[184:187], v[24:27], v[200:203]
 s_cmp_eq_u32 s35, s36
 v_exp_f32 v74, v74
 v_mfma_f32_16x16x32_bf16 v[204:207], a[188:191], v[24:27], v[204:207]
 s_cselect_b32 s36, s47, s36
 s_cselect_b32 s35, 0, s35
 v_cndmask_b32 v100, v4, v14, s[68:69]
 v_cndmask_b32 v101, v4, v14, s[68:69]
 v_mfma_f32_16x16x32_bf16 v[40:43], a[192:195], v[24:27], v[40:43]
 s_cmp_lt_u32 s49, s40
 v_cndmask_b32 v102, v4, v14, s[68:69]
 v_cndmask_b32 v103, v4, v14, s[68:69]
 s_cbranch_scc1 Lam1_12
 v_cvt_pk_bf16_f32 v28, v72, v73
 v_cvt_pk_bf16_f32 v29, v76, v77
 v_exp_f32 v75, v75
 v_exp_f32 v78, v78
 v_exp_f32 v79, v79
 v_cvt_pk_bf16_f32 v30, v74, v75
 v_cvt_pk_bf16_f32 v31, v78, v79
 s_nop 1
 v_mfma_f32_16x16x32_bf16 v[44:47], a[192:195], v[28:31], v[44:47]
 v_mfma_f32_16x16x32_bf16 v[208:211], a[160:163], v[28:31], v[208:211]
 v_mfma_f32_16x16x32_bf16 v[212:215], a[164:167], v[28:31], v[212:215]
 v_mfma_f32_16x16x32_bf16 v[216:219], a[168:171], v[28:31], v[216:219]
 v_mfma_f32_16x16x32_bf16 v[220:223], a[172:175], v[28:31], v[220:223]
 v_mfma_f32_16x16x32_bf16 v[224:227], a[176:179], v[28:31], v[224:227]
 v_mfma_f32_16x16x32_bf16 v[228:231], a[180:183], v[28:31], v[228:231]
 v_mfma_f32_16x16x32_bf16 v[232:235], a[184:187], v[28:31], v[232:235]
 v_mfma_f32_16x16x32_bf16 v[236:239], a[188:191], v[28:31], v[236:239]
 v_cmp_ngt_f32 s[60:61], s73, v32
 v_cmp_nlt_f32 vcc, s74, v32
 s_or_b64 s[60:61], s[60:61], vcc
 v_cmp_ngt_f32 s[62:63], s73, v36
 v_cmp_nlt_f32 vcc, s74, v36
 s_or_b64 s[62:63], s[62:63], vcc
 v_cmp_ngt_f32 s[64:65], s73, v40
 v_cmp_nlt_f32 vcc, s74, v40
 s_or_b64 s[64:65], s[64:65], vcc
 v_cmp_ngt_f32 s[66:67], s73, v44
 v_cmp_nlt_f32 vcc, s74, v44
 s_or_b64 s[66:67], s[66:67], vcc
 s_or_b64 s[60:61], s[60:61], s[62:63]
 s_or_b64 s[64:65], s[64:65], s[66:67]
 s_or_b64 s[60:61], s[60:61], s[64:65]
 s_cbranch_scc1 Laslow_7
Laback_8:
 v_rcp_f32 v32, v32
 v_rcp_f32 v36, v36
 v_rcp_f32 v40, v40
 v_rcp_f32 v44, v44
 s_lshl_b32 s40, s41, 5
 s_add_u32 s40, s40, s32
 s_lshl_b32 s40, s40, 13
 s_add_u32 s40, s40, 0x6000000
 s_add_u32 s44, s40, 4096
 v_pk_mul_f32 v[112:113], v[112:113], v[32:33] op_sel_hi:[1,0]
 v_pk_mul_f32 v[114:115], v[114:115], v[32:33] op_sel_hi:[1,0]
 v_pk_mul_f32 v[116:117], v[116:117], v[32:33] op_sel_hi:[1,0]
 v_pk_mul_f32 v[118:119], v[118:119], v[32:33] op_sel_hi:[1,0]
 v_cvt_pk_bf16_f32 v240, v112, v113
 v_cvt_pk_bf16_f32 v241, v116, v117
 v_cvt_pk_bf16_f32 v242, v114, v115
 v_cvt_pk_bf16_f32 v243, v118, v119
 buffer_store_dwordx4 v[240:243], v1, s[20:23], s40 offen offset:0 sc1
 v_pk_mul_f32 v[120:121], v[120:121], v[32:33] op_sel_hi:[1,0]
 v_pk_mul_f32 v[122:123], v[122:123], v[32:33] op_sel_hi:[1,0]
 v_pk_mul_f32 v[124:125], v[124:125], v[32:33] op_sel_hi:[1,0]
 v_pk_mul_f32 v[126:127], v[126:127], v[32:33] op_sel_hi:[1,0]
 v_cvt_pk_bf16_f32 v244, v120, v121
 v_cvt_pk_bf16_f32 v245, v124, v125
 v_cvt_pk_bf16_f32 v246, v122, v123
 v_cvt_pk_bf16_f32 v247, v126, v127
 buffer_store_dwordx4 v[244:247], v1, s[20:23], s40 offen offset:2048 sc1
 v_pk_mul_f32 v[128:129], v[128:129], v[32:33] op_sel_hi:[1,0]
 v_pk_mul_f32 v[130:131], v[130:131], v[32:33] op_sel_hi:[1,0]
 v_pk_mul_f32 v[132:133], v[132:133], v[32:33] op_sel_hi:[1,0]
 v_pk_mul_f32 v[134:135], v[134:135], v[32:33] op_sel_hi:[1,0]
 v_cvt_pk_bf16_f32 v248, v128, v129
 v_cvt_pk_bf16_f32 v249, v132, v133
 v_cvt_pk_bf16_f32 v250, v130, v131
 v_cvt_pk_bf16_f32 v251, v134, v135
 buffer_store_dwordx4 v[248:251], v1, s[20:23], s44 offen offset:0 sc1
 v_pk_mul_f32 v[136:137], v[136:137], v[32:33] op_sel_hi:[1,0]
 v_pk_mul_f32 v[138:139], v[138:139], v[32:33] op_sel_hi:[1,0]
 v_pk_mul_f32 v[140:141], v[140:141], v[32:33] op_sel_hi:[1,0]
 v_pk_mul_f32 v[142:143], v[142:143], v[32:33] op_sel_hi:[1,0]
 v_cvt_pk_bf16_f32 v252, v136, v137
 v_cvt_pk_bf16_f32 v253, v140, v141
 v_cvt_pk_bf16_f32 v254, v138, v139
 v_cvt_pk_bf16_f32 v255, v142, v143
 buffer_store_dwordx4 v[252:255], v1, s[20:23], s44 offen offset:2048 sc1
 v_pk_mul_f32 v[144:145], v[144:145], v[36:37] op_sel_hi:[1,0]
 v_pk_mul_f32 v[146:147], v[146:147], v[36:37] op_sel_hi:[1,0]
 v_pk_mul_f32 v[148:149], v[148:149], v[36:37] op_sel_hi:[1,0]
 v_pk_mul_f32 v[150:151], v[150:151], v[36:37] op_sel_hi:[1,0]
 v_cvt_pk_bf16_f32 v240, v144, v145
 v_cvt_pk_bf16_f32 v241, v148, v149
 v_cvt_pk_bf16_f32 v242, v146, v147
 v_cvt_pk_bf16_f32 v243, v150, v151
 buffer_store_dwordx4 v[240:243], v1, s[20:23], s40 offen offset:1024 sc1
 v_pk_mul_f32 v[152:153], v[152:153], v[36:37] op_sel_hi:[1,0]
 v_pk_mul_f32 v[154:155], v[154:155], v[36:37] op_sel_hi:[1,0]
 v_pk_mul_f32 v[156:157], v[156:157], v[36:37] op_sel_hi:[1,0]
 v_pk_mul_f32 v[158:159], v[158:159], v[36:37] op_sel_hi:[1,0]
 v_cvt_pk_bf16_f32 v244, v152, v153
 v_cvt_pk_bf16_f32 v245, v156, v157
 v_cvt_pk_bf16_f32 v246, v154, v155
 v_cvt_pk_bf16_f32 v247, v158, v159
 buffer_store_dwordx4 v[244:247], v1, s[20:23], s40 offen offset:3072 sc1
 v_pk_mul_f32 v[160:161], v[160:161], v[36:37] op_sel_hi:[1,0]
 v_pk_mul_f32 v[162:163], v[162:163], v[36:37] op_sel_hi:[1,0]
 v_pk_mul_f32 v[164:165], v[164:165], v[36:37] op_sel_hi:[1,0]
 v_pk_mul_f32 v[166:167], v[166:167], v[36:37] op_sel_hi:[1,0]
 v_cvt_pk_bf16_f32 v248, v160, v161
 v_cvt_pk_bf16_f32 v249, v164, v165
 v_cvt_pk_bf16_f32 v250, v162, v163
 v_cvt_pk_bf16_f32 v251, v166, v167
 buffer_store_dwordx4 v[248:251], v1, s[20:23], s44 offen offset:1024 sc1
 v_pk_mul_f32 v[168:169], v[168:169], v[36:37] op_sel_hi:[1,0]
 v_pk_mul_f32 v[170:171], v[170:171], v[36:37] op_sel_hi:[1,0]
 v_pk_mul_f32 v[172:173], v[172:173], v[36:37] op_sel_hi:[1,0]
 v_pk_mul_f32 v[174:175], v[174:175], v[36:37] op_sel_hi:[1,0]
 v_cvt_pk_bf16_f32 v252, v168, v169
 v_cvt_pk_bf16_f32 v253, v172, v173
 v_cvt_pk_bf16_f32 v254, v170, v171
 v_cvt_pk_bf16_f32 v255, v174, v175
 buffer_store_dwordx4 v[252:255], v1, s[20:23], s44 offen offset:3072 sc1
 s_lshl_b32 s40, s42, 5
 s_add_u32 s40, s40, s32
 s_lshl_b32 s40, s40, 13
 s_add_u32 s40, s40, 0x6000000
 s_add_u32 s44, s40, 4096
 v_pk_mul_f32 v[176:177], v[176:177], v[40:41] op_sel_hi:[1,0]
 v_pk_mul_f32 v[178:179], v[178:179], v[40:41] op_sel_hi:[1,0]
 v_pk_mul_f32 v[180:181], v[180:181], v[40:41] op_sel_hi:[1,0]
 v_pk_mul_f32 v[182:183], v[182:183], v[40:41] op_sel_hi:[1,0]
 v_cvt_pk_bf16_f32 v240, v176, v177
 v_cvt_pk_bf16_f32 v241, v180, v181
 v_cvt_pk_bf16_f32 v242, v178, v179
 v_cvt_pk_bf16_f32 v243, v182, v183
 buffer_store_dwordx4 v[240:243], v1, s[20:23], s40 offen offset:0 sc1
 v_pk_mul_f32 v[184:185], v[184:185], v[40:41] op_sel_hi:[1,0]
 v_pk_mul_f32 v[186:187], v[186:187], v[40:41] op_sel_hi:[1,0]
 v_pk_mul_f32 v[188:189], v[188:189], v[40:41] op_sel_hi:[1,0]
 v_pk_mul_f32 v[190:191], v[190:191], v[40:41] op_sel_hi:[1,0]
 v_cvt_pk_bf16_f32 v244, v184, v185
 v_cvt_pk_bf16_f32 v245, v188, v189
 v_cvt_pk_bf16_f32 v246, v186, v187
 v_cvt_pk_bf16_f32 v247, v190, v191
 buffer_store_dwordx4 v[244:247], v1, s[20:23], s40 offen offset:2048 sc1
 v_pk_mul_f32 v[192:193], v[192:193], v[40:41] op_sel_hi:[1,0]
 v_pk_mul_f32 v[194:195], v[194:195], v[40:41] op_sel_hi:[1,0]
 v_pk_mul_f32 v[196:197], v[196:197], v[40:41] op_sel_hi:[1,0]
 v_pk_mul_f32 v[198:199], v[198:199], v[40:41] op_sel_hi:[1,0]
 v_cvt_pk_bf16_f32 v248, v192, v193
 v_cvt_pk_bf16_f32 v249, v196, v197
 v_cvt_pk_bf16_f32 v250, v194, v195
 v_cvt_pk_bf16_f32 v251, v198, v199
 buffer_store_dwordx4 v[248:251], v1, s[20:23], s44 offen offset:0 sc1
 v_pk_mul_f32 v[200:201], v[200:201], v[40:41] op_sel_hi:[1,0]
 v_pk_mul_f32 v[202:203], v[202:203], v[40:41] op_sel_hi:[1,0]
 v_pk_mul_f32 v[204:205], v[204:205], v[40:41] op_sel_hi:[1,0]
 v_pk_mul_f32 v[206:207], v[206:207], v[40:41] op_sel_hi:[1,0]
 v_cvt_pk_bf16_f32 v252, v200, v201
 v_cvt_pk_bf16_f32 v253, v204, v205
 v_cvt_pk_bf16_f32 v254, v202, v203
 v_cvt_pk_bf16_f32 v255, v206, v207
 buffer_store_dwordx4 v[252:255], v1, s[20:23], s44 offen offset:2048 sc1
 v_pk_mul_f32 v[208:209], v[208:209], v[44:45] op_sel_hi:[1,0]
 v_pk_mul_f32 v[210:211], v[210:211], v[44:45] op_sel_hi:[1,0]
 v_pk_mul_f32 v[212:213], v[212:213], v[44:45] op_sel_hi:[1,0]
 v_pk_mul_f32 v[214:215], v[214:215], v[44:45] op_sel_hi:[1,0]
 v_cvt_pk_bf16_f32 v240, v208, v209
 v_cvt_pk_bf16_f32 v241, v212, v213
 v_cvt_pk_bf16_f32 v242, v210, v211
 v_cvt_pk_bf16_f32 v243, v214, v215
 buffer_store_dwordx4 v[240:243], v1, s[20:23], s40 offen offset:1024 sc1
 v_pk_mul_f32 v[216:217], v[216:217], v[44:45] op_sel_hi:[1,0]
 v_pk_mul_f32 v[218:219], v[218:219], v[44:45] op_sel_hi:[1,0]
 v_pk_mul_f32 v[220:221], v[220:221], v[44:45] op_sel_hi:[1,0]
 v_pk_mul_f32 v[222:223], v[222:223], v[44:45] op_sel_hi:[1,0]
 v_cvt_pk_bf16_f32 v244, v216, v217
 v_cvt_pk_bf16_f32 v245, v220, v221
 v_cvt_pk_bf16_f32 v246, v218, v219
 v_cvt_pk_bf16_f32 v247, v222, v223
 buffer_store_dwordx4 v[244:247], v1, s[20:23], s40 offen offset:3072 sc1
 v_pk_mul_f32 v[224:225], v[224:225], v[44:45] op_sel_hi:[1,0]
 v_pk_mul_f32 v[226:227], v[226:227], v[44:45] op_sel_hi:[1,0]
 v_pk_mul_f32 v[228:229], v[228:229], v[44:45] op_sel_hi:[1,0]
 v_pk_mul_f32 v[230:231], v[230:231], v[44:45] op_sel_hi:[1,0]
 v_cvt_pk_bf16_f32 v248, v224, v225
 v_cvt_pk_bf16_f32 v249, v228, v229
 v_cvt_pk_bf16_f32 v250, v226, v227
 v_cvt_pk_bf16_f32 v251, v230, v231
 buffer_store_dwordx4 v[248:251], v1, s[20:23], s44 offen offset:1024 sc1
 v_pk_mul_f32 v[232:233], v[232:233], v[44:45] op_sel_hi:[1,0]
 v_pk_mul_f32 v[234:235], v[234:235], v[44:45] op_sel_hi:[1,0]
 v_pk_mul_f32 v[236:237], v[236:237], v[44:45] op_sel_hi:[1,0]
 v_pk_mul_f32 v[238:239], v[238:239], v[44:45] op_sel_hi:[1,0]
 v_cvt_pk_bf16_f32 v252, v232, v233
 v_cvt_pk_bf16_f32 v253, v236, v237
 v_cvt_pk_bf16_f32 v254, v234, v235
 v_cvt_pk_bf16_f32 v255, v238, v239
 buffer_store_dwordx4 v[252:255], v1, s[20:23], s44 offen offset:3072 sc1
 s_lshl_b32 s72, s33, 5
 s_add_u32 s72, s72, s32
 s_lshl_b32 s72, s72, 2
 s_add_u32 s72, s72, 0x3c00
 s_cmp_eq_u32 s46, 1
 s_cbranch_scc1 Ladone_9
 s_mov_b32 s46, 1
 s_mov_b32 s33, s34
 v_accvgpr_mov_b32 a0, a64
 v_accvgpr_mov_b32 a1, a65
 v_accvgpr_mov_b32 a2, a66
 v_accvgpr_mov_b32 a3, a67
 v_accvgpr_mov_b32 a4, a68
 v_accvgpr_mov_b32 a5, a69
 v_accvgpr_mov_b32 a6, a70
 v_accvgpr_mov_b32 a7, a71
 v_accvgpr_mov_b32 a8, a72
 v_accvgpr_mov_b32 a9, a73
 v_accvgpr_mov_b32 a10, a74
 v_accvgpr_mov_b32 a11, a75
 v_accvgpr_mov_b32 a12, a76
 v_accvgpr_mov_b32 a13, a77
 v_accvgpr_mov_b32 a14, a78
 v_accvgpr_mov_b32 a15, a79
 v_accvgpr_mov_b32 a16, a80
 v_accvgpr_mov_b32 a17, a81
 v_accvgpr_mov_b32 a18, a82
 v_accvgpr_mov_b32 a19, a83
 v_accvgpr_mov_b32 a20, a84
 v_accvgpr_mov_b32 a21, a85
 v_accvgpr_mov_b32 a22, a86
 v_accvgpr_mov_b32 a23, a87
 v_accvgpr_mov_b32 a24, a88
 v_accvgpr_mov_b32 a25, a89
 v_accvgpr_mov_b32 a26, a90
 v_accvgpr_mov_b32 a27, a91
 v_accvgpr_mov_b32 a28, a92
 v_accvgpr_mov_b32 a29, a93
 v_accvgpr_mov_b32 a30, a94
 v_accvgpr_mov_b32 a31, a95
 v_accvgpr_mov_b32 a32, a96
 v_accvgpr_mov_b32 a33, a97
 v_accvgpr_mov_b32 a34, a98
 v_accvgpr_mov_b32 a35, a99
 v_accvgpr_mov_b32 a36, a100
 v_accvgpr_mov_b32 a37, a101
 v_accvgpr_mov_b32 a38, a102
 v_accvgpr_mov_b32 a39, a103
 v_accvgpr_mov_b32 a40, a104
 v_accvgpr_mov_b32 a41, a105
 v_accvgpr_mov_b32 a42, a106
 v_accvgpr_mov_b32 a43, a107
 v_accvgpr_mov_b32 a44, a108
 v_accvgpr_mov_b32 a45, a109
 v_accvgpr_mov_b32 a46, a110
 v_accvgpr_mov_b32 a47, a111
 v_accvgpr_mov_b32 a48, a112
 v_accvgpr_mov_b32 a49, a113
 v_accvgpr_mov_b32 a50, a114
 v_accvgpr_mov_b32 a51, a115
 v_accvgpr_mov_b32 a52, a116
 v_accvgpr_mov_b32 a53, a117
 v_accvgpr_mov_b32 a54, a118
 v_accvgpr_mov_b32 a55, a119
 v_accvgpr_mov_b32 a56, a120
 v_accvgpr_mov_b32 a57, a121
 v_accvgpr_mov_b32 a58, a122
 v_accvgpr_mov_b32 a59, a123
 v_accvgpr_mov_b32 a60, a124
 v_accvgpr_mov_b32 a61, a125
 v_accvgpr_mov_b32 a62, a126
 v_accvgpr_mov_b32 a63, a127
 s_branch Lablk_6
Laslow_7:
 s_waitcnt vmcnt(0) lgkmcnt(0)
 v_mov_b32 v12, 0
 v_mov_b32 v240, v4
 v_mov_b32 v13, 0
 v_mov_b32 v241, v4
 v_mov_b32 v14, 0
 v_mov_b32 v242, v4
 v_mov_b32 v15, 0
 v_mov_b32 v243, v4
 s_mov_b32 s49, 0
Lsl_14:
 s_lshl_b32 s37, s49, 19
 s_add_u32 s37, s37, s45
 s_sub_u32 s37, s37, s50
 s_add_u32 s44, s37, 0
 buffer_load_dwordx4 a[128:131], v1, s[20:23], s44 offen offset:0 sc1
 buffer_load_dwordx4 a[132:135], v1, s[20:23], s44 offen offset:1024 sc1
 buffer_load_dwordx4 a[136:139], v1, s[20:23], s44 offen offset:2048 sc1
 buffer_load_dwordx4 a[140:143], v1, s[20:23], s44 offen offset:3072 sc1
 s_add_u32 s44, s37, 4096
 buffer_load_dwordx4 a[144:147], v1, s[20:23], s44 offen offset:0 sc1
 buffer_load_dwordx4 a[148:151], v1, s[20:23], s44 offen offset:1024 sc1
 buffer_load_dwordx4 a[152:155], v1, s[20:23], s44 offen offset:2048 sc1
 buffer_load_dwordx4 a[156:159], v1, s[20:23], s44 offen offset:3072 sc1
 s_cmp_lt_u32 s49, s41
 s_cselect_b64 s[68:69], -1, 0
 s_cmp_le_u32 s49, s41
 s_cselect_b64 s[70:71], -1, 0
 s_cmp_eq_u32 s49, s41
 s_cselect_b64 s[60:61], s[52:53], s[68:69]
 s_cselect_b64 s[62:63], s[54:55], s[68:69]
 s_cselect_b64 s[64:65], s[56:57], s[68:69]
 s_cselect_b64 s[66:67], s[58:59], s[68:69]
 v_cndmask_b32 v80, v4, v12, s[60:61]
 v_cndmask_b32 v81, v4, v12, s[62:63]
 v_cndmask_b32 v82, v4, v12, s[64:65]
 v_cndmask_b32 v83, v4, v12, s[66:67]
 v_cndmask_b32 v84, v4, v12, s[68:69]
 v_cndmask_b32 v85, v4, v12, s[68:69]
 v_cndmask_b32 v86, v4, v12, s[68:69]
 v_cndmask_b32 v87, v4, v12, s[68:69]
 v_cndmask_b32 v88, v4, v13, s[70:71]
 v_cndmask_b32 v89, v4, v13, s[70:71]
 v_cndmask_b32 v90, v4, v13, s[70:71]
 v_cndmask_b32 v91, v4, v13, s[70:71]
 v_cndmask_b32 v92, v4, v13, s[60:61]
 v_cndmask_b32 v93, v4, v13, s[62:63]
 v_cndmask_b32 v94, v4, v13, s[64:65]
 v_cndmask_b32 v95, v4, v13, s[66:67]
 s_cmp_lt_u32 s49, s42
 s_cselect_b64 s[68:69], -1, 0
 s_cmp_le_u32 s49, s42
 s_cselect_b64 s[70:71], -1, 0
 s_cmp_eq_u32 s49, s42
 s_cselect_b64 s[60:61], s[52:53], s[68:69]
 s_cselect_b64 s[62:63], s[54:55], s[68:69]
 s_cselect_b64 s[64:65], s[56:57], s[68:69]
 s_cselect_b64 s[66:67], s[58:59], s[68:69]
 v_cndmask_b32 v96, v4, v14, s[60:61]
 v_cndmask_b32 v97, v4, v14, s[62:63]
 v_cndmask_b32 v98, v4, v14, s[64:65]
 v_cndmask_b32 v99, v4, v14, s[66:67]
 v_cndmask_b32 v100, v4, v14, s[68:69]
 v_cndmask_b32 v101, v4, v14, s[68:69]
 v_cndmask_b32 v102, v4, v14, s[68:69]
 v_cndmask_b32 v103, v4, v14, s[68:69]
 v_cndmask_b32 v104, v4, v15, s[70:71]
 v_cndmask_b32 v105, v4, v15, s[70:71]
 v_cndmask_b32 v106, v4, v15, s[70:71]
 v_cndmask_b32 v107, v4, v15, s[70:71]
 v_cndmask_b32 v108, v4, v15, s[60:61]
 v_cndmask_b32 v109, v4, v15, s[62:63]
 v_cndmask_b32 v110, v4, v15, s[64:65]
 v_cndmask_b32 v111, v4, v15, s[66:67]
 s_waitcnt vmcnt(0)
 s_nop 0
 v_mfma_f32_16x16x32_bf16 v[48:51], a[128:131], a[0:3], v[80:83]
 v_mfma_f32_16x16x32_bf16 v[56:59], a[128:131], a[16:19], v[88:91]
 v_mfma_f32_16x16x32_bf16 v[64:67], a[128:131], a[32:35], v[96:99]
 v_mfma_f32_16x16x32_bf16 v[72:75], a[128:131], a[48:51], v[104:107]
 v_mfma_f32_16x16x32_bf16 v[52:55], a[132:135], a[0:3], v[84:87]
 v_mfma_f32_16x16x32_bf16 v[60:63], a[132:135], a[16:19], v[92:95]
 v_mfma_f32_16x16x32_bf16 v[68:71], a[132:135], a[32:35], v[100:103]
 v_mfma_f32_16x16x32_bf16 v[76:79], a[132:135], a[48:51], v[108:111]
 v_mfma_f32_16x16x32_bf16 v[48:51], a[136:139], a[4:7], v[48:51]
 v_mfma_f32_16x16x32_bf16 v[56:59], a[136:139], a[20:23], v[56:59]
 v_mfma_f32_16x16x32_bf16 v[64:67], a[136:139], a[36:39], v[64:67]
 v_mfma_f32_16x16x32_bf16 v[72:75], a[136:139], a[52:55], v[72:75]
 v_mfma_f32_16x16x32_bf16 v[52:55], a[140:143], a[4:7], v[52:55]
 v_mfma_f32_16x16x32_bf16 v[60:63], a[140:143], a[20:23], v[60:63]
 v_mfma_f32_16x16x32_bf16 v[68:71], a[140:143], a[36:39], v[68:71]
 v_mfma_f32_16x16x32_bf16 v[76:79], a[140:143], a[52:55], v[76:79]
 v_mfma_f32_16x16x32_bf16 v[48:51], a[144:147], a[8:11], v[48:51]
 v_mfma_f32_16x16x32_bf16 v[56:59], a[144:147], a[24:27], v[56:59]
 v_mfma_f32_16x16x32_bf16 v[64:67], a[144:147], a[40:43], v[64:67]
 v_mfma_f32_16x16x32_bf16 v[72:75], a[144:147], a[56:59], v[72:75]
 v_mfma_f32_16x16x32_bf16 v[52:55], a[148:151], a[8:11], v[52:55]
 v_mfma_f32_16x16x32_bf16 v[60:63], a[148:151], a[24:27], v[60:63]
 v_mfma_f32_16x16x32_bf16 v[68:71], a[148:151], a[40:43], v[68:71]
 v_mfma_f32_16x16x32_bf16 v[76:79], a[148:151], a[56:59], v[76:79]
 v_mfma_f32_16x16x32_bf16 v[48:51], a[152:155], a[12:15], v[48:51]
 v_mfma_f32_16x16x32_bf16 v[56:59], a[152:155], a[28:31], v[56:59]
 v_mfma_f32_16x16x32_bf16 v[64:67], a[152:155], a[44:47], v[64:67]
 v_mfma_f32_16x16x32_bf16 v[72:75], a[152:155], a[60:63], v[72:75]
 v_mfma_f32_16x16x32_bf16 v[52:55], a[156:159], a[12:15], v[52:55]
 v_mfma_f32_16x16x32_bf16 v[60:63], a[156:159], a[28:31], v[60:63]
 v_mfma_f32_16x16x32_bf16 v[68:71], a[156:159], a[44:47], v[68:71]
 v_mfma_f32_16x16x32_bf16 v[76:79], a[156:159], a[60:63], v[76:79]
 s_nop 7
 v_max3_f32 v240, v240, v48, v49
 v_max3_f32 v240, v240, v50, v51
 v_max3_f32 v240, v240, v52, v53
 v_max3_f32 v240, v240, v54, v55
 v_max3_f32 v241, v241, v56, v57
 v_max3_f32 v241, v241, v58, v59
 v_max3_f32 v241, v241, v60, v61
 v_max3_f32 v241, v241, v62, v63
 v_max3_f32 v242, v242, v64, v65
 v_max3_f32 v242, v242, v66, v67
 v_max3_f32 v242, v242, v68, v69
 v_max3_f32 v242, v242, v70, v71
 v_max3_f32 v243, v243, v72, v73
 v_max3_f32 v243, v243, v74, v75
 v_max3_f32 v243, v243, v76, v77
 v_max3_f32 v243, v243, v78, v79
 s_add_u32 s49, s49, 1
 s_cmp_le_u32 s49, s42
 s_cbranch_scc1 Lsl_14
 v_mov_b32 v244, v240
 v_mov_b32 v245, v241
 v_mov_b32 v246, v242
 v_mov_b32 v247, v243
 v_permlane16_swap_b32 v240, v244
 v_permlane16_swap_b32 v241, v245
 v_permlane16_swap_b32 v242, v246
 v_permlane16_swap_b32 v243, v247
 v_max_f32 v240, v240, v244
 v_max_f32 v241, v241, v245
 v_max_f32 v242, v242, v246
 v_max_f32 v243, v243, v247
 v_mov_b32 v244, v240
 v_mov_b32 v245, v241
 v_mov_b32 v246, v242
 v_mov_b32 v247, v243
 v_permlane32_swap_b32 v240, v244
 v_permlane32_swap_b32 v241, v245
 v_permlane32_swap_b32 v242, v246
 v_permlane32_swap_b32 v243, v247
 v_max_f32 v240, v240, v244
 v_max_f32 v241, v241, v245
 v_max_f32 v242, v242, v246
 v_max_f32 v243, v243, v247
 v_sub_f32 v12, 0, v240
 v_sub_f32 v13, 0, v241
 v_sub_f32 v14, 0, v242
 v_sub_f32 v15, 0, v243
 v_mov_b64 v[112:113], 0
 v_mov_b64 v[114:115], 0
 v_mov_b64 v[116:117], 0
 v_mov_b64 v[118:119], 0
 v_mov_b64 v[120:121], 0
 v_mov_b64 v[122:123], 0
 v_mov_b64 v[124:125], 0
 v_mov_b64 v[126:127], 0
 v_mov_b64 v[128:129], 0
 v_mov_b64 v[130:131], 0
 v_mov_b64 v[132:133], 0
 v_mov_b64 v[134:135], 0
 v_mov_b64 v[136:137], 0
 v_mov_b64 v[138:139], 0
 v_mov_b64 v[140:141], 0
 v_mov_b64 v[142:143], 0
 v_mov_b64 v[144:145], 0
 v_mov_b64 v[146:147], 0
 v_mov_b64 v[148:149], 0
 v_mov_b64 v[150:151], 0
 v_mov_b64 v[152:153], 0
 v_mov_b64 v[154:155], 0
 v_mov_b64 v[156:157], 0
 v_mov_b64 v[158:159], 0
 v_mov_b64 v[160:161], 0
 v_mov_b64 v[162:163], 0
 v_mov_b64 v[164:165], 0
 v_mov_b64 v[166:167], 0
 v_mov_b64 v[168:169], 0
 v_mov_b64 v[170:171], 0
 v_mov_b64 v[172:173], 0
 v_mov_b64 v[174:175], 0
 v_mov_b64 v[176:177], 0
 v_mov_b64 v[178:179], 0
 v_mov_b64 v[180:181], 0
 v_mov_b64 v[182:183], 0
 v_mov_b64 v[184:185], 0
 v_mov_b64 v[186:187], 0
 v_mov_b64 v[188:189], 0
 v_mov_b64 v[190:191], 0
 v_mov_b64 v[192:193], 0
 v_mov_b64 v[194:195], 0
 v_mov_b64 v[196:197], 0
 v_mov_b64 v[198:199], 0
 v_mov_b64 v[200:201], 0
 v_mov_b64 v[202:203], 0
 v_mov_b64 v[204:205], 0
 v_mov_b64 v[206:207], 0
 v_mov_b64 v[208:209], 0
 v_mov_b64 v[210:211], 0
 v_mov_b64 v[212:213], 0
 v_mov_b64 v[214:215], 0
 v_mov_b64 v[216:217], 0
 v_mov_b64 v[218:219], 0
 v_mov_b64 v[220:221], 0
 v_mov_b64 v[222:223], 0
 v_mov_b64 v[224:225], 0
 v_mov_b64 v[226:227], 0
 v_mov_b64 v[228:229], 0
 v_mov_b64 v[230:231], 0
 v_mov_b64 v[232:233], 0
 v_mov_b64 v[234:235], 0
 v_mov_b64 v[236:237], 0
 v_mov_b64 v[238:239], 0
 v_mov_b64 v[32:33], 0
 v_mov_b64 v[34:35], 0
 v_mov_b64 v[36:37], 0
 v_mov_b64 v[38:39], 0
 v_mov_b64 v[40:41], 0
 v_mov_b64 v[42:43], 0
 v_mov_b64 v[44:45], 0
 v_mov_b64 v[46:47], 0
 s_mov_b32 s49, 0
Lsl_15:
 s_lshl_b32 s37, s49, 19
 s_add_u32 s37, s37, s45
 s_sub_u32 s37, s37, s50
 s_add_u32 s44, s37, 0
 buffer_load_dwordx4 a[128:131], v1, s[20:23], s44 offen offset:0 sc1
 buffer_load_dwordx4 a[132:135], v1, s[20:23], s44 offen offset:1024 sc1
 buffer_load_dwordx4 a[136:139], v1, s[20:23], s44 offen offset:2048 sc1
 buffer_load_dwordx4 a[140:143], v1, s[20:23], s44 offen offset:3072 sc1
 s_add_u32 s44, s37, 4096
 buffer_load_dwordx4 a[144:147], v1, s[20:23], s44 offen offset:0 sc1
 buffer_load_dwordx4 a[148:151], v1, s[20:23], s44 offen offset:1024 sc1
 buffer_load_dwordx4 a[152:155], v1, s[20:23], s44 offen offset:2048 sc1
 buffer_load_dwordx4 a[156:159], v1, s[20:23], s44 offen offset:3072 sc1
 s_add_u32 s44, s37, 8192
 buffer_load_dwordx4 a[160:163], v1, s[20:23], s44 offen offset:0 sc1
 buffer_load_dwordx4 a[164:167], v1, s[20:23], s44 offen offset:1024 sc1
 buffer_load_dwordx4 a[168:171], v1, s[20:23], s44 offen offset:2048 sc1
 buffer_load_dwordx4 a[172:175], v1, s[20:23], s44 offen offset:3072 sc1
 s_add_u32 s44, s37, 12288
 buffer_load_dwordx4 a[176:179], v1, s[20:23], s44 offen offset:0 sc1
 buffer_load_dwordx4 a[180:183], v1, s[20:23], s44 offen offset:1024 sc1
 buffer_load_dwordx4 a[184:187], v1, s[20:23], s44 offen offset:2048 sc1
 buffer_load_dwordx4 a[188:191], v1, s[20:23], s44 offen offset:3072 sc1
 s_cmp_lt_u32 s49, s41
 s_cselect_b64 s[68:69], -1, 0
 s_cmp_le_u32 s49, s41
 s_cselect_b64 s[70:71], -1, 0
 s_cmp_eq_u32 s49, s41
 s_cselect_b64 s[60:61], s[52:53], s[68:69]
 s_cselect_b64 s[62:63], s[54:55], s[68:69]
 s_cselect_b64 s[64:65], s[56:57], s[68:69]
 s_cselect_b64 s[66:67], s[58:59], s[68:69]
 v_cndmask_b32 v80, v4, v12, s[60:61]
 v_cndmask_b32 v81, v4, v12, s[62:63]
 v_cndmask_b32 v82, v4, v12, s[64:65]
 v_cndmask_b32 v83, v4, v12, s[66:67]
 v_cndmask_b32 v84, v4, v12, s[68:69]
 v_cndmask_b32 v85, v4, v12, s[68:69]
 v_cndmask_b32 v86, v4, v12, s[68:69]
 v_cndmask_b32 v87, v4, v12, s[68:69]
 v_cndmask_b32 v88, v4, v13, s[70:71]
 v_cndmask_b32 v89, v4, v13, s[70:71]
 v_cndmask_b32 v90, v4, v13, s[70:71]
 v_cndmask_b32 v91, v4, v13, s[70:71]
 v_cndmask_b32 v92, v4, v13, s[60:61]
 v_cndmask_b32 v93, v4, v13, s[62:63]
 v_cndmask_b32 v94, v4, v13, s[64:65]
 v_cndmask_b32 v95, v4, v13, s[66:67]
 s_cmp_lt_u32 s49, s42
 s_cselect_b64 s[68:69], -1, 0
 s_cmp_le_u32 s49, s42
 s_cselect_b64 s[70:71], -1, 0
 s_cmp_eq_u32 s49, s42
 s_cselect_b64 s[60:61], s[52:53], s[68:69]
 s_cselect_b64 s[62:63], s[54:55], s[68:69]
 s_cselect_b64 s[64:65], s[56:57], s[68:69]
 s_cselect_b64 s[66:67], s[58:59], s[68:69]
 v_cndmask_b32 v96, v4, v14, s[60:61]
 v_cndmask_b32 v97, v4, v14, s[62:63]
 v_cndmask_b32 v98, v4, v14, s[64:65]
 v_cndmask_b32 v99, v4, v14, s[66:67]
 v_cndmask_b32 v100, v4, v14, s[68:69]
 v_cndmask_b32 v101, v4, v14, s[68:69]
 v_cndmask_b32 v102, v4, v14, s[68:69]
 v_cndmask_b32 v103, v4, v14, s[68:69]
 v_cndmask_b32 v104, v4, v15, s[70:71]
 v_cndmask_b32 v105, v4, v15, s[70:71]
 v_cndmask_b32 v106, v4, v15, s[70:71]
 v_cndmask_b32 v107, v4, v15, s[70:71]
 v_cndmask_b32 v108, v4, v15, s[60:61]
 v_cndmask_b32 v109, v4, v15, s[62:63]
 v_cndmask_b32 v110, v4, v15, s[64:65]
 v_cndmask_b32 v111, v4, v15, s[66:67]
 s_waitcnt vmcnt(0)
 s_nop 0
 v_mfma_f32_16x16x32_bf16 v[48:51], a[128:131], a[0:3], v[80:83]
 v_mfma_f32_16x16x32_bf16 v[56:59], a[128:131], a[16:19], v[88:91]
 v_mfma_f32_16x16x32_bf16 v[64:67], a[128:131], a[32:35], v[96:99]
 v_mfma_f32_16x16x32_bf16 v[72:75], a[128:131], a[48:51], v[104:107]
 v_mfma_f32_16x16x32_bf16 v[52:55], a[132:135], a[0:3], v[84:87]
 v_mfma_f32_16x16x32_bf16 v[60:63], a[132:135], a[16:19], v[92:95]
 v_mfma_f32_16x16x32_bf16 v[68:71], a[132:135], a[32:35], v[100:103]
 v_mfma_f32_16x16x32_bf16 v[76:79], a[132:135], a[48:51], v[108:111]
 v_mfma_f32_16x16x32_bf16 v[48:51], a[136:139], a[4:7], v[48:51]
 v_mfma_f32_16x16x32_bf16 v[56:59], a[136:139], a[20:23], v[56:59]
 v_mfma_f32_16x16x32_bf16 v[64:67], a[136:139], a[36:39], v[64:67]
 v_mfma_f32_16x16x32_bf16 v[72:75], a[136:139], a[52:55], v[72:75]
 v_mfma_f32_16x16x32_bf16 v[52:55], a[140:143], a[4:7], v[52:55]
 v_mfma_f32_16x16x32_bf16 v[60:63], a[140:143], a[20:23], v[60:63]
 v_mfma_f32_16x16x32_bf16 v[68:71], a[140:143], a[36:39], v[68:71]
 v_mfma_f32_16x16x32_bf16 v[76:79], a[140:143], a[52:55], v[76:79]
 v_mfma_f32_16x16x32_bf16 v[48:51], a[144:147], a[8:11], v[48:51]
 v_mfma_f32_16x16x32_bf16 v[56:59], a[144:147], a[24:27], v[56:59]
 v_mfma_f32_16x16x32_bf16 v[64:67], a[144:147], a[40:43], v[64:67]
 v_mfma_f32_16x16x32_bf16 v[72:75], a[144:147], a[56:59], v[72:75]
 v_mfma_f32_16x16x32_bf16 v[52:55], a[148:151], a[8:11], v[52:55]
 v_mfma_f32_16x16x32_bf16 v[60:63], a[148:151], a[24:27], v[60:63]
 v_mfma_f32_16x16x32_bf16 v[68:71], a[148:151], a[40:43], v[68:71]
 v_mfma_f32_16x16x32_bf16 v[76:79], a[148:151], a[56:59], v[76:79]
 v_mfma_f32_16x16x32_bf16 v[48:51], a[152:155], a[12:15], v[48:51]
 v_mfma_f32_16x16x32_bf16 v[56:59], a[152:155], a[28:31], v[56:59]
 v_mfma_f32_16x16x32_bf16 v[64:67], a[152:155], a[44:47], v[64:67]
 v_mfma_f32_16x16x32_bf16 v[72:75], a[152:155], a[60:63], v[72:75]
 v_mfma_f32_16x16x32_bf16 v[52:55], a[156:159], a[12:15], v[52:55]
 v_mfma_f32_16x16x32_bf16 v[60:63], a[156:159], a[28:31], v[60:63]
 v_mfma_f32_16x16x32_bf16 v[68:71], a[156:159], a[44:47], v[68:71]
 v_mfma_f32_16x16x32_bf16 v[76:79], a[156:159], a[60:63], v[76:79]
 s_nop 7
 v_exp_f32 v48, v48
 v_exp_f32 v49, v49
 v_exp_f32 v52, v52
 v_exp_f32 v53, v53
 v_exp_f32 v50, v50
 v_cvt_pk_bf16_f32 v16, v48, v49
 v_cvt_pk_bf16_f32 v17, v52, v53
 v_exp_f32 v51, v51
 v_exp_f32 v54, v54
 v_exp_f32 v55, v55
 v_cvt_pk_bf16_f32 v18, v50, v51
 v_cvt_pk_bf16_f32 v19, v54, v55
 v_exp_f32 v56, v56
 v_exp_f32 v57, v57
 v_exp_f32 v60, v60
 v_exp_f32 v61, v61
 v_exp_f32 v58, v58
 v_cvt_pk_bf16_f32 v20, v56, v57
 v_cvt_pk_bf16_f32 v21, v60, v61
 v_exp_f32 v59, v59
 v_exp_f32 v62, v62
 v_exp_f32 v63, v63
 v_cvt_pk_bf16_f32 v22, v58, v59
 v_cvt_pk_bf16_f32 v23, v62, v63
 v_exp_f32 v64, v64
 v_exp_f32 v65, v65
 v_exp_f32 v68, v68
 v_exp_f32 v69, v69
 v_exp_f32 v66, v66
 v_cvt_pk_bf16_f32 v24, v64, v65
 v_cvt_pk_bf16_f32 v25, v68, v69
 v_exp_f32 v67, v67
 v_exp_f32 v70, v70
 v_exp_f32 v71, v71
 v_cvt_pk_bf16_f32 v26, v66, v67
 v_cvt_pk_bf16_f32 v27, v70, v71
 v_exp_f32 v72, v72
 v_exp_f32 v73, v73
 v_exp_f32 v76, v76
 v_exp_f32 v77, v77
 v_exp_f32 v74, v74
 v_cvt_pk_bf16_f32 v28, v72, v73
 v_cvt_pk_bf16_f32 v29, v76, v77
 v_exp_f32 v75, v75
 v_exp_f32 v78, v78
 v_exp_f32 v79, v79
 v_cvt_pk_bf16_f32 v30, v74, v75
 v_cvt_pk_bf16_f32 v31, v78, v79
 s_nop 1
 v_mfma_f32_16x16x32_bf16 v[112:115], a[160:163], v[16:19], v[112:115]
 v_mfma_f32_16x16x32_bf16 v[144:147], a[160:163], v[20:23], v[144:147]
 v_mfma_f32_16x16x32_bf16 v[176:179], a[160:163], v[24:27], v[176:179]
 v_mfma_f32_16x16x32_bf16 v[208:211], a[160:163], v[28:31], v[208:211]
 v_mfma_f32_16x16x32_bf16 v[116:119], a[164:167], v[16:19], v[116:119]
 v_mfma_f32_16x16x32_bf16 v[148:151], a[164:167], v[20:23], v[148:151]
 v_mfma_f32_16x16x32_bf16 v[180:183], a[164:167], v[24:27], v[180:183]
 v_mfma_f32_16x16x32_bf16 v[212:215], a[164:167], v[28:31], v[212:215]
 v_mfma_f32_16x16x32_bf16 v[120:123], a[168:171], v[16:19], v[120:123]
 v_mfma_f32_16x16x32_bf16 v[152:155], a[168:171], v[20:23], v[152:155]
 v_mfma_f32_16x16x32_bf16 v[184:187], a[168:171], v[24:27], v[184:187]
 v_mfma_f32_16x16x32_bf16 v[216:219], a[168:171], v[28:31], v[216:219]
 v_mfma_f32_16x16x32_bf16 v[124:127], a[172:175], v[16:19], v[124:127]
 v_mfma_f32_16x16x32_bf16 v[156:159], a[172:175], v[20:23], v[156:159]
 v_mfma_f32_16x16x32_bf16 v[188:191], a[172:175], v[24:27], v[188:191]
 v_mfma_f32_16x16x32_bf16 v[220:223], a[172:175], v[28:31], v[220:223]
 v_mfma_f32_16x16x32_bf16 v[128:131], a[176:179], v[16:19], v[128:131]
 v_mfma_f32_16x16x32_bf16 v[160:163], a[176:179], v[20:23], v[160:163]
 v_mfma_f32_16x16x32_bf16 v[192:195], a[176:179], v[24:27], v[192:195]
 v_mfma_f32_16x16x32_bf16 v[224:227], a[176:179], v[28:31], v[224:227]
 v_mfma_f32_16x16x32_bf16 v[132:135], a[180:183], v[16:19], v[132:135]
 v_mfma_f32_16x16x32_bf16 v[164:167], a[180:183], v[20:23], v[164:167]
 v_mfma_f32_16x16x32_bf16 v[196:199], a[180:183], v[24:27], v[196:199]
 v_mfma_f32_16x16x32_bf16 v[228:231], a[180:183], v[28:31], v[228:231]
 v_mfma_f32_16x16x32_bf16 v[136:139], a[184:187], v[16:19], v[136:139]
 v_mfma_f32_16x16x32_bf16 v[168:171], a[184:187], v[20:23], v[168:171]
 v_mfma_f32_16x16x32_bf16 v[200:203], a[184:187], v[24:27], v[200:203]
 v_mfma_f32_16x16x32_bf16 v[232:235], a[184:187], v[28:31], v[232:235]
 v_mfma_f32_16x16x32_bf16 v[140:143], a[188:191], v[16:19], v[140:143]
 v_mfma_f32_16x16x32_bf16 v[172:175], a[188:191], v[20:23], v[172:175]
 v_mfma_f32_16x16x32_bf16 v[204:207], a[188:191], v[24:27], v[204:207]
 v_mfma_f32_16x16x32_bf16 v[236:239], a[188:191], v[28:31], v[236:239]
 v_mfma_f32_16x16x32_bf16 v[32:35], a[192:195], v[16:19], v[32:35]
 v_mfma_f32_16x16x32_bf16 v[36:39], a[192:195], v[20:23], v[36:39]
 v_mfma_f32_16x16x32_bf16 v[40:43], a[192:195], v[24:27], v[40:43]
 v_mfma_f32_16x16x32_bf16 v[44:47], a[192:195], v[28:31], v[44:47]
 s_add_u32 s49, s49, 1
 s_cmp_le_u32 s49, s42
 s_cbranch_scc1 Lsl_15
 ds_read_b128 a[128:131], v3 offset:0
 ds_read_b128 a[132:135], v3 offset:1024
 ds_read_b128 a[136:139], v3 offset:2048
 ds_read_b128 a[140:143], v3 offset:3072
 ds_read_b128 a[144:147], v3 offset:4096
 ds_read_b128 a[148:151], v3 offset:5120
 ds_read_b128 a[152:155], v3 offset:6144
 ds_read_b128 a[156:159], v3 offset:7168
 s_branch Laback_8
Ladone_9:
 s_waitcnt vmcnt(0) lgkmcnt(0)
 s_barrier
 v_mov_b32 v6, 1
 buffer_store_dword v6, v5, s[20:23], s72 offen sc1
 s_cmp_ge_u32 s6, 27
 s_cbranch_scc1 Lfin
 s_load_dwordx2 s[8:9], s[0:1], 40
 s_mov_b32 s10, 0x480000
 s_mov_b32 s11, 0x20000
 s_mul_i32 s7, s6, 29
 s_lshr_b32 s7, s7, 8
 s_mul_i32 s94, s7, 9
 s_sub_u32 s32, s6, s94
 s_mul_i32 s40, s7, 3
 s_lshl_b32 s7, s7, 2
 s_add_u32 s7, s7, s5
 s_sub_u32 s33, s7, 4
 s_mov_b32 s34, 12
 s_cmp_lt_u32 s33, 4
 s_cselect_b32 s35, 6, 5
 s_mov_b32 s36, 0x6000000
 s_mov_b32 s37, 0
 s_lshl_b32 s38, s4, 5
 s_add_u32 s38, s38, 0x3c00
 s_mov_b32 s39, 0
 s_mov_b32 s93, 0x38
 s_mov_b32 s92, 7
 s_mov_b32 s91, 4
 s_mov_b32 s90, 31
 s_branch Los
Lpb:
 s_load_dwordx2 s[8:9], s[0:1], 48
 s_mov_b32 s10, 0x240000
 s_mov_b32 s11, 0x20000
 s_load_dwordx2 s[12:13], s[0:1], 72
 s_mov_b32 s14, 0x480000
 s_mov_b32 s15, 0x20000
 s_load_dwordx2 s[16:17], s[0:1], 80
 s_mov_b32 s18, 0x480000
 s_mov_b32 s19, 0x20000
 s_lshl_b32 s32, s6, 8
 s_mov_b32 s33, s32
 s_lshl_b32 s34, s6, 14
 s_add_u32 s34, s34, 0x3000000
 s_add_u32 s35, s34, 8192
 s_mov_b32 s36, 64
 s_mov_b32 s37, 0
 s_lshl_b32 s7, s6, 7
 s_add_u32 s7, s7, 0x0
 v_min_u32 v1, 1, v0
 v_lshlrev_b32 v1, 28, v1
 v_add_u32 v13, s7, v1
 s_waitcnt lgkmcnt(0)
 v_and_b32 v1, 63, v0
 v_lshrrev_b32 v2, 3, v0
 v_mul_u32_u24 v10, 1152, v2
 v_lshrrev_b32 v2, 4, v0
 v_xor_b32 v2, v2, v0
 v_and_b32 v2, 7, v2
 v_lshl_add_u32 v10, v2, 4, v10
 v_lshrrev_b32 v2, 4, v1
 v_bfe_u32 v3, v1, 1, 3
 v_xor_b32 v2, v2, v3
 v_and_b32 v3, 15, v1
 v_lshlrev_b32 v3, 7, v3
 v_lshl_add_u32 v4, v2, 4, v3
 v_xor_b32 v5, 64, v4
 v_lshrrev_b32 v2, 4, v0
 v_lshlrev_b32 v11, 13, v2
 v_lshrrev_b32 v2, 7, v0
 v_lshrrev_b32 v3, 4, v1
 v_lshl_add_u32 v3, v2, 2, v3
 v_bfe_u32 v2, v1, 1, 3
 v_xor_b32 v2, v2, v3
 v_lshl_add_u32 v11, v2, 5, v11
 v_and_b32 v2, 1, v1
 v_lshl_add_u32 v11, v2, 4, v11
 v_bfe_u32 v2, v1, 2, 3
 v_xor_b32 v3, s4, v2
 v_lshlrev_b32 v3, 5, v3
 v_and_b32 v2, 3, v2
 v_lshl_add_u32 v3, v2, 8, v3
 v_lshrrev_b32 v2, 4, v1
 v_lshl_add_u32 v3, v2, 11, v3
 v_and_b32 v2, 3, v1
 v_lshl_add_u32 v3, v2, 3, v3
 v_add_u32 v8, 73728, v3
 v_xor_b32 v3, 0x80, v3
 v_add_u32 v9, 73728, v3
 s_lshl_b32 s45, s4, 11
 v_lshl_add_u32 v12, v1, 4, s45
 s_mov_b32 s39, s37
 s_add_u32 s40, s39, 1
 s_lshl_b32 s49, s4, 10
 s_mul_i32 s46, s39, 36864
 s_add_u32 m0, s49, 0
 s_nop 0
 buffer_load_dwordx4 v10, s[8:11], s46 offen offset:0  lds
 s_add_u32 m0, s49, 3968
 s_nop 0
 buffer_load_dwordx4 v10, s[8:11], s46 offen offset:128  lds
 s_add_u32 m0, s49, 7936
 s_nop 0
 buffer_load_dwordx4 v10, s[8:11], s46 offen offset:256  lds
 s_add_u32 m0, s49, 11904
 s_nop 0
 buffer_load_dwordx4 v10, s[8:11], s46 offen offset:384  lds
 s_add_u32 m0, s49, 15872
 s_nop 0
 buffer_load_dwordx4 v10, s[8:11], s46 offen offset:512  lds
 s_add_u32 m0, s49, 19840
 s_nop 0
 buffer_load_dwordx4 v10, s[8:11], s46 offen offset:640  lds
 s_add_u32 m0, s49, 23808
 s_nop 0
 buffer_load_dwordx4 v10, s[8:11], s46 offen offset:768  lds
 s_add_u32 m0, s49, 27776
 s_nop 0
 buffer_load_dwordx4 v10, s[8:11], s46 offen offset:896  lds
 s_add_u32 m0, s49, 31744
 s_nop 0
 buffer_load_dwordx4 v10, s[8:11], s46 offen offset:1024  lds
 s_lshl_b32 s49, s4, 10
 s_add_u32 s49, s49, 36864
 s_mul_i32 s46, s40, 36864
 s_add_u32 m0, s49, 0
 s_nop 0
 buffer_load_dwordx4 v10, s[8:11], s46 offen offset:0  lds
 s_add_u32 m0, s49, 3968
 s_nop 0
 buffer_load_dwordx4 v10, s[8:11], s46 offen offset:128  lds
 s_add_u32 m0, s49, 7936
 s_nop 0
 buffer_load_dwordx4 v10, s[8:11], s46 offen offset:256  lds
 s_add_u32 m0, s49, 11904
 s_nop 0
 buffer_load_dwordx4 v10, s[8:11], s46 offen offset:384  lds
 s_add_u32 m0, s49, 15872
 s_nop 0
 buffer_load_dwordx4 v10, s[8:11], s46 offen offset:512  lds
 s_add_u32 m0, s49, 19840
 s_nop 0
 buffer_load_dwordx4 v10, s[8:11], s46 offen offset:640  lds
 s_add_u32 m0, s49, 23808
 s_nop 0
 buffer_load_dwordx4 v10, s[8:11], s46 offen offset:768  lds
 s_add_u32 m0, s49, 27776
 s_nop 0
 buffer_load_dwordx4 v10, s[8:11], s46 offen offset:896  lds
 s_add_u32 m0, s49, 31744
 s_nop 0
 buffer_load_dwordx4 v10, s[8:11], s46 offen offset:1024  lds
 s_lshl_b32 s49, s4, 10
 s_add_u32 m0, s49, 73728
 s_add_u32 s45, s32, 0
 buffer_load_dwordx4 v11, s[12:15], s45 offen  lds
 s_add_u32 m0, s49, 77824
 s_add_u32 s45, s32, 131072
 buffer_load_dwordx4 v11, s[12:15], s45 offen  lds
 s_add_u32 m0, s49, 81920
 s_add_u32 s45, s33, 0
 buffer_load_dwordx4 v11, s[16:19], s45 offen  lds
 s_add_u32 m0, s49, 86016
 s_add_u32 s45, s33, 131072
 buffer_load_dwordx4 v11, s[16:19], s45 offen  lds
 s_add_u32 m0, s49, 90112
 s_add_u32 s45, s32, 262144
 buffer_load_dwordx4 v11, s[12:15], s45 offen  lds
 s_add_u32 m0, s49, 94208
 s_add_u32 s45, s32, 393216
 buffer_load_dwordx4 v11, s[12:15], s45 offen  lds
 s_add_u32 m0, s49, 98304
 s_add_u32 s45, s33, 262144
 buffer_load_dwordx4 v11, s[16:19], s45 offen  lds
 s_add_u32 m0, s49, 102400
 s_add_u32 s45, s33, 393216
 buffer_load_dwordx4 v11, s[16:19], s45 offen  lds
 s_add_u32 m0, s49, 106496
 s_add_u32 s45, s32, 524288
 buffer_load_dwordx4 v11, s[12:15], s45 offen  lds
 s_add_u32 m0, s49, 110592
 s_add_u32 s45, s32, 655360
 buffer_load_dwordx4 v11, s[12:15], s45 offen  lds
 s_add_u32 m0, s49, 114688
 s_add_u32 s45, s33, 524288
 buffer_load_dwordx4 v11, s[16:19], s45 offen  lds
 s_add_u32 m0, s49, 118784
 s_add_u32 s45, s33, 655360
 buffer_load_dwordx4 v11, s[16:19], s45 offen  lds
 s_waitcnt vmcnt(8) lgkmcnt(0)
 s_barrier
 s_add_u32 m0, s49, 122880
 s_add_u32 s45, s32, 786432
 buffer_load_dwordx4 v11, s[12:15], s45 offen  lds
 s_add_u32 m0, s49, 126976
 s_add_u32 s45, s32, 917504
 buffer_load_dwordx4 v11, s[12:15], s45 offen  lds
 s_add_u32 m0, s49, 131072
 s_add_u32 s45, s33, 786432
 buffer_load_dwordx4 v11, s[16:19], s45 offen  lds
 s_add_u32 m0, s49, 135168
 s_add_u32 s45, s33, 917504
 buffer_load_dwordx4 v11, s[16:19], s45 offen  lds
 ds_read_b64_tr_b16 a[0:1], v8 offset:0
 ds_read_b64_tr_b16 a[2:3], v8 offset:1024
 ds_read_b64_tr_b16 a[72:73], v9 offset:0
 ds_read_b64_tr_b16 a[74:75], v9 offset:1024
 ds_read_b64_tr_b16 a[144:145], v8 offset:8192
 ds_read_b64_tr_b16 a[146:147], v8 offset:9216
 ds_read_b64_tr_b16 a[216:217], v9 offset:8192
 ds_read_b64_tr_b16 a[218:219], v9 offset:9216
 s_waitcnt vmcnt(8) lgkmcnt(0)
 s_barrier
 s_add_u32 m0, s49, 73728
 s_add_u32 s45, s32, 1048576
 buffer_load_dwordx4 v11, s[12:15], s45 offen  lds
 s_add_u32 m0, s49, 77824
 s_add_u32 s45, s32, 1179648
 buffer_load_dwordx4 v11, s[12:15], s45 offen  lds
 s_add_u32 m0, s49, 81920
 s_add_u32 s45, s33, 1048576
 buffer_load_dwordx4 v11, s[16:19], s45 offen  lds
 s_add_u32 m0, s49, 86016
 s_add_u32 s45, s33, 1179648
 buffer_load_dwordx4 v11, s[16:19], s45 offen  lds
 ds_read_b64_tr_b16 a[4:5], v8 offset:16384
 ds_read_b64_tr_b16 a[6:7], v8 offset:17408
 ds_read_b64_tr_b16 a[76:77], v9 offset:16384
 ds_read_b64_tr_b16 a[78:79], v9 offset:17408
 ds_read_b64_tr_b16 a[148:149], v8 offset:24576
 ds_read_b64_tr_b16 a[150:151], v8 offset:25600
 ds_read_b64_tr_b16 a[220:221], v9 offset:24576
 ds_read_b64_tr_b16 a[222:223], v9 offset:25600
 s_waitcnt vmcnt(8) lgkmcnt(0)
 s_barrier
 s_add_u32 m0, s49, 90112
 s_add_u32 s45, s32, 1310720
 buffer_load_dwordx4 v11, s[12:15], s45 offen  lds
 s_add_u32 m0, s49, 94208
 s_add_u32 s45, s32, 1441792
 buffer_load_dwordx4 v11, s[12:15], s45 offen  lds
 s_add_u32 m0, s49, 98304
 s_add_u32 s45, s33, 1310720
 buffer_load_dwordx4 v11, s[16:19], s45 offen  lds
 s_add_u32 m0, s49, 102400
 s_add_u32 s45, s33, 1441792
 buffer_load_dwordx4 v11, s[16:19], s45 offen  lds
 ds_read_b64_tr_b16 a[8:9], v8 offset:32768
 ds_read_b64_tr_b16 a[10:11], v8 offset:33792
 ds_read_b64_tr_b16 a[80:81], v9 offset:32768
 ds_read_b64_tr_b16 a[82:83], v9 offset:33792
 ds_read_b64_tr_b16 a[152:153], v8 offset:40960
 ds_read_b64_tr_b16 a[154:155], v8 offset:41984
 ds_read_b64_tr_b16 a[224:225], v9 offset:40960
 ds_read_b64_tr_b16 a[226:227], v9 offset:41984
 s_waitcnt vmcnt(8) lgkmcnt(0)
 s_barrier
 s_add_u32 m0, s49, 106496
 s_add_u32 s45, s32, 1572864
 buffer_load_dwordx4 v11, s[12:15], s45 offen  lds
 s_add_u32 m0, s49, 110592
 s_add_u32 s45, s32, 1703936
 buffer_load_dwordx4 v11, s[12:15], s45 offen  lds
 s_add_u32 m0, s49, 114688
 s_add_u32 s45, s33, 1572864
 buffer_load_dwordx4 v11, s[16:19], s45 offen  lds
 s_add_u32 m0, s49, 118784
 s_add_u32 s45, s33, 1703936
 buffer_load_dwordx4 v11, s[16:19], s45 offen  lds
 ds_read_b64_tr_b16 a[12:13], v8 offset:49152
 ds_read_b64_tr_b16 a[14:15], v8 offset:50176
 ds_read_b64_tr_b16 a[84:85], v9 offset:49152
 ds_read_b64_tr_b16 a[86:87], v9 offset:50176
 ds_read_b64_tr_b16 a[156:157], v8 offset:57344
 ds_read_b64_tr_b16 a[158:159], v8 offset:58368
 ds_read_b64_tr_b16 a[228:229], v9 offset:57344
 ds_read_b64_tr_b16 a[230:231], v9 offset:58368
 s_waitcnt vmcnt(8) lgkmcnt(0)
 s_barrier
 s_add_u32 m0, s49, 122880
 s_add_u32 s45, s32, 1835008
 buffer_load_dwordx4 v11, s[12:15], s45 offen  lds
 s_add_u32 m0, s49, 126976
 s_add_u32 s45, s32, 1966080
 buffer_load_dwordx4 v11, s[12:15], s45 offen  lds
 s_add_u32 m0, s49, 131072
 s_add_u32 s45, s33, 1835008
 buffer_load_dwordx4 v11, s[16:19], s45 offen  lds
 s_add_u32 m0, s49, 135168
 s_add_u32 s45, s33, 1966080
 buffer_load_dwordx4 v11, s[16:19], s45 offen  lds
 ds_read_b64_tr_b16 a[16:17], v8 offset:0
 ds_read_b64_tr_b16 a[18:19], v8 offset:1024
 ds_read_b64_tr_b16 a[88:89], v9 offset:0
 ds_read_b64_tr_b16 a[90:91], v9 offset:1024
 ds_read_b64_tr_b16 a[160:161], v8 offset:8192
 ds_read_b64_tr_b16 a[162:163], v8 offset:9216
 ds_read_b64_tr_b16 a[232:233], v9 offset:8192
 ds_read_b64_tr_b16 a[234:235], v9 offset:9216
 s_waitcnt vmcnt(8) lgkmcnt(0)
 s_barrier
 s_add_u32 m0, s49, 73728
 s_add_u32 s45, s32, 2097152
 buffer_load_dwordx4 v11, s[12:15], s45 offen  lds
 s_add_u32 m0, s49, 77824
 s_add_u32 s45, s32, 2228224
 buffer_load_dwordx4 v11, s[12:15], s45 offen  lds
 s_add_u32 m0, s49, 81920
 s_add_u32 s45, s33, 2097152
 buffer_load_dwordx4 v11, s[16:19], s45 offen  lds
 s_add_u32 m0, s49, 86016
 s_add_u32 s45, s33, 2228224
 buffer_load_dwordx4 v11, s[16:19], s45 offen  lds
 ds_read_b64_tr_b16 a[20:21], v8 offset:16384
 ds_read_b64_tr_b16 a[22:23], v8 offset:17408
 ds_read_b64_tr_b16 a[92:93], v9 offset:16384
 ds_read_b64_tr_b16 a[94:95], v9 offset:17408
 ds_read_b64_tr_b16 a[164:165], v8 offset:24576
 ds_read_b64_tr_b16 a[166:167], v8 offset:25600
 ds_read_b64_tr_b16 a[236:237], v9 offset:24576
 ds_read_b64_tr_b16 a[238:239], v9 offset:25600
 s_waitcnt vmcnt(8) lgkmcnt(0)
 s_barrier
 s_add_u32 m0, s49, 90112
 s_add_u32 s45, s32, 2359296
 buffer_load_dwordx4 v11, s[12:15], s45 offen  lds
 s_add_u32 m0, s49, 94208
 s_add_u32 s45, s32, 2490368
 buffer_load_dwordx4 v11, s[12:15], s45 offen  lds
 s_add_u32 m0, s49, 98304
 s_add_u32 s45, s33, 2359296
 buffer_load_dwordx4 v11, s[16:19], s45 offen  lds
 s_add_u32 m0, s49, 102400
 s_add_u32 s45, s33, 2490368
 buffer_load_dwordx4 v11, s[16:19], s45 offen  lds
 ds_read_b64_tr_b16 a[24:25], v8 offset:32768
 ds_read_b64_tr_b16 a[26:27], v8 offset:33792
 ds_read_b64_tr_b16 a[96:97], v9 offset:32768
 ds_read_b64_tr_b16 a[98:99], v9 offset:33792
 ds_read_b64_tr_b16 a[168:169], v8 offset:40960
 ds_read_b64_tr_b16 a[170:171], v8 offset:41984
 ds_read_b64_tr_b16 a[240:241], v9 offset:40960
 ds_read_b64_tr_b16 a[242:243], v9 offset:41984
 s_waitcnt vmcnt(8) lgkmcnt(0)
 s_barrier
 s_add_u32 m0, s49, 106496
 s_add_u32 s45, s32, 2621440
 buffer_load_dwordx4 v11, s[12:15], s45 offen  lds
 s_add_u32 m0, s49, 110592
 s_add_u32 s45, s32, 2752512
 buffer_load_dwordx4 v11, s[12:15], s45 offen  lds
 s_add_u32 m0, s49, 114688
 s_add_u32 s45, s33, 2621440
 buffer_load_dwordx4 v11, s[16:19], s45 offen  lds
 s_add_u32 m0, s49, 118784
 s_add_u32 s45, s33, 2752512
 buffer_load_dwordx4 v11, s[16:19], s45 offen  lds
 ds_read_b64_tr_b16 a[28:29], v8 offset:49152
 ds_read_b64_tr_b16 a[30:31], v8 offset:50176
 ds_read_b64_tr_b16 a[100:101], v9 offset:49152
 ds_read_b64_tr_b16 a[102:103], v9 offset:50176
 ds_read_b64_tr_b16 a[172:173], v8 offset:57344
 ds_read_b64_tr_b16 a[174:175], v8 offset:58368
 ds_read_b64_tr_b16 a[244:245], v9 offset:57344
 ds_read_b64_tr_b16 a[246:247], v9 offset:58368
 s_waitcnt vmcnt(8) lgkmcnt(0)
 s_barrier
 s_add_u32 m0, s49, 122880
 s_add_u32 s45, s32, 2883584
 buffer_load_dwordx4 v11, s[12:15], s45 offen  lds
 s_add_u32 m0, s49, 126976
 s_add_u32 s45, s32, 3014656
 buffer_load_dwordx4 v11, s[12:15], s45 offen  lds
 s_add_u32 m0, s49, 131072
 s_add_u32 s45, s33, 2883584
 buffer_load_dwordx4 v11, s[16:19], s45 offen  lds
 s_add_u32 m0, s49, 135168
 s_add_u32 s45, s33, 3014656
 buffer_load_dwordx4 v11, s[16:19], s45 offen  lds
 ds_read_b64_tr_b16 a[32:33], v8 offset:0
 ds_read_b64_tr_b16 a[34:35], v8 offset:1024
 ds_read_b64_tr_b16 a[104:105], v9 offset:0
 ds_read_b64_tr_b16 a[106:107], v9 offset:1024
 ds_read_b64_tr_b16 a[176:177], v8 offset:8192
 ds_read_b64_tr_b16 a[178:179], v8 offset:9216
 ds_read_b64_tr_b16 a[248:249], v9 offset:8192
 ds_read_b64_tr_b16 a[250:251], v9 offset:9216
 s_waitcnt vmcnt(8) lgkmcnt(0)
 s_barrier
 s_add_u32 m0, s49, 73728
 s_add_u32 s45, s32, 3145728
 buffer_load_dwordx4 v11, s[12:15], s45 offen  lds
 s_add_u32 m0, s49, 77824
 s_add_u32 s45, s32, 3276800
 buffer_load_dwordx4 v11, s[12:15], s45 offen  lds
 s_add_u32 m0, s49, 81920
 s_add_u32 s45, s33, 3145728
 buffer_load_dwordx4 v11, s[16:19], s45 offen  lds
 s_add_u32 m0, s49, 86016
 s_add_u32 s45, s33, 3276800
 buffer_load_dwordx4 v11, s[16:19], s45 offen  lds
 ds_read_b64_tr_b16 a[36:37], v8 offset:16384
 ds_read_b64_tr_b16 a[38:39], v8 offset:17408
 ds_read_b64_tr_b16 a[108:109], v9 offset:16384
 ds_read_b64_tr_b16 a[110:111], v9 offset:17408
 ds_read_b64_tr_b16 a[180:181], v8 offset:24576
 ds_read_b64_tr_b16 a[182:183], v8 offset:25600
 ds_read_b64_tr_b16 a[252:253], v9 offset:24576
 ds_read_b64_tr_b16 a[254:255], v9 offset:25600
 s_waitcnt vmcnt(8) lgkmcnt(0)
 s_barrier
 s_add_u32 m0, s49, 90112
 s_add_u32 s45, s32, 3407872
 buffer_load_dwordx4 v11, s[12:15], s45 offen  lds
 s_add_u32 m0, s49, 94208
 s_add_u32 s45, s32, 3538944
 buffer_load_dwordx4 v11, s[12:15], s45 offen  lds
 s_add_u32 m0, s49, 98304
 s_add_u32 s45, s33, 3407872
 buffer_load_dwordx4 v11, s[16:19], s45 offen  lds
 s_add_u32 m0, s49, 102400
 s_add_u32 s45, s33, 3538944
 buffer_load_dwordx4 v11, s[16:19], s45 offen  lds
 ds_read_b64_tr_b16 a[40:41], v8 offset:32768
 ds_read_b64_tr_b16 a[42:43], v8 offset:33792
 ds_read_b64_tr_b16 a[112:113], v9 offset:32768
 ds_read_b64_tr_b16 a[114:115], v9 offset:33792
 ds_read_b64_tr_b16 a[184:185], v8 offset:40960
 ds_read_b64_tr_b16 a[186:187], v8 offset:41984
 ds_read_b64_tr_b16 v[224:225], v9 offset:40960
 ds_read_b64_tr_b16 v[226:227], v9 offset:41984
 s_waitcnt vmcnt(8) lgkmcnt(0)
 s_barrier
 s_add_u32 m0, s49, 106496
 s_add_u32 s45, s32, 3670016
 buffer_load_dwordx4 v11, s[12:15], s45 offen  lds
 s_add_u32 m0, s49, 110592
 s_add_u32 s45, s32, 3801088
 buffer_load_dwordx4 v11, s[12:15], s45 offen  lds
 s_add_u32 m0, s49, 114688
 s_add_u32 s45, s33, 3670016
 buffer_load_dwordx4 v11, s[16:19], s45 offen  lds
 s_add_u32 m0, s49, 118784
 s_add_u32 s45, s33, 3801088
 buffer_load_dwordx4 v11, s[16:19], s45 offen  lds
 ds_read_b64_tr_b16 a[44:45], v8 offset:49152
 ds_read_b64_tr_b16 a[46:47], v8 offset:50176
 ds_read_b64_tr_b16 a[116:117], v9 offset:49152
 ds_read_b64_tr_b16 a[118:119], v9 offset:50176
 ds_read_b64_tr_b16 a[188:189], v8 offset:57344
 ds_read_b64_tr_b16 a[190:191], v8 offset:58368
 ds_read_b64_tr_b16 v[228:229], v9 offset:57344
 ds_read_b64_tr_b16 v[230:231], v9 offset:58368
 s_waitcnt vmcnt(8) lgkmcnt(0)
 s_barrier
 s_add_u32 m0, s49, 122880
 s_add_u32 s45, s32, 3932160
 buffer_load_dwordx4 v11, s[12:15], s45 offen  lds
 s_add_u32 m0, s49, 126976
 s_add_u32 s45, s32, 4063232
 buffer_load_dwordx4 v11, s[12:15], s45 offen  lds
 s_add_u32 m0, s49, 131072
 s_add_u32 s45, s33, 3932160
 buffer_load_dwordx4 v11, s[16:19], s45 offen  lds
 s_add_u32 m0, s49, 135168
 s_add_u32 s45, s33, 4063232
 buffer_load_dwordx4 v11, s[16:19], s45 offen  lds
 ds_read_b64_tr_b16 a[48:49], v8 offset:0
 ds_read_b64_tr_b16 a[50:51], v8 offset:1024
 ds_read_b64_tr_b16 a[120:121], v9 offset:0
 ds_read_b64_tr_b16 a[122:123], v9 offset:1024
 ds_read_b64_tr_b16 a[192:193], v8 offset:8192
 ds_read_b64_tr_b16 a[194:195], v8 offset:9216
 ds_read_b64_tr_b16 v[232:233], v9 offset:8192
 ds_read_b64_tr_b16 v[234:235], v9 offset:9216
 s_waitcnt vmcnt(8) lgkmcnt(0)
 s_barrier
 s_add_u32 m0, s49, 73728
 s_add_u32 s45, s32, 4194304
 buffer_load_dwordx4 v11, s[12:15], s45 offen  lds
 s_add_u32 m0, s49, 77824
 s_add_u32 s45, s32, 4325376
 buffer_load_dwordx4 v11, s[12:15], s45 offen  lds
 s_add_u32 m0, s49, 81920
 s_add_u32 s45, s33, 4194304
 buffer_load_dwordx4 v11, s[16:19], s45 offen  lds
 s_add_u32 m0, s49, 86016
 s_add_u32 s45, s33, 4325376
 buffer_load_dwordx4 v11, s[16:19], s45 offen  lds
 ds_read_b64_tr_b16 a[52:53], v8 offset:16384
 ds_read_b64_tr_b16 a[54:55], v8 offset:17408
 ds_read_b64_tr_b16 a[124:125], v9 offset:16384
 ds_read_b64_tr_b16 a[126:127], v9 offset:17408
 ds_read_b64_tr_b16 a[196:197], v8 offset:24576
 ds_read_b64_tr_b16 a[198:199], v8 offset:25600
 ds_read_b64_tr_b16 v[236:237], v9 offset:24576
 ds_read_b64_tr_b16 v[238:239], v9 offset:25600
 s_waitcnt vmcnt(8) lgkmcnt(0)
 s_barrier
 s_add_u32 m0, s49, 90112
 s_add_u32 s45, s32, 4456448
 buffer_load_dwordx4 v11, s[12:15], s45 offen  lds
 s_add_u32 m0, s49, 94208
 s_add_u32 s45, s32, 4587520
 buffer_load_dwordx4 v11, s[12:15], s45 offen  lds
 s_add_u32 m0, s49, 98304
 s_add_u32 s45, s33, 4456448
 buffer_load_dwordx4 v11, s[16:19], s45 offen  lds
 s_add_u32 m0, s49, 102400
 s_add_u32 s45, s33, 4587520
 buffer_load_dwordx4 v11, s[16:19], s45 offen  lds
 ds_read_b64_tr_b16 a[56:57], v8 offset:32768
 ds_read_b64_tr_b16 a[58:59], v8 offset:33792
 ds_read_b64_tr_b16 a[128:129], v9 offset:32768
 ds_read_b64_tr_b16 a[130:131], v9 offset:33792
 ds_read_b64_tr_b16 a[200:201], v8 offset:40960
 ds_read_b64_tr_b16 a[202:203], v8 offset:41984
 ds_read_b64_tr_b16 v[240:241], v9 offset:40960
 ds_read_b64_tr_b16 v[242:243], v9 offset:41984
 s_waitcnt vmcnt(8) lgkmcnt(0)
 s_barrier
 ds_read_b64_tr_b16 a[60:61], v8 offset:49152
 ds_read_b64_tr_b16 a[62:63], v8 offset:50176
 ds_read_b64_tr_b16 a[132:133], v9 offset:49152
 ds_read_b64_tr_b16 a[134:135], v9 offset:50176
 ds_read_b64_tr_b16 a[204:205], v8 offset:57344
 ds_read_b64_tr_b16 a[206:207], v8 offset:58368
 ds_read_b64_tr_b16 v[244:245], v9 offset:57344
 ds_read_b64_tr_b16 v[246:247], v9 offset:58368
 s_waitcnt vmcnt(4) lgkmcnt(0)
 s_barrier
 ds_read_b64_tr_b16 a[64:65], v8 offset:0
 ds_read_b64_tr_b16 a[66:67], v8 offset:1024
 ds_read_b64_tr_b16 a[136:137], v9 offset:0
 ds_read_b64_tr_b16 a[138:139], v9 offset:1024
 ds_read_b64_tr_b16 a[208:209], v8 offset:8192
 ds_read_b64_tr_b16 a[210:211], v8 offset:9216
 ds_read_b64_tr_b16 v[248:249], v9 offset:8192
 ds_read_b64_tr_b16 v[250:251], v9 offset:9216
 s_waitcnt vmcnt(0) lgkmcnt(0)
 s_barrier
 ds_read_b64_tr_b16 a[68:69], v8 offset:16384
 ds_read_b64_tr_b16 a[70:71], v8 offset:17408
 ds_read_b64_tr_b16 a[140:141], v9 offset:16384
 ds_read_b64_tr_b16 a[142:143], v9 offset:17408
 ds_read_b64_tr_b16 a[212:213], v8 offset:24576
 ds_read_b64_tr_b16 a[214:215], v8 offset:25600
 ds_read_b64_tr_b16 v[252:253], v9 offset:24576
 ds_read_b64_tr_b16 v[254:255], v9 offset:25600
 s_mov_b32 s50, 0x3e0293ee
 s_mov_b32 s42, 0
 s_mov_b32 s43, 0
 s_mov_b32 s44, 73728
 v_mov_b32 v6, v4
 v_mov_b32 v7, v5
 s_mov_b32 s95, 0x40000
 s_cmp_lg_u32 s4, 0
 s_cbranch_scc1 Lfrk_17
 v_min_u32 v21, 1, v0
 v_lshlrev_b32 v21, 28, v21
Lfr_16:
 buffer_load_dword v20, v21, s[28:31], 0 offen offset:0 sc1
 s_waitcnt vmcnt(0)
 v_cmp_eq_u32 vcc, 1, v20
 s_cbranch_vccnz Lfrk_17
 s_sub_u32 s95, s95, 1
 s_cbranch_scc0 Lfr_16
 s_endpgm
Lfrk_17:
 s_lshl_b32 s47, s2, 13
 s_add_u32 s47, s47, 0x8000000
 s_mov_b32 s48, s47
 v_mov_b32 v14, 0
 s_waitcnt vmcnt(0) lgkmcnt(0)
 s_barrier
 ds_read_b128 v[32:35], v6 offset:0
 ds_read_b128 v[36:39], v6 offset:2048
 ds_read_b128 v[40:43], v7 offset:0
 ds_read_b128 v[44:47], v7 offset:2048
 v_lshlrev_b32 v1, 12, v0
 s_lshl_b32 s45, s6, 7
 buffer_load_dword v15, v1, s[8:11], s45 offen
 v_add_u32 v1, 0x100000, v1
 buffer_load_dword v15, v1, s[8:11], s45 offen
 v_add_u32 v1, 0x100000, v1
 buffer_load_dword v15, v1, s[8:11], s45 offen
 v_add_u32 v1, 0x100000, v1
 s_waitcnt lgkmcnt(2)
Lps_loop_18:
 v_mfma_f32_16x16x32_bf16 v[64:67], a[0:3], v[32:35], 0
 ds_read_b128 v[48:51], v6 offset:4096
 v_mfma_f32_16x16x32_bf16 v[72:75], a[72:75], v[32:35], 0
 ds_read_b128 v[52:55], v6 offset:6144
 v_mfma_f32_16x16x32_bf16 v[80:83], v[32:35], a[144:147], 0
 s_add_u32 s41, s40, 1
 v_mfma_f32_16x16x32_bf16 v[88:91], v[32:35], a[216:219], 0
 s_add_u32 s45, s42, 2
 s_mul_i32 s46, s41, 36864
 v_mfma_f32_16x16x32_bf16 v[68:71], a[0:3], v[36:39], 0
 s_cmp_lt_u32 s45, s36
 s_cselect_b32 s46, s46, 0
 v_mfma_f32_16x16x32_bf16 v[76:79], a[72:75], v[36:39], 0
 s_lshl_b32 s49, s4, 10
 s_add_u32 s49, s49, s44
 v_mfma_f32_16x16x32_bf16 v[84:87], v[36:39], a[144:147], 0
 v_mul_f32 v96, s50, v96
 v_mul_f32 v97, s50, v97
 v_mfma_f32_16x16x32_bf16 v[92:95], v[36:39], a[216:219], 0
 s_waitcnt lgkmcnt(2)
 v_mfma_f32_16x16x32_bf16 v[64:67], a[4:7], v[40:43], v[64:67]
 ds_read_b128 v[56:59], v7 offset:4096
 v_mul_f32 v98, s50, v98
 v_mfma_f32_16x16x32_bf16 v[72:75], a[76:79], v[40:43], v[72:75]
 ds_read_b128 v[60:63], v7 offset:6144
 v_mul_f32 v99, s50, v99
 v_mfma_f32_16x16x32_bf16 v[80:83], v[40:43], a[148:151], v[80:83]
 v_mul_f32 v104, s50, v104
 v_mfma_f32_16x16x32_bf16 v[88:91], v[40:43], a[220:223], v[88:91]
 v_mul_f32 v105, s50, v105
 v_mfma_f32_16x16x32_bf16 v[68:71], a[4:7], v[44:47], v[68:71]
 v_mul_f32 v106, s50, v106
 v_mul_f32 v107, s50, v107
 v_mfma_f32_16x16x32_bf16 v[76:79], a[76:79], v[44:47], v[76:79]
 v_cvt_pk_bf16_f32 v16, v96, v104
 v_mfma_f32_16x16x32_bf16 v[84:87], v[44:47], a[148:151], v[84:87]
 v_cvt_pk_bf16_f32 v17, v97, v105
 v_mfma_f32_16x16x32_bf16 v[92:95], v[44:47], a[220:223], v[92:95]
 s_waitcnt lgkmcnt(2)
 v_cvt_pk_bf16_f32 v18, v98, v106
 v_mfma_f32_16x16x32_bf16 v[64:67], a[8:11], v[48:51], v[64:67]
 ds_read_b128 v[32:35], v6 offset:8192
 v_cvt_pk_bf16_f32 v19, v99, v107
 v_mfma_f32_16x16x32_bf16 v[72:75], a[80:83], v[48:51], v[72:75]
 ds_read_b128 v[36:39], v6 offset:10240
 v_mfma_f32_16x16x32_bf16 v[80:83], v[48:51], a[152:155], v[80:83]
 buffer_store_dwordx4 v[16:19], v12, s[20:23], s47 offen offset:0 sc1
 v_mul_f32 v100, s50, v100
 v_mfma_f32_16x16x32_bf16 v[88:91], v[48:51], a[224:227], v[88:91]
 v_mul_f32 v101, s50, v101
 v_mfma_f32_16x16x32_bf16 v[68:71], a[8:11], v[52:55], v[68:71]
 v_mul_f32 v102, s50, v102
 v_mfma_f32_16x16x32_bf16 v[76:79], a[80:83], v[52:55], v[76:79]
 v_mul_f32 v103, s50, v103
 v_mul_f32 v108, s50, v108
 v_mfma_f32_16x16x32_bf16 v[84:87], v[52:55], a[152:155], v[84:87]
 v_mul_f32 v109, s50, v109
 v_mfma_f32_16x16x32_bf16 v[92:95], v[52:55], a[224:227], v[92:95]
 s_waitcnt lgkmcnt(2)
 v_mfma_f32_16x16x32_bf16 v[64:67], a[12:15], v[56:59], v[64:67]
 ds_read_b128 v[40:43], v7 offset:8192
 v_mul_f32 v110, s50, v110
 v_mfma_f32_16x16x32_bf16 v[72:75], a[84:87], v[56:59], v[72:75]
 ds_read_b128 v[44:47], v7 offset:10240
 v_mul_f32 v111, s50, v111
 v_mfma_f32_16x16x32_bf16 v[80:83], v[56:59], a[156:159], v[80:83]
 v_cvt_pk_bf16_f32 v20, v100, v108
 v_mfma_f32_16x16x32_bf16 v[88:91], v[56:59], a[228:231], v[88:91]
 v_cvt_pk_bf16_f32 v21, v101, v109
 v_mfma_f32_16x16x32_bf16 v[68:71], a[12:15], v[60:63], v[68:71]
 v_cvt_pk_bf16_f32 v22, v102, v110
 v_cvt_pk_bf16_f32 v23, v103, v111
 v_mfma_f32_16x16x32_bf16 v[76:79], a[84:87], v[60:63], v[76:79]
 buffer_store_dwordx4 v[20:23], v12, s[20:23], s47 offen offset:1024 sc1
 v_mfma_f32_16x16x32_bf16 v[84:87], v[60:63], a[156:159], v[84:87]
 v_cvt_pk_bf16_f32 v24, v112, v113
 v_mfma_f32_16x16x32_bf16 v[92:95], v[60:63], a[228:231], v[92:95]
 s_waitcnt lgkmcnt(2)
 v_cvt_pk_bf16_f32 v25, v116, v117
 v_mfma_f32_16x16x32_bf16 v[64:67], a[16:19], v[32:35], v[64:67]
 ds_read_b128 v[48:51], v6 offset:12288
 v_cvt_pk_bf16_f32 v26, v114, v115
 v_mfma_f32_16x16x32_bf16 v[72:75], a[88:91], v[32:35], v[72:75]
 ds_read_b128 v[52:55], v6 offset:14336
 v_mfma_f32_16x16x32_bf16 v[80:83], v[32:35], a[160:163], v[80:83]
 v_cvt_pk_bf16_f32 v27, v118, v119
 buffer_store_dwordx4 v[24:27], v12, s[20:23], s48 offen offset:0 sc1
 v_mfma_f32_16x16x32_bf16 v[88:91], v[32:35], a[232:235], v[88:91]
 v_cvt_pk_bf16_f32 v28, v120, v121
 v_mfma_f32_16x16x32_bf16 v[68:71], a[16:19], v[36:39], v[68:71]
 v_cvt_pk_bf16_f32 v29, v124, v125
 v_mfma_f32_16x16x32_bf16 v[76:79], a[88:91], v[36:39], v[76:79]
 v_cvt_pk_bf16_f32 v30, v122, v123
 v_cvt_pk_bf16_f32 v31, v126, v127
 v_mfma_f32_16x16x32_bf16 v[84:87], v[36:39], a[160:163], v[84:87]
 buffer_store_dwordx4 v[28:31], v12, s[20:23], s48 offen offset:1024 sc1
 v_mfma_f32_16x16x32_bf16 v[92:95], v[36:39], a[232:235], v[92:95]
 s_waitcnt lgkmcnt(2)
 v_mfma_f32_16x16x32_bf16 v[64:67], a[20:23], v[40:43], v[64:67]
 ds_read_b128 v[56:59], v7 offset:12288
 v_mfma_f32_16x16x32_bf16 v[72:75], a[92:95], v[40:43], v[72:75]
 ds_read_b128 v[60:63], v7 offset:14336
 v_mfma_f32_16x16x32_bf16 v[80:83], v[40:43], a[164:167], v[80:83]
 s_add_u32 m0, s49, 0
 v_mfma_f32_16x16x32_bf16 v[88:91], v[40:43], a[236:239], v[88:91]
 buffer_load_dwordx4 v10, s[8:11], s46 offen offset:0  lds
 v_mfma_f32_16x16x32_bf16 v[68:71], a[20:23], v[44:47], v[68:71]
 s_add_u32 m0, s49, 3968
 v_mfma_f32_16x16x32_bf16 v[76:79], a[92:95], v[44:47], v[76:79]
 buffer_load_dwordx4 v10, s[8:11], s46 offen offset:128  lds
 v_mfma_f32_16x16x32_bf16 v[84:87], v[44:47], a[164:167], v[84:87]
 v_mfma_f32_16x16x32_bf16 v[92:95], v[44:47], a[236:239], v[92:95]
 s_waitcnt lgkmcnt(2)
 v_mfma_f32_16x16x32_bf16 v[64:67], a[24:27], v[48:51], v[64:67]
 ds_read_b128 v[32:35], v6 offset:16384
 v_mfma_f32_16x16x32_bf16 v[72:75], a[96:99], v[48:51], v[72:75]
 ds_read_b128 v[36:39], v6 offset:18432
 v_mfma_f32_16x16x32_bf16 v[80:83], v[48:51], a[168:171], v[80:83]
 s_add_u32 m0, s49, 7936
 v_mfma_f32_16x16x32_bf16 v[88:91], v[48:51], a[240:243], v[88:91]
 buffer_load_dwordx4 v10, s[8:11], s46 offen offset:256  lds
 v_mfma_f32_16x16x32_bf16 v[68:71], a[24:27], v[52:55], v[68:71]
 s_add_u32 m0, s49, 11904
 v_mfma_f32_16x16x32_bf16 v[76:79], a[96:99], v[52:55], v[76:79]
 buffer_load_dwordx4 v10, s[8:11], s46 offen offset:384  lds
 v_mfma_f32_16x16x32_bf16 v[84:87], v[52:55], a[168:171], v[84:87]
 v_mfma_f32_16x16x32_bf16 v[92:95], v[52:55], a[240:243], v[92:95]
 s_waitcnt lgkmcnt(2)
 v_mfma_f32_16x16x32_bf16 v[64:67], a[28:31], v[56:59], v[64:67]
 ds_read_b128 v[40:43], v7 offset:16384
 v_mfma_f32_16x16x32_bf16 v[72:75], a[100:103], v[56:59], v[72:75]
 ds_read_b128 v[44:47], v7 offset:18432
 v_mfma_f32_16x16x32_bf16 v[80:83], v[56:59], a[172:175], v[80:83]
 s_add_u32 m0, s49, 15872
 v_mfma_f32_16x16x32_bf16 v[88:91], v[56:59], a[244:247], v[88:91]
 buffer_load_dwordx4 v10, s[8:11], s46 offen offset:512  lds
 v_mfma_f32_16x16x32_bf16 v[68:71], a[28:31], v[60:63], v[68:71]
 s_add_u32 m0, s49, 19840
 v_mfma_f32_16x16x32_bf16 v[76:79], a[100:103], v[60:63], v[76:79]
 buffer_load_dwordx4 v10, s[8:11], s46 offen offset:640  lds
 v_mfma_f32_16x16x32_bf16 v[84:87], v[60:63], a[172:175], v[84:87]
 v_mfma_f32_16x16x32_bf16 v[92:95], v[60:63], a[244:247], v[92:95]
 s_waitcnt lgkmcnt(2)
 v_mfma_f32_16x16x32_bf16 v[64:67], a[32:35], v[32:35], v[64:67]
 ds_read_b128 v[48:51], v6 offset:20480
 v_mfma_f32_16x16x32_bf16 v[72:75], a[104:107], v[32:35], v[72:75]
 ds_read_b128 v[52:55], v6 offset:22528
 v_mfma_f32_16x16x32_bf16 v[80:83], v[32:35], a[176:179], v[80:83]
 s_add_u32 m0, s49, 23808
 v_mfma_f32_16x16x32_bf16 v[88:91], v[32:35], a[248:251], v[88:91]
 buffer_load_dwordx4 v10, s[8:11], s46 offen offset:768  lds
 v_mfma_f32_16x16x32_bf16 v[68:71], a[32:35], v[36:39], v[68:71]
 s_add_u32 m0, s49, 27776
 v_mfma_f32_16x16x32_bf16 v[76:79], a[104:107], v[36:39], v[76:79]
 buffer_load_dwordx4 v10, s[8:11], s46 offen offset:896  lds
 v_mfma_f32_16x16x32_bf16 v[84:87], v[36:39], a[176:179], v[84:87]
 v_mfma_f32_16x16x32_bf16 v[92:95], v[36:39], a[248:251], v[92:95]
 s_waitcnt lgkmcnt(2)
 v_mfma_f32_16x16x32_bf16 v[64:67], a[36:39], v[40:43], v[64:67]
 ds_read_b128 v[56:59], v7 offset:20480
 v_mfma_f32_16x16x32_bf16 v[72:75], a[108:111], v[40:43], v[72:75]
 ds_read_b128 v[60:63], v7 offset:22528
 v_mfma_f32_16x16x32_bf16 v[80:83], v[40:43], a[180:183], v[80:83]
 s_add_u32 m0, s49, 31744
 v_mfma_f32_16x16x32_bf16 v[88:91], v[40:43], a[252:255], v[88:91]
 buffer_load_dwordx4 v10, s[8:11], s46 offen offset:1024  lds
 v_mfma_f32_16x16x32_bf16 v[68:71], a[36:39], v[44:47], v[68:71]
 v_mfma_f32_16x16x32_bf16 v[76:79], a[108:111], v[44:47], v[76:79]
 v_mfma_f32_16x16x32_bf16 v[84:87], v[44:47], a[180:183], v[84:87]
 v_mfma_f32_16x16x32_bf16 v[92:95], v[44:47], a[252:255], v[92:95]
 s_waitcnt lgkmcnt(2)
 v_mfma_f32_16x16x32_bf16 v[64:67], a[40:43], v[48:51], v[64:67]
 ds_read_b128 v[32:35], v6 offset:24576
 v_mfma_f32_16x16x32_bf16 v[72:75], a[112:115], v[48:51], v[72:75]
 ds_read_b128 v[36:39], v6 offset:26624
 v_mfma_f32_16x16x32_bf16 v[80:83], v[48:51], a[184:187], v[80:83]
 v_mfma_f32_16x16x32_bf16 v[88:91], v[48:51], v[224:227], v[88:91]
 v_mfma_f32_16x16x32_bf16 v[68:71], a[40:43], v[52:55], v[68:71]
 v_mfma_f32_16x16x32_bf16 v[76:79], a[112:115], v[52:55], v[76:79]
 v_mfma_f32_16x16x32_bf16 v[84:87], v[52:55], a[184:187], v[84:87]
 v_mfma_f32_16x16x32_bf16 v[92:95], v[52:55], v[224:227], v[92:95]
 s_waitcnt lgkmcnt(2)
 v_mfma_f32_16x16x32_bf16 v[64:67], a[44:47], v[56:59], v[64:67]
 ds_read_b128 v[40:43], v7 offset:24576
 v_mfma_f32_16x16x32_bf16 v[72:75], a[116:119], v[56:59], v[72:75]
 ds_read_b128 v[44:47], v7 offset:26624
 v_mfma_f32_16x16x32_bf16 v[80:83], v[56:59], a[188:191], v[80:83]
 v_mfma_f32_16x16x32_bf16 v[88:91], v[56:59], v[228:231], v[88:91]
 v_mfma_f32_16x16x32_bf16 v[68:71], a[44:47], v[60:63], v[68:71]
 v_mfma_f32_16x16x32_bf16 v[76:79], a[116:119], v[60:63], v[76:79]
 v_mfma_f32_16x16x32_bf16 v[84:87], v[60:63], a[188:191], v[84:87]
 v_mfma_f32_16x16x32_bf16 v[92:95], v[60:63], v[228:231], v[92:95]
 s_waitcnt lgkmcnt(2)
 v_mfma_f32_16x16x32_bf16 v[64:67], a[48:51], v[32:35], v[64:67]
 ds_read_b128 v[48:51], v6 offset:28672
 v_mfma_f32_16x16x32_bf16 v[72:75], a[120:123], v[32:35], v[72:75]
 ds_read_b128 v[52:55], v6 offset:30720
 v_mfma_f32_16x16x32_bf16 v[80:83], v[32:35], a[192:195], v[80:83]
 v_mfma_f32_16x16x32_bf16 v[88:91], v[32:35], v[232:235], v[88:91]
 v_mfma_f32_16x16x32_bf16 v[68:71], a[48:51], v[36:39], v[68:71]
 v_mfma_f32_16x16x32_bf16 v[76:79], a[120:123], v[36:39], v[76:79]
 v_mfma_f32_16x16x32_bf16 v[84:87], v[36:39], a[192:195], v[84:87]
 v_mfma_f32_16x16x32_bf16 v[92:95], v[36:39], v[232:235], v[92:95]
 s_waitcnt lgkmcnt(2)
 v_mfma_f32_16x16x32_bf16 v[64:67], a[52:55], v[40:43], v[64:67]
 ds_read_b128 v[56:59], v7 offset:28672
 v_mfma_f32_16x16x32_bf16 v[72:75], a[124:127], v[40:43], v[72:75]
 ds_read_b128 v[60:63], v7 offset:30720
 v_mfma_f32_16x16x32_bf16 v[80:83], v[40:43], a[196:199], v[80:83]
 s_add_u32 s43, s43, 36864
 s_cmp_eq_u32 s43, 147456
 v_mfma_f32_16x16x32_bf16 v[88:91], v[40:43], v[236:239], v[88:91]
 s_cselect_b32 s43, 0, s43
 s_add_u32 s44, s44, 36864
 v_mfma_f32_16x16x32_bf16 v[68:71], a[52:55], v[44:47], v[68:71]
 s_cmp_eq_u32 s44, 147456
 s_cselect_b32 s44, 0, s44
 v_mfma_f32_16x16x32_bf16 v[76:79], a[124:127], v[44:47], v[76:79]
 v_mfma_f32_16x16x32_bf16 v[84:87], v[44:47], a[196:199], v[84:87]
 v_mfma_f32_16x16x32_bf16 v[92:95], v[44:47], v[236:239], v[92:95]
 s_waitcnt lgkmcnt(2)
 v_mfma_f32_16x16x32_bf16 v[64:67], a[56:59], v[48:51], v[64:67]
 ds_read_b128 v[32:35], v6 offset:32768
 v_mfma_f32_16x16x32_bf16 v[72:75], a[128:131], v[48:51], v[72:75]
 ds_read_b128 v[36:39], v6 offset:34816
 v_mfma_f32_16x16x32_bf16 v[80:83], v[48:51], a[200:203], v[80:83]
 v_add_u32 v6, s43, v4
 v_mfma_f32_16x16x32_bf16 v[88:91], v[48:51], v[240:243], v[88:91]
 v_mfma_f32_16x16x32_bf16 v[68:71], a[56:59], v[52:55], v[68:71]
 v_mfma_f32_16x16x32_bf16 v[76:79], a[128:131], v[52:55], v[76:79]
 v_mfma_f32_16x16x32_bf16 v[84:87], v[52:55], a[200:203], v[84:87]
 v_mfma_f32_16x16x32_bf16 v[92:95], v[52:55], v[240:243], v[92:95]
 s_waitcnt lgkmcnt(2)
 v_mfma_f32_16x16x32_bf16 v[64:67], a[60:63], v[56:59], v[64:67]
 ds_read_b128 v[40:43], v7 offset:32768
 v_mfma_f32_16x16x32_bf16 v[72:75], a[132:135], v[56:59], v[72:75]
 ds_read_b128 v[44:47], v7 offset:34816
 v_mfma_f32_16x16x32_bf16 v[80:83], v[56:59], a[204:207], v[80:83]
 v_add_u32 v7, s43, v5
 v_mfma_f32_16x16x32_bf16 v[88:91], v[56:59], v[244:247], v[88:91]
 v_mfma_f32_16x16x32_bf16 v[68:71], a[60:63], v[60:63], v[68:71]
 v_mfma_f32_16x16x32_bf16 v[76:79], a[132:135], v[60:63], v[76:79]
 v_mfma_f32_16x16x32_bf16 v[84:87], v[60:63], a[204:207], v[84:87]
 v_mfma_f32_16x16x32_bf16 v[92:95], v[60:63], v[244:247], v[92:95]
 s_waitcnt lgkmcnt(2)
 v_mfma_f32_16x16x32_bf16 v[64:67], a[64:67], v[32:35], v[64:67]
 s_waitcnt vmcnt(9)
 s_barrier
 ds_read_b128 v[48:51], v6 offset:0
 v_mfma_f32_16x16x32_bf16 v[72:75], a[136:139], v[32:35], v[72:75]
 ds_read_b128 v[52:55], v6 offset:2048
 v_mfma_f32_16x16x32_bf16 v[80:83], v[32:35], a[208:211], v[80:83]
 buffer_store_dword v14, v13, s[20:23], 0 offen sc1
 v_mfma_f32_16x16x32_bf16 v[88:91], v[32:35], v[248:251], v[88:91]
 v_mfma_f32_16x16x32_bf16 v[68:71], a[64:67], v[36:39], v[68:71]
 v_mfma_f32_16x16x32_bf16 v[76:79], a[136:139], v[36:39], v[76:79]
 v_mfma_f32_16x16x32_bf16 v[84:87], v[36:39], a[208:211], v[84:87]
 v_mfma_f32_16x16x32_bf16 v[92:95], v[36:39], v[248:251], v[92:95]
 s_waitcnt lgkmcnt(2)
 v_mfma_f32_16x16x32_bf16 v[64:67], a[68:71], v[40:43], v[64:67]
 ds_read_b128 v[56:59], v7 offset:0
 v_mfma_f32_16x16x32_bf16 v[72:75], a[140:143], v[40:43], v[72:75]
 ds_read_b128 v[60:63], v7 offset:2048
 v_mfma_f32_16x16x32_bf16 v[80:83], v[40:43], a[212:215], v[80:83]
 s_mul_i32 s45, s39, 524288
 s_add_u32 s47, s34, s45
 v_mfma_f32_16x16x32_bf16 v[88:91], v[40:43], v[252:255], v[88:91]
 s_add_u32 s48, s35, s45
 v_add_u32 v14, 1, v14
 v_mfma_f32_16x16x32_bf16 v[68:71], a[68:71], v[44:47], v[68:71]
 s_mov_b32 s39, s40
 s_mov_b32 s40, s41
 v_mfma_f32_16x16x32_bf16 v[76:79], a[140:143], v[44:47], v[76:79]
 s_add_u32 s42, s42, 1
 v_mfma_f32_16x16x32_bf16 v[84:87], v[44:47], a[212:215], v[84:87]
 v_mfma_f32_16x16x32_bf16 v[92:95], v[44:47], v[252:255], v[92:95]
 s_waitcnt lgkmcnt(2)
 v_mfma_f32_16x16x32_bf16 v[96:99], a[0:3], v[48:51], 0
 ds_read_b128 v[32:35], v6 offset:4096
 v_mfma_f32_16x16x32_bf16 v[104:107], a[72:75], v[48:51], 0
 ds_read_b128 v[36:39], v6 offset:6144
 v_mfma_f32_16x16x32_bf16 v[112:115], v[48:51], a[144:147], 0
 s_add_u32 s41, s40, 1
 v_mfma_f32_16x16x32_bf16 v[120:123], v[48:51], a[216:219], 0
 s_add_u32 s45, s42, 2
 s_mul_i32 s46, s41, 36864
 v_mfma_f32_16x16x32_bf16 v[100:103], a[0:3], v[52:55], 0
 s_cmp_lt_u32 s45, s36
 s_cselect_b32 s46, s46, 0
 v_mfma_f32_16x16x32_bf16 v[108:111], a[72:75], v[52:55], 0
 s_lshl_b32 s49, s4, 10
 s_add_u32 s49, s49, s44
 v_mfma_f32_16x16x32_bf16 v[116:119], v[52:55], a[144:147], 0
 v_mul_f32 v64, s50, v64
 v_mul_f32 v65, s50, v65
 v_mfma_f32_16x16x32_bf16 v[124:127], v[52:55], a[216:219], 0
 s_waitcnt lgkmcnt(2)
 v_mfma_f32_16x16x32_bf16 v[96:99], a[4:7], v[56:59], v[96:99]
 ds_read_b128 v[40:43], v7 offset:4096
 v_mul_f32 v66, s50, v66
 v_mfma_f32_16x16x32_bf16 v[104:107], a[76:79], v[56:59], v[104:107]
 ds_read_b128 v[44:47], v7 offset:6144
 v_mul_f32 v67, s50, v67
 v_mfma_f32_16x16x32_bf16 v[112:115], v[56:59], a[148:151], v[112:115]
 v_mul_f32 v72, s50, v72
 v_mfma_f32_16x16x32_bf16 v[120:123], v[56:59], a[220:223], v[120:123]
 v_mul_f32 v73, s50, v73
 v_mfma_f32_16x16x32_bf16 v[100:103], a[4:7], v[60:63], v[100:103]
 v_mul_f32 v74, s50, v74
 v_mul_f32 v75, s50, v75
 v_mfma_f32_16x16x32_bf16 v[108:111], a[76:79], v[60:63], v[108:111]
 v_cvt_pk_bf16_f32 v16, v64, v72
 v_mfma_f32_16x16x32_bf16 v[116:119], v[60:63], a[148:151], v[116:119]
 v_cvt_pk_bf16_f32 v17, v65, v73
 v_mfma_f32_16x16x32_bf16 v[124:127], v[60:63], a[220:223], v[124:127]
 s_waitcnt lgkmcnt(2)
 v_cvt_pk_bf16_f32 v18, v66, v74
 v_mfma_f32_16x16x32_bf16 v[96:99], a[8:11], v[32:35], v[96:99]
 ds_read_b128 v[48:51], v6 offset:8192
 v_cvt_pk_bf16_f32 v19, v67, v75
 v_mfma_f32_16x16x32_bf16 v[104:107], a[80:83], v[32:35], v[104:107]
 ds_read_b128 v[52:55], v6 offset:10240
 v_mfma_f32_16x16x32_bf16 v[112:115], v[32:35], a[152:155], v[112:115]
 buffer_store_dwordx4 v[16:19], v12, s[20:23], s47 offen offset:0 sc1
 v_mul_f32 v68, s50, v68
 v_mfma_f32_16x16x32_bf16 v[120:123], v[32:35], a[224:227], v[120:123]
 v_mul_f32 v69, s50, v69
 v_mfma_f32_16x16x32_bf16 v[100:103], a[8:11], v[36:39], v[100:103]
 v_mul_f32 v70, s50, v70
 v_mfma_f32_16x16x32_bf16 v[108:111], a[80:83], v[36:39], v[108:111]
 v_mul_f32 v71, s50, v71
 v_mul_f32 v76, s50, v76
 v_mfma_f32_16x16x32_bf16 v[116:119], v[36:39], a[152:155], v[116:119]
 v_mul_f32 v77, s50, v77
 v_mfma_f32_16x16x32_bf16 v[124:127], v[36:39], a[224:227], v[124:127]
 s_waitcnt lgkmcnt(2)
 v_mfma_f32_16x16x32_bf16 v[96:99], a[12:15], v[40:43], v[96:99]
 ds_read_b128 v[56:59], v7 offset:8192
 v_mul_f32 v78, s50, v78
 v_mfma_f32_16x16x32_bf16 v[104:107], a[84:87], v[40:43], v[104:107]
 ds_read_b128 v[60:63], v7 offset:10240
 v_mul_f32 v79, s50, v79
 v_mfma_f32_16x16x32_bf16 v[112:115], v[40:43], a[156:159], v[112:115]
 v_cvt_pk_bf16_f32 v20, v68, v76
 v_mfma_f32_16x16x32_bf16 v[120:123], v[40:43], a[228:231], v[120:123]
 v_cvt_pk_bf16_f32 v21, v69, v77
 v_mfma_f32_16x16x32_bf16 v[100:103], a[12:15], v[44:47], v[100:103]
 v_cvt_pk_bf16_f32 v22, v70, v78
 v_cvt_pk_bf16_f32 v23, v71, v79
 v_mfma_f32_16x16x32_bf16 v[108:111], a[84:87], v[44:47], v[108:111]
 buffer_store_dwordx4 v[20:23], v12, s[20:23], s47 offen offset:1024 sc1
 v_mfma_f32_16x16x32_bf16 v[116:119], v[44:47], a[156:159], v[116:119]
 v_cvt_pk_bf16_f32 v24, v80, v81
 v_mfma_f32_16x16x32_bf16 v[124:127], v[44:47], a[228:231], v[124:127]
 s_waitcnt lgkmcnt(2)
 v_cvt_pk_bf16_f32 v25, v84, v85
 v_mfma_f32_16x16x32_bf16 v[96:99], a[16:19], v[48:51], v[96:99]
 ds_read_b128 v[32:35], v6 offset:12288
 v_cvt_pk_bf16_f32 v26, v82, v83
 v_mfma_f32_16x16x32_bf16 v[104:107], a[88:91], v[48:51], v[104:107]
 ds_read_b128 v[36:39], v6 offset:14336
 v_mfma_f32_16x16x32_bf16 v[112:115], v[48:51], a[160:163], v[112:115]
 v_cvt_pk_bf16_f32 v27, v86, v87
 buffer_store_dwordx4 v[24:27], v12, s[20:23], s48 offen offset:0 sc1
 v_mfma_f32_16x16x32_bf16 v[120:123], v[48:51], a[232:235], v[120:123]
 v_cvt_pk_bf16_f32 v28, v88, v89
 v_mfma_f32_16x16x32_bf16 v[100:103], a[16:19], v[52:55], v[100:103]
 v_cvt_pk_bf16_f32 v29, v92, v93
 v_mfma_f32_16x16x32_bf16 v[108:111], a[88:91], v[52:55], v[108:111]
 v_cvt_pk_bf16_f32 v30, v90, v91
 v_cvt_pk_bf16_f32 v31, v94, v95
 v_mfma_f32_16x16x32_bf16 v[116:119], v[52:55], a[160:163], v[116:119]
 buffer_store_dwordx4 v[28:31], v12, s[20:23], s48 offen offset:1024 sc1
 v_mfma_f32_16x16x32_bf16 v[124:127], v[52:55], a[232:235], v[124:127]
 s_waitcnt lgkmcnt(2)
 v_mfma_f32_16x16x32_bf16 v[96:99], a[20:23], v[56:59], v[96:99]
 ds_read_b128 v[40:43], v7 offset:12288
 v_mfma_f32_16x16x32_bf16 v[104:107], a[92:95], v[56:59], v[104:107]
 ds_read_b128 v[44:47], v7 offset:14336
 v_mfma_f32_16x16x32_bf16 v[112:115], v[56:59], a[164:167], v[112:115]
 s_add_u32 m0, s49, 0
 v_mfma_f32_16x16x32_bf16 v[120:123], v[56:59], a[236:239], v[120:123]
 buffer_load_dwordx4 v10, s[8:11], s46 offen offset:0  lds
 v_mfma_f32_16x16x32_bf16 v[100:103], a[20:23], v[60:63], v[100:103]
 s_add_u32 m0, s49, 3968
 v_mfma_f32_16x16x32_bf16 v[108:111], a[92:95], v[60:63], v[108:111]
 buffer_load_dwordx4 v10, s[8:11], s46 offen offset:128  lds
 v_mfma_f32_16x16x32_bf16 v[116:119], v[60:63], a[164:167], v[116:119]
 v_mfma_f32_16x16x32_bf16 v[124:127], v[60:63], a[236:239], v[124:127]
 s_waitcnt lgkmcnt(2)
 v_mfma_f32_16x16x32_bf16 v[96:99], a[24:27], v[32:35], v[96:99]
 ds_read_b128 v[48:51], v6 offset:16384
 v_mfma_f32_16x16x32_bf16 v[104:107], a[96:99], v[32:35], v[104:107]
 ds_read_b128 v[52:55], v6 offset:18432
 v_mfma_f32_16x16x32_bf16 v[112:115], v[32:35], a[168:171], v[112:115]
 s_add_u32 m0, s49, 7936
 v_mfma_f32_16x16x32_bf16 v[120:123], v[32:35], a[240:243], v[120:123]
 buffer_load_dwordx4 v10, s[8:11], s46 offen offset:256  lds
 v_mfma_f32_16x16x32_bf16 v[100:103], a[24:27], v[36:39], v[100:103]
 s_add_u32 m0, s49, 11904
 v_mfma_f32_16x16x32_bf16 v[108:111], a[96:99], v[36:39], v[108:111]
 buffer_load_dwordx4 v10, s[8:11], s46 offen offset:384  lds
 v_mfma_f32_16x16x32_bf16 v[116:119], v[36:39], a[168:171], v[116:119]
 v_mfma_f32_16x16x32_bf16 v[124:127], v[36:39], a[240:243], v[124:127]
 s_waitcnt lgkmcnt(2)
 v_mfma_f32_16x16x32_bf16 v[96:99], a[28:31], v[40:43], v[96:99]
 ds_read_b128 v[56:59], v7 offset:16384
 v_mfma_f32_16x16x32_bf16 v[104:107], a[100:103], v[40:43], v[104:107]
 ds_read_b128 v[60:63], v7 offset:18432
 v_mfma_f32_16x16x32_bf16 v[112:115], v[40:43], a[172:175], v[112:115]
 s_add_u32 m0, s49, 15872
 v_mfma_f32_16x16x32_bf16 v[120:123], v[40:43], a[244:247], v[120:123]
 buffer_load_dwordx4 v10, s[8:11], s46 offen offset:512  lds
 v_mfma_f32_16x16x32_bf16 v[100:103], a[28:31], v[44:47], v[100:103]
 s_add_u32 m0, s49, 19840
 v_mfma_f32_16x16x32_bf16 v[108:111], a[100:103], v[44:47], v[108:111]
 buffer_load_dwordx4 v10, s[8:11], s46 offen offset:640  lds
 v_mfma_f32_16x16x32_bf16 v[116:119], v[44:47], a[172:175], v[116:119]
 v_mfma_f32_16x16x32_bf16 v[124:127], v[44:47], a[244:247], v[124:127]
 s_waitcnt lgkmcnt(2)
 v_mfma_f32_16x16x32_bf16 v[96:99], a[32:35], v[48:51], v[96:99]
 ds_read_b128 v[32:35], v6 offset:20480
 v_mfma_f32_16x16x32_bf16 v[104:107], a[104:107], v[48:51], v[104:107]
 ds_read_b128 v[36:39], v6 offset:22528
 v_mfma_f32_16x16x32_bf16 v[112:115], v[48:51], a[176:179], v[112:115]
 s_add_u32 m0, s49, 23808
 v_mfma_f32_16x16x32_bf16 v[120:123], v[48:51], a[248:251], v[120:123]
 buffer_load_dwordx4 v10, s[8:11], s46 offen offset:768  lds
 v_mfma_f32_16x16x32_bf16 v[100:103], a[32:35], v[52:55], v[100:103]
 s_add_u32 m0, s49, 27776
 v_mfma_f32_16x16x32_bf16 v[108:111], a[104:107], v[52:55], v[108:111]
 buffer_load_dwordx4 v10, s[8:11], s46 offen offset:896  lds
 v_mfma_f32_16x16x32_bf16 v[116:119], v[52:55], a[176:179], v[116:119]
 v_mfma_f32_16x16x32_bf16 v[124:127], v[52:55], a[248:251], v[124:127]
 s_waitcnt lgkmcnt(2)
 v_mfma_f32_16x16x32_bf16 v[96:99], a[36:39], v[56:59], v[96:99]
 ds_read_b128 v[40:43], v7 offset:20480
 v_mfma_f32_16x16x32_bf16 v[104:107], a[108:111], v[56:59], v[104:107]
 ds_read_b128 v[44:47], v7 offset:22528
 v_mfma_f32_16x16x32_bf16 v[112:115], v[56:59], a[180:183], v[112:115]
 s_add_u32 m0, s49, 31744
 v_mfma_f32_16x16x32_bf16 v[120:123], v[56:59], a[252:255], v[120:123]
 buffer_load_dwordx4 v10, s[8:11], s46 offen offset:1024  lds
 v_mfma_f32_16x16x32_bf16 v[100:103], a[36:39], v[60:63], v[100:103]
 v_mfma_f32_16x16x32_bf16 v[108:111], a[108:111], v[60:63], v[108:111]
 v_mfma_f32_16x16x32_bf16 v[116:119], v[60:63], a[180:183], v[116:119]
 v_mfma_f32_16x16x32_bf16 v[124:127], v[60:63], a[252:255], v[124:127]
 s_waitcnt lgkmcnt(2)
 v_mfma_f32_16x16x32_bf16 v[96:99], a[40:43], v[32:35], v[96:99]
 ds_read_b128 v[48:51], v6 offset:24576
 v_mfma_f32_16x16x32_bf16 v[104:107], a[112:115], v[32:35], v[104:107]
 ds_read_b128 v[52:55], v6 offset:26624
 v_mfma_f32_16x16x32_bf16 v[112:115], v[32:35], a[184:187], v[112:115]
 v_mfma_f32_16x16x32_bf16 v[120:123], v[32:35], v[224:227], v[120:123]
 v_mfma_f32_16x16x32_bf16 v[100:103], a[40:43], v[36:39], v[100:103]
 v_mfma_f32_16x16x32_bf16 v[108:111], a[112:115], v[36:39], v[108:111]
 v_mfma_f32_16x16x32_bf16 v[116:119], v[36:39], a[184:187], v[116:119]
 v_mfma_f32_16x16x32_bf16 v[124:127], v[36:39], v[224:227], v[124:127]
 s_waitcnt lgkmcnt(2)
 v_mfma_f32_16x16x32_bf16 v[96:99], a[44:47], v[40:43], v[96:99]
 ds_read_b128 v[56:59], v7 offset:24576
 v_mfma_f32_16x16x32_bf16 v[104:107], a[116:119], v[40:43], v[104:107]
 ds_read_b128 v[60:63], v7 offset:26624
 v_mfma_f32_16x16x32_bf16 v[112:115], v[40:43], a[188:191], v[112:115]
 v_mfma_f32_16x16x32_bf16 v[120:123], v[40:43], v[228:231], v[120:123]
 v_mfma_f32_16x16x32_bf16 v[100:103], a[44:47], v[44:47], v[100:103]
 v_mfma_f32_16x16x32_bf16 v[108:111], a[116:119], v[44:47], v[108:111]
 v_mfma_f32_16x16x32_bf16 v[116:119], v[44:47], a[188:191], v[116:119]
 v_mfma_f32_16x16x32_bf16 v[124:127], v[44:47], v[228:231], v[124:127]
 s_waitcnt lgkmcnt(2)
 v_mfma_f32_16x16x32_bf16 v[96:99], a[48:51], v[48:51], v[96:99]
 ds_read_b128 v[32:35], v6 offset:28672
 v_mfma_f32_16x16x32_bf16 v[104:107], a[120:123], v[48:51], v[104:107]
 ds_read_b128 v[36:39], v6 offset:30720
 v_mfma_f32_16x16x32_bf16 v[112:115], v[48:51], a[192:195], v[112:115]
 v_mfma_f32_16x16x32_bf16 v[120:123], v[48:51], v[232:235], v[120:123]
 v_mfma_f32_16x16x32_bf16 v[100:103], a[48:51], v[52:55], v[100:103]
 v_mfma_f32_16x16x32_bf16 v[108:111], a[120:123], v[52:55], v[108:111]
 v_mfma_f32_16x16x32_bf16 v[116:119], v[52:55], a[192:195], v[116:119]
 v_mfma_f32_16x16x32_bf16 v[124:127], v[52:55], v[232:235], v[124:127]
 s_waitcnt lgkmcnt(2)
 v_mfma_f32_16x16x32_bf16 v[96:99], a[52:55], v[56:59], v[96:99]
 ds_read_b128 v[40:43], v7 offset:28672
 v_mfma_f32_16x16x32_bf16 v[104:107], a[124:127], v[56:59], v[104:107]
 ds_read_b128 v[44:47], v7 offset:30720
 v_mfma_f32_16x16x32_bf16 v[112:115], v[56:59], a[196:199], v[112:115]
 s_add_u32 s43, s43, 36864
 s_cmp_eq_u32 s43, 147456
 v_mfma_f32_16x16x32_bf16 v[120:123], v[56:59], v[236:239], v[120:123]
 s_cselect_b32 s43, 0, s43
 s_add_u32 s44, s44, 36864
 v_mfma_f32_16x16x32_bf16 v[100:103], a[52:55], v[60:63], v[100:103]
 s_cmp_eq_u32 s44, 147456
 s_cselect_b32 s44, 0, s44
 v_mfma_f32_16x16x32_bf16 v[108:111], a[124:127], v[60:63], v[108:111]
 v_mfma_f32_16x16x32_bf16 v[116:119], v[60:63], a[196:199], v[116:119]
 v_mfma_f32_16x16x32_bf16 v[124:127], v[60:63], v[236:239], v[124:127]
 s_waitcnt lgkmcnt(2)
 v_mfma_f32_16x16x32_bf16 v[96:99], a[56:59], v[32:35], v[96:99]
 ds_read_b128 v[48:51], v6 offset:32768
 v_mfma_f32_16x16x32_bf16 v[104:107], a[128:131], v[32:35], v[104:107]
 ds_read_b128 v[52:55], v6 offset:34816
 v_mfma_f32_16x16x32_bf16 v[112:115], v[32:35], a[200:203], v[112:115]
 v_add_u32 v6, s43, v4
 v_mfma_f32_16x16x32_bf16 v[120:123], v[32:35], v[240:243], v[120:123]
 v_mfma_f32_16x16x32_bf16 v[100:103], a[56:59], v[36:39], v[100:103]
 v_mfma_f32_16x16x32_bf16 v[108:111], a[128:131], v[36:39], v[108:111]
 v_mfma_f32_16x16x32_bf16 v[116:119], v[36:39], a[200:203], v[116:119]
 v_mfma_f32_16x16x32_bf16 v[124:127], v[36:39], v[240:243], v[124:127]
 s_waitcnt lgkmcnt(2)
 v_mfma_f32_16x16x32_bf16 v[96:99], a[60:63], v[40:43], v[96:99]
 ds_read_b128 v[56:59], v7 offset:32768
 v_mfma_f32_16x16x32_bf16 v[104:107], a[132:135], v[40:43], v[104:107]
 ds_read_b128 v[60:63], v7 offset:34816
 v_mfma_f32_16x16x32_bf16 v[112:115], v[40:43], a[204:207], v[112:115]
 v_add_u32 v7, s43, v5
 v_mfma_f32_16x16x32_bf16 v[120:123], v[40:43], v[244:247], v[120:123]
 v_mfma_f32_16x16x32_bf16 v[100:103], a[60:63], v[44:47], v[100:103]
 v_mfma_f32_16x16x32_bf16 v[108:111], a[132:135], v[44:47], v[108:111]
 v_mfma_f32_16x16x32_bf16 v[116:119], v[44:47], a[204:207], v[116:119]
 v_mfma_f32_16x16x32_bf16 v[124:127], v[44:47], v[244:247], v[124:127]
 s_waitcnt lgkmcnt(2)
 v_mfma_f32_16x16x32_bf16 v[96:99], a[64:67], v[48:51], v[96:99]
 s_waitcnt vmcnt(9)
 s_barrier
 ds_read_b128 v[32:35], v6 offset:0
 v_mfma_f32_16x16x32_bf16 v[104:107], a[136:139], v[48:51], v[104:107]
 ds_read_b128 v[36:39], v6 offset:2048
 v_mfma_f32_16x16x32_bf16 v[112:115], v[48:51], a[208:211], v[112:115]
 buffer_store_dword v14, v13, s[20:23], 0 offen sc1
 v_mfma_f32_16x16x32_bf16 v[120:123], v[48:51], v[248:251], v[120:123]
 v_mfma_f32_16x16x32_bf16 v[100:103], a[64:67], v[52:55], v[100:103]
 v_mfma_f32_16x16x32_bf16 v[108:111], a[136:139], v[52:55], v[108:111]
 v_mfma_f32_16x16x32_bf16 v[116:119], v[52:55], a[208:211], v[116:119]
 v_mfma_f32_16x16x32_bf16 v[124:127], v[52:55], v[248:251], v[124:127]
 s_waitcnt lgkmcnt(2)
 v_mfma_f32_16x16x32_bf16 v[96:99], a[68:71], v[56:59], v[96:99]
 ds_read_b128 v[40:43], v7 offset:0
 v_mfma_f32_16x16x32_bf16 v[104:107], a[140:143], v[56:59], v[104:107]
 ds_read_b128 v[44:47], v7 offset:2048
 v_mfma_f32_16x16x32_bf16 v[112:115], v[56:59], a[212:215], v[112:115]
 s_mul_i32 s45, s39, 524288
 s_add_u32 s47, s34, s45
 v_mfma_f32_16x16x32_bf16 v[120:123], v[56:59], v[252:255], v[120:123]
 s_add_u32 s48, s35, s45
 v_add_u32 v14, 1, v14
 v_mfma_f32_16x16x32_bf16 v[100:103], a[68:71], v[60:63], v[100:103]
 s_mov_b32 s39, s40
 s_mov_b32 s40, s41
 v_mfma_f32_16x16x32_bf16 v[108:111], a[140:143], v[60:63], v[108:111]
 s_add_u32 s42, s42, 1
 s_cmp_lt_u32 s42, s36
 v_mfma_f32_16x16x32_bf16 v[116:119], v[60:63], a[212:215], v[116:119]
 v_mfma_f32_16x16x32_bf16 v[124:127], v[60:63], v[252:255], v[124:127]
 s_waitcnt lgkmcnt(2)
 s_cbranch_scc1 Lps_loop_18
 s_nop 7
 v_mul_f32 v96, s50, v96
 v_mul_f32 v97, s50, v97
 v_mul_f32 v98, s50, v98
 v_mul_f32 v99, s50, v99
 v_mul_f32 v104, s50, v104
 v_mul_f32 v105, s50, v105
 v_mul_f32 v106, s50, v106
 v_mul_f32 v107, s50, v107
 v_cvt_pk_bf16_f32 v16, v96, v104
 v_cvt_pk_bf16_f32 v17, v97, v105
 v_cvt_pk_bf16_f32 v18, v98, v106
 v_cvt_pk_bf16_f32 v19, v99, v107
 buffer_store_dwordx4 v[16:19], v12, s[20:23], s47 offen offset:0 sc1
 v_mul_f32 v100, s50, v100
 v_mul_f32 v101, s50, v101
 v_mul_f32 v102, s50, v102
 v_mul_f32 v103, s50, v103
 v_mul_f32 v108, s50, v108
 v_mul_f32 v109, s50, v109
 v_mul_f32 v110, s50, v110
 v_mul_f32 v111, s50, v111
 v_cvt_pk_bf16_f32 v20, v100, v108
 v_cvt_pk_bf16_f32 v21, v101, v109
 v_cvt_pk_bf16_f32 v22, v102, v110
 v_cvt_pk_bf16_f32 v23, v103, v111
 buffer_store_dwordx4 v[20:23], v12, s[20:23], s47 offen offset:1024 sc1
 v_cvt_pk_bf16_f32 v24, v112, v113
 v_cvt_pk_bf16_f32 v25, v116, v117
 v_cvt_pk_bf16_f32 v26, v114, v115
 v_cvt_pk_bf16_f32 v27, v118, v119
 buffer_store_dwordx4 v[24:27], v12, s[20:23], s48 offen offset:0 sc1
 v_cvt_pk_bf16_f32 v28, v120, v121
 v_cvt_pk_bf16_f32 v29, v124, v125
 v_cvt_pk_bf16_f32 v30, v122, v123
 v_cvt_pk_bf16_f32 v31, v126, v127
 buffer_store_dwordx4 v[28:31], v12, s[20:23], s48 offen offset:1024 sc1
 s_waitcnt vmcnt(0) lgkmcnt(0)
 s_barrier
 v_mov_b32 v14, s36
 buffer_store_dword v14, v13, s[20:23], 0 offen sc1
 s_branch Lfin
Lqa:
 s_load_dwordx2 s[8:9], s[0:1], 0
 s_mov_b32 s10, 0x240000
 s_mov_b32 s11, 0x20000
 s_load_dwordx2 s[12:13], s[0:1], 16
 s_mov_b32 s14, 0x480000
 s_mov_b32 s15, 0x20000
 s_load_dwordx2 s[16:17], s[0:1], 16
 s_mov_b32 s18, 0x480000
 s_mov_b32 s19, 0x20000
 s_cmp_eq_u32 s2, 255
 s_cbranch_scc0 Lqa1
 v_mov_b32 v4, 0
 v_mov_b32 v5, 0
 v_mov_b32 v6, 0
 v_mov_b32 v7, 0
 v_lshlrev_b32 v1, 4, v0
 s_mov_b32 s7, 0
 buffer_store_dwordx4 v[4:7], v1, s[20:23], s7 offen sc1
 s_mov_b32 s7, 4096
 buffer_store_dwordx4 v[4:7], v1, s[20:23], s7 offen sc1
 s_mov_b32 s7, 8192
 buffer_store_dwordx4 v[4:7], v1, s[20:23], s7 offen sc1
 s_mov_b32 s7, 12288
 buffer_store_dwordx4 v[4:7], v1, s[20:23], s7 offen sc1
 s_mov_b32 s7, 16384
 buffer_store_dwordx4 v[4:7], v1, s[20:23], s7 offen sc1
 v_min_u32 v1, 1, v0
 v_lshlrev_b32 v1, 28, v1
 v_mov_b32 v2, 1
 s_waitcnt vmcnt(0)
 s_barrier
 buffer_store_dword v2, v1, s[28:31], 0 offen sc1
Lqa1:
 s_sub_u32 s3, s5, 2
 s_lshl_b32 s3, s3, 3
 s_lshr_b32 s7, s6, 2
 s_add_u32 s3, s3, s7
 s_lshl_b32 s32, s3, 9
 s_add_u32 s33, s32, 256
 s_lshl_b32 s34, s3, 14
 s_add_u32 s34, s34, 0x5000000
 s_add_u32 s35, s34, 8192
 s_mov_b32 s36, 16
 s_and_b32 s37, s6, 3
 s_lshl_b32 s7, s3, 5
 s_add_u32 s7, s7, s37
 s_lshl_b32 s7, s7, 2
 s_add_u32 s7, s7, 0x3000
 v_min_u32 v1, 1, v0
 v_lshlrev_b32 v1, 28, v1
 v_add_u32 v13, s7, v1
 s_waitcnt lgkmcnt(0)
 v_and_b32 v1, 63, v0
 v_lshrrev_b32 v2, 3, v0
 v_mul_u32_u24 v10, 1152, v2
 v_lshrrev_b32 v2, 4, v0
 v_xor_b32 v2, v2, v0
 v_and_b32 v2, 7, v2
 v_lshl_add_u32 v10, v2, 4, v10
 v_lshrrev_b32 v2, 4, v1
 v_bfe_u32 v3, v1, 1, 3
 v_xor_b32 v2, v2, v3
 v_and_b32 v3, 15, v1
 v_lshlrev_b32 v3, 7, v3
 v_lshl_add_u32 v4, v2, 4, v3
 v_xor_b32 v5, 64, v4
 v_lshrrev_b32 v2, 4, v0
 v_lshlrev_b32 v11, 13, v2
 v_lshrrev_b32 v2, 7, v0
 v_lshrrev_b32 v3, 4, v1
 v_lshl_add_u32 v3, v2, 2, v3
 v_bfe_u32 v2, v1, 1, 3
 v_xor_b32 v2, v2, v3
 v_lshl_add_u32 v11, v2, 5, v11
 v_and_b32 v2, 1, v1
 v_lshl_add_u32 v11, v2, 4, v11
 v_bfe_u32 v2, v1, 2, 3
 v_xor_b32 v3, s4, v2
 v_lshlrev_b32 v3, 5, v3
 v_and_b32 v2, 3, v2
 v_lshl_add_u32 v3, v2, 8, v3
 v_lshrrev_b32 v2, 4, v1
 v_lshl_add_u32 v3, v2, 11, v3
 v_and_b32 v2, 3, v1
 v_lshl_add_u32 v3, v2, 3, v3
 v_add_u32 v8, 73728, v3
 v_xor_b32 v3, 0x80, v3
 v_add_u32 v9, 73728, v3
 s_lshl_b32 s45, s4, 11
 v_lshl_add_u32 v12, v1, 4, s45
 s_mov_b32 s39, s37
 s_add_u32 s40, s39, 4
 s_lshl_b32 s49, s4, 10
 s_mul_i32 s46, s39, 36864
 s_add_u32 m0, s49, 0
 s_nop 0
 buffer_load_dwordx4 v10, s[8:11], s46 offen offset:0  lds
 s_add_u32 m0, s49, 3968
 s_nop 0
 buffer_load_dwordx4 v10, s[8:11], s46 offen offset:128  lds
 s_add_u32 m0, s49, 7936
 s_nop 0
 buffer_load_dwordx4 v10, s[8:11], s46 offen offset:256  lds
 s_add_u32 m0, s49, 11904
 s_nop 0
 buffer_load_dwordx4 v10, s[8:11], s46 offen offset:384  lds
 s_add_u32 m0, s49, 15872
 s_nop 0
 buffer_load_dwordx4 v10, s[8:11], s46 offen offset:512  lds
 s_add_u32 m0, s49, 19840
 s_nop 0
 buffer_load_dwordx4 v10, s[8:11], s46 offen offset:640  lds
 s_add_u32 m0, s49, 23808
 s_nop 0
 buffer_load_dwordx4 v10, s[8:11], s46 offen offset:768  lds
 s_add_u32 m0, s49, 27776
 s_nop 0
 buffer_load_dwordx4 v10, s[8:11], s46 offen offset:896  lds
 s_add_u32 m0, s49, 31744
 s_nop 0
 buffer_load_dwordx4 v10, s[8:11], s46 offen offset:1024  lds
 s_lshl_b32 s49, s4, 10
 s_add_u32 s49, s49, 36864
 s_mul_i32 s46, s40, 36864
 s_add_u32 m0, s49, 0
 s_nop 0
 buffer_load_dwordx4 v10, s[8:11], s46 offen offset:0  lds
 s_add_u32 m0, s49, 3968
 s_nop 0
 buffer_load_dwordx4 v10, s[8:11], s46 offen offset:128  lds
 s_add_u32 m0, s49, 7936
 s_nop 0
 buffer_load_dwordx4 v10, s[8:11], s46 offen offset:256  lds
 s_add_u32 m0, s49, 11904
 s_nop 0
 buffer_load_dwordx4 v10, s[8:11], s46 offen offset:384  lds
 s_add_u32 m0, s49, 15872
 s_nop 0
 buffer_load_dwordx4 v10, s[8:11], s46 offen offset:512  lds
 s_add_u32 m0, s49, 19840
 s_nop 0
 buffer_load_dwordx4 v10, s[8:11], s46 offen offset:640  lds
 s_add_u32 m0, s49, 23808
 s_nop 0
 buffer_load_dwordx4 v10, s[8:11], s46 offen offset:768  lds
 s_add_u32 m0, s49, 27776
 s_nop 0
 buffer_load_dwordx4 v10, s[8:11], s46 offen offset:896  lds
 s_add_u32 m0, s49, 31744
 s_nop 0
 buffer_load_dwordx4 v10, s[8:11], s46 offen offset:1024  lds
 s_lshl_b32 s49, s4, 10
 s_add_u32 m0, s49, 73728
 s_add_u32 s45, s32, 0
 buffer_load_dwordx4 v11, s[12:15], s45 offen  lds
 s_add_u32 m0, s49, 77824
 s_add_u32 s45, s32, 131072
 buffer_load_dwordx4 v11, s[12:15], s45 offen  lds
 s_add_u32 m0, s49, 81920
 s_add_u32 s45, s33, 0
 buffer_load_dwordx4 v11, s[16:19], s45 offen  lds
 s_add_u32 m0, s49, 86016
 s_add_u32 s45, s33, 131072
 buffer_load_dwordx4 v11, s[16:19], s45 offen  lds
 s_add_u32 m0, s49, 90112
 s_add_u32 s45, s32, 262144
 buffer_load_dwordx4 v11, s[12:15], s45 offen  lds
 s_add_u32 m0, s49, 94208
 s_add_u32 s45, s32, 393216
 buffer_load_dwordx4 v11, s[12:15], s45 offen  lds
 s_add_u32 m0, s49, 98304
 s_add_u32 s45, s33, 262144
 buffer_load_dwordx4 v11, s[16:19], s45 offen  lds
 s_add_u32 m0, s49, 102400
 s_add_u32 s45, s33, 393216
 buffer_load_dwordx4 v11, s[16:19], s45 offen  lds
 s_add_u32 m0, s49, 106496
 s_add_u32 s45, s32, 524288
 buffer_load_dwordx4 v11, s[12:15], s45 offen  lds
 s_add_u32 m0, s49, 110592
 s_add_u32 s45, s32, 655360
 buffer_load_dwordx4 v11, s[12:15], s45 offen  lds
 s_add_u32 m0, s49, 114688
 s_add_u32 s45, s33, 524288
 buffer_load_dwordx4 v11, s[16:19], s45 offen  lds
 s_add_u32 m0, s49, 118784
 s_add_u32 s45, s33, 655360
 buffer_load_dwordx4 v11, s[16:19], s45 offen  lds
 s_waitcnt vmcnt(8) lgkmcnt(0)
 s_barrier
 s_add_u32 m0, s49, 122880
 s_add_u32 s45, s32, 786432
 buffer_load_dwordx4 v11, s[12:15], s45 offen  lds
 s_add_u32 m0, s49, 126976
 s_add_u32 s45, s32, 917504
 buffer_load_dwordx4 v11, s[12:15], s45 offen  lds
 s_add_u32 m0, s49, 131072
 s_add_u32 s45, s33, 786432
 buffer_load_dwordx4 v11, s[16:19], s45 offen  lds
 s_add_u32 m0, s49, 135168
 s_add_u32 s45, s33, 917504
 buffer_load_dwordx4 v11, s[16:19], s45 offen  lds
 ds_read_b64_tr_b16 a[0:1], v8 offset:0
 ds_read_b64_tr_b16 a[2:3], v8 offset:1024
 ds_read_b64_tr_b16 a[72:73], v9 offset:0
 ds_read_b64_tr_b16 a[74:75], v9 offset:1024
 ds_read_b64_tr_b16 a[144:145], v8 offset:8192
 ds_read_b64_tr_b16 a[146:147], v8 offset:9216
 ds_read_b64_tr_b16 a[216:217], v9 offset:8192
 ds_read_b64_tr_b16 a[218:219], v9 offset:9216
 s_waitcnt vmcnt(8) lgkmcnt(0)
 s_barrier
 s_add_u32 m0, s49, 73728
 s_add_u32 s45, s32, 1048576
 buffer_load_dwordx4 v11, s[12:15], s45 offen  lds
 s_add_u32 m0, s49, 77824
 s_add_u32 s45, s32, 1179648
 buffer_load_dwordx4 v11, s[12:15], s45 offen  lds
 s_add_u32 m0, s49, 81920
 s_add_u32 s45, s33, 1048576
 buffer_load_dwordx4 v11, s[16:19], s45 offen  lds
 s_add_u32 m0, s49, 86016
 s_add_u32 s45, s33, 1179648
 buffer_load_dwordx4 v11, s[16:19], s45 offen  lds
 ds_read_b64_tr_b16 a[4:5], v8 offset:16384
 ds_read_b64_tr_b16 a[6:7], v8 offset:17408
 ds_read_b64_tr_b16 a[76:77], v9 offset:16384
 ds_read_b64_tr_b16 a[78:79], v9 offset:17408
 ds_read_b64_tr_b16 a[148:149], v8 offset:24576
 ds_read_b64_tr_b16 a[150:151], v8 offset:25600
 ds_read_b64_tr_b16 a[220:221], v9 offset:24576
 ds_read_b64_tr_b16 a[222:223], v9 offset:25600
 s_waitcnt vmcnt(8) lgkmcnt(0)
 s_barrier
 s_add_u32 m0, s49, 90112
 s_add_u32 s45, s32, 1310720
 buffer_load_dwordx4 v11, s[12:15], s45 offen  lds
 s_add_u32 m0, s49, 94208
 s_add_u32 s45, s32, 1441792
 buffer_load_dwordx4 v11, s[12:15], s45 offen  lds
 s_add_u32 m0, s49, 98304
 s_add_u32 s45, s33, 1310720
 buffer_load_dwordx4 v11, s[16:19], s45 offen  lds
 s_add_u32 m0, s49, 102400
 s_add_u32 s45, s33, 1441792
 buffer_load_dwordx4 v11, s[16:19], s45 offen  lds
 ds_read_b64_tr_b16 a[8:9], v8 offset:32768
 ds_read_b64_tr_b16 a[10:11], v8 offset:33792
 ds_read_b64_tr_b16 a[80:81], v9 offset:32768
 ds_read_b64_tr_b16 a[82:83], v9 offset:33792
 ds_read_b64_tr_b16 a[152:153], v8 offset:40960
 ds_read_b64_tr_b16 a[154:155], v8 offset:41984
 ds_read_b64_tr_b16 a[224:225], v9 offset:40960
 ds_read_b64_tr_b16 a[226:227], v9 offset:41984
 s_waitcnt vmcnt(8) lgkmcnt(0)
 s_barrier
 s_add_u32 m0, s49, 106496
 s_add_u32 s45, s32, 1572864
 buffer_load_dwordx4 v11, s[12:15], s45 offen  lds
 s_add_u32 m0, s49, 110592
 s_add_u32 s45, s32, 1703936
 buffer_load_dwordx4 v11, s[12:15], s45 offen  lds
 s_add_u32 m0, s49, 114688
 s_add_u32 s45, s33, 1572864
 buffer_load_dwordx4 v11, s[16:19], s45 offen  lds
 s_add_u32 m0, s49, 118784
 s_add_u32 s45, s33, 1703936
 buffer_load_dwordx4 v11, s[16:19], s45 offen  lds
 ds_read_b64_tr_b16 a[12:13], v8 offset:49152
 ds_read_b64_tr_b16 a[14:15], v8 offset:50176
 ds_read_b64_tr_b16 a[84:85], v9 offset:49152
 ds_read_b64_tr_b16 a[86:87], v9 offset:50176
 ds_read_b64_tr_b16 a[156:157], v8 offset:57344
 ds_read_b64_tr_b16 a[158:159], v8 offset:58368
 ds_read_b64_tr_b16 a[228:229], v9 offset:57344
 ds_read_b64_tr_b16 a[230:231], v9 offset:58368
 s_waitcnt vmcnt(8) lgkmcnt(0)
 s_barrier
 s_add_u32 m0, s49, 122880
 s_add_u32 s45, s32, 1835008
 buffer_load_dwordx4 v11, s[12:15], s45 offen  lds
 s_add_u32 m0, s49, 126976
 s_add_u32 s45, s32, 1966080
 buffer_load_dwordx4 v11, s[12:15], s45 offen  lds
 s_add_u32 m0, s49, 131072
 s_add_u32 s45, s33, 1835008
 buffer_load_dwordx4 v11, s[16:19], s45 offen  lds
 s_add_u32 m0, s49, 135168
 s_add_u32 s45, s33, 1966080
 buffer_load_dwordx4 v11, s[16:19], s45 offen  lds
 ds_read_b64_tr_b16 a[16:17], v8 offset:0
 ds_read_b64_tr_b16 a[18:19], v8 offset:1024
 ds_read_b64_tr_b16 a[88:89], v9 offset:0
 ds_read_b64_tr_b16 a[90:91], v9 offset:1024
 ds_read_b64_tr_b16 a[160:161], v8 offset:8192
 ds_read_b64_tr_b16 a[162:163], v8 offset:9216
 ds_read_b64_tr_b16 a[232:233], v9 offset:8192
 ds_read_b64_tr_b16 a[234:235], v9 offset:9216
 s_waitcnt vmcnt(8) lgkmcnt(0)
 s_barrier
 s_add_u32 m0, s49, 73728
 s_add_u32 s45, s32, 2097152
 buffer_load_dwordx4 v11, s[12:15], s45 offen  lds
 s_add_u32 m0, s49, 77824
 s_add_u32 s45, s32, 2228224
 buffer_load_dwordx4 v11, s[12:15], s45 offen  lds
 s_add_u32 m0, s49, 81920
 s_add_u32 s45, s33, 2097152
 buffer_load_dwordx4 v11, s[16:19], s45 offen  lds
 s_add_u32 m0, s49, 86016
 s_add_u32 s45, s33, 2228224
 buffer_load_dwordx4 v11, s[16:19], s45 offen  lds
 ds_read_b64_tr_b16 a[20:21], v8 offset:16384
 ds_read_b64_tr_b16 a[22:23], v8 offset:17408
 ds_read_b64_tr_b16 a[92:93], v9 offset:16384
 ds_read_b64_tr_b16 a[94:95], v9 offset:17408
 ds_read_b64_tr_b16 a[164:165], v8 offset:24576
 ds_read_b64_tr_b16 a[166:167], v8 offset:25600
 ds_read_b64_tr_b16 a[236:237], v9 offset:24576
 ds_read_b64_tr_b16 a[238:239], v9 offset:25600
 s_waitcnt vmcnt(8) lgkmcnt(0)
 s_barrier
 s_add_u32 m0, s49, 90112
 s_add_u32 s45, s32, 2359296
 buffer_load_dwordx4 v11, s[12:15], s45 offen  lds
 s_add_u32 m0, s49, 94208
 s_add_u32 s45, s32, 2490368
 buffer_load_dwordx4 v11, s[12:15], s45 offen  lds
 s_add_u32 m0, s49, 98304
 s_add_u32 s45, s33, 2359296
 buffer_load_dwordx4 v11, s[16:19], s45 offen  lds
 s_add_u32 m0, s49, 102400
 s_add_u32 s45, s33, 2490368
 buffer_load_dwordx4 v11, s[16:19], s45 offen  lds
 ds_read_b64_tr_b16 a[24:25], v8 offset:32768
 ds_read_b64_tr_b16 a[26:27], v8 offset:33792
 ds_read_b64_tr_b16 a[96:97], v9 offset:32768
 ds_read_b64_tr_b16 a[98:99], v9 offset:33792
 ds_read_b64_tr_b16 a[168:169], v8 offset:40960
 ds_read_b64_tr_b16 a[170:171], v8 offset:41984
 ds_read_b64_tr_b16 a[240:241], v9 offset:40960
 ds_read_b64_tr_b16 a[242:243], v9 offset:41984
 s_waitcnt vmcnt(8) lgkmcnt(0)
 s_barrier
 s_add_u32 m0, s49, 106496
 s_add_u32 s45, s32, 2621440
 buffer_load_dwordx4 v11, s[12:15], s45 offen  lds
 s_add_u32 m0, s49, 110592
 s_add_u32 s45, s32, 2752512
 buffer_load_dwordx4 v11, s[12:15], s45 offen  lds
 s_add_u32 m0, s49, 114688
 s_add_u32 s45, s33, 2621440
 buffer_load_dwordx4 v11, s[16:19], s45 offen  lds
 s_add_u32 m0, s49, 118784
 s_add_u32 s45, s33, 2752512
 buffer_load_dwordx4 v11, s[16:19], s45 offen  lds
 ds_read_b64_tr_b16 a[28:29], v8 offset:49152
 ds_read_b64_tr_b16 a[30:31], v8 offset:50176
 ds_read_b64_tr_b16 a[100:101], v9 offset:49152
 ds_read_b64_tr_b16 a[102:103], v9 offset:50176
 ds_read_b64_tr_b16 a[172:173], v8 offset:57344
 ds_read_b64_tr_b16 a[174:175], v8 offset:58368
 ds_read_b64_tr_b16 a[244:245], v9 offset:57344
 ds_read_b64_tr_b16 a[246:247], v9 offset:58368
 s_waitcnt vmcnt(8) lgkmcnt(0)
 s_barrier
 s_add_u32 m0, s49, 122880
 s_add_u32 s45, s32, 2883584
 buffer_load_dwordx4 v11, s[12:15], s45 offen  lds
 s_add_u32 m0, s49, 126976
 s_add_u32 s45, s32, 3014656
 buffer_load_dwordx4 v11, s[12:15], s45 offen  lds
 s_add_u32 m0, s49, 131072
 s_add_u32 s45, s33, 2883584
 buffer_load_dwordx4 v11, s[16:19], s45 offen  lds
 s_add_u32 m0, s49, 135168
 s_add_u32 s45, s33, 3014656
 buffer_load_dwordx4 v11, s[16:19], s45 offen  lds
 ds_read_b64_tr_b16 a[32:33], v8 offset:0
 ds_read_b64_tr_b16 a[34:35], v8 offset:1024
 ds_read_b64_tr_b16 a[104:105], v9 offset:0
 ds_read_b64_tr_b16 a[106:107], v9 offset:1024
 ds_read_b64_tr_b16 a[176:177], v8 offset:8192
 ds_read_b64_tr_b16 a[178:179], v8 offset:9216
 ds_read_b64_tr_b16 a[248:249], v9 offset:8192
 ds_read_b64_tr_b16 a[250:251], v9 offset:9216
 s_waitcnt vmcnt(8) lgkmcnt(0)
 s_barrier
 s_add_u32 m0, s49, 73728
 s_add_u32 s45, s32, 3145728
 buffer_load_dwordx4 v11, s[12:15], s45 offen  lds
 s_add_u32 m0, s49, 77824
 s_add_u32 s45, s32, 3276800
 buffer_load_dwordx4 v11, s[12:15], s45 offen  lds
 s_add_u32 m0, s49, 81920
 s_add_u32 s45, s33, 3145728
 buffer_load_dwordx4 v11, s[16:19], s45 offen  lds
 s_add_u32 m0, s49, 86016
 s_add_u32 s45, s33, 3276800
 buffer_load_dwordx4 v11, s[16:19], s45 offen  lds
 ds_read_b64_tr_b16 a[36:37], v8 offset:16384
 ds_read_b64_tr_b16 a[38:39], v8 offset:17408
 ds_read_b64_tr_b16 a[108:109], v9 offset:16384
 ds_read_b64_tr_b16 a[110:111], v9 offset:17408
 ds_read_b64_tr_b16 a[180:181], v8 offset:24576
 ds_read_b64_tr_b16 a[182:183], v8 offset:25600
 ds_read_b64_tr_b16 a[252:253], v9 offset:24576
 ds_read_b64_tr_b16 a[254:255], v9 offset:25600
 s_waitcnt vmcnt(8) lgkmcnt(0)
 s_barrier
 s_add_u32 m0, s49, 90112
 s_add_u32 s45, s32, 3407872
 buffer_load_dwordx4 v11, s[12:15], s45 offen  lds
 s_add_u32 m0, s49, 94208
 s_add_u32 s45, s32, 3538944
 buffer_load_dwordx4 v11, s[12:15], s45 offen  lds
 s_add_u32 m0, s49, 98304
 s_add_u32 s45, s33, 3407872
 buffer_load_dwordx4 v11, s[16:19], s45 offen  lds
 s_add_u32 m0, s49, 102400
 s_add_u32 s45, s33, 3538944
 buffer_load_dwordx4 v11, s[16:19], s45 offen  lds
 ds_read_b64_tr_b16 a[40:41], v8 offset:32768
 ds_read_b64_tr_b16 a[42:43], v8 offset:33792
 ds_read_b64_tr_b16 a[112:113], v9 offset:32768
 ds_read_b64_tr_b16 a[114:115], v9 offset:33792
 ds_read_b64_tr_b16 a[184:185], v8 offset:40960
 ds_read_b64_tr_b16 a[186:187], v8 offset:41984
 ds_read_b64_tr_b16 v[224:225], v9 offset:40960
 ds_read_b64_tr_b16 v[226:227], v9 offset:41984
 s_waitcnt vmcnt(8) lgkmcnt(0)
 s_barrier
 s_add_u32 m0, s49, 106496
 s_add_u32 s45, s32, 3670016
 buffer_load_dwordx4 v11, s[12:15], s45 offen  lds
 s_add_u32 m0, s49, 110592
 s_add_u32 s45, s32, 3801088
 buffer_load_dwordx4 v11, s[12:15], s45 offen  lds
 s_add_u32 m0, s49, 114688
 s_add_u32 s45, s33, 3670016
 buffer_load_dwordx4 v11, s[16:19], s45 offen  lds
 s_add_u32 m0, s49, 118784
 s_add_u32 s45, s33, 3801088
 buffer_load_dwordx4 v11, s[16:19], s45 offen  lds
 ds_read_b64_tr_b16 a[44:45], v8 offset:49152
 ds_read_b64_tr_b16 a[46:47], v8 offset:50176
 ds_read_b64_tr_b16 a[116:117], v9 offset:49152
 ds_read_b64_tr_b16 a[118:119], v9 offset:50176
 ds_read_b64_tr_b16 a[188:189], v8 offset:57344
 ds_read_b64_tr_b16 a[190:191], v8 offset:58368
 ds_read_b64_tr_b16 v[228:229], v9 offset:57344
 ds_read_b64_tr_b16 v[230:231], v9 offset:58368
 s_waitcnt vmcnt(8) lgkmcnt(0)
 s_barrier
 s_add_u32 m0, s49, 122880
 s_add_u32 s45, s32, 3932160
 buffer_load_dwordx4 v11, s[12:15], s45 offen  lds
 s_add_u32 m0, s49, 126976
 s_add_u32 s45, s32, 4063232
 buffer_load_dwordx4 v11, s[12:15], s45 offen  lds
 s_add_u32 m0, s49, 131072
 s_add_u32 s45, s33, 3932160
 buffer_load_dwordx4 v11, s[16:19], s45 offen  lds
 s_add_u32 m0, s49, 135168
 s_add_u32 s45, s33, 4063232
 buffer_load_dwordx4 v11, s[16:19], s45 offen  lds
 ds_read_b64_tr_b16 a[48:49], v8 offset:0
 ds_read_b64_tr_b16 a[50:51], v8 offset:1024
 ds_read_b64_tr_b16 a[120:121], v9 offset:0
 ds_read_b64_tr_b16 a[122:123], v9 offset:1024
 ds_read_b64_tr_b16 a[192:193], v8 offset:8192
 ds_read_b64_tr_b16 a[194:195], v8 offset:9216
 ds_read_b64_tr_b16 v[232:233], v9 offset:8192
 ds_read_b64_tr_b16 v[234:235], v9 offset:9216
 s_waitcnt vmcnt(8) lgkmcnt(0)
 s_barrier
 s_add_u32 m0, s49, 73728
 s_add_u32 s45, s32, 4194304
 buffer_load_dwordx4 v11, s[12:15], s45 offen  lds
 s_add_u32 m0, s49, 77824
 s_add_u32 s45, s32, 4325376
 buffer_load_dwordx4 v11, s[12:15], s45 offen  lds
 s_add_u32 m0, s49, 81920
 s_add_u32 s45, s33, 4194304
 buffer_load_dwordx4 v11, s[16:19], s45 offen  lds
 s_add_u32 m0, s49, 86016
 s_add_u32 s45, s33, 4325376
 buffer_load_dwordx4 v11, s[16:19], s45 offen  lds
 ds_read_b64_tr_b16 a[52:53], v8 offset:16384
 ds_read_b64_tr_b16 a[54:55], v8 offset:17408
 ds_read_b64_tr_b16 a[124:125], v9 offset:16384
 ds_read_b64_tr_b16 a[126:127], v9 offset:17408
 ds_read_b64_tr_b16 a[196:197], v8 offset:24576
 ds_read_b64_tr_b16 a[198:199], v8 offset:25600
 ds_read_b64_tr_b16 v[236:237], v9 offset:24576
 ds_read_b64_tr_b16 v[238:239], v9 offset:25600
 s_waitcnt vmcnt(8) lgkmcnt(0)
 s_barrier
 s_add_u32 m0, s49, 90112
 s_add_u32 s45, s32, 4456448
 buffer_load_dwordx4 v11, s[12:15], s45 offen  lds
 s_add_u32 m0, s49, 94208
 s_add_u32 s45, s32, 4587520
 buffer_load_dwordx4 v11, s[12:15], s45 offen  lds
 s_add_u32 m0, s49, 98304
 s_add_u32 s45, s33, 4456448
 buffer_load_dwordx4 v11, s[16:19], s45 offen  lds
 s_add_u32 m0, s49, 102400
 s_add_u32 s45, s33, 4587520
 buffer_load_dwordx4 v11, s[16:19], s45 offen  lds
 ds_read_b64_tr_b16 a[56:57], v8 offset:32768
 ds_read_b64_tr_b16 a[58:59], v8 offset:33792
 ds_read_b64_tr_b16 a[128:129], v9 offset:32768
 ds_read_b64_tr_b16 a[130:131], v9 offset:33792
 ds_read_b64_tr_b16 a[200:201], v8 offset:40960
 ds_read_b64_tr_b16 a[202:203], v8 offset:41984
 ds_read_b64_tr_b16 v[240:241], v9 offset:40960
 ds_read_b64_tr_b16 v[242:243], v9 offset:41984
 s_waitcnt vmcnt(8) lgkmcnt(0)
 s_barrier
 ds_read_b64_tr_b16 a[60:61], v8 offset:49152
 ds_read_b64_tr_b16 a[62:63], v8 offset:50176
 ds_read_b64_tr_b16 a[132:133], v9 offset:49152
 ds_read_b64_tr_b16 a[134:135], v9 offset:50176
 ds_read_b64_tr_b16 a[204:205], v8 offset:57344
 ds_read_b64_tr_b16 a[206:207], v8 offset:58368
 ds_read_b64_tr_b16 v[244:245], v9 offset:57344
 ds_read_b64_tr_b16 v[246:247], v9 offset:58368
 s_waitcnt vmcnt(4) lgkmcnt(0)
 s_barrier
 ds_read_b64_tr_b16 a[64:65], v8 offset:0
 ds_read_b64_tr_b16 a[66:67], v8 offset:1024
 ds_read_b64_tr_b16 a[136:137], v9 offset:0
 ds_read_b64_tr_b16 a[138:139], v9 offset:1024
 ds_read_b64_tr_b16 a[208:209], v8 offset:8192
 ds_read_b64_tr_b16 a[210:211], v8 offset:9216
 ds_read_b64_tr_b16 v[248:249], v9 offset:8192
 ds_read_b64_tr_b16 v[250:251], v9 offset:9216
 s_waitcnt vmcnt(0) lgkmcnt(0)
 s_barrier
 ds_read_b64_tr_b16 a[68:69], v8 offset:16384
 ds_read_b64_tr_b16 a[70:71], v8 offset:17408
 ds_read_b64_tr_b16 a[140:141], v9 offset:16384
 ds_read_b64_tr_b16 a[142:143], v9 offset:17408
 ds_read_b64_tr_b16 a[212:213], v8 offset:24576
 ds_read_b64_tr_b16 a[214:215], v8 offset:25600
 ds_read_b64_tr_b16 v[252:253], v9 offset:24576
 ds_read_b64_tr_b16 v[254:255], v9 offset:25600
 s_mov_b32 s50, 0x3e0293ee
 s_mov_b32 s42, 0
 s_mov_b32 s43, 0
 s_mov_b32 s44, 73728
 v_mov_b32 v6, v4
 v_mov_b32 v7, v5
 s_mov_b32 s95, 0x40000
 s_cmp_lg_u32 s4, 0
 s_cbranch_scc1 Lfrk_20
 v_min_u32 v21, 1, v0
 v_lshlrev_b32 v21, 28, v21
Lfr_19:
 buffer_load_dword v20, v21, s[28:31], 0 offen offset:128 sc1
 s_waitcnt vmcnt(0)
 v_cmp_eq_u32 vcc, 1, v20
 s_cbranch_vccnz Lfrk_20
 s_sleep 12
 s_sub_u32 s95, s95, 1
 s_cbranch_scc0 Lfr_19
 s_endpgm
Lfrk_20:
 s_lshl_b32 s47, s2, 13
 s_add_u32 s47, s47, 0x8000000
 s_mov_b32 s48, s47
 v_mov_b32 v14, 0
 s_waitcnt vmcnt(0) lgkmcnt(0)
 s_barrier
 ds_read_b128 v[32:35], v6 offset:0
 ds_read_b128 v[36:39], v6 offset:2048
 ds_read_b128 v[40:43], v7 offset:0
 ds_read_b128 v[44:47], v7 offset:2048
 v_lshlrev_b32 v1, 12, v0
 s_lshl_b32 s45, s6, 7
 buffer_load_dword v15, v1, s[8:11], s45 offen
 v_add_u32 v1, 0x100000, v1
 buffer_load_dword v15, v1, s[8:11], s45 offen
 v_add_u32 v1, 0x100000, v1
 buffer_load_dword v15, v1, s[8:11], s45 offen
 v_add_u32 v1, 0x100000, v1
 s_waitcnt lgkmcnt(2)
Lps_loop_21:
 v_mfma_f32_16x16x32_bf16 v[64:67], a[0:3], v[32:35], 0
 ds_read_b128 v[48:51], v6 offset:4096
 v_mfma_f32_16x16x32_bf16 v[72:75], a[72:75], v[32:35], 0
 ds_read_b128 v[52:55], v6 offset:6144
 v_mfma_f32_16x16x32_bf16 v[80:83], a[144:147], v[32:35], 0
 s_add_u32 s41, s40, 4
 v_mfma_f32_16x16x32_bf16 v[88:91], a[216:219], v[32:35], 0
 s_add_u32 s45, s42, 2
 s_mul_i32 s46, s41, 36864
 v_mfma_f32_16x16x32_bf16 v[68:71], a[0:3], v[36:39], 0
 s_cmp_lt_u32 s45, s36
 s_cselect_b32 s46, s46, 0
 v_mfma_f32_16x16x32_bf16 v[76:79], a[72:75], v[36:39], 0
 s_lshl_b32 s49, s4, 10
 s_add_u32 s49, s49, s44
 v_mfma_f32_16x16x32_bf16 v[84:87], a[144:147], v[36:39], 0
 v_mfma_f32_16x16x32_bf16 v[92:95], a[216:219], v[36:39], 0
 s_waitcnt lgkmcnt(2)
 v_mfma_f32_16x16x32_bf16 v[64:67], a[4:7], v[40:43], v[64:67]
 ds_read_b128 v[56:59], v7 offset:4096
 v_mfma_f32_16x16x32_bf16 v[72:75], a[76:79], v[40:43], v[72:75]
 ds_read_b128 v[60:63], v7 offset:6144
 v_mfma_f32_16x16x32_bf16 v[80:83], a[148:151], v[40:43], v[80:83]
 s_add_u32 m0, s49, 0
 v_mfma_f32_16x16x32_bf16 v[88:91], a[220:223], v[40:43], v[88:91]
 buffer_load_dwordx4 v10, s[8:11], s46 offen offset:0  lds
 v_mfma_f32_16x16x32_bf16 v[68:71], a[4:7], v[44:47], v[68:71]
 s_add_u32 m0, s49, 3968
 v_mfma_f32_16x16x32_bf16 v[76:79], a[76:79], v[44:47], v[76:79]
 buffer_load_dwordx4 v10, s[8:11], s46 offen offset:128  lds
 v_mfma_f32_16x16x32_bf16 v[84:87], a[148:151], v[44:47], v[84:87]
 v_mfma_f32_16x16x32_bf16 v[92:95], a[220:223], v[44:47], v[92:95]
 s_waitcnt lgkmcnt(2)
 v_mfma_f32_16x16x32_bf16 v[64:67], a[8:11], v[48:51], v[64:67]
 ds_read_b128 v[32:35], v6 offset:8192
 v_mfma_f32_16x16x32_bf16 v[72:75], a[80:83], v[48:51], v[72:75]
 ds_read_b128 v[36:39], v6 offset:10240
 v_mfma_f32_16x16x32_bf16 v[80:83], a[152:155], v[48:51], v[80:83]
 s_add_u32 m0, s49, 7936
 v_mfma_f32_16x16x32_bf16 v[88:91], a[224:227], v[48:51], v[88:91]
 buffer_load_dwordx4 v10, s[8:11], s46 offen offset:256  lds
 v_mfma_f32_16x16x32_bf16 v[68:71], a[8:11], v[52:55], v[68:71]
 s_add_u32 m0, s49, 11904
 v_mfma_f32_16x16x32_bf16 v[76:79], a[80:83], v[52:55], v[76:79]
 buffer_load_dwordx4 v10, s[8:11], s46 offen offset:384  lds
 v_mfma_f32_16x16x32_bf16 v[84:87], a[152:155], v[52:55], v[84:87]
 v_mfma_f32_16x16x32_bf16 v[92:95], a[224:227], v[52:55], v[92:95]
 s_waitcnt lgkmcnt(2)
 v_mfma_f32_16x16x32_bf16 v[64:67], a[12:15], v[56:59], v[64:67]
 ds_read_b128 v[40:43], v7 offset:8192
 v_mfma_f32_16x16x32_bf16 v[72:75], a[84:87], v[56:59], v[72:75]
 ds_read_b128 v[44:47], v7 offset:10240
 v_mfma_f32_16x16x32_bf16 v[80:83], a[156:159], v[56:59], v[80:83]
 s_add_u32 m0, s49, 15872
 v_mfma_f32_16x16x32_bf16 v[88:91], a[228:231], v[56:59], v[88:91]
 buffer_load_dwordx4 v10, s[8:11], s46 offen offset:512  lds
 v_mfma_f32_16x16x32_bf16 v[68:71], a[12:15], v[60:63], v[68:71]
 s_add_u32 m0, s49, 19840
 v_mfma_f32_16x16x32_bf16 v[76:79], a[84:87], v[60:63], v[76:79]
 buffer_load_dwordx4 v10, s[8:11], s46 offen offset:640  lds
 v_mfma_f32_16x16x32_bf16 v[84:87], a[156:159], v[60:63], v[84:87]
 v_mfma_f32_16x16x32_bf16 v[92:95], a[228:231], v[60:63], v[92:95]
 s_waitcnt lgkmcnt(2)
 v_mfma_f32_16x16x32_bf16 v[64:67], a[16:19], v[32:35], v[64:67]
 ds_read_b128 v[48:51], v6 offset:12288
 v_mfma_f32_16x16x32_bf16 v[72:75], a[88:91], v[32:35], v[72:75]
 ds_read_b128 v[52:55], v6 offset:14336
 v_mfma_f32_16x16x32_bf16 v[80:83], a[160:163], v[32:35], v[80:83]
 s_add_u32 m0, s49, 23808
 v_mfma_f32_16x16x32_bf16 v[88:91], a[232:235], v[32:35], v[88:91]
 buffer_load_dwordx4 v10, s[8:11], s46 offen offset:768  lds
 v_mfma_f32_16x16x32_bf16 v[68:71], a[16:19], v[36:39], v[68:71]
 s_add_u32 m0, s49, 27776
 v_mfma_f32_16x16x32_bf16 v[76:79], a[88:91], v[36:39], v[76:79]
 buffer_load_dwordx4 v10, s[8:11], s46 offen offset:896  lds
 v_mfma_f32_16x16x32_bf16 v[84:87], a[160:163], v[36:39], v[84:87]
 v_mfma_f32_16x16x32_bf16 v[92:95], a[232:235], v[36:39], v[92:95]
 s_waitcnt lgkmcnt(2)
 v_mfma_f32_16x16x32_bf16 v[64:67], a[20:23], v[40:43], v[64:67]
 ds_read_b128 v[56:59], v7 offset:12288
 v_mfma_f32_16x16x32_bf16 v[72:75], a[92:95], v[40:43], v[72:75]
 ds_read_b128 v[60:63], v7 offset:14336
 v_mfma_f32_16x16x32_bf16 v[80:83], a[164:167], v[40:43], v[80:83]
 s_add_u32 m0, s49, 31744
 v_mfma_f32_16x16x32_bf16 v[88:91], a[236:239], v[40:43], v[88:91]
 buffer_load_dwordx4 v10, s[8:11], s46 offen offset:1024  lds
 v_mfma_f32_16x16x32_bf16 v[68:71], a[20:23], v[44:47], v[68:71]
 v_mfma_f32_16x16x32_bf16 v[76:79], a[92:95], v[44:47], v[76:79]
 v_mfma_f32_16x16x32_bf16 v[84:87], a[164:167], v[44:47], v[84:87]
 v_mfma_f32_16x16x32_bf16 v[92:95], a[236:239], v[44:47], v[92:95]
 s_waitcnt lgkmcnt(2)
 v_mfma_f32_16x16x32_bf16 v[64:67], a[24:27], v[48:51], v[64:67]
 ds_read_b128 v[32:35], v6 offset:16384
 v_mul_f32 v96, s50, v96
 v_mfma_f32_16x16x32_bf16 v[72:75], a[96:99], v[48:51], v[72:75]
 ds_read_b128 v[36:39], v6 offset:18432
 v_mfma_f32_16x16x32_bf16 v[80:83], a[168:171], v[48:51], v[80:83]
 v_mul_f32 v97, s50, v97
 v_mfma_f32_16x16x32_bf16 v[88:91], a[240:243], v[48:51], v[88:91]
 v_mul_f32 v98, s50, v98
 v_mfma_f32_16x16x32_bf16 v[68:71], a[24:27], v[52:55], v[68:71]
 v_mul_f32 v99, s50, v99
 v_mfma_f32_16x16x32_bf16 v[76:79], a[96:99], v[52:55], v[76:79]
 v_mul_f32 v104, s50, v104
 v_mfma_f32_16x16x32_bf16 v[84:87], a[168:171], v[52:55], v[84:87]
 v_mul_f32 v105, s50, v105
 v_mfma_f32_16x16x32_bf16 v[92:95], a[240:243], v[52:55], v[92:95]
 s_waitcnt lgkmcnt(2)
 v_mfma_f32_16x16x32_bf16 v[64:67], a[28:31], v[56:59], v[64:67]
 ds_read_b128 v[40:43], v7 offset:16384
 v_mfma_f32_16x16x32_bf16 v[72:75], a[100:103], v[56:59], v[72:75]
 ds_read_b128 v[44:47], v7 offset:18432
 v_mul_f32 v106, s50, v106
 v_mfma_f32_16x16x32_bf16 v[80:83], a[172:175], v[56:59], v[80:83]
 v_mul_f32 v107, s50, v107
 v_mfma_f32_16x16x32_bf16 v[88:91], a[244:247], v[56:59], v[88:91]
 v_cvt_pk_bf16_f32 v16, v96, v97
 v_mfma_f32_16x16x32_bf16 v[68:71], a[28:31], v[60:63], v[68:71]
 v_mfma_f32_16x16x32_bf16 v[76:79], a[100:103], v[60:63], v[76:79]
 v_cvt_pk_bf16_f32 v17, v104, v105
 v_mfma_f32_16x16x32_bf16 v[84:87], a[172:175], v[60:63], v[84:87]
 v_cvt_pk_bf16_f32 v18, v98, v99
 v_mfma_f32_16x16x32_bf16 v[92:95], a[244:247], v[60:63], v[92:95]
 s_waitcnt lgkmcnt(2)
 v_cvt_pk_bf16_f32 v19, v106, v107
 v_mfma_f32_16x16x32_bf16 v[64:67], a[32:35], v[32:35], v[64:67]
 ds_read_b128 v[48:51], v6 offset:20480
 v_mfma_f32_16x16x32_bf16 v[72:75], a[104:107], v[32:35], v[72:75]
 ds_read_b128 v[52:55], v6 offset:22528
 v_mfma_f32_16x16x32_bf16 v[80:83], a[176:179], v[32:35], v[80:83]
 buffer_store_dwordx4 v[16:19], v12, s[20:23], s47 offen offset:0 sc1
 v_mfma_f32_16x16x32_bf16 v[88:91], a[248:251], v[32:35], v[88:91]
 v_mul_f32 v100, s50, v100
 v_mfma_f32_16x16x32_bf16 v[68:71], a[32:35], v[36:39], v[68:71]
 v_mul_f32 v101, s50, v101
 v_mfma_f32_16x16x32_bf16 v[76:79], a[104:107], v[36:39], v[76:79]
 v_mul_f32 v102, s50, v102
 v_mfma_f32_16x16x32_bf16 v[84:87], a[176:179], v[36:39], v[84:87]
 v_mul_f32 v103, s50, v103
 v_mfma_f32_16x16x32_bf16 v[92:95], a[248:251], v[36:39], v[92:95]
 s_waitcnt lgkmcnt(2)
 v_mfma_f32_16x16x32_bf16 v[64:67], a[36:39], v[40:43], v[64:67]
 ds_read_b128 v[56:59], v7 offset:20480
 v_mul_f32 v108, s50, v108
 v_mfma_f32_16x16x32_bf16 v[72:75], a[108:111], v[40:43], v[72:75]
 ds_read_b128 v[60:63], v7 offset:22528
 v_mfma_f32_16x16x32_bf16 v[80:83], a[180:183], v[40:43], v[80:83]
 v_mul_f32 v109, s50, v109
 v_mfma_f32_16x16x32_bf16 v[88:91], a[252:255], v[40:43], v[88:91]
 v_mul_f32 v110, s50, v110
 v_mfma_f32_16x16x32_bf16 v[68:71], a[36:39], v[44:47], v[68:71]
 v_mul_f32 v111, s50, v111
 v_mfma_f32_16x16x32_bf16 v[76:79], a[108:111], v[44:47], v[76:79]
 v_mfma_f32_16x16x32_bf16 v[84:87], a[180:183], v[44:47], v[84:87]
 v_cvt_pk_bf16_f32 v20, v100, v101
 v_mfma_f32_16x16x32_bf16 v[92:95], a[252:255], v[44:47], v[92:95]
 s_waitcnt lgkmcnt(2)
 v_cvt_pk_bf16_f32 v21, v108, v109
 v_mfma_f32_16x16x32_bf16 v[64:67], a[40:43], v[48:51], v[64:67]
 ds_read_b128 v[32:35], v6 offset:24576
 v_mfma_f32_16x16x32_bf16 v[72:75], a[112:115], v[48:51], v[72:75]
 ds_read_b128 v[36:39], v6 offset:26624
 v_cvt_pk_bf16_f32 v22, v102, v103
 v_mfma_f32_16x16x32_bf16 v[80:83], a[184:187], v[48:51], v[80:83]
 v_mfma_f32_16x16x32_bf16 v[88:91], v[224:227], v[48:51], v[88:91]
 v_cvt_pk_bf16_f32 v23, v110, v111
 v_mfma_f32_16x16x32_bf16 v[68:71], a[40:43], v[52:55], v[68:71]
 buffer_store_dwordx4 v[20:23], v12, s[20:23], s47 offen offset:1024 sc1
 v_mfma_f32_16x16x32_bf16 v[76:79], a[112:115], v[52:55], v[76:79]
 v_mul_f32 v112, s50, v112
 v_mfma_f32_16x16x32_bf16 v[84:87], a[184:187], v[52:55], v[84:87]
 v_mul_f32 v113, s50, v113
 v_mfma_f32_16x16x32_bf16 v[92:95], v[224:227], v[52:55], v[92:95]
 s_waitcnt lgkmcnt(2)
 v_mfma_f32_16x16x32_bf16 v[64:67], a[44:47], v[56:59], v[64:67]
 ds_read_b128 v[40:43], v7 offset:24576
 v_mul_f32 v114, s50, v114
 v_mfma_f32_16x16x32_bf16 v[72:75], a[116:119], v[56:59], v[72:75]
 ds_read_b128 v[44:47], v7 offset:26624
 v_mfma_f32_16x16x32_bf16 v[80:83], a[188:191], v[56:59], v[80:83]
 v_mul_f32 v115, s50, v115
 v_mfma_f32_16x16x32_bf16 v[88:91], v[228:231], v[56:59], v[88:91]
 v_mul_f32 v120, s50, v120
 v_mfma_f32_16x16x32_bf16 v[68:71], a[44:47], v[60:63], v[68:71]
 v_mul_f32 v121, s50, v121
 v_mfma_f32_16x16x32_bf16 v[76:79], a[116:119], v[60:63], v[76:79]
 v_mfma_f32_16x16x32_bf16 v[84:87], a[188:191], v[60:63], v[84:87]
 v_mul_f32 v122, s50, v122
 v_mfma_f32_16x16x32_bf16 v[92:95], v[228:231], v[60:63], v[92:95]
 s_waitcnt lgkmcnt(2)
 v_mul_f32 v123, s50, v123
 v_mfma_f32_16x16x32_bf16 v[64:67], a[48:51], v[32:35], v[64:67]
 ds_read_b128 v[48:51], v6 offset:28672
 v_mfma_f32_16x16x32_bf16 v[72:75], a[120:123], v[32:35], v[72:75]
 ds_read_b128 v[52:55], v6 offset:30720
 v_cvt_pk_bf16_f32 v24, v112, v113
 v_mfma_f32_16x16x32_bf16 v[80:83], a[192:195], v[32:35], v[80:83]
 v_mfma_f32_16x16x32_bf16 v[88:91], v[232:235], v[32:35], v[88:91]
 v_cvt_pk_bf16_f32 v25, v120, v121
 v_mfma_f32_16x16x32_bf16 v[68:71], a[48:51], v[36:39], v[68:71]
 v_cvt_pk_bf16_f32 v26, v114, v115
 v_mfma_f32_16x16x32_bf16 v[76:79], a[120:123], v[36:39], v[76:79]
 v_cvt_pk_bf16_f32 v27, v122, v123
 v_mfma_f32_16x16x32_bf16 v[84:87], a[192:195], v[36:39], v[84:87]
 buffer_store_dwordx4 v[24:27], v12, s[20:23], s48 offen offset:0 sc1
 v_mfma_f32_16x16x32_bf16 v[92:95], v[232:235], v[36:39], v[92:95]
 s_waitcnt lgkmcnt(2)
 v_mfma_f32_16x16x32_bf16 v[64:67], a[52:55], v[40:43], v[64:67]
 ds_read_b128 v[56:59], v7 offset:28672
 v_mul_f32 v116, s50, v116
 v_mfma_f32_16x16x32_bf16 v[72:75], a[124:127], v[40:43], v[72:75]
 ds_read_b128 v[60:63], v7 offset:30720
 v_mfma_f32_16x16x32_bf16 v[80:83], a[196:199], v[40:43], v[80:83]
 s_add_u32 s43, s43, 36864
 s_cmp_eq_u32 s43, 147456
 v_mfma_f32_16x16x32_bf16 v[88:91], v[236:239], v[40:43], v[88:91]
 s_cselect_b32 s43, 0, s43
 s_add_u32 s44, s44, 36864
 v_mfma_f32_16x16x32_bf16 v[68:71], a[52:55], v[44:47], v[68:71]
 s_cmp_eq_u32 s44, 147456
 s_cselect_b32 s44, 0, s44
 v_mfma_f32_16x16x32_bf16 v[76:79], a[124:127], v[44:47], v[76:79]
 v_mul_f32 v117, s50, v117
 v_mfma_f32_16x16x32_bf16 v[84:87], a[196:199], v[44:47], v[84:87]
 v_mul_f32 v118, s50, v118
 v_mfma_f32_16x16x32_bf16 v[92:95], v[236:239], v[44:47], v[92:95]
 s_waitcnt lgkmcnt(2)
 v_mfma_f32_16x16x32_bf16 v[64:67], a[56:59], v[48:51], v[64:67]
 ds_read_b128 v[32:35], v6 offset:32768
 v_mul_f32 v119, s50, v119
 v_mfma_f32_16x16x32_bf16 v[72:75], a[128:131], v[48:51], v[72:75]
 ds_read_b128 v[36:39], v6 offset:34816
 v_mfma_f32_16x16x32_bf16 v[80:83], a[200:203], v[48:51], v[80:83]
 v_add_u32 v6, s43, v4
 v_mul_f32 v124, s50, v124
 v_mfma_f32_16x16x32_bf16 v[88:91], v[240:243], v[48:51], v[88:91]
 v_mfma_f32_16x16x32_bf16 v[68:71], a[56:59], v[52:55], v[68:71]
 v_mul_f32 v125, s50, v125
 v_mfma_f32_16x16x32_bf16 v[76:79], a[128:131], v[52:55], v[76:79]
 v_mul_f32 v126, s50, v126
 v_mfma_f32_16x16x32_bf16 v[84:87], a[200:203], v[52:55], v[84:87]
 v_mul_f32 v127, s50, v127
 v_mfma_f32_16x16x32_bf16 v[92:95], v[240:243], v[52:55], v[92:95]
 s_waitcnt lgkmcnt(2)
 v_mfma_f32_16x16x32_bf16 v[64:67], a[60:63], v[56:59], v[64:67]
 ds_read_b128 v[40:43], v7 offset:32768
 v_cvt_pk_bf16_f32 v28, v116, v117
 v_mfma_f32_16x16x32_bf16 v[72:75], a[132:135], v[56:59], v[72:75]
 ds_read_b128 v[44:47], v7 offset:34816
 v_mfma_f32_16x16x32_bf16 v[80:83], a[204:207], v[56:59], v[80:83]
 v_add_u32 v7, s43, v5
 v_cvt_pk_bf16_f32 v29, v124, v125
 v_mfma_f32_16x16x32_bf16 v[88:91], v[244:247], v[56:59], v[88:91]
 v_cvt_pk_bf16_f32 v30, v118, v119
 v_mfma_f32_16x16x32_bf16 v[68:71], a[60:63], v[60:63], v[68:71]
 v_mfma_f32_16x16x32_bf16 v[76:79], a[132:135], v[60:63], v[76:79]
 v_cvt_pk_bf16_f32 v31, v126, v127
 v_mfma_f32_16x16x32_bf16 v[84:87], a[204:207], v[60:63], v[84:87]
 buffer_store_dwordx4 v[28:31], v12, s[20:23], s48 offen offset:1024 sc1
 v_mfma_f32_16x16x32_bf16 v[92:95], v[244:247], v[60:63], v[92:95]
 s_waitcnt lgkmcnt(2)
 v_mfma_f32_16x16x32_bf16 v[64:67], a[64:67], v[32:35], v[64:67]
 s_waitcnt vmcnt(13)
 s_barrier
 ds_read_b128 v[48:51], v6 offset:0
 v_mfma_f32_16x16x32_bf16 v[72:75], a[136:139], v[32:35], v[72:75]
 ds_read_b128 v[52:55], v6 offset:2048
 v_mfma_f32_16x16x32_bf16 v[80:83], a[208:211], v[32:35], v[80:83]
 v_mfma_f32_16x16x32_bf16 v[88:91], v[248:251], v[32:35], v[88:91]
 v_mfma_f32_16x16x32_bf16 v[68:71], a[64:67], v[36:39], v[68:71]
 v_mfma_f32_16x16x32_bf16 v[76:79], a[136:139], v[36:39], v[76:79]
 v_mfma_f32_16x16x32_bf16 v[84:87], a[208:211], v[36:39], v[84:87]
 v_mfma_f32_16x16x32_bf16 v[92:95], v[248:251], v[36:39], v[92:95]
 s_waitcnt lgkmcnt(2)
 v_mfma_f32_16x16x32_bf16 v[64:67], a[68:71], v[40:43], v[64:67]
 ds_read_b128 v[56:59], v7 offset:0
 v_mfma_f32_16x16x32_bf16 v[72:75], a[140:143], v[40:43], v[72:75]
 ds_read_b128 v[60:63], v7 offset:2048
 v_mfma_f32_16x16x32_bf16 v[80:83], a[212:215], v[40:43], v[80:83]
 s_mul_i32 s45, s39, 262144
 s_add_u32 s47, s34, s45
 v_mfma_f32_16x16x32_bf16 v[88:91], v[252:255], v[40:43], v[88:91]
 s_add_u32 s48, s35, s45
 v_mov_b32 v14, s42
 v_mfma_f32_16x16x32_bf16 v[68:71], a[68:71], v[44:47], v[68:71]
 s_mov_b32 s39, s40
 s_mov_b32 s40, s41
 v_mfma_f32_16x16x32_bf16 v[76:79], a[140:143], v[44:47], v[76:79]
 s_add_u32 s42, s42, 1
 v_mfma_f32_16x16x32_bf16 v[84:87], a[212:215], v[44:47], v[84:87]
 v_mfma_f32_16x16x32_bf16 v[92:95], v[252:255], v[44:47], v[92:95]
 s_waitcnt lgkmcnt(2)
 v_mfma_f32_16x16x32_bf16 v[96:99], a[0:3], v[48:51], 0
 ds_read_b128 v[32:35], v6 offset:4096
 v_mfma_f32_16x16x32_bf16 v[104:107], a[72:75], v[48:51], 0
 ds_read_b128 v[36:39], v6 offset:6144
 v_mfma_f32_16x16x32_bf16 v[112:115], a[144:147], v[48:51], 0
 s_add_u32 s41, s40, 4
 v_mfma_f32_16x16x32_bf16 v[120:123], a[216:219], v[48:51], 0
 s_add_u32 s45, s42, 2
 s_mul_i32 s46, s41, 36864
 v_mfma_f32_16x16x32_bf16 v[100:103], a[0:3], v[52:55], 0
 s_cmp_lt_u32 s45, s36
 s_cselect_b32 s46, s46, 0
 v_mfma_f32_16x16x32_bf16 v[108:111], a[72:75], v[52:55], 0
 s_lshl_b32 s49, s4, 10
 s_add_u32 s49, s49, s44
 v_mfma_f32_16x16x32_bf16 v[116:119], a[144:147], v[52:55], 0
 v_mfma_f32_16x16x32_bf16 v[124:127], a[216:219], v[52:55], 0
 s_waitcnt lgkmcnt(2)
 v_mfma_f32_16x16x32_bf16 v[96:99], a[4:7], v[56:59], v[96:99]
 ds_read_b128 v[40:43], v7 offset:4096
 v_mfma_f32_16x16x32_bf16 v[104:107], a[76:79], v[56:59], v[104:107]
 ds_read_b128 v[44:47], v7 offset:6144
 v_mfma_f32_16x16x32_bf16 v[112:115], a[148:151], v[56:59], v[112:115]
 s_add_u32 m0, s49, 0
 v_mfma_f32_16x16x32_bf16 v[120:123], a[220:223], v[56:59], v[120:123]
 buffer_load_dwordx4 v10, s[8:11], s46 offen offset:0  lds
 v_mfma_f32_16x16x32_bf16 v[100:103], a[4:7], v[60:63], v[100:103]
 s_add_u32 m0, s49, 3968
 v_mfma_f32_16x16x32_bf16 v[108:111], a[76:79], v[60:63], v[108:111]
 buffer_load_dwordx4 v10, s[8:11], s46 offen offset:128  lds
 v_mfma_f32_16x16x32_bf16 v[116:119], a[148:151], v[60:63], v[116:119]
 v_mfma_f32_16x16x32_bf16 v[124:127], a[220:223], v[60:63], v[124:127]
 s_waitcnt lgkmcnt(2)
 v_mfma_f32_16x16x32_bf16 v[96:99], a[8:11], v[32:35], v[96:99]
 ds_read_b128 v[48:51], v6 offset:8192
 v_mfma_f32_16x16x32_bf16 v[104:107], a[80:83], v[32:35], v[104:107]
 ds_read_b128 v[52:55], v6 offset:10240
 v_mfma_f32_16x16x32_bf16 v[112:115], a[152:155], v[32:35], v[112:115]
 s_add_u32 m0, s49, 7936
 v_mfma_f32_16x16x32_bf16 v[120:123], a[224:227], v[32:35], v[120:123]
 buffer_load_dwordx4 v10, s[8:11], s46 offen offset:256  lds
 v_mfma_f32_16x16x32_bf16 v[100:103], a[8:11], v[36:39], v[100:103]
 s_add_u32 m0, s49, 11904
 v_mfma_f32_16x16x32_bf16 v[108:111], a[80:83], v[36:39], v[108:111]
 buffer_load_dwordx4 v10, s[8:11], s46 offen offset:384  lds
 v_mfma_f32_16x16x32_bf16 v[116:119], a[152:155], v[36:39], v[116:119]
 v_mfma_f32_16x16x32_bf16 v[124:127], a[224:227], v[36:39], v[124:127]
 s_waitcnt lgkmcnt(2)
 v_mfma_f32_16x16x32_bf16 v[96:99], a[12:15], v[40:43], v[96:99]
 ds_read_b128 v[56:59], v7 offset:8192
 v_mfma_f32_16x16x32_bf16 v[104:107], a[84:87], v[40:43], v[104:107]
 ds_read_b128 v[60:63], v7 offset:10240
 v_mfma_f32_16x16x32_bf16 v[112:115], a[156:159], v[40:43], v[112:115]
 s_add_u32 m0, s49, 15872
 v_mfma_f32_16x16x32_bf16 v[120:123], a[228:231], v[40:43], v[120:123]
 buffer_load_dwordx4 v10, s[8:11], s46 offen offset:512  lds
 v_mfma_f32_16x16x32_bf16 v[100:103], a[12:15], v[44:47], v[100:103]
 s_add_u32 m0, s49, 19840
 v_mfma_f32_16x16x32_bf16 v[108:111], a[84:87], v[44:47], v[108:111]
 buffer_load_dwordx4 v10, s[8:11], s46 offen offset:640  lds
 v_mfma_f32_16x16x32_bf16 v[116:119], a[156:159], v[44:47], v[116:119]
 v_mfma_f32_16x16x32_bf16 v[124:127], a[228:231], v[44:47], v[124:127]
 s_waitcnt lgkmcnt(2)
 v_mfma_f32_16x16x32_bf16 v[96:99], a[16:19], v[48:51], v[96:99]
 ds_read_b128 v[32:35], v6 offset:12288
 v_mfma_f32_16x16x32_bf16 v[104:107], a[88:91], v[48:51], v[104:107]
 ds_read_b128 v[36:39], v6 offset:14336
 v_mfma_f32_16x16x32_bf16 v[112:115], a[160:163], v[48:51], v[112:115]
 s_add_u32 m0, s49, 23808
 v_mfma_f32_16x16x32_bf16 v[120:123], a[232:235], v[48:51], v[120:123]
 buffer_load_dwordx4 v10, s[8:11], s46 offen offset:768  lds
 v_mfma_f32_16x16x32_bf16 v[100:103], a[16:19], v[52:55], v[100:103]
 s_add_u32 m0, s49, 27776
 v_mfma_f32_16x16x32_bf16 v[108:111], a[88:91], v[52:55], v[108:111]
 buffer_load_dwordx4 v10, s[8:11], s46 offen offset:896  lds
 v_mfma_f32_16x16x32_bf16 v[116:119], a[160:163], v[52:55], v[116:119]
 v_mfma_f32_16x16x32_bf16 v[124:127], a[232:235], v[52:55], v[124:127]
 s_waitcnt lgkmcnt(2)
 v_mfma_f32_16x16x32_bf16 v[96:99], a[20:23], v[56:59], v[96:99]
 ds_read_b128 v[40:43], v7 offset:12288
 v_mfma_f32_16x16x32_bf16 v[104:107], a[92:95], v[56:59], v[104:107]
 ds_read_b128 v[44:47], v7 offset:14336
 v_mfma_f32_16x16x32_bf16 v[112:115], a[164:167], v[56:59], v[112:115]
 s_add_u32 m0, s49, 31744
 v_mfma_f32_16x16x32_bf16 v[120:123], a[236:239], v[56:59], v[120:123]
 buffer_load_dwordx4 v10, s[8:11], s46 offen offset:1024  lds
 v_mfma_f32_16x16x32_bf16 v[100:103], a[20:23], v[60:63], v[100:103]
 v_mfma_f32_16x16x32_bf16 v[108:111], a[92:95], v[60:63], v[108:111]
 v_mfma_f32_16x16x32_bf16 v[116:119], a[164:167], v[60:63], v[116:119]
 v_mfma_f32_16x16x32_bf16 v[124:127], a[236:239], v[60:63], v[124:127]
 s_waitcnt lgkmcnt(2)
 v_mfma_f32_16x16x32_bf16 v[96:99], a[24:27], v[32:35], v[96:99]
 ds_read_b128 v[48:51], v6 offset:16384
 v_mul_f32 v64, s50, v64
 v_mfma_f32_16x16x32_bf16 v[104:107], a[96:99], v[32:35], v[104:107]
 ds_read_b128 v[52:55], v6 offset:18432
 v_mfma_f32_16x16x32_bf16 v[112:115], a[168:171], v[32:35], v[112:115]
 v_mul_f32 v65, s50, v65
 v_mfma_f32_16x16x32_bf16 v[120:123], a[240:243], v[32:35], v[120:123]
 v_mul_f32 v66, s50, v66
 v_mfma_f32_16x16x32_bf16 v[100:103], a[24:27], v[36:39], v[100:103]
 v_mul_f32 v67, s50, v67
 v_mfma_f32_16x16x32_bf16 v[108:111], a[96:99], v[36:39], v[108:111]
 v_mul_f32 v72, s50, v72
 v_mfma_f32_16x16x32_bf16 v[116:119], a[168:171], v[36:39], v[116:119]
 v_mul_f32 v73, s50, v73
 v_mfma_f32_16x16x32_bf16 v[124:127], a[240:243], v[36:39], v[124:127]
 s_waitcnt lgkmcnt(2)
 v_mfma_f32_16x16x32_bf16 v[96:99], a[28:31], v[40:43], v[96:99]
 ds_read_b128 v[56:59], v7 offset:16384
 v_mfma_f32_16x16x32_bf16 v[104:107], a[100:103], v[40:43], v[104:107]
 ds_read_b128 v[60:63], v7 offset:18432
 v_mul_f32 v74, s50, v74
 v_mfma_f32_16x16x32_bf16 v[112:115], a[172:175], v[40:43], v[112:115]
 v_mul_f32 v75, s50, v75
 v_mfma_f32_16x16x32_bf16 v[120:123], a[244:247], v[40:43], v[120:123]
 v_cvt_pk_bf16_f32 v16, v64, v65
 v_mfma_f32_16x16x32_bf16 v[100:103], a[28:31], v[44:47], v[100:103]
 v_mfma_f32_16x16x32_bf16 v[108:111], a[100:103], v[44:47], v[108:111]
 v_cvt_pk_bf16_f32 v17, v72, v73
 v_mfma_f32_16x16x32_bf16 v[116:119], a[172:175], v[44:47], v[116:119]
 v_cvt_pk_bf16_f32 v18, v66, v67
 v_mfma_f32_16x16x32_bf16 v[124:127], a[244:247], v[44:47], v[124:127]
 s_waitcnt lgkmcnt(2)
 v_cvt_pk_bf16_f32 v19, v74, v75
 v_mfma_f32_16x16x32_bf16 v[96:99], a[32:35], v[48:51], v[96:99]
 ds_read_b128 v[32:35], v6 offset:20480
 v_mfma_f32_16x16x32_bf16 v[104:107], a[104:107], v[48:51], v[104:107]
 ds_read_b128 v[36:39], v6 offset:22528
 v_mfma_f32_16x16x32_bf16 v[112:115], a[176:179], v[48:51], v[112:115]
 buffer_store_dwordx4 v[16:19], v12, s[20:23], s47 offen offset:0 sc1
 v_mfma_f32_16x16x32_bf16 v[120:123], a[248:251], v[48:51], v[120:123]
 v_mul_f32 v68, s50, v68
 v_mfma_f32_16x16x32_bf16 v[100:103], a[32:35], v[52:55], v[100:103]
 v_mul_f32 v69, s50, v69
 v_mfma_f32_16x16x32_bf16 v[108:111], a[104:107], v[52:55], v[108:111]
 v_mul_f32 v70, s50, v70
 v_mfma_f32_16x16x32_bf16 v[116:119], a[176:179], v[52:55], v[116:119]
 v_mul_f32 v71, s50, v71
 v_mfma_f32_16x16x32_bf16 v[124:127], a[248:251], v[52:55], v[124:127]
 s_waitcnt lgkmcnt(2)
 v_mfma_f32_16x16x32_bf16 v[96:99], a[36:39], v[56:59], v[96:99]
 ds_read_b128 v[40:43], v7 offset:20480
 v_mul_f32 v76, s50, v76
 v_mfma_f32_16x16x32_bf16 v[104:107], a[108:111], v[56:59], v[104:107]
 ds_read_b128 v[44:47], v7 offset:22528
 v_mfma_f32_16x16x32_bf16 v[112:115], a[180:183], v[56:59], v[112:115]
 v_mul_f32 v77, s50, v77
 v_mfma_f32_16x16x32_bf16 v[120:123], a[252:255], v[56:59], v[120:123]
 v_mul_f32 v78, s50, v78
 v_mfma_f32_16x16x32_bf16 v[100:103], a[36:39], v[60:63], v[100:103]
 v_mul_f32 v79, s50, v79
 v_mfma_f32_16x16x32_bf16 v[108:111], a[108:111], v[60:63], v[108:111]
 v_mfma_f32_16x16x32_bf16 v[116:119], a[180:183], v[60:63], v[116:119]
 v_cvt_pk_bf16_f32 v20, v68, v69
 v_mfma_f32_16x16x32_bf16 v[124:127], a[252:255], v[60:63], v[124:127]
 s_waitcnt lgkmcnt(2)
 v_cvt_pk_bf16_f32 v21, v76, v77
 v_mfma_f32_16x16x32_bf16 v[96:99], a[40:43], v[32:35], v[96:99]
 ds_read_b128 v[48:51], v6 offset:24576
 v_mfma_f32_16x16x32_bf16 v[104:107], a[112:115], v[32:35], v[104:107]
 ds_read_b128 v[52:55], v6 offset:26624
 v_cvt_pk_bf16_f32 v22, v70, v71
 v_mfma_f32_16x16x32_bf16 v[112:115], a[184:187], v[32:35], v[112:115]
 v_mfma_f32_16x16x32_bf16 v[120:123], v[224:227], v[32:35], v[120:123]
 v_cvt_pk_bf16_f32 v23, v78, v79
 v_mfma_f32_16x16x32_bf16 v[100:103], a[40:43], v[36:39], v[100:103]
 buffer_store_dwordx4 v[20:23], v12, s[20:23], s47 offen offset:1024 sc1
 v_mfma_f32_16x16x32_bf16 v[108:111], a[112:115], v[36:39], v[108:111]
 v_mul_f32 v80, s50, v80
 v_mfma_f32_16x16x32_bf16 v[116:119], a[184:187], v[36:39], v[116:119]
 v_mul_f32 v81, s50, v81
 v_mfma_f32_16x16x32_bf16 v[124:127], v[224:227], v[36:39], v[124:127]
 s_waitcnt lgkmcnt(2)
 v_mfma_f32_16x16x32_bf16 v[96:99], a[44:47], v[40:43], v[96:99]
 ds_read_b128 v[56:59], v7 offset:24576
 v_mul_f32 v82, s50, v82
 v_mfma_f32_16x16x32_bf16 v[104:107], a[116:119], v[40:43], v[104:107]
 ds_read_b128 v[60:63], v7 offset:26624
 v_mfma_f32_16x16x32_bf16 v[112:115], a[188:191], v[40:43], v[112:115]
 v_mul_f32 v83, s50, v83
 v_mfma_f32_16x16x32_bf16 v[120:123], v[228:231], v[40:43], v[120:123]
 v_mul_f32 v88, s50, v88
 v_mfma_f32_16x16x32_bf16 v[100:103], a[44:47], v[44:47], v[100:103]
 v_mul_f32 v89, s50, v89
 v_mfma_f32_16x16x32_bf16 v[108:111], a[116:119], v[44:47], v[108:111]
 v_mfma_f32_16x16x32_bf16 v[116:119], a[188:191], v[44:47], v[116:119]
 v_mul_f32 v90, s50, v90
 v_mfma_f32_16x16x32_bf16 v[124:127], v[228:231], v[44:47], v[124:127]
 s_waitcnt lgkmcnt(2)
 v_mul_f32 v91, s50, v91
 v_mfma_f32_16x16x32_bf16 v[96:99], a[48:51], v[48:51], v[96:99]
 ds_read_b128 v[32:35], v6 offset:28672
 v_mfma_f32_16x16x32_bf16 v[104:107], a[120:123], v[48:51], v[104:107]
 ds_read_b128 v[36:39], v6 offset:30720
 v_cvt_pk_bf16_f32 v24, v80, v81
 v_mfma_f32_16x16x32_bf16 v[112:115], a[192:195], v[48:51], v[112:115]
 v_mfma_f32_16x16x32_bf16 v[120:123], v[232:235], v[48:51], v[120:123]
 v_cvt_pk_bf16_f32 v25, v88, v89
 v_mfma_f32_16x16x32_bf16 v[100:103], a[48:51], v[52:55], v[100:103]
 v_cvt_pk_bf16_f32 v26, v82, v83
 v_mfma_f32_16x16x32_bf16 v[108:111], a[120:123], v[52:55], v[108:111]
 v_cvt_pk_bf16_f32 v27, v90, v91
 v_mfma_f32_16x16x32_bf16 v[116:119], a[192:195], v[52:55], v[116:119]
 buffer_store_dwordx4 v[24:27], v12, s[20:23], s48 offen offset:0 sc1
 v_mfma_f32_16x16x32_bf16 v[124:127], v[232:235], v[52:55], v[124:127]
 s_waitcnt lgkmcnt(2)
 v_mfma_f32_16x16x32_bf16 v[96:99], a[52:55], v[56:59], v[96:99]
 ds_read_b128 v[40:43], v7 offset:28672
 v_mul_f32 v84, s50, v84
 v_mfma_f32_16x16x32_bf16 v[104:107], a[124:127], v[56:59], v[104:107]
 ds_read_b128 v[44:47], v7 offset:30720
 v_mfma_f32_16x16x32_bf16 v[112:115], a[196:199], v[56:59], v[112:115]
 s_add_u32 s43, s43, 36864
 s_cmp_eq_u32 s43, 147456
 v_mfma_f32_16x16x32_bf16 v[120:123], v[236:239], v[56:59], v[120:123]
 s_cselect_b32 s43, 0, s43
 s_add_u32 s44, s44, 36864
 v_mfma_f32_16x16x32_bf16 v[100:103], a[52:55], v[60:63], v[100:103]
 s_cmp_eq_u32 s44, 147456
 s_cselect_b32 s44, 0, s44
 v_mfma_f32_16x16x32_bf16 v[108:111], a[124:127], v[60:63], v[108:111]
 v_mul_f32 v85, s50, v85
 v_mfma_f32_16x16x32_bf16 v[116:119], a[196:199], v[60:63], v[116:119]
 v_mul_f32 v86, s50, v86
 v_mfma_f32_16x16x32_bf16 v[124:127], v[236:239], v[60:63], v[124:127]
 s_waitcnt lgkmcnt(2)
 v_mfma_f32_16x16x32_bf16 v[96:99], a[56:59], v[32:35], v[96:99]
 ds_read_b128 v[48:51], v6 offset:32768
 v_mul_f32 v87, s50, v87
 v_mfma_f32_16x16x32_bf16 v[104:107], a[128:131], v[32:35], v[104:107]
 ds_read_b128 v[52:55], v6 offset:34816
 v_mfma_f32_16x16x32_bf16 v[112:115], a[200:203], v[32:35], v[112:115]
 v_add_u32 v6, s43, v4
 v_mul_f32 v92, s50, v92
 v_mfma_f32_16x16x32_bf16 v[120:123], v[240:243], v[32:35], v[120:123]
 v_mfma_f32_16x16x32_bf16 v[100:103], a[56:59], v[36:39], v[100:103]
 v_mul_f32 v93, s50, v93
 v_mfma_f32_16x16x32_bf16 v[108:111], a[128:131], v[36:39], v[108:111]
 v_mul_f32 v94, s50, v94
 v_mfma_f32_16x16x32_bf16 v[116:119], a[200:203], v[36:39], v[116:119]
 v_mul_f32 v95, s50, v95
 v_mfma_f32_16x16x32_bf16 v[124:127], v[240:243], v[36:39], v[124:127]
 s_waitcnt lgkmcnt(2)
 v_mfma_f32_16x16x32_bf16 v[96:99], a[60:63], v[40:43], v[96:99]
 ds_read_b128 v[56:59], v7 offset:32768
 v_cvt_pk_bf16_f32 v28, v84, v85
 v_mfma_f32_16x16x32_bf16 v[104:107], a[132:135], v[40:43], v[104:107]
 ds_read_b128 v[60:63], v7 offset:34816
 v_mfma_f32_16x16x32_bf16 v[112:115], a[204:207], v[40:43], v[112:115]
 v_add_u32 v7, s43, v5
 v_cvt_pk_bf16_f32 v29, v92, v93
 v_mfma_f32_16x16x32_bf16 v[120:123], v[244:247], v[40:43], v[120:123]
 v_cvt_pk_bf16_f32 v30, v86, v87
 v_mfma_f32_16x16x32_bf16 v[100:103], a[60:63], v[44:47], v[100:103]
 v_mfma_f32_16x16x32_bf16 v[108:111], a[132:135], v[44:47], v[108:111]
 v_cvt_pk_bf16_f32 v31, v94, v95
 v_mfma_f32_16x16x32_bf16 v[116:119], a[204:207], v[44:47], v[116:119]
 buffer_store_dwordx4 v[28:31], v12, s[20:23], s48 offen offset:1024 sc1
 v_mfma_f32_16x16x32_bf16 v[124:127], v[244:247], v[44:47], v[124:127]
 s_waitcnt lgkmcnt(2)
 v_mfma_f32_16x16x32_bf16 v[96:99], a[64:67], v[48:51], v[96:99]
 s_waitcnt vmcnt(13)
 s_barrier
 ds_read_b128 v[32:35], v6 offset:0
 v_mfma_f32_16x16x32_bf16 v[104:107], a[136:139], v[48:51], v[104:107]
 ds_read_b128 v[36:39], v6 offset:2048
 v_mfma_f32_16x16x32_bf16 v[112:115], a[208:211], v[48:51], v[112:115]
 v_mfma_f32_16x16x32_bf16 v[120:123], v[248:251], v[48:51], v[120:123]
 v_mfma_f32_16x16x32_bf16 v[100:103], a[64:67], v[52:55], v[100:103]
 v_mfma_f32_16x16x32_bf16 v[108:111], a[136:139], v[52:55], v[108:111]
 v_mfma_f32_16x16x32_bf16 v[116:119], a[208:211], v[52:55], v[116:119]
 v_mfma_f32_16x16x32_bf16 v[124:127], v[248:251], v[52:55], v[124:127]
 s_waitcnt lgkmcnt(2)
 v_mfma_f32_16x16x32_bf16 v[96:99], a[68:71], v[56:59], v[96:99]
 ds_read_b128 v[40:43], v7 offset:0
 v_mfma_f32_16x16x32_bf16 v[104:107], a[140:143], v[56:59], v[104:107]
 ds_read_b128 v[44:47], v7 offset:2048
 v_mfma_f32_16x16x32_bf16 v[112:115], a[212:215], v[56:59], v[112:115]
 s_mul_i32 s45, s39, 262144
 s_add_u32 s47, s34, s45
 v_mfma_f32_16x16x32_bf16 v[120:123], v[252:255], v[56:59], v[120:123]
 s_add_u32 s48, s35, s45
 v_mov_b32 v14, s42
 v_mfma_f32_16x16x32_bf16 v[100:103], a[68:71], v[60:63], v[100:103]
 s_mov_b32 s39, s40
 s_mov_b32 s40, s41
 v_mfma_f32_16x16x32_bf16 v[108:111], a[140:143], v[60:63], v[108:111]
 s_add_u32 s42, s42, 1
 s_cmp_lt_u32 s42, s36
 v_mfma_f32_16x16x32_bf16 v[116:119], a[212:215], v[60:63], v[116:119]
 v_mfma_f32_16x16x32_bf16 v[124:127], v[252:255], v[60:63], v[124:127]
 s_waitcnt lgkmcnt(2)
 s_cbranch_scc1 Lps_loop_21
 s_nop 7
 v_mul_f32 v96, s50, v96
 v_mul_f32 v97, s50, v97
 v_mul_f32 v98, s50, v98
 v_mul_f32 v99, s50, v99
 v_mul_f32 v104, s50, v104
 v_mul_f32 v105, s50, v105
 v_mul_f32 v106, s50, v106
 v_mul_f32 v107, s50, v107
 v_cvt_pk_bf16_f32 v16, v96, v97
 v_cvt_pk_bf16_f32 v17, v104, v105
 v_cvt_pk_bf16_f32 v18, v98, v99
 v_cvt_pk_bf16_f32 v19, v106, v107
 buffer_store_dwordx4 v[16:19], v12, s[20:23], s47 offen offset:0 sc1
 v_mul_f32 v100, s50, v100
 v_mul_f32 v101, s50, v101
 v_mul_f32 v102, s50, v102
 v_mul_f32 v103, s50, v103
 v_mul_f32 v108, s50, v108
 v_mul_f32 v109, s50, v109
 v_mul_f32 v110, s50, v110
 v_mul_f32 v111, s50, v111
 v_cvt_pk_bf16_f32 v20, v100, v101
 v_cvt_pk_bf16_f32 v21, v108, v109
 v_cvt_pk_bf16_f32 v22, v102, v103
 v_cvt_pk_bf16_f32 v23, v110, v111
 buffer_store_dwordx4 v[20:23], v12, s[20:23], s47 offen offset:1024 sc1
 v_mul_f32 v112, s50, v112
 v_mul_f32 v113, s50, v113
 v_mul_f32 v114, s50, v114
 v_mul_f32 v115, s50, v115
 v_mul_f32 v120, s50, v120
 v_mul_f32 v121, s50, v121
 v_mul_f32 v122, s50, v122
 v_mul_f32 v123, s50, v123
 v_cvt_pk_bf16_f32 v24, v112, v113
 v_cvt_pk_bf16_f32 v25, v120, v121
 v_cvt_pk_bf16_f32 v26, v114, v115
 v_cvt_pk_bf16_f32 v27, v122, v123
 buffer_store_dwordx4 v[24:27], v12, s[20:23], s48 offen offset:0 sc1
 v_mul_f32 v116, s50, v116
 v_mul_f32 v117, s50, v117
 v_mul_f32 v118, s50, v118
 v_mul_f32 v119, s50, v119
 v_mul_f32 v124, s50, v124
 v_mul_f32 v125, s50, v125
 v_mul_f32 v126, s50, v126
 v_mul_f32 v127, s50, v127
 v_cvt_pk_bf16_f32 v28, v116, v117
 v_cvt_pk_bf16_f32 v29, v124, v125
 v_cvt_pk_bf16_f32 v30, v118, v119
 v_cvt_pk_bf16_f32 v31, v126, v127
 buffer_store_dwordx4 v[28:31], v12, s[20:23], s48 offen offset:1024 sc1
 s_waitcnt vmcnt(0) lgkmcnt(0)
 s_barrier
 v_mov_b32 v14, s36
 buffer_store_dword v14, v13, s[20:23], 0 offen sc1
 s_sub_u32 s3, s5, 2
 s_add_u32 s7, s6, s3
 s_cmp_ge_u32 s7, 30
 s_cbranch_scc1 Lfin
 s_cmp_ge_u32 s6, 16
 s_cbranch_scc1 Lob
 s_load_dwordx2 s[8:9], s[0:1], 48
 s_mov_b32 s10, 0x240000
 s_mov_b32 s11, 0x20000
 s_load_dwordx2 s[12:13], s[0:1], 64
 s_mov_b32 s14, 0x480000
 s_mov_b32 s15, 0x20000
 s_load_dwordx2 s[16:17], s[0:1], 64
 s_mov_b32 s18, 0x480000
 s_mov_b32 s19, 0x20000
 s_lshl_b32 s32, s6, 9
 s_add_u32 s33, s32, 256
 s_mov_b32 s36, 32
 s_mov_b32 s37, s3
 s_lshl_b32 s52, s6, 1
 s_lshl_b32 s7, s3, 4
 s_add_u32 s7, s7, s6
 s_and_b32 s94, s7, 3
 s_lshr_b32 s7, s7, 2
 s_lshl_b32 s7, s7, 5
 s_add_u32 s7, s7, s94
 s_lshl_b32 s7, s7, 2
 s_add_u32 s59, s7, 0x3800
 s_waitcnt lgkmcnt(0)
 v_and_b32 v1, 63, v0
 v_lshrrev_b32 v2, 3, v0
 v_mul_u32_u24 v10, 1152, v2
 v_lshrrev_b32 v2, 4, v0
 v_xor_b32 v2, v2, v0
 v_and_b32 v2, 7, v2
 v_lshl_add_u32 v10, v2, 4, v10
 v_lshrrev_b32 v2, 4, v1
 v_bfe_u32 v3, v1, 1, 3
 v_xor_b32 v2, v2, v3
 v_and_b32 v3, 15, v1
 v_lshlrev_b32 v3, 7, v3
 v_lshl_add_u32 v4, v2, 4, v3
 v_xor_b32 v5, 64, v4
 v_lshrrev_b32 v2, 4, v0
 v_lshlrev_b32 v11, 13, v2
 v_lshrrev_b32 v2, 7, v0
 v_lshrrev_b32 v3, 4, v1
 v_lshl_add_u32 v3, v2, 2, v3
 v_bfe_u32 v2, v1, 1, 3
 v_xor_b32 v2, v2, v3
 v_lshl_add_u32 v11, v2, 5, v11
 v_and_b32 v2, 1, v1
 v_lshl_add_u32 v11, v2, 4, v11
 v_bfe_u32 v2, v1, 2, 3
 v_xor_b32 v3, s4, v2
 v_lshlrev_b32 v3, 5, v3
 v_and_b32 v2, 3, v2
 v_lshl_add_u32 v3, v2, 8, v3
 v_lshrrev_b32 v2, 4, v1
 v_lshl_add_u32 v3, v2, 11, v3
 v_and_b32 v2, 3, v1
 v_lshl_add_u32 v3, v2, 3, v3
 v_add_u32 v8, 73728, v3
 v_xor_b32 v3, 0x80, v3
 v_add_u32 v9, 73728, v3
 s_lshl_b32 s45, s4, 11
 v_lshl_add_u32 v12, v1, 4, s45
 s_mov_b32 s39, s37
 s_add_u32 s40, s39, 2
 s_lshl_b32 s49, s4, 10
 s_mul_i32 s46, s39, 36864
 s_add_u32 m0, s49, 0
 s_nop 0
 buffer_load_dwordx4 v10, s[8:11], s46 offen offset:0  lds
 s_add_u32 m0, s49, 3968
 s_nop 0
 buffer_load_dwordx4 v10, s[8:11], s46 offen offset:128  lds
 s_add_u32 m0, s49, 7936
 s_nop 0
 buffer_load_dwordx4 v10, s[8:11], s46 offen offset:256  lds
 s_add_u32 m0, s49, 11904
 s_nop 0
 buffer_load_dwordx4 v10, s[8:11], s46 offen offset:384  lds
 s_add_u32 m0, s49, 15872
 s_nop 0
 buffer_load_dwordx4 v10, s[8:11], s46 offen offset:512  lds
 s_add_u32 m0, s49, 19840
 s_nop 0
 buffer_load_dwordx4 v10, s[8:11], s46 offen offset:640  lds
 s_add_u32 m0, s49, 23808
 s_nop 0
 buffer_load_dwordx4 v10, s[8:11], s46 offen offset:768  lds
 s_add_u32 m0, s49, 27776
 s_nop 0
 buffer_load_dwordx4 v10, s[8:11], s46 offen offset:896  lds
 s_add_u32 m0, s49, 31744
 s_nop 0
 buffer_load_dwordx4 v10, s[8:11], s46 offen offset:1024  lds
 s_lshl_b32 s49, s4, 10
 s_add_u32 s49, s49, 36864
 s_mul_i32 s46, s40, 36864
 s_add_u32 m0, s49, 0
 s_nop 0
 buffer_load_dwordx4 v10, s[8:11], s46 offen offset:0  lds
 s_add_u32 m0, s49, 3968
 s_nop 0
 buffer_load_dwordx4 v10, s[8:11], s46 offen offset:128  lds
 s_add_u32 m0, s49, 7936
 s_nop 0
 buffer_load_dwordx4 v10, s[8:11], s46 offen offset:256  lds
 s_add_u32 m0, s49, 11904
 s_nop 0
 buffer_load_dwordx4 v10, s[8:11], s46 offen offset:384  lds
 s_add_u32 m0, s49, 15872
 s_nop 0
 buffer_load_dwordx4 v10, s[8:11], s46 offen offset:512  lds
 s_add_u32 m0, s49, 19840
 s_nop 0
 buffer_load_dwordx4 v10, s[8:11], s46 offen offset:640  lds
 s_add_u32 m0, s49, 23808
 s_nop 0
 buffer_load_dwordx4 v10, s[8:11], s46 offen offset:768  lds
 s_add_u32 m0, s49, 27776
 s_nop 0
 buffer_load_dwordx4 v10, s[8:11], s46 offen offset:896  lds
 s_add_u32 m0, s49, 31744
 s_nop 0
 buffer_load_dwordx4 v10, s[8:11], s46 offen offset:1024  lds
 s_lshl_b32 s49, s4, 10
 s_add_u32 m0, s49, 73728
 s_add_u32 s45, s32, 0
 buffer_load_dwordx4 v11, s[12:15], s45 offen  lds
 s_add_u32 m0, s49, 77824
 s_add_u32 s45, s32, 131072
 buffer_load_dwordx4 v11, s[12:15], s45 offen  lds
 s_add_u32 m0, s49, 81920
 s_add_u32 s45, s33, 0
 buffer_load_dwordx4 v11, s[16:19], s45 offen  lds
 s_add_u32 m0, s49, 86016
 s_add_u32 s45, s33, 131072
 buffer_load_dwordx4 v11, s[16:19], s45 offen  lds
 s_add_u32 m0, s49, 90112
 s_add_u32 s45, s32, 262144
 buffer_load_dwordx4 v11, s[12:15], s45 offen  lds
 s_add_u32 m0, s49, 94208
 s_add_u32 s45, s32, 393216
 buffer_load_dwordx4 v11, s[12:15], s45 offen  lds
 s_add_u32 m0, s49, 98304
 s_add_u32 s45, s33, 262144
 buffer_load_dwordx4 v11, s[16:19], s45 offen  lds
 s_add_u32 m0, s49, 102400
 s_add_u32 s45, s33, 393216
 buffer_load_dwordx4 v11, s[16:19], s45 offen  lds
 s_add_u32 m0, s49, 106496
 s_add_u32 s45, s32, 524288
 buffer_load_dwordx4 v11, s[12:15], s45 offen  lds
 s_add_u32 m0, s49, 110592
 s_add_u32 s45, s32, 655360
 buffer_load_dwordx4 v11, s[12:15], s45 offen  lds
 s_add_u32 m0, s49, 114688
 s_add_u32 s45, s33, 524288
 buffer_load_dwordx4 v11, s[16:19], s45 offen  lds
 s_add_u32 m0, s49, 118784
 s_add_u32 s45, s33, 655360
 buffer_load_dwordx4 v11, s[16:19], s45 offen  lds
 s_waitcnt vmcnt(8) lgkmcnt(0)
 s_barrier
 s_add_u32 m0, s49, 122880
 s_add_u32 s45, s32, 786432
 buffer_load_dwordx4 v11, s[12:15], s45 offen  lds
 s_add_u32 m0, s49, 126976
 s_add_u32 s45, s32, 917504
 buffer_load_dwordx4 v11, s[12:15], s45 offen  lds
 s_add_u32 m0, s49, 131072
 s_add_u32 s45, s33, 786432
 buffer_load_dwordx4 v11, s[16:19], s45 offen  lds
 s_add_u32 m0, s49, 135168
 s_add_u32 s45, s33, 917504
 buffer_load_dwordx4 v11, s[16:19], s45 offen  lds
 ds_read_b64_tr_b16 a[0:1], v8 offset:0
 ds_read_b64_tr_b16 a[2:3], v8 offset:1024
 ds_read_b64_tr_b16 a[72:73], v9 offset:0
 ds_read_b64_tr_b16 a[74:75], v9 offset:1024
 ds_read_b64_tr_b16 a[144:145], v8 offset:8192
 ds_read_b64_tr_b16 a[146:147], v8 offset:9216
 ds_read_b64_tr_b16 a[216:217], v9 offset:8192
 ds_read_b64_tr_b16 a[218:219], v9 offset:9216
 s_waitcnt vmcnt(8) lgkmcnt(0)
 s_barrier
 s_add_u32 m0, s49, 73728
 s_add_u32 s45, s32, 1048576
 buffer_load_dwordx4 v11, s[12:15], s45 offen  lds
 s_add_u32 m0, s49, 77824
 s_add_u32 s45, s32, 1179648
 buffer_load_dwordx4 v11, s[12:15], s45 offen  lds
 s_add_u32 m0, s49, 81920
 s_add_u32 s45, s33, 1048576
 buffer_load_dwordx4 v11, s[16:19], s45 offen  lds
 s_add_u32 m0, s49, 86016
 s_add_u32 s45, s33, 1179648
 buffer_load_dwordx4 v11, s[16:19], s45 offen  lds
 ds_read_b64_tr_b16 a[4:5], v8 offset:16384
 ds_read_b64_tr_b16 a[6:7], v8 offset:17408
 ds_read_b64_tr_b16 a[76:77], v9 offset:16384
 ds_read_b64_tr_b16 a[78:79], v9 offset:17408
 ds_read_b64_tr_b16 a[148:149], v8 offset:24576
 ds_read_b64_tr_b16 a[150:151], v8 offset:25600
 ds_read_b64_tr_b16 a[220:221], v9 offset:24576
 ds_read_b64_tr_b16 a[222:223], v9 offset:25600
 s_waitcnt vmcnt(8) lgkmcnt(0)
 s_barrier
 s_add_u32 m0, s49, 90112
 s_add_u32 s45, s32, 1310720
 buffer_load_dwordx4 v11, s[12:15], s45 offen  lds
 s_add_u32 m0, s49, 94208
 s_add_u32 s45, s32, 1441792
 buffer_load_dwordx4 v11, s[12:15], s45 offen  lds
 s_add_u32 m0, s49, 98304
 s_add_u32 s45, s33, 1310720
 buffer_load_dwordx4 v11, s[16:19], s45 offen  lds
 s_add_u32 m0, s49, 102400
 s_add_u32 s45, s33, 1441792
 buffer_load_dwordx4 v11, s[16:19], s45 offen  lds
 ds_read_b64_tr_b16 a[8:9], v8 offset:32768
 ds_read_b64_tr_b16 a[10:11], v8 offset:33792
 ds_read_b64_tr_b16 a[80:81], v9 offset:32768
 ds_read_b64_tr_b16 a[82:83], v9 offset:33792
 ds_read_b64_tr_b16 a[152:153], v8 offset:40960
 ds_read_b64_tr_b16 a[154:155], v8 offset:41984
 ds_read_b64_tr_b16 a[224:225], v9 offset:40960
 ds_read_b64_tr_b16 a[226:227], v9 offset:41984
 s_waitcnt vmcnt(8) lgkmcnt(0)
 s_barrier
 s_add_u32 m0, s49, 106496
 s_add_u32 s45, s32, 1572864
 buffer_load_dwordx4 v11, s[12:15], s45 offen  lds
 s_add_u32 m0, s49, 110592
 s_add_u32 s45, s32, 1703936
 buffer_load_dwordx4 v11, s[12:15], s45 offen  lds
 s_add_u32 m0, s49, 114688
 s_add_u32 s45, s33, 1572864
 buffer_load_dwordx4 v11, s[16:19], s45 offen  lds
 s_add_u32 m0, s49, 118784
 s_add_u32 s45, s33, 1703936
 buffer_load_dwordx4 v11, s[16:19], s45 offen  lds
 ds_read_b64_tr_b16 a[12:13], v8 offset:49152
 ds_read_b64_tr_b16 a[14:15], v8 offset:50176
 ds_read_b64_tr_b16 a[84:85], v9 offset:49152
 ds_read_b64_tr_b16 a[86:87], v9 offset:50176
 ds_read_b64_tr_b16 a[156:157], v8 offset:57344
 ds_read_b64_tr_b16 a[158:159], v8 offset:58368
 ds_read_b64_tr_b16 a[228:229], v9 offset:57344
 ds_read_b64_tr_b16 a[230:231], v9 offset:58368
 s_waitcnt vmcnt(8) lgkmcnt(0)
 s_barrier
 s_add_u32 m0, s49, 122880
 s_add_u32 s45, s32, 1835008
 buffer_load_dwordx4 v11, s[12:15], s45 offen  lds
 s_add_u32 m0, s49, 126976
 s_add_u32 s45, s32, 1966080
 buffer_load_dwordx4 v11, s[12:15], s45 offen  lds
 s_add_u32 m0, s49, 131072
 s_add_u32 s45, s33, 1835008
 buffer_load_dwordx4 v11, s[16:19], s45 offen  lds
 s_add_u32 m0, s49, 135168
 s_add_u32 s45, s33, 1966080
 buffer_load_dwordx4 v11, s[16:19], s45 offen  lds
 ds_read_b64_tr_b16 a[16:17], v8 offset:0
 ds_read_b64_tr_b16 a[18:19], v8 offset:1024
 ds_read_b64_tr_b16 a[88:89], v9 offset:0
 ds_read_b64_tr_b16 a[90:91], v9 offset:1024
 ds_read_b64_tr_b16 a[160:161], v8 offset:8192
 ds_read_b64_tr_b16 a[162:163], v8 offset:9216
 ds_read_b64_tr_b16 a[232:233], v9 offset:8192
 ds_read_b64_tr_b16 a[234:235], v9 offset:9216
 s_waitcnt vmcnt(8) lgkmcnt(0)
 s_barrier
 s_add_u32 m0, s49, 73728
 s_add_u32 s45, s32, 2097152
 buffer_load_dwordx4 v11, s[12:15], s45 offen  lds
 s_add_u32 m0, s49, 77824
 s_add_u32 s45, s32, 2228224
 buffer_load_dwordx4 v11, s[12:15], s45 offen  lds
 s_add_u32 m0, s49, 81920
 s_add_u32 s45, s33, 2097152
 buffer_load_dwordx4 v11, s[16:19], s45 offen  lds
 s_add_u32 m0, s49, 86016
 s_add_u32 s45, s33, 2228224
 buffer_load_dwordx4 v11, s[16:19], s45 offen  lds
 ds_read_b64_tr_b16 a[20:21], v8 offset:16384
 ds_read_b64_tr_b16 a[22:23], v8 offset:17408
 ds_read_b64_tr_b16 a[92:93], v9 offset:16384
 ds_read_b64_tr_b16 a[94:95], v9 offset:17408
 ds_read_b64_tr_b16 a[164:165], v8 offset:24576
 ds_read_b64_tr_b16 a[166:167], v8 offset:25600
 ds_read_b64_tr_b16 a[236:237], v9 offset:24576
 ds_read_b64_tr_b16 a[238:239], v9 offset:25600
 s_waitcnt vmcnt(8) lgkmcnt(0)
 s_barrier
 s_add_u32 m0, s49, 90112
 s_add_u32 s45, s32, 2359296
 buffer_load_dwordx4 v11, s[12:15], s45 offen  lds
 s_add_u32 m0, s49, 94208
 s_add_u32 s45, s32, 2490368
 buffer_load_dwordx4 v11, s[12:15], s45 offen  lds
 s_add_u32 m0, s49, 98304
 s_add_u32 s45, s33, 2359296
 buffer_load_dwordx4 v11, s[16:19], s45 offen  lds
 s_add_u32 m0, s49, 102400
 s_add_u32 s45, s33, 2490368
 buffer_load_dwordx4 v11, s[16:19], s45 offen  lds
 ds_read_b64_tr_b16 a[24:25], v8 offset:32768
 ds_read_b64_tr_b16 a[26:27], v8 offset:33792
 ds_read_b64_tr_b16 a[96:97], v9 offset:32768
 ds_read_b64_tr_b16 a[98:99], v9 offset:33792
 ds_read_b64_tr_b16 a[168:169], v8 offset:40960
 ds_read_b64_tr_b16 a[170:171], v8 offset:41984
 ds_read_b64_tr_b16 a[240:241], v9 offset:40960
 ds_read_b64_tr_b16 a[242:243], v9 offset:41984
 s_waitcnt vmcnt(8) lgkmcnt(0)
 s_barrier
 s_add_u32 m0, s49, 106496
 s_add_u32 s45, s32, 2621440
 buffer_load_dwordx4 v11, s[12:15], s45 offen  lds
 s_add_u32 m0, s49, 110592
 s_add_u32 s45, s32, 2752512
 buffer_load_dwordx4 v11, s[12:15], s45 offen  lds
 s_add_u32 m0, s49, 114688
 s_add_u32 s45, s33, 2621440
 buffer_load_dwordx4 v11, s[16:19], s45 offen  lds
 s_add_u32 m0, s49, 118784
 s_add_u32 s45, s33, 2752512
 buffer_load_dwordx4 v11, s[16:19], s45 offen  lds
 ds_read_b64_tr_b16 a[28:29], v8 offset:49152
 ds_read_b64_tr_b16 a[30:31], v8 offset:50176
 ds_read_b64_tr_b16 a[100:101], v9 offset:49152
 ds_read_b64_tr_b16 a[102:103], v9 offset:50176
 ds_read_b64_tr_b16 a[172:173], v8 offset:57344
 ds_read_b64_tr_b16 a[174:175], v8 offset:58368
 ds_read_b64_tr_b16 a[244:245], v9 offset:57344
 ds_read_b64_tr_b16 a[246:247], v9 offset:58368
 s_waitcnt vmcnt(8) lgkmcnt(0)
 s_barrier
 s_add_u32 m0, s49, 122880
 s_add_u32 s45, s32, 2883584
 buffer_load_dwordx4 v11, s[12:15], s45 offen  lds
 s_add_u32 m0, s49, 126976
 s_add_u32 s45, s32, 3014656
 buffer_load_dwordx4 v11, s[12:15], s45 offen  lds
 s_add_u32 m0, s49, 131072
 s_add_u32 s45, s33, 2883584
 buffer_load_dwordx4 v11, s[16:19], s45 offen  lds
 s_add_u32 m0, s49, 135168
 s_add_u32 s45, s33, 3014656
 buffer_load_dwordx4 v11, s[16:19], s45 offen  lds
 ds_read_b64_tr_b16 a[32:33], v8 offset:0
 ds_read_b64_tr_b16 a[34:35], v8 offset:1024
 ds_read_b64_tr_b16 a[104:105], v9 offset:0
 ds_read_b64_tr_b16 a[106:107], v9 offset:1024
 ds_read_b64_tr_b16 a[176:177], v8 offset:8192
 ds_read_b64_tr_b16 a[178:179], v8 offset:9216
 ds_read_b64_tr_b16 a[248:249], v9 offset:8192
 ds_read_b64_tr_b16 a[250:251], v9 offset:9216
 s_waitcnt vmcnt(8) lgkmcnt(0)
 s_barrier
 s_add_u32 m0, s49, 73728
 s_add_u32 s45, s32, 3145728
 buffer_load_dwordx4 v11, s[12:15], s45 offen  lds
 s_add_u32 m0, s49, 77824
 s_add_u32 s45, s32, 3276800
 buffer_load_dwordx4 v11, s[12:15], s45 offen  lds
 s_add_u32 m0, s49, 81920
 s_add_u32 s45, s33, 3145728
 buffer_load_dwordx4 v11, s[16:19], s45 offen  lds
 s_add_u32 m0, s49, 86016
 s_add_u32 s45, s33, 3276800
 buffer_load_dwordx4 v11, s[16:19], s45 offen  lds
 ds_read_b64_tr_b16 a[36:37], v8 offset:16384
 ds_read_b64_tr_b16 a[38:39], v8 offset:17408
 ds_read_b64_tr_b16 a[108:109], v9 offset:16384
 ds_read_b64_tr_b16 a[110:111], v9 offset:17408
 ds_read_b64_tr_b16 a[180:181], v8 offset:24576
 ds_read_b64_tr_b16 a[182:183], v8 offset:25600
 ds_read_b64_tr_b16 a[252:253], v9 offset:24576
 ds_read_b64_tr_b16 a[254:255], v9 offset:25600
 s_waitcnt vmcnt(8) lgkmcnt(0)
 s_barrier
 s_add_u32 m0, s49, 90112
 s_add_u32 s45, s32, 3407872
 buffer_load_dwordx4 v11, s[12:15], s45 offen  lds
 s_add_u32 m0, s49, 94208
 s_add_u32 s45, s32, 3538944
 buffer_load_dwordx4 v11, s[12:15], s45 offen  lds
 s_add_u32 m0, s49, 98304
 s_add_u32 s45, s33, 3407872
 buffer_load_dwordx4 v11, s[16:19], s45 offen  lds
 s_add_u32 m0, s49, 102400
 s_add_u32 s45, s33, 3538944
 buffer_load_dwordx4 v11, s[16:19], s45 offen  lds
 ds_read_b64_tr_b16 a[40:41], v8 offset:32768
 ds_read_b64_tr_b16 a[42:43], v8 offset:33792
 ds_read_b64_tr_b16 a[112:113], v9 offset:32768
 ds_read_b64_tr_b16 a[114:115], v9 offset:33792
 ds_read_b64_tr_b16 a[184:185], v8 offset:40960
 ds_read_b64_tr_b16 a[186:187], v8 offset:41984
 ds_read_b64_tr_b16 v[224:225], v9 offset:40960
 ds_read_b64_tr_b16 v[226:227], v9 offset:41984
 s_waitcnt vmcnt(8) lgkmcnt(0)
 s_barrier
 s_add_u32 m0, s49, 106496
 s_add_u32 s45, s32, 3670016
 buffer_load_dwordx4 v11, s[12:15], s45 offen  lds
 s_add_u32 m0, s49, 110592
 s_add_u32 s45, s32, 3801088
 buffer_load_dwordx4 v11, s[12:15], s45 offen  lds
 s_add_u32 m0, s49, 114688
 s_add_u32 s45, s33, 3670016
 buffer_load_dwordx4 v11, s[16:19], s45 offen  lds
 s_add_u32 m0, s49, 118784
 s_add_u32 s45, s33, 3801088
 buffer_load_dwordx4 v11, s[16:19], s45 offen  lds
 ds_read_b64_tr_b16 a[44:45], v8 offset:49152
 ds_read_b64_tr_b16 a[46:47], v8 offset:50176
 ds_read_b64_tr_b16 a[116:117], v9 offset:49152
 ds_read_b64_tr_b16 a[118:119], v9 offset:50176
 ds_read_b64_tr_b16 a[188:189], v8 offset:57344
 ds_read_b64_tr_b16 a[190:191], v8 offset:58368
 ds_read_b64_tr_b16 v[228:229], v9 offset:57344
 ds_read_b64_tr_b16 v[230:231], v9 offset:58368
 s_waitcnt vmcnt(8) lgkmcnt(0)
 s_barrier
 s_add_u32 m0, s49, 122880
 s_add_u32 s45, s32, 3932160
 buffer_load_dwordx4 v11, s[12:15], s45 offen  lds
 s_add_u32 m0, s49, 126976
 s_add_u32 s45, s32, 4063232
 buffer_load_dwordx4 v11, s[12:15], s45 offen  lds
 s_add_u32 m0, s49, 131072
 s_add_u32 s45, s33, 3932160
 buffer_load_dwordx4 v11, s[16:19], s45 offen  lds
 s_add_u32 m0, s49, 135168
 s_add_u32 s45, s33, 4063232
 buffer_load_dwordx4 v11, s[16:19], s45 offen  lds
 ds_read_b64_tr_b16 a[48:49], v8 offset:0
 ds_read_b64_tr_b16 a[50:51], v8 offset:1024
 ds_read_b64_tr_b16 a[120:121], v9 offset:0
 ds_read_b64_tr_b16 a[122:123], v9 offset:1024
 ds_read_b64_tr_b16 a[192:193], v8 offset:8192
 ds_read_b64_tr_b16 a[194:195], v8 offset:9216
 ds_read_b64_tr_b16 v[232:233], v9 offset:8192
 ds_read_b64_tr_b16 v[234:235], v9 offset:9216
 s_waitcnt vmcnt(8) lgkmcnt(0)
 s_barrier
 s_add_u32 m0, s49, 73728
 s_add_u32 s45, s32, 4194304
 buffer_load_dwordx4 v11, s[12:15], s45 offen  lds
 s_add_u32 m0, s49, 77824
 s_add_u32 s45, s32, 4325376
 buffer_load_dwordx4 v11, s[12:15], s45 offen  lds
 s_add_u32 m0, s49, 81920
 s_add_u32 s45, s33, 4194304
 buffer_load_dwordx4 v11, s[16:19], s45 offen  lds
 s_add_u32 m0, s49, 86016
 s_add_u32 s45, s33, 4325376
 buffer_load_dwordx4 v11, s[16:19], s45 offen  lds
 ds_read_b64_tr_b16 a[52:53], v8 offset:16384
 ds_read_b64_tr_b16 a[54:55], v8 offset:17408
 ds_read_b64_tr_b16 a[124:125], v9 offset:16384
 ds_read_b64_tr_b16 a[126:127], v9 offset:17408
 ds_read_b64_tr_b16 a[196:197], v8 offset:24576
 ds_read_b64_tr_b16 a[198:199], v8 offset:25600
 ds_read_b64_tr_b16 v[236:237], v9 offset:24576
 ds_read_b64_tr_b16 v[238:239], v9 offset:25600
 s_waitcnt vmcnt(8) lgkmcnt(0)
 s_barrier
 s_add_u32 m0, s49, 90112
 s_add_u32 s45, s32, 4456448
 buffer_load_dwordx4 v11, s[12:15], s45 offen  lds
 s_add_u32 m0, s49, 94208
 s_add_u32 s45, s32, 4587520
 buffer_load_dwordx4 v11, s[12:15], s45 offen  lds
 s_add_u32 m0, s49, 98304
 s_add_u32 s45, s33, 4456448
 buffer_load_dwordx4 v11, s[16:19], s45 offen  lds
 s_add_u32 m0, s49, 102400
 s_add_u32 s45, s33, 4587520
 buffer_load_dwordx4 v11, s[16:19], s45 offen  lds
 ds_read_b64_tr_b16 a[56:57], v8 offset:32768
 ds_read_b64_tr_b16 a[58:59], v8 offset:33792
 ds_read_b64_tr_b16 a[128:129], v9 offset:32768
 ds_read_b64_tr_b16 a[130:131], v9 offset:33792
 ds_read_b64_tr_b16 a[200:201], v8 offset:40960
 ds_read_b64_tr_b16 a[202:203], v8 offset:41984
 ds_read_b64_tr_b16 v[240:241], v9 offset:40960
 ds_read_b64_tr_b16 v[242:243], v9 offset:41984
 s_waitcnt vmcnt(8) lgkmcnt(0)
 s_barrier
 ds_read_b64_tr_b16 a[60:61], v8 offset:49152
 ds_read_b64_tr_b16 a[62:63], v8 offset:50176
 ds_read_b64_tr_b16 a[132:133], v9 offset:49152
 ds_read_b64_tr_b16 a[134:135], v9 offset:50176
 ds_read_b64_tr_b16 a[204:205], v8 offset:57344
 ds_read_b64_tr_b16 a[206:207], v8 offset:58368
 ds_read_b64_tr_b16 v[244:245], v9 offset:57344
 ds_read_b64_tr_b16 v[246:247], v9 offset:58368
 s_waitcnt vmcnt(4) lgkmcnt(0)
 s_barrier
 ds_read_b64_tr_b16 a[64:65], v8 offset:0
 ds_read_b64_tr_b16 a[66:67], v8 offset:1024
 ds_read_b64_tr_b16 a[136:137], v9 offset:0
 ds_read_b64_tr_b16 a[138:139], v9 offset:1024
 ds_read_b64_tr_b16 a[208:209], v8 offset:8192
 ds_read_b64_tr_b16 a[210:211], v8 offset:9216
 ds_read_b64_tr_b16 v[248:249], v9 offset:8192
 ds_read_b64_tr_b16 v[250:251], v9 offset:9216
 s_waitcnt vmcnt(0) lgkmcnt(0)
 s_barrier
 ds_read_b64_tr_b16 a[68:69], v8 offset:16384
 ds_read_b64_tr_b16 a[70:71], v8 offset:17408
 ds_read_b64_tr_b16 a[140:141], v9 offset:16384
 ds_read_b64_tr_b16 a[142:143], v9 offset:17408
 ds_read_b64_tr_b16 a[212:213], v8 offset:24576
 ds_read_b64_tr_b16 a[214:215], v8 offset:25600
 ds_read_b64_tr_b16 v[252:253], v9 offset:24576
 ds_read_b64_tr_b16 v[254:255], v9 offset:25600
 s_mov_b32 s50, 0x3e0293ee
 s_mov_b32 s42, 0
 s_mov_b32 s43, 0
 s_mov_b32 s44, 73728
 v_mov_b32 v6, v4
 v_mov_b32 v7, v5
 v_and_b32 v17, 63, v0
 v_lshlrev_b32 v1, 4, v17
 s_lshl_b32 s45, s4, 11
 s_add_u32 s45, s45, 147456
 v_add_u32 v2, s45, v1
 s_lshr_b32 s53, s4, 1
 s_and_b32 s54, s4, 1
 s_add_u32 s52, s52, s53
 s_lshl_b32 s53, s53, 13
 s_lshl_b32 s54, s54, 10
 s_add_u32 s45, s53, s54
 s_add_u32 s45, s45, 147456
 v_add_u32 v3, s45, v1
 s_lshl_b32 s63, s52, 13
 s_add_u32 s63, s63, s54
 s_add_u32 s63, s63, 0x7000000
 s_lshl_b32 s61, s52, 14
 s_add_u32 s61, s61, 0x3000000
 s_lshl_b32 s62, s52, 12
 s_add_u32 s62, s62, 0x400000
 s_lshl_b32 s57, s52, 7
 s_add_u32 s57, s57, 0x1000
 s_waitcnt lgkmcnt(0)
 v_min_u32 v8, 1, v0
 v_lshlrev_b32 v8, 28, v8
 s_mov_b32 s58, 0x40000
 v_mov_b32 v13, 0
 v_mov_b32 v14, 0
 v_min_u32 v15, 1, v17
 v_lshlrev_b32 v15, 28, v15
 v_bfe_u32 v18, v17, 3, 2
 v_and_b32 v19, 7, v17
 v_lshlrev_b32 v19, 7, v19
 v_lshl_add_u32 v18, v18, 11, v19
 v_lshrrev_b32 v19, 5, v17
 v_lshl_or_b32 v11, v19, 28, v18
 s_mov_b32 s56, s61
 v_mov_b32 v18, 0x44444444
 v_mov_b32 v19, 0xeeeeeeee
 v_and_b32 v20, 2, v17
 v_cmp_eq_u32 vcc, 0, v20
 s_nop 1
 v_cndmask_b32 v12, v19, v18, vcc
 v_mov_b32 v217, 0
 v_mov_b32 v218, 0
 v_mov_b32 v220, 0x3f803f80
 v_mov_b32 v221, 0x3f803f80
 v_mov_b32 v222, 0x3f803f80
 v_mov_b32 v223, 0x3f803f80
 v_and_b32 v18, 15, v17
 v_lshrrev_b32 v19, 4, v17
 v_lshlrev_b32 v19, 2, v19
 v_sub_u32 v18, v18, v19
 s_lshr_b32 s45, s54, 6
 v_add_u32 v18, s45, v18
 v_mov_b32 v19, 0xff800000
 v_cmp_le_i32 vcc, 0, v18
 s_nop 1
 v_cndmask_b32 v208, v19, v13, vcc
 v_cmp_le_i32 vcc, 1, v18
 s_nop 1
 v_cndmask_b32 v209, v19, v13, vcc
 v_cmp_le_i32 vcc, 2, v18
 s_nop 1
 v_cndmask_b32 v210, v19, v13, vcc
 v_cmp_le_i32 vcc, 3, v18
 s_nop 1
 v_cndmask_b32 v211, v19, v13, vcc
 v_cmp_le_i32 vcc, 16, v18
 s_nop 1
 v_cndmask_b32 v212, v19, v13, vcc
 v_cmp_le_i32 vcc, 17, v18
 s_nop 1
 v_cndmask_b32 v213, v19, v13, vcc
 v_cmp_le_i32 vcc, 18, v18
 s_nop 1
 v_cndmask_b32 v214, v19, v13, vcc
 v_cmp_le_i32 vcc, 19, v18
 s_nop 1
 v_cndmask_b32 v215, v19, v13, vcc
Lqs_22:
 buffer_load_dword v16, v15, s[20:23], s57 offen sc1
 s_waitcnt vmcnt(0)
 v_cmp_le_u32 vcc, 1, v16
 s_cbranch_vccnz Lqsk_23
 s_sleep 2
 s_sub_u32 s58, s58, 1
 s_cbranch_scc0 Lqs_22
 s_endpgm
Lqsk_23:
 s_waitcnt vmcnt(0) lgkmcnt(0)
 s_barrier
 ds_read_b128 v[32:35], v6 offset:0
 ds_read_b128 v[36:39], v6 offset:2048
 ds_read_b128 v[40:43], v7 offset:0
 ds_read_b128 v[44:47], v7 offset:2048
 s_waitcnt lgkmcnt(2)
Lqb_loop_24:
 v_mfma_f32_16x16x32_bf16 v[64:67], a[0:3], v[32:35], 0
 ds_read_b128 v[48:51], v6 offset:4096
 v_mfma_f32_16x16x32_bf16 v[72:75], a[72:75], v[32:35], 0
 ds_read_b128 v[52:55], v6 offset:6144
 v_mfma_f32_16x16x32_bf16 v[80:83], a[144:147], v[32:35], 0
 s_add_u32 s41, s40, 2
 v_mfma_f32_16x16x32_bf16 v[88:91], a[216:219], v[32:35], 0
 s_add_u32 s45, s42, 2
 s_mul_i32 s46, s41, 36864
 v_mfma_f32_16x16x32_bf16 v[68:71], a[0:3], v[36:39], 0
 s_cmp_lt_u32 s45, s36
 s_cselect_b32 s46, s46, 0
 v_mfma_f32_16x16x32_bf16 v[76:79], a[72:75], v[36:39], 0
 s_lshl_b32 s49, s4, 10
 s_add_u32 s49, s49, s44
 v_mfma_f32_16x16x32_bf16 v[84:87], a[144:147], v[36:39], 0
 s_lshl_b32 s53, s39, 19
 s_add_u32 s53, s53, s61
 v_mfma_f32_16x16x32_bf16 v[92:95], a[216:219], v[36:39], 0
 s_waitcnt lgkmcnt(2)
 v_mfma_f32_16x16x32_bf16 v[64:67], a[4:7], v[40:43], v[64:67]
 ds_read_b128 v[56:59], v7 offset:4096
 v_mfma_f32_16x16x32_bf16 v[72:75], a[76:79], v[40:43], v[72:75]
 ds_read_b128 v[60:63], v7 offset:6144
 v_mfma_f32_16x16x32_bf16 v[80:83], a[148:151], v[40:43], v[80:83]
 s_add_u32 m0, s49, 0
 v_mfma_f32_16x16x32_bf16 v[88:91], a[220:223], v[40:43], v[88:91]
 buffer_load_dwordx4 v10, s[8:11], s46 offen offset:0  lds
 v_mfma_f32_16x16x32_bf16 v[68:71], a[4:7], v[44:47], v[68:71]
 s_add_u32 m0, s49, 3968
 v_mfma_f32_16x16x32_bf16 v[76:79], a[76:79], v[44:47], v[76:79]
 buffer_load_dwordx4 v10, s[8:11], s46 offen offset:128  lds
 v_mfma_f32_16x16x32_bf16 v[84:87], a[148:151], v[44:47], v[84:87]
 s_lshl_b32 s55, s39, 17
 s_add_u32 s55, s55, s62
 v_mfma_f32_16x16x32_bf16 v[92:95], a[220:223], v[44:47], v[92:95]
 s_waitcnt lgkmcnt(2)
 v_mfma_f32_16x16x32_bf16 v[64:67], a[8:11], v[48:51], v[64:67]
 ds_read_b128 v[32:35], v6 offset:8192
 v_mfma_f32_16x16x32_bf16 v[72:75], a[80:83], v[48:51], v[72:75]
 ds_read_b128 v[36:39], v6 offset:10240
 v_mfma_f32_16x16x32_bf16 v[80:83], a[152:155], v[48:51], v[80:83]
 s_add_u32 m0, s49, 7936
 v_mfma_f32_16x16x32_bf16 v[88:91], a[224:227], v[48:51], v[88:91]
 buffer_load_dwordx4 v10, s[8:11], s46 offen offset:256  lds
 v_mfma_f32_16x16x32_bf16 v[68:71], a[8:11], v[52:55], v[68:71]
 s_add_u32 m0, s49, 11904
 v_mfma_f32_16x16x32_bf16 v[76:79], a[80:83], v[52:55], v[76:79]
 buffer_load_dwordx4 v10, s[8:11], s46 offen offset:384  lds
 v_mfma_f32_16x16x32_bf16 v[84:87], a[152:155], v[52:55], v[84:87]
 v_mfma_f32_16x16x32_bf16 v[92:95], a[224:227], v[52:55], v[92:95]
 s_waitcnt lgkmcnt(2)
 v_mfma_f32_16x16x32_bf16 v[64:67], a[12:15], v[56:59], v[64:67]
 ds_read_b128 v[40:43], v7 offset:8192
 v_mfma_f32_16x16x32_bf16 v[72:75], a[84:87], v[56:59], v[72:75]
 ds_read_b128 v[44:47], v7 offset:10240
 v_mfma_f32_16x16x32_bf16 v[80:83], a[156:159], v[56:59], v[80:83]
 s_add_u32 m0, s49, 15872
 v_mfma_f32_16x16x32_bf16 v[88:91], a[228:231], v[56:59], v[88:91]
 buffer_load_dwordx4 v10, s[8:11], s46 offen offset:512  lds
 v_mfma_f32_16x16x32_bf16 v[68:71], a[12:15], v[60:63], v[68:71]
 s_add_u32 m0, s49, 19840
 v_mfma_f32_16x16x32_bf16 v[76:79], a[84:87], v[60:63], v[76:79]
 buffer_load_dwordx4 v10, s[8:11], s46 offen offset:640  lds
 v_mfma_f32_16x16x32_bf16 v[84:87], a[156:159], v[60:63], v[84:87]
 s_add_u32 s60, s39, 1
 v_mfma_f32_16x16x32_bf16 v[92:95], a[228:231], v[60:63], v[92:95]
 s_waitcnt lgkmcnt(2)
 v_mfma_f32_16x16x32_bf16 v[64:67], a[16:19], v[32:35], v[64:67]
 ds_read_b128 v[48:51], v6 offset:12288
 v_mfma_f32_16x16x32_bf16 v[72:75], a[88:91], v[32:35], v[72:75]
 ds_read_b128 v[52:55], v6 offset:14336
 v_mfma_f32_16x16x32_bf16 v[80:83], a[160:163], v[32:35], v[80:83]
 s_add_u32 m0, s49, 23808
 v_mfma_f32_16x16x32_bf16 v[88:91], a[232:235], v[32:35], v[88:91]
 buffer_load_dwordx4 v10, s[8:11], s46 offen offset:768  lds
 v_mfma_f32_16x16x32_bf16 v[68:71], a[16:19], v[36:39], v[68:71]
 s_add_u32 m0, s49, 27776
 v_mfma_f32_16x16x32_bf16 v[76:79], a[88:91], v[36:39], v[76:79]
 buffer_load_dwordx4 v10, s[8:11], s46 offen offset:896  lds
 v_mfma_f32_16x16x32_bf16 v[84:87], a[160:163], v[36:39], v[84:87]
 v_mfma_f32_16x16x32_bf16 v[92:95], a[232:235], v[36:39], v[92:95]
 s_waitcnt lgkmcnt(2)
 v_mfma_f32_16x16x32_bf16 v[64:67], a[20:23], v[40:43], v[64:67]
 ds_read_b128 v[56:59], v7 offset:12288
 v_mfma_f32_16x16x32_bf16 v[72:75], a[92:95], v[40:43], v[72:75]
 ds_read_b128 v[60:63], v7 offset:14336
 v_mfma_f32_16x16x32_bf16 v[80:83], a[164:167], v[40:43], v[80:83]
 s_add_u32 m0, s49, 31744
 v_mfma_f32_16x16x32_bf16 v[88:91], a[236:239], v[40:43], v[88:91]
 buffer_load_dwordx4 v10, s[8:11], s46 offen offset:1024  lds
 v_mfma_f32_16x16x32_bf16 v[68:71], a[20:23], v[44:47], v[68:71]
 v_mfma_f32_16x16x32_bf16 v[76:79], a[92:95], v[44:47], v[76:79]
 v_mfma_f32_16x16x32_bf16 v[84:87], a[164:167], v[44:47], v[84:87]
 v_mfma_f32_16x16x32_bf16 v[92:95], a[236:239], v[44:47], v[92:95]
 s_waitcnt lgkmcnt(2)
 v_mfma_f32_16x16x32_bf16 v[64:67], a[24:27], v[48:51], v[64:67]
 ds_read_b128 v[32:35], v6 offset:16384
 v_mfma_f32_16x16x32_bf16 v[72:75], a[96:99], v[48:51], v[72:75]
 ds_read_b128 v[36:39], v6 offset:18432
 v_mfma_f32_16x16x32_bf16 v[80:83], a[168:171], v[48:51], v[80:83]
 s_waitcnt vmcnt(9)
 buffer_load_dword v17, v11, s[20:23], s56 offen sc1
 v_mfma_f32_16x16x32_bf16 v[88:91], a[240:243], v[48:51], v[88:91]
 s_barrier
 buffer_store_dword v14, v8, s[20:23], s59 offen sc1
 v_mfma_f32_16x16x32_bf16 v[68:71], a[24:27], v[52:55], v[68:71]
 buffer_load_dword v16, v15, s[20:23], s57 offen sc1
 v_mfma_f32_16x16x32_bf16 v[76:79], a[96:99], v[52:55], v[76:79]
 v_mfma_f32_16x16x32_bf16 v[84:87], a[168:171], v[52:55], v[84:87]
 s_lshl_b32 s56, s39, 18
 s_add_u32 s56, s56, s63
 v_mfma_f32_16x16x32_bf16 v[92:95], a[240:243], v[52:55], v[92:95]
 s_waitcnt lgkmcnt(2)
 v_mfma_f32_16x16x32_bf16 v[64:67], a[28:31], v[56:59], v[64:67]
 ds_read_b128 v[40:43], v7 offset:16384
 v_mfma_f32_16x16x32_bf16 v[72:75], a[100:103], v[56:59], v[72:75]
 ds_read_b128 v[44:47], v7 offset:18432
 v_mfma_f32_16x16x32_bf16 v[80:83], a[172:175], v[56:59], v[80:83]
 buffer_load_dwordx4 v[128:131], v1, s[20:23], s53 offen offset:0 sc1
 v_mfma_f32_16x16x32_bf16 v[88:91], a[244:247], v[56:59], v[88:91]
 v_mfma_f32_16x16x32_bf16 v[68:71], a[28:31], v[60:63], v[68:71]
 buffer_load_dwordx4 v[132:135], v1, s[20:23], s53 offen offset:1024 sc1
 v_mfma_f32_16x16x32_bf16 v[76:79], a[100:103], v[60:63], v[76:79]
 v_mfma_f32_16x16x32_bf16 v[84:87], a[172:175], v[60:63], v[84:87]
 v_mfma_f32_16x16x32_bf16 v[92:95], a[244:247], v[60:63], v[92:95]
 s_waitcnt lgkmcnt(2)
 v_mfma_f32_16x16x32_bf16 v[64:67], a[32:35], v[32:35], v[64:67]
 ds_read_b128 v[48:51], v6 offset:20480
 v_mfma_f32_16x16x32_bf16 v[72:75], a[104:107], v[32:35], v[72:75]
 ds_read_b128 v[52:55], v6 offset:22528
 v_mfma_f32_16x16x32_bf16 v[80:83], a[176:179], v[32:35], v[80:83]
 buffer_load_dwordx4 v[136:139], v1, s[20:23], s53 offen offset:2048 sc1
 v_mfma_f32_16x16x32_bf16 v[88:91], a[248:251], v[32:35], v[88:91]
 v_mfma_f32_16x16x32_bf16 v[68:71], a[32:35], v[36:39], v[68:71]
 buffer_load_dwordx4 v[140:143], v1, s[20:23], s53 offen offset:3072 sc1
 v_mfma_f32_16x16x32_bf16 v[76:79], a[104:107], v[36:39], v[76:79]
 v_mfma_f32_16x16x32_bf16 v[84:87], a[176:179], v[36:39], v[84:87]
 s_add_u32 s53, s53, 4096
 v_mfma_f32_16x16x32_bf16 v[92:95], a[248:251], v[36:39], v[92:95]
 s_waitcnt lgkmcnt(2)
 v_mfma_f32_16x16x32_bf16 v[64:67], a[36:39], v[40:43], v[64:67]
 ds_read_b128 v[56:59], v7 offset:20480
 v_mfma_f32_16x16x32_bf16 v[72:75], a[108:111], v[40:43], v[72:75]
 ds_read_b128 v[60:63], v7 offset:22528
 v_mfma_f32_16x16x32_bf16 v[80:83], a[180:183], v[40:43], v[80:83]
 buffer_load_dwordx4 v[144:147], v1, s[20:23], s53 offen offset:0 sc1
 v_mfma_f32_16x16x32_bf16 v[88:91], a[252:255], v[40:43], v[88:91]
 v_mfma_f32_16x16x32_bf16 v[68:71], a[36:39], v[44:47], v[68:71]
 buffer_load_dwordx4 v[148:151], v1, s[20:23], s53 offen offset:1024 sc1
 v_mfma_f32_16x16x32_bf16 v[76:79], a[108:111], v[44:47], v[76:79]
 v_mfma_f32_16x16x32_bf16 v[84:87], a[180:183], v[44:47], v[84:87]
 v_mfma_f32_16x16x32_bf16 v[92:95], a[252:255], v[44:47], v[92:95]
 s_waitcnt lgkmcnt(2)
 v_mfma_f32_16x16x32_bf16 v[64:67], a[40:43], v[48:51], v[64:67]
 ds_read_b128 v[32:35], v6 offset:24576
 v_mfma_f32_16x16x32_bf16 v[72:75], a[112:115], v[48:51], v[72:75]
 ds_read_b128 v[36:39], v6 offset:26624
 v_mfma_f32_16x16x32_bf16 v[80:83], a[184:187], v[48:51], v[80:83]
 buffer_load_dwordx4 v[152:155], v1, s[20:23], s53 offen offset:2048 sc1
 v_mfma_f32_16x16x32_bf16 v[88:91], v[224:227], v[48:51], v[88:91]
 v_mfma_f32_16x16x32_bf16 v[68:71], a[40:43], v[52:55], v[68:71]
 buffer_load_dwordx4 v[156:159], v1, s[20:23], s53 offen offset:3072 sc1
 v_mfma_f32_16x16x32_bf16 v[76:79], a[112:115], v[52:55], v[76:79]
 v_mfma_f32_16x16x32_bf16 v[84:87], a[184:187], v[52:55], v[84:87]
 s_add_u32 s53, s53, 4096
 v_mfma_f32_16x16x32_bf16 v[92:95], v[224:227], v[52:55], v[92:95]
 s_waitcnt lgkmcnt(2)
 v_mfma_f32_16x16x32_bf16 v[64:67], a[44:47], v[56:59], v[64:67]
 ds_read_b128 v[40:43], v7 offset:24576
 v_mfma_f32_16x16x32_bf16 v[72:75], a[116:119], v[56:59], v[72:75]
 ds_read_b128 v[44:47], v7 offset:26624
 v_mfma_f32_16x16x32_bf16 v[80:83], a[188:191], v[56:59], v[80:83]
 buffer_load_dwordx4 v[160:163], v1, s[20:23], s53 offen offset:0 sc1
 v_mfma_f32_16x16x32_bf16 v[88:91], v[228:231], v[56:59], v[88:91]
 v_mfma_f32_16x16x32_bf16 v[68:71], a[44:47], v[60:63], v[68:71]
 buffer_load_dwordx4 v[164:167], v1, s[20:23], s53 offen offset:1024 sc1
 v_mfma_f32_16x16x32_bf16 v[76:79], a[116:119], v[60:63], v[76:79]
 v_mfma_f32_16x16x32_bf16 v[84:87], a[188:191], v[60:63], v[84:87]
 v_mfma_f32_16x16x32_bf16 v[92:95], v[228:231], v[60:63], v[92:95]
 s_waitcnt lgkmcnt(2)
 v_mfma_f32_16x16x32_bf16 v[64:67], a[48:51], v[32:35], v[64:67]
 ds_read_b128 v[48:51], v6 offset:28672
 v_mfma_f32_16x16x32_bf16 v[72:75], a[120:123], v[32:35], v[72:75]
 ds_read_b128 v[52:55], v6 offset:30720
 v_mfma_f32_16x16x32_bf16 v[80:83], a[192:195], v[32:35], v[80:83]
 buffer_load_dwordx4 v[168:171], v1, s[20:23], s53 offen offset:2048 sc1
 v_mfma_f32_16x16x32_bf16 v[88:91], v[232:235], v[32:35], v[88:91]
 v_mfma_f32_16x16x32_bf16 v[68:71], a[48:51], v[36:39], v[68:71]
 buffer_load_dwordx4 v[172:175], v1, s[20:23], s53 offen offset:3072 sc1
 v_mfma_f32_16x16x32_bf16 v[76:79], a[120:123], v[36:39], v[76:79]
 v_mfma_f32_16x16x32_bf16 v[84:87], a[192:195], v[36:39], v[84:87]
 s_add_u32 s53, s53, 4096
 v_mfma_f32_16x16x32_bf16 v[92:95], v[232:235], v[36:39], v[92:95]
 s_waitcnt lgkmcnt(2)
 v_mfma_f32_16x16x32_bf16 v[64:67], a[52:55], v[40:43], v[64:67]
 ds_read_b128 v[56:59], v7 offset:28672
 v_mfma_f32_16x16x32_bf16 v[72:75], a[124:127], v[40:43], v[72:75]
 ds_read_b128 v[60:63], v7 offset:30720
 v_mfma_f32_16x16x32_bf16 v[80:83], a[196:199], v[40:43], v[80:83]
 s_add_u32 s43, s43, 36864
 s_cmp_eq_u32 s43, 147456
 buffer_load_dwordx4 v[176:179], v1, s[20:23], s53 offen offset:0 sc1
 v_mfma_f32_16x16x32_bf16 v[88:91], v[236:239], v[40:43], v[88:91]
 s_cselect_b32 s43, 0, s43
 s_add_u32 s44, s44, 36864
 v_mfma_f32_16x16x32_bf16 v[68:71], a[52:55], v[44:47], v[68:71]
 s_cmp_eq_u32 s44, 147456
 s_cselect_b32 s44, 0, s44
 buffer_load_dwordx4 v[180:183], v1, s[20:23], s53 offen offset:1024 sc1
 v_mfma_f32_16x16x32_bf16 v[76:79], a[124:127], v[44:47], v[76:79]
 v_mfma_f32_16x16x32_bf16 v[84:87], a[196:199], v[44:47], v[84:87]
 v_mfma_f32_16x16x32_bf16 v[92:95], v[236:239], v[44:47], v[92:95]
 s_waitcnt lgkmcnt(2)
 v_mfma_f32_16x16x32_bf16 v[64:67], a[56:59], v[48:51], v[64:67]
 ds_read_b128 v[32:35], v6 offset:32768
 v_mfma_f32_16x16x32_bf16 v[72:75], a[128:131], v[48:51], v[72:75]
 ds_read_b128 v[36:39], v6 offset:34816
 v_mfma_f32_16x16x32_bf16 v[80:83], a[200:203], v[48:51], v[80:83]
 v_add_u32 v6, s43, v4
 buffer_load_dwordx4 v[184:187], v1, s[20:23], s53 offen offset:2048 sc1
 v_mfma_f32_16x16x32_bf16 v[88:91], v[240:243], v[48:51], v[88:91]
 v_mfma_f32_16x16x32_bf16 v[68:71], a[56:59], v[52:55], v[68:71]
 buffer_load_dwordx4 v[188:191], v1, s[20:23], s53 offen offset:3072 sc1
 v_mfma_f32_16x16x32_bf16 v[76:79], a[128:131], v[52:55], v[76:79]
 v_mfma_f32_16x16x32_bf16 v[84:87], a[200:203], v[52:55], v[84:87]
 v_mfma_f32_16x16x32_bf16 v[92:95], v[240:243], v[52:55], v[92:95]
 s_waitcnt lgkmcnt(2)
 v_mfma_f32_16x16x32_bf16 v[64:67], a[60:63], v[56:59], v[64:67]
 ds_read_b128 v[40:43], v7 offset:32768
 v_mfma_f32_16x16x32_bf16 v[72:75], a[132:135], v[56:59], v[72:75]
 ds_read_b128 v[44:47], v7 offset:34816
 v_mfma_f32_16x16x32_bf16 v[80:83], a[204:207], v[56:59], v[80:83]
 v_add_u32 v7, s43, v5
 v_mfma_f32_16x16x32_bf16 v[88:91], v[244:247], v[56:59], v[88:91]
 v_mfma_f32_16x16x32_bf16 v[68:71], a[60:63], v[60:63], v[68:71]
 v_mfma_f32_16x16x32_bf16 v[76:79], a[132:135], v[60:63], v[76:79]
 v_mfma_f32_16x16x32_bf16 v[84:87], a[204:207], v[60:63], v[84:87]
 v_mfma_f32_16x16x32_bf16 v[92:95], v[244:247], v[60:63], v[92:95]
 s_waitcnt lgkmcnt(2)
 v_mfma_f32_16x16x32_bf16 v[64:67], a[64:67], v[32:35], v[64:67]
 s_waitcnt vmcnt(28)
 s_barrier
 ds_read_b128 v[48:51], v6 offset:0
 v_mfma_f32_16x16x32_bf16 v[72:75], a[136:139], v[32:35], v[72:75]
 ds_read_b128 v[52:55], v6 offset:2048
 v_mfma_f32_16x16x32_bf16 v[80:83], a[208:211], v[32:35], v[80:83]
 v_mfma_f32_16x16x32_bf16 v[88:91], v[248:251], v[32:35], v[88:91]
 s_waitcnt vmcnt(16)
 v_cmp_le_u32 vcc, s60, v16
 v_mfma_f32_16x16x32_bf16 v[68:71], a[64:67], v[36:39], v[68:71]
 v_mfma_f32_16x16x32_bf16 v[76:79], a[136:139], v[36:39], v[76:79]
 s_and_b32 s64, vcc_lo, 1
 s_cbranch_scc0 Lqsk_25
 buffer_load_dwordx4 v[192:195], v1, s[20:23], s55 offen offset:0 sc1
 buffer_load_dwordx4 v[196:199], v1, s[20:23], s55 offen offset:1024 sc1
 buffer_load_dwordx4 v[200:203], v1, s[20:23], s55 offen offset:2048 sc1
 buffer_load_dwordx4 v[204:207], v1, s[20:23], s55 offen offset:3072 sc1
Lqsk_25:
 v_mfma_f32_16x16x32_bf16 v[84:87], a[208:211], v[36:39], v[84:87]
 v_mfma_f32_16x16x32_bf16 v[92:95], v[248:251], v[36:39], v[92:95]
 s_waitcnt lgkmcnt(2)
 v_mfma_f32_16x16x32_bf16 v[64:67], a[68:71], v[40:43], v[64:67]
 ds_read_b128 v[56:59], v7 offset:0
 v_mfma_f32_16x16x32_bf16 v[72:75], a[140:143], v[40:43], v[72:75]
 ds_read_b128 v[60:63], v7 offset:2048
 v_mfma_f32_16x16x32_bf16 v[80:83], a[212:215], v[40:43], v[80:83]
 v_mfma_f32_16x16x32_bf16 v[88:91], v[252:255], v[40:43], v[88:91]
 s_mov_b32 s39, s40
 s_mov_b32 s40, s41
 v_mfma_f32_16x16x32_bf16 v[68:71], a[68:71], v[44:47], v[68:71]
 s_add_u32 s42, s42, 1
 v_mov_b32 v14, s42
 v_mfma_f32_16x16x32_bf16 v[76:79], a[140:143], v[44:47], v[76:79]
 v_mfma_f32_16x16x32_bf16 v[84:87], a[212:215], v[44:47], v[84:87]
 v_mfma_f32_16x16x32_bf16 v[92:95], v[252:255], v[44:47], v[92:95]
 s_waitcnt lgkmcnt(2)
 s_nop 7
 v_cvt_pk_bf16_f32 v16, v64, v72
 v_cvt_pk_bf16_f32 v17, v65, v73
 v_cvt_pk_bf16_f32 v18, v66, v74
 v_cvt_pk_bf16_f32 v19, v67, v75
 ds_write_b128 v2, v[16:19] offset:0
 v_cvt_pk_bf16_f32 v20, v68, v76
 v_cvt_pk_bf16_f32 v21, v69, v77
 v_cvt_pk_bf16_f32 v22, v70, v78
 v_cvt_pk_bf16_f32 v23, v71, v79
 ds_write_b128 v2, v[20:23] offset:1024
 v_cvt_pk_bf16_f32 v24, v80, v88
 v_cvt_pk_bf16_f32 v25, v81, v89
 v_cvt_pk_bf16_f32 v26, v82, v90
 v_cvt_pk_bf16_f32 v27, v83, v91
 ds_write_b128 v2, v[24:27] offset:8192
 v_cvt_pk_bf16_f32 v28, v84, v92
 v_cvt_pk_bf16_f32 v29, v85, v93
 v_cvt_pk_bf16_f32 v30, v86, v94
 v_cvt_pk_bf16_f32 v31, v87, v95
 ds_write_b128 v2, v[28:31] offset:9216
 v_mov_b64 v[120:121], 0
 v_mov_b64 v[122:123], 0
 s_waitcnt lgkmcnt(0)
 s_barrier
 ds_read_b128 v[96:99], v3 offset:0
 ds_read_b128 v[100:103], v3 offset:2048
 ds_read_b128 v[104:107], v3 offset:4096
 ds_read_b128 v[108:111], v3 offset:6144
 s_cmp_lg_u32 s64, 0
 s_cbranch_scc1 Lqpre_26
Lqs_27:
 buffer_load_dword v16, v15, s[20:23], s57 offen sc1
 s_waitcnt vmcnt(0)
 v_cmp_le_u32 vcc, s60, v16
 s_cbranch_vccnz Lqsk_28
 s_sleep 2
 s_sub_u32 s58, s58, 1
 s_cbranch_scc0 Lqs_27
 s_endpgm
Lqsk_28:
 buffer_load_dwordx4 v[192:195], v1, s[20:23], s55 offen offset:0 sc1
 buffer_load_dwordx4 v[196:199], v1, s[20:23], s55 offen offset:1024 sc1
 buffer_load_dwordx4 v[200:203], v1, s[20:23], s55 offen offset:2048 sc1
 buffer_load_dwordx4 v[204:207], v1, s[20:23], s55 offen offset:3072 sc1
Lqpre_26:
 s_waitcnt vmcnt(4) lgkmcnt(0)
 v_mfma_f32_16x16x32_bf16 v[112:115], v[128:131], v[96:99], v[208:211]
 v_mfma_f32_16x16x32_bf16 v[116:119], v[132:135], v[96:99], v[212:215]
 v_mfma_f32_16x16x32_bf16 v[112:115], v[136:139], v[100:103], v[112:115]
 v_mfma_f32_16x16x32_bf16 v[116:119], v[140:143], v[100:103], v[116:119]
 v_mfma_f32_16x16x32_bf16 v[112:115], v[144:147], v[104:107], v[112:115]
 v_mfma_f32_16x16x32_bf16 v[116:119], v[148:151], v[104:107], v[116:119]
 v_mfma_f32_16x16x32_bf16 v[112:115], v[152:155], v[108:111], v[112:115]
 v_mfma_f32_16x16x32_bf16 v[116:119], v[156:159], v[108:111], v[116:119]
 s_nop 7
 v_max3_f32 v24, v112, v113, v114
 v_max3_f32 v24, v24, v115, v116
 v_max3_f32 v24, v24, v117, v118
 v_max_f32 v24, v24, v119
 s_waitcnt vmcnt(2)
 v_mov_b64 v[16:17], v[192:193]
 v_mov_b64 v[18:19], v[196:197]
 s_nop 1
 v_smfmac_f32_16x16x64_bf16 v[120:123], v[16:19], v[96:103], v12
 s_waitcnt vmcnt(0)
 v_mov_b64 v[20:21], v[200:201]
 v_mov_b64 v[22:23], v[204:205]
 s_nop 1
 v_smfmac_f32_16x16x64_bf16 v[120:123], v[20:23], v[104:111], v12
 s_nop 7
 v_add_f32 v120, v120, v122
 v_add_f32 v121, v121, v123
 v_mul_f32 v120, s50, v120
 v_mul_f32 v121, s50, v121
 v_max3_f32 v24, v24, v120, v121
 v_mov_b32 v25, v24
 s_nop 1
 v_permlane16_swap_b32 v24, v25
 v_max_f32 v24, v24, v25
 v_mov_b32 v25, v24
 s_nop 1
 v_permlane32_swap_b32 v24, v25
 v_max_f32 v24, v24, v25
 v_sub_f32 v112, v112, v24
 v_sub_f32 v113, v113, v24
 v_sub_f32 v114, v114, v24
 v_sub_f32 v115, v115, v24
 v_sub_f32 v116, v116, v24
 v_sub_f32 v117, v117, v24
 v_sub_f32 v118, v118, v24
 v_sub_f32 v119, v119, v24
 v_sub_f32 v120, v120, v24
 v_sub_f32 v121, v121, v24
 v_exp_f32 v120, v120
 v_exp_f32 v121, v121
 v_exp_f32 v112, v112
 v_exp_f32 v113, v113
 v_exp_f32 v114, v114
 v_exp_f32 v115, v115
 v_exp_f32 v116, v116
 v_exp_f32 v117, v117
 v_exp_f32 v118, v118
 v_exp_f32 v119, v119
 v_cvt_pk_bf16_f32 v216, v120, v121
 v_cvt_pk_bf16_f32 v219, v120, v121
 v_cvt_pk_bf16_f32 v28, v112, v113
 v_cvt_pk_bf16_f32 v29, v116, v117
 v_cvt_pk_bf16_f32 v30, v114, v115
 v_cvt_pk_bf16_f32 v31, v118, v119
 v_mfma_f32_16x16x16_bf16 v[124:127], v[220:221], v[216:217], 0
 v_mfma_f32_16x16x16_bf16 v[64:67], v[194:195], v[216:217], 0
 v_mfma_f32_16x16x16_bf16 v[68:71], v[194:195], v[218:219], 0
 v_mfma_f32_16x16x16_bf16 v[72:75], v[198:199], v[216:217], 0
 v_mfma_f32_16x16x16_bf16 v[76:79], v[198:199], v[218:219], 0
 v_mfma_f32_16x16x16_bf16 v[80:83], v[202:203], v[216:217], 0
 v_mfma_f32_16x16x16_bf16 v[84:87], v[202:203], v[218:219], 0
 v_mfma_f32_16x16x16_bf16 v[88:91], v[206:207], v[216:217], 0
 v_mfma_f32_16x16x16_bf16 v[92:95], v[206:207], v[218:219], 0
 v_mfma_f32_16x16x32_bf16 v[124:127], v[220:223], v[28:31], v[124:127]
 v_mfma_f32_16x16x32_bf16 v[64:67], v[160:163], v[28:31], v[64:67]
 v_mfma_f32_16x16x32_bf16 v[68:71], v[164:167], v[28:31], v[68:71]
 v_mfma_f32_16x16x32_bf16 v[72:75], v[168:171], v[28:31], v[72:75]
 v_mfma_f32_16x16x32_bf16 v[76:79], v[172:175], v[28:31], v[76:79]
 v_mfma_f32_16x16x32_bf16 v[80:83], v[176:179], v[28:31], v[80:83]
 v_mfma_f32_16x16x32_bf16 v[84:87], v[180:183], v[28:31], v[84:87]
 v_mfma_f32_16x16x32_bf16 v[88:91], v[184:187], v[28:31], v[88:91]
 v_mfma_f32_16x16x32_bf16 v[92:95], v[188:191], v[28:31], v[92:95]
 v_rcp_f32 v124, v124
 s_add_u32 s45, s56, 4096
 v_mul_f32 v64, v64, v124
 v_mul_f32 v65, v65, v124
 v_mul_f32 v66, v66, v124
 v_mul_f32 v67, v67, v124
 v_mul_f32 v68, v68, v124
 v_mul_f32 v69, v69, v124
 v_mul_f32 v70, v70, v124
 v_mul_f32 v71, v71, v124
 v_cvt_pk_bf16_f32 v96, v64, v65
 v_cvt_pk_bf16_f32 v97, v68, v69
 v_cvt_pk_bf16_f32 v98, v66, v67
 v_cvt_pk_bf16_f32 v99, v70, v71
 buffer_store_dwordx4 v[96:99], v1, s[20:23], s56 offen offset:0 sc1
 v_mul_f32 v72, v72, v124
 v_mul_f32 v73, v73, v124
 v_mul_f32 v74, v74, v124
 v_mul_f32 v75, v75, v124
 v_mul_f32 v76, v76, v124
 v_mul_f32 v77, v77, v124
 v_mul_f32 v78, v78, v124
 v_mul_f32 v79, v79, v124
 v_cvt_pk_bf16_f32 v100, v72, v73
 v_cvt_pk_bf16_f32 v101, v76, v77
 v_cvt_pk_bf16_f32 v102, v74, v75
 v_cvt_pk_bf16_f32 v103, v78, v79
 buffer_store_dwordx4 v[100:103], v1, s[20:23], s56 offen offset:2048 sc1
 v_mul_f32 v80, v80, v124
 v_mul_f32 v81, v81, v124
 v_mul_f32 v82, v82, v124
 v_mul_f32 v83, v83, v124
 v_mul_f32 v84, v84, v124
 v_mul_f32 v85, v85, v124
 v_mul_f32 v86, v86, v124
 v_mul_f32 v87, v87, v124
 v_cvt_pk_bf16_f32 v104, v80, v81
 v_cvt_pk_bf16_f32 v105, v84, v85
 v_cvt_pk_bf16_f32 v106, v82, v83
 v_cvt_pk_bf16_f32 v107, v86, v87
 buffer_store_dwordx4 v[104:107], v1, s[20:23], s45 offen offset:0 sc1
 v_mul_f32 v88, v88, v124
 v_mul_f32 v89, v89, v124
 v_mul_f32 v90, v90, v124
 v_mul_f32 v91, v91, v124
 v_mul_f32 v92, v92, v124
 v_mul_f32 v93, v93, v124
 v_mul_f32 v94, v94, v124
 v_mul_f32 v95, v95, v124
 v_cvt_pk_bf16_f32 v108, v88, v89
 v_cvt_pk_bf16_f32 v109, v92, v93
 v_cvt_pk_bf16_f32 v110, v90, v91
 v_cvt_pk_bf16_f32 v111, v94, v95
 buffer_store_dwordx4 v[108:111], v1, s[20:23], s45 offen offset:2048 sc1
 v_mfma_f32_16x16x32_bf16 v[64:67], a[0:3], v[48:51], 0
 ds_read_b128 v[32:35], v6 offset:4096
 v_mfma_f32_16x16x32_bf16 v[72:75], a[72:75], v[48:51], 0
 ds_read_b128 v[36:39], v6 offset:6144
 v_mfma_f32_16x16x32_bf16 v[80:83], a[144:147], v[48:51], 0
 s_add_u32 s41, s40, 2
 v_mfma_f32_16x16x32_bf16 v[88:91], a[216:219], v[48:51], 0
 s_add_u32 s45, s42, 2
 s_mul_i32 s46, s41, 36864
 v_mfma_f32_16x16x32_bf16 v[68:71], a[0:3], v[52:55], 0
 s_cmp_lt_u32 s45, s36
 s_cselect_b32 s46, s46, 0
 v_mfma_f32_16x16x32_bf16 v[76:79], a[72:75], v[52:55], 0
 s_lshl_b32 s49, s4, 10
 s_add_u32 s49, s49, s44
 v_mfma_f32_16x16x32_bf16 v[84:87], a[144:147], v[52:55], 0
 s_lshl_b32 s53, s39, 19
 s_add_u32 s53, s53, s61
 v_mfma_f32_16x16x32_bf16 v[92:95], a[216:219], v[52:55], 0
 s_waitcnt lgkmcnt(2)
 v_mfma_f32_16x16x32_bf16 v[64:67], a[4:7], v[56:59], v[64:67]
 ds_read_b128 v[40:43], v7 offset:4096
 v_mfma_f32_16x16x32_bf16 v[72:75], a[76:79], v[56:59], v[72:75]
 ds_read_b128 v[44:47], v7 offset:6144
 v_mfma_f32_16x16x32_bf16 v[80:83], a[148:151], v[56:59], v[80:83]
 s_add_u32 m0, s49, 0
 v_mfma_f32_16x16x32_bf16 v[88:91], a[220:223], v[56:59], v[88:91]
 buffer_load_dwordx4 v10, s[8:11], s46 offen offset:0  lds
 v_mfma_f32_16x16x32_bf16 v[68:71], a[4:7], v[60:63], v[68:71]
 s_add_u32 m0, s49, 3968
 v_mfma_f32_16x16x32_bf16 v[76:79], a[76:79], v[60:63], v[76:79]
 buffer_load_dwordx4 v10, s[8:11], s46 offen offset:128  lds
 v_mfma_f32_16x16x32_bf16 v[84:87], a[148:151], v[60:63], v[84:87]
 s_lshl_b32 s55, s39, 17
 s_add_u32 s55, s55, s62
 v_mfma_f32_16x16x32_bf16 v[92:95], a[220:223], v[60:63], v[92:95]
 s_waitcnt lgkmcnt(2)
 v_mfma_f32_16x16x32_bf16 v[64:67], a[8:11], v[32:35], v[64:67]
 ds_read_b128 v[48:51], v6 offset:8192
 v_mfma_f32_16x16x32_bf16 v[72:75], a[80:83], v[32:35], v[72:75]
 ds_read_b128 v[52:55], v6 offset:10240
 v_mfma_f32_16x16x32_bf16 v[80:83], a[152:155], v[32:35], v[80:83]
 s_add_u32 m0, s49, 7936
 v_mfma_f32_16x16x32_bf16 v[88:91], a[224:227], v[32:35], v[88:91]
 buffer_load_dwordx4 v10, s[8:11], s46 offen offset:256  lds
 v_mfma_f32_16x16x32_bf16 v[68:71], a[8:11], v[36:39], v[68:71]
 s_add_u32 m0, s49, 11904
 v_mfma_f32_16x16x32_bf16 v[76:79], a[80:83], v[36:39], v[76:79]
 buffer_load_dwordx4 v10, s[8:11], s46 offen offset:384  lds
 v_mfma_f32_16x16x32_bf16 v[84:87], a[152:155], v[36:39], v[84:87]
 v_mfma_f32_16x16x32_bf16 v[92:95], a[224:227], v[36:39], v[92:95]
 s_waitcnt lgkmcnt(2)
 v_mfma_f32_16x16x32_bf16 v[64:67], a[12:15], v[40:43], v[64:67]
 ds_read_b128 v[56:59], v7 offset:8192
 v_mfma_f32_16x16x32_bf16 v[72:75], a[84:87], v[40:43], v[72:75]
 ds_read_b128 v[60:63], v7 offset:10240
 v_mfma_f32_16x16x32_bf16 v[80:83], a[156:159], v[40:43], v[80:83]
 s_add_u32 m0, s49, 15872
 v_mfma_f32_16x16x32_bf16 v[88:91], a[228:231], v[40:43], v[88:91]
 buffer_load_dwordx4 v10, s[8:11], s46 offen offset:512  lds
 v_mfma_f32_16x16x32_bf16 v[68:71], a[12:15], v[44:47], v[68:71]
 s_add_u32 m0, s49, 19840
 v_mfma_f32_16x16x32_bf16 v[76:79], a[84:87], v[44:47], v[76:79]
 buffer_load_dwordx4 v10, s[8:11], s46 offen offset:640  lds
 v_mfma_f32_16x16x32_bf16 v[84:87], a[156:159], v[44:47], v[84:87]
 s_add_u32 s60, s39, 1
 v_mfma_f32_16x16x32_bf16 v[92:95], a[228:231], v[44:47], v[92:95]
 s_waitcnt lgkmcnt(2)
 v_mfma_f32_16x16x32_bf16 v[64:67], a[16:19], v[48:51], v[64:67]
 ds_read_b128 v[32:35], v6 offset:12288
 v_mfma_f32_16x16x32_bf16 v[72:75], a[88:91], v[48:51], v[72:75]
 ds_read_b128 v[36:39], v6 offset:14336
 v_mfma_f32_16x16x32_bf16 v[80:83], a[160:163], v[48:51], v[80:83]
 s_add_u32 m0, s49, 23808
 v_mfma_f32_16x16x32_bf16 v[88:91], a[232:235], v[48:51], v[88:91]
 buffer_load_dwordx4 v10, s[8:11], s46 offen offset:768  lds
 v_mfma_f32_16x16x32_bf16 v[68:71], a[16:19], v[52:55], v[68:71]
 s_add_u32 m0, s49, 27776
 v_mfma_f32_16x16x32_bf16 v[76:79], a[88:91], v[52:55], v[76:79]
 buffer_load_dwordx4 v10, s[8:11], s46 offen offset:896  lds
 v_mfma_f32_16x16x32_bf16 v[84:87], a[160:163], v[52:55], v[84:87]
 v_mfma_f32_16x16x32_bf16 v[92:95], a[232:235], v[52:55], v[92:95]
 s_waitcnt lgkmcnt(2)
 v_mfma_f32_16x16x32_bf16 v[64:67], a[20:23], v[56:59], v[64:67]
 ds_read_b128 v[40:43], v7 offset:12288
 v_mfma_f32_16x16x32_bf16 v[72:75], a[92:95], v[56:59], v[72:75]
 ds_read_b128 v[44:47], v7 offset:14336
 v_mfma_f32_16x16x32_bf16 v[80:83], a[164:167], v[56:59], v[80:83]
 s_add_u32 m0, s49, 31744
 v_mfma_f32_16x16x32_bf16 v[88:91], a[236:239], v[56:59], v[88:91]
 buffer_load_dwordx4 v10, s[8:11], s46 offen offset:1024  lds
 v_mfma_f32_16x16x32_bf16 v[68:71], a[20:23], v[60:63], v[68:71]
 v_mfma_f32_16x16x32_bf16 v[76:79], a[92:95], v[60:63], v[76:79]
 v_mfma_f32_16x16x32_bf16 v[84:87], a[164:167], v[60:63], v[84:87]
 v_mfma_f32_16x16x32_bf16 v[92:95], a[236:239], v[60:63], v[92:95]
 s_waitcnt lgkmcnt(2)
 v_mfma_f32_16x16x32_bf16 v[64:67], a[24:27], v[32:35], v[64:67]
 ds_read_b128 v[48:51], v6 offset:16384
 v_mfma_f32_16x16x32_bf16 v[72:75], a[96:99], v[32:35], v[72:75]
 ds_read_b128 v[52:55], v6 offset:18432
 v_mfma_f32_16x16x32_bf16 v[80:83], a[168:171], v[32:35], v[80:83]
 s_waitcnt vmcnt(9)
 buffer_load_dword v17, v11, s[20:23], s56 offen sc1
 v_mfma_f32_16x16x32_bf16 v[88:91], a[240:243], v[32:35], v[88:91]
 s_barrier
 buffer_store_dword v14, v8, s[20:23], s59 offen sc1
 v_mfma_f32_16x16x32_bf16 v[68:71], a[24:27], v[36:39], v[68:71]
 buffer_load_dword v16, v15, s[20:23], s57 offen sc1
 v_mfma_f32_16x16x32_bf16 v[76:79], a[96:99], v[36:39], v[76:79]
 v_mfma_f32_16x16x32_bf16 v[84:87], a[168:171], v[36:39], v[84:87]
 s_lshl_b32 s56, s39, 18
 s_add_u32 s56, s56, s63
 v_mfma_f32_16x16x32_bf16 v[92:95], a[240:243], v[36:39], v[92:95]
 s_waitcnt lgkmcnt(2)
 v_mfma_f32_16x16x32_bf16 v[64:67], a[28:31], v[40:43], v[64:67]
 ds_read_b128 v[56:59], v7 offset:16384
 v_mfma_f32_16x16x32_bf16 v[72:75], a[100:103], v[40:43], v[72:75]
 ds_read_b128 v[60:63], v7 offset:18432
 v_mfma_f32_16x16x32_bf16 v[80:83], a[172:175], v[40:43], v[80:83]
 buffer_load_dwordx4 v[128:131], v1, s[20:23], s53 offen offset:0 sc1
 v_mfma_f32_16x16x32_bf16 v[88:91], a[244:247], v[40:43], v[88:91]
 v_mfma_f32_16x16x32_bf16 v[68:71], a[28:31], v[44:47], v[68:71]
 buffer_load_dwordx4 v[132:135], v1, s[20:23], s53 offen offset:1024 sc1
 v_mfma_f32_16x16x32_bf16 v[76:79], a[100:103], v[44:47], v[76:79]
 v_mfma_f32_16x16x32_bf16 v[84:87], a[172:175], v[44:47], v[84:87]
 v_mfma_f32_16x16x32_bf16 v[92:95], a[244:247], v[44:47], v[92:95]
 s_waitcnt lgkmcnt(2)
 v_mfma_f32_16x16x32_bf16 v[64:67], a[32:35], v[48:51], v[64:67]
 ds_read_b128 v[32:35], v6 offset:20480
 v_mfma_f32_16x16x32_bf16 v[72:75], a[104:107], v[48:51], v[72:75]
 ds_read_b128 v[36:39], v6 offset:22528
 v_mfma_f32_16x16x32_bf16 v[80:83], a[176:179], v[48:51], v[80:83]
 buffer_load_dwordx4 v[136:139], v1, s[20:23], s53 offen offset:2048 sc1
 v_mfma_f32_16x16x32_bf16 v[88:91], a[248:251], v[48:51], v[88:91]
 v_mfma_f32_16x16x32_bf16 v[68:71], a[32:35], v[52:55], v[68:71]
 buffer_load_dwordx4 v[140:143], v1, s[20:23], s53 offen offset:3072 sc1
 v_mfma_f32_16x16x32_bf16 v[76:79], a[104:107], v[52:55], v[76:79]
 v_mfma_f32_16x16x32_bf16 v[84:87], a[176:179], v[52:55], v[84:87]
 s_add_u32 s53, s53, 4096
 v_mfma_f32_16x16x32_bf16 v[92:95], a[248:251], v[52:55], v[92:95]
 s_waitcnt lgkmcnt(2)
 v_mfma_f32_16x16x32_bf16 v[64:67], a[36:39], v[56:59], v[64:67]
 ds_read_b128 v[40:43], v7 offset:20480
 v_mfma_f32_16x16x32_bf16 v[72:75], a[108:111], v[56:59], v[72:75]
 ds_read_b128 v[44:47], v7 offset:22528
 v_mfma_f32_16x16x32_bf16 v[80:83], a[180:183], v[56:59], v[80:83]
 buffer_load_dwordx4 v[144:147], v1, s[20:23], s53 offen offset:0 sc1
 v_mfma_f32_16x16x32_bf16 v[88:91], a[252:255], v[56:59], v[88:91]
 v_mfma_f32_16x16x32_bf16 v[68:71], a[36:39], v[60:63], v[68:71]
 buffer_load_dwordx4 v[148:151], v1, s[20:23], s53 offen offset:1024 sc1
 v_mfma_f32_16x16x32_bf16 v[76:79], a[108:111], v[60:63], v[76:79]
 v_mfma_f32_16x16x32_bf16 v[84:87], a[180:183], v[60:63], v[84:87]
 v_mfma_f32_16x16x32_bf16 v[92:95], a[252:255], v[60:63], v[92:95]
 s_waitcnt lgkmcnt(2)
 v_mfma_f32_16x16x32_bf16 v[64:67], a[40:43], v[32:35], v[64:67]
 ds_read_b128 v[48:51], v6 offset:24576
 v_mfma_f32_16x16x32_bf16 v[72:75], a[112:115], v[32:35], v[72:75]
 ds_read_b128 v[52:55], v6 offset:26624
 v_mfma_f32_16x16x32_bf16 v[80:83], a[184:187], v[32:35], v[80:83]
 buffer_load_dwordx4 v[152:155], v1, s[20:23], s53 offen offset:2048 sc1
 v_mfma_f32_16x16x32_bf16 v[88:91], v[224:227], v[32:35], v[88:91]
 v_mfma_f32_16x16x32_bf16 v[68:71], a[40:43], v[36:39], v[68:71]
 buffer_load_dwordx4 v[156:159], v1, s[20:23], s53 offen offset:3072 sc1
 v_mfma_f32_16x16x32_bf16 v[76:79], a[112:115], v[36:39], v[76:79]
 v_mfma_f32_16x16x32_bf16 v[84:87], a[184:187], v[36:39], v[84:87]
 s_add_u32 s53, s53, 4096
 v_mfma_f32_16x16x32_bf16 v[92:95], v[224:227], v[36:39], v[92:95]
 s_waitcnt lgkmcnt(2)
 v_mfma_f32_16x16x32_bf16 v[64:67], a[44:47], v[40:43], v[64:67]
 ds_read_b128 v[56:59], v7 offset:24576
 v_mfma_f32_16x16x32_bf16 v[72:75], a[116:119], v[40:43], v[72:75]
 ds_read_b128 v[60:63], v7 offset:26624
 v_mfma_f32_16x16x32_bf16 v[80:83], a[188:191], v[40:43], v[80:83]
 buffer_load_dwordx4 v[160:163], v1, s[20:23], s53 offen offset:0 sc1
 v_mfma_f32_16x16x32_bf16 v[88:91], v[228:231], v[40:43], v[88:91]
 v_mfma_f32_16x16x32_bf16 v[68:71], a[44:47], v[44:47], v[68:71]
 buffer_load_dwordx4 v[164:167], v1, s[20:23], s53 offen offset:1024 sc1
 v_mfma_f32_16x16x32_bf16 v[76:79], a[116:119], v[44:47], v[76:79]
 v_mfma_f32_16x16x32_bf16 v[84:87], a[188:191], v[44:47], v[84:87]
 v_mfma_f32_16x16x32_bf16 v[92:95], v[228:231], v[44:47], v[92:95]
 s_waitcnt lgkmcnt(2)
 v_mfma_f32_16x16x32_bf16 v[64:67], a[48:51], v[48:51], v[64:67]
 ds_read_b128 v[32:35], v6 offset:28672
 v_mfma_f32_16x16x32_bf16 v[72:75], a[120:123], v[48:51], v[72:75]
 ds_read_b128 v[36:39], v6 offset:30720
 v_mfma_f32_16x16x32_bf16 v[80:83], a[192:195], v[48:51], v[80:83]
 buffer_load_dwordx4 v[168:171], v1, s[20:23], s53 offen offset:2048 sc1
 v_mfma_f32_16x16x32_bf16 v[88:91], v[232:235], v[48:51], v[88:91]
 v_mfma_f32_16x16x32_bf16 v[68:71], a[48:51], v[52:55], v[68:71]
 buffer_load_dwordx4 v[172:175], v1, s[20:23], s53 offen offset:3072 sc1
 v_mfma_f32_16x16x32_bf16 v[76:79], a[120:123], v[52:55], v[76:79]
 v_mfma_f32_16x16x32_bf16 v[84:87], a[192:195], v[52:55], v[84:87]
 s_add_u32 s53, s53, 4096
 v_mfma_f32_16x16x32_bf16 v[92:95], v[232:235], v[52:55], v[92:95]
 s_waitcnt lgkmcnt(2)
 v_mfma_f32_16x16x32_bf16 v[64:67], a[52:55], v[56:59], v[64:67]
 ds_read_b128 v[40:43], v7 offset:28672
 v_mfma_f32_16x16x32_bf16 v[72:75], a[124:127], v[56:59], v[72:75]
 ds_read_b128 v[44:47], v7 offset:30720
 v_mfma_f32_16x16x32_bf16 v[80:83], a[196:199], v[56:59], v[80:83]
 s_add_u32 s43, s43, 36864
 s_cmp_eq_u32 s43, 147456
 buffer_load_dwordx4 v[176:179], v1, s[20:23], s53 offen offset:0 sc1
 v_mfma_f32_16x16x32_bf16 v[88:91], v[236:239], v[56:59], v[88:91]
 s_cselect_b32 s43, 0, s43
 s_add_u32 s44, s44, 36864
 v_mfma_f32_16x16x32_bf16 v[68:71], a[52:55], v[60:63], v[68:71]
 s_cmp_eq_u32 s44, 147456
 s_cselect_b32 s44, 0, s44
 buffer_load_dwordx4 v[180:183], v1, s[20:23], s53 offen offset:1024 sc1
 v_mfma_f32_16x16x32_bf16 v[76:79], a[124:127], v[60:63], v[76:79]
 v_mfma_f32_16x16x32_bf16 v[84:87], a[196:199], v[60:63], v[84:87]
 v_mfma_f32_16x16x32_bf16 v[92:95], v[236:239], v[60:63], v[92:95]
 s_waitcnt lgkmcnt(2)
 v_mfma_f32_16x16x32_bf16 v[64:67], a[56:59], v[32:35], v[64:67]
 ds_read_b128 v[48:51], v6 offset:32768
 v_mfma_f32_16x16x32_bf16 v[72:75], a[128:131], v[32:35], v[72:75]
 ds_read_b128 v[52:55], v6 offset:34816
 v_mfma_f32_16x16x32_bf16 v[80:83], a[200:203], v[32:35], v[80:83]
 v_add_u32 v6, s43, v4
 buffer_load_dwordx4 v[184:187], v1, s[20:23], s53 offen offset:2048 sc1
 v_mfma_f32_16x16x32_bf16 v[88:91], v[240:243], v[32:35], v[88:91]
 v_mfma_f32_16x16x32_bf16 v[68:71], a[56:59], v[36:39], v[68:71]
 buffer_load_dwordx4 v[188:191], v1, s[20:23], s53 offen offset:3072 sc1
 v_mfma_f32_16x16x32_bf16 v[76:79], a[128:131], v[36:39], v[76:79]
 v_mfma_f32_16x16x32_bf16 v[84:87], a[200:203], v[36:39], v[84:87]
 v_mfma_f32_16x16x32_bf16 v[92:95], v[240:243], v[36:39], v[92:95]
 s_waitcnt lgkmcnt(2)
 v_mfma_f32_16x16x32_bf16 v[64:67], a[60:63], v[40:43], v[64:67]
 ds_read_b128 v[56:59], v7 offset:32768
 v_mfma_f32_16x16x32_bf16 v[72:75], a[132:135], v[40:43], v[72:75]
 ds_read_b128 v[60:63], v7 offset:34816
 v_mfma_f32_16x16x32_bf16 v[80:83], a[204:207], v[40:43], v[80:83]
 v_add_u32 v7, s43, v5
 v_mfma_f32_16x16x32_bf16 v[88:91], v[244:247], v[40:43], v[88:91]
 v_mfma_f32_16x16x32_bf16 v[68:71], a[60:63], v[44:47], v[68:71]
 v_mfma_f32_16x16x32_bf16 v[76:79], a[132:135], v[44:47], v[76:79]
 v_mfma_f32_16x16x32_bf16 v[84:87], a[204:207], v[44:47], v[84:87]
 v_mfma_f32_16x16x32_bf16 v[92:95], v[244:247], v[44:47], v[92:95]
 s_waitcnt lgkmcnt(2)
 v_mfma_f32_16x16x32_bf16 v[64:67], a[64:67], v[48:51], v[64:67]
 s_waitcnt vmcnt(28)
 s_barrier
 ds_read_b128 v[32:35], v6 offset:0
 v_mfma_f32_16x16x32_bf16 v[72:75], a[136:139], v[48:51], v[72:75]
 ds_read_b128 v[36:39], v6 offset:2048
 v_mfma_f32_16x16x32_bf16 v[80:83], a[208:211], v[48:51], v[80:83]
 v_mfma_f32_16x16x32_bf16 v[88:91], v[248:251], v[48:51], v[88:91]
 s_waitcnt vmcnt(16)
 v_cmp_le_u32 vcc, s60, v16
 v_mfma_f32_16x16x32_bf16 v[68:71], a[64:67], v[52:55], v[68:71]
 v_mfma_f32_16x16x32_bf16 v[76:79], a[136:139], v[52:55], v[76:79]
 s_and_b32 s64, vcc_lo, 1
 s_cbranch_scc0 Lqsk_29
 buffer_load_dwordx4 v[192:195], v1, s[20:23], s55 offen offset:0 sc1
 buffer_load_dwordx4 v[196:199], v1, s[20:23], s55 offen offset:1024 sc1
 buffer_load_dwordx4 v[200:203], v1, s[20:23], s55 offen offset:2048 sc1
 buffer_load_dwordx4 v[204:207], v1, s[20:23], s55 offen offset:3072 sc1
Lqsk_29:
 v_mfma_f32_16x16x32_bf16 v[84:87], a[208:211], v[52:55], v[84:87]
 v_mfma_f32_16x16x32_bf16 v[92:95], v[248:251], v[52:55], v[92:95]
 s_waitcnt lgkmcnt(2)
 v_mfma_f32_16x16x32_bf16 v[64:67], a[68:71], v[56:59], v[64:67]
 ds_read_b128 v[40:43], v7 offset:0
 v_mfma_f32_16x16x32_bf16 v[72:75], a[140:143], v[56:59], v[72:75]
 ds_read_b128 v[44:47], v7 offset:2048
 v_mfma_f32_16x16x32_bf16 v[80:83], a[212:215], v[56:59], v[80:83]
 v_mfma_f32_16x16x32_bf16 v[88:91], v[252:255], v[56:59], v[88:91]
 s_mov_b32 s39, s40
 s_mov_b32 s40, s41
 v_mfma_f32_16x16x32_bf16 v[68:71], a[68:71], v[60:63], v[68:71]
 s_add_u32 s42, s42, 1
 v_mov_b32 v14, s42
 v_mfma_f32_16x16x32_bf16 v[76:79], a[140:143], v[60:63], v[76:79]
 v_mfma_f32_16x16x32_bf16 v[84:87], a[212:215], v[60:63], v[84:87]
 v_mfma_f32_16x16x32_bf16 v[92:95], v[252:255], v[60:63], v[92:95]
 s_waitcnt lgkmcnt(2)
 s_nop 7
 v_cvt_pk_bf16_f32 v16, v64, v72
 v_cvt_pk_bf16_f32 v17, v65, v73
 v_cvt_pk_bf16_f32 v18, v66, v74
 v_cvt_pk_bf16_f32 v19, v67, v75
 ds_write_b128 v2, v[16:19] offset:0
 v_cvt_pk_bf16_f32 v20, v68, v76
 v_cvt_pk_bf16_f32 v21, v69, v77
 v_cvt_pk_bf16_f32 v22, v70, v78
 v_cvt_pk_bf16_f32 v23, v71, v79
 ds_write_b128 v2, v[20:23] offset:1024
 v_cvt_pk_bf16_f32 v24, v80, v88
 v_cvt_pk_bf16_f32 v25, v81, v89
 v_cvt_pk_bf16_f32 v26, v82, v90
 v_cvt_pk_bf16_f32 v27, v83, v91
 ds_write_b128 v2, v[24:27] offset:8192
 v_cvt_pk_bf16_f32 v28, v84, v92
 v_cvt_pk_bf16_f32 v29, v85, v93
 v_cvt_pk_bf16_f32 v30, v86, v94
 v_cvt_pk_bf16_f32 v31, v87, v95
 ds_write_b128 v2, v[28:31] offset:9216
 v_mov_b64 v[120:121], 0
 v_mov_b64 v[122:123], 0
 s_waitcnt lgkmcnt(0)
 s_barrier
 ds_read_b128 v[96:99], v3 offset:0
 ds_read_b128 v[100:103], v3 offset:2048
 ds_read_b128 v[104:107], v3 offset:4096
 ds_read_b128 v[108:111], v3 offset:6144
 s_cmp_lg_u32 s64, 0
 s_cbranch_scc1 Lqpre_30
Lqs_31:
 buffer_load_dword v16, v15, s[20:23], s57 offen sc1
 s_waitcnt vmcnt(0)
 v_cmp_le_u32 vcc, s60, v16
 s_cbranch_vccnz Lqsk_32
 s_sleep 2
 s_sub_u32 s58, s58, 1
 s_cbranch_scc0 Lqs_31
 s_endpgm
Lqsk_32:
 buffer_load_dwordx4 v[192:195], v1, s[20:23], s55 offen offset:0 sc1
 buffer_load_dwordx4 v[196:199], v1, s[20:23], s55 offen offset:1024 sc1
 buffer_load_dwordx4 v[200:203], v1, s[20:23], s55 offen offset:2048 sc1
 buffer_load_dwordx4 v[204:207], v1, s[20:23], s55 offen offset:3072 sc1
Lqpre_30:
 s_waitcnt vmcnt(4) lgkmcnt(0)
 v_mfma_f32_16x16x32_bf16 v[112:115], v[128:131], v[96:99], v[208:211]
 v_mfma_f32_16x16x32_bf16 v[116:119], v[132:135], v[96:99], v[212:215]
 v_mfma_f32_16x16x32_bf16 v[112:115], v[136:139], v[100:103], v[112:115]
 v_mfma_f32_16x16x32_bf16 v[116:119], v[140:143], v[100:103], v[116:119]
 v_mfma_f32_16x16x32_bf16 v[112:115], v[144:147], v[104:107], v[112:115]
 v_mfma_f32_16x16x32_bf16 v[116:119], v[148:151], v[104:107], v[116:119]
 v_mfma_f32_16x16x32_bf16 v[112:115], v[152:155], v[108:111], v[112:115]
 v_mfma_f32_16x16x32_bf16 v[116:119], v[156:159], v[108:111], v[116:119]
 s_nop 7
 v_max3_f32 v24, v112, v113, v114
 v_max3_f32 v24, v24, v115, v116
 v_max3_f32 v24, v24, v117, v118
 v_max_f32 v24, v24, v119
 s_waitcnt vmcnt(2)
 v_mov_b64 v[16:17], v[192:193]
 v_mov_b64 v[18:19], v[196:197]
 s_nop 1
 v_smfmac_f32_16x16x64_bf16 v[120:123], v[16:19], v[96:103], v12
 s_waitcnt vmcnt(0)
 v_mov_b64 v[20:21], v[200:201]
 v_mov_b64 v[22:23], v[204:205]
 s_nop 1
 v_smfmac_f32_16x16x64_bf16 v[120:123], v[20:23], v[104:111], v12
 s_nop 7
 v_add_f32 v120, v120, v122
 v_add_f32 v121, v121, v123
 v_mul_f32 v120, s50, v120
 v_mul_f32 v121, s50, v121
 v_max3_f32 v24, v24, v120, v121
 v_mov_b32 v25, v24
 s_nop 1
 v_permlane16_swap_b32 v24, v25
 v_max_f32 v24, v24, v25
 v_mov_b32 v25, v24
 s_nop 1
 v_permlane32_swap_b32 v24, v25
 v_max_f32 v24, v24, v25
 v_sub_f32 v112, v112, v24
 v_sub_f32 v113, v113, v24
 v_sub_f32 v114, v114, v24
 v_sub_f32 v115, v115, v24
 v_sub_f32 v116, v116, v24
 v_sub_f32 v117, v117, v24
 v_sub_f32 v118, v118, v24
 v_sub_f32 v119, v119, v24
 v_sub_f32 v120, v120, v24
 v_sub_f32 v121, v121, v24
 v_exp_f32 v120, v120
 v_exp_f32 v121, v121
 v_exp_f32 v112, v112
 v_exp_f32 v113, v113
 v_exp_f32 v114, v114
 v_exp_f32 v115, v115
 v_exp_f32 v116, v116
 v_exp_f32 v117, v117
 v_exp_f32 v118, v118
 v_exp_f32 v119, v119
 v_cvt_pk_bf16_f32 v216, v120, v121
 v_cvt_pk_bf16_f32 v219, v120, v121
 v_cvt_pk_bf16_f32 v28, v112, v113
 v_cvt_pk_bf16_f32 v29, v116, v117
 v_cvt_pk_bf16_f32 v30, v114, v115
 v_cvt_pk_bf16_f32 v31, v118, v119
 v_mfma_f32_16x16x16_bf16 v[124:127], v[220:221], v[216:217], 0
 v_mfma_f32_16x16x16_bf16 v[64:67], v[194:195], v[216:217], 0
 v_mfma_f32_16x16x16_bf16 v[68:71], v[194:195], v[218:219], 0
 v_mfma_f32_16x16x16_bf16 v[72:75], v[198:199], v[216:217], 0
 v_mfma_f32_16x16x16_bf16 v[76:79], v[198:199], v[218:219], 0
 v_mfma_f32_16x16x16_bf16 v[80:83], v[202:203], v[216:217], 0
 v_mfma_f32_16x16x16_bf16 v[84:87], v[202:203], v[218:219], 0
 v_mfma_f32_16x16x16_bf16 v[88:91], v[206:207], v[216:217], 0
 v_mfma_f32_16x16x16_bf16 v[92:95], v[206:207], v[218:219], 0
 v_mfma_f32_16x16x32_bf16 v[124:127], v[220:223], v[28:31], v[124:127]
 v_mfma_f32_16x16x32_bf16 v[64:67], v[160:163], v[28:31], v[64:67]
 v_mfma_f32_16x16x32_bf16 v[68:71], v[164:167], v[28:31], v[68:71]
 v_mfma_f32_16x16x32_bf16 v[72:75], v[168:171], v[28:31], v[72:75]
 v_mfma_f32_16x16x32_bf16 v[76:79], v[172:175], v[28:31], v[76:79]
 v_mfma_f32_16x16x32_bf16 v[80:83], v[176:179], v[28:31], v[80:83]
 v_mfma_f32_16x16x32_bf16 v[84:87], v[180:183], v[28:31], v[84:87]
 v_mfma_f32_16x16x32_bf16 v[88:91], v[184:187], v[28:31], v[88:91]
 v_mfma_f32_16x16x32_bf16 v[92:95], v[188:191], v[28:31], v[92:95]
 v_rcp_f32 v124, v124
 s_add_u32 s45, s56, 4096
 v_mul_f32 v64, v64, v124
 v_mul_f32 v65, v65, v124
 v_mul_f32 v66, v66, v124
 v_mul_f32 v67, v67, v124
 v_mul_f32 v68, v68, v124
 v_mul_f32 v69, v69, v124
 v_mul_f32 v70, v70, v124
 v_mul_f32 v71, v71, v124
 v_cvt_pk_bf16_f32 v96, v64, v65
 v_cvt_pk_bf16_f32 v97, v68, v69
 v_cvt_pk_bf16_f32 v98, v66, v67
 v_cvt_pk_bf16_f32 v99, v70, v71
 buffer_store_dwordx4 v[96:99], v1, s[20:23], s56 offen offset:0 sc1
 v_mul_f32 v72, v72, v124
 v_mul_f32 v73, v73, v124
 v_mul_f32 v74, v74, v124
 v_mul_f32 v75, v75, v124
 v_mul_f32 v76, v76, v124
 v_mul_f32 v77, v77, v124
 v_mul_f32 v78, v78, v124
 v_mul_f32 v79, v79, v124
 v_cvt_pk_bf16_f32 v100, v72, v73
 v_cvt_pk_bf16_f32 v101, v76, v77
 v_cvt_pk_bf16_f32 v102, v74, v75
 v_cvt_pk_bf16_f32 v103, v78, v79
 buffer_store_dwordx4 v[100:103], v1, s[20:23], s56 offen offset:2048 sc1
 v_mul_f32 v80, v80, v124
 v_mul_f32 v81, v81, v124
 v_mul_f32 v82, v82, v124
 v_mul_f32 v83, v83, v124
 v_mul_f32 v84, v84, v124
 v_mul_f32 v85, v85, v124
 v_mul_f32 v86, v86, v124
 v_mul_f32 v87, v87, v124
 v_cvt_pk_bf16_f32 v104, v80, v81
 v_cvt_pk_bf16_f32 v105, v84, v85
 v_cvt_pk_bf16_f32 v106, v82, v83
 v_cvt_pk_bf16_f32 v107, v86, v87
 buffer_store_dwordx4 v[104:107], v1, s[20:23], s45 offen offset:0 sc1
 v_mul_f32 v88, v88, v124
 v_mul_f32 v89, v89, v124
 v_mul_f32 v90, v90, v124
 v_mul_f32 v91, v91, v124
 v_mul_f32 v92, v92, v124
 v_mul_f32 v93, v93, v124
 v_mul_f32 v94, v94, v124
 v_mul_f32 v95, v95, v124
 v_cvt_pk_bf16_f32 v108, v88, v89
 v_cvt_pk_bf16_f32 v109, v92, v93
 v_cvt_pk_bf16_f32 v110, v90, v91
 v_cvt_pk_bf16_f32 v111, v94, v95
 buffer_store_dwordx4 v[108:111], v1, s[20:23], s45 offen offset:2048 sc1
 s_cmp_lt_u32 s42, s36
 s_cbranch_scc1 Lqb_loop_24
 s_waitcnt vmcnt(0)
 buffer_load_dword v17, v11, s[20:23], s56 offen sc1
 s_barrier
 buffer_store_dword v14, v8, s[20:23], s59 offen sc1
 s_branch Lfin
Lob:
 s_load_dwordx2 s[8:9], s[0:1], 88
 s_mov_b32 s10, 0x480000
 s_mov_b32 s11, 0x20000
 s_sub_u32 s32, s6, 16
 s_mul_i32 s7, s3, 5
 s_add_u32 s7, s7, s6
 s_sub_u32 s7, s7, 25
 s_cmp_lt_u32 s6, 25
 s_cselect_b32 s32, s32, s7
 s_cselect_b32 s33, s3, 4
 s_cselect_b32 s34, 2, 1
 s_cselect_b32 s39, 6, 4
 s_cselect_b32 s35, 22, 20
 s_cselect_b32 s40, 0, 4
 s_mov_b32 s36, 0x7000000
 s_mov_b32 s37, 1152
 s_lshl_b32 s7, s4, 7
 s_add_u32 s38, s7, 0x3800
 s_mov_b32 s93, 1
 s_mov_b32 s92, 3
 s_mov_b32 s91, 9
 s_mov_b32 s90, 1
Los:
 s_load_dwordx2 s[24:25], s[0:1], 104
 s_mov_b32 s26, 0x480000
 s_mov_b32 s27, 0x20000
 s_waitcnt lgkmcnt(0)
 v_and_b32 v15, 63, v0
 v_lshlrev_b32 v1, 4, v15
 v_and_b32 v3, s92, v15
 v_lshlrev_b32 v3, 2, v3
 v_lshrrev_b32 v14, 4, v15
 v_min_u32 v14, 1, v14
 v_lshl_or_b32 v3, v14, 28, v3
 s_add_u32 s44, s32, s40
 s_and_b32 s44, s44, 7
 s_mov_b32 s50, 0x40000
 s_mul_i32 s49, s4, 40960
 v_add_u32 v5, s49, v1
 v_bfe_u32 v14, v15, 5, 1
 v_bfe_u32 v16, v15, 3, 1
 v_lshl_add_u32 v14, v14, 1, v16
 v_bfe_u32 v16, v15, 4, 1
 v_lshl_add_u32 v14, v16, 6, v14
 v_mul_u32_u24 v14, 1152, v14
 v_bfe_u32 v17, v15, 1, 2
 v_xor_b32 v17, v17, v16
 v_lshlrev_b32 v17, 5, v17
 v_and_b32 v16, 1, v15
 v_lshl_add_u32 v17, v16, 4, v17
 v_add_u32 v8, v14, v17
 v_xor_b32 v17, 64, v17
 v_add_u32 v9, v14, v17
 v_lshrrev_b32 v14, 4, v15
 v_bfe_u32 v16, v15, 2, 2
 v_lshl_add_u32 v14, v14, 3, v16
 v_lshlrev_b32 v14, 7, v14
 v_bfe_u32 v16, v15, 3, 2
 v_lshl_add_u32 v14, v16, 5, v14
 v_and_b32 v16, 3, v15
 v_lshl_add_u32 v14, v16, 3, v14
 v_xor_b32 v16, 0, v14
 v_add_u32 v10, s49, v16
 v_xor_b32 v16, 32, v14
 v_add_u32 v11, s49, v16
 v_xor_b32 v16, 64, v14
 v_add_u32 v12, s49, v16
 v_xor_b32 v16, 96, v14
 v_add_u32 v13, s49, v16
 s_lshl_b32 s47, s32, 7
 s_add_u32 s46, s44, 0
 s_and_b32 s46, s46, 7
 s_lshl_b32 s45, s4, 3
 s_add_u32 s46, s46, s45
 s_mul_i32 s46, s46, 147456
 s_add_u32 s46, s46, s47
 s_add_u32 m0, s49, 8192
 s_add_u32 s45, s46, 0
 buffer_load_dwordx4 v8, s[8:11], s45 offen  lds
 s_add_u32 m0, s49, 9216
 s_add_u32 s45, s46, 4608
 buffer_load_dwordx4 v9, s[8:11], s45 offen  lds
 s_add_u32 m0, s49, 10240
 s_add_u32 s45, s46, 9216
 buffer_load_dwordx4 v8, s[8:11], s45 offen  lds
 s_add_u32 m0, s49, 11264
 s_add_u32 s45, s46, 13824
 buffer_load_dwordx4 v9, s[8:11], s45 offen  lds
 s_add_u32 m0, s49, 12288
 s_add_u32 s45, s46, 18432
 buffer_load_dwordx4 v8, s[8:11], s45 offen  lds
 s_add_u32 m0, s49, 13312
 s_add_u32 s45, s46, 23040
 buffer_load_dwordx4 v9, s[8:11], s45 offen  lds
 s_add_u32 m0, s49, 14336
 s_add_u32 s45, s46, 27648
 buffer_load_dwordx4 v8, s[8:11], s45 offen  lds
 s_add_u32 m0, s49, 15360
 s_add_u32 s45, s46, 32256
 buffer_load_dwordx4 v9, s[8:11], s45 offen  lds
 s_add_u32 m0, s49, 16384
 s_add_u32 s45, s46, 36864
 buffer_load_dwordx4 v8, s[8:11], s45 offen  lds
 s_add_u32 m0, s49, 17408
 s_add_u32 s45, s46, 41472
 buffer_load_dwordx4 v9, s[8:11], s45 offen  lds
 s_add_u32 m0, s49, 18432
 s_add_u32 s45, s46, 46080
 buffer_load_dwordx4 v8, s[8:11], s45 offen  lds
 s_add_u32 m0, s49, 19456
 s_add_u32 s45, s46, 50688
 buffer_load_dwordx4 v9, s[8:11], s45 offen  lds
 s_add_u32 m0, s49, 20480
 s_add_u32 s45, s46, 55296
 buffer_load_dwordx4 v8, s[8:11], s45 offen  lds
 s_add_u32 m0, s49, 21504
 s_add_u32 s45, s46, 59904
 buffer_load_dwordx4 v9, s[8:11], s45 offen  lds
 s_add_u32 m0, s49, 22528
 s_add_u32 s45, s46, 64512
 buffer_load_dwordx4 v8, s[8:11], s45 offen  lds
 s_add_u32 m0, s49, 23552
 s_add_u32 s45, s46, 69120
 buffer_load_dwordx4 v9, s[8:11], s45 offen  lds
 s_add_u32 s46, s44, 1
 s_and_b32 s46, s46, 7
 s_lshl_b32 s45, s4, 3
 s_add_u32 s46, s46, s45
 s_mul_i32 s46, s46, 147456
 s_add_u32 s46, s46, s47
 s_add_u32 m0, s49, 24576
 s_add_u32 s45, s46, 0
 buffer_load_dwordx4 v8, s[8:11], s45 offen  lds
 s_add_u32 m0, s49, 25600
 s_add_u32 s45, s46, 4608
 buffer_load_dwordx4 v9, s[8:11], s45 offen  lds
 s_add_u32 m0, s49, 26624
 s_add_u32 s45, s46, 9216
 buffer_load_dwordx4 v8, s[8:11], s45 offen  lds
 s_add_u32 m0, s49, 27648
 s_add_u32 s45, s46, 13824
 buffer_load_dwordx4 v9, s[8:11], s45 offen  lds
 s_add_u32 m0, s49, 28672
 s_add_u32 s45, s46, 18432
 buffer_load_dwordx4 v8, s[8:11], s45 offen  lds
 s_add_u32 m0, s49, 29696
 s_add_u32 s45, s46, 23040
 buffer_load_dwordx4 v9, s[8:11], s45 offen  lds
 s_add_u32 m0, s49, 30720
 s_add_u32 s45, s46, 27648
 buffer_load_dwordx4 v8, s[8:11], s45 offen  lds
 s_add_u32 m0, s49, 31744
 s_add_u32 s45, s46, 32256
 buffer_load_dwordx4 v9, s[8:11], s45 offen  lds
 s_waitcnt vmcnt(20) lgkmcnt(0)
 s_add_u32 m0, s49, 32768
 s_add_u32 s45, s46, 36864
 buffer_load_dwordx4 v8, s[8:11], s45 offen  lds
 s_add_u32 m0, s49, 33792
 s_add_u32 s45, s46, 41472
 buffer_load_dwordx4 v9, s[8:11], s45 offen  lds
 s_add_u32 m0, s49, 34816
 s_add_u32 s45, s46, 46080
 buffer_load_dwordx4 v8, s[8:11], s45 offen  lds
 s_add_u32 m0, s49, 35840
 s_add_u32 s45, s46, 50688
 buffer_load_dwordx4 v9, s[8:11], s45 offen  lds
 ds_read_b64_tr_b16 a[0:1], v10 offset:8192
 ds_read_b64_tr_b16 a[2:3], v10 offset:8704
 ds_read_b64_tr_b16 a[4:5], v11 offset:8192
 ds_read_b64_tr_b16 a[6:7], v11 offset:8704
 ds_read_b64_tr_b16 a[8:9], v12 offset:8192
 ds_read_b64_tr_b16 a[10:11], v12 offset:8704
 ds_read_b64_tr_b16 v[16:17], v13 offset:8192
 ds_read_b64_tr_b16 v[18:19], v13 offset:8704
 s_waitcnt vmcnt(20) lgkmcnt(0)
 s_add_u32 m0, s49, 36864
 s_add_u32 s45, s46, 55296
 buffer_load_dwordx4 v8, s[8:11], s45 offen  lds
 s_add_u32 m0, s49, 37888
 s_add_u32 s45, s46, 59904
 buffer_load_dwordx4 v9, s[8:11], s45 offen  lds
 s_add_u32 m0, s49, 38912
 s_add_u32 s45, s46, 64512
 buffer_load_dwordx4 v8, s[8:11], s45 offen  lds
 s_add_u32 m0, s49, 39936
 s_add_u32 s45, s46, 69120
 buffer_load_dwordx4 v9, s[8:11], s45 offen  lds
 ds_write_b128 v5, v[16:19] offset:0
 ds_read_b64_tr_b16 a[12:13], v10 offset:12288
 ds_read_b64_tr_b16 a[14:15], v10 offset:12800
 ds_read_b64_tr_b16 a[16:17], v11 offset:12288
 ds_read_b64_tr_b16 a[18:19], v11 offset:12800
 ds_read_b64_tr_b16 a[20:21], v12 offset:12288
 ds_read_b64_tr_b16 a[22:23], v12 offset:12800
 ds_read_b64_tr_b16 v[20:21], v13 offset:12288
 ds_read_b64_tr_b16 v[22:23], v13 offset:12800
 s_waitcnt vmcnt(20) lgkmcnt(0)
 s_add_u32 s46, s44, 2
 s_and_b32 s46, s46, 7
 s_lshl_b32 s45, s4, 3
 s_add_u32 s46, s46, s45
 s_mul_i32 s46, s46, 147456
 s_add_u32 s46, s46, s47
 s_add_u32 m0, s49, 8192
 s_add_u32 s45, s46, 0
 buffer_load_dwordx4 v8, s[8:11], s45 offen  lds
 s_add_u32 m0, s49, 9216
 s_add_u32 s45, s46, 4608
 buffer_load_dwordx4 v9, s[8:11], s45 offen  lds
 s_add_u32 m0, s49, 10240
 s_add_u32 s45, s46, 9216
 buffer_load_dwordx4 v8, s[8:11], s45 offen  lds
 s_add_u32 m0, s49, 11264
 s_add_u32 s45, s46, 13824
 buffer_load_dwordx4 v9, s[8:11], s45 offen  lds
 ds_write_b128 v5, v[20:23] offset:1024
 ds_read_b64_tr_b16 a[24:25], v10 offset:16384
 ds_read_b64_tr_b16 a[26:27], v10 offset:16896
 ds_read_b64_tr_b16 a[28:29], v11 offset:16384
 ds_read_b64_tr_b16 a[30:31], v11 offset:16896
 ds_read_b64_tr_b16 a[32:33], v12 offset:16384
 ds_read_b64_tr_b16 a[34:35], v12 offset:16896
 ds_read_b64_tr_b16 v[16:17], v13 offset:16384
 ds_read_b64_tr_b16 v[18:19], v13 offset:16896
 s_waitcnt vmcnt(20) lgkmcnt(0)
 s_add_u32 m0, s49, 12288
 s_add_u32 s45, s46, 18432
 buffer_load_dwordx4 v8, s[8:11], s45 offen  lds
 s_add_u32 m0, s49, 13312
 s_add_u32 s45, s46, 23040
 buffer_load_dwordx4 v9, s[8:11], s45 offen  lds
 s_add_u32 m0, s49, 14336
 s_add_u32 s45, s46, 27648
 buffer_load_dwordx4 v8, s[8:11], s45 offen  lds
 s_add_u32 m0, s49, 15360
 s_add_u32 s45, s46, 32256
 buffer_load_dwordx4 v9, s[8:11], s45 offen  lds
 ds_write_b128 v5, v[16:19] offset:2048
 ds_read_b64_tr_b16 a[36:37], v10 offset:20480
 ds_read_b64_tr_b16 a[38:39], v10 offset:20992
 ds_read_b64_tr_b16 a[40:41], v11 offset:20480
 ds_read_b64_tr_b16 a[42:43], v11 offset:20992
 ds_read_b64_tr_b16 a[44:45], v12 offset:20480
 ds_read_b64_tr_b16 a[46:47], v12 offset:20992
 ds_read_b64_tr_b16 v[20:21], v13 offset:20480
 ds_read_b64_tr_b16 v[22:23], v13 offset:20992
 s_waitcnt vmcnt(20) lgkmcnt(0)
 s_add_u32 m0, s49, 16384
 s_add_u32 s45, s46, 36864
 buffer_load_dwordx4 v8, s[8:11], s45 offen  lds
 s_add_u32 m0, s49, 17408
 s_add_u32 s45, s46, 41472
 buffer_load_dwordx4 v9, s[8:11], s45 offen  lds
 s_add_u32 m0, s49, 18432
 s_add_u32 s45, s46, 46080
 buffer_load_dwordx4 v8, s[8:11], s45 offen  lds
 s_add_u32 m0, s49, 19456
 s_add_u32 s45, s46, 50688
 buffer_load_dwordx4 v9, s[8:11], s45 offen  lds
 ds_write_b128 v5, v[20:23] offset:3072
 ds_read_b64_tr_b16 a[48:49], v10 offset:24576
 ds_read_b64_tr_b16 a[50:51], v10 offset:25088
 ds_read_b64_tr_b16 a[52:53], v11 offset:24576
 ds_read_b64_tr_b16 a[54:55], v11 offset:25088
 ds_read_b64_tr_b16 a[56:57], v12 offset:24576
 ds_read_b64_tr_b16 a[58:59], v12 offset:25088
 ds_read_b64_tr_b16 v[16:17], v13 offset:24576
 ds_read_b64_tr_b16 v[18:19], v13 offset:25088
 s_waitcnt vmcnt(20) lgkmcnt(0)
 s_add_u32 m0, s49, 20480
 s_add_u32 s45, s46, 55296
 buffer_load_dwordx4 v8, s[8:11], s45 offen  lds
 s_add_u32 m0, s49, 21504
 s_add_u32 s45, s46, 59904
 buffer_load_dwordx4 v9, s[8:11], s45 offen  lds
 s_add_u32 m0, s49, 22528
 s_add_u32 s45, s46, 64512
 buffer_load_dwordx4 v8, s[8:11], s45 offen  lds
 s_add_u32 m0, s49, 23552
 s_add_u32 s45, s46, 69120
 buffer_load_dwordx4 v9, s[8:11], s45 offen  lds
 ds_write_b128 v5, v[16:19] offset:4096
 ds_read_b64_tr_b16 a[60:61], v10 offset:28672
 ds_read_b64_tr_b16 a[62:63], v10 offset:29184
 ds_read_b64_tr_b16 a[64:65], v11 offset:28672
 ds_read_b64_tr_b16 a[66:67], v11 offset:29184
 ds_read_b64_tr_b16 a[68:69], v12 offset:28672
 ds_read_b64_tr_b16 a[70:71], v12 offset:29184
 ds_read_b64_tr_b16 v[20:21], v13 offset:28672
 ds_read_b64_tr_b16 v[22:23], v13 offset:29184
 s_waitcnt vmcnt(20) lgkmcnt(0)
 s_add_u32 s46, s44, 3
 s_and_b32 s46, s46, 7
 s_lshl_b32 s45, s4, 3
 s_add_u32 s46, s46, s45
 s_mul_i32 s46, s46, 147456
 s_add_u32 s46, s46, s47
 s_add_u32 m0, s49, 24576
 s_add_u32 s45, s46, 0
 buffer_load_dwordx4 v8, s[8:11], s45 offen  lds
 s_add_u32 m0, s49, 25600
 s_add_u32 s45, s46, 4608
 buffer_load_dwordx4 v9, s[8:11], s45 offen  lds
 s_add_u32 m0, s49, 26624
 s_add_u32 s45, s46, 9216
 buffer_load_dwordx4 v8, s[8:11], s45 offen  lds
 s_add_u32 m0, s49, 27648
 s_add_u32 s45, s46, 13824
 buffer_load_dwordx4 v9, s[8:11], s45 offen  lds
 ds_write_b128 v5, v[20:23] offset:5120
 ds_read_b64_tr_b16 a[72:73], v10 offset:32768
 ds_read_b64_tr_b16 a[74:75], v10 offset:33280
 ds_read_b64_tr_b16 a[76:77], v11 offset:32768
 ds_read_b64_tr_b16 a[78:79], v11 offset:33280
 ds_read_b64_tr_b16 a[80:81], v12 offset:32768
 ds_read_b64_tr_b16 a[82:83], v12 offset:33280
 ds_read_b64_tr_b16 v[16:17], v13 offset:32768
 ds_read_b64_tr_b16 v[18:19], v13 offset:33280
 s_waitcnt vmcnt(20) lgkmcnt(0)
 s_add_u32 m0, s49, 28672
 s_add_u32 s45, s46, 18432
 buffer_load_dwordx4 v8, s[8:11], s45 offen  lds
 s_add_u32 m0, s49, 29696
 s_add_u32 s45, s46, 23040
 buffer_load_dwordx4 v9, s[8:11], s45 offen  lds
 s_add_u32 m0, s49, 30720
 s_add_u32 s45, s46, 27648
 buffer_load_dwordx4 v8, s[8:11], s45 offen  lds
 s_add_u32 m0, s49, 31744
 s_add_u32 s45, s46, 32256
 buffer_load_dwordx4 v9, s[8:11], s45 offen  lds
 ds_write_b128 v5, v[16:19] offset:6144
 ds_read_b64_tr_b16 a[84:85], v10 offset:36864
 ds_read_b64_tr_b16 a[86:87], v10 offset:37376
 ds_read_b64_tr_b16 a[88:89], v11 offset:36864
 ds_read_b64_tr_b16 a[90:91], v11 offset:37376
 ds_read_b64_tr_b16 a[92:93], v12 offset:36864
 ds_read_b64_tr_b16 a[94:95], v12 offset:37376
 ds_read_b64_tr_b16 v[20:21], v13 offset:36864
 ds_read_b64_tr_b16 v[22:23], v13 offset:37376
 s_waitcnt vmcnt(20) lgkmcnt(0)
 s_add_u32 m0, s49, 32768
 s_add_u32 s45, s46, 36864
 buffer_load_dwordx4 v8, s[8:11], s45 offen  lds
 s_add_u32 m0, s49, 33792
 s_add_u32 s45, s46, 41472
 buffer_load_dwordx4 v9, s[8:11], s45 offen  lds
 s_add_u32 m0, s49, 34816
 s_add_u32 s45, s46, 46080
 buffer_load_dwordx4 v8, s[8:11], s45 offen  lds
 s_add_u32 m0, s49, 35840
 s_add_u32 s45, s46, 50688
 buffer_load_dwordx4 v9, s[8:11], s45 offen  lds
 ds_write_b128 v5, v[20:23] offset:7168
 ds_read_b64_tr_b16 a[96:97], v10 offset:8192
 ds_read_b64_tr_b16 a[98:99], v10 offset:8704
 ds_read_b64_tr_b16 a[100:101], v11 offset:8192
 ds_read_b64_tr_b16 a[102:103], v11 offset:8704
 ds_read_b64_tr_b16 a[104:105], v12 offset:8192
 ds_read_b64_tr_b16 a[106:107], v12 offset:8704
 ds_read_b64_tr_b16 v[32:33], v13 offset:8192
 ds_read_b64_tr_b16 v[34:35], v13 offset:8704
 s_waitcnt vmcnt(20) lgkmcnt(0)
 s_add_u32 m0, s49, 36864
 s_add_u32 s45, s46, 55296
 buffer_load_dwordx4 v8, s[8:11], s45 offen  lds
 s_add_u32 m0, s49, 37888
 s_add_u32 s45, s46, 59904
 buffer_load_dwordx4 v9, s[8:11], s45 offen  lds
 s_add_u32 m0, s49, 38912
 s_add_u32 s45, s46, 64512
 buffer_load_dwordx4 v8, s[8:11], s45 offen  lds
 s_add_u32 m0, s49, 39936
 s_add_u32 s45, s46, 69120
 buffer_load_dwordx4 v9, s[8:11], s45 offen  lds
 ds_read_b64_tr_b16 a[108:109], v10 offset:12288
 ds_read_b64_tr_b16 a[110:111], v10 offset:12800
 ds_read_b64_tr_b16 a[112:113], v11 offset:12288
 ds_read_b64_tr_b16 a[114:115], v11 offset:12800
 ds_read_b64_tr_b16 a[116:117], v12 offset:12288
 ds_read_b64_tr_b16 a[118:119], v12 offset:12800
 ds_read_b64_tr_b16 v[36:37], v13 offset:12288
 ds_read_b64_tr_b16 v[38:39], v13 offset:12800
 s_waitcnt vmcnt(20) lgkmcnt(0)
 s_add_u32 s46, s44, 4
 s_and_b32 s46, s46, 7
 s_lshl_b32 s45, s4, 3
 s_add_u32 s46, s46, s45
 s_mul_i32 s46, s46, 147456
 s_add_u32 s46, s46, s47
 s_add_u32 m0, s49, 8192
 s_add_u32 s45, s46, 0
 buffer_load_dwordx4 v8, s[8:11], s45 offen  lds
 s_add_u32 m0, s49, 9216
 s_add_u32 s45, s46, 4608
 buffer_load_dwordx4 v9, s[8:11], s45 offen  lds
 s_add_u32 m0, s49, 10240
 s_add_u32 s45, s46, 9216
 buffer_load_dwordx4 v8, s[8:11], s45 offen  lds
 s_add_u32 m0, s49, 11264
 s_add_u32 s45, s46, 13824
 buffer_load_dwordx4 v9, s[8:11], s45 offen  lds
 ds_read_b64_tr_b16 a[120:121], v10 offset:16384
 ds_read_b64_tr_b16 a[122:123], v10 offset:16896
 ds_read_b64_tr_b16 a[124:125], v11 offset:16384
 ds_read_b64_tr_b16 a[126:127], v11 offset:16896
 ds_read_b64_tr_b16 a[128:129], v12 offset:16384
 ds_read_b64_tr_b16 a[130:131], v12 offset:16896
 ds_read_b64_tr_b16 v[40:41], v13 offset:16384
 ds_read_b64_tr_b16 v[42:43], v13 offset:16896
 s_waitcnt vmcnt(20) lgkmcnt(0)
 s_add_u32 m0, s49, 12288
 s_add_u32 s45, s46, 18432
 buffer_load_dwordx4 v8, s[8:11], s45 offen  lds
 s_add_u32 m0, s49, 13312
 s_add_u32 s45, s46, 23040
 buffer_load_dwordx4 v9, s[8:11], s45 offen  lds
 s_add_u32 m0, s49, 14336
 s_add_u32 s45, s46, 27648
 buffer_load_dwordx4 v8, s[8:11], s45 offen  lds
 s_add_u32 m0, s49, 15360
 s_add_u32 s45, s46, 32256
 buffer_load_dwordx4 v9, s[8:11], s45 offen  lds
 ds_read_b64_tr_b16 a[132:133], v10 offset:20480
 ds_read_b64_tr_b16 a[134:135], v10 offset:20992
 ds_read_b64_tr_b16 a[136:137], v11 offset:20480
 ds_read_b64_tr_b16 a[138:139], v11 offset:20992
 ds_read_b64_tr_b16 a[140:141], v12 offset:20480
 ds_read_b64_tr_b16 a[142:143], v12 offset:20992
 ds_read_b64_tr_b16 v[44:45], v13 offset:20480
 ds_read_b64_tr_b16 v[46:47], v13 offset:20992
 s_waitcnt vmcnt(20) lgkmcnt(0)
 s_add_u32 m0, s49, 16384
 s_add_u32 s45, s46, 36864
 buffer_load_dwordx4 v8, s[8:11], s45 offen  lds
 s_add_u32 m0, s49, 17408
 s_add_u32 s45, s46, 41472
 buffer_load_dwordx4 v9, s[8:11], s45 offen  lds
 s_add_u32 m0, s49, 18432
 s_add_u32 s45, s46, 46080
 buffer_load_dwordx4 v8, s[8:11], s45 offen  lds
 s_add_u32 m0, s49, 19456
 s_add_u32 s45, s46, 50688
 buffer_load_dwordx4 v9, s[8:11], s45 offen  lds
 ds_read_b64_tr_b16 a[144:145], v10 offset:24576
 ds_read_b64_tr_b16 a[146:147], v10 offset:25088
 ds_read_b64_tr_b16 a[148:149], v11 offset:24576
 ds_read_b64_tr_b16 a[150:151], v11 offset:25088
 ds_read_b64_tr_b16 a[152:153], v12 offset:24576
 ds_read_b64_tr_b16 a[154:155], v12 offset:25088
 ds_read_b64_tr_b16 v[48:49], v13 offset:24576
 ds_read_b64_tr_b16 v[50:51], v13 offset:25088
 s_waitcnt vmcnt(20) lgkmcnt(0)
 s_add_u32 m0, s49, 20480
 s_add_u32 s45, s46, 55296
 buffer_load_dwordx4 v8, s[8:11], s45 offen  lds
 s_add_u32 m0, s49, 21504
 s_add_u32 s45, s46, 59904
 buffer_load_dwordx4 v9, s[8:11], s45 offen  lds
 s_add_u32 m0, s49, 22528
 s_add_u32 s45, s46, 64512
 buffer_load_dwordx4 v8, s[8:11], s45 offen  lds
 s_add_u32 m0, s49, 23552
 s_add_u32 s45, s46, 69120
 buffer_load_dwordx4 v9, s[8:11], s45 offen  lds
 ds_read_b64_tr_b16 a[156:157], v10 offset:28672
 ds_read_b64_tr_b16 a[158:159], v10 offset:29184
 ds_read_b64_tr_b16 a[160:161], v11 offset:28672
 ds_read_b64_tr_b16 a[162:163], v11 offset:29184
 ds_read_b64_tr_b16 a[164:165], v12 offset:28672
 ds_read_b64_tr_b16 a[166:167], v12 offset:29184
 ds_read_b64_tr_b16 v[52:53], v13 offset:28672
 ds_read_b64_tr_b16 v[54:55], v13 offset:29184
 s_waitcnt vmcnt(20) lgkmcnt(0)
 s_add_u32 s46, s44, 5
 s_and_b32 s46, s46, 7
 s_lshl_b32 s45, s4, 3
 s_add_u32 s46, s46, s45
 s_mul_i32 s46, s46, 147456
 s_add_u32 s46, s46, s47
 s_add_u32 m0, s49, 24576
 s_add_u32 s45, s46, 0
 buffer_load_dwordx4 v8, s[8:11], s45 offen  lds
 s_add_u32 m0, s49, 25600
 s_add_u32 s45, s46, 4608
 buffer_load_dwordx4 v9, s[8:11], s45 offen  lds
 s_add_u32 m0, s49, 26624
 s_add_u32 s45, s46, 9216
 buffer_load_dwordx4 v8, s[8:11], s45 offen  lds
 s_add_u32 m0, s49, 27648
 s_add_u32 s45, s46, 13824
 buffer_load_dwordx4 v9, s[8:11], s45 offen  lds
 ds_read_b64_tr_b16 a[168:169], v10 offset:32768
 ds_read_b64_tr_b16 a[170:171], v10 offset:33280
 ds_read_b64_tr_b16 a[172:173], v11 offset:32768
 ds_read_b64_tr_b16 a[174:175], v11 offset:33280
 ds_read_b64_tr_b16 a[176:177], v12 offset:32768
 ds_read_b64_tr_b16 a[178:179], v12 offset:33280
 ds_read_b64_tr_b16 v[56:57], v13 offset:32768
 ds_read_b64_tr_b16 v[58:59], v13 offset:33280
 s_waitcnt vmcnt(20) lgkmcnt(0)
 s_add_u32 m0, s49, 28672
 s_add_u32 s45, s46, 18432
 buffer_load_dwordx4 v8, s[8:11], s45 offen  lds
 s_add_u32 m0, s49, 29696
 s_add_u32 s45, s46, 23040
 buffer_load_dwordx4 v9, s[8:11], s45 offen  lds
 s_add_u32 m0, s49, 30720
 s_add_u32 s45, s46, 27648
 buffer_load_dwordx4 v8, s[8:11], s45 offen  lds
 s_add_u32 m0, s49, 31744
 s_add_u32 s45, s46, 32256
 buffer_load_dwordx4 v9, s[8:11], s45 offen  lds
 ds_read_b64_tr_b16 a[180:181], v10 offset:36864
 ds_read_b64_tr_b16 a[182:183], v10 offset:37376
 ds_read_b64_tr_b16 a[184:185], v11 offset:36864
 ds_read_b64_tr_b16 a[186:187], v11 offset:37376
 ds_read_b64_tr_b16 a[188:189], v12 offset:36864
 ds_read_b64_tr_b16 a[190:191], v12 offset:37376
 ds_read_b64_tr_b16 v[60:61], v13 offset:36864
 ds_read_b64_tr_b16 v[62:63], v13 offset:37376
 s_waitcnt vmcnt(20) lgkmcnt(0)
 s_add_u32 m0, s49, 32768
 s_add_u32 s45, s46, 36864
 buffer_load_dwordx4 v8, s[8:11], s45 offen  lds
 s_add_u32 m0, s49, 33792
 s_add_u32 s45, s46, 41472
 buffer_load_dwordx4 v9, s[8:11], s45 offen  lds
 s_add_u32 m0, s49, 34816
 s_add_u32 s45, s46, 46080
 buffer_load_dwordx4 v8, s[8:11], s45 offen  lds
 s_add_u32 m0, s49, 35840
 s_add_u32 s45, s46, 50688
 buffer_load_dwordx4 v9, s[8:11], s45 offen  lds
 ds_read_b64_tr_b16 a[192:193], v10 offset:8192
 ds_read_b64_tr_b16 a[194:195], v10 offset:8704
 ds_read_b64_tr_b16 a[196:197], v11 offset:8192
 ds_read_b64_tr_b16 a[198:199], v11 offset:8704
 ds_read_b64_tr_b16 a[200:201], v12 offset:8192
 ds_read_b64_tr_b16 a[202:203], v12 offset:8704
 ds_read_b64_tr_b16 v[64:65], v13 offset:8192
 ds_read_b64_tr_b16 v[66:67], v13 offset:8704
 s_waitcnt vmcnt(20) lgkmcnt(0)
 s_add_u32 m0, s49, 36864
 s_add_u32 s45, s46, 55296
 buffer_load_dwordx4 v8, s[8:11], s45 offen  lds
 s_add_u32 m0, s49, 37888
 s_add_u32 s45, s46, 59904
 buffer_load_dwordx4 v9, s[8:11], s45 offen  lds
 s_add_u32 m0, s49, 38912
 s_add_u32 s45, s46, 64512
 buffer_load_dwordx4 v8, s[8:11], s45 offen  lds
 s_add_u32 m0, s49, 39936
 s_add_u32 s45, s46, 69120
 buffer_load_dwordx4 v9, s[8:11], s45 offen  lds
 ds_read_b64_tr_b16 a[204:205], v10 offset:12288
 ds_read_b64_tr_b16 a[206:207], v10 offset:12800
 ds_read_b64_tr_b16 a[208:209], v11 offset:12288
 ds_read_b64_tr_b16 a[210:211], v11 offset:12800
 ds_read_b64_tr_b16 a[212:213], v12 offset:12288
 ds_read_b64_tr_b16 a[214:215], v12 offset:12800
 ds_read_b64_tr_b16 v[68:69], v13 offset:12288
 ds_read_b64_tr_b16 v[70:71], v13 offset:12800
 s_waitcnt vmcnt(20) lgkmcnt(0)
 s_add_u32 s46, s44, 6
 s_and_b32 s46, s46, 7
 s_lshl_b32 s45, s4, 3
 s_add_u32 s46, s46, s45
 s_mul_i32 s46, s46, 147456
 s_add_u32 s46, s46, s47
 s_add_u32 m0, s49, 8192
 s_add_u32 s45, s46, 0
 buffer_load_dwordx4 v8, s[8:11], s45 offen  lds
 s_add_u32 m0, s49, 9216
 s_add_u32 s45, s46, 4608
 buffer_load_dwordx4 v9, s[8:11], s45 offen  lds
 s_add_u32 m0, s49, 10240
 s_add_u32 s45, s46, 9216
 buffer_load_dwordx4 v8, s[8:11], s45 offen  lds
 s_add_u32 m0, s49, 11264
 s_add_u32 s45, s46, 13824
 buffer_load_dwordx4 v9, s[8:11], s45 offen  lds
 ds_read_b64_tr_b16 a[216:217], v10 offset:16384
 ds_read_b64_tr_b16 a[218:219], v10 offset:16896
 ds_read_b64_tr_b16 a[220:221], v11 offset:16384
 ds_read_b64_tr_b16 a[222:223], v11 offset:16896
 ds_read_b64_tr_b16 a[224:225], v12 offset:16384
 ds_read_b64_tr_b16 a[226:227], v12 offset:16896
 ds_read_b64_tr_b16 v[72:73], v13 offset:16384
 ds_read_b64_tr_b16 v[74:75], v13 offset:16896
 s_waitcnt vmcnt(20) lgkmcnt(0)
 s_add_u32 m0, s49, 12288
 s_add_u32 s45, s46, 18432
 buffer_load_dwordx4 v8, s[8:11], s45 offen  lds
 s_add_u32 m0, s49, 13312
 s_add_u32 s45, s46, 23040
 buffer_load_dwordx4 v9, s[8:11], s45 offen  lds
 s_add_u32 m0, s49, 14336
 s_add_u32 s45, s46, 27648
 buffer_load_dwordx4 v8, s[8:11], s45 offen  lds
 s_add_u32 m0, s49, 15360
 s_add_u32 s45, s46, 32256
 buffer_load_dwordx4 v9, s[8:11], s45 offen  lds
 ds_read_b64_tr_b16 a[228:229], v10 offset:20480
 ds_read_b64_tr_b16 a[230:231], v10 offset:20992
 ds_read_b64_tr_b16 a[232:233], v11 offset:20480
 ds_read_b64_tr_b16 a[234:235], v11 offset:20992
 ds_read_b64_tr_b16 a[236:237], v12 offset:20480
 ds_read_b64_tr_b16 a[238:239], v12 offset:20992
 ds_read_b64_tr_b16 v[76:77], v13 offset:20480
 ds_read_b64_tr_b16 v[78:79], v13 offset:20992
 s_waitcnt vmcnt(20) lgkmcnt(0)
 s_add_u32 m0, s49, 16384
 s_add_u32 s45, s46, 36864
 buffer_load_dwordx4 v8, s[8:11], s45 offen  lds
 s_add_u32 m0, s49, 17408
 s_add_u32 s45, s46, 41472
 buffer_load_dwordx4 v9, s[8:11], s45 offen  lds
 s_add_u32 m0, s49, 18432
 s_add_u32 s45, s46, 46080
 buffer_load_dwordx4 v8, s[8:11], s45 offen  lds
 s_add_u32 m0, s49, 19456
 s_add_u32 s45, s46, 50688
 buffer_load_dwordx4 v9, s[8:11], s45 offen  lds
 ds_read_b64_tr_b16 a[240:241], v10 offset:24576
 ds_read_b64_tr_b16 a[242:243], v10 offset:25088
 ds_read_b64_tr_b16 a[244:245], v11 offset:24576
 ds_read_b64_tr_b16 a[246:247], v11 offset:25088
 ds_read_b64_tr_b16 a[248:249], v12 offset:24576
 ds_read_b64_tr_b16 a[250:251], v12 offset:25088
 ds_read_b64_tr_b16 v[80:81], v13 offset:24576
 ds_read_b64_tr_b16 v[82:83], v13 offset:25088
 s_waitcnt vmcnt(20) lgkmcnt(0)
 s_add_u32 m0, s49, 20480
 s_add_u32 s45, s46, 55296
 buffer_load_dwordx4 v8, s[8:11], s45 offen  lds
 s_add_u32 m0, s49, 21504
 s_add_u32 s45, s46, 59904
 buffer_load_dwordx4 v9, s[8:11], s45 offen  lds
 s_add_u32 m0, s49, 22528
 s_add_u32 s45, s46, 64512
 buffer_load_dwordx4 v8, s[8:11], s45 offen  lds
 s_add_u32 m0, s49, 23552
 s_add_u32 s45, s46, 69120
 buffer_load_dwordx4 v9, s[8:11], s45 offen  lds
 ds_read_b64_tr_b16 a[252:253], v10 offset:28672
 ds_read_b64_tr_b16 a[254:255], v10 offset:29184
 ds_read_b64_tr_b16 v[128:129], v11 offset:28672
 ds_read_b64_tr_b16 v[130:131], v11 offset:29184
 ds_read_b64_tr_b16 v[132:133], v12 offset:28672
 ds_read_b64_tr_b16 v[134:135], v12 offset:29184
 ds_read_b64_tr_b16 v[84:85], v13 offset:28672
 ds_read_b64_tr_b16 v[86:87], v13 offset:29184
 s_waitcnt vmcnt(20) lgkmcnt(0)
 s_add_u32 s46, s44, 7
 s_and_b32 s46, s46, 7
 s_lshl_b32 s45, s4, 3
 s_add_u32 s46, s46, s45
 s_mul_i32 s46, s46, 147456
 s_add_u32 s46, s46, s47
 s_add_u32 m0, s49, 24576
 s_add_u32 s45, s46, 0
 buffer_load_dwordx4 v8, s[8:11], s45 offen  lds
 s_add_u32 m0, s49, 25600
 s_add_u32 s45, s46, 4608
 buffer_load_dwordx4 v9, s[8:11], s45 offen  lds
 s_add_u32 m0, s49, 26624
 s_add_u32 s45, s46, 9216
 buffer_load_dwordx4 v8, s[8:11], s45 offen  lds
 s_add_u32 m0, s49, 27648
 s_add_u32 s45, s46, 13824
 buffer_load_dwordx4 v9, s[8:11], s45 offen  lds
 ds_read_b64_tr_b16 v[136:137], v10 offset:32768
 ds_read_b64_tr_b16 v[138:139], v10 offset:33280
 ds_read_b64_tr_b16 v[140:141], v11 offset:32768
 ds_read_b64_tr_b16 v[142:143], v11 offset:33280
 ds_read_b64_tr_b16 v[144:145], v12 offset:32768
 ds_read_b64_tr_b16 v[146:147], v12 offset:33280
 ds_read_b64_tr_b16 v[88:89], v13 offset:32768
 ds_read_b64_tr_b16 v[90:91], v13 offset:33280
 s_waitcnt vmcnt(20) lgkmcnt(0)
 s_add_u32 m0, s49, 28672
 s_add_u32 s45, s46, 18432
 buffer_load_dwordx4 v8, s[8:11], s45 offen  lds
 s_add_u32 m0, s49, 29696
 s_add_u32 s45, s46, 23040
 buffer_load_dwordx4 v9, s[8:11], s45 offen  lds
 s_add_u32 m0, s49, 30720
 s_add_u32 s45, s46, 27648
 buffer_load_dwordx4 v8, s[8:11], s45 offen  lds
 s_add_u32 m0, s49, 31744
 s_add_u32 s45, s46, 32256
 buffer_load_dwordx4 v9, s[8:11], s45 offen  lds
 ds_read_b64_tr_b16 v[148:149], v10 offset:36864
 ds_read_b64_tr_b16 v[150:151], v10 offset:37376
 ds_read_b64_tr_b16 v[152:153], v11 offset:36864
 ds_read_b64_tr_b16 v[154:155], v11 offset:37376
 ds_read_b64_tr_b16 v[156:157], v12 offset:36864
 ds_read_b64_tr_b16 v[158:159], v12 offset:37376
 ds_read_b64_tr_b16 v[92:93], v13 offset:36864
 ds_read_b64_tr_b16 v[94:95], v13 offset:37376
 s_waitcnt vmcnt(20) lgkmcnt(0)
 s_add_u32 m0, s49, 32768
 s_add_u32 s45, s46, 36864
 buffer_load_dwordx4 v8, s[8:11], s45 offen  lds
 s_add_u32 m0, s49, 33792
 s_add_u32 s45, s46, 41472
 buffer_load_dwordx4 v9, s[8:11], s45 offen  lds
 s_add_u32 m0, s49, 34816
 s_add_u32 s45, s46, 46080
 buffer_load_dwordx4 v8, s[8:11], s45 offen  lds
 s_add_u32 m0, s49, 35840
 s_add_u32 s45, s46, 50688
 buffer_load_dwordx4 v9, s[8:11], s45 offen  lds
 ds_read_b64_tr_b16 v[160:161], v10 offset:8192
 ds_read_b64_tr_b16 v[162:163], v10 offset:8704
 ds_read_b64_tr_b16 v[164:165], v11 offset:8192
 ds_read_b64_tr_b16 v[166:167], v11 offset:8704
 ds_read_b64_tr_b16 v[168:169], v12 offset:8192
 ds_read_b64_tr_b16 v[170:171], v12 offset:8704
 ds_read_b64_tr_b16 v[96:97], v13 offset:8192
 ds_read_b64_tr_b16 v[98:99], v13 offset:8704
 s_waitcnt vmcnt(20) lgkmcnt(0)
 s_add_u32 m0, s49, 36864
 s_add_u32 s45, s46, 55296
 buffer_load_dwordx4 v8, s[8:11], s45 offen  lds
 s_add_u32 m0, s49, 37888
 s_add_u32 s45, s46, 59904
 buffer_load_dwordx4 v9, s[8:11], s45 offen  lds
 s_add_u32 m0, s49, 38912
 s_add_u32 s45, s46, 64512
 buffer_load_dwordx4 v8, s[8:11], s45 offen  lds
 s_add_u32 m0, s49, 39936
 s_add_u32 s45, s46, 69120
 buffer_load_dwordx4 v9, s[8:11], s45 offen  lds
 ds_read_b64_tr_b16 v[172:173], v10 offset:12288
 ds_read_b64_tr_b16 v[174:175], v10 offset:12800
 ds_read_b64_tr_b16 v[176:177], v11 offset:12288
 ds_read_b64_tr_b16 v[178:179], v11 offset:12800
 ds_read_b64_tr_b16 v[180:181], v12 offset:12288
 ds_read_b64_tr_b16 v[182:183], v12 offset:12800
 ds_read_b64_tr_b16 v[100:101], v13 offset:12288
 ds_read_b64_tr_b16 v[102:103], v13 offset:12800
 s_waitcnt vmcnt(20) lgkmcnt(0)
 ds_read_b64_tr_b16 v[184:185], v10 offset:16384
 ds_read_b64_tr_b16 v[186:187], v10 offset:16896
 ds_read_b64_tr_b16 v[188:189], v11 offset:16384
 ds_read_b64_tr_b16 v[190:191], v11 offset:16896
 ds_read_b64_tr_b16 v[192:193], v12 offset:16384
 ds_read_b64_tr_b16 v[194:195], v12 offset:16896
 ds_read_b64_tr_b16 v[104:105], v13 offset:16384
 ds_read_b64_tr_b16 v[106:107], v13 offset:16896
 s_waitcnt vmcnt(16) lgkmcnt(0)
 ds_read_b64_tr_b16 v[196:197], v10 offset:20480
 ds_read_b64_tr_b16 v[198:199], v10 offset:20992
 ds_read_b64_tr_b16 v[200:201], v11 offset:20480
 ds_read_b64_tr_b16 v[202:203], v11 offset:20992
 ds_read_b64_tr_b16 v[204:205], v12 offset:20480
 ds_read_b64_tr_b16 v[206:207], v12 offset:20992
 ds_read_b64_tr_b16 v[108:109], v13 offset:20480
 ds_read_b64_tr_b16 v[110:111], v13 offset:20992
 s_waitcnt vmcnt(12) lgkmcnt(0)
 ds_read_b64_tr_b16 v[208:209], v10 offset:24576
 ds_read_b64_tr_b16 v[210:211], v10 offset:25088
 ds_read_b64_tr_b16 v[212:213], v11 offset:24576
 ds_read_b64_tr_b16 v[214:215], v11 offset:25088
 ds_read_b64_tr_b16 v[216:217], v12 offset:24576
 ds_read_b64_tr_b16 v[218:219], v12 offset:25088
 ds_read_b64_tr_b16 v[112:113], v13 offset:24576
 ds_read_b64_tr_b16 v[114:115], v13 offset:25088
 s_waitcnt vmcnt(8) lgkmcnt(0)
 ds_read_b64_tr_b16 v[220:221], v10 offset:28672
 ds_read_b64_tr_b16 v[222:223], v10 offset:29184
 ds_read_b64_tr_b16 v[224:225], v11 offset:28672
 ds_read_b64_tr_b16 v[226:227], v11 offset:29184
 ds_read_b64_tr_b16 v[228:229], v12 offset:28672
 ds_read_b64_tr_b16 v[230:231], v12 offset:29184
 ds_read_b64_tr_b16 v[116:117], v13 offset:28672
 ds_read_b64_tr_b16 v[118:119], v13 offset:29184
 s_waitcnt vmcnt(4) lgkmcnt(0)
 ds_read_b64_tr_b16 v[232:233], v10 offset:32768
 ds_read_b64_tr_b16 v[234:235], v10 offset:33280
 ds_read_b64_tr_b16 v[236:237], v11 offset:32768
 ds_read_b64_tr_b16 v[238:239], v11 offset:33280
 ds_read_b64_tr_b16 v[240:241], v12 offset:32768
 ds_read_b64_tr_b16 v[242:243], v12 offset:33280
 ds_read_b64_tr_b16 v[120:121], v13 offset:32768
 ds_read_b64_tr_b16 v[122:123], v13 offset:33280
 s_waitcnt vmcnt(0) lgkmcnt(0)
 ds_read_b64_tr_b16 v[244:245], v10 offset:36864
 ds_read_b64_tr_b16 v[246:247], v10 offset:37376
 ds_read_b64_tr_b16 v[248:249], v11 offset:36864
 ds_read_b64_tr_b16 v[250:251], v11 offset:37376
 ds_read_b64_tr_b16 v[252:253], v12 offset:36864
 ds_read_b64_tr_b16 v[254:255], v12 offset:37376
 ds_read_b64_tr_b16 v[124:125], v13 offset:36864
 ds_read_b64_tr_b16 v[126:127], v13 offset:37376
 s_waitcnt lgkmcnt(0)
 ds_write_b128 v5, v[32:35] offset:8192
 ds_write_b128 v5, v[36:39] offset:9216
 ds_write_b128 v5, v[40:43] offset:10240
 ds_write_b128 v5, v[44:47] offset:11264
 ds_write_b128 v5, v[48:51] offset:12288
 ds_write_b128 v5, v[52:55] offset:13312
 ds_write_b128 v5, v[56:59] offset:14336
 ds_write_b128 v5, v[60:63] offset:15360
 ds_write_b128 v5, v[64:67] offset:16384
 ds_write_b128 v5, v[68:71] offset:17408
 ds_write_b128 v5, v[72:75] offset:18432
 ds_write_b128 v5, v[76:79] offset:19456
 ds_write_b128 v5, v[80:83] offset:20480
 ds_write_b128 v5, v[84:87] offset:21504
 ds_write_b128 v5, v[88:91] offset:22528
 ds_write_b128 v5, v[92:95] offset:23552
 ds_write_b128 v5, v[96:99] offset:24576
 ds_write_b128 v5, v[100:103] offset:25600
 ds_write_b128 v5, v[104:107] offset:26624
 ds_write_b128 v5, v[108:111] offset:27648
 ds_write_b128 v5, v[112:115] offset:28672
 ds_write_b128 v5, v[116:119] offset:29696
 ds_write_b128 v5, v[120:123] offset:30720
 ds_write_b128 v5, v[124:127] offset:31744
 s_waitcnt lgkmcnt(0)
 v_lshrrev_b32 v13, 2, v15
 v_and_b32 v14, 3, v15
 s_lshr_b32 s45, s4, 1
 s_mul_i32 s45, s45, 36864
 s_and_b32 s46, s4, 1
 s_lshl_b32 s46, s46, 6
 s_add_u32 s45, s45, s46
 s_add_u32 s37, s37, s45
 v_mul_u32_u24 v6, 2304, v13
 v_lshl_add_u32 v6, v14, 4, v6
 v_lshl_add_u32 v13, v14, 2, v13
 v_and_b32 v13, 15, v13
 v_lshlrev_b32 v13, 4, v13
 s_lshl_b32 s45, s4, 11
 v_lshl_add_u32 v12, v14, 9, v13
 v_add_u32 v12, s45, v12
 v_lshrrev_b32 v13, 5, v15
 v_lshl_add_u32 v13, v13, 2, v15
 v_and_b32 v13, 15, v13
 v_and_or_b32 v13, v15, 48, v13
 v_lshlrev_b32 v13, 4, v13
 v_xor_b32 v14, 0x80, v13
 v_add_u32 v15, s49, v14
 v_add_u32 v14, s49, v13
 v_add_u32 v4, 32768, v12
 v_add_u32 v7, 114688, v12
 s_lshl_b32 s45, s32, 7
 s_add_u32 s37, s37, s45
 s_lshl_b32 s45, s4, 16
 s_add_u32 s36, s36, s45
 s_mov_b32 s42, s33
 s_mov_b32 s43, 0
 s_and_b32 s53, s42, s93
 s_lshl_b32 s53, s53, s91
 s_add_u32 s53, s53, s38
 s_lshr_b32 s51, s42, s90
 s_add_u32 s51, s51, 1
 ds_read_b128 v[16:19], v5 offset:0
 ds_read_b128 v[20:23], v5 offset:1024
Los0_33:
 buffer_load_dword v2, v3, s[20:23], s53 offen sc1
 s_waitcnt vmcnt(0)
 v_cmp_gt_u32 vcc, s51, v2
 s_and_b32 s52, vcc_lo, 0xffff
 s_cbranch_scc0 Los0k_34
 s_sleep 4
 s_sub_u32 s50, s50, 1
 s_cbranch_scc0 Los0_33
 s_endpgm
Los0k_34:
 s_lshl_b32 s48, s42, 18
 s_add_u32 s48, s48, s36
 s_add_u32 s52, s44, 0
 s_and_b32 s52, s52, 7
 s_lshl_b32 s52, s52, 13
 s_add_u32 s46, s48, s52
 s_add_u32 s47, s46, 4096
 buffer_load_dwordx4 v[32:35], v1, s[20:23], s46 offen offset:0 sc1
 buffer_load_dwordx4 v[36:39], v1, s[20:23], s46 offen offset:1024 sc1
 buffer_load_dwordx4 v[40:43], v1, s[20:23], s46 offen offset:2048 sc1
 buffer_load_dwordx4 v[44:47], v1, s[20:23], s46 offen offset:3072 sc1
 buffer_load_dwordx4 v[48:51], v1, s[20:23], s47 offen offset:0 sc1
 buffer_load_dwordx4 v[52:55], v1, s[20:23], s47 offen offset:1024 sc1
 buffer_load_dwordx4 v[56:59], v1, s[20:23], s47 offen offset:2048 sc1
 buffer_load_dwordx4 v[60:63], v1, s[20:23], s47 offen offset:3072 sc1
 s_add_u32 s52, s44, 1
 s_and_b32 s52, s52, 7
 s_lshl_b32 s52, s52, 13
 s_add_u32 s46, s48, s52
 s_add_u32 s47, s46, 4096
 buffer_load_dwordx4 v[64:67], v1, s[20:23], s46 offen offset:0 sc1
 buffer_load_dwordx4 v[68:71], v1, s[20:23], s46 offen offset:1024 sc1
 buffer_load_dwordx4 v[72:75], v1, s[20:23], s46 offen offset:2048 sc1
 buffer_load_dwordx4 v[76:79], v1, s[20:23], s46 offen offset:3072 sc1
 buffer_load_dwordx4 v[80:83], v1, s[20:23], s47 offen offset:0 sc1
 buffer_load_dwordx4 v[84:87], v1, s[20:23], s47 offen offset:1024 sc1
 buffer_load_dwordx4 v[88:91], v1, s[20:23], s47 offen offset:2048 sc1
 buffer_load_dwordx4 v[92:95], v1, s[20:23], s47 offen offset:3072 sc1
 .p2align 3
Losl_35:
 s_waitcnt vmcnt(14) lgkmcnt(1)
 v_mfma_f32_16x16x32_bf16 v[96:99], a[0:3], v[32:35], 0
 s_add_u32 s52, s44, 2
 s_and_b32 s52, s52, 7
 v_mfma_f32_16x16x32_bf16 v[100:103], a[4:7], v[32:35], 0
 s_lshl_b32 s52, s52, 13
 s_add_u32 s46, s48, s52
 v_mfma_f32_16x16x32_bf16 v[104:107], a[8:11], v[32:35], 0
 s_add_u32 s47, s46, 4096
 v_mfma_f32_16x16x32_bf16 v[108:111], v[16:19], v[32:35], 0
 buffer_load_dwordx4 v[32:35], v1, s[20:23], s46 offen offset:0 sc1
 v_mfma_f32_16x16x32_bf16 v[112:115], a[0:3], v[36:39], 0
 ds_read_b128 v[24:27], v5 offset:2048
 v_mfma_f32_16x16x32_bf16 v[116:119], a[4:7], v[36:39], 0
 v_mfma_f32_16x16x32_bf16 v[120:123], a[8:11], v[36:39], 0
 v_mfma_f32_16x16x32_bf16 v[124:127], v[16:19], v[36:39], 0
 buffer_load_dwordx4 v[36:39], v1, s[20:23], s46 offen offset:1024 sc1
 s_waitcnt vmcnt(14) lgkmcnt(1)
 v_mfma_f32_16x16x32_bf16 v[96:99], a[12:15], v[40:43], v[96:99]
 s_mov_b32 s41, s42
 s_add_u32 s43, s43, 1
 v_mfma_f32_16x16x32_bf16 v[100:103], a[16:19], v[40:43], v[100:103]
 s_cmp_lt_u32 s43, s35
 s_cselect_b32 s45, s34, 0
 v_mfma_f32_16x16x32_bf16 v[104:107], a[20:23], v[40:43], v[104:107]
 s_xor_b32 s34, s34, s39
 s_add_u32 s42, s42, s45
 v_mfma_f32_16x16x32_bf16 v[108:111], v[20:23], v[40:43], v[108:111]
 buffer_load_dwordx4 v[40:43], v1, s[20:23], s46 offen offset:2048 sc1
 v_mfma_f32_16x16x32_bf16 v[112:115], a[12:15], v[44:47], v[112:115]
 ds_read_b128 v[28:31], v5 offset:3072
 v_mfma_f32_16x16x32_bf16 v[116:119], a[16:19], v[44:47], v[116:119]
 v_mfma_f32_16x16x32_bf16 v[120:123], a[20:23], v[44:47], v[120:123]
 v_mfma_f32_16x16x32_bf16 v[124:127], v[20:23], v[44:47], v[124:127]
 buffer_load_dwordx4 v[44:47], v1, s[20:23], s46 offen offset:3072 sc1
 s_waitcnt vmcnt(14) lgkmcnt(1)
 v_mfma_f32_16x16x32_bf16 v[96:99], a[24:27], v[48:51], v[96:99]
 s_and_b32 s53, s42, s93
 s_lshl_b32 s53, s53, s91
 v_mfma_f32_16x16x32_bf16 v[100:103], a[28:31], v[48:51], v[100:103]
 s_add_u32 s53, s53, s38
 s_lshr_b32 s51, s42, s90
 v_mfma_f32_16x16x32_bf16 v[104:107], a[32:35], v[48:51], v[104:107]
 s_add_u32 s51, s51, 1
 v_mfma_f32_16x16x32_bf16 v[108:111], v[24:27], v[48:51], v[108:111]
 buffer_load_dwordx4 v[48:51], v1, s[20:23], s47 offen offset:0 sc1
 v_mfma_f32_16x16x32_bf16 v[112:115], a[24:27], v[52:55], v[112:115]
 ds_read_b128 v[16:19], v5 offset:4096
 v_mfma_f32_16x16x32_bf16 v[116:119], a[28:31], v[52:55], v[116:119]
 v_mfma_f32_16x16x32_bf16 v[120:123], a[32:35], v[52:55], v[120:123]
 v_mfma_f32_16x16x32_bf16 v[124:127], v[24:27], v[52:55], v[124:127]
 buffer_load_dwordx4 v[52:55], v1, s[20:23], s47 offen offset:1024 sc1
 s_waitcnt vmcnt(14) lgkmcnt(1)
 v_mfma_f32_16x16x32_bf16 v[96:99], a[36:39], v[56:59], v[96:99]
 s_mul_i32 s54, s41, 73728
 s_add_u32 s54, s54, s37
 v_mfma_f32_16x16x32_bf16 v[100:103], a[40:43], v[56:59], v[100:103]
 v_mfma_f32_16x16x32_bf16 v[104:107], a[44:47], v[56:59], v[104:107]
 v_mfma_f32_16x16x32_bf16 v[108:111], v[28:31], v[56:59], v[108:111]
 buffer_load_dwordx4 v[56:59], v1, s[20:23], s47 offen offset:2048 sc1
 v_mfma_f32_16x16x32_bf16 v[112:115], a[36:39], v[60:63], v[112:115]
 ds_read_b128 v[20:23], v5 offset:5120
 v_mfma_f32_16x16x32_bf16 v[116:119], a[40:43], v[60:63], v[116:119]
 v_mfma_f32_16x16x32_bf16 v[120:123], a[44:47], v[60:63], v[120:123]
 v_mfma_f32_16x16x32_bf16 v[124:127], v[28:31], v[60:63], v[124:127]
 buffer_load_dwordx4 v[60:63], v1, s[20:23], s47 offen offset:3072 sc1
 s_waitcnt vmcnt(14) lgkmcnt(1)
 v_mfma_f32_16x16x32_bf16 v[96:99], a[48:51], v[64:67], v[96:99]
 s_add_u32 s52, s44, 3
 s_and_b32 s52, s52, 7
 v_mfma_f32_16x16x32_bf16 v[100:103], a[52:55], v[64:67], v[100:103]
 s_lshl_b32 s52, s52, 13
 s_add_u32 s46, s48, s52
 v_mfma_f32_16x16x32_bf16 v[104:107], a[56:59], v[64:67], v[104:107]
 s_add_u32 s47, s46, 4096
 v_mfma_f32_16x16x32_bf16 v[108:111], v[16:19], v[64:67], v[108:111]
 buffer_load_dwordx4 v[64:67], v1, s[20:23], s46 offen offset:0 sc1
 v_mfma_f32_16x16x32_bf16 v[112:115], a[48:51], v[68:71], v[112:115]
 ds_read_b128 v[24:27], v5 offset:6144
 v_mfma_f32_16x16x32_bf16 v[116:119], a[52:55], v[68:71], v[116:119]
 v_mfma_f32_16x16x32_bf16 v[120:123], a[56:59], v[68:71], v[120:123]
 v_mfma_f32_16x16x32_bf16 v[124:127], v[16:19], v[68:71], v[124:127]
 buffer_load_dwordx4 v[68:71], v1, s[20:23], s46 offen offset:1024 sc1
 s_waitcnt vmcnt(14) lgkmcnt(1)
 v_mfma_f32_16x16x32_bf16 v[96:99], a[60:63], v[72:75], v[96:99]
 v_mfma_f32_16x16x32_bf16 v[100:103], a[64:67], v[72:75], v[100:103]
 v_mfma_f32_16x16x32_bf16 v[104:107], a[68:71], v[72:75], v[104:107]
 v_mfma_f32_16x16x32_bf16 v[108:111], v[20:23], v[72:75], v[108:111]
 buffer_load_dwordx4 v[72:75], v1, s[20:23], s46 offen offset:2048 sc1
 v_mfma_f32_16x16x32_bf16 v[112:115], a[60:63], v[76:79], v[112:115]
 ds_read_b128 v[28:31], v5 offset:7168
 v_mfma_f32_16x16x32_bf16 v[116:119], a[64:67], v[76:79], v[116:119]
 v_mfma_f32_16x16x32_bf16 v[120:123], a[68:71], v[76:79], v[120:123]
 v_mfma_f32_16x16x32_bf16 v[124:127], v[20:23], v[76:79], v[124:127]
 buffer_load_dwordx4 v[76:79], v1, s[20:23], s46 offen offset:3072 sc1
 s_waitcnt vmcnt(14) lgkmcnt(1)
 v_mfma_f32_16x16x32_bf16 v[96:99], a[72:75], v[80:83], v[96:99]
 v_mfma_f32_16x16x32_bf16 v[100:103], a[76:79], v[80:83], v[100:103]
 v_mfma_f32_16x16x32_bf16 v[104:107], a[80:83], v[80:83], v[104:107]
 v_mfma_f32_16x16x32_bf16 v[108:111], v[24:27], v[80:83], v[108:111]
 buffer_load_dwordx4 v[80:83], v1, s[20:23], s47 offen offset:0 sc1
 v_mfma_f32_16x16x32_bf16 v[112:115], a[72:75], v[84:87], v[112:115]
 ds_read_b128 v[16:19], v5 offset:8192
 v_mfma_f32_16x16x32_bf16 v[116:119], a[76:79], v[84:87], v[116:119]
 v_mfma_f32_16x16x32_bf16 v[120:123], a[80:83], v[84:87], v[120:123]
 v_mfma_f32_16x16x32_bf16 v[124:127], v[24:27], v[84:87], v[124:127]
 buffer_load_dwordx4 v[84:87], v1, s[20:23], s47 offen offset:1024 sc1
 s_waitcnt vmcnt(14) lgkmcnt(1)
 v_mfma_f32_16x16x32_bf16 v[96:99], a[84:87], v[88:91], v[96:99]
 v_mfma_f32_16x16x32_bf16 v[100:103], a[88:91], v[88:91], v[100:103]
 v_mfma_f32_16x16x32_bf16 v[104:107], a[92:95], v[88:91], v[104:107]
 v_mfma_f32_16x16x32_bf16 v[108:111], v[28:31], v[88:91], v[108:111]
 buffer_load_dwordx4 v[88:91], v1, s[20:23], s47 offen offset:2048 sc1
 v_mfma_f32_16x16x32_bf16 v[112:115], a[84:87], v[92:95], v[112:115]
 ds_read_b128 v[20:23], v5 offset:9216
 v_mfma_f32_16x16x32_bf16 v[116:119], a[88:91], v[92:95], v[116:119]
 v_mfma_f32_16x16x32_bf16 v[120:123], a[92:95], v[92:95], v[120:123]
 v_mfma_f32_16x16x32_bf16 v[124:127], v[28:31], v[92:95], v[124:127]
 buffer_load_dwordx4 v[92:95], v1, s[20:23], s47 offen offset:3072 sc1
 s_waitcnt vmcnt(14) lgkmcnt(1)
 v_mfma_f32_16x16x32_bf16 v[96:99], a[96:99], v[32:35], v[96:99]
 s_add_u32 s52, s44, 4
 s_and_b32 s52, s52, 7
 v_mfma_f32_16x16x32_bf16 v[100:103], a[100:103], v[32:35], v[100:103]
 s_lshl_b32 s52, s52, 13
 s_add_u32 s46, s48, s52
 v_mfma_f32_16x16x32_bf16 v[104:107], a[104:107], v[32:35], v[104:107]
 s_add_u32 s47, s46, 4096
 v_mfma_f32_16x16x32_bf16 v[108:111], v[16:19], v[32:35], v[108:111]
 buffer_load_dwordx4 v[32:35], v1, s[20:23], s46 offen offset:0 sc1
 v_mfma_f32_16x16x32_bf16 v[112:115], a[96:99], v[36:39], v[112:115]
 ds_read_b128 v[24:27], v5 offset:10240
 v_mfma_f32_16x16x32_bf16 v[116:119], a[100:103], v[36:39], v[116:119]
 v_mfma_f32_16x16x32_bf16 v[120:123], a[104:107], v[36:39], v[120:123]
 v_mfma_f32_16x16x32_bf16 v[124:127], v[16:19], v[36:39], v[124:127]
 buffer_load_dwordx4 v[36:39], v1, s[20:23], s46 offen offset:1024 sc1
 s_waitcnt vmcnt(14) lgkmcnt(1)
 v_mfma_f32_16x16x32_bf16 v[96:99], a[108:111], v[40:43], v[96:99]
 v_mfma_f32_16x16x32_bf16 v[100:103], a[112:115], v[40:43], v[100:103]
 v_mfma_f32_16x16x32_bf16 v[104:107], a[116:119], v[40:43], v[104:107]
 v_mfma_f32_16x16x32_bf16 v[108:111], v[20:23], v[40:43], v[108:111]
 buffer_load_dwordx4 v[40:43], v1, s[20:23], s46 offen offset:2048 sc1
 v_mfma_f32_16x16x32_bf16 v[112:115], a[108:111], v[44:47], v[112:115]
 ds_read_b128 v[28:31], v5 offset:11264
 v_mfma_f32_16x16x32_bf16 v[116:119], a[112:115], v[44:47], v[116:119]
 v_mfma_f32_16x16x32_bf16 v[120:123], a[116:119], v[44:47], v[120:123]
 v_mfma_f32_16x16x32_bf16 v[124:127], v[20:23], v[44:47], v[124:127]
 buffer_load_dwordx4 v[44:47], v1, s[20:23], s46 offen offset:3072 sc1
 s_waitcnt vmcnt(14) lgkmcnt(1)
 v_mfma_f32_16x16x32_bf16 v[96:99], a[120:123], v[48:51], v[96:99]
 s_barrier
 v_mfma_f32_16x16x32_bf16 v[100:103], a[124:127], v[48:51], v[100:103]
 v_mfma_f32_16x16x32_bf16 v[104:107], a[128:131], v[48:51], v[104:107]
 v_mfma_f32_16x16x32_bf16 v[108:111], v[24:27], v[48:51], v[108:111]
 buffer_load_dwordx4 v[48:51], v1, s[20:23], s47 offen offset:0 sc1
 v_mfma_f32_16x16x32_bf16 v[112:115], a[120:123], v[52:55], v[112:115]
 ds_read_b128 v[16:19], v5 offset:12288
 v_mfma_f32_16x16x32_bf16 v[116:119], a[124:127], v[52:55], v[116:119]
 v_mfma_f32_16x16x32_bf16 v[120:123], a[128:131], v[52:55], v[120:123]
 v_mfma_f32_16x16x32_bf16 v[124:127], v[24:27], v[52:55], v[124:127]
 buffer_load_dwordx4 v[52:55], v1, s[20:23], s47 offen offset:1024 sc1
 s_waitcnt vmcnt(14) lgkmcnt(1)
 v_mfma_f32_16x16x32_bf16 v[96:99], a[132:135], v[56:59], v[96:99]
 v_mfma_f32_16x16x32_bf16 v[100:103], a[136:139], v[56:59], v[100:103]
 v_mfma_f32_16x16x32_bf16 v[104:107], a[140:143], v[56:59], v[104:107]
 v_mfma_f32_16x16x32_bf16 v[108:111], v[28:31], v[56:59], v[108:111]
 buffer_load_dwordx4 v[56:59], v1, s[20:23], s47 offen offset:2048 sc1
 v_mfma_f32_16x16x32_bf16 v[112:115], a[132:135], v[60:63], v[112:115]
 ds_read_b128 v[20:23], v5 offset:13312
 v_mfma_f32_16x16x32_bf16 v[116:119], a[136:139], v[60:63], v[116:119]
 v_mfma_f32_16x16x32_bf16 v[120:123], a[140:143], v[60:63], v[120:123]
 v_mfma_f32_16x16x32_bf16 v[124:127], v[28:31], v[60:63], v[124:127]
 buffer_load_dwordx4 v[60:63], v1, s[20:23], s47 offen offset:3072 sc1
 s_waitcnt vmcnt(14) lgkmcnt(1)
 v_mfma_f32_16x16x32_bf16 v[96:99], a[144:147], v[64:67], v[96:99]
 s_add_u32 s52, s44, 5
 s_and_b32 s52, s52, 7
 v_mfma_f32_16x16x32_bf16 v[100:103], a[148:151], v[64:67], v[100:103]
 s_lshl_b32 s52, s52, 13
 s_add_u32 s46, s48, s52
 v_mfma_f32_16x16x32_bf16 v[104:107], a[152:155], v[64:67], v[104:107]
 s_add_u32 s47, s46, 4096
 v_mfma_f32_16x16x32_bf16 v[108:111], v[16:19], v[64:67], v[108:111]
 buffer_load_dwordx4 v[64:67], v1, s[20:23], s46 offen offset:0 sc1
 v_mfma_f32_16x16x32_bf16 v[112:115], a[144:147], v[68:71], v[112:115]
 ds_read_b128 v[24:27], v5 offset:14336
 v_mfma_f32_16x16x32_bf16 v[116:119], a[148:151], v[68:71], v[116:119]
 v_mfma_f32_16x16x32_bf16 v[120:123], a[152:155], v[68:71], v[120:123]
 v_mfma_f32_16x16x32_bf16 v[124:127], v[16:19], v[68:71], v[124:127]
 buffer_load_dwordx4 v[68:71], v1, s[20:23], s46 offen offset:1024 sc1
 s_waitcnt vmcnt(14) lgkmcnt(1)
 v_mfma_f32_16x16x32_bf16 v[96:99], a[156:159], v[72:75], v[96:99]
 buffer_load_dword v2, v3, s[20:23], s53 offen sc1
 v_mfma_f32_16x16x32_bf16 v[100:103], a[160:163], v[72:75], v[100:103]
 v_mfma_f32_16x16x32_bf16 v[104:107], a[164:167], v[72:75], v[104:107]
 v_mfma_f32_16x16x32_bf16 v[108:111], v[20:23], v[72:75], v[108:111]
 buffer_load_dwordx4 v[72:75], v1, s[20:23], s46 offen offset:2048 sc1
 v_mfma_f32_16x16x32_bf16 v[112:115], a[156:159], v[76:79], v[112:115]
 ds_read_b128 v[28:31], v5 offset:15360
 v_mfma_f32_16x16x32_bf16 v[116:119], a[160:163], v[76:79], v[116:119]
 v_mfma_f32_16x16x32_bf16 v[120:123], a[164:167], v[76:79], v[120:123]
 v_mfma_f32_16x16x32_bf16 v[124:127], v[20:23], v[76:79], v[124:127]
 buffer_load_dwordx4 v[76:79], v1, s[20:23], s46 offen offset:3072 sc1
 s_waitcnt vmcnt(14) lgkmcnt(1)
 v_mfma_f32_16x16x32_bf16 v[96:99], a[168:171], v[80:83], v[96:99]
 v_mfma_f32_16x16x32_bf16 v[100:103], a[172:175], v[80:83], v[100:103]
 v_mfma_f32_16x16x32_bf16 v[104:107], a[176:179], v[80:83], v[104:107]
 v_mfma_f32_16x16x32_bf16 v[108:111], v[24:27], v[80:83], v[108:111]
 buffer_load_dwordx4 v[80:83], v1, s[20:23], s47 offen offset:0 sc1
 v_mfma_f32_16x16x32_bf16 v[112:115], a[168:171], v[84:87], v[112:115]
 ds_read_b128 v[16:19], v5 offset:16384
 v_mfma_f32_16x16x32_bf16 v[116:119], a[172:175], v[84:87], v[116:119]
 v_mfma_f32_16x16x32_bf16 v[120:123], a[176:179], v[84:87], v[120:123]
 v_mfma_f32_16x16x32_bf16 v[124:127], v[24:27], v[84:87], v[124:127]
 buffer_load_dwordx4 v[84:87], v1, s[20:23], s47 offen offset:1024 sc1
 s_waitcnt vmcnt(14) lgkmcnt(1)
 v_mfma_f32_16x16x32_bf16 v[96:99], a[180:183], v[88:91], v[96:99]
 v_mfma_f32_16x16x32_bf16 v[100:103], a[184:187], v[88:91], v[100:103]
 v_mfma_f32_16x16x32_bf16 v[104:107], a[188:191], v[88:91], v[104:107]
 v_mfma_f32_16x16x32_bf16 v[108:111], v[28:31], v[88:91], v[108:111]
 buffer_load_dwordx4 v[88:91], v1, s[20:23], s47 offen offset:2048 sc1
 v_mfma_f32_16x16x32_bf16 v[112:115], a[180:183], v[92:95], v[112:115]
 ds_read_b128 v[20:23], v5 offset:17408
 v_mfma_f32_16x16x32_bf16 v[116:119], a[184:187], v[92:95], v[116:119]
 v_mfma_f32_16x16x32_bf16 v[120:123], a[188:191], v[92:95], v[120:123]
 v_mfma_f32_16x16x32_bf16 v[124:127], v[28:31], v[92:95], v[124:127]
 buffer_load_dwordx4 v[92:95], v1, s[20:23], s47 offen offset:3072 sc1
 s_waitcnt vmcnt(14) lgkmcnt(1)
 v_mfma_f32_16x16x32_bf16 v[96:99], a[192:195], v[32:35], v[96:99]
 s_add_u32 s52, s44, 6
 s_and_b32 s52, s52, 7
 v_mfma_f32_16x16x32_bf16 v[100:103], a[196:199], v[32:35], v[100:103]
 s_lshl_b32 s52, s52, 13
 s_add_u32 s46, s48, s52
 v_mfma_f32_16x16x32_bf16 v[104:107], a[200:203], v[32:35], v[104:107]
 s_add_u32 s47, s46, 4096
 v_mfma_f32_16x16x32_bf16 v[108:111], v[16:19], v[32:35], v[108:111]
 buffer_load_dwordx4 v[32:35], v1, s[20:23], s46 offen offset:0 sc1
 v_mfma_f32_16x16x32_bf16 v[112:115], a[192:195], v[36:39], v[112:115]
 ds_read_b128 v[24:27], v5 offset:18432
 v_mfma_f32_16x16x32_bf16 v[116:119], a[196:199], v[36:39], v[116:119]
 v_mfma_f32_16x16x32_bf16 v[120:123], a[200:203], v[36:39], v[120:123]
 v_mfma_f32_16x16x32_bf16 v[124:127], v[16:19], v[36:39], v[124:127]
 buffer_load_dwordx4 v[36:39], v1, s[20:23], s46 offen offset:1024 sc1
 s_waitcnt vmcnt(14) lgkmcnt(1)
 v_mfma_f32_16x16x32_bf16 v[96:99], a[204:207], v[40:43], v[96:99]
 v_mfma_f32_16x16x32_bf16 v[100:103], a[208:211], v[40:43], v[100:103]
 v_mfma_f32_16x16x32_bf16 v[104:107], a[212:215], v[40:43], v[104:107]
 v_mfma_f32_16x16x32_bf16 v[108:111], v[20:23], v[40:43], v[108:111]
 buffer_load_dwordx4 v[40:43], v1, s[20:23], s46 offen offset:2048 sc1
 v_mfma_f32_16x16x32_bf16 v[112:115], a[204:207], v[44:47], v[112:115]
 ds_read_b128 v[28:31], v5 offset:19456
 v_mfma_f32_16x16x32_bf16 v[116:119], a[208:211], v[44:47], v[116:119]
 v_mfma_f32_16x16x32_bf16 v[120:123], a[212:215], v[44:47], v[120:123]
 v_mfma_f32_16x16x32_bf16 v[124:127], v[20:23], v[44:47], v[124:127]
 buffer_load_dwordx4 v[44:47], v1, s[20:23], s46 offen offset:3072 sc1
 s_waitcnt vmcnt(14) lgkmcnt(1)
 v_mfma_f32_16x16x32_bf16 v[96:99], a[216:219], v[48:51], v[96:99]
 v_mfma_f32_16x16x32_bf16 v[100:103], a[220:223], v[48:51], v[100:103]
 v_mfma_f32_16x16x32_bf16 v[104:107], a[224:227], v[48:51], v[104:107]
 v_mfma_f32_16x16x32_bf16 v[108:111], v[24:27], v[48:51], v[108:111]
 buffer_load_dwordx4 v[48:51], v1, s[20:23], s47 offen offset:0 sc1
 v_mfma_f32_16x16x32_bf16 v[112:115], a[216:219], v[52:55], v[112:115]
 ds_read_b128 v[16:19], v5 offset:20480
 v_mfma_f32_16x16x32_bf16 v[116:119], a[220:223], v[52:55], v[116:119]
 v_mfma_f32_16x16x32_bf16 v[120:123], a[224:227], v[52:55], v[120:123]
 v_mfma_f32_16x16x32_bf16 v[124:127], v[24:27], v[52:55], v[124:127]
 buffer_load_dwordx4 v[52:55], v1, s[20:23], s47 offen offset:1024 sc1
 s_waitcnt vmcnt(14) lgkmcnt(1)
 v_mfma_f32_16x16x32_bf16 v[96:99], a[228:231], v[56:59], v[96:99]
 v_mfma_f32_16x16x32_bf16 v[100:103], a[232:235], v[56:59], v[100:103]
 v_mfma_f32_16x16x32_bf16 v[104:107], a[236:239], v[56:59], v[104:107]
 v_mfma_f32_16x16x32_bf16 v[108:111], v[28:31], v[56:59], v[108:111]
 buffer_load_dwordx4 v[56:59], v1, s[20:23], s47 offen offset:2048 sc1
 v_mfma_f32_16x16x32_bf16 v[112:115], a[228:231], v[60:63], v[112:115]
 ds_read_b128 v[20:23], v5 offset:21504
 v_mfma_f32_16x16x32_bf16 v[116:119], a[232:235], v[60:63], v[116:119]
 v_mfma_f32_16x16x32_bf16 v[120:123], a[236:239], v[60:63], v[120:123]
 v_mfma_f32_16x16x32_bf16 v[124:127], v[28:31], v[60:63], v[124:127]
 buffer_load_dwordx4 v[60:63], v1, s[20:23], s47 offen offset:3072 sc1
 s_waitcnt vmcnt(14) lgkmcnt(1)
 v_mfma_f32_16x16x32_bf16 v[96:99], a[240:243], v[64:67], v[96:99]
 s_add_u32 s52, s44, 7
 s_and_b32 s52, s52, 7
 v_mfma_f32_16x16x32_bf16 v[100:103], a[244:247], v[64:67], v[100:103]
 s_lshl_b32 s52, s52, 13
 s_add_u32 s46, s48, s52
 v_mfma_f32_16x16x32_bf16 v[104:107], a[248:251], v[64:67], v[104:107]
 s_add_u32 s47, s46, 4096
 v_mfma_f32_16x16x32_bf16 v[108:111], v[16:19], v[64:67], v[108:111]
 buffer_load_dwordx4 v[64:67], v1, s[20:23], s46 offen offset:0 sc1
 v_mfma_f32_16x16x32_bf16 v[112:115], a[240:243], v[68:71], v[112:115]
 ds_read_b128 v[24:27], v5 offset:22528
 v_mfma_f32_16x16x32_bf16 v[116:119], a[244:247], v[68:71], v[116:119]
 v_mfma_f32_16x16x32_bf16 v[120:123], a[248:251], v[68:71], v[120:123]
 v_mfma_f32_16x16x32_bf16 v[124:127], v[16:19], v[68:71], v[124:127]
 buffer_load_dwordx4 v[68:71], v1, s[20:23], s46 offen offset:1024 sc1
 s_waitcnt vmcnt(14) lgkmcnt(1)
 v_mfma_f32_16x16x32_bf16 v[96:99], a[252:255], v[72:75], v[96:99]
 v_mfma_f32_16x16x32_bf16 v[100:103], v[128:131], v[72:75], v[100:103]
 v_mfma_f32_16x16x32_bf16 v[104:107], v[132:135], v[72:75], v[104:107]
 v_mfma_f32_16x16x32_bf16 v[108:111], v[20:23], v[72:75], v[108:111]
 buffer_load_dwordx4 v[72:75], v1, s[20:23], s46 offen offset:2048 sc1
 v_mfma_f32_16x16x32_bf16 v[112:115], a[252:255], v[76:79], v[112:115]
 ds_read_b128 v[28:31], v5 offset:23552
 v_mfma_f32_16x16x32_bf16 v[116:119], v[128:131], v[76:79], v[116:119]
 v_mfma_f32_16x16x32_bf16 v[120:123], v[132:135], v[76:79], v[120:123]
 v_mfma_f32_16x16x32_bf16 v[124:127], v[20:23], v[76:79], v[124:127]
 buffer_load_dwordx4 v[76:79], v1, s[20:23], s46 offen offset:3072 sc1
 s_waitcnt vmcnt(14) lgkmcnt(1)
 v_mfma_f32_16x16x32_bf16 v[96:99], v[136:139], v[80:83], v[96:99]
 v_cmp_gt_u32 vcc, s51, v2
 v_mfma_f32_16x16x32_bf16 v[100:103], v[140:143], v[80:83], v[100:103]
 v_mfma_f32_16x16x32_bf16 v[104:107], v[144:147], v[80:83], v[104:107]
 v_mfma_f32_16x16x32_bf16 v[108:111], v[24:27], v[80:83], v[108:111]
 buffer_load_dwordx4 v[80:83], v1, s[20:23], s47 offen offset:0 sc1
 v_mfma_f32_16x16x32_bf16 v[112:115], v[136:139], v[84:87], v[112:115]
 ds_read_b128 v[16:19], v5 offset:24576
 v_mfma_f32_16x16x32_bf16 v[116:119], v[140:143], v[84:87], v[116:119]
 v_mfma_f32_16x16x32_bf16 v[120:123], v[144:147], v[84:87], v[120:123]
 v_mfma_f32_16x16x32_bf16 v[124:127], v[24:27], v[84:87], v[124:127]
 buffer_load_dwordx4 v[84:87], v1, s[20:23], s47 offen offset:1024 sc1
 s_waitcnt vmcnt(14) lgkmcnt(1)
 v_mfma_f32_16x16x32_bf16 v[96:99], v[148:151], v[88:91], v[96:99]
 s_and_b32 s52, vcc_lo, 0xffff
 s_cbranch_scc1 Losw_36
Loswk_37:
 v_mfma_f32_16x16x32_bf16 v[100:103], v[152:155], v[88:91], v[100:103]
 s_lshl_b32 s48, s42, 18
 s_add_u32 s48, s48, s36
 v_mfma_f32_16x16x32_bf16 v[104:107], v[156:159], v[88:91], v[104:107]
 v_mfma_f32_16x16x32_bf16 v[108:111], v[28:31], v[88:91], v[108:111]
 buffer_load_dwordx4 v[88:91], v1, s[20:23], s47 offen offset:2048 sc1
 v_mfma_f32_16x16x32_bf16 v[112:115], v[148:151], v[92:95], v[112:115]
 ds_read_b128 v[20:23], v5 offset:25600
 v_mfma_f32_16x16x32_bf16 v[116:119], v[152:155], v[92:95], v[116:119]
 v_mfma_f32_16x16x32_bf16 v[120:123], v[156:159], v[92:95], v[120:123]
 v_mfma_f32_16x16x32_bf16 v[124:127], v[28:31], v[92:95], v[124:127]
 buffer_load_dwordx4 v[92:95], v1, s[20:23], s47 offen offset:3072 sc1
 s_waitcnt vmcnt(14) lgkmcnt(1)
 v_mfma_f32_16x16x32_bf16 v[96:99], v[160:163], v[32:35], v[96:99]
 s_add_u32 s52, s44, 0
 s_and_b32 s52, s52, 7
 v_mfma_f32_16x16x32_bf16 v[100:103], v[164:167], v[32:35], v[100:103]
 s_lshl_b32 s52, s52, 13
 s_add_u32 s46, s48, s52
 v_mfma_f32_16x16x32_bf16 v[104:107], v[168:171], v[32:35], v[104:107]
 s_add_u32 s47, s46, 4096
 v_mfma_f32_16x16x32_bf16 v[108:111], v[16:19], v[32:35], v[108:111]
 buffer_load_dwordx4 v[32:35], v1, s[20:23], s46 offen offset:0 sc1
 v_mfma_f32_16x16x32_bf16 v[112:115], v[160:163], v[36:39], v[112:115]
 ds_read_b128 v[24:27], v5 offset:26624
 v_mfma_f32_16x16x32_bf16 v[116:119], v[164:167], v[36:39], v[116:119]
 v_mfma_f32_16x16x32_bf16 v[120:123], v[168:171], v[36:39], v[120:123]
 v_mfma_f32_16x16x32_bf16 v[124:127], v[16:19], v[36:39], v[124:127]
 buffer_load_dwordx4 v[36:39], v1, s[20:23], s46 offen offset:1024 sc1
 s_waitcnt vmcnt(14) lgkmcnt(1)
 v_mfma_f32_16x16x32_bf16 v[96:99], v[172:175], v[40:43], v[96:99]
 v_mfma_f32_16x16x32_bf16 v[100:103], v[176:179], v[40:43], v[100:103]
 v_mfma_f32_16x16x32_bf16 v[104:107], v[180:183], v[40:43], v[104:107]
 v_mfma_f32_16x16x32_bf16 v[108:111], v[20:23], v[40:43], v[108:111]
 buffer_load_dwordx4 v[40:43], v1, s[20:23], s46 offen offset:2048 sc1
 v_mfma_f32_16x16x32_bf16 v[112:115], v[172:175], v[44:47], v[112:115]
 ds_read_b128 v[28:31], v5 offset:27648
 v_mfma_f32_16x16x32_bf16 v[116:119], v[176:179], v[44:47], v[116:119]
 v_mfma_f32_16x16x32_bf16 v[120:123], v[180:183], v[44:47], v[120:123]
 v_mfma_f32_16x16x32_bf16 v[124:127], v[20:23], v[44:47], v[124:127]
 buffer_load_dwordx4 v[44:47], v1, s[20:23], s46 offen offset:3072 sc1
 s_waitcnt vmcnt(14) lgkmcnt(1)
 v_mfma_f32_16x16x32_bf16 v[96:99], v[184:187], v[48:51], v[96:99]
 v_mfma_f32_16x16x32_bf16 v[100:103], v[188:191], v[48:51], v[100:103]
 v_mfma_f32_16x16x32_bf16 v[104:107], v[192:195], v[48:51], v[104:107]
 v_mfma_f32_16x16x32_bf16 v[108:111], v[24:27], v[48:51], v[108:111]
 buffer_load_dwordx4 v[48:51], v1, s[20:23], s47 offen offset:0 sc1
 v_mfma_f32_16x16x32_bf16 v[112:115], v[184:187], v[52:55], v[112:115]
 ds_read_b128 v[16:19], v5 offset:28672
 v_mfma_f32_16x16x32_bf16 v[116:119], v[188:191], v[52:55], v[116:119]
 v_mfma_f32_16x16x32_bf16 v[120:123], v[192:195], v[52:55], v[120:123]
 v_mfma_f32_16x16x32_bf16 v[124:127], v[24:27], v[52:55], v[124:127]
 buffer_load_dwordx4 v[52:55], v1, s[20:23], s47 offen offset:1024 sc1
 s_waitcnt vmcnt(14) lgkmcnt(1)
 v_mfma_f32_16x16x32_bf16 v[96:99], v[196:199], v[56:59], v[96:99]
 v_mfma_f32_16x16x32_bf16 v[100:103], v[200:203], v[56:59], v[100:103]
 v_mfma_f32_16x16x32_bf16 v[104:107], v[204:207], v[56:59], v[104:107]
 v_mfma_f32_16x16x32_bf16 v[108:111], v[28:31], v[56:59], v[108:111]
 buffer_load_dwordx4 v[56:59], v1, s[20:23], s47 offen offset:2048 sc1
 v_mfma_f32_16x16x32_bf16 v[112:115], v[196:199], v[60:63], v[112:115]
 ds_read_b128 v[20:23], v5 offset:29696
 v_mfma_f32_16x16x32_bf16 v[116:119], v[200:203], v[60:63], v[116:119]
 v_mfma_f32_16x16x32_bf16 v[120:123], v[204:207], v[60:63], v[120:123]
 v_mfma_f32_16x16x32_bf16 v[124:127], v[28:31], v[60:63], v[124:127]
 buffer_load_dwordx4 v[60:63], v1, s[20:23], s47 offen offset:3072 sc1
 s_waitcnt vmcnt(14) lgkmcnt(1)
 v_mfma_f32_16x16x32_bf16 v[96:99], v[208:211], v[64:67], v[96:99]
 s_add_u32 s52, s44, 1
 s_and_b32 s52, s52, 7
 v_mfma_f32_16x16x32_bf16 v[100:103], v[212:215], v[64:67], v[100:103]
 s_lshl_b32 s52, s52, 13
 s_add_u32 s46, s48, s52
 v_mfma_f32_16x16x32_bf16 v[104:107], v[216:219], v[64:67], v[104:107]
 s_add_u32 s47, s46, 4096
 v_mfma_f32_16x16x32_bf16 v[108:111], v[16:19], v[64:67], v[108:111]
 buffer_load_dwordx4 v[64:67], v1, s[20:23], s46 offen offset:0 sc1
 v_mfma_f32_16x16x32_bf16 v[112:115], v[208:211], v[68:71], v[112:115]
 ds_read_b128 v[24:27], v5 offset:30720
 v_mfma_f32_16x16x32_bf16 v[116:119], v[212:215], v[68:71], v[116:119]
 v_mfma_f32_16x16x32_bf16 v[120:123], v[216:219], v[68:71], v[120:123]
 v_mfma_f32_16x16x32_bf16 v[124:127], v[16:19], v[68:71], v[124:127]
 buffer_load_dwordx4 v[68:71], v1, s[20:23], s46 offen offset:1024 sc1
 s_waitcnt vmcnt(14) lgkmcnt(1)
 v_mfma_f32_16x16x32_bf16 v[96:99], v[220:223], v[72:75], v[96:99]
 v_mfma_f32_16x16x32_bf16 v[100:103], v[224:227], v[72:75], v[100:103]
 v_mfma_f32_16x16x32_bf16 v[104:107], v[228:231], v[72:75], v[104:107]
 v_mfma_f32_16x16x32_bf16 v[108:111], v[20:23], v[72:75], v[108:111]
 buffer_load_dwordx4 v[72:75], v1, s[20:23], s46 offen offset:2048 sc1
 v_mfma_f32_16x16x32_bf16 v[112:115], v[220:223], v[76:79], v[112:115]
 ds_read_b128 v[28:31], v5 offset:31744
 v_mfma_f32_16x16x32_bf16 v[116:119], v[224:227], v[76:79], v[116:119]
 v_mfma_f32_16x16x32_bf16 v[120:123], v[228:231], v[76:79], v[120:123]
 v_mfma_f32_16x16x32_bf16 v[124:127], v[20:23], v[76:79], v[124:127]
 buffer_load_dwordx4 v[76:79], v1, s[20:23], s46 offen offset:3072 sc1
 s_waitcnt vmcnt(14) lgkmcnt(1)
 v_mfma_f32_16x16x32_bf16 v[96:99], v[232:235], v[80:83], v[96:99]
 v_mfma_f32_16x16x32_bf16 v[100:103], v[236:239], v[80:83], v[100:103]
 v_mfma_f32_16x16x32_bf16 v[104:107], v[240:243], v[80:83], v[104:107]
 v_mfma_f32_16x16x32_bf16 v[108:111], v[24:27], v[80:83], v[108:111]
 buffer_load_dwordx4 v[80:83], v1, s[20:23], s47 offen offset:0 sc1
 v_mfma_f32_16x16x32_bf16 v[112:115], v[232:235], v[84:87], v[112:115]
 ds_read_b128 v[16:19], v5 offset:0
 v_mfma_f32_16x16x32_bf16 v[116:119], v[236:239], v[84:87], v[116:119]
 v_mfma_f32_16x16x32_bf16 v[120:123], v[240:243], v[84:87], v[120:123]
 v_mfma_f32_16x16x32_bf16 v[124:127], v[24:27], v[84:87], v[124:127]
 buffer_load_dwordx4 v[84:87], v1, s[20:23], s47 offen offset:1024 sc1
 s_waitcnt vmcnt(14) lgkmcnt(1)
 v_mfma_f32_16x16x32_bf16 v[96:99], v[244:247], v[88:91], v[96:99]
 v_mfma_f32_16x16x32_bf16 v[100:103], v[248:251], v[88:91], v[100:103]
 v_mfma_f32_16x16x32_bf16 v[104:107], v[252:255], v[88:91], v[104:107]
 v_mfma_f32_16x16x32_bf16 v[108:111], v[28:31], v[88:91], v[108:111]
 buffer_load_dwordx4 v[88:91], v1, s[20:23], s47 offen offset:2048 sc1
 v_mfma_f32_16x16x32_bf16 v[112:115], v[244:247], v[92:95], v[112:115]
 ds_read_b128 v[20:23], v5 offset:1024
 v_mfma_f32_16x16x32_bf16 v[116:119], v[248:251], v[92:95], v[116:119]
 v_mfma_f32_16x16x32_bf16 v[120:123], v[252:255], v[92:95], v[120:123]
 v_mfma_f32_16x16x32_bf16 v[124:127], v[28:31], v[92:95], v[124:127]
 buffer_load_dwordx4 v[92:95], v1, s[20:23], s47 offen offset:3072 sc1
 s_cmp_lt_u32 s43, s35
 ds_write_b128 v14, v[96:99] offset:32768
 ds_write_b128 v15, v[100:103] offset:33792
 ds_write_b128 v14, v[104:107] offset:34816
 ds_write_b128 v15, v[108:111] offset:35840
 ds_write_b128 v14, v[112:115] offset:36864
 ds_write_b128 v15, v[116:119] offset:37888
 ds_write_b128 v14, v[120:123] offset:38912
 ds_write_b128 v15, v[124:127] offset:39936
 s_waitcnt lgkmcnt(0)
 s_barrier
 ds_read_b128 v[96:99], v4 offset:0
 ds_read_b128 v[100:103], v4 offset:256
 ds_read_b128 v[104:107], v4 offset:40960
 ds_read_b128 v[108:111], v4 offset:41216
 ds_read_b128 v[112:115], v7 offset:0
 ds_read_b128 v[116:119], v7 offset:256
 ds_read_b128 v[120:123], v7 offset:40960
 ds_read_b128 v[124:127], v7 offset:41216
 s_waitcnt lgkmcnt(4)
 v_pk_add_f32 v[96:97], v[96:97], v[104:105]
 v_pk_add_f32 v[98:99], v[98:99], v[106:107]
 v_pk_add_f32 v[100:101], v[100:101], v[108:109]
 v_pk_add_f32 v[102:103], v[102:103], v[110:111]
 s_waitcnt lgkmcnt(2)
 v_pk_add_f32 v[96:97], v[96:97], v[112:113]
 v_pk_add_f32 v[98:99], v[98:99], v[114:115]
 v_pk_add_f32 v[100:101], v[100:101], v[116:117]
 v_pk_add_f32 v[102:103], v[102:103], v[118:119]
 s_waitcnt lgkmcnt(0)
 v_pk_add_f32 v[96:97], v[96:97], v[120:121]
 v_pk_add_f32 v[98:99], v[98:99], v[122:123]
 v_pk_add_f32 v[100:101], v[100:101], v[124:125]
 v_pk_add_f32 v[102:103], v[102:103], v[126:127]
 v_cvt_pk_bf16_f32 v8, v96, v97
 v_cvt_pk_bf16_f32 v9, v98, v99
 v_cvt_pk_bf16_f32 v10, v100, v101
 v_cvt_pk_bf16_f32 v11, v102, v103
 buffer_store_dwordx4 v[8:11], v6, s[24:27], s54 offen
 s_cbranch_scc1 Losl_35
 s_branch Lose_38
Losw_36:
 buffer_load_dword v2, v3, s[20:23], s53 offen sc1
 s_waitcnt vmcnt(0)
 v_cmp_gt_u32 vcc, s51, v2
 s_and_b32 s52, vcc_lo, 0xffff
 s_cbranch_scc0 Loswk_37
 s_sleep 4
 s_sub_u32 s50, s50, 1
 s_cbranch_scc0 Losw_36
 s_endpgm
Lose_38:
 s_waitcnt vmcnt(0)
 s_branch Lfin
Lchain:
 s_load_dwordx2 s[8:9], s[0:1], 64
 s_mov_b32 s10, 0x480000
 s_mov_b32 s11, 0x20000
 s_load_dwordx2 s[12:13], s[0:1], 72
 s_mov_b32 s14, 0x480000
 s_mov_b32 s15, 0x20000
 s_load_dwordx2 s[16:17], s[0:1], 80
 s_mov_b32 s18, 0x480000
 s_mov_b32 s19, 0x20000
 s_load_dwordx2 s[24:25], s[0:1], 88
 s_mov_b32 s26, 0x480000
 s_mov_b32 s27, 0x20000
 s_load_dwordx2 s[28:29], s[0:1], 112
 s_mov_b32 s30, 0x100
 s_mov_b32 s31, 0x20000
 s_load_dwordx2 s[32:33], s[0:1], 56
 s_mov_b32 s34, 0x2400
 s_mov_b32 s35, 0x20000
 v_and_b32 v20, 63, v0
 v_lshlrev_b32 v3, 4, v20
 v_mov_b32 v7, 0
 s_mov_b32 s48, 0xcccccccc
 s_mov_b32 s49, 0xcccccccc
 v_mov_b32 v21, 0x44444444
 v_mov_b32 v22, 0xeeeeeeee
 v_cndmask_b32 v5, v21, v22, s[48:49]
 s_lshl_b32 s47, s4, 10
 s_add_u32 s47, s47, 19456
 v_and_b32 v21, 48, v20
 v_lshl_add_u32 v21, v21, 3, s47
 v_and_b32 v22, 8, v20
 v_lshl_add_u32 v21, v22, 2, v21
 v_and_b32 v22, 1, v20
 v_lshl_add_u32 v21, v22, 4, v21
 v_and_b32 v22, 6, v20
 v_lshl_add_u32 v8, v22, 1, v21
 v_and_b32 v21, 32, v20
 v_lshlrev_b32 v21, 5, v21
 v_and_b32 v22, 12, v20
 v_lshl_add_u32 v21, v22, 5, v21
 v_and_b32 v22, 1, v20
 v_lshl_add_u32 v21, v22, 6, v21
 v_and_b32 v22, 16, v20
 v_lshl_add_u32 v21, v22, 1, v21
 v_and_b32 v22, 2, v20
 v_lshl_add_u32 v9, v22, 3, v21
 v_lshrrev_b32 v21, 4, v0
 v_lshlrev_b32 v21, 7, v21
 v_and_b32 v22, 15, v20
 v_lshl_add_u32 v21, v22, 2, v21
 v_add_u32 v10, 17408, v21
 v_and_b32 v22, 1, v20
 v_and_b32 v21, 12, v20
 v_lshlrev_b32 v21, 5, v21
 v_lshl_add_u32 v21, v22, 6, v21
 v_and_b32 v22, 48, v20
 v_add_u32 v11, v21, v22
 s_mov_b32 s55, 0x3e0293ee
 s_mov_b32 s54, 0x40000
 s_lshl_b32 s47, s6, 6
 s_add_u32 s60, s47, 0x100000
 s_add_u32 s61, s47, 0x101000
 s_add_u32 s62, s47, 0x102000
 s_lshl_b32 s47, s6, 7
 s_add_u32 s56, s47, 0x0
 s_add_u32 s57, s47, 0x1000
 s_mul_i32 s47, s6, 10496
 s_add_u32 s40, s47, 0x102000
 s_lshl_b32 s58, s4, 11
 s_add_u32 s47, s47, s58
 s_add_u32 s39, s47, 0x100000
 s_lshl_b32 s42, s4, 11
 s_add_u32 s41, s42, 0x1e0000
 s_mov_b32 s43, 0x1e2000
 s_lshr_b32 s69, s4, 1
 s_lshl_b32 s69, s69, 11
 s_and_b32 s47, s4, 1
 s_lshl_b32 s47, s47, 3
 s_add_u32 s69, s69, s47
 s_lshl_b32 s47, s6, 5
 s_add_u32 s65, s47, 0x1e2000
 s_add_u32 s66, s47, 0x162000
 s_lshr_b32 s47, s6, 3
 s_lshl_b32 s47, s47, 9
 s_and_b32 s58, s6, 1
 s_lshl_b32 s58, s58, 8
 s_add_u32 s47, s47, s58
 s_and_b32 s58, s6, 6
 s_lshl_b32 s58, s58, 5
 s_add_u32 s47, s47, s58
 s_lshl_b32 s58, s4, 11
 s_add_u32 s47, s47, s58
 s_add_u32 s44, s47, 0x1e0000
 s_add_u32 s45, s47, 0x160000
 s_lshl_b32 s47, s6, 14
 s_add_u32 s37, s47, 0x3000000
 s_add_u32 s67, s37, s58
 s_add_u32 s59, s67, 8192
 s_lshl_b32 s47, s6, 12
 s_add_u32 s38, s47, 0x3e0000
 s_mov_b32 s36, 0
 s_mov_b32 s46, 0
 s_waitcnt lgkmcnt(0)
 v_mov_b32 v20, 0
 v_mov_b32 v21, 0
 v_mov_b32 v22, 0
 v_mov_b32 v23, 0
 v_mov_b32 v27, -1
 v_bfe_u32 v24, v3, 8, 1
 v_bfe_u32 v25, v3, 9, 1
 v_lshl_or_b32 v24, v24, 1, v25
 v_bfe_u32 v25, v3, 5, 1
 v_lshl_or_b32 v24, v24, 1, v25
 v_and_b32 v25, 0xd0, v3
 v_lshlrev_b32 v25, 24, v25
 v_lshl_or_b32 v24, v24, 2, v25
 v_bfe_u32 v26, v3, 8, 2
 v_bfe_u32 v25, v3, 2, 4
 v_lshl_or_b32 v26, v26, 4, v25
 v_and_b32 v25, 0xc0, v3
 v_lshl_or_b32 v26, v25, 24, v26
 buffer_store_dwordx4 v[20:23], v3, s[20:23], s39 offen offset:0 sc1
 buffer_store_dwordx4 v[20:23], v3, s[20:23], s39 offen offset:1024 sc1
 buffer_store_dwordx4 v[20:23], v3, s[20:23], s40 offen offset:0 sc1
 buffer_store_dwordx4 v[20:23], v3, s[20:23], s40 offen offset:1024 sc1
 buffer_store_dword v27, v26, s[20:23], s44 offen sc1
 buffer_store_dword v27, v26, s[20:23], s45 offen sc1
 buffer_store_dword v27, v24, s[20:23], s65 offen sc1
 buffer_store_dword v27, v24, s[20:23], s66 offen sc1
 v_and_b32 v30, 63, v0
 v_bfe_u32 v31, v30, 1, 2
 v_lshrrev_b32 v32, 5, v30
 v_xor_b32 v31, v31, v32
 v_lshlrev_b32 v31, 5, v31
 v_and_b32 v32, 1, v30
 v_lshl_add_u32 v31, v32, 4, v31
 v_xor_b32 v33, 64, v31
 v_lshrrev_b32 v32, 3, v30
 s_lshl_b32 s47, s4, 4
 v_and_b32 v34, 3, v32
 v_lshrrev_b32 v35, 2, v32
 v_lshl_add_u32 v34, v34, 1, v35
 v_add_u32 v34, s47, v34
 v_lshl_add_u32 v12, v34, 13, v31
 v_add_u32 v34, 8, v34
 v_lshl_add_u32 v13, v34, 13, v33
 v_and_b32 v34, 1, v32
 v_lshlrev_b32 v34, 6, v34
 v_and_b32 v35, 6, v32
 s_lshl_b32 s47, s4, 3
 v_add3_u32 v34, v34, v35, s47
 v_lshl_add_u32 v56, v34, 13, v31
 v_mul_u32_u24 v35, 1152, v34
 v_add_u32 v14, v35, v31
 v_add_u32 v34, 1, v34
 v_lshl_add_u32 v57, v34, 13, v33
 v_mul_u32_u24 v35, 1152, v34
 v_add_u32 v15, v35, v33
 v_bfe_u32 v31, v30, 4, 1
 v_bfe_u32 v32, v30, 3, 1
 v_lshl_add_u32 v33, v32, 1, v31
 v_xor_b32 v33, s4, v33
 v_lshlrev_b32 v33, 5, v33
 v_lshl_add_u32 v33, v31, 9, v33
 v_lshl_add_u32 v33, v32, 10, v33
 v_bfe_u32 v31, v30, 2, 1
 v_lshl_add_u32 v33, v31, 7, v33
 v_lshrrev_b32 v31, 5, v30
 v_lshl_add_u32 v33, v31, 11, v33
 v_and_b32 v31, 3, v30
 v_lshl_add_u32 v16, v31, 3, v33
 v_add_u32 v17, 0x10000, v16
 v_add_u32 v18, 0x20000, v16
 v_lshlrev_b32 v60, 4, v0
 v_add_u32 v61, 0x10000, v60
 v_add_u32 v62, 0x20000, v60
 s_lshl_b32 s70, s6, 8
 s_mul_i32 s71, s6, 147456
 s_lshl_b32 s72, s4, 11
 s_lshl_b32 s47, s4, 4
 v_add_u32 v31, s47, v30
 s_lshr_b32 s47, s4, 1
 s_lshl_b32 s47, s47, 5
 v_add_u32 v32, s47, v31
 v_lshrrev_b32 v33, 4, v30
 v_lshlrev_b32 v33, 28, v33
 v_lshl_or_b32 v58, v31, 13, v33
 v_lshl_or_b32 v19, v32, 13, v33
 v_mul_u32_u24 v32, 1152, v32
 v_or_b32 v59, v32, v33
 s_add_u32 m0, s72, 24576
 s_add_u32 s47, s70, 0
 buffer_load_dwordx4 v56, s[8:11], s47 offen  lds
 s_add_u32 m0, s72, 25600
 s_nop 0
 buffer_load_dwordx4 v57, s[8:11], s47 offen  lds
 s_add_u32 m0, s72, 32768
 s_add_u32 s47, s70, 128
 buffer_load_dwordx4 v56, s[8:11], s47 offen  lds
 s_add_u32 m0, s72, 33792
 s_nop 0
 buffer_load_dwordx4 v57, s[8:11], s47 offen  lds
 s_add_u32 m0, s72, 40960
 s_add_u32 s47, s70, 0
 buffer_load_dwordx4 v56, s[12:15], s47 offen  lds
 s_add_u32 m0, s72, 41984
 s_nop 0
 buffer_load_dwordx4 v57, s[12:15], s47 offen  lds
 s_add_u32 m0, s72, 49152
 s_add_u32 s47, s70, 0
 buffer_load_dwordx4 v56, s[16:19], s47 offen  lds
 s_add_u32 m0, s72, 50176
 s_nop 0
 buffer_load_dwordx4 v57, s[16:19], s47 offen  lds
 s_add_u32 m0, s72, 57344
 s_add_u32 s47, s70, 128
 buffer_load_dwordx4 v56, s[16:19], s47 offen  lds
 s_add_u32 m0, s72, 58368
 s_nop 0
 buffer_load_dwordx4 v57, s[16:19], s47 offen  lds
 s_add_u32 m0, s72, 65536
 s_add_u32 s47, s70, 262144
 buffer_load_dwordx4 v56, s[8:11], s47 offen  lds
 s_add_u32 m0, s72, 66560
 s_nop 0
 buffer_load_dwordx4 v57, s[8:11], s47 offen  lds
 s_add_u32 m0, s72, 73728
 s_add_u32 s47, s70, 262272
 buffer_load_dwordx4 v56, s[8:11], s47 offen  lds
 s_add_u32 m0, s72, 74752
 s_nop 0
 buffer_load_dwordx4 v57, s[8:11], s47 offen  lds
 s_add_u32 m0, s72, 81920
 s_add_u32 s47, s70, 262144
 buffer_load_dwordx4 v56, s[12:15], s47 offen  lds
 s_add_u32 m0, s72, 82944
 s_nop 0
 buffer_load_dwordx4 v57, s[12:15], s47 offen  lds
 s_waitcnt vmcnt(14)
 s_waitcnt lgkmcnt(0)
 s_barrier
 s_getreg_b32 s73, hwreg(HW_REG_XCC_ID, 0, 3)
 s_lshl_b32 s73, s73, 3
 s_lshl_b64 s[74:75], 1, s73
 v_mov_b32 v64, s74
 v_mov_b32 v65, s75
 v_mov_b32 v66, 0x7ff00000
 v_cmp_eq_u32 vcc, 0, v0
 s_nop 1
 v_cndmask_b32 v66, v66, v7, vcc
 buffer_atomic_add_x2 v[64:65], v66, s[28:31], 0 offen offset:8
 s_add_u32 m0, s72, 90112
 s_add_u32 s47, s70, 262144
 buffer_load_dwordx4 v56, s[16:19], s47 offen  lds
 s_add_u32 m0, s72, 91136
 s_nop 0
 buffer_load_dwordx4 v57, s[16:19], s47 offen  lds
 ds_read_b64_tr_b16 v[72:73], v16 offset:24576
 ds_read_b64_tr_b16 v[74:75], v16 offset:24832
 ds_read_b64_tr_b16 v[76:77], v16 offset:28672
 ds_read_b64_tr_b16 v[78:79], v16 offset:28928
 s_waitcnt vmcnt(15)
 s_waitcnt lgkmcnt(0)
 s_barrier
 s_add_u32 m0, s72, 98304
 s_add_u32 s47, s70, 262272
 buffer_load_dwordx4 v56, s[16:19], s47 offen  lds
 s_add_u32 m0, s72, 99328
 s_nop 0
 buffer_load_dwordx4 v57, s[16:19], s47 offen  lds
 ds_read_b64_tr_b16 v[80:81], v16 offset:32768
 ds_read_b64_tr_b16 v[82:83], v16 offset:33024
 ds_read_b64_tr_b16 v[84:85], v16 offset:36864
 ds_read_b64_tr_b16 v[86:87], v16 offset:37120
 s_waitcnt vmcnt(15)
 s_waitcnt lgkmcnt(0)
 s_barrier
 s_add_u32 m0, s72, 106496
 s_add_u32 s47, s70, 1048576
 buffer_load_dwordx4 v56, s[8:11], s47 offen  lds
 s_add_u32 m0, s72, 107520
 s_nop 0
 buffer_load_dwordx4 v57, s[8:11], s47 offen  lds
 ds_read_b64_tr_b16 v[88:89], v16 offset:40960
 ds_read_b64_tr_b16 v[90:91], v16 offset:41216
 ds_read_b64_tr_b16 v[92:93], v16 offset:45056
 ds_read_b64_tr_b16 v[94:95], v16 offset:45312
 s_waitcnt vmcnt(15)
 s_waitcnt lgkmcnt(0)
 s_barrier
 s_add_u32 m0, s72, 114688
 s_add_u32 s47, s70, 1048704
 buffer_load_dwordx4 v56, s[8:11], s47 offen  lds
 s_add_u32 m0, s72, 115712
 s_nop 0
 buffer_load_dwordx4 v57, s[8:11], s47 offen  lds
 ds_read_b64_tr_b16 v[96:97], v16 offset:49152
 ds_read_b64_tr_b16 v[98:99], v16 offset:49408
 ds_read_b64_tr_b16 v[100:101], v16 offset:53248
 ds_read_b64_tr_b16 v[102:103], v16 offset:53504
 s_waitcnt vmcnt(15)
 s_waitcnt lgkmcnt(0)
 s_barrier
 s_add_u32 m0, s72, 122880
 s_add_u32 s47, s70, 1048576
 buffer_load_dwordx4 v56, s[12:15], s47 offen  lds
 s_add_u32 m0, s72, 123904
 s_nop 0
 buffer_load_dwordx4 v57, s[12:15], s47 offen  lds
 v_lshrrev_b32 v68, 4, v3
 v_bfe_u32 v69, v68, 2, 2
 v_and_b32 v70, 1, v68
 v_lshl_add_u32 v69, v69, 1, v70
 v_mul_u32_u24 v69, 1152, v69
 v_and_b32 v70, 48, v68
 v_and_b32 v71, 2, v68
 v_lshl_add_u32 v71, v71, 2, v70
 v_lshl_add_u32 v71, v71, 1, v69
 v_add_u32 v69, v70, v69
 s_lshr_b32 s47, s4, 1
 s_lshl_b32 s47, s47, 8
 s_and_b32 s58, s4, 1
 s_lshl_b32 s58, s58, 6
 s_add_u32 s47, s47, s58
 buffer_load_dwordx4 v[20:23], v69, s[32:35], s47 offen offset:0
 buffer_load_dwordx4 v[24:27], v69, s[32:35], s47 offen offset:128
 buffer_load_dwordx4 v[28:31], v69, s[32:35], s47 offen offset:512
 buffer_load_dwordx4 v[32:35], v69, s[32:35], s47 offen offset:640
 buffer_load_dwordx4 v[36:39], v71, s[32:35], 0 offen offset:1024
 ds_read_b64_tr_b16 v[104:105], v16 offset:57344
 ds_read_b64_tr_b16 v[106:107], v16 offset:57600
 ds_read_b64_tr_b16 v[108:109], v16 offset:61440
 ds_read_b64_tr_b16 v[110:111], v16 offset:61696
 s_waitcnt vmcnt(20)
 s_waitcnt lgkmcnt(0)
 s_barrier
 s_add_u32 m0, s72, 131072
 s_add_u32 s47, s70, 1048576
 buffer_load_dwordx4 v56, s[16:19], s47 offen  lds
 s_add_u32 m0, s72, 132096
 s_nop 0
 buffer_load_dwordx4 v57, s[16:19], s47 offen  lds
 ds_read_b64_tr_b16 v[112:113], v17 offset:0
 ds_read_b64_tr_b16 v[114:115], v17 offset:256
 ds_read_b64_tr_b16 v[116:117], v17 offset:4096
 ds_read_b64_tr_b16 v[118:119], v17 offset:4352
 s_waitcnt vmcnt(20)
 s_waitcnt lgkmcnt(0)
 s_barrier
 s_add_u32 m0, s72, 139264
 s_add_u32 s47, s70, 1048704
 buffer_load_dwordx4 v56, s[16:19], s47 offen  lds
 s_add_u32 m0, s72, 140288
 s_nop 0
 buffer_load_dwordx4 v57, s[16:19], s47 offen  lds
 ds_read_b64_tr_b16 v[120:121], v17 offset:8192
 ds_read_b64_tr_b16 v[122:123], v17 offset:8448
 ds_read_b64_tr_b16 v[124:125], v17 offset:12288
 ds_read_b64_tr_b16 v[126:127], v17 offset:12544
 s_waitcnt vmcnt(20)
 s_waitcnt lgkmcnt(0)
 s_barrier
 s_add_u32 m0, s72, 147456
 s_add_u32 s47, s70, 1310720
 buffer_load_dwordx4 v56, s[8:11], s47 offen  lds
 s_add_u32 m0, s72, 148480
 s_nop 0
 buffer_load_dwordx4 v57, s[8:11], s47 offen  lds
 ds_read_b64_tr_b16 v[128:129], v17 offset:16384
 ds_read_b64_tr_b16 v[130:131], v17 offset:16640
 ds_read_b64_tr_b16 v[132:133], v17 offset:20480
 ds_read_b64_tr_b16 v[134:135], v17 offset:20736
 s_waitcnt vmcnt(19)
 s_waitcnt lgkmcnt(0)
 s_barrier
 s_add_u32 m0, s72, 155648
 s_add_u32 s47, s70, 1310848
 buffer_load_dwordx4 v56, s[8:11], s47 offen  lds
 s_add_u32 m0, s72, 156672
 s_nop 0
 buffer_load_dwordx4 v57, s[8:11], s47 offen  lds
 ds_read_b64_tr_b16 v[136:137], v17 offset:24576
 ds_read_b64_tr_b16 v[138:139], v17 offset:24832
 ds_read_b64_tr_b16 v[140:141], v17 offset:28672
 ds_read_b64_tr_b16 v[142:143], v17 offset:28928
 s_waitcnt vmcnt(19)
 s_waitcnt lgkmcnt(0)
 s_barrier
 s_add_u32 m0, s72, 24576
 s_add_u32 s47, s70, 1310720
 buffer_load_dwordx4 v56, s[12:15], s47 offen  lds
 s_add_u32 m0, s72, 25600
 s_nop 0
 buffer_load_dwordx4 v57, s[12:15], s47 offen  lds
 ds_read_b64_tr_b16 v[144:145], v17 offset:32768
 ds_read_b64_tr_b16 v[146:147], v17 offset:33024
 ds_read_b64_tr_b16 v[148:149], v17 offset:36864
 ds_read_b64_tr_b16 v[150:151], v17 offset:37120
 s_waitcnt vmcnt(19)
 s_waitcnt lgkmcnt(0)
 s_barrier
 s_add_u32 m0, s72, 32768
 s_add_u32 s47, s70, 1310720
 buffer_load_dwordx4 v56, s[16:19], s47 offen  lds
 s_add_u32 m0, s72, 33792
 s_nop 0
 buffer_load_dwordx4 v57, s[16:19], s47 offen  lds
 ds_read_b64_tr_b16 v[152:153], v17 offset:40960
 ds_read_b64_tr_b16 v[154:155], v17 offset:41216
 ds_read_b64_tr_b16 v[156:157], v17 offset:45056
 ds_read_b64_tr_b16 v[158:159], v17 offset:45312
 s_waitcnt vmcnt(19)
 s_waitcnt lgkmcnt(0)
 s_barrier
 s_add_u32 m0, s72, 40960
 s_add_u32 s47, s70, 1310848
 buffer_load_dwordx4 v56, s[16:19], s47 offen  lds
 s_add_u32 m0, s72, 41984
 s_nop 0
 buffer_load_dwordx4 v57, s[16:19], s47 offen  lds
 ds_read_b64_tr_b16 v[160:161], v17 offset:49152
 ds_read_b64_tr_b16 v[162:163], v17 offset:49408
 ds_read_b64_tr_b16 v[164:165], v17 offset:53248
 ds_read_b64_tr_b16 v[166:167], v17 offset:53504
 s_waitcnt vmcnt(19)
 s_waitcnt lgkmcnt(0)
 s_barrier
 s_add_u32 m0, s72, 49152
 s_add_u32 s47, s70, 2097152
 buffer_load_dwordx4 v56, s[8:11], s47 offen  lds
 s_add_u32 m0, s72, 50176
 s_nop 0
 buffer_load_dwordx4 v57, s[8:11], s47 offen  lds
 ds_read_b64_tr_b16 v[168:169], v17 offset:57344
 ds_read_b64_tr_b16 v[170:171], v17 offset:57600
 ds_read_b64_tr_b16 v[172:173], v17 offset:61440
 ds_read_b64_tr_b16 v[174:175], v17 offset:61696
 s_waitcnt vmcnt(14)
 s_waitcnt lgkmcnt(0)
 s_barrier
 s_add_u32 m0, s72, 57344
 s_add_u32 s47, s70, 2097280
 buffer_load_dwordx4 v56, s[8:11], s47 offen  lds
 s_add_u32 m0, s72, 58368
 s_nop 0
 buffer_load_dwordx4 v57, s[8:11], s47 offen  lds
 ds_read_b64_tr_b16 v[176:177], v18 offset:0
 ds_read_b64_tr_b16 v[178:179], v18 offset:256
 ds_read_b64_tr_b16 v[180:181], v18 offset:4096
 ds_read_b64_tr_b16 v[182:183], v18 offset:4352
 s_waitcnt vmcnt(14)
 s_waitcnt lgkmcnt(0)
 s_barrier
 s_add_u32 m0, s72, 65536
 s_add_u32 s47, s70, 2097152
 buffer_load_dwordx4 v56, s[12:15], s47 offen  lds
 s_add_u32 m0, s72, 66560
 s_nop 0
 buffer_load_dwordx4 v57, s[12:15], s47 offen  lds
 v_mov_b32 v68, 0x05040100
 v_mov_b32 v69, 0x07060302
 v_cndmask_b32 v70, v68, v69, s[48:49]
 v_perm_b32 v20, v24, v20, v70
 v_perm_b32 v21, v25, v21, v70
 v_perm_b32 v22, v26, v22, v70
 v_perm_b32 v23, v27, v23, v70
 v_perm_b32 v28, v32, v28, v70
 v_perm_b32 v29, v33, v29, v70
 v_perm_b32 v30, v34, v30, v70
 v_perm_b32 v31, v35, v31, v70
 v_perm_b32 v24, v37, v36, v68
 v_perm_b32 v25, v39, v38, v68
 v_perm_b32 v26, v37, v36, v69
 v_perm_b32 v27, v39, v38, v69
 ds_write_b128 v60, v[20:23]
 ds_write_b128 v60, v[28:31] offset:4096
 ds_write_b128 v3, v[24:27] offset:8192
 ds_read_b64_tr_b16 v[184:185], v18 offset:8192
 ds_read_b64_tr_b16 v[186:187], v18 offset:8448
 ds_read_b64_tr_b16 v[188:189], v18 offset:12288
 ds_read_b64_tr_b16 v[190:191], v18 offset:12544
 s_waitcnt vmcnt(14)
 s_waitcnt lgkmcnt(0)
 s_barrier
 s_add_u32 m0, s72, 73728
 s_add_u32 s47, s70, 2097152
 buffer_load_dwordx4 v56, s[16:19], s47 offen  lds
 s_add_u32 m0, s72, 74752
 s_nop 0
 buffer_load_dwordx4 v57, s[16:19], s47 offen  lds
 ds_read_b64_tr_b16 v[192:193], v18 offset:16384
 ds_read_b64_tr_b16 v[194:195], v18 offset:16640
 ds_read_b64_tr_b16 v[196:197], v18 offset:20480
 ds_read_b64_tr_b16 v[198:199], v18 offset:20736
 s_waitcnt vmcnt(14)
 s_waitcnt lgkmcnt(0)
 s_barrier
 s_add_u32 m0, s72, 81920
 s_add_u32 s47, s70, 2097280
 buffer_load_dwordx4 v56, s[16:19], s47 offen  lds
 s_add_u32 m0, s72, 82944
 s_nop 0
 buffer_load_dwordx4 v57, s[16:19], s47 offen  lds
 ds_read_b64_tr_b16 v[200:201], v18 offset:24576
 ds_read_b64_tr_b16 v[202:203], v18 offset:24832
 ds_read_b64_tr_b16 v[204:205], v18 offset:28672
 ds_read_b64_tr_b16 v[206:207], v18 offset:28928
 s_waitcnt vmcnt(14)
 s_waitcnt lgkmcnt(0)
 s_barrier
 s_add_u32 m0, s72, 90112
 s_add_u32 s47, s70, 2359296
 buffer_load_dwordx4 v56, s[8:11], s47 offen  lds
 s_add_u32 m0, s72, 91136
 s_nop 0
 buffer_load_dwordx4 v57, s[8:11], s47 offen  lds
 ds_read_b64_tr_b16 v[208:209], v16 offset:24576
 ds_read_b64_tr_b16 v[210:211], v16 offset:24832
 ds_read_b64_tr_b16 v[212:213], v16 offset:28672
 ds_read_b64_tr_b16 v[214:215], v16 offset:28928
 s_waitcnt vmcnt(14)
 s_waitcnt lgkmcnt(0)
 s_barrier
 s_add_u32 m0, s72, 98304
 s_add_u32 s47, s70, 2359424
 buffer_load_dwordx4 v56, s[8:11], s47 offen  lds
 s_add_u32 m0, s72, 99328
 s_nop 0
 buffer_load_dwordx4 v57, s[8:11], s47 offen  lds
 ds_read_b64_tr_b16 v[216:217], v16 offset:32768
 ds_read_b64_tr_b16 v[218:219], v16 offset:33024
 ds_read_b64_tr_b16 v[220:221], v16 offset:36864
 ds_read_b64_tr_b16 v[222:223], v16 offset:37120
 s_waitcnt vmcnt(14)
 s_waitcnt lgkmcnt(0)
 s_barrier
 s_add_u32 m0, s72, 106496
 s_add_u32 s47, s70, 2359296
 buffer_load_dwordx4 v56, s[12:15], s47 offen  lds
 s_add_u32 m0, s72, 107520
 s_nop 0
 buffer_load_dwordx4 v57, s[12:15], s47 offen  lds
 ds_read_b64_tr_b16 v[224:225], v16 offset:40960
 ds_read_b64_tr_b16 v[226:227], v16 offset:41216
 ds_read_b64_tr_b16 v[228:229], v16 offset:45056
 ds_read_b64_tr_b16 v[230:231], v16 offset:45312
 s_waitcnt vmcnt(14)
 s_waitcnt lgkmcnt(0)
 s_barrier
 s_add_u32 m0, s72, 114688
 s_add_u32 s47, s70, 2359296
 buffer_load_dwordx4 v56, s[16:19], s47 offen  lds
 s_add_u32 m0, s72, 115712
 s_nop 0
 buffer_load_dwordx4 v57, s[16:19], s47 offen  lds
 ds_read_b64_tr_b16 v[232:233], v16 offset:49152
 ds_read_b64_tr_b16 v[234:235], v16 offset:49408
 ds_read_b64_tr_b16 v[236:237], v16 offset:53248
 ds_read_b64_tr_b16 v[238:239], v16 offset:53504
 s_waitcnt vmcnt(14)
 s_waitcnt lgkmcnt(0)
 s_barrier
 s_add_u32 m0, s72, 122880
 s_add_u32 s47, s70, 2359424
 buffer_load_dwordx4 v56, s[16:19], s47 offen  lds
 s_add_u32 m0, s72, 123904
 s_nop 0
 buffer_load_dwordx4 v57, s[16:19], s47 offen  lds
 ds_read_b64_tr_b16 v[240:241], v16 offset:57344
 ds_read_b64_tr_b16 v[242:243], v16 offset:57600
 ds_read_b64_tr_b16 v[244:245], v16 offset:61440
 ds_read_b64_tr_b16 v[246:247], v16 offset:61696
 s_waitcnt vmcnt(14)
 s_waitcnt lgkmcnt(0)
 s_barrier
 s_add_u32 m0, s72, 131072
 s_add_u32 s47, s70, 3145728
 buffer_load_dwordx4 v56, s[8:11], s47 offen  lds
 s_add_u32 m0, s72, 132096
 s_nop 0
 buffer_load_dwordx4 v57, s[8:11], s47 offen  lds
 ds_read_b64_tr_b16 v[248:249], v17 offset:0
 ds_read_b64_tr_b16 v[250:251], v17 offset:256
 ds_read_b64_tr_b16 v[252:253], v17 offset:4096
 ds_read_b64_tr_b16 v[254:255], v17 offset:4352
 s_waitcnt vmcnt(14)
 s_waitcnt lgkmcnt(0)
 s_barrier
 s_add_u32 m0, s72, 139264
 s_add_u32 s47, s70, 3145856
 buffer_load_dwordx4 v56, s[8:11], s47 offen  lds
 s_add_u32 m0, s72, 140288
 s_nop 0
 buffer_load_dwordx4 v57, s[8:11], s47 offen  lds
 ds_read_b64_tr_b16 a[0:1], v17 offset:8192
 ds_read_b64_tr_b16 a[2:3], v17 offset:8448
 ds_read_b64_tr_b16 a[4:5], v17 offset:12288
 ds_read_b64_tr_b16 a[6:7], v17 offset:12544
 s_waitcnt vmcnt(14)
 s_waitcnt lgkmcnt(0)
 s_barrier
 s_add_u32 m0, s72, 147456
 s_add_u32 s47, s70, 3145728
 buffer_load_dwordx4 v56, s[12:15], s47 offen  lds
 s_add_u32 m0, s72, 148480
 s_nop 0
 buffer_load_dwordx4 v57, s[12:15], s47 offen  lds
 ds_read_b64_tr_b16 a[8:9], v17 offset:16384
 ds_read_b64_tr_b16 a[10:11], v17 offset:16640
 ds_read_b64_tr_b16 a[12:13], v17 offset:20480
 ds_read_b64_tr_b16 a[14:15], v17 offset:20736
 s_waitcnt vmcnt(14)
 s_waitcnt lgkmcnt(0)
 s_barrier
 s_add_u32 m0, s72, 155648
 s_add_u32 s47, s70, 3145728
 buffer_load_dwordx4 v56, s[16:19], s47 offen  lds
 s_add_u32 m0, s72, 156672
 s_nop 0
 buffer_load_dwordx4 v57, s[16:19], s47 offen  lds
 ds_read_b64_tr_b16 a[16:17], v17 offset:24576
 ds_read_b64_tr_b16 a[18:19], v17 offset:24832
 ds_read_b64_tr_b16 a[20:21], v17 offset:28672
 ds_read_b64_tr_b16 a[22:23], v17 offset:28928
 s_waitcnt vmcnt(14)
 s_waitcnt lgkmcnt(0)
 s_barrier
 s_add_u32 m0, s72, 24576
 s_add_u32 s47, s70, 3145856
 buffer_load_dwordx4 v56, s[16:19], s47 offen  lds
 s_add_u32 m0, s72, 25600
 s_nop 0
 buffer_load_dwordx4 v57, s[16:19], s47 offen  lds
 ds_read_b64_tr_b16 a[24:25], v17 offset:32768
 ds_read_b64_tr_b16 a[26:27], v17 offset:33024
 ds_read_b64_tr_b16 a[28:29], v17 offset:36864
 ds_read_b64_tr_b16 a[30:31], v17 offset:37120
 s_waitcnt vmcnt(14)
 s_waitcnt lgkmcnt(0)
 s_barrier
 s_add_u32 m0, s72, 32768
 s_add_u32 s47, s70, 3407872
 buffer_load_dwordx4 v56, s[8:11], s47 offen  lds
 s_add_u32 m0, s72, 33792
 s_nop 0
 buffer_load_dwordx4 v57, s[8:11], s47 offen  lds
 ds_read_b64_tr_b16 a[32:33], v17 offset:40960
 ds_read_b64_tr_b16 a[34:35], v17 offset:41216
 ds_read_b64_tr_b16 a[36:37], v17 offset:45056
 ds_read_b64_tr_b16 a[38:39], v17 offset:45312
 s_waitcnt vmcnt(14)
 s_waitcnt lgkmcnt(0)
 s_barrier
 s_add_u32 m0, s72, 40960
 s_add_u32 s47, s70, 3408000
 buffer_load_dwordx4 v56, s[8:11], s47 offen  lds
 s_add_u32 m0, s72, 41984
 s_nop 0
 buffer_load_dwordx4 v57, s[8:11], s47 offen  lds
 ds_read_b64_tr_b16 a[40:41], v17 offset:49152
 ds_read_b64_tr_b16 a[42:43], v17 offset:49408
 ds_read_b64_tr_b16 a[44:45], v17 offset:53248
 ds_read_b64_tr_b16 a[46:47], v17 offset:53504
 s_waitcnt vmcnt(14)
 s_waitcnt lgkmcnt(0)
 s_barrier
 s_add_u32 m0, s72, 49152
 s_add_u32 s47, s70, 3407872
 buffer_load_dwordx4 v56, s[12:15], s47 offen  lds
 s_add_u32 m0, s72, 50176
 s_nop 0
 buffer_load_dwordx4 v57, s[12:15], s47 offen  lds
 ds_read_b64_tr_b16 a[48:49], v17 offset:57344
 ds_read_b64_tr_b16 a[50:51], v17 offset:57600
 ds_read_b64_tr_b16 a[52:53], v17 offset:61440
 ds_read_b64_tr_b16 a[54:55], v17 offset:61696
 s_waitcnt vmcnt(14)
 s_waitcnt lgkmcnt(0)
 s_barrier
 s_add_u32 m0, s72, 57344
 s_add_u32 s47, s70, 3407872
 buffer_load_dwordx4 v56, s[16:19], s47 offen  lds
 s_add_u32 m0, s72, 58368
 s_nop 0
 buffer_load_dwordx4 v57, s[16:19], s47 offen  lds
 v_min_u32 v65, 16, v3
 v_lshlrev_b32 v65, 24, v65
 buffer_load_dwordx4 v[68:71], v65, s[28:31], 0 offen sc1
 ds_read_b64_tr_b16 a[56:57], v18 offset:0
 ds_read_b64_tr_b16 a[58:59], v18 offset:256
 ds_read_b64_tr_b16 a[60:61], v18 offset:4096
 ds_read_b64_tr_b16 a[62:63], v18 offset:4352
 s_waitcnt vmcnt(15)
 s_waitcnt lgkmcnt(0)
 s_barrier
 s_add_u32 m0, s72, 65536
 s_add_u32 s47, s70, 3408000
 buffer_load_dwordx4 v56, s[16:19], s47 offen  lds
 s_add_u32 m0, s72, 66560
 s_nop 0
 buffer_load_dwordx4 v57, s[16:19], s47 offen  lds
 ds_read_b64_tr_b16 a[64:65], v18 offset:8192
 ds_read_b64_tr_b16 a[66:67], v18 offset:8448
 ds_read_b64_tr_b16 a[68:69], v18 offset:12288
 ds_read_b64_tr_b16 a[70:71], v18 offset:12544
 s_waitcnt vmcnt(15)
 s_waitcnt lgkmcnt(0)
 s_barrier
 s_add_u32 m0, s72, 73728
 s_add_u32 s47, s70, 4194304
 buffer_load_dwordx4 v12, s[8:11], s47 offen  lds
 s_add_u32 m0, s72, 74752
 s_nop 0
 buffer_load_dwordx4 v13, s[8:11], s47 offen  lds
 ds_read_b64_tr_b16 a[72:73], v18 offset:16384
 ds_read_b64_tr_b16 a[74:75], v18 offset:16640
 ds_read_b64_tr_b16 a[76:77], v18 offset:20480
 ds_read_b64_tr_b16 a[78:79], v18 offset:20736
 s_waitcnt vmcnt(15)
 s_waitcnt lgkmcnt(0)
 s_barrier
 s_add_u32 m0, s72, 81920
 s_add_u32 s47, s70, 4194432
 buffer_load_dwordx4 v12, s[8:11], s47 offen  lds
 s_add_u32 m0, s72, 82944
 s_nop 0
 buffer_load_dwordx4 v13, s[8:11], s47 offen  lds
 ds_read_b64_tr_b16 a[80:81], v18 offset:24576
 ds_read_b64_tr_b16 a[82:83], v18 offset:24832
 ds_read_b64_tr_b16 a[84:85], v18 offset:28672
 ds_read_b64_tr_b16 a[86:87], v18 offset:28928
 s_waitcnt vmcnt(15)
 s_waitcnt lgkmcnt(0)
 s_barrier
 s_add_u32 m0, s72, 90112
 s_add_u32 s47, s70, 4194304
 buffer_load_dwordx4 v12, s[12:15], s47 offen  lds
 s_add_u32 m0, s72, 91136
 s_nop 0
 buffer_load_dwordx4 v13, s[12:15], s47 offen  lds
 ds_read_b64_tr_b16 a[88:89], v16 offset:24576
 ds_read_b64_tr_b16 a[90:91], v16 offset:24832
 ds_read_b64_tr_b16 a[92:93], v16 offset:28672
 ds_read_b64_tr_b16 a[94:95], v16 offset:28928
 s_waitcnt vmcnt(15)
 s_waitcnt lgkmcnt(0)
 s_barrier
 s_add_u32 m0, s72, 98304
 s_add_u32 s47, s70, 4194304
 buffer_load_dwordx4 v12, s[16:19], s47 offen  lds
 s_add_u32 m0, s72, 99328
 s_nop 0
 buffer_load_dwordx4 v13, s[16:19], s47 offen  lds
 ds_read_b64_tr_b16 a[96:97], v16 offset:32768
 ds_read_b64_tr_b16 a[98:99], v16 offset:33024
 ds_read_b64_tr_b16 a[100:101], v16 offset:36864
 ds_read_b64_tr_b16 a[102:103], v16 offset:37120
 s_waitcnt vmcnt(15)
 s_waitcnt lgkmcnt(0)
 s_barrier
 s_add_u32 m0, s72, 106496
 s_add_u32 s47, s70, 4194432
 buffer_load_dwordx4 v12, s[16:19], s47 offen  lds
 s_add_u32 m0, s72, 107520
 s_nop 0
 buffer_load_dwordx4 v13, s[16:19], s47 offen  lds
 ds_read_b64_tr_b16 a[104:105], v16 offset:40960
 ds_read_b64_tr_b16 a[106:107], v16 offset:41216
 ds_read_b64_tr_b16 a[108:109], v16 offset:45056
 ds_read_b64_tr_b16 a[110:111], v16 offset:45312
 s_waitcnt vmcnt(15)
 s_waitcnt lgkmcnt(0)
 s_barrier
 s_add_u32 m0, s72, 114688
 s_add_u32 s47, s71, 0
 buffer_load_dwordx4 v14, s[24:27], s47 offen  lds
 s_add_u32 m0, s72, 115712
 s_nop 0
 buffer_load_dwordx4 v15, s[24:27], s47 offen  lds
 ds_read_b64_tr_b16 a[112:113], v16 offset:49152
 ds_read_b64_tr_b16 a[114:115], v16 offset:49408
 ds_read_b64_tr_b16 a[116:117], v16 offset:53248
 ds_read_b64_tr_b16 a[118:119], v16 offset:53504
 s_waitcnt vmcnt(15)
 s_waitcnt lgkmcnt(0)
 s_barrier
 s_add_u32 m0, s72, 122880
 s_add_u32 s47, s71, 128
 buffer_load_dwordx4 v14, s[24:27], s47 offen  lds
 s_add_u32 m0, s72, 123904
 s_nop 0
 buffer_load_dwordx4 v15, s[24:27], s47 offen  lds
 ds_read_b64_tr_b16 a[120:121], v16 offset:57344
 ds_read_b64_tr_b16 a[122:123], v16 offset:57600
 ds_read_b64_tr_b16 a[124:125], v16 offset:61440
 ds_read_b64_tr_b16 a[126:127], v16 offset:61696
 s_waitcnt vmcnt(14)
 s_waitcnt lgkmcnt(0)
 s_barrier
 s_add_u32 m0, s72, 131072
 s_add_u32 s47, s71, 256
 buffer_load_dwordx4 v14, s[24:27], s47 offen  lds
 s_add_u32 m0, s72, 132096
 s_nop 0
 buffer_load_dwordx4 v15, s[24:27], s47 offen  lds
 ds_read_b64_tr_b16 a[128:129], v17 offset:0
 ds_read_b64_tr_b16 a[130:131], v17 offset:256
 ds_read_b64_tr_b16 a[132:133], v17 offset:4096
 ds_read_b64_tr_b16 a[134:135], v17 offset:4352
 s_waitcnt vmcnt(14)
 s_waitcnt lgkmcnt(0)
 s_barrier
 s_add_u32 m0, s72, 139264
 s_add_u32 s47, s71, 384
 buffer_load_dwordx4 v14, s[24:27], s47 offen  lds
 s_add_u32 m0, s72, 140288
 s_nop 0
 buffer_load_dwordx4 v15, s[24:27], s47 offen  lds
 s_branch Lhsc_41
Lhs_40:
 buffer_load_dwordx4 v[68:71], v65, s[28:31], 0 offen sc1
 s_waitcnt vmcnt(0)
Lhsc_41:
 v_sad_u8 v69, v70, 0, 0
 v_sad_u8 v69, v71, 0, v69
 v_lshrrev_b32 v69, 5, v69
 v_min_u32 v68, v68, v69
 v_cmp_ne_u32 vcc, 0, v68
 s_cbranch_vccnz Lhsok_42
 s_sub_u32 s54, s54, 1
 s_cbranch_scc0 Lhs_40
 s_endpgm
Lhsok_42:
 v_readfirstlane_b32 s74, v70
 v_readfirstlane_b32 s75, v71
 buffer_load_dwordx4 v[20:23], v3, s[20:23], s39 offen offset:0 sc1
 buffer_load_dwordx4 v[20:23], v3, s[20:23], s39 offen offset:1024 sc1
 buffer_load_dwordx4 v[20:23], v3, s[20:23], s40 offen offset:0 sc1
 buffer_load_dwordx4 v[20:23], v3, s[20:23], s40 offen offset:1024 sc1
 v_lshlrev_b32 v67, 6, v0
 ds_read_b64_tr_b16 a[136:137], v17 offset:8192
 ds_read_b64_tr_b16 a[138:139], v17 offset:8448
 ds_read_b64_tr_b16 a[140:141], v17 offset:12288
 ds_read_b64_tr_b16 a[142:143], v17 offset:12544
 s_waitcnt vmcnt(18)
 s_waitcnt lgkmcnt(0)
 s_barrier
 s_add_u32 m0, s72, 147456
 s_add_u32 s47, s71, 512
 buffer_load_dwordx4 v14, s[24:27], s47 offen  lds
 s_add_u32 m0, s72, 148480
 s_nop 0
 buffer_load_dwordx4 v15, s[24:27], s47 offen  lds
 ds_read_b64_tr_b16 a[144:145], v17 offset:16384
 ds_read_b64_tr_b16 a[146:147], v17 offset:16640
 ds_read_b64_tr_b16 a[148:149], v17 offset:20480
 ds_read_b64_tr_b16 a[150:151], v17 offset:20736
 s_waitcnt vmcnt(18)
 s_waitcnt lgkmcnt(0)
 s_barrier
 s_add_u32 m0, s72, 155648
 s_add_u32 s47, s71, 640
 buffer_load_dwordx4 v14, s[24:27], s47 offen  lds
 s_add_u32 m0, s72, 156672
 s_nop 0
 buffer_load_dwordx4 v15, s[24:27], s47 offen  lds
 ds_read_b64_tr_b16 a[152:153], v17 offset:24576
 ds_read_b64_tr_b16 a[154:155], v17 offset:24832
 ds_read_b64_tr_b16 a[156:157], v17 offset:28672
 ds_read_b64_tr_b16 a[158:159], v17 offset:28928
 s_waitcnt vmcnt(18)
 s_waitcnt lgkmcnt(0)
 s_barrier
 s_add_u32 m0, s72, 24576
 s_add_u32 s47, s71, 768
 buffer_load_dwordx4 v14, s[24:27], s47 offen  lds
 s_add_u32 m0, s72, 25600
 s_nop 0
 buffer_load_dwordx4 v15, s[24:27], s47 offen  lds
 ds_read_b64_tr_b16 a[160:161], v17 offset:32768
 ds_read_b64_tr_b16 a[162:163], v17 offset:33024
 ds_read_b64_tr_b16 a[164:165], v17 offset:36864
 ds_read_b64_tr_b16 a[166:167], v17 offset:37120
 s_waitcnt vmcnt(18)
 s_waitcnt lgkmcnt(0)
 s_barrier
 s_add_u32 m0, s72, 32768
 s_add_u32 s47, s71, 896
 buffer_load_dwordx4 v14, s[24:27], s47 offen  lds
 s_add_u32 m0, s72, 33792
 s_nop 0
 buffer_load_dwordx4 v15, s[24:27], s47 offen  lds
 ds_read_b64_tr_b16 a[168:169], v17 offset:40960
 ds_read_b64_tr_b16 a[170:171], v17 offset:41216
 ds_read_b64_tr_b16 a[172:173], v17 offset:45056
 ds_read_b64_tr_b16 a[174:175], v17 offset:45312
 s_waitcnt vmcnt(18)
 s_waitcnt lgkmcnt(0)
 s_barrier
 s_add_u32 m0, s72, 40960
 s_add_u32 s47, s71, 37760
 buffer_load_dwordx4 v14, s[24:27], s47 offen  lds
 s_add_u32 m0, s72, 41984
 s_nop 0
 buffer_load_dwordx4 v15, s[24:27], s47 offen  lds
 ds_read_b64_tr_b16 a[176:177], v17 offset:49152
 ds_read_b64_tr_b16 a[178:179], v17 offset:49408
 ds_read_b64_tr_b16 a[180:181], v17 offset:53248
 ds_read_b64_tr_b16 a[182:183], v17 offset:53504
 s_waitcnt vmcnt(18)
 s_waitcnt lgkmcnt(0)
 s_barrier
 s_add_u32 m0, s72, 49152
 s_add_u32 s47, s71, 1024
 buffer_load_dwordx4 v14, s[24:27], s47 offen  lds
 s_add_u32 m0, s72, 50176
 s_nop 0
 buffer_load_dwordx4 v15, s[24:27], s47 offen  lds
 ds_read_b64_tr_b16 a[184:185], v17 offset:57344
 ds_read_b64_tr_b16 a[186:187], v17 offset:57600
 ds_read_b64_tr_b16 a[188:189], v17 offset:61440
 ds_read_b64_tr_b16 a[190:191], v17 offset:61696
 s_waitcnt vmcnt(18)
 s_waitcnt lgkmcnt(0)
 s_barrier
 s_add_u32 m0, s72, 57344
 s_add_u32 s47, s70, 2097280
 buffer_load_dwordx4 v56, s[12:15], s47 offen  lds
 s_add_u32 m0, s72, 58368
 s_nop 0
 buffer_load_dwordx4 v57, s[12:15], s47 offen  lds
 ds_read_b64_tr_b16 a[192:193], v18 offset:0
 ds_read_b64_tr_b16 a[194:195], v18 offset:256
 ds_read_b64_tr_b16 a[196:197], v18 offset:4096
 ds_read_b64_tr_b16 a[198:199], v18 offset:4352
 s_waitcnt vmcnt(18)
 s_waitcnt lgkmcnt(0)
 s_barrier
 s_add_u32 m0, s72, 65536
 s_add_u32 s47, s70, 2359424
 buffer_load_dwordx4 v56, s[12:15], s47 offen  lds
 s_add_u32 m0, s72, 66560
 s_nop 0
 buffer_load_dwordx4 v57, s[12:15], s47 offen  lds
 s_lshl_b32 s47, s6, 2
 s_add_u32 s47, s47, 0x4000
 v_mov_b32 v64, 1
 buffer_store_dword v64, v66, s[20:23], s47 offen
 ds_read_b64_tr_b16 a[200:201], v18 offset:8192
 ds_read_b64_tr_b16 a[202:203], v18 offset:8448
 ds_read_b64_tr_b16 a[204:205], v18 offset:12288
 ds_read_b64_tr_b16 a[206:207], v18 offset:12544
 s_waitcnt vmcnt(15)
 s_waitcnt lgkmcnt(0)
 s_barrier
 s_add_u32 m0, s72, 73728
 s_add_u32 s47, s70, 3145856
 buffer_load_dwordx4 v56, s[12:15], s47 offen  lds
 s_add_u32 m0, s72, 74752
 s_nop 0
 buffer_load_dwordx4 v57, s[12:15], s47 offen  lds
 ds_read_b64_tr_b16 a[208:209], v18 offset:16384
 ds_read_b64_tr_b16 a[210:211], v18 offset:16640
 ds_read_b64_tr_b16 a[212:213], v18 offset:20480
 ds_read_b64_tr_b16 a[214:215], v18 offset:20736
 s_waitcnt vmcnt(15)
 s_waitcnt lgkmcnt(0)
 s_barrier
 s_add_u32 m0, s72, 81920
 s_add_u32 s47, s70, 3408000
 buffer_load_dwordx4 v56, s[12:15], s47 offen  lds
 s_add_u32 m0, s72, 82944
 s_nop 0
 buffer_load_dwordx4 v57, s[12:15], s47 offen  lds
 ds_read_b64_tr_b16 a[216:217], v18 offset:24576
 ds_read_b64_tr_b16 a[218:219], v18 offset:24832
 ds_read_b64_tr_b16 a[220:221], v18 offset:28672
 ds_read_b64_tr_b16 a[222:223], v18 offset:28928
 s_waitcnt vmcnt(15)
 s_waitcnt lgkmcnt(0)
 s_barrier
 s_add_u32 m0, s72, 90112
 s_add_u32 s47, s70, 4194432
 buffer_load_dwordx4 v12, s[12:15], s47 offen  lds
 s_add_u32 m0, s72, 91136
 s_nop 0
 buffer_load_dwordx4 v13, s[12:15], s47 offen  lds
 ds_read_b64_tr_b16 a[224:225], v16 offset:24576
 ds_read_b64_tr_b16 a[226:227], v16 offset:24832
 ds_read_b64_tr_b16 a[228:229], v16 offset:28672
 ds_read_b64_tr_b16 a[230:231], v16 offset:28928
 s_waitcnt vmcnt(15)
 s_waitcnt lgkmcnt(0)
 s_barrier
 s_add_u32 m0, s72, 98304
 s_add_u32 s47, s71, 37888
 buffer_load_dwordx4 v14, s[24:27], s47 offen  lds
 s_add_u32 m0, s72, 99328
 s_nop 0
 buffer_load_dwordx4 v15, s[24:27], s47 offen  lds
 s_and_b32 s47, s6, 29
 s_cbranch_scc1 Lgt_43
 buffer_store_dword v64, v66, s[28:31], 0 offen offset:128 sc1
Lgt_43:
 ds_read_b64_tr_b16 a[232:233], v16 offset:32768
 ds_read_b64_tr_b16 a[234:235], v16 offset:33024
 ds_read_b64_tr_b16 a[236:237], v16 offset:36864
 ds_read_b64_tr_b16 a[238:239], v16 offset:37120
 s_waitcnt vmcnt(15)
 s_waitcnt lgkmcnt(0)
 s_barrier
 s_add_u32 m0, s72, 106496
 s_add_u32 s47, s71, 36864
 buffer_load_dwordx4 v14, s[24:27], s47 offen  lds
 s_add_u32 m0, s72, 107520
 s_nop 0
 buffer_load_dwordx4 v15, s[24:27], s47 offen  lds
 ds_read_b64_tr_b16 a[240:241], v16 offset:40960
 ds_read_b64_tr_b16 a[242:243], v16 offset:41216
 ds_read_b64_tr_b16 a[244:245], v16 offset:45056
 ds_read_b64_tr_b16 a[246:247], v16 offset:45312
 s_waitcnt vmcnt(15)
 s_waitcnt lgkmcnt(0)
 s_barrier
 s_add_u32 m0, s72, 114688
 s_add_u32 s47, s71, 36992
 buffer_load_dwordx4 v14, s[24:27], s47 offen  lds
 s_add_u32 m0, s72, 115712
 s_nop 0
 buffer_load_dwordx4 v15, s[24:27], s47 offen  lds
 ds_read_b64_tr_b16 a[248:249], v16 offset:49152
 ds_read_b64_tr_b16 a[250:251], v16 offset:49408
 ds_read_b64_tr_b16 a[252:253], v16 offset:53248
 ds_read_b64_tr_b16 a[254:255], v16 offset:53504
 s_waitcnt vmcnt(15)
 s_waitcnt lgkmcnt(0)
 s_barrier
 s_add_u32 m0, s72, 122880
 s_add_u32 s47, s71, 37120
 buffer_load_dwordx4 v14, s[24:27], s47 offen  lds
 s_add_u32 m0, s72, 123904
 s_nop 0
 buffer_load_dwordx4 v15, s[24:27], s47 offen  lds
 v_lshrrev_b32 v68, 2, v3
 s_mov_b32 s47, 0x4000
 buffer_load_dword v68, v68, s[20:23], s47 offen sc1
 ds_read_b64_tr_b16 v[48:49], v16 offset:57344
 ds_read_b64_tr_b16 v[50:51], v16 offset:57600
 ds_read_b64_tr_b16 v[52:53], v16 offset:61440
 ds_read_b64_tr_b16 v[54:55], v16 offset:61696
 s_waitcnt vmcnt(16)
 s_waitcnt lgkmcnt(0)
 s_barrier
 s_add_u32 m0, s72, 131072
 s_add_u32 s47, s71, 37248
 buffer_load_dwordx4 v14, s[24:27], s47 offen  lds
 s_add_u32 m0, s72, 132096
 s_nop 0
 buffer_load_dwordx4 v15, s[24:27], s47 offen  lds
 ds_write_b128 v60, v[48:51] offset:57344
 ds_write_b128 v60, v[52:55] offset:61440
 ds_read_b64_tr_b16 v[40:41], v17 offset:0
 ds_read_b64_tr_b16 v[42:43], v17 offset:256
 ds_read_b64_tr_b16 v[44:45], v17 offset:4096
 ds_read_b64_tr_b16 v[46:47], v17 offset:4352
 s_waitcnt vmcnt(15)
 s_waitcnt lgkmcnt(0)
 s_barrier
 s_add_u32 m0, s72, 139264
 s_add_u32 s47, s71, 37376
 buffer_load_dwordx4 v14, s[24:27], s47 offen  lds
 s_add_u32 m0, s72, 140288
 s_nop 0
 buffer_load_dwordx4 v15, s[24:27], s47 offen  lds
 ds_write_b128 v61, v[40:43] offset:0
 ds_write_b128 v61, v[44:47] offset:4096
 ds_read_b64_tr_b16 v[48:49], v17 offset:8192
 ds_read_b64_tr_b16 v[50:51], v17 offset:8448
 ds_read_b64_tr_b16 v[52:53], v17 offset:12288
 ds_read_b64_tr_b16 v[54:55], v17 offset:12544
 s_waitcnt vmcnt(15)
 s_waitcnt lgkmcnt(0)
 s_barrier
 s_add_u32 m0, s72, 147456
 s_add_u32 s47, s71, 37504
 buffer_load_dwordx4 v14, s[24:27], s47 offen  lds
 s_add_u32 m0, s72, 148480
 s_nop 0
 buffer_load_dwordx4 v15, s[24:27], s47 offen  lds
 ds_write_b128 v61, v[48:51] offset:8192
 ds_write_b128 v61, v[52:55] offset:12288
 ds_read_b64_tr_b16 v[40:41], v17 offset:16384
 ds_read_b64_tr_b16 v[42:43], v17 offset:16640
 ds_read_b64_tr_b16 v[44:45], v17 offset:20480
 ds_read_b64_tr_b16 v[46:47], v17 offset:20736
 s_waitcnt vmcnt(15)
 s_waitcnt lgkmcnt(0)
 s_barrier
 s_add_u32 m0, s72, 155648
 s_add_u32 s47, s71, 37632
 buffer_load_dwordx4 v14, s[24:27], s47 offen  lds
 s_add_u32 m0, s72, 156672
 s_nop 0
 buffer_load_dwordx4 v15, s[24:27], s47 offen  lds
 ds_write_b128 v61, v[40:43] offset:16384
 ds_write_b128 v61, v[44:47] offset:20480
 ds_read_b64_tr_b16 v[48:49], v17 offset:24576
 ds_read_b64_tr_b16 v[50:51], v17 offset:24832
 ds_read_b64_tr_b16 v[52:53], v17 offset:28672
 ds_read_b64_tr_b16 v[54:55], v17 offset:28928
 s_waitcnt vmcnt(15)
 s_waitcnt lgkmcnt(0)
 s_barrier
 s_add_u32 m0, s72, 24576
 s_add_u32 s47, s70, 128
 buffer_load_dwordx4 v56, s[12:15], s47 offen  lds
 s_add_u32 m0, s72, 25600
 s_nop 0
 buffer_load_dwordx4 v57, s[12:15], s47 offen  lds
 ds_write_b128 v61, v[48:51] offset:24576
 ds_write_b128 v61, v[52:55] offset:28672
 ds_read_b64_tr_b16 v[40:41], v17 offset:32768
 ds_read_b64_tr_b16 v[42:43], v17 offset:33024
 ds_read_b64_tr_b16 v[44:45], v17 offset:36864
 ds_read_b64_tr_b16 v[46:47], v17 offset:37120
 s_waitcnt vmcnt(15)
 s_waitcnt lgkmcnt(0)
 s_barrier
 s_add_u32 m0, s72, 32768
 s_add_u32 s47, s70, 262272
 buffer_load_dwordx4 v56, s[12:15], s47 offen  lds
 s_add_u32 m0, s72, 33792
 s_nop 0
 buffer_load_dwordx4 v57, s[12:15], s47 offen  lds
 ds_write_b128 v61, v[40:43] offset:32768
 ds_write_b128 v61, v[44:47] offset:36864
 ds_read_b64_tr_b16 v[48:49], v17 offset:40960
 ds_read_b64_tr_b16 v[50:51], v17 offset:41216
 ds_read_b64_tr_b16 v[52:53], v17 offset:45056
 ds_read_b64_tr_b16 v[54:55], v17 offset:45312
 s_waitcnt vmcnt(15)
 s_waitcnt lgkmcnt(0)
 s_barrier
 s_add_u32 m0, s72, 40960
 s_add_u32 s47, s70, 1048704
 buffer_load_dwordx4 v56, s[12:15], s47 offen  lds
 s_add_u32 m0, s72, 41984
 s_nop 0
 buffer_load_dwordx4 v57, s[12:15], s47 offen  lds
 ds_write_b128 v61, v[48:51] offset:40960
 ds_write_b128 v61, v[52:55] offset:45056
 ds_read_b64_tr_b16 v[40:41], v17 offset:49152
 ds_read_b64_tr_b16 v[42:43], v17 offset:49408
 ds_read_b64_tr_b16 v[44:45], v17 offset:53248
 ds_read_b64_tr_b16 v[46:47], v17 offset:53504
 s_waitcnt vmcnt(15)
 s_waitcnt lgkmcnt(0)
 s_barrier
 s_add_u32 m0, s72, 49152
 s_add_u32 s47, s70, 1310848
 buffer_load_dwordx4 v56, s[12:15], s47 offen  lds
 s_add_u32 m0, s72, 50176
 s_nop 0
 buffer_load_dwordx4 v57, s[12:15], s47 offen  lds
 buffer_load_dword v1, v65, s[20:23], s56 offen sc1
 ds_write_b128 v61, v[40:43] offset:49152
 ds_write_b128 v61, v[44:47] offset:53248
 ds_read_b64_tr_b16 v[48:49], v17 offset:57344
 ds_read_b64_tr_b16 v[50:51], v17 offset:57600
 ds_read_b64_tr_b16 v[52:53], v17 offset:61440
 ds_read_b64_tr_b16 v[54:55], v17 offset:61696
 s_waitcnt vmcnt(15)
 s_waitcnt lgkmcnt(0)
 s_barrier
 v_cmp_ne_u32 vcc, 0, v68
 s_mov_b32 s77, vcc_lo
 s_add_u32 s58, s6, 1
 s_and_b32 s58, s58, 31
 s_bitcmp1_b32 s77, s58
 s_cbranch_scc1 Lhlp_44
 s_lshl_b32 s76, s58, 8
 s_mul_i32 s80, s58, 147456
 s_add_u32 s47, s76, 3145856
 buffer_load_dword v63, v19, s[12:15], s47 offen
 s_add_u32 s47, s80, 37888
 buffer_load_dword v63, v59, s[24:27], s47 offen
 s_add_u32 s47, s80, 37120
 buffer_load_dword v63, v59, s[24:27], s47 offen
 s_add_u32 s47, s80, 37504
 buffer_load_dword v63, v59, s[24:27], s47 offen
 s_add_u32 s47, s76, 262272
 buffer_load_dword v63, v19, s[12:15], s47 offen
Lhlp_44:
 s_add_u32 s58, s6, 2
 s_and_b32 s58, s58, 31
 s_bitcmp1_b32 s77, s58
 s_cbranch_scc1 Lhlp_45
 s_lshl_b32 s76, s58, 8
 s_mul_i32 s80, s58, 147456
 s_add_u32 s47, s76, 3408000
 buffer_load_dword v63, v19, s[12:15], s47 offen
 s_add_u32 s47, s80, 36864
 buffer_load_dword v63, v59, s[24:27], s47 offen
 s_add_u32 s47, s80, 37248
 buffer_load_dword v63, v59, s[24:27], s47 offen
 s_add_u32 s47, s80, 37632
 buffer_load_dword v63, v59, s[24:27], s47 offen
 s_add_u32 s47, s76, 1048704
 buffer_load_dword v63, v19, s[12:15], s47 offen
Lhlp_45:
 s_add_u32 s58, s6, 3
 s_and_b32 s58, s58, 31
 s_bitcmp1_b32 s77, s58
 s_cbranch_scc1 Lhlp_46
 s_lshl_b32 s76, s58, 8
 s_mul_i32 s80, s58, 147456
 s_add_u32 s47, s76, 4194432
 buffer_load_dword v63, v58, s[12:15], s47 offen
 s_add_u32 s47, s80, 36992
 buffer_load_dword v63, v59, s[24:27], s47 offen
 s_add_u32 s47, s80, 37376
 buffer_load_dword v63, v59, s[24:27], s47 offen
 s_add_u32 s47, s76, 128
 buffer_load_dword v63, v19, s[12:15], s47 offen
 s_add_u32 s47, s76, 1310848
 buffer_load_dword v63, v19, s[12:15], s47 offen
Lhlp_46:
 ds_write_b128 v61, v[48:51] offset:57344
 ds_write_b128 v61, v[52:55] offset:61440
 ds_read_b64_tr_b16 v[40:41], v18 offset:0
 ds_read_b64_tr_b16 v[42:43], v18 offset:256
 ds_read_b64_tr_b16 v[44:45], v18 offset:4096
 ds_read_b64_tr_b16 v[46:47], v18 offset:4352
 s_waitcnt vmcnt(13)
 s_waitcnt lgkmcnt(0)
 s_barrier
 ds_write_b128 v62, v[40:43] offset:0
 ds_write_b128 v62, v[44:47] offset:4096
 ds_read_b64_tr_b16 v[48:49], v18 offset:8192
 ds_read_b64_tr_b16 v[50:51], v18 offset:8448
 ds_read_b64_tr_b16 v[52:53], v18 offset:12288
 ds_read_b64_tr_b16 v[54:55], v18 offset:12544
 s_waitcnt vmcnt(11)
 s_waitcnt lgkmcnt(0)
 s_barrier
 ds_write_b128 v62, v[48:51] offset:8192
 ds_write_b128 v62, v[52:55] offset:12288
 ds_read_b64_tr_b16 v[40:41], v18 offset:16384
 ds_read_b64_tr_b16 v[42:43], v18 offset:16640
 ds_read_b64_tr_b16 v[44:45], v18 offset:20480
 ds_read_b64_tr_b16 v[46:47], v18 offset:20736
 s_waitcnt vmcnt(9)
 s_waitcnt lgkmcnt(0)
 s_barrier
 ds_write_b128 v62, v[40:43] offset:16384
 ds_write_b128 v62, v[44:47] offset:20480
 ds_read_b64_tr_b16 v[48:49], v18 offset:24576
 ds_read_b64_tr_b16 v[50:51], v18 offset:24832
 ds_read_b64_tr_b16 v[52:53], v18 offset:28672
 ds_read_b64_tr_b16 v[54:55], v18 offset:28928
 s_waitcnt vmcnt(7)
 s_waitcnt lgkmcnt(0)
 s_barrier
 ds_write_b128 v62, v[48:51] offset:24576
 ds_write_b128 v62, v[52:55] offset:28672
 ds_read_b64_tr_b16 v[40:41], v16 offset:24576
 ds_read_b64_tr_b16 v[42:43], v16 offset:24832
 ds_read_b64_tr_b16 v[44:45], v16 offset:28672
 ds_read_b64_tr_b16 v[46:47], v16 offset:28928
 s_waitcnt vmcnt(5)
 s_waitcnt lgkmcnt(0)
 s_barrier
 ds_write_b128 v60, v[40:43] offset:24576
 ds_write_b128 v60, v[44:47] offset:28672
 ds_read_b64_tr_b16 v[48:49], v16 offset:32768
 ds_read_b64_tr_b16 v[50:51], v16 offset:33024
 ds_read_b64_tr_b16 v[52:53], v16 offset:36864
 ds_read_b64_tr_b16 v[54:55], v16 offset:37120
 s_waitcnt vmcnt(3)
 s_waitcnt lgkmcnt(0)
 s_barrier
 ds_write_b128 v60, v[48:51] offset:32768
 ds_write_b128 v60, v[52:55] offset:36864
 ds_read_b64_tr_b16 v[40:41], v16 offset:40960
 ds_read_b64_tr_b16 v[42:43], v16 offset:41216
 ds_read_b64_tr_b16 v[44:45], v16 offset:45056
 ds_read_b64_tr_b16 v[46:47], v16 offset:45312
 s_waitcnt vmcnt(1)
 s_waitcnt lgkmcnt(0)
 s_barrier
 ds_write_b128 v60, v[40:43] offset:40960
 ds_write_b128 v60, v[44:47] offset:45056
 ds_read_b64_tr_b16 v[48:49], v16 offset:49152
 ds_read_b64_tr_b16 v[50:51], v16 offset:49408
 ds_read_b64_tr_b16 v[52:53], v16 offset:53248
 ds_read_b64_tr_b16 v[54:55], v16 offset:53504
 s_waitcnt lgkmcnt(0)
 s_barrier
 ds_write_b128 v60, v[48:51] offset:49152
 ds_write_b128 v60, v[52:55] offset:53248
 v_lshlrev_b32 v0, 4, v0
 s_waitcnt vmcnt(0)
 v_cmp_le_u32 vcc, 2, v1
 s_cbranch_vccnz Lpbk_47
Lpb0_48:
 buffer_load_dword v1, v7, s[20:23], s56 offen sc1
 s_waitcnt vmcnt(0)
 v_cmp_le_u32 vcc, 2, v1
 s_cbranch_vccnz Lpb0ok_49
 s_sub_u32 s54, s54, 1
 s_cbranch_scc0 Lpb0_48
 s_endpgm
Lpb0ok_49:
Lpbk_47:
 s_lshl_b32 s47, s4, 11
 s_add_u32 m0, s47, 9216
 s_add_u32 s68, s37, 0x80000
 buffer_load_dwordx4 v3, s[20:23], s67 offen offset:0 sc1 lds
 buffer_load_dwordx4 v3, s[20:23], s67 offen offset:1024 sc1 lds
 buffer_load_dword v68, v67, s[20:23], s37 offen sc1
 buffer_load_dword v68, v67, s[20:23], s68 offen sc1
 s_add_u32 s68, s68, 0x80000
 s_mov_b32 s24, 0xf000f
 s_mov_b32 s25, 0xf000f
 s_mov_b32 s26, 0xf000f0
 s_mov_b32 s27, 0xf000f0
 s_mov_b32 s28, 0xf000f00
 s_mov_b32 s29, 0xf000f00
 s_mov_b32 s30, 0xf000f000
 s_mov_b32 s31, 0xf000f000
 s_mov_b32 s32, 0xaaaaaaaa
 s_mov_b32 s33, 0xaaaaaaaa
 s_mov_b32 s34, 0x3f803f80
 s_mov_b32 s35, 0x3f803f80
 s_mov_b32 s70, -1
 s_mov_b32 s71, 0
 s_lshl_b32 s47, s4, 12
 s_add_u32 s68, s68, s47
 v_mov_b32 v2, 0
 v_mov_b32 v4, 0
 s_waitcnt lgkmcnt(0)
 ds_read_b128 v[20:23], v0 offset:24576
 ds_read_b128 v[24:27], v0 offset:28672
 ds_read_b128 v[28:31], v0 offset:32768
 ds_read_b128 v[32:35], v0 offset:36864
 v_mov_b64 v[36:37], 0
 v_mov_b64 v[38:39], 0
 v_mov_b64 v[40:41], 0
 v_mov_b64 v[42:43], 0
 v_mov_b64 v[44:45], 0
 v_mov_b64 v[46:47], 0
 v_mov_b64 v[48:49], 0
 v_mov_b64 v[50:51], 0
 v_lshl_add_u32 v1, v3, 3, s68
 v_mov_b32 v6, s56
 v_cndmask_b32 v1, v6, v1, s[70:71]
 v_min_u32 v6, 16, v0
 v_lshlrev_b32 v6, 24, v6
 s_max_u32 s47, s36, 1
 v_add_u32 v2, -1, s47
 s_xor_b32 s44, s44, 0x80000
 s_xor_b32 s45, s45, 0x80000
 s_xor_b32 s65, s65, 0x80000
 s_xor_b32 s66, s66, 0x80000
 s_xor_b32 s41, s41, 0x80000
 s_xor_b32 s43, s43, 0x80000
 s_lshr_b64 s[74:75], s[74:75], s73
 s_and_b32 s74, s74, 0xff
 s_cmp_eq_u32 s74, 32
 s_waitcnt vmcnt(2)
 s_cbranch_scc0 Lslow_50
 .p2align 3
Lstep_52:
 s_mov_b64 exec, -1
 s_waitcnt lgkmcnt(0)
 buffer_load_dwordx4 v[12:15], v3, s[20:23], s59 offen offset:0 sc1
 buffer_load_dwordx4 v[16:19], v3, s[20:23], s59 offen offset:1024 sc1
 s_barrier
 ds_read_b128 v[52:55], v3 offset:0
 ds_read_b128 v[56:59], v3 offset:1024
 ds_read_b128 v[60:63], v3 offset:2048
 buffer_store_dwordx4 v[64:67], v0, s[20:23], s38 offen sc1
 s_waitcnt lgkmcnt(2)
 v_smfmac_f32_16x16x64_bf16 v[36:39], v[52:55], v[72:79], v5
 v_smfmac_f32_16x16x64_bf16 v[40:43], v[52:55], v[80:87], v5
 buffer_load_dword v1, v1, s[20:23], 0 offen sc1
 v_smfmac_f32_16x16x64_bf16 v[44:47], v[52:55], v[88:95], v5
 s_waitcnt lgkmcnt(1)
 v_smfmac_f32_16x16x64_bf16 v[48:51], v[52:55], v[20:27], v5
 buffer_store_dword v2, v6, s[20:23], s57 offen sc1
 v_smfmac_f32_16x16x64_bf16 v[36:39], v[56:59], v[112:119], v5
 ds_read_b128 v[20:23], v0 offset:40960
 v_mov_b64 v[64:65], 0
 v_smfmac_f32_16x16x64_bf16 v[40:43], v[56:59], v[120:127], v5
 ds_read_b128 v[24:27], v0 offset:45056
 v_mov_b64 v[66:67], 0
 v_smfmac_f32_16x16x64_bf16 v[44:47], v[56:59], v[128:135], v5
 ds_read_b128 v[52:55], v3 offset:3072
 s_waitcnt lgkmcnt(3)
 v_smfmac_f32_16x16x64_bf16 v[48:51], v[56:59], v[28:35], v5
 s_waitcnt vmcnt(5)
 v_smfmac_f32_16x16x64_bf16 v[36:39], v[60:63], v[152:159], v5
 ds_read_b128 v[28:31], v0 offset:49152
 v_mov_b64 v[68:69], 0
 v_smfmac_f32_16x16x64_bf16 v[40:43], v[60:63], v[160:167], v5
 ds_read_b128 v[32:35], v0 offset:53248
 v_mov_b64 v[70:71], 0
 v_smfmac_f32_16x16x64_bf16 v[44:47], v[60:63], v[168:175], v5
 ds_read_b128 v[56:59], v3 offset:4096
 s_waitcnt lgkmcnt(3)
 v_smfmac_f32_16x16x64_bf16 v[48:51], v[60:63], v[20:27], v5
 v_smfmac_f32_16x16x64_bf16 v[36:39], v[52:55], v[192:199], v5
 ds_read_b128 v[20:23], v0 offset:57344
 v_smfmac_f32_16x16x64_bf16 v[40:43], v[52:55], v[200:207], v5
 ds_read_b128 v[24:27], v0 offset:61440
 v_smfmac_f32_16x16x64_bf16 v[44:47], v[52:55], v[208:215], v5
 ds_read_b128 v[60:63], v3 offset:5120
 v_smfmac_f32_16x16x64_bf16 v[64:67], v[52:55], v[216:223], v5
 v_smfmac_f32_16x16x64_bf16 v[68:71], v[52:55], v[224:231], v5
 s_waitcnt lgkmcnt(3)
 v_add_u32 v0, 0x10000, v0
 v_smfmac_f32_16x16x64_bf16 v[48:51], v[52:55], v[28:35], v5
 v_smfmac_f32_16x16x64_bf16 v[36:39], v[56:59], v[232:239], v5
 ds_read_b128 v[28:31], v0 offset:0
 v_smfmac_f32_16x16x64_bf16 v[40:43], v[56:59], v[240:247], v5
 ds_read_b128 v[32:35], v0 offset:4096
 v_smfmac_f32_16x16x64_bf16 v[44:47], v[56:59], v[248:255], v5
 ds_read_b128 v[52:55], v3 offset:6144
 v_smfmac_f32_16x16x64_bf16 v[64:67], v[56:59], a[0:7], v5
 v_smfmac_f32_16x16x64_bf16 v[68:71], v[56:59], a[8:15], v5
 s_waitcnt lgkmcnt(3)
 v_smfmac_f32_16x16x64_bf16 v[48:51], v[56:59], v[20:27], v5
 v_smfmac_f32_16x16x64_bf16 v[36:39], v[60:63], a[16:23], v5
 ds_read_b128 v[20:23], v0 offset:8192
 v_smfmac_f32_16x16x64_bf16 v[40:43], v[60:63], a[24:31], v5
 ds_read_b128 v[24:27], v0 offset:12288
 v_smfmac_f32_16x16x64_bf16 v[44:47], v[60:63], a[32:39], v5
 ds_read_b128 v[56:59], v3 offset:7168
 v_smfmac_f32_16x16x64_bf16 v[64:67], v[60:63], a[40:47], v5
 v_smfmac_f32_16x16x64_bf16 v[68:71], v[60:63], a[48:55], v5
 s_waitcnt lgkmcnt(3)
 v_smfmac_f32_16x16x64_bf16 v[48:51], v[60:63], v[28:35], v5
 v_smfmac_f32_16x16x64_bf16 v[36:39], v[52:55], a[56:63], v5
 ds_read_b128 v[28:31], v0 offset:16384
 v_smfmac_f32_16x16x64_bf16 v[40:43], v[52:55], a[64:71], v5
 ds_read_b128 v[32:35], v0 offset:20480
 v_smfmac_f32_16x16x64_bf16 v[44:47], v[52:55], a[72:79], v5
 ds_read_b128 v[60:63], v3 offset:8192
 s_waitcnt lgkmcnt(3)
 v_smfmac_f32_16x16x64_bf16 v[48:51], v[52:55], v[20:27], v5
 v_smfmac_f32_16x16x64_bf16 v[36:39], v[56:59], a[96:103], v5
 ds_read_b128 v[20:23], v0 offset:24576
 v_smfmac_f32_16x16x64_bf16 v[40:43], v[56:59], a[104:111], v5
 ds_read_b128 v[24:27], v0 offset:28672
 s_waitcnt lgkmcnt(2)
 v_smfmac_f32_16x16x64_bf16 v[36:39], v[60:63], a[136:143], v5
 v_smfmac_f32_16x16x64_bf16 v[40:43], v[60:63], a[144:151], v5
 v_smfmac_f32_16x16x64_bf16 v[64:67], v[52:55], a[80:87], v5
 s_nop 0
 v_add_f32 v36, v36, v38
 v_smfmac_f32_16x16x64_bf16 v[68:71], v[52:55], a[88:95], v5
 ds_read_b128 v[52:55], v3 offset:0
 v_add_f32 v37, v37, v39
 v_smfmac_f32_16x16x64_bf16 v[44:47], v[56:59], a[112:119], v5
 v_add_f32 v40, v40, v42
 v_add_f32 v41, v41, v43
 v_smfmac_f32_16x16x64_bf16 v[48:51], v[56:59], v[28:35], v5
 s_waitcnt lgkmcnt(1)
 v_cvt_pk_bf16_f32 v36, v36, v40
 v_smfmac_f32_16x16x64_bf16 v[44:47], v[60:63], a[152:159], v5
 ds_read_b128 v[32:35], v3 offset:11264
 v_cvt_pk_bf16_f32 v37, v37, v41
 v_smfmac_f32_16x16x64_bf16 v[48:51], v[60:63], v[20:27], v5
 ds_write2_b32 v10, v36, v37 offset0:0 offset1:16
 v_smfmac_f32_16x16x64_bf16 v[64:67], v[56:59], a[120:127], v5
 ds_read_b128 v[20:23], v3 offset:9216
 v_add_f32 v44, v44, v46
 v_add_f32 v45, v45, v47
 v_smfmac_f32_16x16x64_bf16 v[68:71], v[56:59], a[128:135], v5
 s_waitcnt lgkmcnt(3)
 v_add_f32 v48, v48, v50
 v_add_f32 v49, v49, v51
 v_cvt_pk_bf16_f32 v44, v44, v48
 v_cvt_pk_bf16_f32 v45, v45, v49
 ds_write2_b32 v8, v44, v45 offset0:0 offset1:16
 v_smfmac_f32_16x16x64_bf16 v[64:67], v[52:55], v[96:103], v5
 ds_read_b128 v[56:59], v3 offset:1024
 v_mov_b64 v[28:29], 0
 v_smfmac_f32_16x16x64_bf16 v[68:71], v[52:55], v[104:111], v5
 ds_read_b128 v[52:55], v3 offset:2048
 v_mov_b64 v[30:31], 0
 v_smfmac_f32_16x16x64_bf16 v[64:67], v[60:63], a[160:167], v5
 ds_read_b128 v[24:27], v3 offset:10240
 v_smfmac_f32_16x16x64_bf16 v[68:71], v[60:63], a[168:175], v5
 s_waitcnt lgkmcnt(3)
 s_barrier
 ds_read_b128 v[36:39], v11 offset:17408
 s_waitcnt lgkmcnt(3)
 v_smfmac_f32_16x16x64_bf16 v[64:67], v[56:59], v[136:143], v5
 ds_read_b128 v[40:43], v11 offset:17920
 s_waitcnt lgkmcnt(3)
 v_smfmac_f32_16x16x64_bf16 v[68:71], v[56:59], v[144:151], v5
 ds_read_b128 v[60:63], v9 offset:19456
 ds_read_b128 v[44:47], v11 offset:18432
 v_smfmac_f32_16x16x64_bf16 v[64:67], v[52:55], v[176:183], v5
 ds_read_b128 v[48:51], v11 offset:18944
 v_smfmac_f32_16x16x64_bf16 v[68:71], v[52:55], v[184:191], v5
 ds_read_b128 v[52:55], v3 offset:12288
 s_waitcnt lgkmcnt(5)
 v_mfma_f32_16x16x32_bf16 v[20:23], v[20:23], v[36:39], 0
 ds_read_b128 v[56:59], v9 offset:21504
 v_mfma_f32_16x16x32_bf16 v[24:27], v[24:27], v[36:39], 0
 v_add_f32 v64, v64, v66
 v_add_f32 v65, v65, v67
 s_waitcnt lgkmcnt(5)
 v_mfma_f32_16x16x32_bf16 v[20:23], v[32:35], v[40:43], v[20:23]
 ds_read_b128 v[32:35], v3 offset:13312
 v_cvt_pk_bf16_f32 v2, v64, v65
 v_add_f32 v68, v68, v70
 s_waitcnt lgkmcnt(5)
 v_smfmac_f32_16x16x64_bf16 v[28:31], v[60:63], v[36:43], v5
 ds_read_b128 v[60:63], v3 offset:14336
 ds_read_b128 v[36:39], v3 offset:15360
 v_add_f32 v69, v69, v71
 s_waitcnt lgkmcnt(4)
 v_mfma_f32_16x16x32_bf16 v[24:27], v[52:55], v[40:43], v[24:27]
 ds_read_b128 v[52:55], v3 offset:16384
 v_cvt_pk_bf16_f32 v4, v68, v69
 s_waitcnt lgkmcnt(4)
 v_smfmac_f32_16x16x64_bf16 v[28:31], v[56:59], v[44:51], v5
 ds_read_b128 v[40:43], v0 offset:36864
 s_waitcnt lgkmcnt(4)
 v_mfma_f32_16x16x32_bf16 v[20:23], v[32:35], v[44:47], v[20:23]
 v_mov_b64 v[32:33], s[34:35]
 v_mov_b64 v[34:35], s[34:35]
 s_waitcnt lgkmcnt(3)
 v_mfma_f32_16x16x32_bf16 v[24:27], v[60:63], v[44:47], v[24:27]
 ds_read_b128 v[44:47], v0 offset:40960
 v_add_f32 v28, v28, v30
 v_add_f32 v29, v29, v31
 s_waitcnt lgkmcnt(3)
 v_mfma_f32_16x16x32_bf16 v[20:23], v[36:39], v[48:51], v[20:23]
 ds_read_b128 v[36:39], v0 offset:32768
 v_cndmask_b32 v28, v28, v29, s[48:49]
 v_mul_f32 v28, s55, v28
 s_waitcnt lgkmcnt(3)
 v_mfma_f32_16x16x32_bf16 v[24:27], v[52:55], v[48:51], v[24:27]
 ds_read_b128 v[48:51], v0 offset:45056
 v_exp_f32 v28, v28
 v_mov_b64 v[64:65], 0
 v_cndmask_b32 v29, 0, v28, s[48:49]
 v_cndmask_b32 v28, v28, 0, s[48:49]
 v_cvt_pk_bf16_f32 v6, v28, v29
 v_mov_b64 v[66:67], 0
 v_mov_b64 v[68:69], 0
 v_cndmask_b32 v20, v20, v24, s[48:49]
 v_cndmask_b32 v21, v21, v25, s[48:49]
 v_cndmask_b32 v22, v22, v26, s[48:49]
 v_cndmask_b32 v23, v23, v27, s[48:49]
 v_mfma_f32_16x16x16_bf16 v[60:63], v[6:7], v[32:33], 0
 s_waitcnt vmcnt(3)
 v_exp_f32 v20, v20
 v_mfma_f32_16x16x16_bf16 v[52:55], v[6:7], v[2:3], 0
 s_cmp_eq_u32 s36, 63
 v_exp_f32 v21, v21
 v_mfma_f32_16x16x16_bf16 v[56:59], v[6:7], v[4:5], 0
 v_exp_f32 v22, v22
 v_exp_f32 v23, v23
 v_cvt_pk_bf16_f32 v30, v20, v21
 v_cvt_pk_bf16_f32 v31, v22, v23
 v_mov_b64 v[70:71], 0
 v_mov_b64 v[20:21], 0
 v_smfmac_f32_16x16x32_bf16 v[60:63], v[30:31], v[32:35], v5
 v_mov_b64 v[22:23], 0
 v_mov_b64 v[24:25], 0
 v_smfmac_f32_16x16x32_bf16 v[52:55], v[30:31], v[12:15], v5
 v_mov_b64 v[26:27], 0
 v_smfmac_f32_16x16x32_bf16 v[56:59], v[30:31], v[16:19], v5
 s_nop 0
 v_add_f32 v60, v60, v62
 v_add_f32 v61, v61, v63
 v_rcp_f32 v60, v60
 v_rcp_f32 v61, v61
 v_add_f32 v52, v52, v54
 v_add_f32 v53, v53, v55
 v_mul_f32 v52, v52, v60
 v_mul_f32 v53, v53, v61
 v_add_f32 v56, v56, v58
 v_add_f32 v57, v57, v59
 v_mul_f32 v56, v56, v60
 v_mul_f32 v57, v57, v61
 v_cvt_pk_bf16_f32 v52, v52, v56
 v_cvt_pk_bf16_f32 v53, v53, v57
 ds_write2_b32 v8, v52, v53 offset0:128 offset1:144
 v_subrev_u32 v60, 0x21800000, v60
 v_subrev_u32 v61, 0x21800000, v61
 v_max_u32 v60, v60, v61
 v_cmp_lt_u32 vcc, 0x3c000000, v60
 s_cbranch_scc1 Lchexit_51
 v_mov_b64 v[28:29], 0
 v_mov_b64 v[30:31], 0
 v_mov_b64 v[32:33], 0
 v_mov_b64 v[34:35], 0
 s_cbranch_vccnz Lmx_54
Lmxb_55:
 s_waitcnt lgkmcnt(0)
 v_bfe_u32 v6, v0, 7, 5
 s_barrier
 ds_read_b128 v[52:55], v9 offset:19968
 v_mul_u32_u24 v6, 10496, v6
 ds_read_b128 v[56:59], v9 offset:22016
 ds_read_b128 v[12:15], v0 offset:49152
 v_bfe_u32 v60, v3, 4, 3
 ds_read_b128 v[16:19], v0 offset:53248
 s_add_u32 s67, s67, 0x80000
 v_lshl_add_u32 v6, v60, 3, v6
 s_xor_b32 s46, s46, 0x1
 s_add_u32 s59, s59, 0x80000
 v_mov_b64 v[60:61], 0
 s_add_u32 s38, s38, 0x20000
 v_mov_b64 v[62:63], 0
 s_waitcnt lgkmcnt(3)
 v_smfmac_f32_16x16x64_bf16 v[64:67], v[52:55], a[248:255], v5
 buffer_load_dwordx4 v3, s[20:23], s67 offen offset:0 sc1 lds
 v_smfmac_f32_16x16x64_bf16 v[68:71], v[52:55], a[176:183], v5
 s_waitcnt lgkmcnt(2)
 s_cmp_lt_u32 s36, 61
 v_smfmac_f32_16x16x64_bf16 v[64:67], v[56:59], v[36:43], v5
 ds_read_b128 v[36:39], v0 offset:57344
 buffer_load_dwordx4 v3, s[20:23], s67 offen offset:1024 sc1 lds
 v_smfmac_f32_16x16x64_bf16 v[20:23], v[52:55], a[184:191], v5
 ds_read_b128 v[40:43], v0 offset:61440
 s_cselect_b32 s47, 0x80000, 0
 v_add_u32 v0, 0x10000, v0
 v_smfmac_f32_16x16x64_bf16 v[68:71], v[56:59], v[44:51], v5
 ds_read_b128 v[44:47], v0 offset:0
 s_add_u32 s68, s68, s47
 v_add_f32 v64, v64, v66
 v_add_f32 v65, v65, v67
 v_cvt_pk_bf16_f32 v65, v65, v65
 v_smfmac_f32_16x16x64_bf16 v[24:27], v[52:55], a[192:199], v5
 ds_read_b128 v[48:51], v0 offset:4096
 s_waitcnt lgkmcnt(4)
 v_cvt_pk_bf16_f32 v64, v64, v64
 v_and_or_b32 v65, v65, -2, s46
 v_smfmac_f32_16x16x64_bf16 v[20:23], v[56:59], v[12:19], v5
 ds_read_b128 v[12:15], v0 offset:8192
 buffer_store_dwordx2 v[64:65], v6, s[20:23], s62 offen
 v_add_f32 v68, v68, v70
 v_add_f32 v69, v69, v71
 v_smfmac_f32_16x16x64_bf16 v[28:31], v[52:55], a[200:207], v5
 ds_read_b128 v[16:19], v0 offset:12288
 s_waitcnt lgkmcnt(4)
 v_mov_b64 v[64:65], 0
 v_mov_b64 v[66:67], 0
 v_smfmac_f32_16x16x64_bf16 v[24:27], v[56:59], v[36:43], v5
 ds_read_b128 v[36:39], v0 offset:16384
 s_add_u32 s36, s36, 1
 v_add_f32 v20, v20, v22
 v_add_f32 v21, v21, v23
 v_cvt_pk_bf16_f32 v69, v69, v21
 v_smfmac_f32_16x16x64_bf16 v[32:35], v[52:55], a[208:215], v5
 ds_read_b128 v[40:43], v0 offset:20480
 s_waitcnt lgkmcnt(4)
 v_cvt_pk_bf16_f32 v68, v68, v20
 v_and_or_b32 v69, v69, -2, s46
 v_smfmac_f32_16x16x64_bf16 v[28:31], v[56:59], v[44:51], v5
 ds_read_b128 v[44:47], v0 offset:24576
 buffer_store_dwordx2 v[68:69], v6, s[20:23], s60 offen offset:0
 v_add_f32 v24, v24, v26
 v_add_f32 v25, v25, v27
 v_smfmac_f32_16x16x64_bf16 v[60:63], v[52:55], a[216:223], v5
 ds_read_b128 v[48:51], v0 offset:28672
 s_waitcnt lgkmcnt(4)
 v_mov_b64 v[20:21], 0
 v_mov_b64 v[22:23], 0
 v_smfmac_f32_16x16x64_bf16 v[32:35], v[56:59], v[12:19], v5
 s_add_u32 s58, s36, 2
 s_min_u32 s58, s58, 64
 v_add_f32 v28, v28, v30
 v_add_f32 v29, v29, v31
 v_cvt_pk_bf16_f32 v25, v25, v29
 v_smfmac_f32_16x16x64_bf16 v[64:67], v[52:55], a[224:231], v5
 s_waitcnt lgkmcnt(2)
 s_xor_b32 s44, s44, 0x80000
 v_cvt_pk_bf16_f32 v24, v24, v28
 v_and_or_b32 v25, v25, -2, s46
 v_smfmac_f32_16x16x64_bf16 v[60:63], v[56:59], v[36:43], v5
 buffer_store_dwordx2 v[24:25], v6, s[20:23], s60 offen offset:2048
 v_add_f32 v32, v32, v34
 v_smfmac_f32_16x16x64_bf16 v[20:23], v[52:55], a[232:239], v5
 s_waitcnt lgkmcnt(0)
 s_xor_b32 s45, s45, 0x80000
 v_add_f32 v33, v33, v35
 v_smfmac_f32_16x16x64_bf16 v[64:67], v[56:59], v[44:51], v5
 s_xor_b32 s65, s65, 0x80000
 s_xor_b32 s66, s66, 0x80000
 v_add_f32 v60, v60, v62
 v_add_f32 v61, v61, v63
 v_smfmac_f32_16x16x64_bf16 v[20:23], v[56:59], a[240:247], v5
 s_cmp_eq_u32 s4, 0
 v_cvt_pk_bf16_f32 v33, v33, v61
 v_cvt_pk_bf16_f32 v32, v32, v60
 v_and_or_b32 v33, v33, -2, s46
 buffer_store_dwordx2 v[32:33], v6, s[20:23], s61 offen offset:0
 v_add_f32 v64, v64, v66
 v_add_f32 v65, v65, v67
 s_nop 0
 v_add_f32 v20, v20, v22
 v_add_f32 v21, v21, v23
 v_cvt_pk_bf16_f32 v65, v65, v21
 v_cvt_pk_bf16_f32 v64, v64, v20
 v_and_or_b32 v65, v65, -2, s46
 buffer_store_dwordx2 v[64:65], v6, s[20:23], s61 offen offset:2048
 s_cbranch_scc1 LwH_56
 s_cmp_eq_u32 s4, 1
 s_cbranch_scc1 Lw_57
 s_cmp_eq_u32 s4, 2
 s_cbranch_scc1 Lw_58
 s_xor_b32 s41, s41, 0x80000
 s_xor_b32 s43, s43, 0x80000
 v_mov_b32 v47, 0x3f80
 v_cndmask_b32 v47, v47, 1.0, s[32:33]
 v_cndmask_b32 v44, 0, v47, s[24:25]
 v_cndmask_b32 v45, 0, v47, s[26:27]
 v_cndmask_b32 v46, 0, v47, s[28:29]
 v_cndmask_b32 v47, 0, v47, s[30:31]
 v_bfe_u32 v52, v3, 8, 2
 v_bfe_u32 v58, v3, 2, 4
 v_lshl_or_b32 v52, v52, 4, v58
 v_and_b32 v58, 0xc0, v3
 v_lshl_or_b32 v52, v58, 24, v52
 v_subrev_u32 v0, 0x20000, v0
 v_mov_b32 v59, -1
 v_add_u32 v54, s42, v3
 v_add_u32 v58, s69, v9
 ds_read_b64 v[64:65], v58 offset:19456
 v_mov_b32 v66, v2
 v_mov_b32 v67, v4
 ds_read_b128 v[20:23], v0 offset:24576
 ds_read_b128 v[24:27], v0 offset:28672
 ds_read_b128 v[28:31], v0 offset:32768
 ds_read_b128 v[32:35], v0 offset:36864
 s_waitcnt vmcnt(0)
 buffer_load_dwordx4 v[36:39], v3, s[20:23], s39 offen offset:0 sc1
 buffer_load_dwordx4 v[40:43], v3, s[20:23], s39 offen offset:1024 sc1
 s_nop 15
 s_nop 10
 buffer_load_dwordx4 v[12:15], v3, s[20:23], s39 offen offset:0 sc1
 buffer_load_dwordx4 v[16:19], v3, s[20:23], s39 offen offset:1024 sc1
 s_waitcnt vmcnt(3)
 v_mfma_f32_16x16x32_bf16 v[48:51], v[44:47], v[36:39], 0
 s_waitcnt vmcnt(2)
 v_mfma_f32_16x16x32_bf16 v[48:51], v[44:47], v[40:43], v[48:51]
 v_bitop3_b32 v55, v37, v39, s46 bitop3:0x7e
 v_bitop3_b32 v56, v41, v43, s46 bitop3:0x7e
 v_bitop3_b32 v55, v55, 1, v56 bitop3:0xc8
 v_cmp_ne_u32 vcc, 0, v55
 s_nop 3
 v_add_f32_dpp v48, v48, v48 row_ror:4 row_mask:0xf bank_mask:0xf
 v_add_f32_dpp v49, v49, v49 row_ror:4 row_mask:0xf bank_mask:0xf
 s_cbranch_vccnz Lr2_60
 v_add_f32_dpp v48, v48, v48 row_ror:8 row_mask:0xf bank_mask:0xf
 v_add_f32_dpp v49, v49, v49 row_ror:8 row_mask:0xf bank_mask:0xf
 v_cvt_pk_bf16_f32 v48, v48, v49
 buffer_store_dword v48, v52, s[20:23], s44 offen
Lb1_61:
 buffer_store_dword v59, v52, s[20:23], s45 offen
 v_cmp_gt_u32 vcc, s58, v1
 v_mov_b64 v[36:37], 0
 v_mov_b64 v[38:39], 0
 v_mov_b64 v[40:41], 0
 v_mov_b64 v[42:43], 0
 v_mov_b64 v[44:45], 0
 v_mov_b64 v[46:47], 0
 v_mov_b64 v[48:49], 0
 v_mov_b64 v[50:51], 0
 s_cmp_lg_u32 vcc_hi, 0
 s_cbranch_scc1 Lfw_63
Lfok_62:
 v_lshl_add_u32 v1, v3, 3, s68
 v_mov_b32 v6, s56
 v_cndmask_b32 v1, v6, v1, s[70:71]
 v_min_u32 v6, 16, v0
 v_lshlrev_b32 v6, 24, v6
 s_max_u32 s47, s36, 1
 v_add_u32 v2, -1, s47
 s_nop 15
 s_nop 0
 buffer_load_dwordx4 v[12:15], v3, s[20:23], s41 offen offset:0 sc1
 buffer_load_dwordx4 v[16:19], v3, s[20:23], s41 offen offset:1024 sc1
 s_nop 15
 s_nop 7
Lp2_64:
 buffer_load_dwordx4 v[12:15], v3, s[20:23], s41 offen offset:0 sc1
 buffer_load_dwordx4 v[16:19], v3, s[20:23], s41 offen offset:1024 sc1
 s_waitcnt vmcnt(2)
 v_max3_u32 v55, v12, v13, v14
 v_max3_u32 v55, v55, v15, v16
 v_max3_u32 v55, v55, v17, v18
 v_max_u32 v55, v55, v19
 ds_write_b128 v54, v[12:15] offset:0
 ds_write_b128 v54, v[16:19] offset:1024
 v_cmpx_eq_u32 vcc, -1, v55
 s_cbranch_execz Lstep_52
 buffer_load_dwordx4 v[12:15], v3, s[20:23], s41 offen offset:0 sc1
 buffer_load_dwordx4 v[16:19], v3, s[20:23], s41 offen offset:1024 sc1
 s_waitcnt vmcnt(2)
 v_max3_u32 v55, v12, v13, v14
 v_max3_u32 v55, v55, v15, v16
 v_max3_u32 v55, v55, v17, v18
 v_max_u32 v55, v55, v19
 ds_write_b128 v54, v[12:15] offset:0
 ds_write_b128 v54, v[16:19] offset:1024
 v_cmpx_eq_u32 vcc, -1, v55
 s_cbranch_execz Lstep_52
 buffer_load_dwordx4 v[12:15], v3, s[20:23], s41 offen offset:0 sc1
 buffer_load_dwordx4 v[16:19], v3, s[20:23], s41 offen offset:1024 sc1
 s_waitcnt vmcnt(2)
 v_max3_u32 v55, v12, v13, v14
 v_max3_u32 v55, v55, v15, v16
 v_max3_u32 v55, v55, v17, v18
 v_max_u32 v55, v55, v19
 ds_write_b128 v54, v[12:15] offset:0
 ds_write_b128 v54, v[16:19] offset:1024
 v_cmpx_eq_u32 vcc, -1, v55
 s_cbranch_execz Lstep_52
 s_sub_u32 s54, s54, 1
 s_cbranch_scc0 Lp2_64
 s_endpgm
Lw_58:
 s_xor_b32 s41, s41, 0x80000
 s_xor_b32 s43, s43, 0x80000
 v_mov_b32 v47, 0x3f80
 v_cndmask_b32 v47, v47, 1.0, s[32:33]
 v_cndmask_b32 v44, 0, v47, s[24:25]
 v_cndmask_b32 v45, 0, v47, s[26:27]
 v_cndmask_b32 v46, 0, v47, s[28:29]
 v_cndmask_b32 v47, 0, v47, s[30:31]
 v_bfe_u32 v52, v3, 8, 2
 v_bfe_u32 v58, v3, 2, 4
 v_lshl_or_b32 v52, v52, 4, v58
 v_and_b32 v58, 0xc0, v3
 v_lshl_or_b32 v52, v58, 24, v52
 v_subrev_u32 v0, 0x20000, v0
 v_mov_b32 v59, -1
 v_add_u32 v54, s42, v3
 v_add_u32 v58, s69, v9
 ds_read_b64 v[64:65], v58 offset:19456
 v_mov_b32 v66, v2
 v_mov_b32 v67, v4
 ds_read_b128 v[20:23], v0 offset:24576
 ds_read_b128 v[24:27], v0 offset:28672
 ds_read_b128 v[28:31], v0 offset:32768
 ds_read_b128 v[32:35], v0 offset:36864
 s_waitcnt vmcnt(1)
 buffer_load_dwordx4 v[36:39], v3, s[20:23], s39 offen offset:0 sc1
 buffer_load_dwordx4 v[40:43], v3, s[20:23], s39 offen offset:1024 sc1
 s_nop 15
 s_nop 10
 buffer_load_dwordx4 v[12:15], v3, s[20:23], s39 offen offset:0 sc1
 buffer_load_dwordx4 v[16:19], v3, s[20:23], s39 offen offset:1024 sc1
 s_waitcnt vmcnt(3)
 v_mfma_f32_16x16x32_bf16 v[48:51], v[44:47], v[36:39], 0
 s_waitcnt vmcnt(2)
 v_mfma_f32_16x16x32_bf16 v[48:51], v[44:47], v[40:43], v[48:51]
 v_bitop3_b32 v55, v37, v39, s46 bitop3:0x7e
 v_bitop3_b32 v56, v41, v43, s46 bitop3:0x7e
 v_bitop3_b32 v55, v55, 1, v56 bitop3:0xc8
 v_cmp_ne_u32 vcc, 0, v55
 s_nop 3
 v_add_f32_dpp v48, v48, v48 row_ror:4 row_mask:0xf bank_mask:0xf
 v_add_f32_dpp v49, v49, v49 row_ror:4 row_mask:0xf bank_mask:0xf
 s_cbranch_vccnz Lr2_66
 v_add_f32_dpp v48, v48, v48 row_ror:8 row_mask:0xf bank_mask:0xf
 v_add_f32_dpp v49, v49, v49 row_ror:8 row_mask:0xf bank_mask:0xf
 v_cvt_pk_bf16_f32 v48, v48, v49
 buffer_store_dword v48, v52, s[20:23], s44 offen
Lb1_67:
 buffer_store_dword v59, v52, s[20:23], s45 offen
 v_cmp_gt_u32 vcc, s58, v1
 v_mov_b64 v[36:37], 0
 v_mov_b64 v[38:39], 0
 v_mov_b64 v[40:41], 0
 v_mov_b64 v[42:43], 0
 v_mov_b64 v[44:45], 0
 v_mov_b64 v[46:47], 0
 v_mov_b64 v[48:49], 0
 v_mov_b64 v[50:51], 0
 s_cmp_lg_u32 vcc_hi, 0
 s_cbranch_scc1 Lfw_69
Lfok_68:
 v_lshl_add_u32 v1, v3, 3, s68
 v_mov_b32 v6, s56
 v_cndmask_b32 v1, v6, v1, s[70:71]
 v_min_u32 v6, 16, v0
 v_lshlrev_b32 v6, 24, v6
 s_max_u32 s47, s36, 1
 v_add_u32 v2, -1, s47
 s_nop 15
 s_nop 0
 buffer_load_dwordx4 v[12:15], v3, s[20:23], s41 offen offset:0 sc1
 buffer_load_dwordx4 v[16:19], v3, s[20:23], s41 offen offset:1024 sc1
 s_nop 15
 s_nop 7
Lp2_70:
 buffer_load_dwordx4 v[12:15], v3, s[20:23], s41 offen offset:0 sc1
 buffer_load_dwordx4 v[16:19], v3, s[20:23], s41 offen offset:1024 sc1
 s_waitcnt vmcnt(2)
 v_max3_u32 v55, v12, v13, v14
 v_max3_u32 v55, v55, v15, v16
 v_max3_u32 v55, v55, v17, v18
 v_max_u32 v55, v55, v19
 ds_write_b128 v54, v[12:15] offset:0
 ds_write_b128 v54, v[16:19] offset:1024
 v_cmpx_eq_u32 vcc, -1, v55
 s_cbranch_execz Lstep_52
 buffer_load_dwordx4 v[12:15], v3, s[20:23], s41 offen offset:0 sc1
 buffer_load_dwordx4 v[16:19], v3, s[20:23], s41 offen offset:1024 sc1
 s_waitcnt vmcnt(2)
 v_max3_u32 v55, v12, v13, v14
 v_max3_u32 v55, v55, v15, v16
 v_max3_u32 v55, v55, v17, v18
 v_max_u32 v55, v55, v19
 ds_write_b128 v54, v[12:15] offset:0
 ds_write_b128 v54, v[16:19] offset:1024
 v_cmpx_eq_u32 vcc, -1, v55
 s_cbranch_execz Lstep_52
 buffer_load_dwordx4 v[12:15], v3, s[20:23], s41 offen offset:0 sc1
 buffer_load_dwordx4 v[16:19], v3, s[20:23], s41 offen offset:1024 sc1
 s_waitcnt vmcnt(2)
 v_max3_u32 v55, v12, v13, v14
 v_max3_u32 v55, v55, v15, v16
 v_max3_u32 v55, v55, v17, v18
 v_max_u32 v55, v55, v19
 ds_write_b128 v54, v[12:15] offset:0
 ds_write_b128 v54, v[16:19] offset:1024
 v_cmpx_eq_u32 vcc, -1, v55
 s_cbranch_execz Lstep_52
 s_sub_u32 s54, s54, 1
 s_cbranch_scc0 Lp2_70
 s_endpgm
Lw_57:
 s_xor_b32 s41, s41, 0x80000
 s_xor_b32 s43, s43, 0x80000
 v_mov_b32 v47, 0x3f80
 v_cndmask_b32 v47, v47, 1.0, s[32:33]
 v_cndmask_b32 v44, 0, v47, s[24:25]
 v_cndmask_b32 v45, 0, v47, s[26:27]
 v_cndmask_b32 v46, 0, v47, s[28:29]
 v_cndmask_b32 v47, 0, v47, s[30:31]
 v_bfe_u32 v52, v3, 8, 2
 v_bfe_u32 v58, v3, 2, 4
 v_lshl_or_b32 v52, v52, 4, v58
 v_and_b32 v58, 0xc0, v3
 v_lshl_or_b32 v52, v58, 24, v52
 v_subrev_u32 v0, 0x20000, v0
 v_mov_b32 v59, -1
 v_add_u32 v54, s42, v3
 v_add_u32 v58, s69, v9
 ds_read_b64 v[64:65], v58 offset:19456
 v_mov_b32 v66, v2
 v_mov_b32 v67, v4
 ds_read_b128 v[20:23], v0 offset:24576
 ds_read_b128 v[24:27], v0 offset:28672
 ds_read_b128 v[28:31], v0 offset:32768
 ds_read_b128 v[32:35], v0 offset:36864
 s_waitcnt vmcnt(2)
 buffer_load_dwordx4 v[36:39], v3, s[20:23], s39 offen offset:0 sc1
 buffer_load_dwordx4 v[40:43], v3, s[20:23], s39 offen offset:1024 sc1
 s_nop 15
 s_nop 10
 buffer_load_dwordx4 v[12:15], v3, s[20:23], s39 offen offset:0 sc1
 buffer_load_dwordx4 v[16:19], v3, s[20:23], s39 offen offset:1024 sc1
 s_waitcnt vmcnt(3)
 v_mfma_f32_16x16x32_bf16 v[48:51], v[44:47], v[36:39], 0
 s_waitcnt vmcnt(2)
 v_mfma_f32_16x16x32_bf16 v[48:51], v[44:47], v[40:43], v[48:51]
 v_bitop3_b32 v55, v37, v39, s46 bitop3:0x7e
 v_bitop3_b32 v56, v41, v43, s46 bitop3:0x7e
 v_bitop3_b32 v55, v55, 1, v56 bitop3:0xc8
 v_cmp_ne_u32 vcc, 0, v55
 s_nop 3
 v_add_f32_dpp v48, v48, v48 row_ror:4 row_mask:0xf bank_mask:0xf
 v_add_f32_dpp v49, v49, v49 row_ror:4 row_mask:0xf bank_mask:0xf
 s_cbranch_vccnz Lr2_72
 v_add_f32_dpp v48, v48, v48 row_ror:8 row_mask:0xf bank_mask:0xf
 v_add_f32_dpp v49, v49, v49 row_ror:8 row_mask:0xf bank_mask:0xf
 v_cvt_pk_bf16_f32 v48, v48, v49
 buffer_store_dword v48, v52, s[20:23], s44 offen
Lb1_73:
 buffer_store_dword v59, v52, s[20:23], s45 offen
 v_cmp_gt_u32 vcc, s58, v1
 v_mov_b64 v[36:37], 0
 v_mov_b64 v[38:39], 0
 v_mov_b64 v[40:41], 0
 v_mov_b64 v[42:43], 0
 v_mov_b64 v[44:45], 0
 v_mov_b64 v[46:47], 0
 v_mov_b64 v[48:49], 0
 v_mov_b64 v[50:51], 0
 s_cmp_lg_u32 vcc_hi, 0
 s_cbranch_scc1 Lfw_75
Lfok_74:
 v_lshl_add_u32 v1, v3, 3, s68
 v_mov_b32 v6, s56
 v_cndmask_b32 v1, v6, v1, s[70:71]
 v_min_u32 v6, 16, v0
 v_lshlrev_b32 v6, 24, v6
 s_max_u32 s47, s36, 1
 v_add_u32 v2, -1, s47
 s_nop 15
 s_nop 0
 buffer_load_dwordx4 v[12:15], v3, s[20:23], s41 offen offset:0 sc1
 buffer_load_dwordx4 v[16:19], v3, s[20:23], s41 offen offset:1024 sc1
 s_nop 15
 s_nop 7
Lp2_76:
 buffer_load_dwordx4 v[12:15], v3, s[20:23], s41 offen offset:0 sc1
 buffer_load_dwordx4 v[16:19], v3, s[20:23], s41 offen offset:1024 sc1
 s_waitcnt vmcnt(2)
 v_max3_u32 v55, v12, v13, v14
 v_max3_u32 v55, v55, v15, v16
 v_max3_u32 v55, v55, v17, v18
 v_max_u32 v55, v55, v19
 ds_write_b128 v54, v[12:15] offset:0
 ds_write_b128 v54, v[16:19] offset:1024
 v_cmpx_eq_u32 vcc, -1, v55
 s_cbranch_execz Lstep_52
 buffer_load_dwordx4 v[12:15], v3, s[20:23], s41 offen offset:0 sc1
 buffer_load_dwordx4 v[16:19], v3, s[20:23], s41 offen offset:1024 sc1
 s_waitcnt vmcnt(2)
 v_max3_u32 v55, v12, v13, v14
 v_max3_u32 v55, v55, v15, v16
 v_max3_u32 v55, v55, v17, v18
 v_max_u32 v55, v55, v19
 ds_write_b128 v54, v[12:15] offset:0
 ds_write_b128 v54, v[16:19] offset:1024
 v_cmpx_eq_u32 vcc, -1, v55
 s_cbranch_execz Lstep_52
 buffer_load_dwordx4 v[12:15], v3, s[20:23], s41 offen offset:0 sc1
 buffer_load_dwordx4 v[16:19], v3, s[20:23], s41 offen offset:1024 sc1
 s_waitcnt vmcnt(2)
 v_max3_u32 v55, v12, v13, v14
 v_max3_u32 v55, v55, v15, v16
 v_max3_u32 v55, v55, v17, v18
 v_max_u32 v55, v55, v19
 ds_write_b128 v54, v[12:15] offset:0
 ds_write_b128 v54, v[16:19] offset:1024
 v_cmpx_eq_u32 vcc, -1, v55
 s_cbranch_execz Lstep_52
 s_sub_u32 s54, s54, 1
 s_cbranch_scc0 Lp2_76
 s_endpgm
LwH_56:
 v_bfe_u32 v53, v3, 8, 1
 v_bfe_u32 v58, v3, 9, 1
 v_lshl_or_b32 v53, v53, 1, v58
 v_bfe_u32 v58, v3, 5, 1
 v_lshl_or_b32 v53, v53, 1, v58
 v_and_b32 v58, 0xd0, v3
 v_lshlrev_b32 v58, 24, v58
 v_lshl_or_b32 v53, v53, 2, v58
 s_waitcnt vmcnt(2)
 buffer_load_dwordx4 v[20:23], v3, s[20:23], s40 offen offset:0 sc1
 buffer_load_dwordx4 v[24:27], v3, s[20:23], s40 offen offset:1024 sc1
 buffer_load_dwordx4 v[36:39], v3, s[20:23], s39 offen offset:0 sc1
 buffer_load_dwordx4 v[40:43], v3, s[20:23], s39 offen offset:1024 sc1
 s_xor_b32 s41, s41, 0x80000
 s_xor_b32 s43, s43, 0x80000
 v_mov_b32 v47, 0x3f80
 v_cndmask_b32 v47, v47, 1.0, s[32:33]
 v_cndmask_b32 v44, 0, v47, s[24:25]
 v_cndmask_b32 v45, 0, v47, s[26:27]
 v_cndmask_b32 v46, 0, v47, s[28:29]
 v_cndmask_b32 v47, 0, v47, s[30:31]
 v_bfe_u32 v52, v3, 8, 2
 v_bfe_u32 v58, v3, 2, 4
 v_lshl_or_b32 v52, v52, 4, v58
 v_and_b32 v58, 0xc0, v3
 v_lshl_or_b32 v52, v58, 24, v52
 v_subrev_u32 v0, 0x20000, v0
 v_mov_b32 v59, -1
 v_add_u32 v54, s42, v3
 v_add_u32 v58, s69, v9
 ds_read_b64 v[64:65], v58 offset:19456
 v_mov_b32 v66, v2
 v_mov_b32 v67, v4
 s_waitcnt vmcnt(2)
 v_mfma_f32_16x16x32_bf16 v[28:31], v[44:47], v[20:23], 0
 v_mfma_f32_16x16x32_bf16 v[28:31], v[44:47], v[24:27], v[28:31]
 s_waitcnt vmcnt(1)
 v_mfma_f32_16x16x32_bf16 v[48:51], v[44:47], v[36:39], 0
 s_waitcnt vmcnt(0)
 v_mfma_f32_16x16x32_bf16 v[48:51], v[44:47], v[40:43], v[48:51]
 v_bitop3_b32 v55, v37, v39, s46 bitop3:0x7e
 v_bitop3_b32 v56, v41, v43, s46 bitop3:0x7e
 v_bitop3_b32 v57, v21, v23, s46 bitop3:0x7e
 v_or3_b32 v55, v55, v56, v57
 v_bitop3_b32 v56, v25, v27, s46 bitop3:0x7e
 v_bitop3_b32 v55, v55, 1, v56 bitop3:0xc8
 v_cmp_ne_u32 vcc, 0, v55
 v_add_f32_dpp v29, v29, v29 row_ror:4 row_mask:0xf bank_mask:0xf
 v_add_f32_dpp v48, v48, v48 row_ror:4 row_mask:0xf bank_mask:0xf
 v_add_f32_dpp v49, v49, v49 row_ror:4 row_mask:0xf bank_mask:0xf
 v_add_f32_dpp v29, v29, v29 row_ror:8 row_mask:0xf bank_mask:0xf
 v_add_f32_dpp v48, v48, v48 row_ror:8 row_mask:0xf bank_mask:0xf
 v_add_f32_dpp v49, v49, v49 row_ror:8 row_mask:0xf bank_mask:0xf
 s_cbranch_vccnz Lr1_77
 v_cvt_pk_bf16_f32 v48, v48, v49
 buffer_store_dword v48, v52, s[20:23], s44 offen
 v_mov_b32_dpp v30, v29 quad_perm:[1,0,3,2] row_mask:0xf bank_mask:0xf
 v_cvt_pk_bf16_f32 v29, v29, v30
 buffer_store_dword v29, v53, s[20:23], s65 offen
Lb1_78:
 buffer_store_dword v59, v52, s[20:23], s45 offen
 buffer_store_dword v59, v53, s[20:23], s66 offen
 v_cmp_gt_u32 vcc, s58, v1
 ds_read_b128 v[20:23], v0 offset:24576
 ds_read_b128 v[24:27], v0 offset:28672
 ds_read_b128 v[28:31], v0 offset:32768
 ds_read_b128 v[32:35], v0 offset:36864
 v_mov_b64 v[36:37], 0
 v_mov_b64 v[38:39], 0
 v_mov_b64 v[40:41], 0
 v_mov_b64 v[42:43], 0
 v_mov_b64 v[44:45], 0
 v_mov_b64 v[46:47], 0
 v_mov_b64 v[48:49], 0
 v_mov_b64 v[50:51], 0
 s_cmp_lg_u32 vcc_hi, 0
 s_cbranch_scc1 Lfw_80
Lfok_79:
 v_lshl_add_u32 v1, v3, 3, s68
 v_mov_b32 v6, s56
 v_cndmask_b32 v1, v6, v1, s[70:71]
 v_min_u32 v6, 16, v0
 v_lshlrev_b32 v6, 24, v6
 s_max_u32 s47, s36, 1
 v_add_u32 v2, -1, s47
 s_nop 10
 buffer_load_dwordx4 v[12:15], v3, s[20:23], s41 offen offset:0 sc1
 buffer_load_dwordx4 v[16:19], v3, s[20:23], s41 offen offset:1024 sc1
 buffer_load_dwordx4 v[68:71], v3, s[20:23], s43 offen offset:0 sc1
 s_nop 15
 s_nop 7
Lp2_81:
 buffer_load_dwordx4 v[12:15], v3, s[20:23], s41 offen offset:0 sc1
 buffer_load_dwordx4 v[16:19], v3, s[20:23], s41 offen offset:1024 sc1
 buffer_load_dwordx4 v[68:71], v3, s[20:23], s43 offen offset:0 sc1
 s_waitcnt vmcnt(3)
 v_max3_u32 v55, v12, v13, v14
 v_max3_u32 v55, v55, v15, v16
 v_max3_u32 v55, v55, v17, v18
 v_max3_u32 v55, v55, v19, v68
 v_max3_u32 v55, v55, v69, v70
 v_max_u32 v55, v55, v71
 ds_write_b128 v54, v[12:15] offset:0
 ds_write_b128 v54, v[16:19] offset:1024
 ds_write_b128 v54, v[68:71] offset:8192
 v_cmpx_eq_u32 vcc, -1, v55
 s_cbranch_execz Lstep_52
 buffer_load_dwordx4 v[12:15], v3, s[20:23], s41 offen offset:0 sc1
 buffer_load_dwordx4 v[16:19], v3, s[20:23], s41 offen offset:1024 sc1
 buffer_load_dwordx4 v[68:71], v3, s[20:23], s43 offen offset:0 sc1
 s_waitcnt vmcnt(3)
 v_max3_u32 v55, v12, v13, v14
 v_max3_u32 v55, v55, v15, v16
 v_max3_u32 v55, v55, v17, v18
 v_max3_u32 v55, v55, v19, v68
 v_max3_u32 v55, v55, v69, v70
 v_max_u32 v55, v55, v71
 ds_write_b128 v54, v[12:15] offset:0
 ds_write_b128 v54, v[16:19] offset:1024
 ds_write_b128 v54, v[68:71] offset:8192
 v_cmpx_eq_u32 vcc, -1, v55
 s_cbranch_execz Lstep_52
 buffer_load_dwordx4 v[12:15], v3, s[20:23], s41 offen offset:0 sc1
 buffer_load_dwordx4 v[16:19], v3, s[20:23], s41 offen offset:1024 sc1
 buffer_load_dwordx4 v[68:71], v3, s[20:23], s43 offen offset:0 sc1
 s_waitcnt vmcnt(3)
 v_max3_u32 v55, v12, v13, v14
 v_max3_u32 v55, v55, v15, v16
 v_max3_u32 v55, v55, v17, v18
 v_max3_u32 v55, v55, v19, v68
 v_max3_u32 v55, v55, v69, v70
 v_max_u32 v55, v55, v71
 ds_write_b128 v54, v[12:15] offset:0
 ds_write_b128 v54, v[16:19] offset:1024
 ds_write_b128 v54, v[68:71] offset:8192
 v_cmpx_eq_u32 vcc, -1, v55
 s_cbranch_execz Lstep_52
 s_sub_u32 s54, s54, 1
 s_cbranch_scc0 Lp2_81
 s_endpgm
Lr1_77:
 s_mov_b64 exec, vcc
Lrt_82:
 buffer_load_dwordx4 v[20:23], v3, s[20:23], s40 offen offset:0 sc1
 buffer_load_dwordx4 v[24:27], v3, s[20:23], s40 offen offset:1024 sc1
 buffer_load_dwordx4 v[36:39], v3, s[20:23], s39 offen offset:0 sc1
 buffer_load_dwordx4 v[40:43], v3, s[20:23], s39 offen offset:1024 sc1
 s_waitcnt vmcnt(4)
 v_bitop3_b32 v55, v37, v39, s46 bitop3:0x7e
 v_bitop3_b32 v56, v41, v43, s46 bitop3:0x7e
 v_bitop3_b32 v57, v21, v23, s46 bitop3:0x7e
 v_or3_b32 v55, v55, v56, v57
 v_bitop3_b32 v56, v25, v27, s46 bitop3:0x7e
 v_bitop3_b32 v55, v55, 1, v56 bitop3:0xc8
 v_cmpx_ne_u32 vcc, 0, v55
 s_cbranch_execz Lrte_83
 buffer_load_dwordx4 v[20:23], v3, s[20:23], s40 offen offset:0 sc1
 buffer_load_dwordx4 v[24:27], v3, s[20:23], s40 offen offset:1024 sc1
 buffer_load_dwordx4 v[36:39], v3, s[20:23], s39 offen offset:0 sc1
 buffer_load_dwordx4 v[40:43], v3, s[20:23], s39 offen offset:1024 sc1
 s_waitcnt vmcnt(4)
 v_bitop3_b32 v55, v37, v39, s46 bitop3:0x7e
 v_bitop3_b32 v56, v41, v43, s46 bitop3:0x7e
 v_bitop3_b32 v57, v21, v23, s46 bitop3:0x7e
 v_or3_b32 v55, v55, v56, v57
 v_bitop3_b32 v56, v25, v27, s46 bitop3:0x7e
 v_bitop3_b32 v55, v55, 1, v56 bitop3:0xc8
 v_cmpx_ne_u32 vcc, 0, v55
 s_cbranch_execz Lrte_83
 buffer_load_dwordx4 v[20:23], v3, s[20:23], s40 offen offset:0 sc1
 buffer_load_dwordx4 v[24:27], v3, s[20:23], s40 offen offset:1024 sc1
 buffer_load_dwordx4 v[36:39], v3, s[20:23], s39 offen offset:0 sc1
 buffer_load_dwordx4 v[40:43], v3, s[20:23], s39 offen offset:1024 sc1
 s_waitcnt vmcnt(4)
 v_bitop3_b32 v55, v37, v39, s46 bitop3:0x7e
 v_bitop3_b32 v56, v41, v43, s46 bitop3:0x7e
 v_bitop3_b32 v57, v21, v23, s46 bitop3:0x7e
 v_or3_b32 v55, v55, v56, v57
 v_bitop3_b32 v56, v25, v27, s46 bitop3:0x7e
 v_bitop3_b32 v55, v55, 1, v56 bitop3:0xc8
 v_cmpx_ne_u32 vcc, 0, v55
 s_cbranch_execz Lrte_83
 s_sub_u32 s54, s54, 1
 s_cbranch_scc0 Lrt_82
 s_endpgm
Lrte_83:
 s_mov_b64 exec, -1
 s_nop 2
 v_mfma_f32_16x16x32_bf16 v[28:31], v[44:47], v[20:23], 0
 v_mfma_f32_16x16x32_bf16 v[28:31], v[44:47], v[24:27], v[28:31]
 v_mfma_f32_16x16x32_bf16 v[48:51], v[44:47], v[36:39], 0
 v_mfma_f32_16x16x32_bf16 v[48:51], v[44:47], v[40:43], v[48:51]
 s_nop 6
 v_add_f32_dpp v29, v29, v29 row_ror:4 row_mask:0xf bank_mask:0xf
 v_add_f32_dpp v48, v48, v48 row_ror:4 row_mask:0xf bank_mask:0xf
 v_add_f32_dpp v49, v49, v49 row_ror:4 row_mask:0xf bank_mask:0xf
 v_add_f32_dpp v29, v29, v29 row_ror:8 row_mask:0xf bank_mask:0xf
 v_add_f32_dpp v48, v48, v48 row_ror:8 row_mask:0xf bank_mask:0xf
 v_add_f32_dpp v49, v49, v49 row_ror:8 row_mask:0xf bank_mask:0xf
 v_cvt_pk_bf16_f32 v48, v48, v49
 buffer_store_dword v48, v52, s[20:23], s44 offen
 v_mov_b32_dpp v30, v29 quad_perm:[1,0,3,2] row_mask:0xf bank_mask:0xf
 v_cvt_pk_bf16_f32 v29, v29, v30
 buffer_store_dword v29, v53, s[20:23], s65 offen
 s_waitcnt vmcnt(2)
 s_branch Lb1_78
Lmx_54:
 s_waitcnt lgkmcnt(0)
 ds_read_b128 v[36:39], v11 offset:17408
 ds_read_b128 v[40:43], v11 offset:17920
 ds_read_b128 v[44:47], v11 offset:18432
 ds_read_b128 v[48:51], v11 offset:18944
 v_mov_b64 v[28:29], 0
 v_mov_b64 v[30:31], 0
 ds_read_b128 v[52:55], v3 offset:9216
 ds_read_b128 v[56:59], v3 offset:10240
 s_waitcnt lgkmcnt(0)
 v_mfma_f32_16x16x32_bf16 v[20:23], v[52:55], v[36:39], 0
 v_mfma_f32_16x16x32_bf16 v[24:27], v[56:59], v[36:39], 0
 ds_read_b128 v[52:55], v3 offset:11264
 ds_read_b128 v[56:59], v3 offset:12288
 s_waitcnt lgkmcnt(0)
 v_mfma_f32_16x16x32_bf16 v[20:23], v[52:55], v[40:43], v[20:23]
 v_mfma_f32_16x16x32_bf16 v[24:27], v[56:59], v[40:43], v[24:27]
 ds_read_b128 v[52:55], v3 offset:13312
 ds_read_b128 v[56:59], v3 offset:14336
 s_waitcnt lgkmcnt(0)
 v_mfma_f32_16x16x32_bf16 v[20:23], v[52:55], v[44:47], v[20:23]
 v_mfma_f32_16x16x32_bf16 v[24:27], v[56:59], v[44:47], v[24:27]
 ds_read_b128 v[52:55], v3 offset:15360
 ds_read_b128 v[56:59], v3 offset:16384
 s_waitcnt lgkmcnt(0)
 v_mfma_f32_16x16x32_bf16 v[20:23], v[52:55], v[48:51], v[20:23]
 v_mfma_f32_16x16x32_bf16 v[24:27], v[56:59], v[48:51], v[24:27]
 ds_read_b128 v[52:55], v9 offset:19456
 ds_read_b128 v[56:59], v9 offset:21504
 s_waitcnt lgkmcnt(0)
 v_smfmac_f32_16x16x64_bf16 v[28:31], v[52:55], v[36:43], v5
 v_smfmac_f32_16x16x64_bf16 v[28:31], v[56:59], v[44:51], v5
 ds_read_b128 v[36:39], v0 offset:32768
 ds_read_b128 v[40:43], v0 offset:36864
 ds_read_b128 v[44:47], v0 offset:40960
 ds_read_b128 v[48:51], v0 offset:45056
 v_mov_b64 v[32:33], s[34:35]
 v_mov_b64 v[34:35], s[34:35]
 s_nop 1
 v_add_f32 v28, v28, v30
 v_add_f32 v29, v29, v31
 v_mul_f32 v28, s55, v28
 v_mul_f32 v29, s55, v29
 v_max_f32 v30, v28, v29
 v_cndmask_b32 v28, v28, v29, s[48:49]
 v_max3_f32 v30, v30, v20, v21
 v_max3_f32 v30, v30, v22, v23
 v_max3_f32 v30, v30, v24, v25
 v_max3_f32 v31, v30, v26, v27
 v_max3_f32 v29, v30, v26, v27
 v_cndmask_b32 v20, v20, v24, s[48:49]
 v_cndmask_b32 v21, v21, v25, s[48:49]
 v_permlane16_swap_b32 v31, v29
 v_max_f32 v30, v31, v29
 v_max_f32 v6, v31, v29
 v_cndmask_b32 v22, v22, v26, s[48:49]
 v_cndmask_b32 v23, v23, v27, s[48:49]
 v_permlane32_swap_b32 v30, v6
 v_max_f32 v30, v30, v6
 v_sub_f32 v28, v28, v30
 v_sub_f32 v20, v20, v30
 v_sub_f32 v21, v21, v30
 v_sub_f32 v22, v22, v30
 v_sub_f32 v23, v23, v30
 v_exp_f32 v28, v28
 v_exp_f32 v20, v20
 v_exp_f32 v21, v21
 v_exp_f32 v22, v22
 v_exp_f32 v23, v23
 v_cndmask_b32 v29, 0, v28, s[48:49]
 v_cndmask_b32 v28, v28, 0, s[48:49]
 v_cvt_pk_bf16_f32 v6, v28, v29
 v_cvt_pk_bf16_f32 v30, v20, v21
 v_cvt_pk_bf16_f32 v31, v22, v23
 v_mfma_f32_16x16x16_bf16 v[60:63], v[6:7], v[32:33], 0
 v_mfma_f32_16x16x16_bf16 v[52:55], v[6:7], v[2:3], 0
 v_mfma_f32_16x16x16_bf16 v[56:59], v[6:7], v[4:5], 0
 v_smfmac_f32_16x16x32_bf16 v[60:63], v[30:31], v[32:35], v5
 v_smfmac_f32_16x16x32_bf16 v[52:55], v[30:31], v[12:15], v5
 v_smfmac_f32_16x16x32_bf16 v[56:59], v[30:31], v[16:19], v5
 s_nop 0
 v_add_f32 v60, v60, v62
 v_add_f32 v61, v61, v63
 v_rcp_f32 v60, v60
 v_rcp_f32 v61, v61
 v_add_f32 v52, v52, v54
 v_add_f32 v53, v53, v55
 v_mul_f32 v52, v52, v60
 v_mul_f32 v53, v53, v61
 v_add_f32 v56, v56, v58
 v_add_f32 v57, v57, v59
 v_mul_f32 v56, v56, v60
 v_mul_f32 v57, v57, v61
 v_cvt_pk_bf16_f32 v52, v52, v56
 v_cvt_pk_bf16_f32 v53, v53, v57
 ds_write2_b32 v8, v52, v53 offset0:128 offset1:144
 v_mov_b64 v[20:21], 0
 v_mov_b64 v[22:23], 0
 v_mov_b64 v[24:25], 0
 v_mov_b64 v[26:27], 0
 v_mov_b64 v[28:29], 0
 v_mov_b64 v[30:31], 0
 v_mov_b64 v[32:33], 0
 v_mov_b64 v[34:35], 0
 s_waitcnt lgkmcnt(0)
 s_branch Lmxb_55
Lr2_60:
 s_waitcnt vmcnt(1)
 v_mfma_f32_16x16x32_bf16 v[48:51], v[44:47], v[12:15], 0
 s_waitcnt vmcnt(0)
 v_mfma_f32_16x16x32_bf16 v[48:51], v[44:47], v[16:19], v[48:51]
 v_bitop3_b32 v55, v13, v15, s46 bitop3:0x7e
 v_bitop3_b32 v56, v17, v19, s46 bitop3:0x7e
 v_bitop3_b32 v55, v55, 1, v56 bitop3:0xc8
 v_cmp_ne_u32 vcc, 0, v55
 s_nop 3
 v_add_f32_dpp v48, v48, v48 row_ror:4 row_mask:0xf bank_mask:0xf
 v_add_f32_dpp v49, v49, v49 row_ror:4 row_mask:0xf bank_mask:0xf
 s_cbranch_vccnz Lr1_59
 v_add_f32_dpp v48, v48, v48 row_ror:8 row_mask:0xf bank_mask:0xf
 v_add_f32_dpp v49, v49, v49 row_ror:8 row_mask:0xf bank_mask:0xf
 v_cvt_pk_bf16_f32 v48, v48, v49
 buffer_store_dword v48, v52, s[20:23], s44 offen
 s_branch Lb1_61
Lr1_59:
 s_mov_b64 exec, vcc
Lrt_84:
 buffer_load_dwordx4 v[12:15], v3, s[20:23], s39 offen offset:0 sc1
 buffer_load_dwordx4 v[16:19], v3, s[20:23], s39 offen offset:1024 sc1
 s_waitcnt vmcnt(2)
 v_bitop3_b32 v55, v13, v15, s46 bitop3:0x7e
 v_bitop3_b32 v56, v17, v19, s46 bitop3:0x7e
 v_bitop3_b32 v55, v55, 1, v56 bitop3:0xc8
 v_cmpx_ne_u32 vcc, 0, v55
 s_cbranch_execz Lrte_85
 buffer_load_dwordx4 v[12:15], v3, s[20:23], s39 offen offset:0 sc1
 buffer_load_dwordx4 v[16:19], v3, s[20:23], s39 offen offset:1024 sc1
 s_waitcnt vmcnt(2)
 v_bitop3_b32 v55, v13, v15, s46 bitop3:0x7e
 v_bitop3_b32 v56, v17, v19, s46 bitop3:0x7e
 v_bitop3_b32 v55, v55, 1, v56 bitop3:0xc8
 v_cmpx_ne_u32 vcc, 0, v55
 s_cbranch_execz Lrte_85
 buffer_load_dwordx4 v[12:15], v3, s[20:23], s39 offen offset:0 sc1
 buffer_load_dwordx4 v[16:19], v3, s[20:23], s39 offen offset:1024 sc1
 s_waitcnt vmcnt(2)
 v_bitop3_b32 v55, v13, v15, s46 bitop3:0x7e
 v_bitop3_b32 v56, v17, v19, s46 bitop3:0x7e
 v_bitop3_b32 v55, v55, 1, v56 bitop3:0xc8
 v_cmpx_ne_u32 vcc, 0, v55
 s_cbranch_execz Lrte_85
 s_sub_u32 s54, s54, 1
 s_cbranch_scc0 Lrt_84
 s_endpgm
Lrte_85:
 s_mov_b64 exec, -1
 s_nop 2
 v_mfma_f32_16x16x32_bf16 v[48:51], v[44:47], v[12:15], 0
 v_mfma_f32_16x16x32_bf16 v[48:51], v[44:47], v[16:19], v[48:51]
 s_nop 7
 v_add_f32_dpp v48, v48, v48 row_ror:4 row_mask:0xf bank_mask:0xf
 v_add_f32_dpp v49, v49, v49 row_ror:4 row_mask:0xf bank_mask:0xf
 s_nop 0
 v_add_f32_dpp v48, v48, v48 row_ror:8 row_mask:0xf bank_mask:0xf
 v_add_f32_dpp v49, v49, v49 row_ror:8 row_mask:0xf bank_mask:0xf
 v_cvt_pk_bf16_f32 v48, v48, v49
 buffer_store_dword v48, v52, s[20:23], s44 offen
 s_branch Lb1_61
Lr2_66:
 s_waitcnt vmcnt(1)
 v_mfma_f32_16x16x32_bf16 v[48:51], v[44:47], v[12:15], 0
 s_waitcnt vmcnt(0)
 v_mfma_f32_16x16x32_bf16 v[48:51], v[44:47], v[16:19], v[48:51]
 v_bitop3_b32 v55, v13, v15, s46 bitop3:0x7e
 v_bitop3_b32 v56, v17, v19, s46 bitop3:0x7e
 v_bitop3_b32 v55, v55, 1, v56 bitop3:0xc8
 v_cmp_ne_u32 vcc, 0, v55
 s_nop 3
 v_add_f32_dpp v48, v48, v48 row_ror:4 row_mask:0xf bank_mask:0xf
 v_add_f32_dpp v49, v49, v49 row_ror:4 row_mask:0xf bank_mask:0xf
 s_cbranch_vccnz Lr1_65
 v_add_f32_dpp v48, v48, v48 row_ror:8 row_mask:0xf bank_mask:0xf
 v_add_f32_dpp v49, v49, v49 row_ror:8 row_mask:0xf bank_mask:0xf
 v_cvt_pk_bf16_f32 v48, v48, v49
 buffer_store_dword v48, v52, s[20:23], s44 offen
 s_branch Lb1_67
Lr1_65:
 s_mov_b64 exec, vcc
Lrt_86:
 buffer_load_dwordx4 v[12:15], v3, s[20:23], s39 offen offset:0 sc1
 buffer_load_dwordx4 v[16:19], v3, s[20:23], s39 offen offset:1024 sc1
 s_waitcnt vmcnt(2)
 v_bitop3_b32 v55, v13, v15, s46 bitop3:0x7e
 v_bitop3_b32 v56, v17, v19, s46 bitop3:0x7e
 v_bitop3_b32 v55, v55, 1, v56 bitop3:0xc8
 v_cmpx_ne_u32 vcc, 0, v55
 s_cbranch_execz Lrte_87
 buffer_load_dwordx4 v[12:15], v3, s[20:23], s39 offen offset:0 sc1
 buffer_load_dwordx4 v[16:19], v3, s[20:23], s39 offen offset:1024 sc1
 s_waitcnt vmcnt(2)
 v_bitop3_b32 v55, v13, v15, s46 bitop3:0x7e
 v_bitop3_b32 v56, v17, v19, s46 bitop3:0x7e
 v_bitop3_b32 v55, v55, 1, v56 bitop3:0xc8
 v_cmpx_ne_u32 vcc, 0, v55
 s_cbranch_execz Lrte_87
 buffer_load_dwordx4 v[12:15], v3, s[20:23], s39 offen offset:0 sc1
 buffer_load_dwordx4 v[16:19], v3, s[20:23], s39 offen offset:1024 sc1
 s_waitcnt vmcnt(2)
 v_bitop3_b32 v55, v13, v15, s46 bitop3:0x7e
 v_bitop3_b32 v56, v17, v19, s46 bitop3:0x7e
 v_bitop3_b32 v55, v55, 1, v56 bitop3:0xc8
 v_cmpx_ne_u32 vcc, 0, v55
 s_cbranch_execz Lrte_87
 s_sub_u32 s54, s54, 1
 s_cbranch_scc0 Lrt_86
 s_endpgm
Lrte_87:
 s_mov_b64 exec, -1
 s_nop 2
 v_mfma_f32_16x16x32_bf16 v[48:51], v[44:47], v[12:15], 0
 v_mfma_f32_16x16x32_bf16 v[48:51], v[44:47], v[16:19], v[48:51]
 s_nop 7
 v_add_f32_dpp v48, v48, v48 row_ror:4 row_mask:0xf bank_mask:0xf
 v_add_f32_dpp v49, v49, v49 row_ror:4 row_mask:0xf bank_mask:0xf
 s_nop 0
 v_add_f32_dpp v48, v48, v48 row_ror:8 row_mask:0xf bank_mask:0xf
 v_add_f32_dpp v49, v49, v49 row_ror:8 row_mask:0xf bank_mask:0xf
 v_cvt_pk_bf16_f32 v48, v48, v49
 buffer_store_dword v48, v52, s[20:23], s44 offen
 s_branch Lb1_67
Lr2_72:
 s_waitcnt vmcnt(1)
 v_mfma_f32_16x16x32_bf16 v[48:51], v[44:47], v[12:15], 0
 s_waitcnt vmcnt(0)
 v_mfma_f32_16x16x32_bf16 v[48:51], v[44:47], v[16:19], v[48:51]
 v_bitop3_b32 v55, v13, v15, s46 bitop3:0x7e
 v_bitop3_b32 v56, v17, v19, s46 bitop3:0x7e
 v_bitop3_b32 v55, v55, 1, v56 bitop3:0xc8
 v_cmp_ne_u32 vcc, 0, v55
 s_nop 3
 v_add_f32_dpp v48, v48, v48 row_ror:4 row_mask:0xf bank_mask:0xf
 v_add_f32_dpp v49, v49, v49 row_ror:4 row_mask:0xf bank_mask:0xf
 s_cbranch_vccnz Lr1_71
 v_add_f32_dpp v48, v48, v48 row_ror:8 row_mask:0xf bank_mask:0xf
 v_add_f32_dpp v49, v49, v49 row_ror:8 row_mask:0xf bank_mask:0xf
 v_cvt_pk_bf16_f32 v48, v48, v49
 buffer_store_dword v48, v52, s[20:23], s44 offen
 s_branch Lb1_73
Lr1_71:
 s_mov_b64 exec, vcc
Lrt_88:
 buffer_load_dwordx4 v[12:15], v3, s[20:23], s39 offen offset:0 sc1
 buffer_load_dwordx4 v[16:19], v3, s[20:23], s39 offen offset:1024 sc1
 s_waitcnt vmcnt(2)
 v_bitop3_b32 v55, v13, v15, s46 bitop3:0x7e
 v_bitop3_b32 v56, v17, v19, s46 bitop3:0x7e
 v_bitop3_b32 v55, v55, 1, v56 bitop3:0xc8
 v_cmpx_ne_u32 vcc, 0, v55
 s_cbranch_execz Lrte_89
 buffer_load_dwordx4 v[12:15], v3, s[20:23], s39 offen offset:0 sc1
 buffer_load_dwordx4 v[16:19], v3, s[20:23], s39 offen offset:1024 sc1
 s_waitcnt vmcnt(2)
 v_bitop3_b32 v55, v13, v15, s46 bitop3:0x7e
 v_bitop3_b32 v56, v17, v19, s46 bitop3:0x7e
 v_bitop3_b32 v55, v55, 1, v56 bitop3:0xc8
 v_cmpx_ne_u32 vcc, 0, v55
 s_cbranch_execz Lrte_89
 buffer_load_dwordx4 v[12:15], v3, s[20:23], s39 offen offset:0 sc1
 buffer_load_dwordx4 v[16:19], v3, s[20:23], s39 offen offset:1024 sc1
 s_waitcnt vmcnt(2)
 v_bitop3_b32 v55, v13, v15, s46 bitop3:0x7e
 v_bitop3_b32 v56, v17, v19, s46 bitop3:0x7e
 v_bitop3_b32 v55, v55, 1, v56 bitop3:0xc8
 v_cmpx_ne_u32 vcc, 0, v55
 s_cbranch_execz Lrte_89
 s_sub_u32 s54, s54, 1
 s_cbranch_scc0 Lrt_88
 s_endpgm
Lrte_89:
 s_mov_b64 exec, -1
 s_nop 2
 v_mfma_f32_16x16x32_bf16 v[48:51], v[44:47], v[12:15], 0
 v_mfma_f32_16x16x32_bf16 v[48:51], v[44:47], v[16:19], v[48:51]
 s_nop 7
 v_add_f32_dpp v48, v48, v48 row_ror:4 row_mask:0xf bank_mask:0xf
 v_add_f32_dpp v49, v49, v49 row_ror:4 row_mask:0xf bank_mask:0xf
 s_nop 0
 v_add_f32_dpp v48, v48, v48 row_ror:8 row_mask:0xf bank_mask:0xf
 v_add_f32_dpp v49, v49, v49 row_ror:8 row_mask:0xf bank_mask:0xf
 v_cvt_pk_bf16_f32 v48, v48, v49
 buffer_store_dword v48, v52, s[20:23], s44 offen
 s_branch Lb1_73
Lfw_63:
Lpb_90:
 buffer_load_dword v1, v7, s[20:23], s56 offen sc1
 s_waitcnt vmcnt(0)
 v_cmp_le_u32 vcc, s58, v1
 s_cbranch_vccnz Lpbok_91
 s_sub_u32 s54, s54, 1
 s_cbranch_scc0 Lpb_90
 s_endpgm
Lpbok_91:
 s_branch Lfok_62
Lfw_69:
Lpb_92:
 buffer_load_dword v1, v7, s[20:23], s56 offen sc1
 s_waitcnt vmcnt(0)
 v_cmp_le_u32 vcc, s58, v1
 s_cbranch_vccnz Lpbok_93
 s_sub_u32 s54, s54, 1
 s_cbranch_scc0 Lpb_92
 s_endpgm
Lpbok_93:
 s_branch Lfok_68
Lfw_75:
Lpb_94:
 buffer_load_dword v1, v7, s[20:23], s56 offen sc1
 s_waitcnt vmcnt(0)
 v_cmp_le_u32 vcc, s58, v1
 s_cbranch_vccnz Lpbok_95
 s_sub_u32 s54, s54, 1
 s_cbranch_scc0 Lpb_94
 s_endpgm
Lpbok_95:
 s_branch Lfok_74
Lfw_80:
Lpb_96:
 buffer_load_dword v1, v7, s[20:23], s56 offen sc1
 s_waitcnt vmcnt(0)
 v_cmp_le_u32 vcc, s58, v1
 s_cbranch_vccnz Lpbok_97
 s_sub_u32 s54, s54, 1
 s_cbranch_scc0 Lpb_96
 s_endpgm
Lpbok_97:
 s_branch Lfok_79
Lfail_53:
 s_endpgm
Lslow_50:
 .p2align 3
Lstep_98:
 s_mov_b64 exec, -1
 s_waitcnt lgkmcnt(0)
 buffer_load_dwordx4 v[12:15], v3, s[20:23], s59 offen offset:0 sc1
 buffer_load_dwordx4 v[16:19], v3, s[20:23], s59 offen offset:1024 sc1
 s_barrier
 ds_read_b128 v[52:55], v3 offset:0
 ds_read_b128 v[56:59], v3 offset:1024
 ds_read_b128 v[60:63], v3 offset:2048
 buffer_store_dwordx4 v[64:67], v0, s[20:23], s38 offen sc1
 s_waitcnt lgkmcnt(2)
 v_smfmac_f32_16x16x64_bf16 v[36:39], v[52:55], v[72:79], v5
 v_smfmac_f32_16x16x64_bf16 v[40:43], v[52:55], v[80:87], v5
 buffer_load_dword v1, v1, s[20:23], 0 offen sc1
 v_smfmac_f32_16x16x64_bf16 v[44:47], v[52:55], v[88:95], v5
 s_waitcnt lgkmcnt(1)
 v_smfmac_f32_16x16x64_bf16 v[48:51], v[52:55], v[20:27], v5
 buffer_store_dword v2, v6, s[20:23], s57 offen sc1
 v_smfmac_f32_16x16x64_bf16 v[36:39], v[56:59], v[112:119], v5
 ds_read_b128 v[20:23], v0 offset:40960
 v_mov_b64 v[64:65], 0
 v_smfmac_f32_16x16x64_bf16 v[40:43], v[56:59], v[120:127], v5
 ds_read_b128 v[24:27], v0 offset:45056
 v_mov_b64 v[66:67], 0
 v_smfmac_f32_16x16x64_bf16 v[44:47], v[56:59], v[128:135], v5
 ds_read_b128 v[52:55], v3 offset:3072
 s_waitcnt lgkmcnt(3)
 v_smfmac_f32_16x16x64_bf16 v[48:51], v[56:59], v[28:35], v5
 s_waitcnt vmcnt(5)
 v_smfmac_f32_16x16x64_bf16 v[36:39], v[60:63], v[152:159], v5
 ds_read_b128 v[28:31], v0 offset:49152
 v_mov_b64 v[68:69], 0
 v_smfmac_f32_16x16x64_bf16 v[40:43], v[60:63], v[160:167], v5
 ds_read_b128 v[32:35], v0 offset:53248
 v_mov_b64 v[70:71], 0
 v_smfmac_f32_16x16x64_bf16 v[44:47], v[60:63], v[168:175], v5
 ds_read_b128 v[56:59], v3 offset:4096
 s_waitcnt lgkmcnt(3)
 v_smfmac_f32_16x16x64_bf16 v[48:51], v[60:63], v[20:27], v5
 v_smfmac_f32_16x16x64_bf16 v[36:39], v[52:55], v[192:199], v5
 ds_read_b128 v[20:23], v0 offset:57344
 v_smfmac_f32_16x16x64_bf16 v[40:43], v[52:55], v[200:207], v5
 ds_read_b128 v[24:27], v0 offset:61440
 v_smfmac_f32_16x16x64_bf16 v[44:47], v[52:55], v[208:215], v5
 ds_read_b128 v[60:63], v3 offset:5120
 v_smfmac_f32_16x16x64_bf16 v[64:67], v[52:55], v[216:223], v5
 v_smfmac_f32_16x16x64_bf16 v[68:71], v[52:55], v[224:231], v5
 s_waitcnt lgkmcnt(3)
 v_add_u32 v0, 0x10000, v0
 v_smfmac_f32_16x16x64_bf16 v[48:51], v[52:55], v[28:35], v5
 v_smfmac_f32_16x16x64_bf16 v[36:39], v[56:59], v[232:239], v5
 ds_read_b128 v[28:31], v0 offset:0
 v_smfmac_f32_16x16x64_bf16 v[40:43], v[56:59], v[240:247], v5
 ds_read_b128 v[32:35], v0 offset:4096
 v_smfmac_f32_16x16x64_bf16 v[44:47], v[56:59], v[248:255], v5
 ds_read_b128 v[52:55], v3 offset:6144
 v_smfmac_f32_16x16x64_bf16 v[64:67], v[56:59], a[0:7], v5
 v_smfmac_f32_16x16x64_bf16 v[68:71], v[56:59], a[8:15], v5
 s_waitcnt lgkmcnt(3)
 v_smfmac_f32_16x16x64_bf16 v[48:51], v[56:59], v[20:27], v5
 v_smfmac_f32_16x16x64_bf16 v[36:39], v[60:63], a[16:23], v5
 ds_read_b128 v[20:23], v0 offset:8192
 v_smfmac_f32_16x16x64_bf16 v[40:43], v[60:63], a[24:31], v5
 ds_read_b128 v[24:27], v0 offset:12288
 v_smfmac_f32_16x16x64_bf16 v[44:47], v[60:63], a[32:39], v5
 ds_read_b128 v[56:59], v3 offset:7168
 v_smfmac_f32_16x16x64_bf16 v[64:67], v[60:63], a[40:47], v5
 v_smfmac_f32_16x16x64_bf16 v[68:71], v[60:63], a[48:55], v5
 s_waitcnt lgkmcnt(3)
 v_smfmac_f32_16x16x64_bf16 v[48:51], v[60:63], v[28:35], v5
 v_smfmac_f32_16x16x64_bf16 v[36:39], v[52:55], a[56:63], v5
 ds_read_b128 v[28:31], v0 offset:16384
 v_smfmac_f32_16x16x64_bf16 v[40:43], v[52:55], a[64:71], v5
 ds_read_b128 v[32:35], v0 offset:20480
 v_smfmac_f32_16x16x64_bf16 v[44:47], v[52:55], a[72:79], v5
 ds_read_b128 v[60:63], v3 offset:8192
 s_waitcnt lgkmcnt(3)
 v_smfmac_f32_16x16x64_bf16 v[48:51], v[52:55], v[20:27], v5
 v_smfmac_f32_16x16x64_bf16 v[36:39], v[56:59], a[96:103], v5
 ds_read_b128 v[20:23], v0 offset:24576
 v_smfmac_f32_16x16x64_bf16 v[40:43], v[56:59], a[104:111], v5
 ds_read_b128 v[24:27], v0 offset:28672
 s_waitcnt lgkmcnt(2)
 v_smfmac_f32_16x16x64_bf16 v[36:39], v[60:63], a[136:143], v5
 v_smfmac_f32_16x16x64_bf16 v[40:43], v[60:63], a[144:151], v5
 v_smfmac_f32_16x16x64_bf16 v[64:67], v[52:55], a[80:87], v5
 s_nop 0
 v_add_f32 v36, v36, v38
 v_smfmac_f32_16x16x64_bf16 v[68:71], v[52:55], a[88:95], v5
 ds_read_b128 v[52:55], v3 offset:0
 v_add_f32 v37, v37, v39
 v_smfmac_f32_16x16x64_bf16 v[44:47], v[56:59], a[112:119], v5
 v_add_f32 v40, v40, v42
 v_add_f32 v41, v41, v43
 v_smfmac_f32_16x16x64_bf16 v[48:51], v[56:59], v[28:35], v5
 s_waitcnt lgkmcnt(1)
 v_cvt_pk_bf16_f32 v36, v36, v40
 v_smfmac_f32_16x16x64_bf16 v[44:47], v[60:63], a[152:159], v5
 ds_read_b128 v[32:35], v3 offset:11264
 v_cvt_pk_bf16_f32 v37, v37, v41
 v_smfmac_f32_16x16x64_bf16 v[48:51], v[60:63], v[20:27], v5
 ds_write2_b32 v10, v36, v37 offset0:0 offset1:16
 v_smfmac_f32_16x16x64_bf16 v[64:67], v[56:59], a[120:127], v5
 ds_read_b128 v[20:23], v3 offset:9216
 v_add_f32 v44, v44, v46
 v_add_f32 v45, v45, v47
 v_smfmac_f32_16x16x64_bf16 v[68:71], v[56:59], a[128:135], v5
 s_waitcnt lgkmcnt(3)
 v_add_f32 v48, v48, v50
 v_add_f32 v49, v49, v51
 v_cvt_pk_bf16_f32 v44, v44, v48
 v_cvt_pk_bf16_f32 v45, v45, v49
 ds_write2_b32 v8, v44, v45 offset0:0 offset1:16
 v_smfmac_f32_16x16x64_bf16 v[64:67], v[52:55], v[96:103], v5
 ds_read_b128 v[56:59], v3 offset:1024
 v_mov_b64 v[28:29], 0
 v_smfmac_f32_16x16x64_bf16 v[68:71], v[52:55], v[104:111], v5
 ds_read_b128 v[52:55], v3 offset:2048
 v_mov_b64 v[30:31], 0
 v_smfmac_f32_16x16x64_bf16 v[64:67], v[60:63], a[160:167], v5
 ds_read_b128 v[24:27], v3 offset:10240
 v_smfmac_f32_16x16x64_bf16 v[68:71], v[60:63], a[168:175], v5
 s_waitcnt lgkmcnt(3)
 s_barrier
 ds_read_b128 v[36:39], v11 offset:17408
 s_waitcnt lgkmcnt(3)
 v_smfmac_f32_16x16x64_bf16 v[64:67], v[56:59], v[136:143], v5
 ds_read_b128 v[40:43], v11 offset:17920
 s_waitcnt lgkmcnt(3)
 v_smfmac_f32_16x16x64_bf16 v[68:71], v[56:59], v[144:151], v5
 ds_read_b128 v[60:63], v9 offset:19456
 ds_read_b128 v[44:47], v11 offset:18432
 v_smfmac_f32_16x16x64_bf16 v[64:67], v[52:55], v[176:183], v5
 ds_read_b128 v[48:51], v11 offset:18944
 v_smfmac_f32_16x16x64_bf16 v[68:71], v[52:55], v[184:191], v5
 ds_read_b128 v[52:55], v3 offset:12288
 s_waitcnt lgkmcnt(5)
 v_mfma_f32_16x16x32_bf16 v[20:23], v[20:23], v[36:39], 0
 ds_read_b128 v[56:59], v9 offset:21504
 v_mfma_f32_16x16x32_bf16 v[24:27], v[24:27], v[36:39], 0
 v_add_f32 v64, v64, v66
 v_add_f32 v65, v65, v67
 s_waitcnt lgkmcnt(5)
 v_mfma_f32_16x16x32_bf16 v[20:23], v[32:35], v[40:43], v[20:23]
 ds_read_b128 v[32:35], v3 offset:13312
 v_cvt_pk_bf16_f32 v2, v64, v65
 v_add_f32 v68, v68, v70
 s_waitcnt lgkmcnt(5)
 v_smfmac_f32_16x16x64_bf16 v[28:31], v[60:63], v[36:43], v5
 ds_read_b128 v[60:63], v3 offset:14336
 ds_read_b128 v[36:39], v3 offset:15360
 v_add_f32 v69, v69, v71
 s_waitcnt lgkmcnt(4)
 v_mfma_f32_16x16x32_bf16 v[24:27], v[52:55], v[40:43], v[24:27]
 ds_read_b128 v[52:55], v3 offset:16384
 v_cvt_pk_bf16_f32 v4, v68, v69
 s_waitcnt lgkmcnt(4)
 v_smfmac_f32_16x16x64_bf16 v[28:31], v[56:59], v[44:51], v5
 ds_read_b128 v[40:43], v0 offset:36864
 s_waitcnt lgkmcnt(4)
 v_mfma_f32_16x16x32_bf16 v[20:23], v[32:35], v[44:47], v[20:23]
 v_mov_b64 v[32:33], s[34:35]
 v_mov_b64 v[34:35], s[34:35]
 s_waitcnt lgkmcnt(3)
 v_mfma_f32_16x16x32_bf16 v[24:27], v[60:63], v[44:47], v[24:27]
 ds_read_b128 v[44:47], v0 offset:40960
 v_add_f32 v28, v28, v30
 v_add_f32 v29, v29, v31
 s_waitcnt lgkmcnt(3)
 v_mfma_f32_16x16x32_bf16 v[20:23], v[36:39], v[48:51], v[20:23]
 ds_read_b128 v[36:39], v0 offset:32768
 v_cndmask_b32 v28, v28, v29, s[48:49]
 v_mul_f32 v28, s55, v28
 s_waitcnt lgkmcnt(3)
 v_mfma_f32_16x16x32_bf16 v[24:27], v[52:55], v[48:51], v[24:27]
 ds_read_b128 v[48:51], v0 offset:45056
 v_exp_f32 v28, v28
 v_mov_b64 v[64:65], 0
 v_cndmask_b32 v29, 0, v28, s[48:49]
 v_cndmask_b32 v28, v28, 0, s[48:49]
 v_cvt_pk_bf16_f32 v6, v28, v29
 v_mov_b64 v[66:67], 0
 v_mov_b64 v[68:69], 0
 v_cndmask_b32 v20, v20, v24, s[48:49]
 v_cndmask_b32 v21, v21, v25, s[48:49]
 v_cndmask_b32 v22, v22, v26, s[48:49]
 v_cndmask_b32 v23, v23, v27, s[48:49]
 v_mfma_f32_16x16x16_bf16 v[60:63], v[6:7], v[32:33], 0
 s_waitcnt vmcnt(3)
 v_exp_f32 v20, v20
 v_mfma_f32_16x16x16_bf16 v[52:55], v[6:7], v[2:3], 0
 s_cmp_eq_u32 s36, 63
 v_exp_f32 v21, v21
 v_mfma_f32_16x16x16_bf16 v[56:59], v[6:7], v[4:5], 0
 v_exp_f32 v22, v22
 v_exp_f32 v23, v23
 v_cvt_pk_bf16_f32 v30, v20, v21
 v_cvt_pk_bf16_f32 v31, v22, v23
 v_mov_b64 v[70:71], 0
 v_mov_b64 v[20:21], 0
 v_smfmac_f32_16x16x32_bf16 v[60:63], v[30:31], v[32:35], v5
 v_mov_b64 v[22:23], 0
 v_mov_b64 v[24:25], 0
 v_smfmac_f32_16x16x32_bf16 v[52:55], v[30:31], v[12:15], v5
 v_mov_b64 v[26:27], 0
 v_smfmac_f32_16x16x32_bf16 v[56:59], v[30:31], v[16:19], v5
 s_nop 0
 v_add_f32 v60, v60, v62
 v_add_f32 v61, v61, v63
 v_rcp_f32 v60, v60
 v_rcp_f32 v61, v61
 v_add_f32 v52, v52, v54
 v_add_f32 v53, v53, v55
 v_mul_f32 v52, v52, v60
 v_mul_f32 v53, v53, v61
 v_add_f32 v56, v56, v58
 v_add_f32 v57, v57, v59
 v_mul_f32 v56, v56, v60
 v_mul_f32 v57, v57, v61
 v_cvt_pk_bf16_f32 v52, v52, v56
 v_cvt_pk_bf16_f32 v53, v53, v57
 ds_write2_b32 v8, v52, v53 offset0:128 offset1:144
 v_subrev_u32 v60, 0x21800000, v60
 v_subrev_u32 v61, 0x21800000, v61
 v_max_u32 v60, v60, v61
 v_cmp_lt_u32 vcc, 0x3c000000, v60
 s_cbranch_scc1 Lchexit_51
 v_mov_b64 v[28:29], 0
 v_mov_b64 v[30:31], 0
 v_mov_b64 v[32:33], 0
 v_mov_b64 v[34:35], 0
 s_cbranch_vccnz Lmx_100
Lmxb_101:
 s_waitcnt lgkmcnt(0)
 v_bfe_u32 v6, v0, 7, 5
 s_barrier
 ds_read_b128 v[52:55], v9 offset:19968
 v_mul_u32_u24 v6, 10496, v6
 ds_read_b128 v[56:59], v9 offset:22016
 ds_read_b128 v[12:15], v0 offset:49152
 v_bfe_u32 v60, v3, 4, 3
 ds_read_b128 v[16:19], v0 offset:53248
 s_add_u32 s67, s67, 0x80000
 v_lshl_add_u32 v6, v60, 3, v6
 s_xor_b32 s46, s46, 0x1
 s_add_u32 s59, s59, 0x80000
 v_mov_b64 v[60:61], 0
 s_add_u32 s38, s38, 0x20000
 v_mov_b64 v[62:63], 0
 s_waitcnt lgkmcnt(3)
 v_smfmac_f32_16x16x64_bf16 v[64:67], v[52:55], a[248:255], v5
 buffer_load_dwordx4 v3, s[20:23], s67 offen offset:0 sc1 lds
 v_smfmac_f32_16x16x64_bf16 v[68:71], v[52:55], a[176:183], v5
 s_waitcnt lgkmcnt(2)
 s_cmp_lt_u32 s36, 61
 v_smfmac_f32_16x16x64_bf16 v[64:67], v[56:59], v[36:43], v5
 ds_read_b128 v[36:39], v0 offset:57344
 buffer_load_dwordx4 v3, s[20:23], s67 offen offset:1024 sc1 lds
 v_smfmac_f32_16x16x64_bf16 v[20:23], v[52:55], a[184:191], v5
 ds_read_b128 v[40:43], v0 offset:61440
 s_cselect_b32 s47, 0x80000, 0
 v_add_u32 v0, 0x10000, v0
 v_smfmac_f32_16x16x64_bf16 v[68:71], v[56:59], v[44:51], v5
 ds_read_b128 v[44:47], v0 offset:0
 s_add_u32 s68, s68, s47
 v_add_f32 v64, v64, v66
 v_add_f32 v65, v65, v67
 v_cvt_pk_bf16_f32 v65, v65, v65
 v_smfmac_f32_16x16x64_bf16 v[24:27], v[52:55], a[192:199], v5
 ds_read_b128 v[48:51], v0 offset:4096
 s_waitcnt lgkmcnt(4)
 v_cvt_pk_bf16_f32 v64, v64, v64
 v_and_or_b32 v65, v65, -2, s46
 v_smfmac_f32_16x16x64_bf16 v[20:23], v[56:59], v[12:19], v5
 ds_read_b128 v[12:15], v0 offset:8192
 buffer_store_dwordx2 v[64:65], v6, s[20:23], s62 offen sc1
 v_add_f32 v68, v68, v70
 v_add_f32 v69, v69, v71
 v_smfmac_f32_16x16x64_bf16 v[28:31], v[52:55], a[200:207], v5
 ds_read_b128 v[16:19], v0 offset:12288
 s_waitcnt lgkmcnt(4)
 v_mov_b64 v[64:65], 0
 v_mov_b64 v[66:67], 0
 v_smfmac_f32_16x16x64_bf16 v[24:27], v[56:59], v[36:43], v5
 ds_read_b128 v[36:39], v0 offset:16384
 s_add_u32 s36, s36, 1
 v_add_f32 v20, v20, v22
 v_add_f32 v21, v21, v23
 v_cvt_pk_bf16_f32 v69, v69, v21
 v_smfmac_f32_16x16x64_bf16 v[32:35], v[52:55], a[208:215], v5
 ds_read_b128 v[40:43], v0 offset:20480
 s_waitcnt lgkmcnt(4)
 v_cvt_pk_bf16_f32 v68, v68, v20
 v_and_or_b32 v69, v69, -2, s46
 v_smfmac_f32_16x16x64_bf16 v[28:31], v[56:59], v[44:51], v5
 ds_read_b128 v[44:47], v0 offset:24576
 buffer_store_dwordx2 v[68:69], v6, s[20:23], s60 offen offset:0 sc1
 v_add_f32 v24, v24, v26
 v_add_f32 v25, v25, v27
 v_smfmac_f32_16x16x64_bf16 v[60:63], v[52:55], a[216:223], v5
 ds_read_b128 v[48:51], v0 offset:28672
 s_waitcnt lgkmcnt(4)
 v_mov_b64 v[20:21], 0
 v_mov_b64 v[22:23], 0
 v_smfmac_f32_16x16x64_bf16 v[32:35], v[56:59], v[12:19], v5
 s_add_u32 s58, s36, 2
 s_min_u32 s58, s58, 64
 v_add_f32 v28, v28, v30
 v_add_f32 v29, v29, v31
 v_cvt_pk_bf16_f32 v25, v25, v29
 v_smfmac_f32_16x16x64_bf16 v[64:67], v[52:55], a[224:231], v5
 s_waitcnt lgkmcnt(2)
 s_xor_b32 s44, s44, 0x80000
 v_cvt_pk_bf16_f32 v24, v24, v28
 v_and_or_b32 v25, v25, -2, s46
 v_smfmac_f32_16x16x64_bf16 v[60:63], v[56:59], v[36:43], v5
 buffer_store_dwordx2 v[24:25], v6, s[20:23], s60 offen offset:2048 sc1
 v_add_f32 v32, v32, v34
 v_smfmac_f32_16x16x64_bf16 v[20:23], v[52:55], a[232:239], v5
 s_waitcnt lgkmcnt(0)
 s_xor_b32 s45, s45, 0x80000
 v_add_f32 v33, v33, v35
 v_smfmac_f32_16x16x64_bf16 v[64:67], v[56:59], v[44:51], v5
 s_xor_b32 s65, s65, 0x80000
 s_xor_b32 s66, s66, 0x80000
 v_add_f32 v60, v60, v62
 v_add_f32 v61, v61, v63
 v_smfmac_f32_16x16x64_bf16 v[20:23], v[56:59], a[240:247], v5
 s_cmp_eq_u32 s4, 0
 v_cvt_pk_bf16_f32 v33, v33, v61
 v_cvt_pk_bf16_f32 v32, v32, v60
 v_and_or_b32 v33, v33, -2, s46
 buffer_store_dwordx2 v[32:33], v6, s[20:23], s61 offen offset:0 sc1
 v_add_f32 v64, v64, v66
 v_add_f32 v65, v65, v67
 s_nop 0
 v_add_f32 v20, v20, v22
 v_add_f32 v21, v21, v23
 v_cvt_pk_bf16_f32 v65, v65, v21
 v_cvt_pk_bf16_f32 v64, v64, v20
 v_and_or_b32 v65, v65, -2, s46
 buffer_store_dwordx2 v[64:65], v6, s[20:23], s61 offen offset:2048 sc1
 s_cbranch_scc1 LwH_102
 s_cmp_eq_u32 s4, 1
 s_cbranch_scc1 Lw_103
 s_cmp_eq_u32 s4, 2
 s_cbranch_scc1 Lw_104
 s_xor_b32 s41, s41, 0x80000
 s_xor_b32 s43, s43, 0x80000
 v_mov_b32 v47, 0x3f80
 v_cndmask_b32 v47, v47, 1.0, s[32:33]
 v_cndmask_b32 v44, 0, v47, s[24:25]
 v_cndmask_b32 v45, 0, v47, s[26:27]
 v_cndmask_b32 v46, 0, v47, s[28:29]
 v_cndmask_b32 v47, 0, v47, s[30:31]
 v_bfe_u32 v52, v3, 8, 2
 v_bfe_u32 v58, v3, 2, 4
 v_lshl_or_b32 v52, v52, 4, v58
 v_and_b32 v58, 0xc0, v3
 v_lshl_or_b32 v52, v58, 24, v52
 v_subrev_u32 v0, 0x20000, v0
 v_mov_b32 v59, -1
 v_add_u32 v54, s42, v3
 v_add_u32 v58, s69, v9
 ds_read_b64 v[64:65], v58 offset:19456
 v_mov_b32 v66, v2
 v_mov_b32 v67, v4
 ds_read_b128 v[20:23], v0 offset:24576
 ds_read_b128 v[24:27], v0 offset:28672
 ds_read_b128 v[28:31], v0 offset:32768
 ds_read_b128 v[32:35], v0 offset:36864
 s_waitcnt vmcnt(0)
 buffer_load_dwordx4 v[36:39], v3, s[20:23], s39 offen offset:0 sc1
 buffer_load_dwordx4 v[40:43], v3, s[20:23], s39 offen offset:1024 sc1
 s_nop 15
 s_nop 10
 buffer_load_dwordx4 v[12:15], v3, s[20:23], s39 offen offset:0 sc1
 buffer_load_dwordx4 v[16:19], v3, s[20:23], s39 offen offset:1024 sc1
 s_waitcnt vmcnt(3)
 v_mfma_f32_16x16x32_bf16 v[48:51], v[44:47], v[36:39], 0
 s_waitcnt vmcnt(2)
 v_mfma_f32_16x16x32_bf16 v[48:51], v[44:47], v[40:43], v[48:51]
 v_bitop3_b32 v55, v37, v39, s46 bitop3:0x7e
 v_bitop3_b32 v56, v41, v43, s46 bitop3:0x7e
 v_bitop3_b32 v55, v55, 1, v56 bitop3:0xc8
 v_cmp_ne_u32 vcc, 0, v55
 s_nop 3
 v_add_f32_dpp v48, v48, v48 row_ror:4 row_mask:0xf bank_mask:0xf
 v_add_f32_dpp v49, v49, v49 row_ror:4 row_mask:0xf bank_mask:0xf
 s_cbranch_vccnz Lr2_106
 v_add_f32_dpp v48, v48, v48 row_ror:8 row_mask:0xf bank_mask:0xf
 v_add_f32_dpp v49, v49, v49 row_ror:8 row_mask:0xf bank_mask:0xf
 v_cvt_pk_bf16_f32 v48, v48, v49
 buffer_store_dword v48, v52, s[20:23], s44 offen sc1
Lb1_107:
 buffer_store_dword v59, v52, s[20:23], s45 offen sc1
 v_cmp_gt_u32 vcc, s58, v1
 v_mov_b64 v[36:37], 0
 v_mov_b64 v[38:39], 0
 v_mov_b64 v[40:41], 0
 v_mov_b64 v[42:43], 0
 v_mov_b64 v[44:45], 0
 v_mov_b64 v[46:47], 0
 v_mov_b64 v[48:49], 0
 v_mov_b64 v[50:51], 0
 s_cmp_lg_u32 vcc_hi, 0
 s_cbranch_scc1 Lfw_109
Lfok_108:
 v_lshl_add_u32 v1, v3, 3, s68
 v_mov_b32 v6, s56
 v_cndmask_b32 v1, v6, v1, s[70:71]
 v_min_u32 v6, 16, v0
 v_lshlrev_b32 v6, 24, v6
 s_max_u32 s47, s36, 1
 v_add_u32 v2, -1, s47
 s_nop 15
 s_nop 0
 buffer_load_dwordx4 v[12:15], v3, s[20:23], s41 offen offset:0 sc1
 buffer_load_dwordx4 v[16:19], v3, s[20:23], s41 offen offset:1024 sc1
 s_nop 15
 s_nop 7
Lp2_110:
 buffer_load_dwordx4 v[12:15], v3, s[20:23], s41 offen offset:0 sc1
 buffer_load_dwordx4 v[16:19], v3, s[20:23], s41 offen offset:1024 sc1
 s_waitcnt vmcnt(2)
 v_max3_u32 v55, v12, v13, v14
 v_max3_u32 v55, v55, v15, v16
 v_max3_u32 v55, v55, v17, v18
 v_max_u32 v55, v55, v19
 ds_write_b128 v54, v[12:15] offset:0
 ds_write_b128 v54, v[16:19] offset:1024
 v_cmpx_eq_u32 vcc, -1, v55
 s_cbranch_execz Lstep_98
 buffer_load_dwordx4 v[12:15], v3, s[20:23], s41 offen offset:0 sc1
 buffer_load_dwordx4 v[16:19], v3, s[20:23], s41 offen offset:1024 sc1
 s_waitcnt vmcnt(2)
 v_max3_u32 v55, v12, v13, v14
 v_max3_u32 v55, v55, v15, v16
 v_max3_u32 v55, v55, v17, v18
 v_max_u32 v55, v55, v19
 ds_write_b128 v54, v[12:15] offset:0
 ds_write_b128 v54, v[16:19] offset:1024
 v_cmpx_eq_u32 vcc, -1, v55
 s_cbranch_execz Lstep_98
 buffer_load_dwordx4 v[12:15], v3, s[20:23], s41 offen offset:0 sc1
 buffer_load_dwordx4 v[16:19], v3, s[20:23], s41 offen offset:1024 sc1
 s_waitcnt vmcnt(2)
 v_max3_u32 v55, v12, v13, v14
 v_max3_u32 v55, v55, v15, v16
 v_max3_u32 v55, v55, v17, v18
 v_max_u32 v55, v55, v19
 ds_write_b128 v54, v[12:15] offset:0
 ds_write_b128 v54, v[16:19] offset:1024
 v_cmpx_eq_u32 vcc, -1, v55
 s_cbranch_execz Lstep_98
 s_sub_u32 s54, s54, 1
 s_cbranch_scc0 Lp2_110
 s_endpgm
Lw_104:
 s_xor_b32 s41, s41, 0x80000
 s_xor_b32 s43, s43, 0x80000
 v_mov_b32 v47, 0x3f80
 v_cndmask_b32 v47, v47, 1.0, s[32:33]
 v_cndmask_b32 v44, 0, v47, s[24:25]
 v_cndmask_b32 v45, 0, v47, s[26:27]
 v_cndmask_b32 v46, 0, v47, s[28:29]
 v_cndmask_b32 v47, 0, v47, s[30:31]
 v_bfe_u32 v52, v3, 8, 2
 v_bfe_u32 v58, v3, 2, 4
 v_lshl_or_b32 v52, v52, 4, v58
 v_and_b32 v58, 0xc0, v3
 v_lshl_or_b32 v52, v58, 24, v52
 v_subrev_u32 v0, 0x20000, v0
 v_mov_b32 v59, -1
 v_add_u32 v54, s42, v3
 v_add_u32 v58, s69, v9
 ds_read_b64 v[64:65], v58 offset:19456
 v_mov_b32 v66, v2
 v_mov_b32 v67, v4
 ds_read_b128 v[20:23], v0 offset:24576
 ds_read_b128 v[24:27], v0 offset:28672
 ds_read_b128 v[28:31], v0 offset:32768
 ds_read_b128 v[32:35], v0 offset:36864
 s_waitcnt vmcnt(1)
 buffer_load_dwordx4 v[36:39], v3, s[20:23], s39 offen offset:0 sc1
 buffer_load_dwordx4 v[40:43], v3, s[20:23], s39 offen offset:1024 sc1
 s_nop 15
 s_nop 10
 buffer_load_dwordx4 v[12:15], v3, s[20:23], s39 offen offset:0 sc1
 buffer_load_dwordx4 v[16:19], v3, s[20:23], s39 offen offset:1024 sc1
 s_waitcnt vmcnt(3)
 v_mfma_f32_16x16x32_bf16 v[48:51], v[44:47], v[36:39], 0
 s_waitcnt vmcnt(2)
 v_mfma_f32_16x16x32_bf16 v[48:51], v[44:47], v[40:43], v[48:51]
 v_bitop3_b32 v55, v37, v39, s46 bitop3:0x7e
 v_bitop3_b32 v56, v41, v43, s46 bitop3:0x7e
 v_bitop3_b32 v55, v55, 1, v56 bitop3:0xc8
 v_cmp_ne_u32 vcc, 0, v55
 s_nop 3
 v_add_f32_dpp v48, v48, v48 row_ror:4 row_mask:0xf bank_mask:0xf
 v_add_f32_dpp v49, v49, v49 row_ror:4 row_mask:0xf bank_mask:0xf
 s_cbranch_vccnz Lr2_112
 v_add_f32_dpp v48, v48, v48 row_ror:8 row_mask:0xf bank_mask:0xf
 v_add_f32_dpp v49, v49, v49 row_ror:8 row_mask:0xf bank_mask:0xf
 v_cvt_pk_bf16_f32 v48, v48, v49
 buffer_store_dword v48, v52, s[20:23], s44 offen sc1
Lb1_113:
 buffer_store_dword v59, v52, s[20:23], s45 offen sc1
 v_cmp_gt_u32 vcc, s58, v1
 v_mov_b64 v[36:37], 0
 v_mov_b64 v[38:39], 0
 v_mov_b64 v[40:41], 0
 v_mov_b64 v[42:43], 0
 v_mov_b64 v[44:45], 0
 v_mov_b64 v[46:47], 0
 v_mov_b64 v[48:49], 0
 v_mov_b64 v[50:51], 0
 s_cmp_lg_u32 vcc_hi, 0
 s_cbranch_scc1 Lfw_115
Lfok_114:
 v_lshl_add_u32 v1, v3, 3, s68
 v_mov_b32 v6, s56
 v_cndmask_b32 v1, v6, v1, s[70:71]
 v_min_u32 v6, 16, v0
 v_lshlrev_b32 v6, 24, v6
 s_max_u32 s47, s36, 1
 v_add_u32 v2, -1, s47
 s_nop 15
 s_nop 0
 buffer_load_dwordx4 v[12:15], v3, s[20:23], s41 offen offset:0 sc1
 buffer_load_dwordx4 v[16:19], v3, s[20:23], s41 offen offset:1024 sc1
 s_nop 15
 s_nop 7
Lp2_116:
 buffer_load_dwordx4 v[12:15], v3, s[20:23], s41 offen offset:0 sc1
 buffer_load_dwordx4 v[16:19], v3, s[20:23], s41 offen offset:1024 sc1
 s_waitcnt vmcnt(2)
 v_max3_u32 v55, v12, v13, v14
 v_max3_u32 v55, v55, v15, v16
 v_max3_u32 v55, v55, v17, v18
 v_max_u32 v55, v55, v19
 ds_write_b128 v54, v[12:15] offset:0
 ds_write_b128 v54, v[16:19] offset:1024
 v_cmpx_eq_u32 vcc, -1, v55
 s_cbranch_execz Lstep_98
 buffer_load_dwordx4 v[12:15], v3, s[20:23], s41 offen offset:0 sc1
 buffer_load_dwordx4 v[16:19], v3, s[20:23], s41 offen offset:1024 sc1
 s_waitcnt vmcnt(2)
 v_max3_u32 v55, v12, v13, v14
 v_max3_u32 v55, v55, v15, v16
 v_max3_u32 v55, v55, v17, v18
 v_max_u32 v55, v55, v19
 ds_write_b128 v54, v[12:15] offset:0
 ds_write_b128 v54, v[16:19] offset:1024
 v_cmpx_eq_u32 vcc, -1, v55
 s_cbranch_execz Lstep_98
 buffer_load_dwordx4 v[12:15], v3, s[20:23], s41 offen offset:0 sc1
 buffer_load_dwordx4 v[16:19], v3, s[20:23], s41 offen offset:1024 sc1
 s_waitcnt vmcnt(2)
 v_max3_u32 v55, v12, v13, v14
 v_max3_u32 v55, v55, v15, v16
 v_max3_u32 v55, v55, v17, v18
 v_max_u32 v55, v55, v19
 ds_write_b128 v54, v[12:15] offset:0
 ds_write_b128 v54, v[16:19] offset:1024
 v_cmpx_eq_u32 vcc, -1, v55
 s_cbranch_execz Lstep_98
 s_sub_u32 s54, s54, 1
 s_cbranch_scc0 Lp2_116
 s_endpgm
Lw_103:
 s_xor_b32 s41, s41, 0x80000
 s_xor_b32 s43, s43, 0x80000
 v_mov_b32 v47, 0x3f80
 v_cndmask_b32 v47, v47, 1.0, s[32:33]
 v_cndmask_b32 v44, 0, v47, s[24:25]
 v_cndmask_b32 v45, 0, v47, s[26:27]
 v_cndmask_b32 v46, 0, v47, s[28:29]
 v_cndmask_b32 v47, 0, v47, s[30:31]
 v_bfe_u32 v52, v3, 8, 2
 v_bfe_u32 v58, v3, 2, 4
 v_lshl_or_b32 v52, v52, 4, v58
 v_and_b32 v58, 0xc0, v3
 v_lshl_or_b32 v52, v58, 24, v52
 v_subrev_u32 v0, 0x20000, v0
 v_mov_b32 v59, -1
 v_add_u32 v54, s42, v3
 v_add_u32 v58, s69, v9
 ds_read_b64 v[64:65], v58 offset:19456
 v_mov_b32 v66, v2
 v_mov_b32 v67, v4
 ds_read_b128 v[20:23], v0 offset:24576
 ds_read_b128 v[24:27], v0 offset:28672
 ds_read_b128 v[28:31], v0 offset:32768
 ds_read_b128 v[32:35], v0 offset:36864
 s_waitcnt vmcnt(2)
 buffer_load_dwordx4 v[36:39], v3, s[20:23], s39 offen offset:0 sc1
 buffer_load_dwordx4 v[40:43], v3, s[20:23], s39 offen offset:1024 sc1
 s_nop 15
 s_nop 10
 buffer_load_dwordx4 v[12:15], v3, s[20:23], s39 offen offset:0 sc1
 buffer_load_dwordx4 v[16:19], v3, s[20:23], s39 offen offset:1024 sc1
 s_waitcnt vmcnt(3)
 v_mfma_f32_16x16x32_bf16 v[48:51], v[44:47], v[36:39], 0
 s_waitcnt vmcnt(2)
 v_mfma_f32_16x16x32_bf16 v[48:51], v[44:47], v[40:43], v[48:51]
 v_bitop3_b32 v55, v37, v39, s46 bitop3:0x7e
 v_bitop3_b32 v56, v41, v43, s46 bitop3:0x7e
 v_bitop3_b32 v55, v55, 1, v56 bitop3:0xc8
 v_cmp_ne_u32 vcc, 0, v55
 s_nop 3
 v_add_f32_dpp v48, v48, v48 row_ror:4 row_mask:0xf bank_mask:0xf
 v_add_f32_dpp v49, v49, v49 row_ror:4 row_mask:0xf bank_mask:0xf
 s_cbranch_vccnz Lr2_118
 v_add_f32_dpp v48, v48, v48 row_ror:8 row_mask:0xf bank_mask:0xf
 v_add_f32_dpp v49, v49, v49 row_ror:8 row_mask:0xf bank_mask:0xf
 v_cvt_pk_bf16_f32 v48, v48, v49
 buffer_store_dword v48, v52, s[20:23], s44 offen sc1
Lb1_119:
 buffer_store_dword v59, v52, s[20:23], s45 offen sc1
 v_cmp_gt_u32 vcc, s58, v1
 v_mov_b64 v[36:37], 0
 v_mov_b64 v[38:39], 0
 v_mov_b64 v[40:41], 0
 v_mov_b64 v[42:43], 0
 v_mov_b64 v[44:45], 0
 v_mov_b64 v[46:47], 0
 v_mov_b64 v[48:49], 0
 v_mov_b64 v[50:51], 0
 s_cmp_lg_u32 vcc_hi, 0
 s_cbranch_scc1 Lfw_121
Lfok_120:
 v_lshl_add_u32 v1, v3, 3, s68
 v_mov_b32 v6, s56
 v_cndmask_b32 v1, v6, v1, s[70:71]
 v_min_u32 v6, 16, v0
 v_lshlrev_b32 v6, 24, v6
 s_max_u32 s47, s36, 1
 v_add_u32 v2, -1, s47
 s_nop 15
 s_nop 0
 buffer_load_dwordx4 v[12:15], v3, s[20:23], s41 offen offset:0 sc1
 buffer_load_dwordx4 v[16:19], v3, s[20:23], s41 offen offset:1024 sc1
 s_nop 15
 s_nop 7
Lp2_122:
 buffer_load_dwordx4 v[12:15], v3, s[20:23], s41 offen offset:0 sc1
 buffer_load_dwordx4 v[16:19], v3, s[20:23], s41 offen offset:1024 sc1
 s_waitcnt vmcnt(2)
 v_max3_u32 v55, v12, v13, v14
 v_max3_u32 v55, v55, v15, v16
 v_max3_u32 v55, v55, v17, v18
 v_max_u32 v55, v55, v19
 ds_write_b128 v54, v[12:15] offset:0
 ds_write_b128 v54, v[16:19] offset:1024
 v_cmpx_eq_u32 vcc, -1, v55
 s_cbranch_execz Lstep_98
 buffer_load_dwordx4 v[12:15], v3, s[20:23], s41 offen offset:0 sc1
 buffer_load_dwordx4 v[16:19], v3, s[20:23], s41 offen offset:1024 sc1
 s_waitcnt vmcnt(2)
 v_max3_u32 v55, v12, v13, v14
 v_max3_u32 v55, v55, v15, v16
 v_max3_u32 v55, v55, v17, v18
 v_max_u32 v55, v55, v19
 ds_write_b128 v54, v[12:15] offset:0
 ds_write_b128 v54, v[16:19] offset:1024
 v_cmpx_eq_u32 vcc, -1, v55
 s_cbranch_execz Lstep_98
 buffer_load_dwordx4 v[12:15], v3, s[20:23], s41 offen offset:0 sc1
 buffer_load_dwordx4 v[16:19], v3, s[20:23], s41 offen offset:1024 sc1
 s_waitcnt vmcnt(2)
 v_max3_u32 v55, v12, v13, v14
 v_max3_u32 v55, v55, v15, v16
 v_max3_u32 v55, v55, v17, v18
 v_max_u32 v55, v55, v19
 ds_write_b128 v54, v[12:15] offset:0
 ds_write_b128 v54, v[16:19] offset:1024
 v_cmpx_eq_u32 vcc, -1, v55
 s_cbranch_execz Lstep_98
 s_sub_u32 s54, s54, 1
 s_cbranch_scc0 Lp2_122
 s_endpgm
LwH_102:
 v_bfe_u32 v53, v3, 8, 1
 v_bfe_u32 v58, v3, 9, 1
 v_lshl_or_b32 v53, v53, 1, v58
 v_bfe_u32 v58, v3, 5, 1
 v_lshl_or_b32 v53, v53, 1, v58
 v_and_b32 v58, 0xd0, v3
 v_lshlrev_b32 v58, 24, v58
 v_lshl_or_b32 v53, v53, 2, v58
 s_waitcnt vmcnt(2)
 buffer_load_dwordx4 v[20:23], v3, s[20:23], s40 offen offset:0 sc1
 buffer_load_dwordx4 v[24:27], v3, s[20:23], s40 offen offset:1024 sc1
 buffer_load_dwordx4 v[36:39], v3, s[20:23], s39 offen offset:0 sc1
 buffer_load_dwordx4 v[40:43], v3, s[20:23], s39 offen offset:1024 sc1
 s_xor_b32 s41, s41, 0x80000
 s_xor_b32 s43, s43, 0x80000
 v_mov_b32 v47, 0x3f80
 v_cndmask_b32 v47, v47, 1.0, s[32:33]
 v_cndmask_b32 v44, 0, v47, s[24:25]
 v_cndmask_b32 v45, 0, v47, s[26:27]
 v_cndmask_b32 v46, 0, v47, s[28:29]
 v_cndmask_b32 v47, 0, v47, s[30:31]
 v_bfe_u32 v52, v3, 8, 2
 v_bfe_u32 v58, v3, 2, 4
 v_lshl_or_b32 v52, v52, 4, v58
 v_and_b32 v58, 0xc0, v3
 v_lshl_or_b32 v52, v58, 24, v52
 v_subrev_u32 v0, 0x20000, v0
 v_mov_b32 v59, -1
 v_add_u32 v54, s42, v3
 v_add_u32 v58, s69, v9
 ds_read_b64 v[64:65], v58 offset:19456
 v_mov_b32 v66, v2
 v_mov_b32 v67, v4
 s_waitcnt vmcnt(2)
 v_mfma_f32_16x16x32_bf16 v[28:31], v[44:47], v[20:23], 0
 v_mfma_f32_16x16x32_bf16 v[28:31], v[44:47], v[24:27], v[28:31]
 s_waitcnt vmcnt(1)
 v_mfma_f32_16x16x32_bf16 v[48:51], v[44:47], v[36:39], 0
 s_waitcnt vmcnt(0)
 v_mfma_f32_16x16x32_bf16 v[48:51], v[44:47], v[40:43], v[48:51]
 v_bitop3_b32 v55, v37, v39, s46 bitop3:0x7e
 v_bitop3_b32 v56, v41, v43, s46 bitop3:0x7e
 v_bitop3_b32 v57, v21, v23, s46 bitop3:0x7e
 v_or3_b32 v55, v55, v56, v57
 v_bitop3_b32 v56, v25, v27, s46 bitop3:0x7e
 v_bitop3_b32 v55, v55, 1, v56 bitop3:0xc8
 v_cmp_ne_u32 vcc, 0, v55
 v_add_f32_dpp v29, v29, v29 row_ror:4 row_mask:0xf bank_mask:0xf
 v_add_f32_dpp v48, v48, v48 row_ror:4 row_mask:0xf bank_mask:0xf
 v_add_f32_dpp v49, v49, v49 row_ror:4 row_mask:0xf bank_mask:0xf
 v_add_f32_dpp v29, v29, v29 row_ror:8 row_mask:0xf bank_mask:0xf
 v_add_f32_dpp v48, v48, v48 row_ror:8 row_mask:0xf bank_mask:0xf
 v_add_f32_dpp v49, v49, v49 row_ror:8 row_mask:0xf bank_mask:0xf
 s_cbranch_vccnz Lr1_123
 v_cvt_pk_bf16_f32 v48, v48, v49
 buffer_store_dword v48, v52, s[20:23], s44 offen sc1
 v_mov_b32_dpp v30, v29 quad_perm:[1,0,3,2] row_mask:0xf bank_mask:0xf
 v_cvt_pk_bf16_f32 v29, v29, v30
 buffer_store_dword v29, v53, s[20:23], s65 offen sc1
Lb1_124:
 buffer_store_dword v59, v52, s[20:23], s45 offen sc1
 buffer_store_dword v59, v53, s[20:23], s66 offen sc1
 v_cmp_gt_u32 vcc, s58, v1
 ds_read_b128 v[20:23], v0 offset:24576
 ds_read_b128 v[24:27], v0 offset:28672
 ds_read_b128 v[28:31], v0 offset:32768
 ds_read_b128 v[32:35], v0 offset:36864
 v_mov_b64 v[36:37], 0
 v_mov_b64 v[38:39], 0
 v_mov_b64 v[40:41], 0
 v_mov_b64 v[42:43], 0
 v_mov_b64 v[44:45], 0
 v_mov_b64 v[46:47], 0
 v_mov_b64 v[48:49], 0
 v_mov_b64 v[50:51], 0
 s_cmp_lg_u32 vcc_hi, 0
 s_cbranch_scc1 Lfw_126
Lfok_125:
 v_lshl_add_u32 v1, v3, 3, s68
 v_mov_b32 v6, s56
 v_cndmask_b32 v1, v6, v1, s[70:71]
 v_min_u32 v6, 16, v0
 v_lshlrev_b32 v6, 24, v6
 s_max_u32 s47, s36, 1
 v_add_u32 v2, -1, s47
 s_nop 10
 buffer_load_dwordx4 v[12:15], v3, s[20:23], s41 offen offset:0 sc1
 buffer_load_dwordx4 v[16:19], v3, s[20:23], s41 offen offset:1024 sc1
 buffer_load_dwordx4 v[68:71], v3, s[20:23], s43 offen offset:0 sc1
 s_nop 15
 s_nop 7
Lp2_127:
 buffer_load_dwordx4 v[12:15], v3, s[20:23], s41 offen offset:0 sc1
 buffer_load_dwordx4 v[16:19], v3, s[20:23], s41 offen offset:1024 sc1
 buffer_load_dwordx4 v[68:71], v3, s[20:23], s43 offen offset:0 sc1
 s_waitcnt vmcnt(3)
 v_max3_u32 v55, v12, v13, v14
 v_max3_u32 v55, v55, v15, v16
 v_max3_u32 v55, v55, v17, v18
 v_max3_u32 v55, v55, v19, v68
 v_max3_u32 v55, v55, v69, v70
 v_max_u32 v55, v55, v71
 ds_write_b128 v54, v[12:15] offset:0
 ds_write_b128 v54, v[16:19] offset:1024
 ds_write_b128 v54, v[68:71] offset:8192
 v_cmpx_eq_u32 vcc, -1, v55
 s_cbranch_execz Lstep_98
 buffer_load_dwordx4 v[12:15], v3, s[20:23], s41 offen offset:0 sc1
 buffer_load_dwordx4 v[16:19], v3, s[20:23], s41 offen offset:1024 sc1
 buffer_load_dwordx4 v[68:71], v3, s[20:23], s43 offen offset:0 sc1
 s_waitcnt vmcnt(3)
 v_max3_u32 v55, v12, v13, v14
 v_max3_u32 v55, v55, v15, v16
 v_max3_u32 v55, v55, v17, v18
 v_max3_u32 v55, v55, v19, v68
 v_max3_u32 v55, v55, v69, v70
 v_max_u32 v55, v55, v71
 ds_write_b128 v54, v[12:15] offset:0
 ds_write_b128 v54, v[16:19] offset:1024
 ds_write_b128 v54, v[68:71] offset:8192
 v_cmpx_eq_u32 vcc, -1, v55
 s_cbranch_execz Lstep_98
 buffer_load_dwordx4 v[12:15], v3, s[20:23], s41 offen offset:0 sc1
 buffer_load_dwordx4 v[16:19], v3, s[20:23], s41 offen offset:1024 sc1
 buffer_load_dwordx4 v[68:71], v3, s[20:23], s43 offen offset:0 sc1
 s_waitcnt vmcnt(3)
 v_max3_u32 v55, v12, v13, v14
 v_max3_u32 v55, v55, v15, v16
 v_max3_u32 v55, v55, v17, v18
 v_max3_u32 v55, v55, v19, v68
 v_max3_u32 v55, v55, v69, v70
 v_max_u32 v55, v55, v71
 ds_write_b128 v54, v[12:15] offset:0
 ds_write_b128 v54, v[16:19] offset:1024
 ds_write_b128 v54, v[68:71] offset:8192
 v_cmpx_eq_u32 vcc, -1, v55
 s_cbranch_execz Lstep_98
 s_sub_u32 s54, s54, 1
 s_cbranch_scc0 Lp2_127
 s_endpgm
Lr1_123:
 s_mov_b64 exec, vcc
Lrt_128:
 buffer_load_dwordx4 v[20:23], v3, s[20:23], s40 offen offset:0 sc1
 buffer_load_dwordx4 v[24:27], v3, s[20:23], s40 offen offset:1024 sc1
 buffer_load_dwordx4 v[36:39], v3, s[20:23], s39 offen offset:0 sc1
 buffer_load_dwordx4 v[40:43], v3, s[20:23], s39 offen offset:1024 sc1
 s_waitcnt vmcnt(4)
 v_bitop3_b32 v55, v37, v39, s46 bitop3:0x7e
 v_bitop3_b32 v56, v41, v43, s46 bitop3:0x7e
 v_bitop3_b32 v57, v21, v23, s46 bitop3:0x7e
 v_or3_b32 v55, v55, v56, v57
 v_bitop3_b32 v56, v25, v27, s46 bitop3:0x7e
 v_bitop3_b32 v55, v55, 1, v56 bitop3:0xc8
 v_cmpx_ne_u32 vcc, 0, v55
 s_cbranch_execz Lrte_129
 buffer_load_dwordx4 v[20:23], v3, s[20:23], s40 offen offset:0 sc1
 buffer_load_dwordx4 v[24:27], v3, s[20:23], s40 offen offset:1024 sc1
 buffer_load_dwordx4 v[36:39], v3, s[20:23], s39 offen offset:0 sc1
 buffer_load_dwordx4 v[40:43], v3, s[20:23], s39 offen offset:1024 sc1
 s_waitcnt vmcnt(4)
 v_bitop3_b32 v55, v37, v39, s46 bitop3:0x7e
 v_bitop3_b32 v56, v41, v43, s46 bitop3:0x7e
 v_bitop3_b32 v57, v21, v23, s46 bitop3:0x7e
 v_or3_b32 v55, v55, v56, v57
 v_bitop3_b32 v56, v25, v27, s46 bitop3:0x7e
 v_bitop3_b32 v55, v55, 1, v56 bitop3:0xc8
 v_cmpx_ne_u32 vcc, 0, v55
 s_cbranch_execz Lrte_129
 buffer_load_dwordx4 v[20:23], v3, s[20:23], s40 offen offset:0 sc1
 buffer_load_dwordx4 v[24:27], v3, s[20:23], s40 offen offset:1024 sc1
 buffer_load_dwordx4 v[36:39], v3, s[20:23], s39 offen offset:0 sc1
 buffer_load_dwordx4 v[40:43], v3, s[20:23], s39 offen offset:1024 sc1
 s_waitcnt vmcnt(4)
 v_bitop3_b32 v55, v37, v39, s46 bitop3:0x7e
 v_bitop3_b32 v56, v41, v43, s46 bitop3:0x7e
 v_bitop3_b32 v57, v21, v23, s46 bitop3:0x7e
 v_or3_b32 v55, v55, v56, v57
 v_bitop3_b32 v56, v25, v27, s46 bitop3:0x7e
 v_bitop3_b32 v55, v55, 1, v56 bitop3:0xc8
 v_cmpx_ne_u32 vcc, 0, v55
 s_cbranch_execz Lrte_129
 s_sub_u32 s54, s54, 1
 s_cbranch_scc0 Lrt_128
 s_endpgm
Lrte_129:
 s_mov_b64 exec, -1
 s_nop 2
 v_mfma_f32_16x16x32_bf16 v[28:31], v[44:47], v[20:23], 0
 v_mfma_f32_16x16x32_bf16 v[28:31], v[44:47], v[24:27], v[28:31]
 v_mfma_f32_16x16x32_bf16 v[48:51], v[44:47], v[36:39], 0
 v_mfma_f32_16x16x32_bf16 v[48:51], v[44:47], v[40:43], v[48:51]
 s_nop 6
 v_add_f32_dpp v29, v29, v29 row_ror:4 row_mask:0xf bank_mask:0xf
 v_add_f32_dpp v48, v48, v48 row_ror:4 row_mask:0xf bank_mask:0xf
 v_add_f32_dpp v49, v49, v49 row_ror:4 row_mask:0xf bank_mask:0xf
 v_add_f32_dpp v29, v29, v29 row_ror:8 row_mask:0xf bank_mask:0xf
 v_add_f32_dpp v48, v48, v48 row_ror:8 row_mask:0xf bank_mask:0xf
 v_add_f32_dpp v49, v49, v49 row_ror:8 row_mask:0xf bank_mask:0xf
 v_cvt_pk_bf16_f32 v48, v48, v49
 buffer_store_dword v48, v52, s[20:23], s44 offen sc1
 v_mov_b32_dpp v30, v29 quad_perm:[1,0,3,2] row_mask:0xf bank_mask:0xf
 v_cvt_pk_bf16_f32 v29, v29, v30
 buffer_store_dword v29, v53, s[20:23], s65 offen sc1
 s_waitcnt vmcnt(2)
 s_branch Lb1_124
Lmx_100:
 s_waitcnt lgkmcnt(0)
 ds_read_b128 v[36:39], v11 offset:17408
 ds_read_b128 v[40:43], v11 offset:17920
 ds_read_b128 v[44:47], v11 offset:18432
 ds_read_b128 v[48:51], v11 offset:18944
 v_mov_b64 v[28:29], 0
 v_mov_b64 v[30:31], 0
 ds_read_b128 v[52:55], v3 offset:9216
 ds_read_b128 v[56:59], v3 offset:10240
 s_waitcnt lgkmcnt(0)
 v_mfma_f32_16x16x32_bf16 v[20:23], v[52:55], v[36:39], 0
 v_mfma_f32_16x16x32_bf16 v[24:27], v[56:59], v[36:39], 0
 ds_read_b128 v[52:55], v3 offset:11264
 ds_read_b128 v[56:59], v3 offset:12288
 s_waitcnt lgkmcnt(0)
 v_mfma_f32_16x16x32_bf16 v[20:23], v[52:55], v[40:43], v[20:23]
 v_mfma_f32_16x16x32_bf16 v[24:27], v[56:59], v[40:43], v[24:27]
 ds_read_b128 v[52:55], v3 offset:13312
 ds_read_b128 v[56:59], v3 offset:14336
 s_waitcnt lgkmcnt(0)
 v_mfma_f32_16x16x32_bf16 v[20:23], v[52:55], v[44:47], v[20:23]
 v_mfma_f32_16x16x32_bf16 v[24:27], v[56:59], v[44:47], v[24:27]
 ds_read_b128 v[52:55], v3 offset:15360
 ds_read_b128 v[56:59], v3 offset:16384
 s_waitcnt lgkmcnt(0)
 v_mfma_f32_16x16x32_bf16 v[20:23], v[52:55], v[48:51], v[20:23]
 v_mfma_f32_16x16x32_bf16 v[24:27], v[56:59], v[48:51], v[24:27]
 ds_read_b128 v[52:55], v9 offset:19456
 ds_read_b128 v[56:59], v9 offset:21504
 s_waitcnt lgkmcnt(0)
 v_smfmac_f32_16x16x64_bf16 v[28:31], v[52:55], v[36:43], v5
 v_smfmac_f32_16x16x64_bf16 v[28:31], v[56:59], v[44:51], v5
 ds_read_b128 v[36:39], v0 offset:32768
 ds_read_b128 v[40:43], v0 offset:36864
 ds_read_b128 v[44:47], v0 offset:40960
 ds_read_b128 v[48:51], v0 offset:45056
 v_mov_b64 v[32:33], s[34:35]
 v_mov_b64 v[34:35], s[34:35]
 s_nop 1
 v_add_f32 v28, v28, v30
 v_add_f32 v29, v29, v31
 v_mul_f32 v28, s55, v28
 v_mul_f32 v29, s55, v29
 v_max_f32 v30, v28, v29
 v_cndmask_b32 v28, v28, v29, s[48:49]
 v_max3_f32 v30, v30, v20, v21
 v_max3_f32 v30, v30, v22, v23
 v_max3_f32 v30, v30, v24, v25
 v_max3_f32 v31, v30, v26, v27
 v_max3_f32 v29, v30, v26, v27
 v_cndmask_b32 v20, v20, v24, s[48:49]
 v_cndmask_b32 v21, v21, v25, s[48:49]
 v_permlane16_swap_b32 v31, v29
 v_max_f32 v30, v31, v29
 v_max_f32 v6, v31, v29
 v_cndmask_b32 v22, v22, v26, s[48:49]
 v_cndmask_b32 v23, v23, v27, s[48:49]
 v_permlane32_swap_b32 v30, v6
 v_max_f32 v30, v30, v6
 v_sub_f32 v28, v28, v30
 v_sub_f32 v20, v20, v30
 v_sub_f32 v21, v21, v30
 v_sub_f32 v22, v22, v30
 v_sub_f32 v23, v23, v30
 v_exp_f32 v28, v28
 v_exp_f32 v20, v20
 v_exp_f32 v21, v21
 v_exp_f32 v22, v22
 v_exp_f32 v23, v23
 v_cndmask_b32 v29, 0, v28, s[48:49]
 v_cndmask_b32 v28, v28, 0, s[48:49]
 v_cvt_pk_bf16_f32 v6, v28, v29
 v_cvt_pk_bf16_f32 v30, v20, v21
 v_cvt_pk_bf16_f32 v31, v22, v23
 v_mfma_f32_16x16x16_bf16 v[60:63], v[6:7], v[32:33], 0
 v_mfma_f32_16x16x16_bf16 v[52:55], v[6:7], v[2:3], 0
 v_mfma_f32_16x16x16_bf16 v[56:59], v[6:7], v[4:5], 0
 v_smfmac_f32_16x16x32_bf16 v[60:63], v[30:31], v[32:35], v5
 v_smfmac_f32_16x16x32_bf16 v[52:55], v[30:31], v[12:15], v5
 v_smfmac_f32_16x16x32_bf16 v[56:59], v[30:31], v[16:19], v5
 s_nop 0
 v_add_f32 v60, v60, v62
 v_add_f32 v61, v61, v63
 v_rcp_f32 v60, v60
 v_rcp_f32 v61, v61
 v_add_f32 v52, v52, v54
 v_add_f32 v53, v53, v55
 v_mul_f32 v52, v52, v60
 v_mul_f32 v53, v53, v61
 v_add_f32 v56, v56, v58
 v_add_f32 v57, v57, v59
 v_mul_f32 v56, v56, v60
 v_mul_f32 v57, v57, v61
 v_cvt_pk_bf16_f32 v52, v52, v56
 v_cvt_pk_bf16_f32 v53, v53, v57
 ds_write2_b32 v8, v52, v53 offset0:128 offset1:144
 v_mov_b64 v[20:21], 0
 v_mov_b64 v[22:23], 0
 v_mov_b64 v[24:25], 0
 v_mov_b64 v[26:27], 0
 v_mov_b64 v[28:29], 0
 v_mov_b64 v[30:31], 0
 v_mov_b64 v[32:33], 0
 v_mov_b64 v[34:35], 0
 s_waitcnt lgkmcnt(0)
 s_branch Lmxb_101
Lr2_106:
 s_waitcnt vmcnt(1)
 v_mfma_f32_16x16x32_bf16 v[48:51], v[44:47], v[12:15], 0
 s_waitcnt vmcnt(0)
 v_mfma_f32_16x16x32_bf16 v[48:51], v[44:47], v[16:19], v[48:51]
 v_bitop3_b32 v55, v13, v15, s46 bitop3:0x7e
 v_bitop3_b32 v56, v17, v19, s46 bitop3:0x7e
 v_bitop3_b32 v55, v55, 1, v56 bitop3:0xc8
 v_cmp_ne_u32 vcc, 0, v55
 s_nop 3
 v_add_f32_dpp v48, v48, v48 row_ror:4 row_mask:0xf bank_mask:0xf
 v_add_f32_dpp v49, v49, v49 row_ror:4 row_mask:0xf bank_mask:0xf
 s_cbranch_vccnz Lr1_105
 v_add_f32_dpp v48, v48, v48 row_ror:8 row_mask:0xf bank_mask:0xf
 v_add_f32_dpp v49, v49, v49 row_ror:8 row_mask:0xf bank_mask:0xf
 v_cvt_pk_bf16_f32 v48, v48, v49
 buffer_store_dword v48, v52, s[20:23], s44 offen sc1
 s_branch Lb1_107
Lr1_105:
 s_mov_b64 exec, vcc
Lrt_130:
 buffer_load_dwordx4 v[12:15], v3, s[20:23], s39 offen offset:0 sc1
 buffer_load_dwordx4 v[16:19], v3, s[20:23], s39 offen offset:1024 sc1
 s_waitcnt vmcnt(2)
 v_bitop3_b32 v55, v13, v15, s46 bitop3:0x7e
 v_bitop3_b32 v56, v17, v19, s46 bitop3:0x7e
 v_bitop3_b32 v55, v55, 1, v56 bitop3:0xc8
 v_cmpx_ne_u32 vcc, 0, v55
 s_cbranch_execz Lrte_131
 buffer_load_dwordx4 v[12:15], v3, s[20:23], s39 offen offset:0 sc1
 buffer_load_dwordx4 v[16:19], v3, s[20:23], s39 offen offset:1024 sc1
 s_waitcnt vmcnt(2)
 v_bitop3_b32 v55, v13, v15, s46 bitop3:0x7e
 v_bitop3_b32 v56, v17, v19, s46 bitop3:0x7e
 v_bitop3_b32 v55, v55, 1, v56 bitop3:0xc8
 v_cmpx_ne_u32 vcc, 0, v55
 s_cbranch_execz Lrte_131
 buffer_load_dwordx4 v[12:15], v3, s[20:23], s39 offen offset:0 sc1
 buffer_load_dwordx4 v[16:19], v3, s[20:23], s39 offen offset:1024 sc1
 s_waitcnt vmcnt(2)
 v_bitop3_b32 v55, v13, v15, s46 bitop3:0x7e
 v_bitop3_b32 v56, v17, v19, s46 bitop3:0x7e
 v_bitop3_b32 v55, v55, 1, v56 bitop3:0xc8
 v_cmpx_ne_u32 vcc, 0, v55
 s_cbranch_execz Lrte_131
 s_sub_u32 s54, s54, 1
 s_cbranch_scc0 Lrt_130
 s_endpgm
Lrte_131:
 s_mov_b64 exec, -1
 s_nop 2
 v_mfma_f32_16x16x32_bf16 v[48:51], v[44:47], v[12:15], 0
 v_mfma_f32_16x16x32_bf16 v[48:51], v[44:47], v[16:19], v[48:51]
 s_nop 7
 v_add_f32_dpp v48, v48, v48 row_ror:4 row_mask:0xf bank_mask:0xf
 v_add_f32_dpp v49, v49, v49 row_ror:4 row_mask:0xf bank_mask:0xf
 s_nop 0
 v_add_f32_dpp v48, v48, v48 row_ror:8 row_mask:0xf bank_mask:0xf
 v_add_f32_dpp v49, v49, v49 row_ror:8 row_mask:0xf bank_mask:0xf
 v_cvt_pk_bf16_f32 v48, v48, v49
 buffer_store_dword v48, v52, s[20:23], s44 offen sc1
 s_branch Lb1_107
Lr2_112:
 s_waitcnt vmcnt(1)
 v_mfma_f32_16x16x32_bf16 v[48:51], v[44:47], v[12:15], 0
 s_waitcnt vmcnt(0)
 v_mfma_f32_16x16x32_bf16 v[48:51], v[44:47], v[16:19], v[48:51]
 v_bitop3_b32 v55, v13, v15, s46 bitop3:0x7e
 v_bitop3_b32 v56, v17, v19, s46 bitop3:0x7e
 v_bitop3_b32 v55, v55, 1, v56 bitop3:0xc8
 v_cmp_ne_u32 vcc, 0, v55
 s_nop 3
 v_add_f32_dpp v48, v48, v48 row_ror:4 row_mask:0xf bank_mask:0xf
 v_add_f32_dpp v49, v49, v49 row_ror:4 row_mask:0xf bank_mask:0xf
 s_cbranch_vccnz Lr1_111
 v_add_f32_dpp v48, v48, v48 row_ror:8 row_mask:0xf bank_mask:0xf
 v_add_f32_dpp v49, v49, v49 row_ror:8 row_mask:0xf bank_mask:0xf
 v_cvt_pk_bf16_f32 v48, v48, v49
 buffer_store_dword v48, v52, s[20:23], s44 offen sc1
 s_branch Lb1_113
Lr1_111:
 s_mov_b64 exec, vcc
Lrt_132:
 buffer_load_dwordx4 v[12:15], v3, s[20:23], s39 offen offset:0 sc1
 buffer_load_dwordx4 v[16:19], v3, s[20:23], s39 offen offset:1024 sc1
 s_waitcnt vmcnt(2)
 v_bitop3_b32 v55, v13, v15, s46 bitop3:0x7e
 v_bitop3_b32 v56, v17, v19, s46 bitop3:0x7e
 v_bitop3_b32 v55, v55, 1, v56 bitop3:0xc8
 v_cmpx_ne_u32 vcc, 0, v55
 s_cbranch_execz Lrte_133
 buffer_load_dwordx4 v[12:15], v3, s[20:23], s39 offen offset:0 sc1
 buffer_load_dwordx4 v[16:19], v3, s[20:23], s39 offen offset:1024 sc1
 s_waitcnt vmcnt(2)
 v_bitop3_b32 v55, v13, v15, s46 bitop3:0x7e
 v_bitop3_b32 v56, v17, v19, s46 bitop3:0x7e
 v_bitop3_b32 v55, v55, 1, v56 bitop3:0xc8
 v_cmpx_ne_u32 vcc, 0, v55
 s_cbranch_execz Lrte_133
 buffer_load_dwordx4 v[12:15], v3, s[20:23], s39 offen offset:0 sc1
 buffer_load_dwordx4 v[16:19], v3, s[20:23], s39 offen offset:1024 sc1
 s_waitcnt vmcnt(2)
 v_bitop3_b32 v55, v13, v15, s46 bitop3:0x7e
 v_bitop3_b32 v56, v17, v19, s46 bitop3:0x7e
 v_bitop3_b32 v55, v55, 1, v56 bitop3:0xc8
 v_cmpx_ne_u32 vcc, 0, v55
 s_cbranch_execz Lrte_133
 s_sub_u32 s54, s54, 1
 s_cbranch_scc0 Lrt_132
 s_endpgm
Lrte_133:
 s_mov_b64 exec, -1
 s_nop 2
 v_mfma_f32_16x16x32_bf16 v[48:51], v[44:47], v[12:15], 0
 v_mfma_f32_16x16x32_bf16 v[48:51], v[44:47], v[16:19], v[48:51]
 s_nop 7
 v_add_f32_dpp v48, v48, v48 row_ror:4 row_mask:0xf bank_mask:0xf
 v_add_f32_dpp v49, v49, v49 row_ror:4 row_mask:0xf bank_mask:0xf
 s_nop 0
 v_add_f32_dpp v48, v48, v48 row_ror:8 row_mask:0xf bank_mask:0xf
 v_add_f32_dpp v49, v49, v49 row_ror:8 row_mask:0xf bank_mask:0xf
 v_cvt_pk_bf16_f32 v48, v48, v49
 buffer_store_dword v48, v52, s[20:23], s44 offen sc1
 s_branch Lb1_113
Lr2_118:
 s_waitcnt vmcnt(1)
 v_mfma_f32_16x16x32_bf16 v[48:51], v[44:47], v[12:15], 0
 s_waitcnt vmcnt(0)
 v_mfma_f32_16x16x32_bf16 v[48:51], v[44:47], v[16:19], v[48:51]
 v_bitop3_b32 v55, v13, v15, s46 bitop3:0x7e
 v_bitop3_b32 v56, v17, v19, s46 bitop3:0x7e
 v_bitop3_b32 v55, v55, 1, v56 bitop3:0xc8
 v_cmp_ne_u32 vcc, 0, v55
 s_nop 3
 v_add_f32_dpp v48, v48, v48 row_ror:4 row_mask:0xf bank_mask:0xf
 v_add_f32_dpp v49, v49, v49 row_ror:4 row_mask:0xf bank_mask:0xf
 s_cbranch_vccnz Lr1_117
 v_add_f32_dpp v48, v48, v48 row_ror:8 row_mask:0xf bank_mask:0xf
 v_add_f32_dpp v49, v49, v49 row_ror:8 row_mask:0xf bank_mask:0xf
 v_cvt_pk_bf16_f32 v48, v48, v49
 buffer_store_dword v48, v52, s[20:23], s44 offen sc1
 s_branch Lb1_119
Lr1_117:
 s_mov_b64 exec, vcc
Lrt_134:
 buffer_load_dwordx4 v[12:15], v3, s[20:23], s39 offen offset:0 sc1
 buffer_load_dwordx4 v[16:19], v3, s[20:23], s39 offen offset:1024 sc1
 s_waitcnt vmcnt(2)
 v_bitop3_b32 v55, v13, v15, s46 bitop3:0x7e
 v_bitop3_b32 v56, v17, v19, s46 bitop3:0x7e
 v_bitop3_b32 v55, v55, 1, v56 bitop3:0xc8
 v_cmpx_ne_u32 vcc, 0, v55
 s_cbranch_execz Lrte_135
 buffer_load_dwordx4 v[12:15], v3, s[20:23], s39 offen offset:0 sc1
 buffer_load_dwordx4 v[16:19], v3, s[20:23], s39 offen offset:1024 sc1
 s_waitcnt vmcnt(2)
 v_bitop3_b32 v55, v13, v15, s46 bitop3:0x7e
 v_bitop3_b32 v56, v17, v19, s46 bitop3:0x7e
 v_bitop3_b32 v55, v55, 1, v56 bitop3:0xc8
 v_cmpx_ne_u32 vcc, 0, v55
 s_cbranch_execz Lrte_135
 buffer_load_dwordx4 v[12:15], v3, s[20:23], s39 offen offset:0 sc1
 buffer_load_dwordx4 v[16:19], v3, s[20:23], s39 offen offset:1024 sc1
 s_waitcnt vmcnt(2)
 v_bitop3_b32 v55, v13, v15, s46 bitop3:0x7e
 v_bitop3_b32 v56, v17, v19, s46 bitop3:0x7e
 v_bitop3_b32 v55, v55, 1, v56 bitop3:0xc8
 v_cmpx_ne_u32 vcc, 0, v55
 s_cbranch_execz Lrte_135
 s_sub_u32 s54, s54, 1
 s_cbranch_scc0 Lrt_134
 s_endpgm
Lrte_135:
 s_mov_b64 exec, -1
 s_nop 2
 v_mfma_f32_16x16x32_bf16 v[48:51], v[44:47], v[12:15], 0
 v_mfma_f32_16x16x32_bf16 v[48:51], v[44:47], v[16:19], v[48:51]
 s_nop 7
 v_add_f32_dpp v48, v48, v48 row_ror:4 row_mask:0xf bank_mask:0xf
 v_add_f32_dpp v49, v49, v49 row_ror:4 row_mask:0xf bank_mask:0xf
 s_nop 0
 v_add_f32_dpp v48, v48, v48 row_ror:8 row_mask:0xf bank_mask:0xf
 v_add_f32_dpp v49, v49, v49 row_ror:8 row_mask:0xf bank_mask:0xf
 v_cvt_pk_bf16_f32 v48, v48, v49
 buffer_store_dword v48, v52, s[20:23], s44 offen sc1
 s_branch Lb1_119
Lfw_109:
Lpb_136:
 buffer_load_dword v1, v7, s[20:23], s56 offen sc1
 s_waitcnt vmcnt(0)
 v_cmp_le_u32 vcc, s58, v1
 s_cbranch_vccnz Lpbok_137
 s_sub_u32 s54, s54, 1
 s_cbranch_scc0 Lpb_136
 s_endpgm
Lpbok_137:
 s_branch Lfok_108
Lfw_115:
Lpb_138:
 buffer_load_dword v1, v7, s[20:23], s56 offen sc1
 s_waitcnt vmcnt(0)
 v_cmp_le_u32 vcc, s58, v1
 s_cbranch_vccnz Lpbok_139
 s_sub_u32 s54, s54, 1
 s_cbranch_scc0 Lpb_138
 s_endpgm
Lpbok_139:
 s_branch Lfok_114
Lfw_121:
Lpb_140:
 buffer_load_dword v1, v7, s[20:23], s56 offen sc1
 s_waitcnt vmcnt(0)
 v_cmp_le_u32 vcc, s58, v1
 s_cbranch_vccnz Lpbok_141
 s_sub_u32 s54, s54, 1
 s_cbranch_scc0 Lpb_140
 s_endpgm
Lpbok_141:
 s_branch Lfok_120
Lfw_126:
Lpb_142:
 buffer_load_dword v1, v7, s[20:23], s56 offen sc1
 s_waitcnt vmcnt(0)
 v_cmp_le_u32 vcc, s58, v1
 s_cbranch_vccnz Lpbok_143
 s_sub_u32 s54, s54, 1
 s_cbranch_scc0 Lpb_142
 s_endpgm
Lpbok_143:
 s_branch Lfok_125
Lfail_99:
 s_endpgm
Lchexit_51:
 s_add_u32 s38, s38, 0x10000
 v_add_u32 v6, s69, v9
 ds_read_b64 v[64:65], v6 offset:19456
 v_mov_b32 v66, v2
 v_mov_b32 v67, v4
 s_waitcnt lgkmcnt(0)
 buffer_store_dwordx4 v[64:67], v0, s[20:23], s38 offen sc1
 s_waitcnt vmcnt(0) lgkmcnt(0)
 s_barrier
 v_subrev_u32 v0, 0x10000, v0
 v_min_u32 v0, 16, v0
 v_lshlrev_b32 v0, 24, v0
 v_mov_b32 v6, 64
 buffer_store_dword v6, v0, s[20:23], s57 offen sc1
Lfin:
Lend:
 s_endpgm
.section .rodata,"a"
.p2align 6
.amdhsa_kernel concat_heads__compressed_kv_cla__memory_aug_recurrent_mem_tr__prompt_kernel
  .amdhsa_next_free_vgpr 512
  .amdhsa_next_free_sgpr 102
  .amdhsa_accum_offset 256
  .amdhsa_group_segment_fixed_size 0
  .amdhsa_kernarg_size 128
  .amdhsa_user_sgpr_count 2
  .amdhsa_user_sgpr_kernarg_segment_ptr 1
  .amdhsa_system_sgpr_workgroup_id_x 1
  .amdhsa_float_denorm_mode_32 3
.end_amdhsa_kernel
```

```asm
; @launch grid=(256,1,1) block=(256,1,1) lds=163840
.amdgcn_target "amdgcn-amd-amdhsa--gfx950"
.text
.globl concat_heads__compressed_kv_cla__memory_aug_recurrent_mem_tr__prompt_kernel
.p2align 8
.type concat_heads__compressed_kv_cla__memory_aug_recurrent_mem_tr__prompt_kernel,@function
concat_heads__compressed_kv_cla__memory_aug_recurrent_mem_tr__prompt_kernel:
 s_cmp_ge_u32 s2, 256
 s_cbranch_scc1 Lend
 s_load_dwordx2 s[20:21], s[0:1], 120
 s_mov_b32 s22, 0x10000000
 s_mov_b32 s23, 0x20000
 s_load_dwordx2 s[28:29], s[0:1], 112
 s_mov_b32 s30, 0x100
 s_mov_b32 s31, 0x20000
 v_lshrrev_b32 v1, 6, v0
 s_and_b32 s5, s2, 7
 s_lshr_b32 s6, s2, 3
 v_readfirstlane_b32 s4, v1
 s_lshl_b32 s5, s5, 2
 s_lshr_b32 s5, 0x37654120, s5
 s_and_b32 s5, s5, 7
 s_waitcnt lgkmcnt(0)
 s_cmp_eq_u32 s5, 0
 s_cbranch_scc1 Lchain
 s_cmp_eq_u32 s5, 1
 s_cbranch_scc1 Lpb
 s_cmp_lt_u32 s5, 4
 s_cbranch_scc1 Lqa
 s_load_dwordx2 s[8:9], s[0:1], 8
 s_mov_b32 s10, 0x200000
 s_mov_b32 s11, 0x20000
 s_load_dwordx2 s[12:13], s[0:1], 24
 s_mov_b32 s14, 0x400000
 s_mov_b32 s15, 0x20000
 s_load_dwordx2 s[16:17], s[0:1], 32
 s_mov_b32 s18, 0x400000
 s_mov_b32 s19, 0x20000
 s_sub_u32 s3, s5, 4
 s_lshl_b32 s3, s3, 3
 s_lshr_b32 s7, s6, 2
 s_add_u32 s3, s3, s7
 s_lshl_b32 s32, s3, 8
 s_mov_b32 s33, s32
 s_lshl_b32 s34, s3, 14
 s_add_u32 s34, s34, 0x1000000
 s_add_u32 s35, s34, 8192
 s_mov_b32 s36, 16
 s_and_b32 s37, s6, 3
 s_lshl_b32 s7, s3, 5
 s_add_u32 s7, s7, s37
 s_lshl_b32 s7, s7, 2
 s_add_u32 s7, s7, 0x2000
 v_min_u32 v1, 1, v0
 v_lshlrev_b32 v1, 28, v1
 v_add_u32 v13, s7, v1
 s_waitcnt lgkmcnt(0)
 v_and_b32 v1, 63, v0
 v_lshrrev_b32 v2, 3, v0
 v_mul_u32_u24 v10, 1024, v2
 v_lshrrev_b32 v2, 4, v0
 v_xor_b32 v2, v2, v0
 v_and_b32 v2, 7, v2
 v_lshl_add_u32 v10, v2, 4, v10
 v_lshrrev_b32 v2, 4, v1
 v_bfe_u32 v3, v1, 1, 3
 v_xor_b32 v2, v2, v3
 v_and_b32 v3, 15, v1
 v_lshlrev_b32 v3, 7, v3
 v_lshl_add_u32 v4, v2, 4, v3
 v_xor_b32 v5, 64, v4
 v_lshrrev_b32 v2, 4, v0
 v_lshlrev_b32 v11, 13, v2
 v_lshrrev_b32 v2, 7, v0
 v_lshrrev_b32 v3, 4, v1
 v_lshl_add_u32 v3, v2, 2, v3
 v_bfe_u32 v2, v1, 1, 3
 v_xor_b32 v2, v2, v3
 v_lshl_add_u32 v11, v2, 5, v11
 v_and_b32 v2, 1, v1
 v_lshl_add_u32 v11, v2, 4, v11
 v_bfe_u32 v2, v1, 2, 3
 v_xor_b32 v3, s4, v2
 v_lshlrev_b32 v3, 5, v3
 v_and_b32 v2, 3, v2
 v_lshl_add_u32 v3, v2, 8, v3
 v_lshrrev_b32 v2, 4, v1
 v_lshl_add_u32 v3, v2, 11, v3
 v_and_b32 v2, 3, v1
 v_lshl_add_u32 v3, v2, 3, v3
 v_add_u32 v8, 65536, v3
 v_xor_b32 v3, 0x80, v3
 v_add_u32 v9, 65536, v3
 s_lshl_b32 s45, s4, 11
 v_lshl_add_u32 v12, v1, 4, s45
 s_mov_b32 s39, s37
 s_add_u32 s40, s39, 4
 s_lshl_b32 s49, s4, 10
 s_mul_i32 s46, s39, 32768
 s_add_u32 m0, s49, 0
 s_nop 0
 buffer_load_dwordx4 v10, s[8:11], s46 offen offset:0  lds
 s_add_u32 m0, s49, 3968
 s_nop 0
 buffer_load_dwordx4 v10, s[8:11], s46 offen offset:128  lds
 s_add_u32 m0, s49, 7936
 s_nop 0
 buffer_load_dwordx4 v10, s[8:11], s46 offen offset:256  lds
 s_add_u32 m0, s49, 11904
 s_nop 0
 buffer_load_dwordx4 v10, s[8:11], s46 offen offset:384  lds
 s_add_u32 m0, s49, 15872
 s_nop 0
 buffer_load_dwordx4 v10, s[8:11], s46 offen offset:512  lds
 s_add_u32 m0, s49, 19840
 s_nop 0
 buffer_load_dwordx4 v10, s[8:11], s46 offen offset:640  lds
 s_add_u32 m0, s49, 23808
 s_nop 0
 buffer_load_dwordx4 v10, s[8:11], s46 offen offset:768  lds
 s_add_u32 m0, s49, 27776
 s_nop 0
 buffer_load_dwordx4 v10, s[8:11], s46 offen offset:896  lds
 s_lshl_b32 s49, s4, 10
 s_add_u32 s49, s49, 32768
 s_mul_i32 s46, s40, 32768
 s_add_u32 m0, s49, 0
 s_nop 0
 buffer_load_dwordx4 v10, s[8:11], s46 offen offset:0  lds
 s_add_u32 m0, s49, 3968
 s_nop 0
 buffer_load_dwordx4 v10, s[8:11], s46 offen offset:128  lds
 s_add_u32 m0, s49, 7936
 s_nop 0
 buffer_load_dwordx4 v10, s[8:11], s46 offen offset:256  lds
 s_add_u32 m0, s49, 11904
 s_nop 0
 buffer_load_dwordx4 v10, s[8:11], s46 offen offset:384  lds
 s_add_u32 m0, s49, 15872
 s_nop 0
 buffer_load_dwordx4 v10, s[8:11], s46 offen offset:512  lds
 s_add_u32 m0, s49, 19840
 s_nop 0
 buffer_load_dwordx4 v10, s[8:11], s46 offen offset:640  lds
 s_add_u32 m0, s49, 23808
 s_nop 0
 buffer_load_dwordx4 v10, s[8:11], s46 offen offset:768  lds
 s_add_u32 m0, s49, 27776
 s_nop 0
 buffer_load_dwordx4 v10, s[8:11], s46 offen offset:896  lds
 s_lshl_b32 s49, s4, 10
 s_add_u32 m0, s49, 65536
 s_add_u32 s45, s32, 0
 buffer_load_dwordx4 v11, s[12:15], s45 offen  lds
 s_add_u32 m0, s49, 69632
 s_add_u32 s45, s32, 131072
 buffer_load_dwordx4 v11, s[12:15], s45 offen  lds
 s_add_u32 m0, s49, 73728
 s_add_u32 s45, s33, 0
 buffer_load_dwordx4 v11, s[16:19], s45 offen  lds
 s_add_u32 m0, s49, 77824
 s_add_u32 s45, s33, 131072
 buffer_load_dwordx4 v11, s[16:19], s45 offen  lds
 s_add_u32 m0, s49, 81920
 s_add_u32 s45, s32, 262144
 buffer_load_dwordx4 v11, s[12:15], s45 offen  lds
 s_add_u32 m0, s49, 86016
 s_add_u32 s45, s32, 393216
 buffer_load_dwordx4 v11, s[12:15], s45 offen  lds
 s_add_u32 m0, s49, 90112
 s_add_u32 s45, s33, 262144
 buffer_load_dwordx4 v11, s[16:19], s45 offen  lds
 s_add_u32 m0, s49, 94208
 s_add_u32 s45, s33, 393216
 buffer_load_dwordx4 v11, s[16:19], s45 offen  lds
 s_add_u32 m0, s49, 98304
 s_add_u32 s45, s32, 524288
 buffer_load_dwordx4 v11, s[12:15], s45 offen  lds
 s_add_u32 m0, s49, 102400
 s_add_u32 s45, s32, 655360
 buffer_load_dwordx4 v11, s[12:15], s45 offen  lds
 s_add_u32 m0, s49, 106496
 s_add_u32 s45, s33, 524288
 buffer_load_dwordx4 v11, s[16:19], s45 offen  lds
 s_add_u32 m0, s49, 110592
 s_add_u32 s45, s33, 655360
 buffer_load_dwordx4 v11, s[16:19], s45 offen  lds
 s_waitcnt vmcnt(8) lgkmcnt(0)
 s_barrier
 s_add_u32 m0, s49, 114688
 s_add_u32 s45, s32, 786432
 buffer_load_dwordx4 v11, s[12:15], s45 offen  lds
 s_add_u32 m0, s49, 118784
 s_add_u32 s45, s32, 917504
 buffer_load_dwordx4 v11, s[12:15], s45 offen  lds
 s_add_u32 m0, s49, 122880
 s_add_u32 s45, s33, 786432
 buffer_load_dwordx4 v11, s[16:19], s45 offen  lds
 s_add_u32 m0, s49, 126976
 s_add_u32 s45, s33, 917504
 buffer_load_dwordx4 v11, s[16:19], s45 offen  lds
 ds_read_b64_tr_b16 a[0:1], v8 offset:0
 ds_read_b64_tr_b16 a[2:3], v8 offset:1024
 ds_read_b64_tr_b16 a[64:65], v9 offset:0
 ds_read_b64_tr_b16 a[66:67], v9 offset:1024
 ds_read_b64_tr_b16 a[128:129], v8 offset:8192
 ds_read_b64_tr_b16 a[130:131], v8 offset:9216
 ds_read_b64_tr_b16 a[192:193], v9 offset:8192
 ds_read_b64_tr_b16 a[194:195], v9 offset:9216
 s_waitcnt vmcnt(8) lgkmcnt(0)
 s_barrier
 s_add_u32 m0, s49, 65536
 s_add_u32 s45, s32, 1048576
 buffer_load_dwordx4 v11, s[12:15], s45 offen  lds
 s_add_u32 m0, s49, 69632
 s_add_u32 s45, s32, 1179648
 buffer_load_dwordx4 v11, s[12:15], s45 offen  lds
 s_add_u32 m0, s49, 73728
 s_add_u32 s45, s33, 1048576
 buffer_load_dwordx4 v11, s[16:19], s45 offen  lds
 s_add_u32 m0, s49, 77824
 s_add_u32 s45, s33, 1179648
 buffer_load_dwordx4 v11, s[16:19], s45 offen  lds
 ds_read_b64_tr_b16 a[4:5], v8 offset:16384
 ds_read_b64_tr_b16 a[6:7], v8 offset:17408
 ds_read_b64_tr_b16 a[68:69], v9 offset:16384
 ds_read_b64_tr_b16 a[70:71], v9 offset:17408
 ds_read_b64_tr_b16 a[132:133], v8 offset:24576
 ds_read_b64_tr_b16 a[134:135], v8 offset:25600
 ds_read_b64_tr_b16 a[196:197], v9 offset:24576
 ds_read_b64_tr_b16 a[198:199], v9 offset:25600
 s_waitcnt vmcnt(8) lgkmcnt(0)
 s_barrier
 s_add_u32 m0, s49, 81920
 s_add_u32 s45, s32, 1310720
 buffer_load_dwordx4 v11, s[12:15], s45 offen  lds
 s_add_u32 m0, s49, 86016
 s_add_u32 s45, s32, 1441792
 buffer_load_dwordx4 v11, s[12:15], s45 offen  lds
 s_add_u32 m0, s49, 90112
 s_add_u32 s45, s33, 1310720
 buffer_load_dwordx4 v11, s[16:19], s45 offen  lds
 s_add_u32 m0, s49, 94208
 s_add_u32 s45, s33, 1441792
 buffer_load_dwordx4 v11, s[16:19], s45 offen  lds
 ds_read_b64_tr_b16 a[8:9], v8 offset:32768
 ds_read_b64_tr_b16 a[10:11], v8 offset:33792
 ds_read_b64_tr_b16 a[72:73], v9 offset:32768
 ds_read_b64_tr_b16 a[74:75], v9 offset:33792
 ds_read_b64_tr_b16 a[136:137], v8 offset:40960
 ds_read_b64_tr_b16 a[138:139], v8 offset:41984
 ds_read_b64_tr_b16 a[200:201], v9 offset:40960
 ds_read_b64_tr_b16 a[202:203], v9 offset:41984
 s_waitcnt vmcnt(8) lgkmcnt(0)
 s_barrier
 s_add_u32 m0, s49, 98304
 s_add_u32 s45, s32, 1572864
 buffer_load_dwordx4 v11, s[12:15], s45 offen  lds
 s_add_u32 m0, s49, 102400
 s_add_u32 s45, s32, 1703936
 buffer_load_dwordx4 v11, s[12:15], s45 offen  lds
 s_add_u32 m0, s49, 106496
 s_add_u32 s45, s33, 1572864
 buffer_load_dwordx4 v11, s[16:19], s45 offen  lds
 s_add_u32 m0, s49, 110592
 s_add_u32 s45, s33, 1703936
 buffer_load_dwordx4 v11, s[16:19], s45 offen  lds
 ds_read_b64_tr_b16 a[12:13], v8 offset:49152
 ds_read_b64_tr_b16 a[14:15], v8 offset:50176
 ds_read_b64_tr_b16 a[76:77], v9 offset:49152
 ds_read_b64_tr_b16 a[78:79], v9 offset:50176
 ds_read_b64_tr_b16 a[140:141], v8 offset:57344
 ds_read_b64_tr_b16 a[142:143], v8 offset:58368
 ds_read_b64_tr_b16 a[204:205], v9 offset:57344
 ds_read_b64_tr_b16 a[206:207], v9 offset:58368
 s_waitcnt vmcnt(8) lgkmcnt(0)
 s_barrier
 s_add_u32 m0, s49, 114688
 s_add_u32 s45, s32, 1835008
 buffer_load_dwordx4 v11, s[12:15], s45 offen  lds
 s_add_u32 m0, s49, 118784
 s_add_u32 s45, s32, 1966080
 buffer_load_dwordx4 v11, s[12:15], s45 offen  lds
 s_add_u32 m0, s49, 122880
 s_add_u32 s45, s33, 1835008
 buffer_load_dwordx4 v11, s[16:19], s45 offen  lds
 s_add_u32 m0, s49, 126976
 s_add_u32 s45, s33, 1966080
 buffer_load_dwordx4 v11, s[16:19], s45 offen  lds
 ds_read_b64_tr_b16 a[16:17], v8 offset:0
 ds_read_b64_tr_b16 a[18:19], v8 offset:1024
 ds_read_b64_tr_b16 a[80:81], v9 offset:0
 ds_read_b64_tr_b16 a[82:83], v9 offset:1024
 ds_read_b64_tr_b16 a[144:145], v8 offset:8192
 ds_read_b64_tr_b16 a[146:147], v8 offset:9216
 ds_read_b64_tr_b16 a[208:209], v9 offset:8192
 ds_read_b64_tr_b16 a[210:211], v9 offset:9216
 s_waitcnt vmcnt(8) lgkmcnt(0)
 s_barrier
 s_add_u32 m0, s49, 65536
 s_add_u32 s45, s32, 2097152
 buffer_load_dwordx4 v11, s[12:15], s45 offen  lds
 s_add_u32 m0, s49, 69632
 s_add_u32 s45, s32, 2228224
 buffer_load_dwordx4 v11, s[12:15], s45 offen  lds
 s_add_u32 m0, s49, 73728
 s_add_u32 s45, s33, 2097152
 buffer_load_dwordx4 v11, s[16:19], s45 offen  lds
 s_add_u32 m0, s49, 77824
 s_add_u32 s45, s33, 2228224
 buffer_load_dwordx4 v11, s[16:19], s45 offen  lds
 ds_read_b64_tr_b16 a[20:21], v8 offset:16384
 ds_read_b64_tr_b16 a[22:23], v8 offset:17408
 ds_read_b64_tr_b16 a[84:85], v9 offset:16384
 ds_read_b64_tr_b16 a[86:87], v9 offset:17408
 ds_read_b64_tr_b16 a[148:149], v8 offset:24576
 ds_read_b64_tr_b16 a[150:151], v8 offset:25600
 ds_read_b64_tr_b16 a[212:213], v9 offset:24576
 ds_read_b64_tr_b16 a[214:215], v9 offset:25600
 s_waitcnt vmcnt(8) lgkmcnt(0)
 s_barrier
 s_add_u32 m0, s49, 81920
 s_add_u32 s45, s32, 2359296
 buffer_load_dwordx4 v11, s[12:15], s45 offen  lds
 s_add_u32 m0, s49, 86016
 s_add_u32 s45, s32, 2490368
 buffer_load_dwordx4 v11, s[12:15], s45 offen  lds
 s_add_u32 m0, s49, 90112
 s_add_u32 s45, s33, 2359296
 buffer_load_dwordx4 v11, s[16:19], s45 offen  lds
 s_add_u32 m0, s49, 94208
 s_add_u32 s45, s33, 2490368
 buffer_load_dwordx4 v11, s[16:19], s45 offen  lds
 ds_read_b64_tr_b16 a[24:25], v8 offset:32768
 ds_read_b64_tr_b16 a[26:27], v8 offset:33792
 ds_read_b64_tr_b16 a[88:89], v9 offset:32768
 ds_read_b64_tr_b16 a[90:91], v9 offset:33792
 ds_read_b64_tr_b16 a[152:153], v8 offset:40960
 ds_read_b64_tr_b16 a[154:155], v8 offset:41984
 ds_read_b64_tr_b16 a[216:217], v9 offset:40960
 ds_read_b64_tr_b16 a[218:219], v9 offset:41984
 s_waitcnt vmcnt(8) lgkmcnt(0)
 s_barrier
 s_add_u32 m0, s49, 98304
 s_add_u32 s45, s32, 2621440
 buffer_load_dwordx4 v11, s[12:15], s45 offen  lds
 s_add_u32 m0, s49, 102400
 s_add_u32 s45, s32, 2752512
 buffer_load_dwordx4 v11, s[12:15], s45 offen  lds
 s_add_u32 m0, s49, 106496
 s_add_u32 s45, s33, 2621440
 buffer_load_dwordx4 v11, s[16:19], s45 offen  lds
 s_add_u32 m0, s49, 110592
 s_add_u32 s45, s33, 2752512
 buffer_load_dwordx4 v11, s[16:19], s45 offen  lds
 ds_read_b64_tr_b16 a[28:29], v8 offset:49152
 ds_read_b64_tr_b16 a[30:31], v8 offset:50176
 ds_read_b64_tr_b16 a[92:93], v9 offset:49152
 ds_read_b64_tr_b16 a[94:95], v9 offset:50176
 ds_read_b64_tr_b16 a[156:157], v8 offset:57344
 ds_read_b64_tr_b16 a[158:159], v8 offset:58368
 ds_read_b64_tr_b16 a[220:221], v9 offset:57344
 ds_read_b64_tr_b16 a[222:223], v9 offset:58368
 s_waitcnt vmcnt(8) lgkmcnt(0)
 s_barrier
 s_add_u32 m0, s49, 114688
 s_add_u32 s45, s32, 2883584
 buffer_load_dwordx4 v11, s[12:15], s45 offen  lds
 s_add_u32 m0, s49, 118784
 s_add_u32 s45, s32, 3014656
 buffer_load_dwordx4 v11, s[12:15], s45 offen  lds
 s_add_u32 m0, s49, 122880
 s_add_u32 s45, s33, 2883584
 buffer_load_dwordx4 v11, s[16:19], s45 offen  lds
 s_add_u32 m0, s49, 126976
 s_add_u32 s45, s33, 3014656
 buffer_load_dwordx4 v11, s[16:19], s45 offen  lds
 ds_read_b64_tr_b16 a[32:33], v8 offset:0
 ds_read_b64_tr_b16 a[34:35], v8 offset:1024
 ds_read_b64_tr_b16 a[96:97], v9 offset:0
 ds_read_b64_tr_b16 a[98:99], v9 offset:1024
 ds_read_b64_tr_b16 a[160:161], v8 offset:8192
 ds_read_b64_tr_b16 a[162:163], v8 offset:9216
 ds_read_b64_tr_b16 a[224:225], v9 offset:8192
 ds_read_b64_tr_b16 a[226:227], v9 offset:9216
 s_waitcnt vmcnt(8) lgkmcnt(0)
 s_barrier
 s_add_u32 m0, s49, 65536
 s_add_u32 s45, s32, 3145728
 buffer_load_dwordx4 v11, s[12:15], s45 offen  lds
 s_add_u32 m0, s49, 69632
 s_add_u32 s45, s32, 3276800
 buffer_load_dwordx4 v11, s[12:15], s45 offen  lds
 s_add_u32 m0, s49, 73728
 s_add_u32 s45, s33, 3145728
 buffer_load_dwordx4 v11, s[16:19], s45 offen  lds
 s_add_u32 m0, s49, 77824
 s_add_u32 s45, s33, 3276800
 buffer_load_dwordx4 v11, s[16:19], s45 offen  lds
 ds_read_b64_tr_b16 a[36:37], v8 offset:16384
 ds_read_b64_tr_b16 a[38:39], v8 offset:17408
 ds_read_b64_tr_b16 a[100:101], v9 offset:16384
 ds_read_b64_tr_b16 a[102:103], v9 offset:17408
 ds_read_b64_tr_b16 a[164:165], v8 offset:24576
 ds_read_b64_tr_b16 a[166:167], v8 offset:25600
 ds_read_b64_tr_b16 a[228:229], v9 offset:24576
 ds_read_b64_tr_b16 a[230:231], v9 offset:25600
 s_waitcnt vmcnt(8) lgkmcnt(0)
 s_barrier
 s_add_u32 m0, s49, 81920
 s_add_u32 s45, s32, 3407872
 buffer_load_dwordx4 v11, s[12:15], s45 offen  lds
 s_add_u32 m0, s49, 86016
 s_add_u32 s45, s32, 3538944
 buffer_load_dwordx4 v11, s[12:15], s45 offen  lds
 s_add_u32 m0, s49, 90112
 s_add_u32 s45, s33, 3407872
 buffer_load_dwordx4 v11, s[16:19], s45 offen  lds
 s_add_u32 m0, s49, 94208
 s_add_u32 s45, s33, 3538944
 buffer_load_dwordx4 v11, s[16:19], s45 offen  lds
 ds_read_b64_tr_b16 a[40:41], v8 offset:32768
 ds_read_b64_tr_b16 a[42:43], v8 offset:33792
 ds_read_b64_tr_b16 a[104:105], v9 offset:32768
 ds_read_b64_tr_b16 a[106:107], v9 offset:33792
 ds_read_b64_tr_b16 a[168:169], v8 offset:40960
 ds_read_b64_tr_b16 a[170:171], v8 offset:41984
 ds_read_b64_tr_b16 a[232:233], v9 offset:40960
 ds_read_b64_tr_b16 a[234:235], v9 offset:41984
 s_waitcnt vmcnt(8) lgkmcnt(0)
 s_barrier
 s_add_u32 m0, s49, 98304
 s_add_u32 s45, s32, 3670016
 buffer_load_dwordx4 v11, s[12:15], s45 offen  lds
 s_add_u32 m0, s49, 102400
 s_add_u32 s45, s32, 3801088
 buffer_load_dwordx4 v11, s[12:15], s45 offen  lds
 s_add_u32 m0, s49, 106496
 s_add_u32 s45, s33, 3670016
 buffer_load_dwordx4 v11, s[16:19], s45 offen  lds
 s_add_u32 m0, s49, 110592
 s_add_u32 s45, s33, 3801088
 buffer_load_dwordx4 v11, s[16:19], s45 offen  lds
 ds_read_b64_tr_b16 a[44:45], v8 offset:49152
 ds_read_b64_tr_b16 a[46:47], v8 offset:50176
 ds_read_b64_tr_b16 a[108:109], v9 offset:49152
 ds_read_b64_tr_b16 a[110:111], v9 offset:50176
 ds_read_b64_tr_b16 a[172:173], v8 offset:57344
 ds_read_b64_tr_b16 a[174:175], v8 offset:58368
 ds_read_b64_tr_b16 a[236:237], v9 offset:57344
 ds_read_b64_tr_b16 a[238:239], v9 offset:58368
 s_waitcnt vmcnt(8) lgkmcnt(0)
 s_barrier
 s_add_u32 m0, s49, 114688
 s_add_u32 s45, s32, 3932160
 buffer_load_dwordx4 v11, s[12:15], s45 offen  lds
 s_add_u32 m0, s49, 118784
 s_add_u32 s45, s32, 4063232
 buffer_load_dwordx4 v11, s[12:15], s45 offen  lds
 s_add_u32 m0, s49, 122880
 s_add_u32 s45, s33, 3932160
 buffer_load_dwordx4 v11, s[16:19], s45 offen  lds
 s_add_u32 m0, s49, 126976
 s_add_u32 s45, s33, 4063232
 buffer_load_dwordx4 v11, s[16:19], s45 offen  lds
 ds_read_b64_tr_b16 a[48:49], v8 offset:0
 ds_read_b64_tr_b16 a[50:51], v8 offset:1024
 ds_read_b64_tr_b16 a[112:113], v9 offset:0
 ds_read_b64_tr_b16 a[114:115], v9 offset:1024
 ds_read_b64_tr_b16 a[176:177], v8 offset:8192
 ds_read_b64_tr_b16 a[178:179], v8 offset:9216
 ds_read_b64_tr_b16 a[240:241], v9 offset:8192
 ds_read_b64_tr_b16 a[242:243], v9 offset:9216
 s_waitcnt vmcnt(8) lgkmcnt(0)
 s_barrier
 ds_read_b64_tr_b16 a[52:53], v8 offset:16384
 ds_read_b64_tr_b16 a[54:55], v8 offset:17408
 ds_read_b64_tr_b16 a[116:117], v9 offset:16384
 ds_read_b64_tr_b16 a[118:119], v9 offset:17408
 ds_read_b64_tr_b16 a[180:181], v8 offset:24576
 ds_read_b64_tr_b16 a[182:183], v8 offset:25600
 ds_read_b64_tr_b16 a[244:245], v9 offset:24576
 ds_read_b64_tr_b16 a[246:247], v9 offset:25600
 s_waitcnt vmcnt(4) lgkmcnt(0)
 s_barrier
 ds_read_b64_tr_b16 a[56:57], v8 offset:32768
 ds_read_b64_tr_b16 a[58:59], v8 offset:33792
 ds_read_b64_tr_b16 a[120:121], v9 offset:32768
 ds_read_b64_tr_b16 a[122:123], v9 offset:33792
 ds_read_b64_tr_b16 a[184:185], v8 offset:40960
 ds_read_b64_tr_b16 a[186:187], v8 offset:41984
 ds_read_b64_tr_b16 a[248:249], v9 offset:40960
 ds_read_b64_tr_b16 a[250:251], v9 offset:41984
 s_waitcnt vmcnt(0) lgkmcnt(0)
 s_barrier
 ds_read_b64_tr_b16 a[60:61], v8 offset:49152
 ds_read_b64_tr_b16 a[62:63], v8 offset:50176
 ds_read_b64_tr_b16 a[124:125], v9 offset:49152
 ds_read_b64_tr_b16 a[126:127], v9 offset:50176
 ds_read_b64_tr_b16 a[188:189], v8 offset:57344
 ds_read_b64_tr_b16 a[190:191], v8 offset:58368
 ds_read_b64_tr_b16 a[252:253], v9 offset:57344
 ds_read_b64_tr_b16 a[254:255], v9 offset:58368
 s_mov_b32 s50, 0x3e0293ee
 s_mov_b32 s42, 0
 s_mov_b32 s43, 0
 s_mov_b32 s44, 65536
 v_mov_b32 v6, v4
 v_mov_b32 v7, v5
 s_mov_b32 s95, 0x40000
 s_cmp_lg_u32 s4, 0
 s_cbranch_scc1 Lfrk_2
 v_min_u32 v21, 1, v0
 v_lshlrev_b32 v21, 28, v21
Lfr_1:
 buffer_load_dword v20, v21, s[28:31], 0 offen offset:128 sc1
 s_waitcnt vmcnt(0)
 v_cmp_eq_u32 vcc, 1, v20
 s_cbranch_vccnz Lfrk_2
 s_sleep 12
 s_sub_u32 s95, s95, 1
 s_cbranch_scc0 Lfr_1
 s_endpgm
Lfrk_2:
 s_lshl_b32 s47, s2, 13
 s_add_u32 s47, s47, 0x8000000
 s_mov_b32 s48, s47
 v_mov_b32 v14, 0
 s_waitcnt vmcnt(0) lgkmcnt(0)
 s_barrier
 ds_read_b128 v[32:35], v6 offset:0
 ds_read_b128 v[36:39], v6 offset:2048
 ds_read_b128 v[40:43], v7 offset:0
 ds_read_b128 v[44:47], v7 offset:2048
 v_lshlrev_b32 v1, 12, v0
 s_lshl_b32 s45, s6, 7
 buffer_load_dword v15, v1, s[8:11], s45 offen
 v_add_u32 v1, 0x100000, v1
 buffer_load_dword v15, v1, s[8:11], s45 offen
 v_add_u32 v1, 0x100000, v1
 s_waitcnt lgkmcnt(2)
Lps_loop_3:
 v_mfma_f32_16x16x32_bf16 v[64:67], a[0:3], v[32:35], 0
 ds_read_b128 v[48:51], v6 offset:4096
 v_mfma_f32_16x16x32_bf16 v[72:75], a[64:67], v[32:35], 0
 ds_read_b128 v[52:55], v6 offset:6144
 v_mfma_f32_16x16x32_bf16 v[80:83], v[32:35], a[128:131], 0
 s_add_u32 s41, s40, 4
 v_mfma_f32_16x16x32_bf16 v[88:91], v[32:35], a[192:195], 0
 s_add_u32 s45, s42, 2
 s_mul_i32 s46, s41, 32768
 v_mfma_f32_16x16x32_bf16 v[68:71], a[0:3], v[36:39], 0
 s_cmp_lt_u32 s45, s36
 s_cselect_b32 s46, s46, 0
 v_mfma_f32_16x16x32_bf16 v[76:79], a[64:67], v[36:39], 0
 s_lshl_b32 s49, s4, 10
 s_add_u32 s49, s49, s44
 v_mfma_f32_16x16x32_bf16 v[84:87], v[36:39], a[128:131], 0
 v_mfma_f32_16x16x32_bf16 v[92:95], v[36:39], a[192:195], 0
 s_waitcnt lgkmcnt(2)
 v_mfma_f32_16x16x32_bf16 v[64:67], a[4:7], v[40:43], v[64:67]
 ds_read_b128 v[56:59], v7 offset:4096
 v_mfma_f32_16x16x32_bf16 v[72:75], a[68:71], v[40:43], v[72:75]
 ds_read_b128 v[60:63], v7 offset:6144
 v_mfma_f32_16x16x32_bf16 v[80:83], v[40:43], a[132:135], v[80:83]
 s_add_u32 m0, s49, 0
 v_mfma_f32_16x16x32_bf16 v[88:91], v[40:43], a[196:199], v[88:91]
 buffer_load_dwordx4 v10, s[8:11], s46 offen offset:0  lds
 v_mfma_f32_16x16x32_bf16 v[68:71], a[4:7], v[44:47], v[68:71]
 s_add_u32 m0, s49, 3968
 v_mfma_f32_16x16x32_bf16 v[76:79], a[68:71], v[44:47], v[76:79]
 buffer_load_dwordx4 v10, s[8:11], s46 offen offset:128  lds
 v_mfma_f32_16x16x32_bf16 v[84:87], v[44:47], a[132:135], v[84:87]
 v_mfma_f32_16x16x32_bf16 v[92:95], v[44:47], a[196:199], v[92:95]
 s_waitcnt lgkmcnt(2)
 v_mfma_f32_16x16x32_bf16 v[64:67], a[8:11], v[48:51], v[64:67]
 ds_read_b128 v[32:35], v6 offset:8192
 v_mfma_f32_16x16x32_bf16 v[72:75], a[72:75], v[48:51], v[72:75]
 ds_read_b128 v[36:39], v6 offset:10240
 v_mfma_f32_16x16x32_bf16 v[80:83], v[48:51], a[136:139], v[80:83]
 s_add_u32 m0, s49, 7936
 v_mfma_f32_16x16x32_bf16 v[88:91], v[48:51], a[200:203], v[88:91]
 buffer_load_dwordx4 v10, s[8:11], s46 offen offset:256  lds
 v_mfma_f32_16x16x32_bf16 v[68:71], a[8:11], v[52:55], v[68:71]
 s_add_u32 m0, s49, 11904
 v_mfma_f32_16x16x32_bf16 v[76:79], a[72:75], v[52:55], v[76:79]
 buffer_load_dwordx4 v10, s[8:11], s46 offen offset:384  lds
 v_mfma_f32_16x16x32_bf16 v[84:87], v[52:55], a[136:139], v[84:87]
 v_mfma_f32_16x16x32_bf16 v[92:95], v[52:55], a[200:203], v[92:95]
 s_waitcnt lgkmcnt(2)
 v_mfma_f32_16x16x32_bf16 v[64:67], a[12:15], v[56:59], v[64:67]
 ds_read_b128 v[40:43], v7 offset:8192
 v_mfma_f32_16x16x32_bf16 v[72:75], a[76:79], v[56:59], v[72:75]
 ds_read_b128 v[44:47], v7 offset:10240
 v_mfma_f32_16x16x32_bf16 v[80:83], v[56:59], a[140:143], v[80:83]
 s_add_u32 m0, s49, 15872
 v_mfma_f32_16x16x32_bf16 v[88:91], v[56:59], a[204:207], v[88:91]
 buffer_load_dwordx4 v10, s[8:11], s46 offen offset:512  lds
 v_mfma_f32_16x16x32_bf16 v[68:71], a[12:15], v[60:63], v[68:71]
 s_add_u32 m0, s49, 19840
 v_mfma_f32_16x16x32_bf16 v[76:79], a[76:79], v[60:63], v[76:79]
 buffer_load_dwordx4 v10, s[8:11], s46 offen offset:640  lds
 v_mfma_f32_16x16x32_bf16 v[84:87], v[60:63], a[140:143], v[84:87]
 v_mfma_f32_16x16x32_bf16 v[92:95], v[60:63], a[204:207], v[92:95]
 s_waitcnt lgkmcnt(2)
 v_mfma_f32_16x16x32_bf16 v[64:67], a[16:19], v[32:35], v[64:67]
 ds_read_b128 v[48:51], v6 offset:12288
 v_mfma_f32_16x16x32_bf16 v[72:75], a[80:83], v[32:35], v[72:75]
 ds_read_b128 v[52:55], v6 offset:14336
 v_mfma_f32_16x16x32_bf16 v[80:83], v[32:35], a[144:147], v[80:83]
 s_add_u32 m0, s49, 23808
 v_mfma_f32_16x16x32_bf16 v[88:91], v[32:35], a[208:211], v[88:91]
 buffer_load_dwordx4 v10, s[8:11], s46 offen offset:768  lds
 v_mfma_f32_16x16x32_bf16 v[68:71], a[16:19], v[36:39], v[68:71]
 s_add_u32 m0, s49, 27776
 v_mfma_f32_16x16x32_bf16 v[76:79], a[80:83], v[36:39], v[76:79]
 buffer_load_dwordx4 v10, s[8:11], s46 offen offset:896  lds
 v_mfma_f32_16x16x32_bf16 v[84:87], v[36:39], a[144:147], v[84:87]
 v_mfma_f32_16x16x32_bf16 v[92:95], v[36:39], a[208:211], v[92:95]
 s_waitcnt lgkmcnt(2)
 v_mfma_f32_16x16x32_bf16 v[64:67], a[20:23], v[40:43], v[64:67]
 ds_read_b128 v[56:59], v7 offset:12288
 v_mfma_f32_16x16x32_bf16 v[72:75], a[84:87], v[40:43], v[72:75]
 ds_read_b128 v[60:63], v7 offset:14336
 v_mfma_f32_16x16x32_bf16 v[80:83], v[40:43], a[148:151], v[80:83]
 v_mfma_f32_16x16x32_bf16 v[88:91], v[40:43], a[212:215], v[88:91]
 v_mfma_f32_16x16x32_bf16 v[68:71], a[20:23], v[44:47], v[68:71]
 v_mfma_f32_16x16x32_bf16 v[76:79], a[84:87], v[44:47], v[76:79]
 v_mfma_f32_16x16x32_bf16 v[84:87], v[44:47], a[148:151], v[84:87]
 v_mfma_f32_16x16x32_bf16 v[92:95], v[44:47], a[212:215], v[92:95]
 s_waitcnt lgkmcnt(2)
 v_mfma_f32_16x16x32_bf16 v[64:67], a[24:27], v[48:51], v[64:67]
 ds_read_b128 v[32:35], v6 offset:16384
 v_mfma_f32_16x16x32_bf16 v[72:75], a[88:91], v[48:51], v[72:75]
 ds_read_b128 v[36:39], v6 offset:18432
 v_mfma_f32_16x16x32_bf16 v[80:83], v[48:51], a[152:155], v[80:83]
 v_cvt_pk_bf16_f32 v16, v96, v97
 v_mfma_f32_16x16x32_bf16 v[88:91], v[48:51], a[216:219], v[88:91]
 v_cvt_pk_bf16_f32 v17, v104, v105
 v_mfma_f32_16x16x32_bf16 v[68:71], a[24:27], v[52:55], v[68:71]
 v_mfma_f32_16x16x32_bf16 v[76:79], a[88:91], v[52:55], v[76:79]
 v_cvt_pk_bf16_f32 v18, v98, v99
 v_mfma_f32_16x16x32_bf16 v[84:87], v[52:55], a[152:155], v[84:87]
 v_mfma_f32_16x16x32_bf16 v[92:95], v[52:55], a[216:219], v[92:95]
 s_waitcnt lgkmcnt(2)
 v_mfma_f32_16x16x32_bf16 v[64:67], a[28:31], v[56:59], v[64:67]
 ds_read_b128 v[40:43], v7 offset:16384
 v_mfma_f32_16x16x32_bf16 v[72:75], a[92:95], v[56:59], v[72:75]
 ds_read_b128 v[44:47], v7 offset:18432
 v_mfma_f32_16x16x32_bf16 v[80:83], v[56:59], a[156:159], v[80:83]
 v_cvt_pk_bf16_f32 v19, v106, v107
 v_mfma_f32_16x16x32_bf16 v[88:91], v[56:59], a[220:223], v[88:91]
 v_mfma_f32_16x16x32_bf16 v[68:71], a[28:31], v[60:63], v[68:71]
 buffer_store_dwordx4 v[16:19], v12, s[20:23], s47 offen offset:0 sc1
 v_mfma_f32_16x16x32_bf16 v[76:79], a[92:95], v[60:63], v[76:79]
 v_cvt_pk_bf16_f32 v20, v100, v101
 v_mfma_f32_16x16x32_bf16 v[84:87], v[60:63], a[156:159], v[84:87]
 v_mfma_f32_16x16x32_bf16 v[92:95], v[60:63], a[220:223], v[92:95]
 s_waitcnt lgkmcnt(2)
 v_mfma_f32_16x16x32_bf16 v[64:67], a[32:35], v[32:35], v[64:67]
 ds_read_b128 v[48:51], v6 offset:20480
 v_mfma_f32_16x16x32_bf16 v[72:75], a[96:99], v[32:35], v[72:75]
 ds_read_b128 v[52:55], v6 offset:22528
 v_mfma_f32_16x16x32_bf16 v[80:83], v[32:35], a[160:163], v[80:83]
 v_cvt_pk_bf16_f32 v21, v108, v109
 v_mfma_f32_16x16x32_bf16 v[88:91], v[32:35], a[224:227], v[88:91]
 v_mfma_f32_16x16x32_bf16 v[68:71], a[32:35], v[36:39], v[68:71]
 v_cvt_pk_bf16_f32 v22, v102, v103
 v_mfma_f32_16x16x32_bf16 v[76:79], a[96:99], v[36:39], v[76:79]
 v_mfma_f32_16x16x32_bf16 v[84:87], v[36:39], a[160:163], v[84:87]
 v_cvt_pk_bf16_f32 v23, v110, v111
 v_mfma_f32_16x16x32_bf16 v[92:95], v[36:39], a[224:227], v[92:95]
 s_waitcnt lgkmcnt(2)
 v_mfma_f32_16x16x32_bf16 v[64:67], a[36:39], v[40:43], v[64:67]
 ds_read_b128 v[56:59], v7 offset:20480
 v_mfma_f32_16x16x32_bf16 v[72:75], a[100:103], v[40:43], v[72:75]
 ds_read_b128 v[60:63], v7 offset:22528
 v_mfma_f32_16x16x32_bf16 v[80:83], v[40:43], a[164:167], v[80:83]
 buffer_store_dwordx4 v[20:23], v12, s[20:23], s47 offen offset:1024 sc1
 v_mfma_f32_16x16x32_bf16 v[88:91], v[40:43], a[228:231], v[88:91]
 v_mfma_f32_16x16x32_bf16 v[68:71], a[36:39], v[44:47], v[68:71]
 v_cvt_pk_bf16_f32 v24, v112, v113
 v_mfma_f32_16x16x32_bf16 v[76:79], a[100:103], v[44:47], v[76:79]
 v_mfma_f32_16x16x32_bf16 v[84:87], v[44:47], a[164:167], v[84:87]
 v_cvt_pk_bf16_f32 v25, v116, v117
 v_mfma_f32_16x16x32_bf16 v[92:95], v[44:47], a[228:231], v[92:95]
 s_waitcnt lgkmcnt(2)
 v_mfma_f32_16x16x32_bf16 v[64:67], a[40:43], v[48:51], v[64:67]
 ds_read_b128 v[32:35], v6 offset:24576
 v_mfma_f32_16x16x32_bf16 v[72:75], a[104:107], v[48:51], v[72:75]
 ds_read_b128 v[36:39], v6 offset:26624
 v_mfma_f32_16x16x32_bf16 v[80:83], v[48:51], a[168:171], v[80:83]
 v_mfma_f32_16x16x32_bf16 v[88:91], v[48:51], a[232:235], v[88:91]
 v_cvt_pk_bf16_f32 v26, v114, v115
 v_mfma_f32_16x16x32_bf16 v[68:71], a[40:43], v[52:55], v[68:71]
 v_cvt_pk_bf16_f32 v27, v118, v119
 v_mfma_f32_16x16x32_bf16 v[76:79], a[104:107], v[52:55], v[76:79]
 v_mfma_f32_16x16x32_bf16 v[84:87], v[52:55], a[168:171], v[84:87]
 buffer_store_dwordx4 v[24:27], v12, s[20:23], s48 offen offset:0 sc1
 v_mfma_f32_16x16x32_bf16 v[92:95], v[52:55], a[232:235], v[92:95]
 s_waitcnt lgkmcnt(2)
 v_mfma_f32_16x16x32_bf16 v[64:67], a[44:47], v[56:59], v[64:67]
 ds_read_b128 v[40:43], v7 offset:24576
 v_mfma_f32_16x16x32_bf16 v[72:75], a[108:111], v[56:59], v[72:75]
 ds_read_b128 v[44:47], v7 offset:26624
 v_mfma_f32_16x16x32_bf16 v[80:83], v[56:59], a[172:175], v[80:83]
 s_add_u32 s43, s43, 32768
 s_cmp_eq_u32 s43, 131072
 v_mfma_f32_16x16x32_bf16 v[88:91], v[56:59], a[236:239], v[88:91]
 s_cselect_b32 s43, 0, s43
 s_add_u32 s44, s44, 32768
 v_mfma_f32_16x16x32_bf16 v[68:71], a[44:47], v[60:63], v[68:71]
 s_cmp_eq_u32 s44, 131072
 s_cselect_b32 s44, 0, s44
 v_mfma_f32_16x16x32_bf16 v[76:79], a[108:111], v[60:63], v[76:79]
 v_mfma_f32_16x16x32_bf16 v[84:87], v[60:63], a[172:175], v[84:87]
 v_cvt_pk_bf16_f32 v28, v120, v121
 v_mfma_f32_16x16x32_bf16 v[92:95], v[60:63], a[236:239], v[92:95]
 s_waitcnt lgkmcnt(2)
 v_mfma_f32_16x16x32_bf16 v[64:67], a[48:51], v[32:35], v[64:67]
 ds_read_b128 v[48:51], v6 offset:28672
 v_mfma_f32_16x16x32_bf16 v[72:75], a[112:115], v[32:35], v[72:75]
 ds_read_b128 v[52:55], v6 offset:30720
 v_mfma_f32_16x16x32_bf16 v[80:83], v[32:35], a[176:179], v[80:83]
 v_add_u32 v6, s43, v4
 v_mfma_f32_16x16x32_bf16 v[88:91], v[32:35], a[240:243], v[88:91]
 v_mfma_f32_16x16x32_bf16 v[68:71], a[48:51], v[36:39], v[68:71]
 v_cvt_pk_bf16_f32 v29, v124, v125
 v_mfma_f32_16x16x32_bf16 v[76:79], a[112:115], v[36:39], v[76:79]
 v_cvt_pk_bf16_f32 v30, v122, v123
 v_mfma_f32_16x16x32_bf16 v[84:87], v[36:39], a[176:179], v[84:87]
 v_mfma_f32_16x16x32_bf16 v[92:95], v[36:39], a[240:243], v[92:95]
 s_waitcnt lgkmcnt(2)
 v_mfma_f32_16x16x32_bf16 v[64:67], a[52:55], v[40:43], v[64:67]
 ds_read_b128 v[56:59], v7 offset:28672
 v_mfma_f32_16x16x32_bf16 v[72:75], a[116:119], v[40:43], v[72:75]
 ds_read_b128 v[60:63], v7 offset:30720
 v_mfma_f32_16x16x32_bf16 v[80:83], v[40:43], a[180:183], v[80:83]
 v_add_u32 v7, s43, v5
 v_mfma_f32_16x16x32_bf16 v[88:91], v[40:43], a[244:247], v[88:91]
 v_cvt_pk_bf16_f32 v31, v126, v127
 v_mfma_f32_16x16x32_bf16 v[68:71], a[52:55], v[44:47], v[68:71]
 v_mfma_f32_16x16x32_bf16 v[76:79], a[116:119], v[44:47], v[76:79]
 buffer_store_dwordx4 v[28:31], v12, s[20:23], s48 offen offset:1024 sc1
 v_mfma_f32_16x16x32_bf16 v[84:87], v[44:47], a[180:183], v[84:87]
 v_mfma_f32_16x16x32_bf16 v[92:95], v[44:47], a[244:247], v[92:95]
 s_waitcnt lgkmcnt(2)
 v_mfma_f32_16x16x32_bf16 v[64:67], a[56:59], v[48:51], v[64:67]
 s_waitcnt vmcnt(12)
 s_barrier
 ds_read_b128 v[32:35], v6 offset:0
 v_mfma_f32_16x16x32_bf16 v[72:75], a[120:123], v[48:51], v[72:75]
 ds_read_b128 v[36:39], v6 offset:2048
 v_mfma_f32_16x16x32_bf16 v[80:83], v[48:51], a[184:187], v[80:83]
 v_mfma_f32_16x16x32_bf16 v[88:91], v[48:51], a[248:251], v[88:91]
 v_mfma_f32_16x16x32_bf16 v[68:71], a[56:59], v[52:55], v[68:71]
 v_mfma_f32_16x16x32_bf16 v[76:79], a[120:123], v[52:55], v[76:79]
 v_mfma_f32_16x16x32_bf16 v[84:87], v[52:55], a[184:187], v[84:87]
 v_mfma_f32_16x16x32_bf16 v[92:95], v[52:55], a[248:251], v[92:95]
 s_waitcnt lgkmcnt(2)
 v_mfma_f32_16x16x32_bf16 v[64:67], a[60:63], v[56:59], v[64:67]
 ds_read_b128 v[40:43], v7 offset:0
 v_mfma_f32_16x16x32_bf16 v[72:75], a[124:127], v[56:59], v[72:75]
 ds_read_b128 v[44:47], v7 offset:2048
 v_mfma_f32_16x16x32_bf16 v[80:83], v[56:59], a[188:191], v[80:83]
 s_mul_i32 s45, s39, 524288
 s_add_u32 s47, s34, s45
 v_mfma_f32_16x16x32_bf16 v[88:91], v[56:59], a[252:255], v[88:91]
 s_add_u32 s48, s35, s45
 v_mov_b32 v14, s42
 v_mfma_f32_16x16x32_bf16 v[68:71], a[60:63], v[60:63], v[68:71]
 s_mov_b32 s39, s40
 s_mov_b32 s40, s41
 v_mfma_f32_16x16x32_bf16 v[76:79], a[124:127], v[60:63], v[76:79]
 s_add_u32 s42, s42, 1
 v_mfma_f32_16x16x32_bf16 v[84:87], v[60:63], a[188:191], v[84:87]
 v_mfma_f32_16x16x32_bf16 v[92:95], v[60:63], a[252:255], v[92:95]
 s_waitcnt lgkmcnt(2)
 v_mfma_f32_16x16x32_bf16 v[96:99], a[0:3], v[32:35], 0
 ds_read_b128 v[48:51], v6 offset:4096
 v_mfma_f32_16x16x32_bf16 v[104:107], a[64:67], v[32:35], 0
 ds_read_b128 v[52:55], v6 offset:6144
 v_mfma_f32_16x16x32_bf16 v[112:115], v[32:35], a[128:131], 0
 s_add_u32 s41, s40, 4
 v_mfma_f32_16x16x32_bf16 v[120:123], v[32:35], a[192:195], 0
 s_add_u32 s45, s42, 2
 s_mul_i32 s46, s41, 32768
 v_mfma_f32_16x16x32_bf16 v[100:103], a[0:3], v[36:39], 0
 s_cmp_lt_u32 s45, s36
 s_cselect_b32 s46, s46, 0
 v_mfma_f32_16x16x32_bf16 v[108:111], a[64:67], v[36:39], 0
 s_lshl_b32 s49, s4, 10
 s_add_u32 s49, s49, s44
 v_mfma_f32_16x16x32_bf16 v[116:119], v[36:39], a[128:131], 0
 v_mfma_f32_16x16x32_bf16 v[124:127], v[36:39], a[192:195], 0
 s_waitcnt lgkmcnt(2)
 v_mfma_f32_16x16x32_bf16 v[96:99], a[4:7], v[40:43], v[96:99]
 ds_read_b128 v[56:59], v7 offset:4096
 v_mfma_f32_16x16x32_bf16 v[104:107], a[68:71], v[40:43], v[104:107]
 ds_read_b128 v[60:63], v7 offset:6144
 v_mfma_f32_16x16x32_bf16 v[112:115], v[40:43], a[132:135], v[112:115]
 s_add_u32 m0, s49, 0
 v_mfma_f32_16x16x32_bf16 v[120:123], v[40:43], a[196:199], v[120:123]
 buffer_load_dwordx4 v10, s[8:11], s46 offen offset:0  lds
 v_mfma_f32_16x16x32_bf16 v[100:103], a[4:7], v[44:47], v[100:103]
 s_add_u32 m0, s49, 3968
 v_mfma_f32_16x16x32_bf16 v[108:111], a[68:71], v[44:47], v[108:111]
 buffer_load_dwordx4 v10, s[8:11], s46 offen offset:128  lds
 v_mfma_f32_16x16x32_bf16 v[116:119], v[44:47], a[132:135], v[116:119]
 v_mfma_f32_16x16x32_bf16 v[124:127], v[44:47], a[196:199], v[124:127]
 s_waitcnt lgkmcnt(2)
 v_mfma_f32_16x16x32_bf16 v[96:99], a[8:11], v[48:51], v[96:99]
 ds_read_b128 v[32:35], v6 offset:8192
 v_mfma_f32_16x16x32_bf16 v[104:107], a[72:75], v[48:51], v[104:107]
 ds_read_b128 v[36:39], v6 offset:10240
 v_mfma_f32_16x16x32_bf16 v[112:115], v[48:51], a[136:139], v[112:115]
 s_add_u32 m0, s49, 7936
 v_mfma_f32_16x16x32_bf16 v[120:123], v[48:51], a[200:203], v[120:123]
 buffer_load_dwordx4 v10, s[8:11], s46 offen offset:256  lds
 v_mfma_f32_16x16x32_bf16 v[100:103], a[8:11], v[52:55], v[100:103]
 s_add_u32 m0, s49, 11904
 v_mfma_f32_16x16x32_bf16 v[108:111], a[72:75], v[52:55], v[108:111]
 buffer_load_dwordx4 v10, s[8:11], s46 offen offset:384  lds
 v_mfma_f32_16x16x32_bf16 v[116:119], v[52:55], a[136:139], v[116:119]
 v_mfma_f32_16x16x32_bf16 v[124:127], v[52:55], a[200:203], v[124:127]
 s_waitcnt lgkmcnt(2)
 v_mfma_f32_16x16x32_bf16 v[96:99], a[12:15], v[56:59], v[96:99]
 ds_read_b128 v[40:43], v7 offset:8192
 v_mfma_f32_16x16x32_bf16 v[104:107], a[76:79], v[56:59], v[104:107]
 ds_read_b128 v[44:47], v7 offset:10240
 v_mfma_f32_16x16x32_bf16 v[112:115], v[56:59], a[140:143], v[112:115]
 s_add_u32 m0, s49, 15872
 v_mfma_f32_16x16x32_bf16 v[120:123], v[56:59], a[204:207], v[120:123]
 buffer_load_dwordx4 v10, s[8:11], s46 offen offset:512  lds
 v_mfma_f32_16x16x32_bf16 v[100:103], a[12:15], v[60:63], v[100:103]
 s_add_u32 m0, s49, 19840
 v_mfma_f32_16x16x32_bf16 v[108:111], a[76:79], v[60:63], v[108:111]
 buffer_load_dwordx4 v10, s[8:11], s46 offen offset:640  lds
 v_mfma_f32_16x16x32_bf16 v[116:119], v[60:63], a[140:143], v[116:119]
 v_mfma_f32_16x16x32_bf16 v[124:127], v[60:63], a[204:207], v[124:127]
 s_waitcnt lgkmcnt(2)
 v_mfma_f32_16x16x32_bf16 v[96:99], a[16:19], v[32:35], v[96:99]
 ds_read_b128 v[48:51], v6 offset:12288
 v_mfma_f32_16x16x32_bf16 v[104:107], a[80:83], v[32:35], v[104:107]
 ds_read_b128 v[52:55], v6 offset:14336
 v_mfma_f32_16x16x32_bf16 v[112:115], v[32:35], a[144:147], v[112:115]
 s_add_u32 m0, s49, 23808
 v_mfma_f32_16x16x32_bf16 v[120:123], v[32:35], a[208:211], v[120:123]
 buffer_load_dwordx4 v10, s[8:11], s46 offen offset:768  lds
 v_mfma_f32_16x16x32_bf16 v[100:103], a[16:19], v[36:39], v[100:103]
 s_add_u32 m0, s49, 27776
 v_mfma_f32_16x16x32_bf16 v[108:111], a[80:83], v[36:39], v[108:111]
 buffer_load_dwordx4 v10, s[8:11], s46 offen offset:896  lds
 v_mfma_f32_16x16x32_bf16 v[116:119], v[36:39], a[144:147], v[116:119]
 v_mfma_f32_16x16x32_bf16 v[124:127], v[36:39], a[208:211], v[124:127]
 s_waitcnt lgkmcnt(2)
 v_mfma_f32_16x16x32_bf16 v[96:99], a[20:23], v[40:43], v[96:99]
 ds_read_b128 v[56:59], v7 offset:12288
 v_mfma_f32_16x16x32_bf16 v[104:107], a[84:87], v[40:43], v[104:107]
 ds_read_b128 v[60:63], v7 offset:14336
 v_mfma_f32_16x16x32_bf16 v[112:115], v[40:43], a[148:151], v[112:115]
 v_mfma_f32_16x16x32_bf16 v[120:123], v[40:43], a[212:215], v[120:123]
 v_mfma_f32_16x16x32_bf16 v[100:103], a[20:23], v[44:47], v[100:103]
 v_mfma_f32_16x16x32_bf16 v[108:111], a[84:87], v[44:47], v[108:111]
 v_mfma_f32_16x16x32_bf16 v[116:119], v[44:47], a[148:151], v[116:119]
 v_mfma_f32_16x16x32_bf16 v[124:127], v[44:47], a[212:215], v[124:127]
 s_waitcnt lgkmcnt(2)
 v_mfma_f32_16x16x32_bf16 v[96:99], a[24:27], v[48:51], v[96:99]
 ds_read_b128 v[32:35], v6 offset:16384
 v_mfma_f32_16x16x32_bf16 v[104:107], a[88:91], v[48:51], v[104:107]
 ds_read_b128 v[36:39], v6 offset:18432
 v_mfma_f32_16x16x32_bf16 v[112:115], v[48:51], a[152:155], v[112:115]
 v_cvt_pk_bf16_f32 v16, v64, v65
 v_mfma_f32_16x16x32_bf16 v[120:123], v[48:51], a[216:219], v[120:123]
 v_cvt_pk_bf16_f32 v17, v72, v73
 v_mfma_f32_16x16x32_bf16 v[100:103], a[24:27], v[52:55], v[100:103]
 v_mfma_f32_16x16x32_bf16 v[108:111], a[88:91], v[52:55], v[108:111]
 v_cvt_pk_bf16_f32 v18, v66, v67
 v_mfma_f32_16x16x32_bf16 v[116:119], v[52:55], a[152:155], v[116:119]
 v_mfma_f32_16x16x32_bf16 v[124:127], v[52:55], a[216:219], v[124:127]
 s_waitcnt lgkmcnt(2)
 v_mfma_f32_16x16x32_bf16 v[96:99], a[28:31], v[56:59], v[96:99]
 ds_read_b128 v[40:43], v7 offset:16384
 v_mfma_f32_16x16x32_bf16 v[104:107], a[92:95], v[56:59], v[104:107]
 ds_read_b128 v[44:47], v7 offset:18432
 v_mfma_f32_16x16x32_bf16 v[112:115], v[56:59], a[156:159], v[112:115]
 v_cvt_pk_bf16_f32 v19, v74, v75
 v_mfma_f32_16x16x32_bf16 v[120:123], v[56:59], a[220:223], v[120:123]
 v_mfma_f32_16x16x32_bf16 v[100:103], a[28:31], v[60:63], v[100:103]
 buffer_store_dwordx4 v[16:19], v12, s[20:23], s47 offen offset:0 sc1
 v_mfma_f32_16x16x32_bf16 v[108:111], a[92:95], v[60:63], v[108:111]
 v_cvt_pk_bf16_f32 v20, v68, v69
 v_mfma_f32_16x16x32_bf16 v[116:119], v[60:63], a[156:159], v[116:119]
 v_mfma_f32_16x16x32_bf16 v[124:127], v[60:63], a[220:223], v[124:127]
 s_waitcnt lgkmcnt(2)
 v_mfma_f32_16x16x32_bf16 v[96:99], a[32:35], v[32:35], v[96:99]
 ds_read_b128 v[48:51], v6 offset:20480
 v_mfma_f32_16x16x32_bf16 v[104:107], a[96:99], v[32:35], v[104:107]
 ds_read_b128 v[52:55], v6 offset:22528
 v_mfma_f32_16x16x32_bf16 v[112:115], v[32:35], a[160:163], v[112:115]
 v_cvt_pk_bf16_f32 v21, v76, v77
 v_mfma_f32_16x16x32_bf16 v[120:123], v[32:35], a[224:227], v[120:123]
 v_mfma_f32_16x16x32_bf16 v[100:103], a[32:35], v[36:39], v[100:103]
 v_cvt_pk_bf16_f32 v22, v70, v71
 v_mfma_f32_16x16x32_bf16 v[108:111], a[96:99], v[36:39], v[108:111]
 v_mfma_f32_16x16x32_bf16 v[116:119], v[36:39], a[160:163], v[116:119]
 v_cvt_pk_bf16_f32 v23, v78, v79
 v_mfma_f32_16x16x32_bf16 v[124:127], v[36:39], a[224:227], v[124:127]
 s_waitcnt lgkmcnt(2)
 v_mfma_f32_16x16x32_bf16 v[96:99], a[36:39], v[40:43], v[96:99]
 ds_read_b128 v[56:59], v7 offset:20480
 v_mfma_f32_16x16x32_bf16 v[104:107], a[100:103], v[40:43], v[104:107]
 ds_read_b128 v[60:63], v7 offset:22528
 v_mfma_f32_16x16x32_bf16 v[112:115], v[40:43], a[164:167], v[112:115]
 buffer_store_dwordx4 v[20:23], v12, s[20:23], s47 offen offset:1024 sc1
 v_mfma_f32_16x16x32_bf16 v[120:123], v[40:43], a[228:231], v[120:123]
 v_mfma_f32_16x16x32_bf16 v[100:103], a[36:39], v[44:47], v[100:103]
 v_cvt_pk_bf16_f32 v24, v80, v81
 v_mfma_f32_16x16x32_bf16 v[108:111], a[100:103], v[44:47], v[108:111]
 v_mfma_f32_16x16x32_bf16 v[116:119], v[44:47], a[164:167], v[116:119]
 v_cvt_pk_bf16_f32 v25, v84, v85
 v_mfma_f32_16x16x32_bf16 v[124:127], v[44:47], a[228:231], v[124:127]
 s_waitcnt lgkmcnt(2)
 v_mfma_f32_16x16x32_bf16 v[96:99], a[40:43], v[48:51], v[96:99]
 ds_read_b128 v[32:35], v6 offset:24576
 v_mfma_f32_16x16x32_bf16 v[104:107], a[104:107], v[48:51], v[104:107]
 ds_read_b128 v[36:39], v6 offset:26624
 v_mfma_f32_16x16x32_bf16 v[112:115], v[48:51], a[168:171], v[112:115]
 v_mfma_f32_16x16x32_bf16 v[120:123], v[48:51], a[232:235], v[120:123]
 v_cvt_pk_bf16_f32 v26, v82, v83
 v_mfma_f32_16x16x32_bf16 v[100:103], a[40:43], v[52:55], v[100:103]
 v_cvt_pk_bf16_f32 v27, v86, v87
 v_mfma_f32_16x16x32_bf16 v[108:111], a[104:107], v[52:55], v[108:111]
 v_mfma_f32_16x16x32_bf16 v[116:119], v[52:55], a[168:171], v[116:119]
 buffer_store_dwordx4 v[24:27], v12, s[20:23], s48 offen offset:0 sc1
 v_mfma_f32_16x16x32_bf16 v[124:127], v[52:55], a[232:235], v[124:127]
 s_waitcnt lgkmcnt(2)
 v_mfma_f32_16x16x32_bf16 v[96:99], a[44:47], v[56:59], v[96:99]
 ds_read_b128 v[40:43], v7 offset:24576
 v_mfma_f32_16x16x32_bf16 v[104:107], a[108:111], v[56:59], v[104:107]
 ds_read_b128 v[44:47], v7 offset:26624
 v_mfma_f32_16x16x32_bf16 v[112:115], v[56:59], a[172:175], v[112:115]
 s_add_u32 s43, s43, 32768
 s_cmp_eq_u32 s43, 131072
 v_mfma_f32_16x16x32_bf16 v[120:123], v[56:59], a[236:239], v[120:123]
 s_cselect_b32 s43, 0, s43
 s_add_u32 s44, s44, 32768
 v_mfma_f32_16x16x32_bf16 v[100:103], a[44:47], v[60:63], v[100:103]
 s_cmp_eq_u32 s44, 131072
 s_cselect_b32 s44, 0, s44
 v_mfma_f32_16x16x32_bf16 v[108:111], a[108:111], v[60:63], v[108:111]
 v_mfma_f32_16x16x32_bf16 v[116:119], v[60:63], a[172:175], v[116:119]
 v_cvt_pk_bf16_f32 v28, v88, v89
 v_mfma_f32_16x16x32_bf16 v[124:127], v[60:63], a[236:239], v[124:127]
 s_waitcnt lgkmcnt(2)
 v_mfma_f32_16x16x32_bf16 v[96:99], a[48:51], v[32:35], v[96:99]
 ds_read_b128 v[48:51], v6 offset:28672
 v_mfma_f32_16x16x32_bf16 v[104:107], a[112:115], v[32:35], v[104:107]
 ds_read_b128 v[52:55], v6 offset:30720
 v_mfma_f32_16x16x32_bf16 v[112:115], v[32:35], a[176:179], v[112:115]
 v_add_u32 v6, s43, v4
 v_mfma_f32_16x16x32_bf16 v[120:123], v[32:35], a[240:243], v[120:123]
 v_mfma_f32_16x16x32_bf16 v[100:103], a[48:51], v[36:39], v[100:103]
 v_cvt_pk_bf16_f32 v29, v92, v93
 v_mfma_f32_16x16x32_bf16 v[108:111], a[112:115], v[36:39], v[108:111]
 v_cvt_pk_bf16_f32 v30, v90, v91
 v_mfma_f32_16x16x32_bf16 v[116:119], v[36:39], a[176:179], v[116:119]
 v_mfma_f32_16x16x32_bf16 v[124:127], v[36:39], a[240:243], v[124:127]
 s_waitcnt lgkmcnt(2)
 v_mfma_f32_16x16x32_bf16 v[96:99], a[52:55], v[40:43], v[96:99]
 ds_read_b128 v[56:59], v7 offset:28672
 v_mfma_f32_16x16x32_bf16 v[104:107], a[116:119], v[40:43], v[104:107]
 ds_read_b128 v[60:63], v7 offset:30720
 v_mfma_f32_16x16x32_bf16 v[112:115], v[40:43], a[180:183], v[112:115]
 v_add_u32 v7, s43, v5
 v_mfma_f32_16x16x32_bf16 v[120:123], v[40:43], a[244:247], v[120:123]
 v_cvt_pk_bf16_f32 v31, v94, v95
 v_mfma_f32_16x16x32_bf16 v[100:103], a[52:55], v[44:47], v[100:103]
 v_mfma_f32_16x16x32_bf16 v[108:111], a[116:119], v[44:47], v[108:111]
 buffer_store_dwordx4 v[28:31], v12, s[20:23], s48 offen offset:1024 sc1
 v_mfma_f32_16x16x32_bf16 v[116:119], v[44:47], a[180:183], v[116:119]
 v_mfma_f32_16x16x32_bf16 v[124:127], v[44:47], a[244:247], v[124:127]
 s_waitcnt lgkmcnt(2)
 v_mfma_f32_16x16x32_bf16 v[96:99], a[56:59], v[48:51], v[96:99]
 s_waitcnt vmcnt(12)
 s_barrier
 ds_read_b128 v[32:35], v6 offset:0
 v_mfma_f32_16x16x32_bf16 v[104:107], a[120:123], v[48:51], v[104:107]
 ds_read_b128 v[36:39], v6 offset:2048
 v_mfma_f32_16x16x32_bf16 v[112:115], v[48:51], a[184:187], v[112:115]
 v_mfma_f32_16x16x32_bf16 v[120:123], v[48:51], a[248:251], v[120:123]
 v_mfma_f32_16x16x32_bf16 v[100:103], a[56:59], v[52:55], v[100:103]
 v_mfma_f32_16x16x32_bf16 v[108:111], a[120:123], v[52:55], v[108:111]
 v_mfma_f32_16x16x32_bf16 v[116:119], v[52:55], a[184:187], v[116:119]
 v_mfma_f32_16x16x32_bf16 v[124:127], v[52:55], a[248:251], v[124:127]
 s_waitcnt lgkmcnt(2)
 v_mfma_f32_16x16x32_bf16 v[96:99], a[60:63], v[56:59], v[96:99]
 ds_read_b128 v[40:43], v7 offset:0
 v_mfma_f32_16x16x32_bf16 v[104:107], a[124:127], v[56:59], v[104:107]
 ds_read_b128 v[44:47], v7 offset:2048
 v_mfma_f32_16x16x32_bf16 v[112:115], v[56:59], a[188:191], v[112:115]
 s_mul_i32 s45, s39, 524288
 s_add_u32 s47, s34, s45
 v_mfma_f32_16x16x32_bf16 v[120:123], v[56:59], a[252:255], v[120:123]
 s_add_u32 s48, s35, s45
 v_mov_b32 v14, s42
 v_mfma_f32_16x16x32_bf16 v[100:103], a[60:63], v[60:63], v[100:103]
 s_mov_b32 s39, s40
 s_mov_b32 s40, s41
 v_mfma_f32_16x16x32_bf16 v[108:111], a[124:127], v[60:63], v[108:111]
 s_add_u32 s42, s42, 1
 s_cmp_lt_u32 s42, s36
 v_mfma_f32_16x16x32_bf16 v[116:119], v[60:63], a[188:191], v[116:119]
 v_mfma_f32_16x16x32_bf16 v[124:127], v[60:63], a[252:255], v[124:127]
 s_waitcnt lgkmcnt(2)
 s_cbranch_scc1 Lps_loop_3
 s_nop 7
 v_cvt_pk_bf16_f32 v16, v96, v97
 v_cvt_pk_bf16_f32 v17, v104, v105
 v_cvt_pk_bf16_f32 v18, v98, v99
 v_cvt_pk_bf16_f32 v19, v106, v107
 buffer_store_dwordx4 v[16:19], v12, s[20:23], s47 offen offset:0 sc1
 v_cvt_pk_bf16_f32 v20, v100, v101
 v_cvt_pk_bf16_f32 v21, v108, v109
 v_cvt_pk_bf16_f32 v22, v102, v103
 v_cvt_pk_bf16_f32 v23, v110, v111
 buffer_store_dwordx4 v[20:23], v12, s[20:23], s47 offen offset:1024 sc1
 v_cvt_pk_bf16_f32 v24, v112, v113
 v_cvt_pk_bf16_f32 v25, v116, v117
 v_cvt_pk_bf16_f32 v26, v114, v115
 v_cvt_pk_bf16_f32 v27, v118, v119
 buffer_store_dwordx4 v[24:27], v12, s[20:23], s48 offen offset:0 sc1
 v_cvt_pk_bf16_f32 v28, v120, v121
 v_cvt_pk_bf16_f32 v29, v124, v125
 v_cvt_pk_bf16_f32 v30, v122, v123
 v_cvt_pk_bf16_f32 v31, v126, v127
 buffer_store_dwordx4 v[28:31], v12, s[20:23], s48 offen offset:1024 sc1
 s_waitcnt vmcnt(0) lgkmcnt(0)
 s_barrier
 v_mov_b32 v14, s36
 buffer_store_dword v14, v13, s[20:23], 0 offen sc1
 s_mov_b32 s32, s3
 s_and_b32 s33, s6, 3
 s_sub_u32 s34, 7, s33
 v_and_b32 v1, 63, v0
 v_lshlrev_b32 v1, 4, v1
 v_mov_b32 v4, 0xff800000
 v_min_u32 v5, 1, v0
 v_lshlrev_b32 v5, 28, v5
 v_mov_b32 v6, 0x3f803f80
 v_accvgpr_write_b32 a192, v6
 v_accvgpr_write_b32 a193, v6
 v_accvgpr_write_b32 a194, v6
 v_accvgpr_write_b32 a195, v6
 s_mov_b32 s52, 0xfff0ffff
 s_mov_b32 s53, 0xf000ff00
 s_mov_b32 s54, 0xffe0fffe
 s_mov_b32 s55, 0xe000fe00
 s_mov_b32 s56, 0xffc0fffc
 s_mov_b32 s57, 0xc000fc00
 s_mov_b32 s58, 0xff80fff8
 s_mov_b32 s59, 0x8000f800
 s_mov_b32 s73, 0x53800000
 s_mov_b32 s74, 0x21800000
 s_lshl_b32 s50, s4, 12
 s_lshl_b32 s45, s32, 14
 s_add_u32 s45, s45, s50
 s_add_u32 s45, s45, 0x1000000
 s_lshl_b32 s36, s33, 3
 s_add_u32 s36, s36, 8
 s_lshl_b32 s47, s34, 3
 s_add_u32 s47, s47, 8
 s_mov_b32 s35, 0
 s_mov_b32 s38, 0
 s_mov_b32 s46, 0
 s_lshl_b32 s7, s3, 7
 s_add_u32 s7, s7, 0x2000
 s_lshr_b32 s94, s3, 1
 s_lshl_b32 s94, s94, 7
 s_add_u32 s94, s94, 0x3000
 v_mov_b32 v8, 0
Law_4:
 buffer_load_dwordx4 v[16:19], v8, s[20:23], s7 offen sc1
 buffer_load_dwordx4 v[20:23], v8, s[20:23], s94 offen sc1
 s_waitcnt vmcnt(0)
 v_min3_u32 v16, v16, v17, v18
 v_min3_u32 v16, v16, v19, v20
 v_min3_u32 v16, v16, v21, v22
 v_min_u32 v16, v16, v23
 v_cmp_le_u32 vcc, 16, v16
 s_cbranch_vccnz Lawk_5
 s_sleep 2
 s_sub_u32 s95, s95, 1
 s_cbranch_scc0 Law_4
 s_endpgm
Lawk_5:
 s_lshl_b32 s37, s35, 19
 s_add_u32 m0, s38, s50
 s_add_u32 s37, s37, s45
 buffer_load_dwordx4 v1, s[20:23], s37 offen offset:0 sc1 lds
 buffer_load_dwordx4 v1, s[20:23], s37 offen offset:1024 sc1 lds
 buffer_load_dwordx4 v1, s[20:23], s37 offen offset:2048 sc1 lds
 buffer_load_dwordx4 v1, s[20:23], s37 offen offset:3072 sc1 lds
 s_add_u32 s38, s38, 0x4000
 s_and_b32 s38, s38, 0x1ffff
 s_add_u32 s35, s35, 1
 s_cmp_eq_u32 s35, s36
 s_cselect_b32 s36, s47, s36
 s_cselect_b32 s35, 0, s35
 s_lshl_b32 s44, s33, 3
 s_add_u32 s44, s44, s4
 s_lshl_b32 s44, s44, 5
 s_add_u32 s44, s44, s32
 s_lshl_b32 s44, s44, 13
 s_add_u32 s44, s44, 0x5000000
 buffer_load_dwordx4 a[0:3], v1, s[20:23], s44 offen offset:0 sc1
 buffer_load_dwordx4 a[16:19], v1, s[20:23], s44 offen offset:1024 sc1
 buffer_load_dwordx4 a[4:7], v1, s[20:23], s44 offen offset:2048 sc1
 buffer_load_dwordx4 a[20:23], v1, s[20:23], s44 offen offset:3072 sc1
 s_add_u32 s44, s44, 4096
 buffer_load_dwordx4 a[8:11], v1, s[20:23], s44 offen offset:0 sc1
 buffer_load_dwordx4 a[24:27], v1, s[20:23], s44 offen offset:1024 sc1
 buffer_load_dwordx4 a[12:15], v1, s[20:23], s44 offen offset:2048 sc1
 buffer_load_dwordx4 a[28:31], v1, s[20:23], s44 offen offset:3072 sc1
 s_lshl_b32 s44, s33, 3
 s_add_u32 s44, s44, 7
 s_sub_u32 s44, s44, s4
 s_lshl_b32 s44, s44, 5
 s_add_u32 s44, s44, s32
 s_lshl_b32 s44, s44, 13
 s_add_u32 s44, s44, 0x5000000
 buffer_load_dwordx4 a[32:35], v1, s[20:23], s44 offen offset:0 sc1
 buffer_load_dwordx4 a[48:51], v1, s[20:23], s44 offen offset:1024 sc1
 buffer_load_dwordx4 a[36:39], v1, s[20:23], s44 offen offset:2048 sc1
 buffer_load_dwordx4 a[52:55], v1, s[20:23], s44 offen offset:3072 sc1
 s_add_u32 s44, s44, 4096
 buffer_load_dwordx4 a[40:43], v1, s[20:23], s44 offen offset:0 sc1
 buffer_load_dwordx4 a[56:59], v1, s[20:23], s44 offen offset:1024 sc1
 buffer_load_dwordx4 a[44:47], v1, s[20:23], s44 offen offset:2048 sc1
 buffer_load_dwordx4 a[60:63], v1, s[20:23], s44 offen offset:3072 sc1
 s_lshl_b32 s37, s35, 19
 s_add_u32 m0, s38, s50
 s_add_u32 s37, s37, s45
 buffer_load_dwordx4 v1, s[20:23], s37 offen offset:0 sc1 lds
 buffer_load_dwordx4 v1, s[20:23], s37 offen offset:1024 sc1 lds
 buffer_load_dwordx4 v1, s[20:23], s37 offen offset:2048 sc1 lds
 buffer_load_dwordx4 v1, s[20:23], s37 offen offset:3072 sc1 lds
 s_add_u32 s38, s38, 0x4000
 s_and_b32 s38, s38, 0x1ffff
 s_add_u32 s35, s35, 1
 s_cmp_eq_u32 s35, s36
 s_cselect_b32 s36, s47, s36
 s_cselect_b32 s35, 0, s35
 s_lshl_b32 s37, s35, 19
 s_add_u32 m0, s38, s50
 s_add_u32 s37, s37, s45
 buffer_load_dwordx4 v1, s[20:23], s37 offen offset:0 sc1 lds
 buffer_load_dwordx4 v1, s[20:23], s37 offen offset:1024 sc1 lds
 buffer_load_dwordx4 v1, s[20:23], s37 offen offset:2048 sc1 lds
 buffer_load_dwordx4 v1, s[20:23], s37 offen offset:3072 sc1 lds
 s_add_u32 s38, s38, 0x4000
 s_and_b32 s38, s38, 0x1ffff
 s_add_u32 s35, s35, 1
 s_cmp_eq_u32 s35, s36
 s_cselect_b32 s36, s47, s36
 s_cselect_b32 s35, 0, s35
 s_lshl_b32 s37, s35, 19
 s_add_u32 m0, s38, s50
 s_add_u32 s37, s37, s45
 buffer_load_dwordx4 v1, s[20:23], s37 offen offset:0 sc1 lds
 buffer_load_dwordx4 v1, s[20:23], s37 offen offset:1024 sc1 lds
 buffer_load_dwordx4 v1, s[20:23], s37 offen offset:2048 sc1 lds
 buffer_load_dwordx4 v1, s[20:23], s37 offen offset:3072 sc1 lds
 s_add_u32 s38, s38, 0x4000
 s_and_b32 s38, s38, 0x1ffff
 s_add_u32 s35, s35, 1
 s_cmp_eq_u32 s35, s36
 s_cselect_b32 s36, s47, s36
 s_cselect_b32 s35, 0, s35
 s_lshl_b32 s37, s35, 19
 s_add_u32 m0, s38, s50
 s_add_u32 s37, s37, s45
 buffer_load_dwordx4 v1, s[20:23], s37 offen offset:0 sc1 lds
 buffer_load_dwordx4 v1, s[20:23], s37 offen offset:1024 sc1 lds
 buffer_load_dwordx4 v1, s[20:23], s37 offen offset:2048 sc1 lds
 buffer_load_dwordx4 v1, s[20:23], s37 offen offset:3072 sc1 lds
 s_add_u32 s38, s38, 0x4000
 s_and_b32 s38, s38, 0x1ffff
 s_add_u32 s35, s35, 1
 s_cmp_eq_u32 s35, s36
 s_cselect_b32 s36, s47, s36
 s_cselect_b32 s35, 0, s35
 s_lshl_b32 s37, s35, 19
 s_add_u32 m0, s38, s50
 s_add_u32 s37, s37, s45
 buffer_load_dwordx4 v1, s[20:23], s37 offen offset:0 sc1 lds
 buffer_load_dwordx4 v1, s[20:23], s37 offen offset:1024 sc1 lds
 buffer_load_dwordx4 v1, s[20:23], s37 offen offset:2048 sc1 lds
 buffer_load_dwordx4 v1, s[20:23], s37 offen offset:3072 sc1 lds
 s_add_u32 s38, s38, 0x4000
 s_and_b32 s38, s38, 0x1ffff
 s_add_u32 s35, s35, 1
 s_cmp_eq_u32 s35, s36
 s_cselect_b32 s36, s47, s36
 s_cselect_b32 s35, 0, s35
 s_lshl_b32 s37, s35, 19
 s_add_u32 m0, s38, s50
 s_add_u32 s37, s37, s45
 buffer_load_dwordx4 v1, s[20:23], s37 offen offset:0 sc1 lds
 buffer_load_dwordx4 v1, s[20:23], s37 offen offset:1024 sc1 lds
 buffer_load_dwordx4 v1, s[20:23], s37 offen offset:2048 sc1 lds
 buffer_load_dwordx4 v1, s[20:23], s37 offen offset:3072 sc1 lds
 s_add_u32 s38, s38, 0x4000
 s_and_b32 s38, s38, 0x1ffff
 s_add_u32 s35, s35, 1
 s_cmp_eq_u32 s35, s36
 s_cselect_b32 s36, s47, s36
 s_cselect_b32 s35, 0, s35
 s_lshl_b32 s44, s34, 3
 s_add_u32 s44, s44, s4
 s_lshl_b32 s44, s44, 5
 s_add_u32 s44, s44, s32
 s_lshl_b32 s44, s44, 13
 s_add_u32 s44, s44, 0x5000000
 buffer_load_dwordx4 a[64:67], v1, s[20:23], s44 offen offset:0 sc1
 buffer_load_dwordx4 a[80:83], v1, s[20:23], s44 offen offset:1024 sc1
 buffer_load_dwordx4 a[68:71], v1, s[20:23], s44 offen offset:2048 sc1
 buffer_load_dwordx4 a[84:87], v1, s[20:23], s44 offen offset:3072 sc1
 s_add_u32 s44, s44, 4096
 buffer_load_dwordx4 a[72:75], v1, s[20:23], s44 offen offset:0 sc1
 buffer_load_dwordx4 a[88:91], v1, s[20:23], s44 offen offset:1024 sc1
 buffer_load_dwordx4 a[76:79], v1, s[20:23], s44 offen offset:2048 sc1
 buffer_load_dwordx4 a[92:95], v1, s[20:23], s44 offen offset:3072 sc1
 s_lshl_b32 s44, s34, 3
 s_add_u32 s44, s44, 7
 s_sub_u32 s44, s44, s4
 s_lshl_b32 s44, s44, 5
 s_add_u32 s44, s44, s32
 s_lshl_b32 s44, s44, 13
 s_add_u32 s44, s44, 0x5000000
 buffer_load_dwordx4 a[96:99], v1, s[20:23], s44 offen offset:0 sc1
 buffer_load_dwordx4 a[112:115], v1, s[20:23], s44 offen offset:1024 sc1
 buffer_load_dwordx4 a[100:103], v1, s[20:23], s44 offen offset:2048 sc1
 buffer_load_dwordx4 a[116:119], v1, s[20:23], s44 offen offset:3072 sc1
 s_add_u32 s44, s44, 4096
 buffer_load_dwordx4 a[104:107], v1, s[20:23], s44 offen offset:0 sc1
 buffer_load_dwordx4 a[120:123], v1, s[20:23], s44 offen offset:1024 sc1
 buffer_load_dwordx4 a[108:111], v1, s[20:23], s44 offen offset:2048 sc1
 buffer_load_dwordx4 a[124:127], v1, s[20:23], s44 offen offset:3072 sc1
 s_waitcnt vmcnt(40)
 s_barrier
 v_mov_b32 v2, v1
 ds_read_b128 a[128:131], v2 offset:0
 ds_read_b128 a[132:135], v2 offset:1024
 ds_read_b128 a[136:139], v2 offset:2048
 ds_read_b128 a[140:143], v2 offset:3072
 ds_read_b128 a[144:147], v2 offset:4096
 ds_read_b128 a[148:151], v2 offset:5120
 ds_read_b128 a[152:155], v2 offset:6144
 ds_read_b128 a[156:159], v2 offset:7168
 s_mov_b32 s39, 0
 s_add_u32 s39, s39, 0x4000
 s_and_b32 s39, s39, 0x1ffff
 v_mov_b32 v3, v2
 v_add_u32 v2, s39, v1
 s_mov_b32 s72, 0x8000000
Lablk_6:
 s_lshl_b32 s43, s33, 3
 s_add_u32 s41, s43, s4
 s_add_u32 s42, s43, 7
 s_sub_u32 s42, s42, s4
 s_mov_b32 s49, 0
 s_waitcnt lgkmcnt(0)
 v_mfma_f32_16x16x32_bf16 v[48:51], a[128:131], a[0:3], 0
 s_cmp_lt_u32 s49, s41
 v_mov_b64 v[176:177], 0
 v_mov_b64 v[178:179], 0
 v_mfma_f32_16x16x32_bf16 v[56:59], a[128:131], a[16:19], 0
 s_cselect_b64 s[68:69], -1, 0
 v_mov_b64 v[180:181], 0
 v_mov_b64 v[182:183], 0
 v_mfma_f32_16x16x32_bf16 v[64:67], a[128:131], a[32:35], 0
 v_mfma_f32_16x16x32_bf16 v[72:75], a[128:131], a[48:51], 0
 s_cmp_le_u32 s49, s41
 v_mov_b64 v[184:185], 0
 v_mov_b64 v[186:187], 0
 v_mfma_f32_16x16x32_bf16 v[48:51], a[136:139], a[4:7], v[48:51]
 v_mfma_f32_16x16x32_bf16 v[56:59], a[136:139], a[20:23], v[56:59]
 s_cselect_b64 s[70:71], -1, 0
 v_mov_b64 v[188:189], 0
 v_mov_b64 v[190:191], 0
 v_mfma_f32_16x16x32_bf16 v[64:67], a[136:139], a[36:39], v[64:67]
 v_mfma_f32_16x16x32_bf16 v[72:75], a[136:139], a[52:55], v[72:75]
 s_cmp_eq_u32 s49, s41
 v_mov_b64 v[192:193], 0
 v_mov_b64 v[194:195], 0
 v_mfma_f32_16x16x32_bf16 v[48:51], a[144:147], a[8:11], v[48:51]
 s_cselect_b64 s[60:61], s[52:53], s[68:69]
 v_mfma_f32_16x16x32_bf16 v[56:59], a[144:147], a[24:27], v[56:59]
 v_mov_b64 v[196:197], 0
 v_mov_b64 v[198:199], 0
 v_mfma_f32_16x16x32_bf16 v[64:67], a[144:147], a[40:43], v[64:67]
 s_cselect_b64 s[62:63], s[54:55], s[68:69]
 v_mfma_f32_16x16x32_bf16 v[72:75], a[144:147], a[56:59], v[72:75]
 v_mov_b64 v[200:201], 0
 v_mov_b64 v[202:203], 0
 v_mfma_f32_16x16x32_bf16 v[48:51], a[152:155], a[12:15], v[48:51]
 s_cselect_b64 s[64:65], s[56:57], s[68:69]
 v_mfma_f32_16x16x32_bf16 v[56:59], a[152:155], a[28:31], v[56:59]
 v_mov_b64 v[204:205], 0
 v_mov_b64 v[206:207], 0
 v_mfma_f32_16x16x32_bf16 v[64:67], a[152:155], a[44:47], v[64:67]
 s_cselect_b64 s[66:67], s[58:59], s[68:69]
 v_mfma_f32_16x16x32_bf16 v[72:75], a[152:155], a[60:63], v[72:75]
 s_nop 4
 v_max3_f32 v12, v48, v49, v50
 v_max3_f32 v13, v56, v57, v58
 v_max3_f32 v14, v64, v65, v66
 v_max3_f32 v15, v72, v73, v74
 v_max_f32 v12, v12, v51
 v_max_f32 v13, v13, v59
 v_max_f32 v14, v14, v67
 v_max_f32 v15, v15, v75
 v_mov_b32 v6, v12
 v_mov_b32 v7, v13
 v_mov_b32 v8, v14
 v_mov_b32 v9, v15
 v_permlane16_swap_b32 v12, v6
 v_permlane16_swap_b32 v13, v7
 v_permlane16_swap_b32 v14, v8
 v_permlane16_swap_b32 v15, v9
 v_max_f32 v12, v12, v6
 v_max_f32 v13, v13, v7
 v_max_f32 v14, v14, v8
 v_max_f32 v15, v15, v9
 v_mov_b32 v6, v12
 v_mov_b32 v7, v13
 v_mov_b32 v8, v14
 v_mov_b32 v9, v15
 v_permlane32_swap_b32 v12, v6
 v_permlane32_swap_b32 v13, v7
 v_permlane32_swap_b32 v14, v8
 v_permlane32_swap_b32 v15, v9
 v_max_f32 v12, v12, v6
 v_max_f32 v13, v13, v7
 v_max_f32 v14, v14, v8
 v_max_f32 v15, v15, v9
 v_sub_f32 v12, 0, v12
 v_sub_f32 v13, 0, v13
 v_sub_f32 v14, 0, v14
 v_sub_f32 v15, 0, v15
 v_cndmask_b32 v80, v4, v12, s[60:61]
 v_cndmask_b32 v81, v4, v12, s[62:63]
 v_cndmask_b32 v82, v4, v12, s[64:65]
 v_cndmask_b32 v83, v4, v12, s[66:67]
 v_cndmask_b32 v84, v4, v12, s[68:69]
 v_cndmask_b32 v85, v4, v12, s[68:69]
 v_cndmask_b32 v86, v4, v12, s[68:69]
 v_cndmask_b32 v87, v4, v12, s[68:69]
 v_cndmask_b32 v88, v4, v13, s[70:71]
 v_cndmask_b32 v89, v4, v13, s[70:71]
 v_cndmask_b32 v90, v4, v13, s[70:71]
 v_cndmask_b32 v91, v4, v13, s[70:71]
 v_cndmask_b32 v92, v4, v13, s[60:61]
 v_cndmask_b32 v93, v4, v13, s[62:63]
 v_cndmask_b32 v94, v4, v13, s[64:65]
 v_cndmask_b32 v95, v4, v13, s[66:67]
 v_mov_b32 v96, v14
 v_mov_b32 v97, v14
 v_mov_b32 v98, v14
 v_mov_b32 v99, v14
 v_mov_b32 v100, v14
 v_mov_b32 v101, v14
 v_mov_b32 v102, v14
 v_mov_b32 v103, v14
 v_mov_b32 v104, v15
 v_mov_b32 v105, v15
 v_mov_b32 v106, v15
 v_mov_b32 v107, v15
 v_mov_b32 v108, v15
 v_mov_b32 v109, v15
 v_mov_b32 v110, v15
 v_mov_b32 v111, v15
 v_mov_b32 v6, 1
 s_waitcnt lgkmcnt(0)
 v_mfma_f32_16x16x32_bf16 v[48:51], a[128:131], a[0:3], v[80:83]
 ds_read_b128 a[160:163], v3 offset:8192
 v_mov_b64 v[208:209], 0
 v_mov_b64 v[210:211], 0
 v_mfma_f32_16x16x32_bf16 v[56:59], a[128:131], a[16:19], v[88:91]
 v_mov_b64 v[212:213], 0
 v_mov_b64 v[214:215], 0
 v_mfma_f32_16x16x32_bf16 v[52:55], a[132:135], a[0:3], v[84:87]
 ds_read_b128 a[164:167], v3 offset:9216
 v_mfma_f32_16x16x32_bf16 v[60:63], a[132:135], a[16:19], v[92:95]
 v_mov_b64 v[216:217], 0
 v_mov_b64 v[218:219], 0
 v_mfma_f32_16x16x32_bf16 v[48:51], a[136:139], a[4:7], v[48:51]
 ds_read_b128 a[168:171], v3 offset:10240
 v_mov_b64 v[220:221], 0
 v_mov_b64 v[222:223], 0
 v_mfma_f32_16x16x32_bf16 v[56:59], a[136:139], a[20:23], v[56:59]
 v_mfma_f32_16x16x32_bf16 v[52:55], a[140:143], a[4:7], v[52:55]
 ds_read_b128 a[172:175], v3 offset:11264
 v_mov_b64 v[224:225], 0
 v_mov_b64 v[226:227], 0
 v_mfma_f32_16x16x32_bf16 v[60:63], a[140:143], a[20:23], v[60:63]
 v_mov_b64 v[228:229], 0
 v_mov_b64 v[230:231], 0
 v_mfma_f32_16x16x32_bf16 v[48:51], a[144:147], a[8:11], v[48:51]
 ds_read_b128 a[176:179], v3 offset:12288
 v_mfma_f32_16x16x32_bf16 v[56:59], a[144:147], a[24:27], v[56:59]
 v_mov_b64 v[232:233], 0
 v_mov_b64 v[234:235], 0
 v_mfma_f32_16x16x32_bf16 v[52:55], a[148:151], a[8:11], v[52:55]
 ds_read_b128 a[180:183], v3 offset:13312
 v_mov_b64 v[236:237], 0
 v_mov_b64 v[238:239], 0
 v_mfma_f32_16x16x32_bf16 v[60:63], a[148:151], a[24:27], v[60:63]
 v_mfma_f32_16x16x32_bf16 v[48:51], a[152:155], a[12:15], v[48:51]
 ds_read_b128 a[184:187], v3 offset:14336
 v_mov_b64 v[40:41], 0
 v_mov_b64 v[42:43], 0
 v_mfma_f32_16x16x32_bf16 v[56:59], a[152:155], a[28:31], v[56:59]
 v_mov_b64 v[44:45], 0
 v_mov_b64 v[46:47], 0
 v_mfma_f32_16x16x32_bf16 v[52:55], a[156:159], a[12:15], v[52:55]
 ds_read_b128 a[188:191], v3 offset:15360
 v_mfma_f32_16x16x32_bf16 v[60:63], a[156:159], a[28:31], v[60:63]
 v_mfma_f32_16x16x32_bf16 v[64:67], a[128:131], a[32:35], v[96:99]
 s_waitcnt vmcnt(0)
 s_barrier
 buffer_store_dword v6, v5, s[20:23], s72 offen sc1
 v_mfma_f32_16x16x32_bf16 v[72:75], a[128:131], a[48:51], v[104:107]
 ds_read_b128 a[128:131], v2 offset:0
 v_mfma_f32_16x16x32_bf16 v[68:71], a[132:135], a[32:35], v[100:103]
 s_add_u32 s49, s49, 1
 v_mfma_f32_16x16x32_bf16 v[76:79], a[132:135], a[48:51], v[108:111]
 ds_read_b128 a[132:135], v2 offset:1024
 v_exp_f32 v48, v48
 v_exp_f32 v49, v49
 v_mfma_f32_16x16x32_bf16 v[64:67], a[136:139], a[36:39], v[64:67]
 s_cmp_lt_u32 s49, s41
 v_exp_f32 v52, v52
 v_exp_f32 v53, v53
 v_mfma_f32_16x16x32_bf16 v[72:75], a[136:139], a[52:55], v[72:75]
 ds_read_b128 a[136:139], v2 offset:2048
 v_exp_f32 v50, v50
 v_mfma_f32_16x16x32_bf16 v[68:71], a[140:143], a[36:39], v[68:71]
 s_cselect_b64 s[68:69], -1, 0
 v_cvt_pk_bf16_f32 v16, v48, v49
 v_cvt_pk_bf16_f32 v17, v52, v53
 v_exp_f32 v51, v51
 v_mfma_f32_16x16x32_bf16 v[76:79], a[140:143], a[52:55], v[76:79]
 ds_read_b128 a[140:143], v2 offset:3072
 v_exp_f32 v54, v54
 v_exp_f32 v55, v55
 v_mfma_f32_16x16x32_bf16 v[64:67], a[144:147], a[40:43], v[64:67]
 v_cvt_pk_bf16_f32 v18, v50, v51
 v_cvt_pk_bf16_f32 v19, v54, v55
 v_mfma_f32_16x16x32_bf16 v[72:75], a[144:147], a[56:59], v[72:75]
 ds_read_b128 a[144:147], v2 offset:4096
 v_exp_f32 v56, v56
 v_exp_f32 v57, v57
 v_mfma_f32_16x16x32_bf16 v[68:71], a[148:151], a[40:43], v[68:71]
 s_cmp_le_u32 s49, s41
 v_exp_f32 v60, v60
 v_exp_f32 v61, v61
 v_mfma_f32_16x16x32_bf16 v[76:79], a[148:151], a[56:59], v[76:79]
 ds_read_b128 a[148:151], v2 offset:5120
 v_exp_f32 v58, v58
 v_mfma_f32_16x16x32_bf16 v[64:67], a[152:155], a[44:47], v[64:67]
 s_cselect_b64 s[70:71], -1, 0
 v_cvt_pk_bf16_f32 v20, v56, v57
 v_cvt_pk_bf16_f32 v21, v60, v61
 v_exp_f32 v59, v59
 v_mfma_f32_16x16x32_bf16 v[72:75], a[152:155], a[60:63], v[72:75]
 ds_read_b128 a[152:155], v2 offset:6144
 v_exp_f32 v62, v62
 v_exp_f32 v63, v63
 v_mfma_f32_16x16x32_bf16 v[68:71], a[156:159], a[44:47], v[68:71]
 v_cvt_pk_bf16_f32 v22, v58, v59
 v_cvt_pk_bf16_f32 v23, v62, v63
 v_mfma_f32_16x16x32_bf16 v[76:79], a[156:159], a[60:63], v[76:79]
 ds_read_b128 a[156:159], v2 offset:7168
 s_waitcnt lgkmcnt(8)
 v_mfma_f32_16x16x32_bf16 v[112:115], a[160:163], v[16:19], 0
 s_add_u32 s39, s39, 0x4000
 s_and_b32 s39, s39, 0x1ffff
 v_mfma_f32_16x16x32_bf16 v[144:147], a[160:163], v[20:23], 0
 s_cmp_eq_u32 s49, s41
 v_mfma_f32_16x16x32_bf16 v[116:119], a[164:167], v[16:19], 0
 s_cselect_b64 s[60:61], s[52:53], s[68:69]
 v_mfma_f32_16x16x32_bf16 v[148:151], a[164:167], v[20:23], 0
 s_cselect_b64 s[62:63], s[54:55], s[68:69]
 v_mov_b32 v3, v2
 v_add_u32 v2, s39, v1
 v_exp_f32 v64, v64
 v_mfma_f32_16x16x32_bf16 v[120:123], a[168:171], v[16:19], 0
 s_cselect_b64 s[64:65], s[56:57], s[68:69]
 v_exp_f32 v65, v65
 v_mfma_f32_16x16x32_bf16 v[152:155], a[168:171], v[20:23], 0
 s_cselect_b64 s[66:67], s[58:59], s[68:69]
 v_exp_f32 v68, v68
 v_mfma_f32_16x16x32_bf16 v[124:127], a[172:175], v[16:19], 0
 s_lshl_b32 s37, s35, 19
 v_exp_f32 v69, v69
 v_exp_f32 v66, v66
 v_mfma_f32_16x16x32_bf16 v[156:159], a[172:175], v[20:23], 0
 s_add_u32 m0, s38, s50
 v_cvt_pk_bf16_f32 v24, v64, v65
 v_cvt_pk_bf16_f32 v25, v68, v69
 v_mfma_f32_16x16x32_bf16 v[128:131], a[176:179], v[16:19], 0
 s_add_u32 s37, s37, s45
 v_exp_f32 v67, v67
 v_mfma_f32_16x16x32_bf16 v[160:163], a[176:179], v[20:23], 0
 buffer_load_dwordx4 v1, s[20:23], s37 offen offset:0 sc1 lds
 buffer_load_dwordx4 v1, s[20:23], s37 offen offset:1024 sc1 lds
 v_exp_f32 v70, v70
 v_mfma_f32_16x16x32_bf16 v[132:135], a[180:183], v[16:19], 0
 buffer_load_dwordx4 v1, s[20:23], s37 offen offset:2048 sc1 lds
 v_exp_f32 v71, v71
 v_cvt_pk_bf16_f32 v26, v66, v67
 v_cvt_pk_bf16_f32 v27, v70, v71
 v_mfma_f32_16x16x32_bf16 v[164:167], a[180:183], v[20:23], 0
 buffer_load_dwordx4 v1, s[20:23], s37 offen offset:3072 sc1 lds
 v_cndmask_b32 v80, v4, v12, s[60:61]
 v_cndmask_b32 v81, v4, v12, s[62:63]
 v_mfma_f32_16x16x32_bf16 v[136:139], a[184:187], v[16:19], 0
 s_add_u32 s38, s38, 0x4000
 v_cndmask_b32 v82, v4, v12, s[64:65]
 v_cndmask_b32 v83, v4, v12, s[66:67]
 v_mfma_f32_16x16x32_bf16 v[168:171], a[184:187], v[20:23], 0
 s_and_b32 s38, s38, 0x1ffff
 v_cndmask_b32 v84, v4, v12, s[68:69]
 v_cndmask_b32 v85, v4, v12, s[68:69]
 v_mfma_f32_16x16x32_bf16 v[140:143], a[188:191], v[16:19], 0
 s_add_u32 s35, s35, 1
 v_cndmask_b32 v86, v4, v12, s[68:69]
 v_cndmask_b32 v87, v4, v12, s[68:69]
 v_cndmask_b32 v88, v4, v13, s[70:71]
 v_cndmask_b32 v89, v4, v13, s[70:71]
 v_mfma_f32_16x16x32_bf16 v[172:175], a[188:191], v[20:23], 0
 s_cmp_eq_u32 s35, s36
 v_cndmask_b32 v90, v4, v13, s[70:71]
 v_cndmask_b32 v91, v4, v13, s[70:71]
 v_mfma_f32_16x16x32_bf16 v[32:35], a[192:195], v[16:19], 0
 s_cselect_b32 s36, s47, s36
 v_cndmask_b32 v92, v4, v13, s[60:61]
 v_cndmask_b32 v93, v4, v13, s[62:63]
 v_mfma_f32_16x16x32_bf16 v[36:39], a[192:195], v[20:23], 0
 s_cselect_b32 s35, 0, s35
 v_cndmask_b32 v94, v4, v13, s[64:65]
 v_cndmask_b32 v95, v4, v13, s[66:67]
 s_cmp_eq_u32 s43, 0
 s_cbranch_scc1 Lamk_11
 s_sub_u32 s40, s43, 1
 .p2align 3
Lapl_10:
 s_waitcnt lgkmcnt(0)
 v_mfma_f32_16x16x32_bf16 v[48:51], a[128:131], a[0:3], v[80:83]
 v_exp_f32 v72, v72
 v_mfma_f32_16x16x32_bf16 v[56:59], a[128:131], a[16:19], v[88:91]
 v_exp_f32 v73, v73
 v_mfma_f32_16x16x32_bf16 v[52:55], a[132:135], a[0:3], v[84:87]
 v_mfma_f32_16x16x32_bf16 v[60:63], a[132:135], a[16:19], v[92:95]
 v_exp_f32 v76, v76
 v_mfma_f32_16x16x32_bf16 v[48:51], a[136:139], a[4:7], v[48:51]
 v_exp_f32 v77, v77
 v_mfma_f32_16x16x32_bf16 v[56:59], a[136:139], a[20:23], v[56:59]
 v_mfma_f32_16x16x32_bf16 v[52:55], a[140:143], a[4:7], v[52:55]
 v_exp_f32 v74, v74
 v_mfma_f32_16x16x32_bf16 v[60:63], a[140:143], a[20:23], v[60:63]
 v_cvt_pk_bf16_f32 v28, v72, v73
 v_cvt_pk_bf16_f32 v29, v76, v77
 v_mfma_f32_16x16x32_bf16 v[48:51], a[144:147], a[8:11], v[48:51]
 v_mfma_f32_16x16x32_bf16 v[56:59], a[144:147], a[24:27], v[56:59]
 v_exp_f32 v75, v75
 v_mfma_f32_16x16x32_bf16 v[52:55], a[148:151], a[8:11], v[52:55]
 v_exp_f32 v78, v78
 v_mfma_f32_16x16x32_bf16 v[60:63], a[148:151], a[24:27], v[60:63]
 v_mfma_f32_16x16x32_bf16 v[48:51], a[152:155], a[12:15], v[48:51]
 v_exp_f32 v79, v79
 v_mfma_f32_16x16x32_bf16 v[56:59], a[152:155], a[28:31], v[56:59]
 v_cvt_pk_bf16_f32 v30, v74, v75
 v_cvt_pk_bf16_f32 v31, v78, v79
 v_mfma_f32_16x16x32_bf16 v[52:55], a[156:159], a[12:15], v[52:55]
 v_mfma_f32_16x16x32_bf16 v[60:63], a[156:159], a[28:31], v[60:63]
 v_mfma_f32_16x16x32_bf16 v[176:179], a[160:163], v[24:27], v[176:179]
 v_mfma_f32_16x16x32_bf16 v[208:211], a[160:163], v[28:31], v[208:211]
 ds_read_b128 a[160:163], v3 offset:8192
 v_mfma_f32_16x16x32_bf16 v[180:183], a[164:167], v[24:27], v[180:183]
 v_mfma_f32_16x16x32_bf16 v[212:215], a[164:167], v[28:31], v[212:215]
 ds_read_b128 a[164:167], v3 offset:9216
 v_exp_f32 v48, v48
 v_mfma_f32_16x16x32_bf16 v[184:187], a[168:171], v[24:27], v[184:187]
 v_exp_f32 v49, v49
 v_mfma_f32_16x16x32_bf16 v[216:219], a[168:171], v[28:31], v[216:219]
 ds_read_b128 a[168:171], v3 offset:10240
 v_exp_f32 v52, v52
 v_mfma_f32_16x16x32_bf16 v[188:191], a[172:175], v[24:27], v[188:191]
 v_mfma_f32_16x16x32_bf16 v[220:223], a[172:175], v[28:31], v[220:223]
 ds_read_b128 a[172:175], v3 offset:11264
 v_exp_f32 v53, v53
 v_mfma_f32_16x16x32_bf16 v[192:195], a[176:179], v[24:27], v[192:195]
 v_exp_f32 v50, v50
 v_mfma_f32_16x16x32_bf16 v[224:227], a[176:179], v[28:31], v[224:227]
 ds_read_b128 a[176:179], v3 offset:12288
 v_mfma_f32_16x16x32_bf16 v[196:199], a[180:183], v[24:27], v[196:199]
 v_cvt_pk_bf16_f32 v16, v48, v49
 v_cvt_pk_bf16_f32 v17, v52, v53
 v_mfma_f32_16x16x32_bf16 v[228:231], a[180:183], v[28:31], v[228:231]
 ds_read_b128 a[180:183], v3 offset:13312
 v_exp_f32 v51, v51
 v_mfma_f32_16x16x32_bf16 v[200:203], a[184:187], v[24:27], v[200:203]
 v_exp_f32 v54, v54
 v_mfma_f32_16x16x32_bf16 v[232:235], a[184:187], v[28:31], v[232:235]
 ds_read_b128 a[184:187], v3 offset:14336
 v_mfma_f32_16x16x32_bf16 v[204:207], a[188:191], v[24:27], v[204:207]
 v_exp_f32 v55, v55
 v_mfma_f32_16x16x32_bf16 v[236:239], a[188:191], v[28:31], v[236:239]
 ds_read_b128 a[188:191], v3 offset:15360
 v_cvt_pk_bf16_f32 v18, v50, v51
 v_cvt_pk_bf16_f32 v19, v54, v55
 v_mfma_f32_16x16x32_bf16 v[40:43], a[192:195], v[24:27], v[40:43]
 v_mfma_f32_16x16x32_bf16 v[44:47], a[192:195], v[28:31], v[44:47]
 v_mfma_f32_16x16x32_bf16 v[64:67], a[128:131], a[32:35], v[96:99]
 s_waitcnt vmcnt(20)
 s_barrier
 v_exp_f32 v56, v56
 v_mfma_f32_16x16x32_bf16 v[72:75], a[128:131], a[48:51], v[104:107]
 ds_read_b128 a[128:131], v2 offset:0
 v_exp_f32 v57, v57
 v_mfma_f32_16x16x32_bf16 v[68:71], a[132:135], a[32:35], v[100:103]
 s_add_u32 s39, s39, 0x4000
 v_mfma_f32_16x16x32_bf16 v[76:79], a[132:135], a[48:51], v[108:111]
 ds_read_b128 a[132:135], v2 offset:1024
 v_exp_f32 v60, v60
 v_mfma_f32_16x16x32_bf16 v[64:67], a[136:139], a[36:39], v[64:67]
 v_exp_f32 v61, v61
 v_mfma_f32_16x16x32_bf16 v[72:75], a[136:139], a[52:55], v[72:75]
 ds_read_b128 a[136:139], v2 offset:2048
 v_mfma_f32_16x16x32_bf16 v[68:71], a[140:143], a[36:39], v[68:71]
 v_exp_f32 v58, v58
 v_mfma_f32_16x16x32_bf16 v[76:79], a[140:143], a[52:55], v[76:79]
 ds_read_b128 a[140:143], v2 offset:3072
 v_cvt_pk_bf16_f32 v20, v56, v57
 v_cvt_pk_bf16_f32 v21, v60, v61
 v_mfma_f32_16x16x32_bf16 v[64:67], a[144:147], a[40:43], v[64:67]
 s_and_b32 s39, s39, 0x1ffff
 v_mfma_f32_16x16x32_bf16 v[72:75], a[144:147], a[56:59], v[72:75]
 ds_read_b128 a[144:147], v2 offset:4096
 v_exp_f32 v59, v59
 v_mfma_f32_16x16x32_bf16 v[68:71], a[148:151], a[40:43], v[68:71]
 v_exp_f32 v62, v62
 v_mfma_f32_16x16x32_bf16 v[76:79], a[148:151], a[56:59], v[76:79]
 ds_read_b128 a[148:151], v2 offset:5120
 v_mfma_f32_16x16x32_bf16 v[64:67], a[152:155], a[44:47], v[64:67]
 v_exp_f32 v63, v63
 v_mfma_f32_16x16x32_bf16 v[72:75], a[152:155], a[60:63], v[72:75]
 ds_read_b128 a[152:155], v2 offset:6144
 v_cvt_pk_bf16_f32 v22, v58, v59
 v_cvt_pk_bf16_f32 v23, v62, v63
 v_mfma_f32_16x16x32_bf16 v[68:71], a[156:159], a[44:47], v[68:71]
 v_mfma_f32_16x16x32_bf16 v[76:79], a[156:159], a[60:63], v[76:79]
 ds_read_b128 a[156:159], v2 offset:7168
 s_waitcnt lgkmcnt(8)
 v_mfma_f32_16x16x32_bf16 v[112:115], a[160:163], v[16:19], v[112:115]
 s_lshl_b32 s37, s35, 19
 v_mov_b32 v3, v2
 v_add_u32 v2, s39, v1
 v_mfma_f32_16x16x32_bf16 v[144:147], a[160:163], v[20:23], v[144:147]
 s_add_u32 m0, s38, s50
 v_mfma_f32_16x16x32_bf16 v[116:119], a[164:167], v[16:19], v[116:119]
 s_add_u32 s37, s37, s45
 v_mfma_f32_16x16x32_bf16 v[148:151], a[164:167], v[20:23], v[148:151]
 buffer_load_dwordx4 v1, s[20:23], s37 offen offset:0 sc1 lds
 v_exp_f32 v64, v64
 v_mfma_f32_16x16x32_bf16 v[120:123], a[168:171], v[16:19], v[120:123]
 buffer_load_dwordx4 v1, s[20:23], s37 offen offset:1024 sc1 lds
 v_mfma_f32_16x16x32_bf16 v[152:155], a[168:171], v[20:23], v[152:155]
 v_exp_f32 v65, v65
 v_mfma_f32_16x16x32_bf16 v[124:127], a[172:175], v[16:19], v[124:127]
 buffer_load_dwordx4 v1, s[20:23], s37 offen offset:2048 sc1 lds
 v_exp_f32 v68, v68
 v_mfma_f32_16x16x32_bf16 v[156:159], a[172:175], v[20:23], v[156:159]
 buffer_load_dwordx4 v1, s[20:23], s37 offen offset:3072 sc1 lds
 v_exp_f32 v69, v69
 v_mfma_f32_16x16x32_bf16 v[128:131], a[176:179], v[16:19], v[128:131]
 s_add_u32 s38, s38, 0x4000
 v_mfma_f32_16x16x32_bf16 v[160:163], a[176:179], v[20:23], v[160:163]
 s_and_b32 s38, s38, 0x1ffff
 v_exp_f32 v66, v66
 v_mfma_f32_16x16x32_bf16 v[132:135], a[180:183], v[16:19], v[132:135]
 s_add_u32 s35, s35, 1
 v_cvt_pk_bf16_f32 v24, v64, v65
 v_cvt_pk_bf16_f32 v25, v68, v69
 v_mfma_f32_16x16x32_bf16 v[164:167], a[180:183], v[20:23], v[164:167]
 v_exp_f32 v67, v67
 v_mfma_f32_16x16x32_bf16 v[136:139], a[184:187], v[16:19], v[136:139]
 s_cmp_eq_u32 s35, s36
 v_mfma_f32_16x16x32_bf16 v[168:171], a[184:187], v[20:23], v[168:171]
 s_cselect_b32 s36, s47, s36
 v_exp_f32 v70, v70
 v_mfma_f32_16x16x32_bf16 v[140:143], a[188:191], v[16:19], v[140:143]
 s_cselect_b32 s35, 0, s35
 v_exp_f32 v71, v71
 v_mfma_f32_16x16x32_bf16 v[172:175], a[188:191], v[20:23], v[172:175]
 s_add_u32 s49, s49, 1
 v_cvt_pk_bf16_f32 v26, v66, v67
 v_cvt_pk_bf16_f32 v27, v70, v71
 v_mfma_f32_16x16x32_bf16 v[32:35], a[192:195], v[16:19], v[32:35]
 s_cmp_lt_u32 s49, s40
 v_mfma_f32_16x16x32_bf16 v[36:39], a[192:195], v[20:23], v[36:39]
 s_cbranch_scc1 Lapl_10
Lamk_11:
 s_add_u32 s40, s43, 4
 .p2align 3
Lamk_13:
 s_waitcnt lgkmcnt(0)
 v_mfma_f32_16x16x32_bf16 v[48:51], a[128:131], a[0:3], v[80:83]
 s_add_u32 s49, s49, 1
 v_exp_f32 v72, v72
 v_mfma_f32_16x16x32_bf16 v[56:59], a[128:131], a[16:19], v[88:91]
 s_cmp_lt_u32 s49, s41
 v_exp_f32 v73, v73
 v_mfma_f32_16x16x32_bf16 v[52:55], a[132:135], a[0:3], v[84:87]
 v_mfma_f32_16x16x32_bf16 v[60:63], a[132:135], a[16:19], v[92:95]
 s_cselect_b64 s[68:69], -1, 0
 v_exp_f32 v76, v76
 v_mfma_f32_16x16x32_bf16 v[48:51], a[136:139], a[4:7], v[48:51]
 s_cmp_le_u32 s49, s41
 v_exp_f32 v77, v77
 v_mfma_f32_16x16x32_bf16 v[56:59], a[136:139], a[20:23], v[56:59]
 v_mfma_f32_16x16x32_bf16 v[52:55], a[140:143], a[4:7], v[52:55]
 s_cselect_b64 s[70:71], -1, 0
 v_exp_f32 v74, v74
 v_mfma_f32_16x16x32_bf16 v[60:63], a[140:143], a[20:23], v[60:63]
 v_cvt_pk_bf16_f32 v28, v72, v73
 v_cvt_pk_bf16_f32 v29, v76, v77
 v_mfma_f32_16x16x32_bf16 v[48:51], a[144:147], a[8:11], v[48:51]
 s_cmp_eq_u32 s49, s41
 v_mfma_f32_16x16x32_bf16 v[56:59], a[144:147], a[24:27], v[56:59]
 s_cselect_b64 s[60:61], s[52:53], s[68:69]
 v_exp_f32 v75, v75
 v_mfma_f32_16x16x32_bf16 v[52:55], a[148:151], a[8:11], v[52:55]
 v_exp_f32 v78, v78
 v_mfma_f32_16x16x32_bf16 v[60:63], a[148:151], a[24:27], v[60:63]
 s_cselect_b64 s[62:63], s[54:55], s[68:69]
 v_mfma_f32_16x16x32_bf16 v[48:51], a[152:155], a[12:15], v[48:51]
 s_cselect_b64 s[64:65], s[56:57], s[68:69]
 v_exp_f32 v79, v79
 v_mfma_f32_16x16x32_bf16 v[56:59], a[152:155], a[28:31], v[56:59]
 v_cvt_pk_bf16_f32 v30, v74, v75
 v_cvt_pk_bf16_f32 v31, v78, v79
 v_mfma_f32_16x16x32_bf16 v[52:55], a[156:159], a[12:15], v[52:55]
 s_cselect_b64 s[66:67], s[58:59], s[68:69]
 v_mfma_f32_16x16x32_bf16 v[60:63], a[156:159], a[28:31], v[60:63]
 v_mfma_f32_16x16x32_bf16 v[176:179], a[160:163], v[24:27], v[176:179]
 v_mfma_f32_16x16x32_bf16 v[208:211], a[160:163], v[28:31], v[208:211]
 ds_read_b128 a[160:163], v3 offset:8192
 v_mfma_f32_16x16x32_bf16 v[180:183], a[164:167], v[24:27], v[180:183]
 v_mfma_f32_16x16x32_bf16 v[212:215], a[164:167], v[28:31], v[212:215]
 ds_read_b128 a[164:167], v3 offset:9216
 v_exp_f32 v48, v48
 v_mfma_f32_16x16x32_bf16 v[184:187], a[168:171], v[24:27], v[184:187]
 v_exp_f32 v49, v49
 v_mfma_f32_16x16x32_bf16 v[216:219], a[168:171], v[28:31], v[216:219]
 ds_read_b128 a[168:171], v3 offset:10240
 v_exp_f32 v52, v52
 v_mfma_f32_16x16x32_bf16 v[188:191], a[172:175], v[24:27], v[188:191]
 v_exp_f32 v53, v53
 v_mfma_f32_16x16x32_bf16 v[220:223], a[172:175], v[28:31], v[220:223]
 ds_read_b128 a[172:175], v3 offset:11264
 v_exp_f32 v50, v50
 v_mfma_f32_16x16x32_bf16 v[192:195], a[176:179], v[24:27], v[192:195]
 v_cvt_pk_bf16_f32 v16, v48, v49
 v_cvt_pk_bf16_f32 v17, v52, v53
 v_mfma_f32_16x16x32_bf16 v[224:227], a[176:179], v[28:31], v[224:227]
 ds_read_b128 a[176:179], v3 offset:12288
 v_exp_f32 v51, v51
 v_mfma_f32_16x16x32_bf16 v[196:199], a[180:183], v[24:27], v[196:199]
 v_exp_f32 v54, v54
 v_mfma_f32_16x16x32_bf16 v[228:231], a[180:183], v[28:31], v[228:231]
 ds_read_b128 a[180:183], v3 offset:13312
 v_exp_f32 v55, v55
 v_mfma_f32_16x16x32_bf16 v[200:203], a[184:187], v[24:27], v[200:203]
 v_cvt_pk_bf16_f32 v18, v50, v51
 v_cvt_pk_bf16_f32 v19, v54, v55
 v_mfma_f32_16x16x32_bf16 v[232:235], a[184:187], v[28:31], v[232:235]
 ds_read_b128 a[184:187], v3 offset:14336
 v_cndmask_b32 v80, v4, v12, s[60:61]
 v_cndmask_b32 v81, v4, v12, s[62:63]
 v_mfma_f32_16x16x32_bf16 v[204:207], a[188:191], v[24:27], v[204:207]
 v_cndmask_b32 v82, v4, v12, s[64:65]
 v_cndmask_b32 v83, v4, v12, s[66:67]
 v_mfma_f32_16x16x32_bf16 v[236:239], a[188:191], v[28:31], v[236:239]
 ds_read_b128 a[188:191], v3 offset:15360
 v_cndmask_b32 v84, v4, v12, s[68:69]
 v_cndmask_b32 v85, v4, v12, s[68:69]
 v_mfma_f32_16x16x32_bf16 v[40:43], a[192:195], v[24:27], v[40:43]
 v_cndmask_b32 v86, v4, v12, s[68:69]
 v_cndmask_b32 v87, v4, v12, s[68:69]
 v_mfma_f32_16x16x32_bf16 v[44:47], a[192:195], v[28:31], v[44:47]
 v_mfma_f32_16x16x32_bf16 v[64:67], a[128:131], a[32:35], v[96:99]
 s_waitcnt vmcnt(20)
 s_barrier
 v_exp_f32 v56, v56
 v_mfma_f32_16x16x32_bf16 v[72:75], a[128:131], a[48:51], v[104:107]
 ds_read_b128 a[128:131], v2 offset:0
 v_exp_f32 v57, v57
 v_mfma_f32_16x16x32_bf16 v[68:71], a[132:135], a[32:35], v[100:103]
 s_add_u32 s39, s39, 0x4000
 v_exp_f32 v60, v60
 v_mfma_f32_16x16x32_bf16 v[76:79], a[132:135], a[48:51], v[108:111]
 ds_read_b128 a[132:135], v2 offset:1024
 v_exp_f32 v61, v61
 v_mfma_f32_16x16x32_bf16 v[64:67], a[136:139], a[36:39], v[64:67]
 v_exp_f32 v58, v58
 v_mfma_f32_16x16x32_bf16 v[72:75], a[136:139], a[52:55], v[72:75]
 ds_read_b128 a[136:139], v2 offset:2048
 v_cvt_pk_bf16_f32 v20, v56, v57
 v_cvt_pk_bf16_f32 v21, v60, v61
 v_mfma_f32_16x16x32_bf16 v[68:71], a[140:143], a[36:39], v[68:71]
 v_exp_f32 v59, v59
 v_mfma_f32_16x16x32_bf16 v[76:79], a[140:143], a[52:55], v[76:79]
 ds_read_b128 a[140:143], v2 offset:3072
 v_exp_f32 v62, v62
 v_mfma_f32_16x16x32_bf16 v[64:67], a[144:147], a[40:43], v[64:67]
 s_and_b32 s39, s39, 0x1ffff
 v_exp_f32 v63, v63
 v_mfma_f32_16x16x32_bf16 v[72:75], a[144:147], a[56:59], v[72:75]
 ds_read_b128 a[144:147], v2 offset:4096
 v_cvt_pk_bf16_f32 v22, v58, v59
 v_cvt_pk_bf16_f32 v23, v62, v63
 v_mfma_f32_16x16x32_bf16 v[68:71], a[148:151], a[40:43], v[68:71]
 v_cndmask_b32 v88, v4, v13, s[70:71]
 v_cndmask_b32 v89, v4, v13, s[70:71]
 v_mfma_f32_16x16x32_bf16 v[76:79], a[148:151], a[56:59], v[76:79]
 ds_read_b128 a[148:151], v2 offset:5120
 v_cndmask_b32 v90, v4, v13, s[70:71]
 v_cndmask_b32 v91, v4, v13, s[70:71]
 v_mfma_f32_16x16x32_bf16 v[64:67], a[152:155], a[44:47], v[64:67]
 v_cndmask_b32 v92, v4, v13, s[60:61]
 v_cndmask_b32 v93, v4, v13, s[62:63]
 v_mfma_f32_16x16x32_bf16 v[72:75], a[152:155], a[60:63], v[72:75]
 ds_read_b128 a[152:155], v2 offset:6144
 v_cndmask_b32 v94, v4, v13, s[64:65]
 v_cndmask_b32 v95, v4, v13, s[66:67]
 v_mfma_f32_16x16x32_bf16 v[68:71], a[156:159], a[44:47], v[68:71]
 v_mfma_f32_16x16x32_bf16 v[76:79], a[156:159], a[60:63], v[76:79]
 ds_read_b128 a[156:159], v2 offset:7168
 s_waitcnt lgkmcnt(8)
 v_mfma_f32_16x16x32_bf16 v[112:115], a[160:163], v[16:19], v[112:115]
 s_lshl_b32 s37, s35, 19
 v_mov_b32 v3, v2
 v_add_u32 v2, s39, v1
 v_mfma_f32_16x16x32_bf16 v[144:147], a[160:163], v[20:23], v[144:147]
 s_add_u32 m0, s38, s50
 v_mfma_f32_16x16x32_bf16 v[116:119], a[164:167], v[16:19], v[116:119]
 s_add_u32 s37, s37, s45
 v_mfma_f32_16x16x32_bf16 v[148:151], a[164:167], v[20:23], v[148:151]
 buffer_load_dwordx4 v1, s[20:23], s37 offen offset:0 sc1 lds
 v_exp_f32 v64, v64
 v_mfma_f32_16x16x32_bf16 v[120:123], a[168:171], v[16:19], v[120:123]
 v_mfma_f32_16x16x32_bf16 v[152:155], a[168:171], v[20:23], v[152:155]
 buffer_load_dwordx4 v1, s[20:23], s37 offen offset:1024 sc1 lds
 v_exp_f32 v65, v65
 v_mfma_f32_16x16x32_bf16 v[124:127], a[172:175], v[16:19], v[124:127]
 buffer_load_dwordx4 v1, s[20:23], s37 offen offset:2048 sc1 lds
 v_exp_f32 v68, v68
 v_mfma_f32_16x16x32_bf16 v[156:159], a[172:175], v[20:23], v[156:159]
 buffer_load_dwordx4 v1, s[20:23], s37 offen offset:3072 sc1 lds
 v_exp_f32 v69, v69
 v_mfma_f32_16x16x32_bf16 v[128:131], a[176:179], v[16:19], v[128:131]
 v_mfma_f32_16x16x32_bf16 v[160:163], a[176:179], v[20:23], v[160:163]
 s_add_u32 s38, s38, 0x4000
 v_exp_f32 v66, v66
 v_mfma_f32_16x16x32_bf16 v[132:135], a[180:183], v[16:19], v[132:135]
 s_and_b32 s38, s38, 0x1ffff
 v_cvt_pk_bf16_f32 v24, v64, v65
 v_cvt_pk_bf16_f32 v25, v68, v69
 v_mfma_f32_16x16x32_bf16 v[164:167], a[180:183], v[20:23], v[164:167]
 s_add_u32 s35, s35, 1
 v_exp_f32 v67, v67
 v_mfma_f32_16x16x32_bf16 v[136:139], a[184:187], v[16:19], v[136:139]
 s_cmp_eq_u32 s35, s36
 v_mfma_f32_16x16x32_bf16 v[168:171], a[184:187], v[20:23], v[168:171]
 v_exp_f32 v70, v70
 v_mfma_f32_16x16x32_bf16 v[140:143], a[188:191], v[16:19], v[140:143]
 s_cselect_b32 s36, s47, s36
 v_exp_f32 v71, v71
 v_mfma_f32_16x16x32_bf16 v[172:175], a[188:191], v[20:23], v[172:175]
 s_cselect_b32 s35, 0, s35
 v_cvt_pk_bf16_f32 v26, v66, v67
 v_cvt_pk_bf16_f32 v27, v70, v71
 v_mfma_f32_16x16x32_bf16 v[32:35], a[192:195], v[16:19], v[32:35]
 s_cmp_lt_u32 s49, s40
 v_mfma_f32_16x16x32_bf16 v[36:39], a[192:195], v[20:23], v[36:39]
 s_cbranch_scc1 Lamk_13
 s_add_u32 s40, s43, 8
 s_cmp_lt_u32 s49, s42
 s_cselect_b64 s[68:69], -1, 0
 s_cmp_le_u32 s49, s42
 s_cselect_b64 s[70:71], -1, 0
 s_cmp_eq_u32 s49, s42
 s_cselect_b64 s[60:61], s[52:53], s[68:69]
 s_cselect_b64 s[62:63], s[54:55], s[68:69]
 s_cselect_b64 s[64:65], s[56:57], s[68:69]
 s_cselect_b64 s[66:67], s[58:59], s[68:69]
 v_mfma_f32_16x16x32_bf16 v[176:179], a[160:163], v[24:27], v[176:179]
 v_cndmask_b32 v96, v4, v14, s[60:61]
 v_cndmask_b32 v97, v4, v14, s[62:63]
 v_mfma_f32_16x16x32_bf16 v[180:183], a[164:167], v[24:27], v[180:183]
 v_cndmask_b32 v98, v4, v14, s[64:65]
 v_cndmask_b32 v99, v4, v14, s[66:67]
 v_mfma_f32_16x16x32_bf16 v[184:187], a[168:171], v[24:27], v[184:187]
 v_cndmask_b32 v100, v4, v14, s[68:69]
 v_cndmask_b32 v101, v4, v14, s[68:69]
 v_mfma_f32_16x16x32_bf16 v[188:191], a[172:175], v[24:27], v[188:191]
 v_exp_f32 v72, v72
 v_mfma_f32_16x16x32_bf16 v[192:195], a[176:179], v[24:27], v[192:195]
 v_exp_f32 v73, v73
 v_mfma_f32_16x16x32_bf16 v[196:199], a[180:183], v[24:27], v[196:199]
 v_exp_f32 v76, v76
 v_mfma_f32_16x16x32_bf16 v[200:203], a[184:187], v[24:27], v[200:203]
 v_exp_f32 v77, v77
 v_mfma_f32_16x16x32_bf16 v[204:207], a[188:191], v[24:27], v[204:207]
 v_exp_f32 v74, v74
 v_mfma_f32_16x16x32_bf16 v[40:43], a[192:195], v[24:27], v[40:43]
 v_cndmask_b32 v102, v4, v14, s[68:69]
 v_cndmask_b32 v103, v4, v14, s[68:69]
 s_nop 0
 .p2align 3
Lam1_12:
 s_waitcnt lgkmcnt(0)
 v_mfma_f32_16x16x32_bf16 v[64:67], a[128:131], a[32:35], v[96:99]
 v_cvt_pk_bf16_f32 v28, v72, v73
 v_cvt_pk_bf16_f32 v29, v76, v77
 v_mfma_f32_16x16x32_bf16 v[68:71], a[132:135], a[32:35], v[100:103]
 v_exp_f32 v75, v75
 v_mfma_f32_16x16x32_bf16 v[64:67], a[136:139], a[36:39], v[64:67]
 v_exp_f32 v78, v78
 v_mfma_f32_16x16x32_bf16 v[68:71], a[140:143], a[36:39], v[68:71]
 v_exp_f32 v79, v79
 v_mfma_f32_16x16x32_bf16 v[64:67], a[144:147], a[40:43], v[64:67]
 v_cvt_pk_bf16_f32 v30, v74, v75
 v_cvt_pk_bf16_f32 v31, v78, v79
 v_mfma_f32_16x16x32_bf16 v[68:71], a[148:151], a[40:43], v[68:71]
 v_cndmask_b32 v104, v4, v15, s[70:71]
 v_cndmask_b32 v105, v4, v15, s[70:71]
 v_mfma_f32_16x16x32_bf16 v[64:67], a[152:155], a[44:47], v[64:67]
 v_mfma_f32_16x16x32_bf16 v[68:71], a[156:159], a[44:47], v[68:71]
 v_mfma_f32_16x16x32_bf16 v[208:211], a[160:163], v[28:31], v[208:211]
 ds_read_b128 a[160:163], v3 offset:8192
 v_cndmask_b32 v106, v4, v15, s[70:71]
 v_cndmask_b32 v107, v4, v15, s[70:71]
 v_mfma_f32_16x16x32_bf16 v[212:215], a[164:167], v[28:31], v[212:215]
 ds_read_b128 a[164:167], v3 offset:9216
 v_cndmask_b32 v108, v4, v15, s[60:61]
 v_cndmask_b32 v109, v4, v15, s[62:63]
 v_mfma_f32_16x16x32_bf16 v[216:219], a[168:171], v[28:31], v[216:219]
 ds_read_b128 a[168:171], v3 offset:10240
 v_cndmask_b32 v110, v4, v15, s[64:65]
 v_cndmask_b32 v111, v4, v15, s[66:67]
 v_mfma_f32_16x16x32_bf16 v[220:223], a[172:175], v[28:31], v[220:223]
 ds_read_b128 a[172:175], v3 offset:11264
 v_exp_f32 v64, v64
 v_mfma_f32_16x16x32_bf16 v[224:227], a[176:179], v[28:31], v[224:227]
 ds_read_b128 a[176:179], v3 offset:12288
 v_exp_f32 v65, v65
 v_mfma_f32_16x16x32_bf16 v[228:231], a[180:183], v[28:31], v[228:231]
 ds_read_b128 a[180:183], v3 offset:13312
 v_exp_f32 v68, v68
 v_mfma_f32_16x16x32_bf16 v[232:235], a[184:187], v[28:31], v[232:235]
 ds_read_b128 a[184:187], v3 offset:14336
 v_exp_f32 v69, v69
 v_mfma_f32_16x16x32_bf16 v[236:239], a[188:191], v[28:31], v[236:239]
 ds_read_b128 a[188:191], v3 offset:15360
 v_exp_f32 v66, v66
 v_mfma_f32_16x16x32_bf16 v[44:47], a[192:195], v[28:31], v[44:47]
 v_mfma_f32_16x16x32_bf16 v[72:75], a[128:131], a[48:51], v[104:107]
 s_waitcnt vmcnt(20)
 s_barrier
 ds_read_b128 a[128:131], v2 offset:0
 s_add_u32 s39, s39, 0x4000
 v_cvt_pk_bf16_f32 v24, v64, v65
 v_cvt_pk_bf16_f32 v25, v68, v69
 v_mfma_f32_16x16x32_bf16 v[76:79], a[132:135], a[48:51], v[108:111]
 ds_read_b128 a[132:135], v2 offset:1024
 v_exp_f32 v67, v67
 v_mfma_f32_16x16x32_bf16 v[72:75], a[136:139], a[52:55], v[72:75]
 ds_read_b128 a[136:139], v2 offset:2048
 v_exp_f32 v70, v70
 v_mfma_f32_16x16x32_bf16 v[76:79], a[140:143], a[52:55], v[76:79]
 ds_read_b128 a[140:143], v2 offset:3072
 v_mfma_f32_16x16x32_bf16 v[72:75], a[144:147], a[56:59], v[72:75]
 ds_read_b128 a[144:147], v2 offset:4096
 s_and_b32 s39, s39, 0x1ffff
 v_exp_f32 v71, v71
 v_mfma_f32_16x16x32_bf16 v[76:79], a[148:151], a[56:59], v[76:79]
 ds_read_b128 a[148:151], v2 offset:5120
 v_cvt_pk_bf16_f32 v26, v66, v67
 v_cvt_pk_bf16_f32 v27, v70, v71
 v_mfma_f32_16x16x32_bf16 v[72:75], a[152:155], a[60:63], v[72:75]
 ds_read_b128 a[152:155], v2 offset:6144
 v_mfma_f32_16x16x32_bf16 v[76:79], a[156:159], a[60:63], v[76:79]
 ds_read_b128 a[156:159], v2 offset:7168
 s_waitcnt lgkmcnt(8)
 s_add_u32 s49, s49, 1
 s_cmp_lt_u32 s49, s42
 s_cselect_b64 s[68:69], -1, 0
 s_cmp_le_u32 s49, s42
 s_cselect_b64 s[70:71], -1, 0
 s_cmp_eq_u32 s49, s42
 s_cselect_b64 s[60:61], s[52:53], s[68:69]
 s_cselect_b64 s[62:63], s[54:55], s[68:69]
 s_cselect_b64 s[64:65], s[56:57], s[68:69]
 s_cselect_b64 s[66:67], s[58:59], s[68:69]
 v_mfma_f32_16x16x32_bf16 v[176:179], a[160:163], v[24:27], v[176:179]
 s_lshl_b32 s37, s35, 19
 s_add_u32 m0, s38, s50
 v_mov_b32 v3, v2
 v_add_u32 v2, s39, v1
 v_cndmask_b32 v96, v4, v14, s[60:61]
 v_cndmask_b32 v97, v4, v14, s[62:63]
 v_mfma_f32_16x16x32_bf16 v[180:183], a[164:167], v[24:27], v[180:183]
 s_add_u32 s37, s37, s45
 buffer_load_dwordx4 v1, s[20:23], s37 offen offset:0 sc1 lds
 v_cndmask_b32 v98, v4, v14, s[64:65]
 v_cndmask_b32 v99, v4, v14, s[66:67]
 v_mfma_f32_16x16x32_bf16 v[184:187], a[168:171], v[24:27], v[184:187]
 buffer_load_dwordx4 v1, s[20:23], s37 offen offset:1024 sc1 lds
 v_exp_f32 v72, v72
 v_mfma_f32_16x16x32_bf16 v[188:191], a[172:175], v[24:27], v[188:191]
 buffer_load_dwordx4 v1, s[20:23], s37 offen offset:2048 sc1 lds
 buffer_load_dwordx4 v1, s[20:23], s37 offen offset:3072 sc1 lds
 v_exp_f32 v73, v73
 v_mfma_f32_16x16x32_bf16 v[192:195], a[176:179], v[24:27], v[192:195]
 s_add_u32 s38, s38, 0x4000
 v_exp_f32 v76, v76
 v_mfma_f32_16x16x32_bf16 v[196:199], a[180:183], v[24:27], v[196:199]
 s_and_b32 s38, s38, 0x1ffff
 s_add_u32 s35, s35, 1
 v_exp_f32 v77, v77
 v_mfma_f32_16x16x32_bf16 v[200:203], a[184:187], v[24:27], v[200:203]
 s_cmp_eq_u32 s35, s36
 v_exp_f32 v74, v74
 v_mfma_f32_16x16x32_bf16 v[204:207], a[188:191], v[24:27], v[204:207]
 s_cselect_b32 s36, s47, s36
 s_cselect_b32 s35, 0, s35
 v_cndmask_b32 v100, v4, v14, s[68:69]
 v_cndmask_b32 v101, v4, v14, s[68:69]
 v_mfma_f32_16x16x32_bf16 v[40:43], a[192:195], v[24:27], v[40:43]
 s_cmp_lt_u32 s49, s40
 v_cndmask_b32 v102, v4, v14, s[68:69]
 v_cndmask_b32 v103, v4, v14, s[68:69]
 s_cbranch_scc1 Lam1_12
 v_cvt_pk_bf16_f32 v28, v72, v73
 v_cvt_pk_bf16_f32 v29, v76, v77
 v_exp_f32 v75, v75
 v_exp_f32 v78, v78
 v_exp_f32 v79, v79
 v_cvt_pk_bf16_f32 v30, v74, v75
 v_cvt_pk_bf16_f32 v31, v78, v79
 s_nop 1
 v_mfma_f32_16x16x32_bf16 v[44:47], a[192:195], v[28:31], v[44:47]
 v_mfma_f32_16x16x32_bf16 v[208:211], a[160:163], v[28:31], v[208:211]
 v_mfma_f32_16x16x32_bf16 v[212:215], a[164:167], v[28:31], v[212:215]
 v_mfma_f32_16x16x32_bf16 v[216:219], a[168:171], v[28:31], v[216:219]
 v_mfma_f32_16x16x32_bf16 v[220:223], a[172:175], v[28:31], v[220:223]
 v_mfma_f32_16x16x32_bf16 v[224:227], a[176:179], v[28:31], v[224:227]
 v_mfma_f32_16x16x32_bf16 v[228:231], a[180:183], v[28:31], v[228:231]
 v_mfma_f32_16x16x32_bf16 v[232:235], a[184:187], v[28:31], v[232:235]
 v_mfma_f32_16x16x32_bf16 v[236:239], a[188:191], v[28:31], v[236:239]
 v_cmp_ngt_f32 s[60:61], s73, v32
 v_cmp_nlt_f32 vcc, s74, v32
 s_or_b64 s[60:61], s[60:61], vcc
 v_cmp_ngt_f32 s[62:63], s73, v36
 v_cmp_nlt_f32 vcc, s74, v36
 s_or_b64 s[62:63], s[62:63], vcc
 v_cmp_ngt_f32 s[64:65], s73, v40
 v_cmp_nlt_f32 vcc, s74, v40
 s_or_b64 s[64:65], s[64:65], vcc
 v_cmp_ngt_f32 s[66:67], s73, v44
 v_cmp_nlt_f32 vcc, s74, v44
 s_or_b64 s[66:67], s[66:67], vcc
 s_or_b64 s[60:61], s[60:61], s[62:63]
 s_or_b64 s[64:65], s[64:65], s[66:67]
 s_or_b64 s[60:61], s[60:61], s[64:65]
 s_cbranch_scc1 Laslow_7
Laback_8:
 v_rcp_f32 v32, v32
 v_rcp_f32 v36, v36
 v_rcp_f32 v40, v40
 v_rcp_f32 v44, v44
 s_lshl_b32 s40, s41, 5
 s_add_u32 s40, s40, s32
 s_lshl_b32 s40, s40, 13
 s_add_u32 s40, s40, 0x6000000
 s_add_u32 s44, s40, 4096
 v_pk_mul_f32 v[112:113], v[112:113], v[32:33] op_sel_hi:[1,0]
 v_pk_mul_f32 v[114:115], v[114:115], v[32:33] op_sel_hi:[1,0]
 v_pk_mul_f32 v[116:117], v[116:117], v[32:33] op_sel_hi:[1,0]
 v_pk_mul_f32 v[118:119], v[118:119], v[32:33] op_sel_hi:[1,0]
 v_cvt_pk_bf16_f32 v240, v112, v113
 v_cvt_pk_bf16_f32 v241, v116, v117
 v_cvt_pk_bf16_f32 v242, v114, v115
 v_cvt_pk_bf16_f32 v243, v118, v119
 buffer_store_dwordx4 v[240:243], v1, s[20:23], s40 offen offset:0 sc1
 v_pk_mul_f32 v[120:121], v[120:121], v[32:33] op_sel_hi:[1,0]
 v_pk_mul_f32 v[122:123], v[122:123], v[32:33] op_sel_hi:[1,0]
 v_pk_mul_f32 v[124:125], v[124:125], v[32:33] op_sel_hi:[1,0]
 v_pk_mul_f32 v[126:127], v[126:127], v[32:33] op_sel_hi:[1,0]
 v_cvt_pk_bf16_f32 v244, v120, v121
 v_cvt_pk_bf16_f32 v245, v124, v125
 v_cvt_pk_bf16_f32 v246, v122, v123
 v_cvt_pk_bf16_f32 v247, v126, v127
 buffer_store_dwordx4 v[244:247], v1, s[20:23], s40 offen offset:2048 sc1
 v_pk_mul_f32 v[128:129], v[128:129], v[32:33] op_sel_hi:[1,0]
 v_pk_mul_f32 v[130:131], v[130:131], v[32:33] op_sel_hi:[1,0]
 v_pk_mul_f32 v[132:133], v[132:133], v[32:33] op_sel_hi:[1,0]
 v_pk_mul_f32 v[134:135], v[134:135], v[32:33] op_sel_hi:[1,0]
 v_cvt_pk_bf16_f32 v248, v128, v129
 v_cvt_pk_bf16_f32 v249, v132, v133
 v_cvt_pk_bf16_f32 v250, v130, v131
 v_cvt_pk_bf16_f32 v251, v134, v135
 buffer_store_dwordx4 v[248:251], v1, s[20:23], s44 offen offset:0 sc1
 v_pk_mul_f32 v[136:137], v[136:137], v[32:33] op_sel_hi:[1,0]
 v_pk_mul_f32 v[138:139], v[138:139], v[32:33] op_sel_hi:[1,0]
 v_pk_mul_f32 v[140:141], v[140:141], v[32:33] op_sel_hi:[1,0]
 v_pk_mul_f32 v[142:143], v[142:143], v[32:33] op_sel_hi:[1,0]
 v_cvt_pk_bf16_f32 v252, v136, v137
 v_cvt_pk_bf16_f32 v253, v140, v141
 v_cvt_pk_bf16_f32 v254, v138, v139
 v_cvt_pk_bf16_f32 v255, v142, v143
 buffer_store_dwordx4 v[252:255], v1, s[20:23], s44 offen offset:2048 sc1
 v_pk_mul_f32 v[144:145], v[144:145], v[36:37] op_sel_hi:[1,0]
 v_pk_mul_f32 v[146:147], v[146:147], v[36:37] op_sel_hi:[1,0]
 v_pk_mul_f32 v[148:149], v[148:149], v[36:37] op_sel_hi:[1,0]
 v_pk_mul_f32 v[150:151], v[150:151], v[36:37] op_sel_hi:[1,0]
 v_cvt_pk_bf16_f32 v240, v144, v145
 v_cvt_pk_bf16_f32 v241, v148, v149
 v_cvt_pk_bf16_f32 v242, v146, v147
 v_cvt_pk_bf16_f32 v243, v150, v151
 buffer_store_dwordx4 v[240:243], v1, s[20:23], s40 offen offset:1024 sc1
 v_pk_mul_f32 v[152:153], v[152:153], v[36:37] op_sel_hi:[1,0]
 v_pk_mul_f32 v[154:155], v[154:155], v[36:37] op_sel_hi:[1,0]
 v_pk_mul_f32 v[156:157], v[156:157], v[36:37] op_sel_hi:[1,0]
 v_pk_mul_f32 v[158:159], v[158:159], v[36:37] op_sel_hi:[1,0]
 v_cvt_pk_bf16_f32 v244, v152, v153
 v_cvt_pk_bf16_f32 v245, v156, v157
 v_cvt_pk_bf16_f32 v246, v154, v155
 v_cvt_pk_bf16_f32 v247, v158, v159
 buffer_store_dwordx4 v[244:247], v1, s[20:23], s40 offen offset:3072 sc1
 v_pk_mul_f32 v[160:161], v[160:161], v[36:37] op_sel_hi:[1,0]
 v_pk_mul_f32 v[162:163], v[162:163], v[36:37] op_sel_hi:[1,0]
 v_pk_mul_f32 v[164:165], v[164:165], v[36:37] op_sel_hi:[1,0]
 v_pk_mul_f32 v[166:167], v[166:167], v[36:37] op_sel_hi:[1,0]
 v_cvt_pk_bf16_f32 v248, v160, v161
 v_cvt_pk_bf16_f32 v249, v164, v165
 v_cvt_pk_bf16_f32 v250, v162, v163
 v_cvt_pk_bf16_f32 v251, v166, v167
 buffer_store_dwordx4 v[248:251], v1, s[20:23], s44 offen offset:1024 sc1
 v_pk_mul_f32 v[168:169], v[168:169], v[36:37] op_sel_hi:[1,0]
 v_pk_mul_f32 v[170:171], v[170:171], v[36:37] op_sel_hi:[1,0]
 v_pk_mul_f32 v[172:173], v[172:173], v[36:37] op_sel_hi:[1,0]
 v_pk_mul_f32 v[174:175], v[174:175], v[36:37] op_sel_hi:[1,0]
 v_cvt_pk_bf16_f32 v252, v168, v169
 v_cvt_pk_bf16_f32 v253, v172, v173
 v_cvt_pk_bf16_f32 v254, v170, v171
 v_cvt_pk_bf16_f32 v255, v174, v175
 buffer_store_dwordx4 v[252:255], v1, s[20:23], s44 offen offset:3072 sc1
 s_lshl_b32 s40, s42, 5
 s_add_u32 s40, s40, s32
 s_lshl_b32 s40, s40, 13
 s_add_u32 s40, s40, 0x6000000
 s_add_u32 s44, s40, 4096
 v_pk_mul_f32 v[176:177], v[176:177], v[40:41] op_sel_hi:[1,0]
 v_pk_mul_f32 v[178:179], v[178:179], v[40:41] op_sel_hi:[1,0]
 v_pk_mul_f32 v[180:181], v[180:181], v[40:41] op_sel_hi:[1,0]
 v_pk_mul_f32 v[182:183], v[182:183], v[40:41] op_sel_hi:[1,0]
 v_cvt_pk_bf16_f32 v240, v176, v177
 v_cvt_pk_bf16_f32 v241, v180, v181
 v_cvt_pk_bf16_f32 v242, v178, v179
 v_cvt_pk_bf16_f32 v243, v182, v183
 buffer_store_dwordx4 v[240:243], v1, s[20:23], s40 offen offset:0 sc1
 v_pk_mul_f32 v[184:185], v[184:185], v[40:41] op_sel_hi:[1,0]
 v_pk_mul_f32 v[186:187], v[186:187], v[40:41] op_sel_hi:[1,0]
 v_pk_mul_f32 v[188:189], v[188:189], v[40:41] op_sel_hi:[1,0]
 v_pk_mul_f32 v[190:191], v[190:191], v[40:41] op_sel_hi:[1,0]
 v_cvt_pk_bf16_f32 v244, v184, v185
 v_cvt_pk_bf16_f32 v245, v188, v189
 v_cvt_pk_bf16_f32 v246, v186, v187
 v_cvt_pk_bf16_f32 v247, v190, v191
 buffer_store_dwordx4 v[244:247], v1, s[20:23], s40 offen offset:2048 sc1
 v_pk_mul_f32 v[192:193], v[192:193], v[40:41] op_sel_hi:[1,0]
 v_pk_mul_f32 v[194:195], v[194:195], v[40:41] op_sel_hi:[1,0]
 v_pk_mul_f32 v[196:197], v[196:197], v[40:41] op_sel_hi:[1,0]
 v_pk_mul_f32 v[198:199], v[198:199], v[40:41] op_sel_hi:[1,0]
 v_cvt_pk_bf16_f32 v248, v192, v193
 v_cvt_pk_bf16_f32 v249, v196, v197
 v_cvt_pk_bf16_f32 v250, v194, v195
 v_cvt_pk_bf16_f32 v251, v198, v199
 buffer_store_dwordx4 v[248:251], v1, s[20:23], s44 offen offset:0 sc1
 v_pk_mul_f32 v[200:201], v[200:201], v[40:41] op_sel_hi:[1,0]
 v_pk_mul_f32 v[202:203], v[202:203], v[40:41] op_sel_hi:[1,0]
 v_pk_mul_f32 v[204:205], v[204:205], v[40:41] op_sel_hi:[1,0]
 v_pk_mul_f32 v[206:207], v[206:207], v[40:41] op_sel_hi:[1,0]
 v_cvt_pk_bf16_f32 v252, v200, v201
 v_cvt_pk_bf16_f32 v253, v204, v205
 v_cvt_pk_bf16_f32 v254, v202, v203
 v_cvt_pk_bf16_f32 v255, v206, v207
 buffer_store_dwordx4 v[252:255], v1, s[20:23], s44 offen offset:2048 sc1
 v_pk_mul_f32 v[208:209], v[208:209], v[44:45] op_sel_hi:[1,0]
 v_pk_mul_f32 v[210:211], v[210:211], v[44:45] op_sel_hi:[1,0]
 v_pk_mul_f32 v[212:213], v[212:213], v[44:45] op_sel_hi:[1,0]
 v_pk_mul_f32 v[214:215], v[214:215], v[44:45] op_sel_hi:[1,0]
 v_cvt_pk_bf16_f32 v240, v208, v209
 v_cvt_pk_bf16_f32 v241, v212, v213
 v_cvt_pk_bf16_f32 v242, v210, v211
 v_cvt_pk_bf16_f32 v243, v214, v215
 buffer_store_dwordx4 v[240:243], v1, s[20:23], s40 offen offset:1024 sc1
 v_pk_mul_f32 v[216:217], v[216:217], v[44:45] op_sel_hi:[1,0]
 v_pk_mul_f32 v[218:219], v[218:219], v[44:45] op_sel_hi:[1,0]
 v_pk_mul_f32 v[220:221], v[220:221], v[44:45] op_sel_hi:[1,0]
 v_pk_mul_f32 v[222:223], v[222:223], v[44:45] op_sel_hi:[1,0]
 v_cvt_pk_bf16_f32 v244, v216, v217
 v_cvt_pk_bf16_f32 v245, v220, v221
 v_cvt_pk_bf16_f32 v246, v218, v219
 v_cvt_pk_bf16_f32 v247, v222, v223
 buffer_store_dwordx4 v[244:247], v1, s[20:23], s40 offen offset:3072 sc1
 v_pk_mul_f32 v[224:225], v[224:225], v[44:45] op_sel_hi:[1,0]
 v_pk_mul_f32 v[226:227], v[226:227], v[44:45] op_sel_hi:[1,0]
 v_pk_mul_f32 v[228:229], v[228:229], v[44:45] op_sel_hi:[1,0]
 v_pk_mul_f32 v[230:231], v[230:231], v[44:45] op_sel_hi:[1,0]
 v_cvt_pk_bf16_f32 v248, v224, v225
 v_cvt_pk_bf16_f32 v249, v228, v229
 v_cvt_pk_bf16_f32 v250, v226, v227
 v_cvt_pk_bf16_f32 v251, v230, v231
 buffer_store_dwordx4 v[248:251], v1, s[20:23], s44 offen offset:1024 sc1
 v_pk_mul_f32 v[232:233], v[232:233], v[44:45] op_sel_hi:[1,0]
 v_pk_mul_f32 v[234:235], v[234:235], v[44:45] op_sel_hi:[1,0]
 v_pk_mul_f32 v[236:237], v[236:237], v[44:45] op_sel_hi:[1,0]
 v_pk_mul_f32 v[238:239], v[238:239], v[44:45] op_sel_hi:[1,0]
 v_cvt_pk_bf16_f32 v252, v232, v233
 v_cvt_pk_bf16_f32 v253, v236, v237
 v_cvt_pk_bf16_f32 v254, v234, v235
 v_cvt_pk_bf16_f32 v255, v238, v239
 buffer_store_dwordx4 v[252:255], v1, s[20:23], s44 offen offset:3072 sc1
 s_lshl_b32 s72, s33, 5
 s_add_u32 s72, s72, s32
 s_lshl_b32 s72, s72, 2
 s_add_u32 s72, s72, 0x3c00
 s_cmp_eq_u32 s46, 1
 s_cbranch_scc1 Ladone_9
 s_mov_b32 s46, 1
 s_mov_b32 s33, s34
 v_accvgpr_mov_b32 a0, a64
 v_accvgpr_mov_b32 a1, a65
 v_accvgpr_mov_b32 a2, a66
 v_accvgpr_mov_b32 a3, a67
 v_accvgpr_mov_b32 a4, a68
 v_accvgpr_mov_b32 a5, a69
 v_accvgpr_mov_b32 a6, a70
 v_accvgpr_mov_b32 a7, a71
 v_accvgpr_mov_b32 a8, a72
 v_accvgpr_mov_b32 a9, a73
 v_accvgpr_mov_b32 a10, a74
 v_accvgpr_mov_b32 a11, a75
 v_accvgpr_mov_b32 a12, a76
 v_accvgpr_mov_b32 a13, a77
 v_accvgpr_mov_b32 a14, a78
 v_accvgpr_mov_b32 a15, a79
 v_accvgpr_mov_b32 a16, a80
 v_accvgpr_mov_b32 a17, a81
 v_accvgpr_mov_b32 a18, a82
 v_accvgpr_mov_b32 a19, a83
 v_accvgpr_mov_b32 a20, a84
 v_accvgpr_mov_b32 a21, a85
 v_accvgpr_mov_b32 a22, a86
 v_accvgpr_mov_b32 a23, a87
 v_accvgpr_mov_b32 a24, a88
 v_accvgpr_mov_b32 a25, a89
 v_accvgpr_mov_b32 a26, a90
 v_accvgpr_mov_b32 a27, a91
 v_accvgpr_mov_b32 a28, a92
 v_accvgpr_mov_b32 a29, a93
 v_accvgpr_mov_b32 a30, a94
 v_accvgpr_mov_b32 a31, a95
 v_accvgpr_mov_b32 a32, a96
 v_accvgpr_mov_b32 a33, a97
 v_accvgpr_mov_b32 a34, a98
 v_accvgpr_mov_b32 a35, a99
 v_accvgpr_mov_b32 a36, a100
 v_accvgpr_mov_b32 a37, a101
 v_accvgpr_mov_b32 a38, a102
 v_accvgpr_mov_b32 a39, a103
 v_accvgpr_mov_b32 a40, a104
 v_accvgpr_mov_b32 a41, a105
 v_accvgpr_mov_b32 a42, a106
 v_accvgpr_mov_b32 a43, a107
 v_accvgpr_mov_b32 a44, a108
 v_accvgpr_mov_b32 a45, a109
 v_accvgpr_mov_b32 a46, a110
 v_accvgpr_mov_b32 a47, a111
 v_accvgpr_mov_b32 a48, a112
 v_accvgpr_mov_b32 a49, a113
 v_accvgpr_mov_b32 a50, a114
 v_accvgpr_mov_b32 a51, a115
 v_accvgpr_mov_b32 a52, a116
 v_accvgpr_mov_b32 a53, a117
 v_accvgpr_mov_b32 a54, a118
 v_accvgpr_mov_b32 a55, a119
 v_accvgpr_mov_b32 a56, a120
 v_accvgpr_mov_b32 a57, a121
 v_accvgpr_mov_b32 a58, a122
 v_accvgpr_mov_b32 a59, a123
 v_accvgpr_mov_b32 a60, a124
 v_accvgpr_mov_b32 a61, a125
 v_accvgpr_mov_b32 a62, a126
 v_accvgpr_mov_b32 a63, a127
 s_branch Lablk_6
Laslow_7:
 s_waitcnt vmcnt(0) lgkmcnt(0)
 v_mov_b32 v12, 0
 v_mov_b32 v240, v4
 v_mov_b32 v13, 0
 v_mov_b32 v241, v4
 v_mov_b32 v14, 0
 v_mov_b32 v242, v4
 v_mov_b32 v15, 0
 v_mov_b32 v243, v4
 s_mov_b32 s49, 0
Lsl_14:
 s_lshl_b32 s37, s49, 19
 s_add_u32 s37, s37, s45
 s_sub_u32 s37, s37, s50
 s_add_u32 s44, s37, 0
 buffer_load_dwordx4 a[128:131], v1, s[20:23], s44 offen offset:0 sc1
 buffer_load_dwordx4 a[132:135], v1, s[20:23], s44 offen offset:1024 sc1
 buffer_load_dwordx4 a[136:139], v1, s[20:23], s44 offen offset:2048 sc1
 buffer_load_dwordx4 a[140:143], v1, s[20:23], s44 offen offset:3072 sc1
 s_add_u32 s44, s37, 4096
 buffer_load_dwordx4 a[144:147], v1, s[20:23], s44 offen offset:0 sc1
 buffer_load_dwordx4 a[148:151], v1, s[20:23], s44 offen offset:1024 sc1
 buffer_load_dwordx4 a[152:155], v1, s[20:23], s44 offen offset:2048 sc1
 buffer_load_dwordx4 a[156:159], v1, s[20:23], s44 offen offset:3072 sc1
 s_cmp_lt_u32 s49, s41
 s_cselect_b64 s[68:69], -1, 0
 s_cmp_le_u32 s49, s41
 s_cselect_b64 s[70:71], -1, 0
 s_cmp_eq_u32 s49, s41
 s_cselect_b64 s[60:61], s[52:53], s[68:69]
 s_cselect_b64 s[62:63], s[54:55], s[68:69]
 s_cselect_b64 s[64:65], s[56:57], s[68:69]
 s_cselect_b64 s[66:67], s[58:59], s[68:69]
 v_cndmask_b32 v80, v4, v12, s[60:61]
 v_cndmask_b32 v81, v4, v12, s[62:63]
 v_cndmask_b32 v82, v4, v12, s[64:65]
 v_cndmask_b32 v83, v4, v12, s[66:67]
 v_cndmask_b32 v84, v4, v12, s[68:69]
 v_cndmask_b32 v85, v4, v12, s[68:69]
 v_cndmask_b32 v86, v4, v12, s[68:69]
 v_cndmask_b32 v87, v4, v12, s[68:69]
 v_cndmask_b32 v88, v4, v13, s[70:71]
 v_cndmask_b32 v89, v4, v13, s[70:71]
 v_cndmask_b32 v90, v4, v13, s[70:71]
 v_cndmask_b32 v91, v4, v13, s[70:71]
 v_cndmask_b32 v92, v4, v13, s[60:61]
 v_cndmask_b32 v93, v4, v13, s[62:63]
 v_cndmask_b32 v94, v4, v13, s[64:65]
 v_cndmask_b32 v95, v4, v13, s[66:67]
 s_cmp_lt_u32 s49, s42
 s_cselect_b64 s[68:69], -1, 0
 s_cmp_le_u32 s49, s42
 s_cselect_b64 s[70:71], -1, 0
 s_cmp_eq_u32 s49, s42
 s_cselect_b64 s[60:61], s[52:53], s[68:69]
 s_cselect_b64 s[62:63], s[54:55], s[68:69]
 s_cselect_b64 s[64:65], s[56:57], s[68:69]
 s_cselect_b64 s[66:67], s[58:59], s[68:69]
 v_cndmask_b32 v96, v4, v14, s[60:61]
 v_cndmask_b32 v97, v4, v14, s[62:63]
 v_cndmask_b32 v98, v4, v14, s[64:65]
 v_cndmask_b32 v99, v4, v14, s[66:67]
 v_cndmask_b32 v100, v4, v14, s[68:69]
 v_cndmask_b32 v101, v4, v14, s[68:69]
 v_cndmask_b32 v102, v4, v14, s[68:69]
 v_cndmask_b32 v103, v4, v14, s[68:69]
 v_cndmask_b32 v104, v4, v15, s[70:71]
 v_cndmask_b32 v105, v4, v15, s[70:71]
 v_cndmask_b32 v106, v4, v15, s[70:71]
 v_cndmask_b32 v107, v4, v15, s[70:71]
 v_cndmask_b32 v108, v4, v15, s[60:61]
 v_cndmask_b32 v109, v4, v15, s[62:63]
 v_cndmask_b32 v110, v4, v15, s[64:65]
 v_cndmask_b32 v111, v4, v15, s[66:67]
 s_waitcnt vmcnt(0)
 s_nop 0
 v_mfma_f32_16x16x32_bf16 v[48:51], a[128:131], a[0:3], v[80:83]
 v_mfma_f32_16x16x32_bf16 v[56:59], a[128:131], a[16:19], v[88:91]
 v_mfma_f32_16x16x32_bf16 v[64:67], a[128:131], a[32:35], v[96:99]
 v_mfma_f32_16x16x32_bf16 v[72:75], a[128:131], a[48:51], v[104:107]
 v_mfma_f32_16x16x32_bf16 v[52:55], a[132:135], a[0:3], v[84:87]
 v_mfma_f32_16x16x32_bf16 v[60:63], a[132:135], a[16:19], v[92:95]
 v_mfma_f32_16x16x32_bf16 v[68:71], a[132:135], a[32:35], v[100:103]
 v_mfma_f32_16x16x32_bf16 v[76:79], a[132:135], a[48:51], v[108:111]
 v_mfma_f32_16x16x32_bf16 v[48:51], a[136:139], a[4:7], v[48:51]
 v_mfma_f32_16x16x32_bf16 v[56:59], a[136:139], a[20:23], v[56:59]
 v_mfma_f32_16x16x32_bf16 v[64:67], a[136:139], a[36:39], v[64:67]
 v_mfma_f32_16x16x32_bf16 v[72:75], a[136:139], a[52:55], v[72:75]
 v_mfma_f32_16x16x32_bf16 v[52:55], a[140:143], a[4:7], v[52:55]
 v_mfma_f32_16x16x32_bf16 v[60:63], a[140:143], a[20:23], v[60:63]
 v_mfma_f32_16x16x32_bf16 v[68:71], a[140:143], a[36:39], v[68:71]
 v_mfma_f32_16x16x32_bf16 v[76:79], a[140:143], a[52:55], v[76:79]
 v_mfma_f32_16x16x32_bf16 v[48:51], a[144:147], a[8:11], v[48:51]
 v_mfma_f32_16x16x32_bf16 v[56:59], a[144:147], a[24:27], v[56:59]
 v_mfma_f32_16x16x32_bf16 v[64:67], a[144:147], a[40:43], v[64:67]
 v_mfma_f32_16x16x32_bf16 v[72:75], a[144:147], a[56:59], v[72:75]
 v_mfma_f32_16x16x32_bf16 v[52:55], a[148:151], a[8:11], v[52:55]
 v_mfma_f32_16x16x32_bf16 v[60:63], a[148:151], a[24:27], v[60:63]
 v_mfma_f32_16x16x32_bf16 v[68:71], a[148:151], a[40:43], v[68:71]
 v_mfma_f32_16x16x32_bf16 v[76:79], a[148:151], a[56:59], v[76:79]
 v_mfma_f32_16x16x32_bf16 v[48:51], a[152:155], a[12:15], v[48:51]
 v_mfma_f32_16x16x32_bf16 v[56:59], a[152:155], a[28:31], v[56:59]
 v_mfma_f32_16x16x32_bf16 v[64:67], a[152:155], a[44:47], v[64:67]
 v_mfma_f32_16x16x32_bf16 v[72:75], a[152:155], a[60:63], v[72:75]
 v_mfma_f32_16x16x32_bf16 v[52:55], a[156:159], a[12:15], v[52:55]
 v_mfma_f32_16x16x32_bf16 v[60:63], a[156:159], a[28:31], v[60:63]
 v_mfma_f32_16x16x32_bf16 v[68:71], a[156:159], a[44:47], v[68:71]
 v_mfma_f32_16x16x32_bf16 v[76:79], a[156:159], a[60:63], v[76:79]
 s_nop 7
 v_max3_f32 v240, v240, v48, v49
 v_max3_f32 v240, v240, v50, v51
 v_max3_f32 v240, v240, v52, v53
 v_max3_f32 v240, v240, v54, v55
 v_max3_f32 v241, v241, v56, v57
 v_max3_f32 v241, v241, v58, v59
 v_max3_f32 v241, v241, v60, v61
 v_max3_f32 v241, v241, v62, v63
 v_max3_f32 v242, v242, v64, v65
 v_max3_f32 v242, v242, v66, v67
 v_max3_f32 v242, v242, v68, v69
 v_max3_f32 v242, v242, v70, v71
 v_max3_f32 v243, v243, v72, v73
 v_max3_f32 v243, v243, v74, v75
 v_max3_f32 v243, v243, v76, v77
 v_max3_f32 v243, v243, v78, v79
 s_add_u32 s49, s49, 1
 s_cmp_le_u32 s49, s42
 s_cbranch_scc1 Lsl_14
 v_mov_b32 v244, v240
 v_mov_b32 v245, v241
 v_mov_b32 v246, v242
 v_mov_b32 v247, v243
 v_permlane16_swap_b32 v240, v244
 v_permlane16_swap_b32 v241, v245
 v_permlane16_swap_b32 v242, v246
 v_permlane16_swap_b32 v243, v247
 v_max_f32 v240, v240, v244
 v_max_f32 v241, v241, v245
 v_max_f32 v242, v242, v246
 v_max_f32 v243, v243, v247
 v_mov_b32 v244, v240
 v_mov_b32 v245, v241
 v_mov_b32 v246, v242
 v_mov_b32 v247, v243
 v_permlane32_swap_b32 v240, v244
 v_permlane32_swap_b32 v241, v245
 v_permlane32_swap_b32 v242, v246
 v_permlane32_swap_b32 v243, v247
 v_max_f32 v240, v240, v244
 v_max_f32 v241, v241, v245
 v_max_f32 v242, v242, v246
 v_max_f32 v243, v243, v247
 v_sub_f32 v12, 0, v240
 v_sub_f32 v13, 0, v241
 v_sub_f32 v14, 0, v242
 v_sub_f32 v15, 0, v243
 v_mov_b64 v[112:113], 0
 v_mov_b64 v[114:115], 0
 v_mov_b64 v[116:117], 0
 v_mov_b64 v[118:119], 0
 v_mov_b64 v[120:121], 0
 v_mov_b64 v[122:123], 0
 v_mov_b64 v[124:125], 0
 v_mov_b64 v[126:127], 0
 v_mov_b64 v[128:129], 0
 v_mov_b64 v[130:131], 0
 v_mov_b64 v[132:133], 0
 v_mov_b64 v[134:135], 0
 v_mov_b64 v[136:137], 0
 v_mov_b64 v[138:139], 0
 v_mov_b64 v[140:141], 0
 v_mov_b64 v[142:143], 0
 v_mov_b64 v[144:145], 0
 v_mov_b64 v[146:147], 0
 v_mov_b64 v[148:149], 0
 v_mov_b64 v[150:151], 0
 v_mov_b64 v[152:153], 0
 v_mov_b64 v[154:155], 0
 v_mov_b64 v[156:157], 0
 v_mov_b64 v[158:159], 0
 v_mov_b64 v[160:161], 0
 v_mov_b64 v[162:163], 0
 v_mov_b64 v[164:165], 0
 v_mov_b64 v[166:167], 0
 v_mov_b64 v[168:169], 0
 v_mov_b64 v[170:171], 0
 v_mov_b64 v[172:173], 0
 v_mov_b64 v[174:175], 0
 v_mov_b64 v[176:177], 0
 v_mov_b64 v[178:179], 0
 v_mov_b64 v[180:181], 0
 v_mov_b64 v[182:183], 0
 v_mov_b64 v[184:185], 0
 v_mov_b64 v[186:187], 0
 v_mov_b64 v[188:189], 0
 v_mov_b64 v[190:191], 0
 v_mov_b64 v[192:193], 0
 v_mov_b64 v[194:195], 0
 v_mov_b64 v[196:197], 0
 v_mov_b64 v[198:199], 0
 v_mov_b64 v[200:201], 0
 v_mov_b64 v[202:203], 0
 v_mov_b64 v[204:205], 0
 v_mov_b64 v[206:207], 0
 v_mov_b64 v[208:209], 0
 v_mov_b64 v[210:211], 0
 v_mov_b64 v[212:213], 0
 v_mov_b64 v[214:215], 0
 v_mov_b64 v[216:217], 0
 v_mov_b64 v[218:219], 0
 v_mov_b64 v[220:221], 0
 v_mov_b64 v[222:223], 0
 v_mov_b64 v[224:225], 0
 v_mov_b64 v[226:227], 0
 v_mov_b64 v[228:229], 0
 v_mov_b64 v[230:231], 0
 v_mov_b64 v[232:233], 0
 v_mov_b64 v[234:235], 0
 v_mov_b64 v[236:237], 0
 v_mov_b64 v[238:239], 0
 v_mov_b64 v[32:33], 0
 v_mov_b64 v[34:35], 0
 v_mov_b64 v[36:37], 0
 v_mov_b64 v[38:39], 0
 v_mov_b64 v[40:41], 0
 v_mov_b64 v[42:43], 0
 v_mov_b64 v[44:45], 0
 v_mov_b64 v[46:47], 0
 s_mov_b32 s49, 0
Lsl_15:
 s_lshl_b32 s37, s49, 19
 s_add_u32 s37, s37, s45
 s_sub_u32 s37, s37, s50
 s_add_u32 s44, s37, 0
 buffer_load_dwordx4 a[128:131], v1, s[20:23], s44 offen offset:0 sc1
 buffer_load_dwordx4 a[132:135], v1, s[20:23], s44 offen offset:1024 sc1
 buffer_load_dwordx4 a[136:139], v1, s[20:23], s44 offen offset:2048 sc1
 buffer_load_dwordx4 a[140:143], v1, s[20:23], s44 offen offset:3072 sc1
 s_add_u32 s44, s37, 4096
 buffer_load_dwordx4 a[144:147], v1, s[20:23], s44 offen offset:0 sc1
 buffer_load_dwordx4 a[148:151], v1, s[20:23], s44 offen offset:1024 sc1
 buffer_load_dwordx4 a[152:155], v1, s[20:23], s44 offen offset:2048 sc1
 buffer_load_dwordx4 a[156:159], v1, s[20:23], s44 offen offset:3072 sc1
 s_add_u32 s44, s37, 8192
 buffer_load_dwordx4 a[160:163], v1, s[20:23], s44 offen offset:0 sc1
 buffer_load_dwordx4 a[164:167], v1, s[20:23], s44 offen offset:1024 sc1
 buffer_load_dwordx4 a[168:171], v1, s[20:23], s44 offen offset:2048 sc1
 buffer_load_dwordx4 a[172:175], v1, s[20:23], s44 offen offset:3072 sc1
 s_add_u32 s44, s37, 12288
 buffer_load_dwordx4 a[176:179], v1, s[20:23], s44 offen offset:0 sc1
 buffer_load_dwordx4 a[180:183], v1, s[20:23], s44 offen offset:1024 sc1
 buffer_load_dwordx4 a[184:187], v1, s[20:23], s44 offen offset:2048 sc1
 buffer_load_dwordx4 a[188:191], v1, s[20:23], s44 offen offset:3072 sc1
 s_cmp_lt_u32 s49, s41
 s_cselect_b64 s[68:69], -1, 0
 s_cmp_le_u32 s49, s41
 s_cselect_b64 s[70:71], -1, 0
 s_cmp_eq_u32 s49, s41
 s_cselect_b64 s[60:61], s[52:53], s[68:69]
 s_cselect_b64 s[62:63], s[54:55], s[68:69]
 s_cselect_b64 s[64:65], s[56:57], s[68:69]
 s_cselect_b64 s[66:67], s[58:59], s[68:69]
 v_cndmask_b32 v80, v4, v12, s[60:61]
 v_cndmask_b32 v81, v4, v12, s[62:63]
 v_cndmask_b32 v82, v4, v12, s[64:65]
 v_cndmask_b32 v83, v4, v12, s[66:67]
 v_cndmask_b32 v84, v4, v12, s[68:69]
 v_cndmask_b32 v85, v4, v12, s[68:69]
 v_cndmask_b32 v86, v4, v12, s[68:69]
 v_cndmask_b32 v87, v4, v12, s[68:69]
 v_cndmask_b32 v88, v4, v13, s[70:71]
 v_cndmask_b32 v89, v4, v13, s[70:71]
 v_cndmask_b32 v90, v4, v13, s[70:71]
 v_cndmask_b32 v91, v4, v13, s[70:71]
 v_cndmask_b32 v92, v4, v13, s[60:61]
 v_cndmask_b32 v93, v4, v13, s[62:63]
 v_cndmask_b32 v94, v4, v13, s[64:65]
 v_cndmask_b32 v95, v4, v13, s[66:67]
 s_cmp_lt_u32 s49, s42
 s_cselect_b64 s[68:69], -1, 0
 s_cmp_le_u32 s49, s42
 s_cselect_b64 s[70:71], -1, 0
 s_cmp_eq_u32 s49, s42
 s_cselect_b64 s[60:61], s[52:53], s[68:69]
 s_cselect_b64 s[62:63], s[54:55], s[68:69]
 s_cselect_b64 s[64:65], s[56:57], s[68:69]
 s_cselect_b64 s[66:67], s[58:59], s[68:69]
 v_cndmask_b32 v96, v4, v14, s[60:61]
 v_cndmask_b32 v97, v4, v14, s[62:63]
 v_cndmask_b32 v98, v4, v14, s[64:65]
 v_cndmask_b32 v99, v4, v14, s[66:67]
 v_cndmask_b32 v100, v4, v14, s[68:69]
 v_cndmask_b32 v101, v4, v14, s[68:69]
 v_cndmask_b32 v102, v4, v14, s[68:69]
 v_cndmask_b32 v103, v4, v14, s[68:69]
 v_cndmask_b32 v104, v4, v15, s[70:71]
 v_cndmask_b32 v105, v4, v15, s[70:71]
 v_cndmask_b32 v106, v4, v15, s[70:71]
 v_cndmask_b32 v107, v4, v15, s[70:71]
 v_cndmask_b32 v108, v4, v15, s[60:61]
 v_cndmask_b32 v109, v4, v15, s[62:63]
 v_cndmask_b32 v110, v4, v15, s[64:65]
 v_cndmask_b32 v111, v4, v15, s[66:67]
 s_waitcnt vmcnt(0)
 s_nop 0
 v_mfma_f32_16x16x32_bf16 v[48:51], a[128:131], a[0:3], v[80:83]
 v_mfma_f32_16x16x32_bf16 v[56:59], a[128:131], a[16:19], v[88:91]
 v_mfma_f32_16x16x32_bf16 v[64:67], a[128:131], a[32:35], v[96:99]
 v_mfma_f32_16x16x32_bf16 v[72:75], a[128:131], a[48:51], v[104:107]
 v_mfma_f32_16x16x32_bf16 v[52:55], a[132:135], a[0:3], v[84:87]
 v_mfma_f32_16x16x32_bf16 v[60:63], a[132:135], a[16:19], v[92:95]
 v_mfma_f32_16x16x32_bf16 v[68:71], a[132:135], a[32:35], v[100:103]
 v_mfma_f32_16x16x32_bf16 v[76:79], a[132:135], a[48:51], v[108:111]
 v_mfma_f32_16x16x32_bf16 v[48:51], a[136:139], a[4:7], v[48:51]
 v_mfma_f32_16x16x32_bf16 v[56:59], a[136:139], a[20:23], v[56:59]
 v_mfma_f32_16x16x32_bf16 v[64:67], a[136:139], a[36:39], v[64:67]
 v_mfma_f32_16x16x32_bf16 v[72:75], a[136:139], a[52:55], v[72:75]
 v_mfma_f32_16x16x32_bf16 v[52:55], a[140:143], a[4:7], v[52:55]
 v_mfma_f32_16x16x32_bf16 v[60:63], a[140:143], a[20:23], v[60:63]
 v_mfma_f32_16x16x32_bf16 v[68:71], a[140:143], a[36:39], v[68:71]
 v_mfma_f32_16x16x32_bf16 v[76:79], a[140:143], a[52:55], v[76:79]
 v_mfma_f32_16x16x32_bf16 v[48:51], a[144:147], a[8:11], v[48:51]
 v_mfma_f32_16x16x32_bf16 v[56:59], a[144:147], a[24:27], v[56:59]
 v_mfma_f32_16x16x32_bf16 v[64:67], a[144:147], a[40:43], v[64:67]
 v_mfma_f32_16x16x32_bf16 v[72:75], a[144:147], a[56:59], v[72:75]
 v_mfma_f32_16x16x32_bf16 v[52:55], a[148:151], a[8:11], v[52:55]
 v_mfma_f32_16x16x32_bf16 v[60:63], a[148:151], a[24:27], v[60:63]
 v_mfma_f32_16x16x32_bf16 v[68:71], a[148:151], a[40:43], v[68:71]
 v_mfma_f32_16x16x32_bf16 v[76:79], a[148:151], a[56:59], v[76:79]
 v_mfma_f32_16x16x32_bf16 v[48:51], a[152:155], a[12:15], v[48:51]
 v_mfma_f32_16x16x32_bf16 v[56:59], a[152:155], a[28:31], v[56:59]
 v_mfma_f32_16x16x32_bf16 v[64:67], a[152:155], a[44:47], v[64:67]
 v_mfma_f32_16x16x32_bf16 v[72:75], a[152:155], a[60:63], v[72:75]
 v_mfma_f32_16x16x32_bf16 v[52:55], a[156:159], a[12:15], v[52:55]
 v_mfma_f32_16x16x32_bf16 v[60:63], a[156:159], a[28:31], v[60:63]
 v_mfma_f32_16x16x32_bf16 v[68:71], a[156:159], a[44:47], v[68:71]
 v_mfma_f32_16x16x32_bf16 v[76:79], a[156:159], a[60:63], v[76:79]
 s_nop 7
 v_exp_f32 v48, v48
 v_exp_f32 v49, v49
 v_exp_f32 v52, v52
 v_exp_f32 v53, v53
 v_exp_f32 v50, v50
 v_cvt_pk_bf16_f32 v16, v48, v49
 v_cvt_pk_bf16_f32 v17, v52, v53
 v_exp_f32 v51, v51
 v_exp_f32 v54, v54
 v_exp_f32 v55, v55
 v_cvt_pk_bf16_f32 v18, v50, v51
 v_cvt_pk_bf16_f32 v19, v54, v55
 v_exp_f32 v56, v56
 v_exp_f32 v57, v57
 v_exp_f32 v60, v60
 v_exp_f32 v61, v61
 v_exp_f32 v58, v58
 v_cvt_pk_bf16_f32 v20, v56, v57
 v_cvt_pk_bf16_f32 v21, v60, v61
 v_exp_f32 v59, v59
 v_exp_f32 v62, v62
 v_exp_f32 v63, v63
 v_cvt_pk_bf16_f32 v22, v58, v59
 v_cvt_pk_bf16_f32 v23, v62, v63
 v_exp_f32 v64, v64
 v_exp_f32 v65, v65
 v_exp_f32 v68, v68
 v_exp_f32 v69, v69
 v_exp_f32 v66, v66
 v_cvt_pk_bf16_f32 v24, v64, v65
 v_cvt_pk_bf16_f32 v25, v68, v69
 v_exp_f32 v67, v67
 v_exp_f32 v70, v70
 v_exp_f32 v71, v71
 v_cvt_pk_bf16_f32 v26, v66, v67
 v_cvt_pk_bf16_f32 v27, v70, v71
 v_exp_f32 v72, v72
 v_exp_f32 v73, v73
 v_exp_f32 v76, v76
 v_exp_f32 v77, v77
 v_exp_f32 v74, v74
 v_cvt_pk_bf16_f32 v28, v72, v73
 v_cvt_pk_bf16_f32 v29, v76, v77
 v_exp_f32 v75, v75
 v_exp_f32 v78, v78
 v_exp_f32 v79, v79
 v_cvt_pk_bf16_f32 v30, v74, v75
 v_cvt_pk_bf16_f32 v31, v78, v79
 s_nop 1
 v_mfma_f32_16x16x32_bf16 v[112:115], a[160:163], v[16:19], v[112:115]
 v_mfma_f32_16x16x32_bf16 v[144:147], a[160:163], v[20:23], v[144:147]
 v_mfma_f32_16x16x32_bf16 v[176:179], a[160:163], v[24:27], v[176:179]
 v_mfma_f32_16x16x32_bf16 v[208:211], a[160:163], v[28:31], v[208:211]
 v_mfma_f32_16x16x32_bf16 v[116:119], a[164:167], v[16:19], v[116:119]
 v_mfma_f32_16x16x32_bf16 v[148:151], a[164:167], v[20:23], v[148:151]
 v_mfma_f32_16x16x32_bf16 v[180:183], a[164:167], v[24:27], v[180:183]
 v_mfma_f32_16x16x32_bf16 v[212:215], a[164:167], v[28:31], v[212:215]
 v_mfma_f32_16x16x32_bf16 v[120:123], a[168:171], v[16:19], v[120:123]
 v_mfma_f32_16x16x32_bf16 v[152:155], a[168:171], v[20:23], v[152:155]
 v_mfma_f32_16x16x32_bf16 v[184:187], a[168:171], v[24:27], v[184:187]
 v_mfma_f32_16x16x32_bf16 v[216:219], a[168:171], v[28:31], v[216:219]
 v_mfma_f32_16x16x32_bf16 v[124:127], a[172:175], v[16:19], v[124:127]
 v_mfma_f32_16x16x32_bf16 v[156:159], a[172:175], v[20:23], v[156:159]
 v_mfma_f32_16x16x32_bf16 v[188:191], a[172:175], v[24:27], v[188:191]
 v_mfma_f32_16x16x32_bf16 v[220:223], a[172:175], v[28:31], v[220:223]
 v_mfma_f32_16x16x32_bf16 v[128:131], a[176:179], v[16:19], v[128:131]
 v_mfma_f32_16x16x32_bf16 v[160:163], a[176:179], v[20:23], v[160:163]
 v_mfma_f32_16x16x32_bf16 v[192:195], a[176:179], v[24:27], v[192:195]
 v_mfma_f32_16x16x32_bf16 v[224:227], a[176:179], v[28:31], v[224:227]
 v_mfma_f32_16x16x32_bf16 v[132:135], a[180:183], v[16:19], v[132:135]
 v_mfma_f32_16x16x32_bf16 v[164:167], a[180:183], v[20:23], v[164:167]
 v_mfma_f32_16x16x32_bf16 v[196:199], a[180:183], v[24:27], v[196:199]
 v_mfma_f32_16x16x32_bf16 v[228:231], a[180:183], v[28:31], v[228:231]
 v_mfma_f32_16x16x32_bf16 v[136:139], a[184:187], v[16:19], v[136:139]
 v_mfma_f32_16x16x32_bf16 v[168:171], a[184:187], v[20:23], v[168:171]
 v_mfma_f32_16x16x32_bf16 v[200:203], a[184:187], v[24:27], v[200:203]
 v_mfma_f32_16x16x32_bf16 v[232:235], a[184:187], v[28:31], v[232:235]
 v_mfma_f32_16x16x32_bf16 v[140:143], a[188:191], v[16:19], v[140:143]
 v_mfma_f32_16x16x32_bf16 v[172:175], a[188:191], v[20:23], v[172:175]
 v_mfma_f32_16x16x32_bf16 v[204:207], a[188:191], v[24:27], v[204:207]
 v_mfma_f32_16x16x32_bf16 v[236:239], a[188:191], v[28:31], v[236:239]
 v_mfma_f32_16x16x32_bf16 v[32:35], a[192:195], v[16:19], v[32:35]
 v_mfma_f32_16x16x32_bf16 v[36:39], a[192:195], v[20:23], v[36:39]
 v_mfma_f32_16x16x32_bf16 v[40:43], a[192:195], v[24:27], v[40:43]
 v_mfma_f32_16x16x32_bf16 v[44:47], a[192:195], v[28:31], v[44:47]
 s_add_u32 s49, s49, 1
 s_cmp_le_u32 s49, s42
 s_cbranch_scc1 Lsl_15
 ds_read_b128 a[128:131], v3 offset:0
 ds_read_b128 a[132:135], v3 offset:1024
 ds_read_b128 a[136:139], v3 offset:2048
 ds_read_b128 a[140:143], v3 offset:3072
 ds_read_b128 a[144:147], v3 offset:4096
 ds_read_b128 a[148:151], v3 offset:5120
 ds_read_b128 a[152:155], v3 offset:6144
 ds_read_b128 a[156:159], v3 offset:7168
 s_branch Laback_8
Ladone_9:
 s_waitcnt vmcnt(0) lgkmcnt(0)
 s_barrier
 v_mov_b32 v6, 1
 buffer_store_dword v6, v5, s[20:23], s72 offen sc1
 s_cmp_ge_u32 s6, 27
 s_cbranch_scc1 Lfin
 s_load_dwordx2 s[8:9], s[0:1], 40
 s_mov_b32 s10, 0x480000
 s_mov_b32 s11, 0x20000
 s_mul_i32 s7, s6, 29
 s_lshr_b32 s7, s7, 8
 s_mul_i32 s94, s7, 9
 s_sub_u32 s32, s6, s94
 s_mul_i32 s40, s7, 3
 s_lshl_b32 s7, s7, 2
 s_add_u32 s7, s7, s5
 s_sub_u32 s33, s7, 4
 s_mov_b32 s34, 12
 s_cmp_lt_u32 s33, 4
 s_cselect_b32 s35, 6, 5
 s_mov_b32 s36, 0x6000000
 s_mov_b32 s37, 0
 s_lshl_b32 s38, s4, 5
 s_add_u32 s38, s38, 0x3c00
 s_mov_b32 s39, 0
 s_mov_b32 s93, 0x38
 s_mov_b32 s92, 7
 s_mov_b32 s91, 4
 s_mov_b32 s90, 31
 s_branch Los
Lpb:
 s_load_dwordx2 s[8:9], s[0:1], 48
 s_mov_b32 s10, 0x240000
 s_mov_b32 s11, 0x20000
 s_load_dwordx2 s[12:13], s[0:1], 72
 s_mov_b32 s14, 0x480000
 s_mov_b32 s15, 0x20000
 s_load_dwordx2 s[16:17], s[0:1], 80
 s_mov_b32 s18, 0x480000
 s_mov_b32 s19, 0x20000
 s_lshl_b32 s32, s6, 8
 s_mov_b32 s33, s32
 s_lshl_b32 s34, s6, 14
 s_add_u32 s34, s34, 0x3000000
 s_add_u32 s35, s34, 8192
 s_mov_b32 s36, 64
 s_mov_b32 s37, 0
 s_lshl_b32 s7, s6, 7
 s_add_u32 s7, s7, 0x0
 v_min_u32 v1, 1, v0
 v_lshlrev_b32 v1, 28, v1
 v_add_u32 v13, s7, v1
 s_waitcnt lgkmcnt(0)
 v_and_b32 v1, 63, v0
 v_lshrrev_b32 v2, 3, v0
 v_mul_u32_u24 v10, 1152, v2
 v_lshrrev_b32 v2, 4, v0
 v_xor_b32 v2, v2, v0
 v_and_b32 v2, 7, v2
 v_lshl_add_u32 v10, v2, 4, v10
 v_lshrrev_b32 v2, 4, v1
 v_bfe_u32 v3, v1, 1, 3
 v_xor_b32 v2, v2, v3
 v_and_b32 v3, 15, v1
 v_lshlrev_b32 v3, 7, v3
 v_lshl_add_u32 v4, v2, 4, v3
 v_xor_b32 v5, 64, v4
 v_lshrrev_b32 v2, 4, v0
 v_lshlrev_b32 v11, 13, v2
 v_lshrrev_b32 v2, 7, v0
 v_lshrrev_b32 v3, 4, v1
 v_lshl_add_u32 v3, v2, 2, v3
 v_bfe_u32 v2, v1, 1, 3
 v_xor_b32 v2, v2, v3
 v_lshl_add_u32 v11, v2, 5, v11
 v_and_b32 v2, 1, v1
 v_lshl_add_u32 v11, v2, 4, v11
 v_bfe_u32 v2, v1, 2, 3
 v_xor_b32 v3, s4, v2
 v_lshlrev_b32 v3, 5, v3
 v_and_b32 v2, 3, v2
 v_lshl_add_u32 v3, v2, 8, v3
 v_lshrrev_b32 v2, 4, v1
 v_lshl_add_u32 v3, v2, 11, v3
 v_and_b32 v2, 3, v1
 v_lshl_add_u32 v3, v2, 3, v3
 v_add_u32 v8, 73728, v3
 v_xor_b32 v3, 0x80, v3
 v_add_u32 v9, 73728, v3
 s_lshl_b32 s45, s4, 11
 v_lshl_add_u32 v12, v1, 4, s45
 s_mov_b32 s39, s37
 s_add_u32 s40, s39, 1
 s_lshl_b32 s49, s4, 10
 s_mul_i32 s46, s39, 36864
 s_add_u32 m0, s49, 0
 s_nop 0
 buffer_load_dwordx4 v10, s[8:11], s46 offen offset:0  lds
 s_add_u32 m0, s49, 3968
 s_nop 0
 buffer_load_dwordx4 v10, s[8:11], s46 offen offset:128  lds
 s_add_u32 m0, s49, 7936
 s_nop 0
 buffer_load_dwordx4 v10, s[8:11], s46 offen offset:256  lds
 s_add_u32 m0, s49, 11904
 s_nop 0
 buffer_load_dwordx4 v10, s[8:11], s46 offen offset:384  lds
 s_add_u32 m0, s49, 15872
 s_nop 0
 buffer_load_dwordx4 v10, s[8:11], s46 offen offset:512  lds
 s_add_u32 m0, s49, 19840
 s_nop 0
 buffer_load_dwordx4 v10, s[8:11], s46 offen offset:640  lds
 s_add_u32 m0, s49, 23808
 s_nop 0
 buffer_load_dwordx4 v10, s[8:11], s46 offen offset:768  lds
 s_add_u32 m0, s49, 27776
 s_nop 0
 buffer_load_dwordx4 v10, s[8:11], s46 offen offset:896  lds
 s_add_u32 m0, s49, 31744
 s_nop 0
 buffer_load_dwordx4 v10, s[8:11], s46 offen offset:1024  lds
 s_lshl_b32 s49, s4, 10
 s_add_u32 s49, s49, 36864
 s_mul_i32 s46, s40, 36864
 s_add_u32 m0, s49, 0
 s_nop 0
 buffer_load_dwordx4 v10, s[8:11], s46 offen offset:0  lds
 s_add_u32 m0, s49, 3968
 s_nop 0
 buffer_load_dwordx4 v10, s[8:11], s46 offen offset:128  lds
 s_add_u32 m0, s49, 7936
 s_nop 0
 buffer_load_dwordx4 v10, s[8:11], s46 offen offset:256  lds
 s_add_u32 m0, s49, 11904
 s_nop 0
 buffer_load_dwordx4 v10, s[8:11], s46 offen offset:384  lds
 s_add_u32 m0, s49, 15872
 s_nop 0
 buffer_load_dwordx4 v10, s[8:11], s46 offen offset:512  lds
 s_add_u32 m0, s49, 19840
 s_nop 0
 buffer_load_dwordx4 v10, s[8:11], s46 offen offset:640  lds
 s_add_u32 m0, s49, 23808
 s_nop 0
 buffer_load_dwordx4 v10, s[8:11], s46 offen offset:768  lds
 s_add_u32 m0, s49, 27776
 s_nop 0
 buffer_load_dwordx4 v10, s[8:11], s46 offen offset:896  lds
 s_add_u32 m0, s49, 31744
 s_nop 0
 buffer_load_dwordx4 v10, s[8:11], s46 offen offset:1024  lds
 s_lshl_b32 s49, s4, 10
 s_add_u32 m0, s49, 73728
 s_add_u32 s45, s32, 0
 buffer_load_dwordx4 v11, s[12:15], s45 offen  lds
 s_add_u32 m0, s49, 77824
 s_add_u32 s45, s32, 131072
 buffer_load_dwordx4 v11, s[12:15], s45 offen  lds
 s_add_u32 m0, s49, 81920
 s_add_u32 s45, s33, 0
 buffer_load_dwordx4 v11, s[16:19], s45 offen  lds
 s_add_u32 m0, s49, 86016
 s_add_u32 s45, s33, 131072
 buffer_load_dwordx4 v11, s[16:19], s45 offen  lds
 s_add_u32 m0, s49, 90112
 s_add_u32 s45, s32, 262144
 buffer_load_dwordx4 v11, s[12:15], s45 offen  lds
 s_add_u32 m0, s49, 94208
 s_add_u32 s45, s32, 393216
 buffer_load_dwordx4 v11, s[12:15], s45 offen  lds
 s_add_u32 m0, s49, 98304
 s_add_u32 s45, s33, 262144
 buffer_load_dwordx4 v11, s[16:19], s45 offen  lds
 s_add_u32 m0, s49, 102400
 s_add_u32 s45, s33, 393216
 buffer_load_dwordx4 v11, s[16:19], s45 offen  lds
 s_add_u32 m0, s49, 106496
 s_add_u32 s45, s32, 524288
 buffer_load_dwordx4 v11, s[12:15], s45 offen  lds
 s_add_u32 m0, s49, 110592
 s_add_u32 s45, s32, 655360
 buffer_load_dwordx4 v11, s[12:15], s45 offen  lds
 s_add_u32 m0, s49, 114688
 s_add_u32 s45, s33, 524288
 buffer_load_dwordx4 v11, s[16:19], s45 offen  lds
 s_add_u32 m0, s49, 118784
 s_add_u32 s45, s33, 655360
 buffer_load_dwordx4 v11, s[16:19], s45 offen  lds
 s_waitcnt vmcnt(8) lgkmcnt(0)
 s_barrier
 s_add_u32 m0, s49, 122880
 s_add_u32 s45, s32, 786432
 buffer_load_dwordx4 v11, s[12:15], s45 offen  lds
 s_add_u32 m0, s49, 126976
 s_add_u32 s45, s32, 917504
 buffer_load_dwordx4 v11, s[12:15], s45 offen  lds
 s_add_u32 m0, s49, 131072
 s_add_u32 s45, s33, 786432
 buffer_load_dwordx4 v11, s[16:19], s45 offen  lds
 s_add_u32 m0, s49, 135168
 s_add_u32 s45, s33, 917504
 buffer_load_dwordx4 v11, s[16:19], s45 offen  lds
 ds_read_b64_tr_b16 a[0:1], v8 offset:0
 ds_read_b64_tr_b16 a[2:3], v8 offset:1024
 ds_read_b64_tr_b16 a[72:73], v9 offset:0
 ds_read_b64_tr_b16 a[74:75], v9 offset:1024
 ds_read_b64_tr_b16 a[144:145], v8 offset:8192
 ds_read_b64_tr_b16 a[146:147], v8 offset:9216
 ds_read_b64_tr_b16 a[216:217], v9 offset:8192
 ds_read_b64_tr_b16 a[218:219], v9 offset:9216
 s_waitcnt vmcnt(8) lgkmcnt(0)
 s_barrier
 s_add_u32 m0, s49, 73728
 s_add_u32 s45, s32, 1048576
 buffer_load_dwordx4 v11, s[12:15], s45 offen  lds
 s_add_u32 m0, s49, 77824
 s_add_u32 s45, s32, 1179648
 buffer_load_dwordx4 v11, s[12:15], s45 offen  lds
 s_add_u32 m0, s49, 81920
 s_add_u32 s45, s33, 1048576
 buffer_load_dwordx4 v11, s[16:19], s45 offen  lds
 s_add_u32 m0, s49, 86016
 s_add_u32 s45, s33, 1179648
 buffer_load_dwordx4 v11, s[16:19], s45 offen  lds
 ds_read_b64_tr_b16 a[4:5], v8 offset:16384
 ds_read_b64_tr_b16 a[6:7], v8 offset:17408
 ds_read_b64_tr_b16 a[76:77], v9 offset:16384
 ds_read_b64_tr_b16 a[78:79], v9 offset:17408
 ds_read_b64_tr_b16 a[148:149], v8 offset:24576
 ds_read_b64_tr_b16 a[150:151], v8 offset:25600
 ds_read_b64_tr_b16 a[220:221], v9 offset:24576
 ds_read_b64_tr_b16 a[222:223], v9 offset:25600
 s_waitcnt vmcnt(8) lgkmcnt(0)
 s_barrier
 s_add_u32 m0, s49, 90112
 s_add_u32 s45, s32, 1310720
 buffer_load_dwordx4 v11, s[12:15], s45 offen  lds
 s_add_u32 m0, s49, 94208
 s_add_u32 s45, s32, 1441792
 buffer_load_dwordx4 v11, s[12:15], s45 offen  lds
 s_add_u32 m0, s49, 98304
 s_add_u32 s45, s33, 1310720
 buffer_load_dwordx4 v11, s[16:19], s45 offen  lds
 s_add_u32 m0, s49, 102400
 s_add_u32 s45, s33, 1441792
 buffer_load_dwordx4 v11, s[16:19], s45 offen  lds
 ds_read_b64_tr_b16 a[8:9], v8 offset:32768
 ds_read_b64_tr_b16 a[10:11], v8 offset:33792
 ds_read_b64_tr_b16 a[80:81], v9 offset:32768
 ds_read_b64_tr_b16 a[82:83], v9 offset:33792
 ds_read_b64_tr_b16 a[152:153], v8 offset:40960
 ds_read_b64_tr_b16 a[154:155], v8 offset:41984
 ds_read_b64_tr_b16 a[224:225], v9 offset:40960
 ds_read_b64_tr_b16 a[226:227], v9 offset:41984
 s_waitcnt vmcnt(8) lgkmcnt(0)
 s_barrier
 s_add_u32 m0, s49, 106496
 s_add_u32 s45, s32, 1572864
 buffer_load_dwordx4 v11, s[12:15], s45 offen  lds
 s_add_u32 m0, s49, 110592
 s_add_u32 s45, s32, 1703936
 buffer_load_dwordx4 v11, s[12:15], s45 offen  lds
 s_add_u32 m0, s49, 114688
 s_add_u32 s45, s33, 1572864
 buffer_load_dwordx4 v11, s[16:19], s45 offen  lds
 s_add_u32 m0, s49, 118784
 s_add_u32 s45, s33, 1703936
 buffer_load_dwordx4 v11, s[16:19], s45 offen  lds
 ds_read_b64_tr_b16 a[12:13], v8 offset:49152
 ds_read_b64_tr_b16 a[14:15], v8 offset:50176
 ds_read_b64_tr_b16 a[84:85], v9 offset:49152
 ds_read_b64_tr_b16 a[86:87], v9 offset:50176
 ds_read_b64_tr_b16 a[156:157], v8 offset:57344
 ds_read_b64_tr_b16 a[158:159], v8 offset:58368
 ds_read_b64_tr_b16 a[228:229], v9 offset:57344
 ds_read_b64_tr_b16 a[230:231], v9 offset:58368
 s_waitcnt vmcnt(8) lgkmcnt(0)
 s_barrier
 s_add_u32 m0, s49, 122880
 s_add_u32 s45, s32, 1835008
 buffer_load_dwordx4 v11, s[12:15], s45 offen  lds
 s_add_u32 m0, s49, 126976
 s_add_u32 s45, s32, 1966080
 buffer_load_dwordx4 v11, s[12:15], s45 offen  lds
 s_add_u32 m0, s49, 131072
 s_add_u32 s45, s33, 1835008
 buffer_load_dwordx4 v11, s[16:19], s45 offen  lds
 s_add_u32 m0, s49, 135168
 s_add_u32 s45, s33, 1966080
 buffer_load_dwordx4 v11, s[16:19], s45 offen  lds
 ds_read_b64_tr_b16 a[16:17], v8 offset:0
 ds_read_b64_tr_b16 a[18:19], v8 offset:1024
 ds_read_b64_tr_b16 a[88:89], v9 offset:0
 ds_read_b64_tr_b16 a[90:91], v9 offset:1024
 ds_read_b64_tr_b16 a[160:161], v8 offset:8192
 ds_read_b64_tr_b16 a[162:163], v8 offset:9216
 ds_read_b64_tr_b16 a[232:233], v9 offset:8192
 ds_read_b64_tr_b16 a[234:235], v9 offset:9216
 s_waitcnt vmcnt(8) lgkmcnt(0)
 s_barrier
 s_add_u32 m0, s49, 73728
 s_add_u32 s45, s32, 2097152
 buffer_load_dwordx4 v11, s[12:15], s45 offen  lds
 s_add_u32 m0, s49, 77824
 s_add_u32 s45, s32, 2228224
 buffer_load_dwordx4 v11, s[12:15], s45 offen  lds
 s_add_u32 m0, s49, 81920
 s_add_u32 s45, s33, 2097152
 buffer_load_dwordx4 v11, s[16:19], s45 offen  lds
 s_add_u32 m0, s49, 86016
 s_add_u32 s45, s33, 2228224
 buffer_load_dwordx4 v11, s[16:19], s45 offen  lds
 ds_read_b64_tr_b16 a[20:21], v8 offset:16384
 ds_read_b64_tr_b16 a[22:23], v8 offset:17408
 ds_read_b64_tr_b16 a[92:93], v9 offset:16384
 ds_read_b64_tr_b16 a[94:95], v9 offset:17408
 ds_read_b64_tr_b16 a[164:165], v8 offset:24576
 ds_read_b64_tr_b16 a[166:167], v8 offset:25600
 ds_read_b64_tr_b16 a[236:237], v9 offset:24576
 ds_read_b64_tr_b16 a[238:239], v9 offset:25600
 s_waitcnt vmcnt(8) lgkmcnt(0)
 s_barrier
 s_add_u32 m0, s49, 90112
 s_add_u32 s45, s32, 2359296
 buffer_load_dwordx4 v11, s[12:15], s45 offen  lds
 s_add_u32 m0, s49, 94208
 s_add_u32 s45, s32, 2490368
 buffer_load_dwordx4 v11, s[12:15], s45 offen  lds
 s_add_u32 m0, s49, 98304
 s_add_u32 s45, s33, 2359296
 buffer_load_dwordx4 v11, s[16:19], s45 offen  lds
 s_add_u32 m0, s49, 102400
 s_add_u32 s45, s33, 2490368
 buffer_load_dwordx4 v11, s[16:19], s45 offen  lds
 ds_read_b64_tr_b16 a[24:25], v8 offset:32768
 ds_read_b64_tr_b16 a[26:27], v8 offset:33792
 ds_read_b64_tr_b16 a[96:97], v9 offset:32768
 ds_read_b64_tr_b16 a[98:99], v9 offset:33792
 ds_read_b64_tr_b16 a[168:169], v8 offset:40960
 ds_read_b64_tr_b16 a[170:171], v8 offset:41984
 ds_read_b64_tr_b16 a[240:241], v9 offset:40960
 ds_read_b64_tr_b16 a[242:243], v9 offset:41984
 s_waitcnt vmcnt(8) lgkmcnt(0)
 s_barrier
 s_add_u32 m0, s49, 106496
 s_add_u32 s45, s32, 2621440
 buffer_load_dwordx4 v11, s[12:15], s45 offen  lds
 s_add_u32 m0, s49, 110592
 s_add_u32 s45, s32, 2752512
 buffer_load_dwordx4 v11, s[12:15], s45 offen  lds
 s_add_u32 m0, s49, 114688
 s_add_u32 s45, s33, 2621440
 buffer_load_dwordx4 v11, s[16:19], s45 offen  lds
 s_add_u32 m0, s49, 118784
 s_add_u32 s45, s33, 2752512
 buffer_load_dwordx4 v11, s[16:19], s45 offen  lds
 ds_read_b64_tr_b16 a[28:29], v8 offset:49152
 ds_read_b64_tr_b16 a[30:31], v8 offset:50176
 ds_read_b64_tr_b16 a[100:101], v9 offset:49152
 ds_read_b64_tr_b16 a[102:103], v9 offset:50176
 ds_read_b64_tr_b16 a[172:173], v8 offset:57344
 ds_read_b64_tr_b16 a[174:175], v8 offset:58368
 ds_read_b64_tr_b16 a[244:245], v9 offset:57344
 ds_read_b64_tr_b16 a[246:247], v9 offset:58368
 s_waitcnt vmcnt(8) lgkmcnt(0)
 s_barrier
 s_add_u32 m0, s49, 122880
 s_add_u32 s45, s32, 2883584
 buffer_load_dwordx4 v11, s[12:15], s45 offen  lds
 s_add_u32 m0, s49, 126976
 s_add_u32 s45, s32, 3014656
 buffer_load_dwordx4 v11, s[12:15], s45 offen  lds
 s_add_u32 m0, s49, 131072
 s_add_u32 s45, s33, 2883584
 buffer_load_dwordx4 v11, s[16:19], s45 offen  lds
 s_add_u32 m0, s49, 135168
 s_add_u32 s45, s33, 3014656
 buffer_load_dwordx4 v11, s[16:19], s45 offen  lds
 ds_read_b64_tr_b16 a[32:33], v8 offset:0
 ds_read_b64_tr_b16 a[34:35], v8 offset:1024
 ds_read_b64_tr_b16 a[104:105], v9 offset:0
 ds_read_b64_tr_b16 a[106:107], v9 offset:1024
 ds_read_b64_tr_b16 a[176:177], v8 offset:8192
 ds_read_b64_tr_b16 a[178:179], v8 offset:9216
 ds_read_b64_tr_b16 a[248:249], v9 offset:8192
 ds_read_b64_tr_b16 a[250:251], v9 offset:9216
 s_waitcnt vmcnt(8) lgkmcnt(0)
 s_barrier
 s_add_u32 m0, s49, 73728
 s_add_u32 s45, s32, 3145728
 buffer_load_dwordx4 v11, s[12:15], s45 offen  lds
 s_add_u32 m0, s49, 77824
 s_add_u32 s45, s32, 3276800
 buffer_load_dwordx4 v11, s[12:15], s45 offen  lds
 s_add_u32 m0, s49, 81920
 s_add_u32 s45, s33, 3145728
 buffer_load_dwordx4 v11, s[16:19], s45 offen  lds
 s_add_u32 m0, s49, 86016
 s_add_u32 s45, s33, 3276800
 buffer_load_dwordx4 v11, s[16:19], s45 offen  lds
 ds_read_b64_tr_b16 a[36:37], v8 offset:16384
 ds_read_b64_tr_b16 a[38:39], v8 offset:17408
 ds_read_b64_tr_b16 a[108:109], v9 offset:16384
 ds_read_b64_tr_b16 a[110:111], v9 offset:17408
 ds_read_b64_tr_b16 a[180:181], v8 offset:24576
 ds_read_b64_tr_b16 a[182:183], v8 offset:25600
 ds_read_b64_tr_b16 a[252:253], v9 offset:24576
 ds_read_b64_tr_b16 a[254:255], v9 offset:25600
 s_waitcnt vmcnt(8) lgkmcnt(0)
 s_barrier
 s_add_u32 m0, s49, 90112
 s_add_u32 s45, s32, 3407872
 buffer_load_dwordx4 v11, s[12:15], s45 offen  lds
 s_add_u32 m0, s49, 94208
 s_add_u32 s45, s32, 3538944
 buffer_load_dwordx4 v11, s[12:15], s45 offen  lds
 s_add_u32 m0, s49, 98304
 s_add_u32 s45, s33, 3407872
 buffer_load_dwordx4 v11, s[16:19], s45 offen  lds
 s_add_u32 m0, s49, 102400
 s_add_u32 s45, s33, 3538944
 buffer_load_dwordx4 v11, s[16:19], s45 offen  lds
 ds_read_b64_tr_b16 a[40:41], v8 offset:32768
 ds_read_b64_tr_b16 a[42:43], v8 offset:33792
 ds_read_b64_tr_b16 a[112:113], v9 offset:32768
 ds_read_b64_tr_b16 a[114:115], v9 offset:33792
 ds_read_b64_tr_b16 a[184:185], v8 offset:40960
 ds_read_b64_tr_b16 a[186:187], v8 offset:41984
 ds_read_b64_tr_b16 v[224:225], v9 offset:40960
 ds_read_b64_tr_b16 v[226:227], v9 offset:41984
 s_waitcnt vmcnt(8) lgkmcnt(0)
 s_barrier
 s_add_u32 m0, s49, 106496
 s_add_u32 s45, s32, 3670016
 buffer_load_dwordx4 v11, s[12:15], s45 offen  lds
 s_add_u32 m0, s49, 110592
 s_add_u32 s45, s32, 3801088
 buffer_load_dwordx4 v11, s[12:15], s45 offen  lds
 s_add_u32 m0, s49, 114688
 s_add_u32 s45, s33, 3670016
 buffer_load_dwordx4 v11, s[16:19], s45 offen  lds
 s_add_u32 m0, s49, 118784
 s_add_u32 s45, s33, 3801088
 buffer_load_dwordx4 v11, s[16:19], s45 offen  lds
 ds_read_b64_tr_b16 a[44:45], v8 offset:49152
 ds_read_b64_tr_b16 a[46:47], v8 offset:50176
 ds_read_b64_tr_b16 a[116:117], v9 offset:49152
 ds_read_b64_tr_b16 a[118:119], v9 offset:50176
 ds_read_b64_tr_b16 a[188:189], v8 offset:57344
 ds_read_b64_tr_b16 a[190:191], v8 offset:58368
 ds_read_b64_tr_b16 v[228:229], v9 offset:57344
 ds_read_b64_tr_b16 v[230:231], v9 offset:58368
 s_waitcnt vmcnt(8) lgkmcnt(0)
 s_barrier
 s_add_u32 m0, s49, 122880
 s_add_u32 s45, s32, 3932160
 buffer_load_dwordx4 v11, s[12:15], s45 offen  lds
 s_add_u32 m0, s49, 126976
 s_add_u32 s45, s32, 4063232
 buffer_load_dwordx4 v11, s[12:15], s45 offen  lds
 s_add_u32 m0, s49, 131072
 s_add_u32 s45, s33, 3932160
 buffer_load_dwordx4 v11, s[16:19], s45 offen  lds
 s_add_u32 m0, s49, 135168
 s_add_u32 s45, s33, 4063232
 buffer_load_dwordx4 v11, s[16:19], s45 offen  lds
 ds_read_b64_tr_b16 a[48:49], v8 offset:0
 ds_read_b64_tr_b16 a[50:51], v8 offset:1024
 ds_read_b64_tr_b16 a[120:121], v9 offset:0
 ds_read_b64_tr_b16 a[122:123], v9 offset:1024
 ds_read_b64_tr_b16 a[192:193], v8 offset:8192
 ds_read_b64_tr_b16 a[194:195], v8 offset:9216
 ds_read_b64_tr_b16 v[232:233], v9 offset:8192
 ds_read_b64_tr_b16 v[234:235], v9 offset:9216
 s_waitcnt vmcnt(8) lgkmcnt(0)
 s_barrier
 s_add_u32 m0, s49, 73728
 s_add_u32 s45, s32, 4194304
 buffer_load_dwordx4 v11, s[12:15], s45 offen  lds
 s_add_u32 m0, s49, 77824
 s_add_u32 s45, s32, 4325376
 buffer_load_dwordx4 v11, s[12:15], s45 offen  lds
 s_add_u32 m0, s49, 81920
 s_add_u32 s45, s33, 4194304
 buffer_load_dwordx4 v11, s[16:19], s45 offen  lds
 s_add_u32 m0, s49, 86016
 s_add_u32 s45, s33, 4325376
 buffer_load_dwordx4 v11, s[16:19], s45 offen  lds
 ds_read_b64_tr_b16 a[52:53], v8 offset:16384
 ds_read_b64_tr_b16 a[54:55], v8 offset:17408
 ds_read_b64_tr_b16 a[124:125], v9 offset:16384
 ds_read_b64_tr_b16 a[126:127], v9 offset:17408
 ds_read_b64_tr_b16 a[196:197], v8 offset:24576
 ds_read_b64_tr_b16 a[198:199], v8 offset:25600
 ds_read_b64_tr_b16 v[236:237], v9 offset:24576
 ds_read_b64_tr_b16 v[238:239], v9 offset:25600
 s_waitcnt vmcnt(8) lgkmcnt(0)
 s_barrier
 s_add_u32 m0, s49, 90112
 s_add_u32 s45, s32, 4456448
 buffer_load_dwordx4 v11, s[12:15], s45 offen  lds
 s_add_u32 m0, s49, 94208
 s_add_u32 s45, s32, 4587520
 buffer_load_dwordx4 v11, s[12:15], s45 offen  lds
 s_add_u32 m0, s49, 98304
 s_add_u32 s45, s33, 4456448
 buffer_load_dwordx4 v11, s[16:19], s45 offen  lds
 s_add_u32 m0, s49, 102400
 s_add_u32 s45, s33, 4587520
 buffer_load_dwordx4 v11, s[16:19], s45 offen  lds
 ds_read_b64_tr_b16 a[56:57], v8 offset:32768
 ds_read_b64_tr_b16 a[58:59], v8 offset:33792
 ds_read_b64_tr_b16 a[128:129], v9 offset:32768
 ds_read_b64_tr_b16 a[130:131], v9 offset:33792
 ds_read_b64_tr_b16 a[200:201], v8 offset:40960
 ds_read_b64_tr_b16 a[202:203], v8 offset:41984
 ds_read_b64_tr_b16 v[240:241], v9 offset:40960
 ds_read_b64_tr_b16 v[242:243], v9 offset:41984
 s_waitcnt vmcnt(8) lgkmcnt(0)
 s_barrier
 ds_read_b64_tr_b16 a[60:61], v8 offset:49152
 ds_read_b64_tr_b16 a[62:63], v8 offset:50176
 ds_read_b64_tr_b16 a[132:133], v9 offset:49152
 ds_read_b64_tr_b16 a[134:135], v9 offset:50176
 ds_read_b64_tr_b16 a[204:205], v8 offset:57344
 ds_read_b64_tr_b16 a[206:207], v8 offset:58368
 ds_read_b64_tr_b16 v[244:245], v9 offset:57344
 ds_read_b64_tr_b16 v[246:247], v9 offset:58368
 s_waitcnt vmcnt(4) lgkmcnt(0)
 s_barrier
 ds_read_b64_tr_b16 a[64:65], v8 offset:0
 ds_read_b64_tr_b16 a[66:67], v8 offset:1024
 ds_read_b64_tr_b16 a[136:137], v9 offset:0
 ds_read_b64_tr_b16 a[138:139], v9 offset:1024
 ds_read_b64_tr_b16 a[208:209], v8 offset:8192
 ds_read_b64_tr_b16 a[210:211], v8 offset:9216
 ds_read_b64_tr_b16 v[248:249], v9 offset:8192
 ds_read_b64_tr_b16 v[250:251], v9 offset:9216
 s_waitcnt vmcnt(0) lgkmcnt(0)
 s_barrier
 ds_read_b64_tr_b16 a[68:69], v8 offset:16384
 ds_read_b64_tr_b16 a[70:71], v8 offset:17408
 ds_read_b64_tr_b16 a[140:141], v9 offset:16384
 ds_read_b64_tr_b16 a[142:143], v9 offset:17408
 ds_read_b64_tr_b16 a[212:213], v8 offset:24576
 ds_read_b64_tr_b16 a[214:215], v8 offset:25600
 ds_read_b64_tr_b16 v[252:253], v9 offset:24576
 ds_read_b64_tr_b16 v[254:255], v9 offset:25600
 s_mov_b32 s50, 0x3e0293ee
 s_mov_b32 s42, 0
 s_mov_b32 s43, 0
 s_mov_b32 s44, 73728
 v_mov_b32 v6, v4
 v_mov_b32 v7, v5
 s_mov_b32 s95, 0x40000
 s_cmp_lg_u32 s4, 0
 s_cbranch_scc1 Lfrk_17
 v_min_u32 v21, 1, v0
 v_lshlrev_b32 v21, 28, v21
Lfr_16:
 buffer_load_dword v20, v21, s[28:31], 0 offen offset:0 sc1
 s_waitcnt vmcnt(0)
 v_cmp_eq_u32 vcc, 1, v20
 s_cbranch_vccnz Lfrk_17
 s_sub_u32 s95, s95, 1
 s_cbranch_scc0 Lfr_16
 s_endpgm
Lfrk_17:
 s_lshl_b32 s47, s2, 13
 s_add_u32 s47, s47, 0x8000000
 s_mov_b32 s48, s47
 v_mov_b32 v14, 0
 s_waitcnt vmcnt(0) lgkmcnt(0)
 s_barrier
 ds_read_b128 v[32:35], v6 offset:0
 ds_read_b128 v[36:39], v6 offset:2048
 ds_read_b128 v[40:43], v7 offset:0
 ds_read_b128 v[44:47], v7 offset:2048
 v_lshlrev_b32 v1, 12, v0
 s_lshl_b32 s45, s6, 7
 buffer_load_dword v15, v1, s[8:11], s45 offen
 v_add_u32 v1, 0x100000, v1
 buffer_load_dword v15, v1, s[8:11], s45 offen
 v_add_u32 v1, 0x100000, v1
 buffer_load_dword v15, v1, s[8:11], s45 offen
 v_add_u32 v1, 0x100000, v1
 s_waitcnt lgkmcnt(2)
Lps_loop_18:
 v_mfma_f32_16x16x32_bf16 v[64:67], a[0:3], v[32:35], 0
 ds_read_b128 v[48:51], v6 offset:4096
 v_mfma_f32_16x16x32_bf16 v[72:75], a[72:75], v[32:35], 0
 ds_read_b128 v[52:55], v6 offset:6144
 v_mfma_f32_16x16x32_bf16 v[80:83], v[32:35], a[144:147], 0
 s_add_u32 s41, s40, 1
 v_mfma_f32_16x16x32_bf16 v[88:91], v[32:35], a[216:219], 0
 s_add_u32 s45, s42, 2
 s_mul_i32 s46, s41, 36864
 v_mfma_f32_16x16x32_bf16 v[68:71], a[0:3], v[36:39], 0
 s_cmp_lt_u32 s45, s36
 s_cselect_b32 s46, s46, 0
 v_mfma_f32_16x16x32_bf16 v[76:79], a[72:75], v[36:39], 0
 s_lshl_b32 s49, s4, 10
 s_add_u32 s49, s49, s44
 v_mfma_f32_16x16x32_bf16 v[84:87], v[36:39], a[144:147], 0
 v_mul_f32 v96, s50, v96
 v_mul_f32 v97, s50, v97
 v_mfma_f32_16x16x32_bf16 v[92:95], v[36:39], a[216:219], 0
 s_waitcnt lgkmcnt(2)
 v_mfma_f32_16x16x32_bf16 v[64:67], a[4:7], v[40:43], v[64:67]
 ds_read_b128 v[56:59], v7 offset:4096
 v_mul_f32 v98, s50, v98
 v_mfma_f32_16x16x32_bf16 v[72:75], a[76:79], v[40:43], v[72:75]
 ds_read_b128 v[60:63], v7 offset:6144
 v_mul_f32 v99, s50, v99
 v_mfma_f32_16x16x32_bf16 v[80:83], v[40:43], a[148:151], v[80:83]
 v_mul_f32 v104, s50, v104
 v_mfma_f32_16x16x32_bf16 v[88:91], v[40:43], a[220:223], v[88:91]
 v_mul_f32 v105, s50, v105
 v_mfma_f32_16x16x32_bf16 v[68:71], a[4:7], v[44:47], v[68:71]
 v_mul_f32 v106, s50, v106
 v_mul_f32 v107, s50, v107
 v_mfma_f32_16x16x32_bf16 v[76:79], a[76:79], v[44:47], v[76:79]
 v_cvt_pk_bf16_f32 v16, v96, v104
 v_mfma_f32_16x16x32_bf16 v[84:87], v[44:47], a[148:151], v[84:87]
 v_cvt_pk_bf16_f32 v17, v97, v105
 v_mfma_f32_16x16x32_bf16 v[92:95], v[44:47], a[220:223], v[92:95]
 s_waitcnt lgkmcnt(2)
 v_cvt_pk_bf16_f32 v18, v98, v106
 v_mfma_f32_16x16x32_bf16 v[64:67], a[8:11], v[48:51], v[64:67]
 ds_read_b128 v[32:35], v6 offset:8192
 v_cvt_pk_bf16_f32 v19, v99, v107
 v_mfma_f32_16x16x32_bf16 v[72:75], a[80:83], v[48:51], v[72:75]
 ds_read_b128 v[36:39], v6 offset:10240
 v_mfma_f32_16x16x32_bf16 v[80:83], v[48:51], a[152:155], v[80:83]
 buffer_store_dwordx4 v[16:19], v12, s[20:23], s47 offen offset:0 sc1
 v_mul_f32 v100, s50, v100
 v_mfma_f32_16x16x32_bf16 v[88:91], v[48:51], a[224:227], v[88:91]
 v_mul_f32 v101, s50, v101
 v_mfma_f32_16x16x32_bf16 v[68:71], a[8:11], v[52:55], v[68:71]
 v_mul_f32 v102, s50, v102
 v_mfma_f32_16x16x32_bf16 v[76:79], a[80:83], v[52:55], v[76:79]
 v_mul_f32 v103, s50, v103
 v_mul_f32 v108, s50, v108
 v_mfma_f32_16x16x32_bf16 v[84:87], v[52:55], a[152:155], v[84:87]
 v_mul_f32 v109, s50, v109
 v_mfma_f32_16x16x32_bf16 v[92:95], v[52:55], a[224:227], v[92:95]
 s_waitcnt lgkmcnt(2)
 v_mfma_f32_16x16x32_bf16 v[64:67], a[12:15], v[56:59], v[64:67]
 ds_read_b128 v[40:43], v7 offset:8192
 v_mul_f32 v110, s50, v110
 v_mfma_f32_16x16x32_bf16 v[72:75], a[84:87], v[56:59], v[72:75]
 ds_read_b128 v[44:47], v7 offset:10240
 v_mul_f32 v111, s50, v111
 v_mfma_f32_16x16x32_bf16 v[80:83], v[56:59], a[156:159], v[80:83]
 v_cvt_pk_bf16_f32 v20, v100, v108
 v_mfma_f32_16x16x32_bf16 v[88:91], v[56:59], a[228:231], v[88:91]
 v_cvt_pk_bf16_f32 v21, v101, v109
 v_mfma_f32_16x16x32_bf16 v[68:71], a[12:15], v[60:63], v[68:71]
 v_cvt_pk_bf16_f32 v22, v102, v110
 v_cvt_pk_bf16_f32 v23, v103, v111
 v_mfma_f32_16x16x32_bf16 v[76:79], a[84:87], v[60:63], v[76:79]
 buffer_store_dwordx4 v[20:23], v12, s[20:23], s47 offen offset:1024 sc1
 v_mfma_f32_16x16x32_bf16 v[84:87], v[60:63], a[156:159], v[84:87]
 v_cvt_pk_bf16_f32 v24, v112, v113
 v_mfma_f32_16x16x32_bf16 v[92:95], v[60:63], a[228:231], v[92:95]
 s_waitcnt lgkmcnt(2)
 v_cvt_pk_bf16_f32 v25, v116, v117
 v_mfma_f32_16x16x32_bf16 v[64:67], a[16:19], v[32:35], v[64:67]
 ds_read_b128 v[48:51], v6 offset:12288
 v_cvt_pk_bf16_f32 v26, v114, v115
 v_mfma_f32_16x16x32_bf16 v[72:75], a[88:91], v[32:35], v[72:75]
 ds_read_b128 v[52:55], v6 offset:14336
 v_mfma_f32_16x16x32_bf16 v[80:83], v[32:35], a[160:163], v[80:83]
 v_cvt_pk_bf16_f32 v27, v118, v119
 buffer_store_dwordx4 v[24:27], v12, s[20:23], s48 offen offset:0 sc1
 v_mfma_f32_16x16x32_bf16 v[88:91], v[32:35], a[232:235], v[88:91]
 v_cvt_pk_bf16_f32 v28, v120, v121
 v_mfma_f32_16x16x32_bf16 v[68:71], a[16:19], v[36:39], v[68:71]
 v_cvt_pk_bf16_f32 v29, v124, v125
 v_mfma_f32_16x16x32_bf16 v[76:79], a[88:91], v[36:39], v[76:79]
 v_cvt_pk_bf16_f32 v30, v122, v123
 v_cvt_pk_bf16_f32 v31, v126, v127
 v_mfma_f32_16x16x32_bf16 v[84:87], v[36:39], a[160:163], v[84:87]
 buffer_store_dwordx4 v[28:31], v12, s[20:23], s48 offen offset:1024 sc1
 v_mfma_f32_16x16x32_bf16 v[92:95], v[36:39], a[232:235], v[92:95]
 s_waitcnt lgkmcnt(2)
 v_mfma_f32_16x16x32_bf16 v[64:67], a[20:23], v[40:43], v[64:67]
 ds_read_b128 v[56:59], v7 offset:12288
 v_mfma_f32_16x16x32_bf16 v[72:75], a[92:95], v[40:43], v[72:75]
 ds_read_b128 v[60:63], v7 offset:14336
 v_mfma_f32_16x16x32_bf16 v[80:83], v[40:43], a[164:167], v[80:83]
 s_add_u32 m0, s49, 0
 v_mfma_f32_16x16x32_bf16 v[88:91], v[40:43], a[236:239], v[88:91]
 buffer_load_dwordx4 v10, s[8:11], s46 offen offset:0  lds
 v_mfma_f32_16x16x32_bf16 v[68:71], a[20:23], v[44:47], v[68:71]
 s_add_u32 m0, s49, 3968
 v_mfma_f32_16x16x32_bf16 v[76:79], a[92:95], v[44:47], v[76:79]
 buffer_load_dwordx4 v10, s[8:11], s46 offen offset:128  lds
 v_mfma_f32_16x16x32_bf16 v[84:87], v[44:47], a[164:167], v[84:87]
 v_mfma_f32_16x16x32_bf16 v[92:95], v[44:47], a[236:239], v[92:95]
 s_waitcnt lgkmcnt(2)
 v_mfma_f32_16x16x32_bf16 v[64:67], a[24:27], v[48:51], v[64:67]
 ds_read_b128 v[32:35], v6 offset:16384
 v_mfma_f32_16x16x32_bf16 v[72:75], a[96:99], v[48:51], v[72:75]
 ds_read_b128 v[36:39], v6 offset:18432
 v_mfma_f32_16x16x32_bf16 v[80:83], v[48:51], a[168:171], v[80:83]
 s_add_u32 m0, s49, 7936
 v_mfma_f32_16x16x32_bf16 v[88:91], v[48:51], a[240:243], v[88:91]
 buffer_load_dwordx4 v10, s[8:11], s46 offen offset:256  lds
 v_mfma_f32_16x16x32_bf16 v[68:71], a[24:27], v[52:55], v[68:71]
 s_add_u32 m0, s49, 11904
 v_mfma_f32_16x16x32_bf16 v[76:79], a[96:99], v[52:55], v[76:79]
 buffer_load_dwordx4 v10, s[8:11], s46 offen offset:384  lds
 v_mfma_f32_16x16x32_bf16 v[84:87], v[52:55], a[168:171], v[84:87]
 v_mfma_f32_16x16x32_bf16 v[92:95], v[52:55], a[240:243], v[92:95]
 s_waitcnt lgkmcnt(2)
 v_mfma_f32_16x16x32_bf16 v[64:67], a[28:31], v[56:59], v[64:67]
 ds_read_b128 v[40:43], v7 offset:16384
 v_mfma_f32_16x16x32_bf16 v[72:75], a[100:103], v[56:59], v[72:75]
 ds_read_b128 v[44:47], v7 offset:18432
 v_mfma_f32_16x16x32_bf16 v[80:83], v[56:59], a[172:175], v[80:83]
 s_add_u32 m0, s49, 15872
 v_mfma_f32_16x16x32_bf16 v[88:91], v[56:59], a[244:247], v[88:91]
 buffer_load_dwordx4 v10, s[8:11], s46 offen offset:512  lds
 v_mfma_f32_16x16x32_bf16 v[68:71], a[28:31], v[60:63], v[68:71]
 s_add_u32 m0, s49, 19840
 v_mfma_f32_16x16x32_bf16 v[76:79], a[100:103], v[60:63], v[76:79]
 buffer_load_dwordx4 v10, s[8:11], s46 offen offset:640  lds
 v_mfma_f32_16x16x32_bf16 v[84:87], v[60:63], a[172:175], v[84:87]
 v_mfma_f32_16x16x32_bf16 v[92:95], v[60:63], a[244:247], v[92:95]
 s_waitcnt lgkmcnt(2)
 v_mfma_f32_16x16x32_bf16 v[64:67], a[32:35], v[32:35], v[64:67]
 ds_read_b128 v[48:51], v6 offset:20480
 v_mfma_f32_16x16x32_bf16 v[72:75], a[104:107], v[32:35], v[72:75]
 ds_read_b128 v[52:55], v6 offset:22528
 v_mfma_f32_16x16x32_bf16 v[80:83], v[32:35], a[176:179], v[80:83]
 s_add_u32 m0, s49, 23808
 v_mfma_f32_16x16x32_bf16 v[88:91], v[32:35], a[248:251], v[88:91]
 buffer_load_dwordx4 v10, s[8:11], s46 offen offset:768  lds
 v_mfma_f32_16x16x32_bf16 v[68:71], a[32:35], v[36:39], v[68:71]
 s_add_u32 m0, s49, 27776
 v_mfma_f32_16x16x32_bf16 v[76:79], a[104:107], v[36:39], v[76:79]
 buffer_load_dwordx4 v10, s[8:11], s46 offen offset:896  lds
 v_mfma_f32_16x16x32_bf16 v[84:87], v[36:39], a[176:179], v[84:87]
 v_mfma_f32_16x16x32_bf16 v[92:95], v[36:39], a[248:251], v[92:95]
 s_waitcnt lgkmcnt(2)
 v_mfma_f32_16x16x32_bf16 v[64:67], a[36:39], v[40:43], v[64:67]
 ds_read_b128 v[56:59], v7 offset:20480
 v_mfma_f32_16x16x32_bf16 v[72:75], a[108:111], v[40:43], v[72:75]
 ds_read_b128 v[60:63], v7 offset:22528
 v_mfma_f32_16x16x32_bf16 v[80:83], v[40:43], a[180:183], v[80:83]
 s_add_u32 m0, s49, 31744
 v_mfma_f32_16x16x32_bf16 v[88:91], v[40:43], a[252:255], v[88:91]
 buffer_load_dwordx4 v10, s[8:11], s46 offen offset:1024  lds
 v_mfma_f32_16x16x32_bf16 v[68:71], a[36:39], v[44:47], v[68:71]
 v_mfma_f32_16x16x32_bf16 v[76:79], a[108:111], v[44:47], v[76:79]
 v_mfma_f32_16x16x32_bf16 v[84:87], v[44:47], a[180:183], v[84:87]
 v_mfma_f32_16x16x32_bf16 v[92:95], v[44:47], a[252:255], v[92:95]
 s_waitcnt lgkmcnt(2)
 v_mfma_f32_16x16x32_bf16 v[64:67], a[40:43], v[48:51], v[64:67]
 ds_read_b128 v[32:35], v6 offset:24576
 v_mfma_f32_16x16x32_bf16 v[72:75], a[112:115], v[48:51], v[72:75]
 ds_read_b128 v[36:39], v6 offset:26624
 v_mfma_f32_16x16x32_bf16 v[80:83], v[48:51], a[184:187], v[80:83]
 v_mfma_f32_16x16x32_bf16 v[88:91], v[48:51], v[224:227], v[88:91]
 v_mfma_f32_16x16x32_bf16 v[68:71], a[40:43], v[52:55], v[68:71]
 v_mfma_f32_16x16x32_bf16 v[76:79], a[112:115], v[52:55], v[76:79]
 v_mfma_f32_16x16x32_bf16 v[84:87], v[52:55], a[184:187], v[84:87]
 v_mfma_f32_16x16x32_bf16 v[92:95], v[52:55], v[224:227], v[92:95]
 s_waitcnt lgkmcnt(2)
 v_mfma_f32_16x16x32_bf16 v[64:67], a[44:47], v[56:59], v[64:67]
 ds_read_b128 v[40:43], v7 offset:24576
 v_mfma_f32_16x16x32_bf16 v[72:75], a[116:119], v[56:59], v[72:75]
 ds_read_b128 v[44:47], v7 offset:26624
 v_mfma_f32_16x16x32_bf16 v[80:83], v[56:59], a[188:191], v[80:83]
 v_mfma_f32_16x16x32_bf16 v[88:91], v[56:59], v[228:231], v[88:91]
 v_mfma_f32_16x16x32_bf16 v[68:71], a[44:47], v[60:63], v[68:71]
 v_mfma_f32_16x16x32_bf16 v[76:79], a[116:119], v[60:63], v[76:79]
 v_mfma_f32_16x16x32_bf16 v[84:87], v[60:63], a[188:191], v[84:87]
 v_mfma_f32_16x16x32_bf16 v[92:95], v[60:63], v[228:231], v[92:95]
 s_waitcnt lgkmcnt(2)
 v_mfma_f32_16x16x32_bf16 v[64:67], a[48:51], v[32:35], v[64:67]
 ds_read_b128 v[48:51], v6 offset:28672
 v_mfma_f32_16x16x32_bf16 v[72:75], a[120:123], v[32:35], v[72:75]
 ds_read_b128 v[52:55], v6 offset:30720
 v_mfma_f32_16x16x32_bf16 v[80:83], v[32:35], a[192:195], v[80:83]
 v_mfma_f32_16x16x32_bf16 v[88:91], v[32:35], v[232:235], v[88:91]
 v_mfma_f32_16x16x32_bf16 v[68:71], a[48:51], v[36:39], v[68:71]
 v_mfma_f32_16x16x32_bf16 v[76:79], a[120:123], v[36:39], v[76:79]
 v_mfma_f32_16x16x32_bf16 v[84:87], v[36:39], a[192:195], v[84:87]
 v_mfma_f32_16x16x32_bf16 v[92:95], v[36:39], v[232:235], v[92:95]
 s_waitcnt lgkmcnt(2)
 v_mfma_f32_16x16x32_bf16 v[64:67], a[52:55], v[40:43], v[64:67]
 ds_read_b128 v[56:59], v7 offset:28672
 v_mfma_f32_16x16x32_bf16 v[72:75], a[124:127], v[40:43], v[72:75]
 ds_read_b128 v[60:63], v7 offset:30720
 v_mfma_f32_16x16x32_bf16 v[80:83], v[40:43], a[196:199], v[80:83]
 s_add_u32 s43, s43, 36864
 s_cmp_eq_u32 s43, 147456
 v_mfma_f32_16x16x32_bf16 v[88:91], v[40:43], v[236:239], v[88:91]
 s_cselect_b32 s43, 0, s43
 s_add_u32 s44, s44, 36864
 v_mfma_f32_16x16x32_bf16 v[68:71], a[52:55], v[44:47], v[68:71]
 s_cmp_eq_u32 s44, 147456
 s_cselect_b32 s44, 0, s44
 v_mfma_f32_16x16x32_bf16 v[76:79], a[124:127], v[44:47], v[76:79]
 v_mfma_f32_16x16x32_bf16 v[84:87], v[44:47], a[196:199], v[84:87]
 v_mfma_f32_16x16x32_bf16 v[92:95], v[44:47], v[236:239], v[92:95]
 s_waitcnt lgkmcnt(2)
 v_mfma_f32_16x16x32_bf16 v[64:67], a[56:59], v[48:51], v[64:67]
 ds_read_b128 v[32:35], v6 offset:32768
 v_mfma_f32_16x16x32_bf16 v[72:75], a[128:131], v[48:51], v[72:75]
 ds_read_b128 v[36:39], v6 offset:34816
 v_mfma_f32_16x16x32_bf16 v[80:83], v[48:51], a[200:203], v[80:83]
 v_add_u32 v6, s43, v4
 v_mfma_f32_16x16x32_bf16 v[88:91], v[48:51], v[240:243], v[88:91]
 v_mfma_f32_16x16x32_bf16 v[68:71], a[56:59], v[52:55], v[68:71]
 v_mfma_f32_16x16x32_bf16 v[76:79], a[128:131], v[52:55], v[76:79]
 v_mfma_f32_16x16x32_bf16 v[84:87], v[52:55], a[200:203], v[84:87]
 v_mfma_f32_16x16x32_bf16 v[92:95], v[52:55], v[240:243], v[92:95]
 s_waitcnt lgkmcnt(2)
 v_mfma_f32_16x16x32_bf16 v[64:67], a[60:63], v[56:59], v[64:67]
 ds_read_b128 v[40:43], v7 offset:32768
 v_mfma_f32_16x16x32_bf16 v[72:75], a[132:135], v[56:59], v[72:75]
 ds_read_b128 v[44:47], v7 offset:34816
 v_mfma_f32_16x16x32_bf16 v[80:83], v[56:59], a[204:207], v[80:83]
 v_add_u32 v7, s43, v5
 v_mfma_f32_16x16x32_bf16 v[88:91], v[56:59], v[244:247], v[88:91]
 v_mfma_f32_16x16x32_bf16 v[68:71], a[60:63], v[60:63], v[68:71]
 v_mfma_f32_16x16x32_bf16 v[76:79], a[132:135], v[60:63], v[76:79]
 v_mfma_f32_16x16x32_bf16 v[84:87], v[60:63], a[204:207], v[84:87]
 v_mfma_f32_16x16x32_bf16 v[92:95], v[60:63], v[244:247], v[92:95]
 s_waitcnt lgkmcnt(2)
 v_mfma_f32_16x16x32_bf16 v[64:67], a[64:67], v[32:35], v[64:67]
 s_waitcnt vmcnt(9)
 s_barrier
 ds_read_b128 v[48:51], v6 offset:0
 v_mfma_f32_16x16x32_bf16 v[72:75], a[136:139], v[32:35], v[72:75]
 ds_read_b128 v[52:55], v6 offset:2048
 v_mfma_f32_16x16x32_bf16 v[80:83], v[32:35], a[208:211], v[80:83]
 buffer_store_dword v14, v13, s[20:23], 0 offen sc1
 v_mfma_f32_16x16x32_bf16 v[88:91], v[32:35], v[248:251], v[88:91]
 v_mfma_f32_16x16x32_bf16 v[68:71], a[64:67], v[36:39], v[68:71]
 v_mfma_f32_16x16x32_bf16 v[76:79], a[136:139], v[36:39], v[76:79]
 v_mfma_f32_16x16x32_bf16 v[84:87], v[36:39], a[208:211], v[84:87]
 v_mfma_f32_16x16x32_bf16 v[92:95], v[36:39], v[248:251], v[92:95]
 s_waitcnt lgkmcnt(2)
 v_mfma_f32_16x16x32_bf16 v[64:67], a[68:71], v[40:43], v[64:67]
 ds_read_b128 v[56:59], v7 offset:0
 v_mfma_f32_16x16x32_bf16 v[72:75], a[140:143], v[40:43], v[72:75]
 ds_read_b128 v[60:63], v7 offset:2048
 v_mfma_f32_16x16x32_bf16 v[80:83], v[40:43], a[212:215], v[80:83]
 s_mul_i32 s45, s39, 524288
 s_add_u32 s47, s34, s45
 v_mfma_f32_16x16x32_bf16 v[88:91], v[40:43], v[252:255], v[88:91]
 s_add_u32 s48, s35, s45
 v_add_u32 v14, 1, v14
 v_mfma_f32_16x16x32_bf16 v[68:71], a[68:71], v[44:47], v[68:71]
 s_mov_b32 s39, s40
 s_mov_b32 s40, s41
 v_mfma_f32_16x16x32_bf16 v[76:79], a[140:143], v[44:47], v[76:79]
 s_add_u32 s42, s42, 1
 v_mfma_f32_16x16x32_bf16 v[84:87], v[44:47], a[212:215], v[84:87]
 v_mfma_f32_16x16x32_bf16 v[92:95], v[44:47], v[252:255], v[92:95]
 s_waitcnt lgkmcnt(2)
 v_mfma_f32_16x16x32_bf16 v[96:99], a[0:3], v[48:51], 0
 ds_read_b128 v[32:35], v6 offset:4096
 v_mfma_f32_16x16x32_bf16 v[104:107], a[72:75], v[48:51], 0
 ds_read_b128 v[36:39], v6 offset:6144
 v_mfma_f32_16x16x32_bf16 v[112:115], v[48:51], a[144:147], 0
 s_add_u32 s41, s40, 1
 v_mfma_f32_16x16x32_bf16 v[120:123], v[48:51], a[216:219], 0
 s_add_u32 s45, s42, 2
 s_mul_i32 s46, s41, 36864
 v_mfma_f32_16x16x32_bf16 v[100:103], a[0:3], v[52:55], 0
 s_cmp_lt_u32 s45, s36
 s_cselect_b32 s46, s46, 0
 v_mfma_f32_16x16x32_bf16 v[108:111], a[72:75], v[52:55], 0
 s_lshl_b32 s49, s4, 10
 s_add_u32 s49, s49, s44
 v_mfma_f32_16x16x32_bf16 v[116:119], v[52:55], a[144:147], 0
 v_mul_f32 v64, s50, v64
 v_mul_f32 v65, s50, v65
 v_mfma_f32_16x16x32_bf16 v[124:127], v[52:55], a[216:219], 0
 s_waitcnt lgkmcnt(2)
 v_mfma_f32_16x16x32_bf16 v[96:99], a[4:7], v[56:59], v[96:99]
 ds_read_b128 v[40:43], v7 offset:4096
 v_mul_f32 v66, s50, v66
 v_mfma_f32_16x16x32_bf16 v[104:107], a[76:79], v[56:59], v[104:107]
 ds_read_b128 v[44:47], v7 offset:6144
 v_mul_f32 v67, s50, v67
 v_mfma_f32_16x16x32_bf16 v[112:115], v[56:59], a[148:151], v[112:115]
 v_mul_f32 v72, s50, v72
 v_mfma_f32_16x16x32_bf16 v[120:123], v[56:59], a[220:223], v[120:123]
 v_mul_f32 v73, s50, v73
 v_mfma_f32_16x16x32_bf16 v[100:103], a[4:7], v[60:63], v[100:103]
 v_mul_f32 v74, s50, v74
 v_mul_f32 v75, s50, v75
 v_mfma_f32_16x16x32_bf16 v[108:111], a[76:79], v[60:63], v[108:111]
 v_cvt_pk_bf16_f32 v16, v64, v72
 v_mfma_f32_16x16x32_bf16 v[116:119], v[60:63], a[148:151], v[116:119]
 v_cvt_pk_bf16_f32 v17, v65, v73
 v_mfma_f32_16x16x32_bf16 v[124:127], v[60:63], a[220:223], v[124:127]
 s_waitcnt lgkmcnt(2)
 v_cvt_pk_bf16_f32 v18, v66, v74
 v_mfma_f32_16x16x32_bf16 v[96:99], a[8:11], v[32:35], v[96:99]
 ds_read_b128 v[48:51], v6 offset:8192
 v_cvt_pk_bf16_f32 v19, v67, v75
 v_mfma_f32_16x16x32_bf16 v[104:107], a[80:83], v[32:35], v[104:107]
 ds_read_b128 v[52:55], v6 offset:10240
 v_mfma_f32_16x16x32_bf16 v[112:115], v[32:35], a[152:155], v[112:115]
 buffer_store_dwordx4 v[16:19], v12, s[20:23], s47 offen offset:0 sc1
 v_mul_f32 v68, s50, v68
 v_mfma_f32_16x16x32_bf16 v[120:123], v[32:35], a[224:227], v[120:123]
 v_mul_f32 v69, s50, v69
 v_mfma_f32_16x16x32_bf16 v[100:103], a[8:11], v[36:39], v[100:103]
 v_mul_f32 v70, s50, v70
 v_mfma_f32_16x16x32_bf16 v[108:111], a[80:83], v[36:39], v[108:111]
 v_mul_f32 v71, s50, v71
 v_mul_f32 v76, s50, v76
 v_mfma_f32_16x16x32_bf16 v[116:119], v[36:39], a[152:155], v[116:119]
 v_mul_f32 v77, s50, v77
 v_mfma_f32_16x16x32_bf16 v[124:127], v[36:39], a[224:227], v[124:127]
 s_waitcnt lgkmcnt(2)
 v_mfma_f32_16x16x32_bf16 v[96:99], a[12:15], v[40:43], v[96:99]
 ds_read_b128 v[56:59], v7 offset:8192
 v_mul_f32 v78, s50, v78
 v_mfma_f32_16x16x32_bf16 v[104:107], a[84:87], v[40:43], v[104:107]
 ds_read_b128 v[60:63], v7 offset:10240
 v_mul_f32 v79, s50, v79
 v_mfma_f32_16x16x32_bf16 v[112:115], v[40:43], a[156:159], v[112:115]
 v_cvt_pk_bf16_f32 v20, v68, v76
 v_mfma_f32_16x16x32_bf16 v[120:123], v[40:43], a[228:231], v[120:123]
 v_cvt_pk_bf16_f32 v21, v69, v77
 v_mfma_f32_16x16x32_bf16 v[100:103], a[12:15], v[44:47], v[100:103]
 v_cvt_pk_bf16_f32 v22, v70, v78
 v_cvt_pk_bf16_f32 v23, v71, v79
 v_mfma_f32_16x16x32_bf16 v[108:111], a[84:87], v[44:47], v[108:111]
 buffer_store_dwordx4 v[20:23], v12, s[20:23], s47 offen offset:1024 sc1
 v_mfma_f32_16x16x32_bf16 v[116:119], v[44:47], a[156:159], v[116:119]
 v_cvt_pk_bf16_f32 v24, v80, v81
 v_mfma_f32_16x16x32_bf16 v[124:127], v[44:47], a[228:231], v[124:127]
 s_waitcnt lgkmcnt(2)
 v_cvt_pk_bf16_f32 v25, v84, v85
 v_mfma_f32_16x16x32_bf16 v[96:99], a[16:19], v[48:51], v[96:99]
 ds_read_b128 v[32:35], v6 offset:12288
 v_cvt_pk_bf16_f32 v26, v82, v83
 v_mfma_f32_16x16x32_bf16 v[104:107], a[88:91], v[48:51], v[104:107]
 ds_read_b128 v[36:39], v6 offset:14336
 v_mfma_f32_16x16x32_bf16 v[112:115], v[48:51], a[160:163], v[112:115]
 v_cvt_pk_bf16_f32 v27, v86, v87
 buffer_store_dwordx4 v[24:27], v12, s[20:23], s48 offen offset:0 sc1
 v_mfma_f32_16x16x32_bf16 v[120:123], v[48:51], a[232:235], v[120:123]
 v_cvt_pk_bf16_f32 v28, v88, v89
 v_mfma_f32_16x16x32_bf16 v[100:103], a[16:19], v[52:55], v[100:103]
 v_cvt_pk_bf16_f32 v29, v92, v93
 v_mfma_f32_16x16x32_bf16 v[108:111], a[88:91], v[52:55], v[108:111]
 v_cvt_pk_bf16_f32 v30, v90, v91
 v_cvt_pk_bf16_f32 v31, v94, v95
 v_mfma_f32_16x16x32_bf16 v[116:119], v[52:55], a[160:163], v[116:119]
 buffer_store_dwordx4 v[28:31], v12, s[20:23], s48 offen offset:1024 sc1
 v_mfma_f32_16x16x32_bf16 v[124:127], v[52:55], a[232:235], v[124:127]
 s_waitcnt lgkmcnt(2)
 v_mfma_f32_16x16x32_bf16 v[96:99], a[20:23], v[56:59], v[96:99]
 ds_read_b128 v[40:43], v7 offset:12288
 v_mfma_f32_16x16x32_bf16 v[104:107], a[92:95], v[56:59], v[104:107]
 ds_read_b128 v[44:47], v7 offset:14336
 v_mfma_f32_16x16x32_bf16 v[112:115], v[56:59], a[164:167], v[112:115]
 s_add_u32 m0, s49, 0
 v_mfma_f32_16x16x32_bf16 v[120:123], v[56:59], a[236:239], v[120:123]
 buffer_load_dwordx4 v10, s[8:11], s46 offen offset:0  lds
 v_mfma_f32_16x16x32_bf16 v[100:103], a[20:23], v[60:63], v[100:103]
 s_add_u32 m0, s49, 3968
 v_mfma_f32_16x16x32_bf16 v[108:111], a[92:95], v[60:63], v[108:111]
 buffer_load_dwordx4 v10, s[8:11], s46 offen offset:128  lds
 v_mfma_f32_16x16x32_bf16 v[116:119], v[60:63], a[164:167], v[116:119]
 v_mfma_f32_16x16x32_bf16 v[124:127], v[60:63], a[236:239], v[124:127]
 s_waitcnt lgkmcnt(2)
 v_mfma_f32_16x16x32_bf16 v[96:99], a[24:27], v[32:35], v[96:99]
 ds_read_b128 v[48:51], v6 offset:16384
 v_mfma_f32_16x16x32_bf16 v[104:107], a[96:99], v[32:35], v[104:107]
 ds_read_b128 v[52:55], v6 offset:18432
 v_mfma_f32_16x16x32_bf16 v[112:115], v[32:35], a[168:171], v[112:115]
 s_add_u32 m0, s49, 7936
 v_mfma_f32_16x16x32_bf16 v[120:123], v[32:35], a[240:243], v[120:123]
 buffer_load_dwordx4 v10, s[8:11], s46 offen offset:256  lds
 v_mfma_f32_16x16x32_bf16 v[100:103], a[24:27], v[36:39], v[100:103]
 s_add_u32 m0, s49, 11904
 v_mfma_f32_16x16x32_bf16 v[108:111], a[96:99], v[36:39], v[108:111]
 buffer_load_dwordx4 v10, s[8:11], s46 offen offset:384  lds
 v_mfma_f32_16x16x32_bf16 v[116:119], v[36:39], a[168:171], v[116:119]
 v_mfma_f32_16x16x32_bf16 v[124:127], v[36:39], a[240:243], v[124:127]
 s_waitcnt lgkmcnt(2)
 v_mfma_f32_16x16x32_bf16 v[96:99], a[28:31], v[40:43], v[96:99]
 ds_read_b128 v[56:59], v7 offset:16384
 v_mfma_f32_16x16x32_bf16 v[104:107], a[100:103], v[40:43], v[104:107]
 ds_read_b128 v[60:63], v7 offset:18432
 v_mfma_f32_16x16x32_bf16 v[112:115], v[40:43], a[172:175], v[112:115]
 s_add_u32 m0, s49, 15872
 v_mfma_f32_16x16x32_bf16 v[120:123], v[40:43], a[244:247], v[120:123]
 buffer_load_dwordx4 v10, s[8:11], s46 offen offset:512  lds
 v_mfma_f32_16x16x32_bf16 v[100:103], a[28:31], v[44:47], v[100:103]
 s_add_u32 m0, s49, 19840
 v_mfma_f32_16x16x32_bf16 v[108:111], a[100:103], v[44:47], v[108:111]
 buffer_load_dwordx4 v10, s[8:11], s46 offen offset:640  lds
 v_mfma_f32_16x16x32_bf16 v[116:119], v[44:47], a[172:175], v[116:119]
 v_mfma_f32_16x16x32_bf16 v[124:127], v[44:47], a[244:247], v[124:127]
 s_waitcnt lgkmcnt(2)
 v_mfma_f32_16x16x32_bf16 v[96:99], a[32:35], v[48:51], v[96:99]
 ds_read_b128 v[32:35], v6 offset:20480
 v_mfma_f32_16x16x32_bf16 v[104:107], a[104:107], v[48:51], v[104:107]
 ds_read_b128 v[36:39], v6 offset:22528
 v_mfma_f32_16x16x32_bf16 v[112:115], v[48:51], a[176:179], v[112:115]
 s_add_u32 m0, s49, 23808
 v_mfma_f32_16x16x32_bf16 v[120:123], v[48:51], a[248:251], v[120:123]
 buffer_load_dwordx4 v10, s[8:11], s46 offen offset:768  lds
 v_mfma_f32_16x16x32_bf16 v[100:103], a[32:35], v[52:55], v[100:103]
 s_add_u32 m0, s49, 27776
 v_mfma_f32_16x16x32_bf16 v[108:111], a[104:107], v[52:55], v[108:111]
 buffer_load_dwordx4 v10, s[8:11], s46 offen offset:896  lds
 v_mfma_f32_16x16x32_bf16 v[116:119], v[52:55], a[176:179], v[116:119]
 v_mfma_f32_16x16x32_bf16 v[124:127], v[52:55], a[248:251], v[124:127]
 s_waitcnt lgkmcnt(2)
 v_mfma_f32_16x16x32_bf16 v[96:99], a[36:39], v[56:59], v[96:99]
 ds_read_b128 v[40:43], v7 offset:20480
 v_mfma_f32_16x16x32_bf16 v[104:107], a[108:111], v[56:59], v[104:107]
 ds_read_b128 v[44:47], v7 offset:22528
 v_mfma_f32_16x16x32_bf16 v[112:115], v[56:59], a[180:183], v[112:115]
 s_add_u32 m0, s49, 31744
 v_mfma_f32_16x16x32_bf16 v[120:123], v[56:59], a[252:255], v[120:123]
 buffer_load_dwordx4 v10, s[8:11], s46 offen offset:1024  lds
 v_mfma_f32_16x16x32_bf16 v[100:103], a[36:39], v[60:63], v[100:103]
 v_mfma_f32_16x16x32_bf16 v[108:111], a[108:111], v[60:63], v[108:111]
 v_mfma_f32_16x16x32_bf16 v[116:119], v[60:63], a[180:183], v[116:119]
 v_mfma_f32_16x16x32_bf16 v[124:127], v[60:63], a[252:255], v[124:127]
 s_waitcnt lgkmcnt(2)
 v_mfma_f32_16x16x32_bf16 v[96:99], a[40:43], v[32:35], v[96:99]
 ds_read_b128 v[48:51], v6 offset:24576
 v_mfma_f32_16x16x32_bf16 v[104:107], a[112:115], v[32:35], v[104:107]
 ds_read_b128 v[52:55], v6 offset:26624
 v_mfma_f32_16x16x32_bf16 v[112:115], v[32:35], a[184:187], v[112:115]
 v_mfma_f32_16x16x32_bf16 v[120:123], v[32:35], v[224:227], v[120:123]
 v_mfma_f32_16x16x32_bf16 v[100:103], a[40:43], v[36:39], v[100:103]
 v_mfma_f32_16x16x32_bf16 v[108:111], a[112:115], v[36:39], v[108:111]
 v_mfma_f32_16x16x32_bf16 v[116:119], v[36:39], a[184:187], v[116:119]
 v_mfma_f32_16x16x32_bf16 v[124:127], v[36:39], v[224:227], v[124:127]
 s_waitcnt lgkmcnt(2)
 v_mfma_f32_16x16x32_bf16 v[96:99], a[44:47], v[40:43], v[96:99]
 ds_read_b128 v[56:59], v7 offset:24576
 v_mfma_f32_16x16x32_bf16 v[104:107], a[116:119], v[40:43], v[104:107]
 ds_read_b128 v[60:63], v7 offset:26624
 v_mfma_f32_16x16x32_bf16 v[112:115], v[40:43], a[188:191], v[112:115]
 v_mfma_f32_16x16x32_bf16 v[120:123], v[40:43], v[228:231], v[120:123]
 v_mfma_f32_16x16x32_bf16 v[100:103], a[44:47], v[44:47], v[100:103]
 v_mfma_f32_16x16x32_bf16 v[108:111], a[116:119], v[44:47], v[108:111]
 v_mfma_f32_16x16x32_bf16 v[116:119], v[44:47], a[188:191], v[116:119]
 v_mfma_f32_16x16x32_bf16 v[124:127], v[44:47], v[228:231], v[124:127]
 s_waitcnt lgkmcnt(2)
 v_mfma_f32_16x16x32_bf16 v[96:99], a[48:51], v[48:51], v[96:99]
 ds_read_b128 v[32:35], v6 offset:28672
 v_mfma_f32_16x16x32_bf16 v[104:107], a[120:123], v[48:51], v[104:107]
 ds_read_b128 v[36:39], v6 offset:30720
 v_mfma_f32_16x16x32_bf16 v[112:115], v[48:51], a[192:195], v[112:115]
 v_mfma_f32_16x16x32_bf16 v[120:123], v[48:51], v[232:235], v[120:123]
 v_mfma_f32_16x16x32_bf16 v[100:103], a[48:51], v[52:55], v[100:103]
 v_mfma_f32_16x16x32_bf16 v[108:111], a[120:123], v[52:55], v[108:111]
 v_mfma_f32_16x16x32_bf16 v[116:119], v[52:55], a[192:195], v[116:119]
 v_mfma_f32_16x16x32_bf16 v[124:127], v[52:55], v[232:235], v[124:127]
 s_waitcnt lgkmcnt(2)
 v_mfma_f32_16x16x32_bf16 v[96:99], a[52:55], v[56:59], v[96:99]
 ds_read_b128 v[40:43], v7 offset:28672
 v_mfma_f32_16x16x32_bf16 v[104:107], a[124:127], v[56:59], v[104:107]
 ds_read_b128 v[44:47], v7 offset:30720
 v_mfma_f32_16x16x32_bf16 v[112:115], v[56:59], a[196:199], v[112:115]
 s_add_u32 s43, s43, 36864
 s_cmp_eq_u32 s43, 147456
 v_mfma_f32_16x16x32_bf16 v[120:123], v[56:59], v[236:239], v[120:123]
 s_cselect_b32 s43, 0, s43
 s_add_u32 s44, s44, 36864
 v_mfma_f32_16x16x32_bf16 v[100:103], a[52:55], v[60:63], v[100:103]
 s_cmp_eq_u32 s44, 147456
 s_cselect_b32 s44, 0, s44
 v_mfma_f32_16x16x32_bf16 v[108:111], a[124:127], v[60:63], v[108:111]
 v_mfma_f32_16x16x32_bf16 v[116:119], v[60:63], a[196:199], v[116:119]
 v_mfma_f32_16x16x32_bf16 v[124:127], v[60:63], v[236:239], v[124:127]
 s_waitcnt lgkmcnt(2)
 v_mfma_f32_16x16x32_bf16 v[96:99], a[56:59], v[32:35], v[96:99]
 ds_read_b128 v[48:51], v6 offset:32768
 v_mfma_f32_16x16x32_bf16 v[104:107], a[128:131], v[32:35], v[104:107]
 ds_read_b128 v[52:55], v6 offset:34816
 v_mfma_f32_16x16x32_bf16 v[112:115], v[32:35], a[200:203], v[112:115]
 v_add_u32 v6, s43, v4
 v_mfma_f32_16x16x32_bf16 v[120:123], v[32:35], v[240:243], v[120:123]
 v_mfma_f32_16x16x32_bf16 v[100:103], a[56:59], v[36:39], v[100:103]
 v_mfma_f32_16x16x32_bf16 v[108:111], a[128:131], v[36:39], v[108:111]
 v_mfma_f32_16x16x32_bf16 v[116:119], v[36:39], a[200:203], v[116:119]
 v_mfma_f32_16x16x32_bf16 v[124:127], v[36:39], v[240:243], v[124:127]
 s_waitcnt lgkmcnt(2)
 v_mfma_f32_16x16x32_bf16 v[96:99], a[60:63], v[40:43], v[96:99]
 ds_read_b128 v[56:59], v7 offset:32768
 v_mfma_f32_16x16x32_bf16 v[104:107], a[132:135], v[40:43], v[104:107]
 ds_read_b128 v[60:63], v7 offset:34816
 v_mfma_f32_16x16x32_bf16 v[112:115], v[40:43], a[204:207], v[112:115]
 v_add_u32 v7, s43, v5
 v_mfma_f32_16x16x32_bf16 v[120:123], v[40:43], v[244:247], v[120:123]
 v_mfma_f32_16x16x32_bf16 v[100:103], a[60:63], v[44:47], v[100:103]
 v_mfma_f32_16x16x32_bf16 v[108:111], a[132:135], v[44:47], v[108:111]
 v_mfma_f32_16x16x32_bf16 v[116:119], v[44:47], a[204:207], v[116:119]
 v_mfma_f32_16x16x32_bf16 v[124:127], v[44:47], v[244:247], v[124:127]
 s_waitcnt lgkmcnt(2)
 v_mfma_f32_16x16x32_bf16 v[96:99], a[64:67], v[48:51], v[96:99]
 s_waitcnt vmcnt(9)
 s_barrier
 ds_read_b128 v[32:35], v6 offset:0
 v_mfma_f32_16x16x32_bf16 v[104:107], a[136:139], v[48:51], v[104:107]
 ds_read_b128 v[36:39], v6 offset:2048
 v_mfma_f32_16x16x32_bf16 v[112:115], v[48:51], a[208:211], v[112:115]
 buffer_store_dword v14, v13, s[20:23], 0 offen sc1
 v_mfma_f32_16x16x32_bf16 v[120:123], v[48:51], v[248:251], v[120:123]
 v_mfma_f32_16x16x32_bf16 v[100:103], a[64:67], v[52:55], v[100:103]
 v_mfma_f32_16x16x32_bf16 v[108:111], a[136:139], v[52:55], v[108:111]
 v_mfma_f32_16x16x32_bf16 v[116:119], v[52:55], a[208:211], v[116:119]
 v_mfma_f32_16x16x32_bf16 v[124:127], v[52:55], v[248:251], v[124:127]
 s_waitcnt lgkmcnt(2)
 v_mfma_f32_16x16x32_bf16 v[96:99], a[68:71], v[56:59], v[96:99]
 ds_read_b128 v[40:43], v7 offset:0
 v_mfma_f32_16x16x32_bf16 v[104:107], a[140:143], v[56:59], v[104:107]
 ds_read_b128 v[44:47], v7 offset:2048
 v_mfma_f32_16x16x32_bf16 v[112:115], v[56:59], a[212:215], v[112:115]
 s_mul_i32 s45, s39, 524288
 s_add_u32 s47, s34, s45
 v_mfma_f32_16x16x32_bf16 v[120:123], v[56:59], v[252:255], v[120:123]
 s_add_u32 s48, s35, s45
 v_add_u32 v14, 1, v14
 v_mfma_f32_16x16x32_bf16 v[100:103], a[68:71], v[60:63], v[100:103]
 s_mov_b32 s39, s40
 s_mov_b32 s40, s41
 v_mfma_f32_16x16x32_bf16 v[108:111], a[140:143], v[60:63], v[108:111]
 s_add_u32 s42, s42, 1
 s_cmp_lt_u32 s42, s36
 v_mfma_f32_16x16x32_bf16 v[116:119], v[60:63], a[212:215], v[116:119]
 v_mfma_f32_16x16x32_bf16 v[124:127], v[60:63], v[252:255], v[124:127]
 s_waitcnt lgkmcnt(2)
 s_cbranch_scc1 Lps_loop_18
 s_nop 7
 v_mul_f32 v96, s50, v96
 v_mul_f32 v97, s50, v97
 v_mul_f32 v98, s50, v98
 v_mul_f32 v99, s50, v99
 v_mul_f32 v104, s50, v104
 v_mul_f32 v105, s50, v105
 v_mul_f32 v106, s50, v106
 v_mul_f32 v107, s50, v107
 v_cvt_pk_bf16_f32 v16, v96, v104
 v_cvt_pk_bf16_f32 v17, v97, v105
 v_cvt_pk_bf16_f32 v18, v98, v106
 v_cvt_pk_bf16_f32 v19, v99, v107
 buffer_store_dwordx4 v[16:19], v12, s[20:23], s47 offen offset:0 sc1
 v_mul_f32 v100, s50, v100
 v_mul_f32 v101, s50, v101
 v_mul_f32 v102, s50, v102
 v_mul_f32 v103, s50, v103
 v_mul_f32 v108, s50, v108
 v_mul_f32 v109, s50, v109
 v_mul_f32 v110, s50, v110
 v_mul_f32 v111, s50, v111
 v_cvt_pk_bf16_f32 v20, v100, v108
 v_cvt_pk_bf16_f32 v21, v101, v109
 v_cvt_pk_bf16_f32 v22, v102, v110
 v_cvt_pk_bf16_f32 v23, v103, v111
 buffer_store_dwordx4 v[20:23], v12, s[20:23], s47 offen offset:1024 sc1
 v_cvt_pk_bf16_f32 v24, v112, v113
 v_cvt_pk_bf16_f32 v25, v116, v117
 v_cvt_pk_bf16_f32 v26, v114, v115
 v_cvt_pk_bf16_f32 v27, v118, v119
 buffer_store_dwordx4 v[24:27], v12, s[20:23], s48 offen offset:0 sc1
 v_cvt_pk_bf16_f32 v28, v120, v121
 v_cvt_pk_bf16_f32 v29, v124, v125
 v_cvt_pk_bf16_f32 v30, v122, v123
 v_cvt_pk_bf16_f32 v31, v126, v127
 buffer_store_dwordx4 v[28:31], v12, s[20:23], s48 offen offset:1024 sc1
 s_waitcnt vmcnt(0) lgkmcnt(0)
 s_barrier
 v_mov_b32 v14, s36
 buffer_store_dword v14, v13, s[20:23], 0 offen sc1
 s_branch Lfin
Lqa:
 s_load_dwordx2 s[8:9], s[0:1], 0
 s_mov_b32 s10, 0x240000
 s_mov_b32 s11, 0x20000
 s_load_dwordx2 s[12:13], s[0:1], 16
 s_mov_b32 s14, 0x480000
 s_mov_b32 s15, 0x20000
 s_load_dwordx2 s[16:17], s[0:1], 16
 s_mov_b32 s18, 0x480000
 s_mov_b32 s19, 0x20000
 s_cmp_eq_u32 s2, 255
 s_cbranch_scc0 Lqa1
 v_mov_b32 v4, 0
 v_mov_b32 v5, 0
 v_mov_b32 v6, 0
 v_mov_b32 v7, 0
 v_lshlrev_b32 v1, 4, v0
 s_mov_b32 s7, 0
 buffer_store_dwordx4 v[4:7], v1, s[20:23], s7 offen sc1
 s_mov_b32 s7, 4096
 buffer_store_dwordx4 v[4:7], v1, s[20:23], s7 offen sc1
 s_mov_b32 s7, 8192
 buffer_store_dwordx4 v[4:7], v1, s[20:23], s7 offen sc1
 s_mov_b32 s7, 12288
 buffer_store_dwordx4 v[4:7], v1, s[20:23], s7 offen sc1
 s_mov_b32 s7, 16384
 buffer_store_dwordx4 v[4:7], v1, s[20:23], s7 offen sc1
 v_min_u32 v1, 1, v0
 v_lshlrev_b32 v1, 28, v1
 v_mov_b32 v2, 1
 s_waitcnt vmcnt(0)
 s_barrier
 buffer_store_dword v2, v1, s[28:31], 0 offen sc1
Lqa1:
 s_sub_u32 s3, s5, 2
 s_lshl_b32 s3, s3, 3
 s_lshr_b32 s7, s6, 2
 s_add_u32 s3, s3, s7
 s_lshl_b32 s32, s3, 9
 s_add_u32 s33, s32, 256
 s_lshl_b32 s34, s3, 14
 s_add_u32 s34, s34, 0x5000000
 s_add_u32 s35, s34, 8192
 s_mov_b32 s36, 16
 s_and_b32 s37, s6, 3
 s_lshl_b32 s7, s3, 5
 s_add_u32 s7, s7, s37
 s_lshl_b32 s7, s7, 2
 s_add_u32 s7, s7, 0x3000
 v_min_u32 v1, 1, v0
 v_lshlrev_b32 v1, 28, v1
 v_add_u32 v13, s7, v1
 s_waitcnt lgkmcnt(0)
 v_and_b32 v1, 63, v0
 v_lshrrev_b32 v2, 3, v0
 v_mul_u32_u24 v10, 1152, v2
 v_lshrrev_b32 v2, 4, v0
 v_xor_b32 v2, v2, v0
 v_and_b32 v2, 7, v2
 v_lshl_add_u32 v10, v2, 4, v10
 v_lshrrev_b32 v2, 4, v1
 v_bfe_u32 v3, v1, 1, 3
 v_xor_b32 v2, v2, v3
 v_and_b32 v3, 15, v1
 v_lshlrev_b32 v3, 7, v3
 v_lshl_add_u32 v4, v2, 4, v3
 v_xor_b32 v5, 64, v4
 v_lshrrev_b32 v2, 4, v0
 v_lshlrev_b32 v11, 13, v2
 v_lshrrev_b32 v2, 7, v0
 v_lshrrev_b32 v3, 4, v1
 v_lshl_add_u32 v3, v2, 2, v3
 v_bfe_u32 v2, v1, 1, 3
 v_xor_b32 v2, v2, v3
 v_lshl_add_u32 v11, v2, 5, v11
 v_and_b32 v2, 1, v1
 v_lshl_add_u32 v11, v2, 4, v11
 v_bfe_u32 v2, v1, 2, 3
 v_xor_b32 v3, s4, v2
 v_lshlrev_b32 v3, 5, v3
 v_and_b32 v2, 3, v2
 v_lshl_add_u32 v3, v2, 8, v3
 v_lshrrev_b32 v2, 4, v1
 v_lshl_add_u32 v3, v2, 11, v3
 v_and_b32 v2, 3, v1
 v_lshl_add_u32 v3, v2, 3, v3
 v_add_u32 v8, 73728, v3
 v_xor_b32 v3, 0x80, v3
 v_add_u32 v9, 73728, v3
 s_lshl_b32 s45, s4, 11
 v_lshl_add_u32 v12, v1, 4, s45
 s_mov_b32 s39, s37
 s_add_u32 s40, s39, 4
 s_lshl_b32 s49, s4, 10
 s_mul_i32 s46, s39, 36864
 s_add_u32 m0, s49, 0
 s_nop 0
 buffer_load_dwordx4 v10, s[8:11], s46 offen offset:0  lds
 s_add_u32 m0, s49, 3968
 s_nop 0
 buffer_load_dwordx4 v10, s[8:11], s46 offen offset:128  lds
 s_add_u32 m0, s49, 7936
 s_nop 0
 buffer_load_dwordx4 v10, s[8:11], s46 offen offset:256  lds
 s_add_u32 m0, s49, 11904
 s_nop 0
 buffer_load_dwordx4 v10, s[8:11], s46 offen offset:384  lds
 s_add_u32 m0, s49, 15872
 s_nop 0
 buffer_load_dwordx4 v10, s[8:11], s46 offen offset:512  lds
 s_add_u32 m0, s49, 19840
 s_nop 0
 buffer_load_dwordx4 v10, s[8:11], s46 offen offset:640  lds
 s_add_u32 m0, s49, 23808
 s_nop 0
 buffer_load_dwordx4 v10, s[8:11], s46 offen offset:768  lds
 s_add_u32 m0, s49, 27776
 s_nop 0
 buffer_load_dwordx4 v10, s[8:11], s46 offen offset:896  lds
 s_add_u32 m0, s49, 31744
 s_nop 0
 buffer_load_dwordx4 v10, s[8:11], s46 offen offset:1024  lds
 s_lshl_b32 s49, s4, 10
 s_add_u32 s49, s49, 36864
 s_mul_i32 s46, s40, 36864
 s_add_u32 m0, s49, 0
 s_nop 0
 buffer_load_dwordx4 v10, s[8:11], s46 offen offset:0  lds
 s_add_u32 m0, s49, 3968
 s_nop 0
 buffer_load_dwordx4 v10, s[8:11], s46 offen offset:128  lds
 s_add_u32 m0, s49, 7936
 s_nop 0
 buffer_load_dwordx4 v10, s[8:11], s46 offen offset:256  lds
 s_add_u32 m0, s49, 11904
 s_nop 0
 buffer_load_dwordx4 v10, s[8:11], s46 offen offset:384  lds
 s_add_u32 m0, s49, 15872
 s_nop 0
 buffer_load_dwordx4 v10, s[8:11], s46 offen offset:512  lds
 s_add_u32 m0, s49, 19840
 s_nop 0
 buffer_load_dwordx4 v10, s[8:11], s46 offen offset:640  lds
 s_add_u32 m0, s49, 23808
 s_nop 0
 buffer_load_dwordx4 v10, s[8:11], s46 offen offset:768  lds
 s_add_u32 m0, s49, 27776
 s_nop 0
 buffer_load_dwordx4 v10, s[8:11], s46 offen offset:896  lds
 s_add_u32 m0, s49, 31744
 s_nop 0
 buffer_load_dwordx4 v10, s[8:11], s46 offen offset:1024  lds
 s_lshl_b32 s49, s4, 10
 s_add_u32 m0, s49, 73728
 s_add_u32 s45, s32, 0
 buffer_load_dwordx4 v11, s[12:15], s45 offen  lds
 s_add_u32 m0, s49, 77824
 s_add_u32 s45, s32, 131072
 buffer_load_dwordx4 v11, s[12:15], s45 offen  lds
 s_add_u32 m0, s49, 81920
 s_add_u32 s45, s33, 0
 buffer_load_dwordx4 v11, s[16:19], s45 offen  lds
 s_add_u32 m0, s49, 86016
 s_add_u32 s45, s33, 131072
 buffer_load_dwordx4 v11, s[16:19], s45 offen  lds
 s_add_u32 m0, s49, 90112
 s_add_u32 s45, s32, 262144
 buffer_load_dwordx4 v11, s[12:15], s45 offen  lds
 s_add_u32 m0, s49, 94208
 s_add_u32 s45, s32, 393216
 buffer_load_dwordx4 v11, s[12:15], s45 offen  lds
 s_add_u32 m0, s49, 98304
 s_add_u32 s45, s33, 262144
 buffer_load_dwordx4 v11, s[16:19], s45 offen  lds
 s_add_u32 m0, s49, 102400
 s_add_u32 s45, s33, 393216
 buffer_load_dwordx4 v11, s[16:19], s45 offen  lds
 s_add_u32 m0, s49, 106496
 s_add_u32 s45, s32, 524288
 buffer_load_dwordx4 v11, s[12:15], s45 offen  lds
 s_add_u32 m0, s49, 110592
 s_add_u32 s45, s32, 655360
 buffer_load_dwordx4 v11, s[12:15], s45 offen  lds
 s_add_u32 m0, s49, 114688
 s_add_u32 s45, s33, 524288
 buffer_load_dwordx4 v11, s[16:19], s45 offen  lds
 s_add_u32 m0, s49, 118784
 s_add_u32 s45, s33, 655360
 buffer_load_dwordx4 v11, s[16:19], s45 offen  lds
 s_waitcnt vmcnt(8) lgkmcnt(0)
 s_barrier
 s_add_u32 m0, s49, 122880
 s_add_u32 s45, s32, 786432
 buffer_load_dwordx4 v11, s[12:15], s45 offen  lds
 s_add_u32 m0, s49, 126976
 s_add_u32 s45, s32, 917504
 buffer_load_dwordx4 v11, s[12:15], s45 offen  lds
 s_add_u32 m0, s49, 131072
 s_add_u32 s45, s33, 786432
 buffer_load_dwordx4 v11, s[16:19], s45 offen  lds
 s_add_u32 m0, s49, 135168
 s_add_u32 s45, s33, 917504
 buffer_load_dwordx4 v11, s[16:19], s45 offen  lds
 ds_read_b64_tr_b16 a[0:1], v8 offset:0
 ds_read_b64_tr_b16 a[2:3], v8 offset:1024
 ds_read_b64_tr_b16 a[72:73], v9 offset:0
 ds_read_b64_tr_b16 a[74:75], v9 offset:1024
 ds_read_b64_tr_b16 a[144:145], v8 offset:8192
 ds_read_b64_tr_b16 a[146:147], v8 offset:9216
 ds_read_b64_tr_b16 a[216:217], v9 offset:8192
 ds_read_b64_tr_b16 a[218:219], v9 offset:9216
 s_waitcnt vmcnt(8) lgkmcnt(0)
 s_barrier
 s_add_u32 m0, s49, 73728
 s_add_u32 s45, s32, 1048576
 buffer_load_dwordx4 v11, s[12:15], s45 offen  lds
 s_add_u32 m0, s49, 77824
 s_add_u32 s45, s32, 1179648
 buffer_load_dwordx4 v11, s[12:15], s45 offen  lds
 s_add_u32 m0, s49, 81920
 s_add_u32 s45, s33, 1048576
 buffer_load_dwordx4 v11, s[16:19], s45 offen  lds
 s_add_u32 m0, s49, 86016
 s_add_u32 s45, s33, 1179648
 buffer_load_dwordx4 v11, s[16:19], s45 offen  lds
 ds_read_b64_tr_b16 a[4:5], v8 offset:16384
 ds_read_b64_tr_b16 a[6:7], v8 offset:17408
 ds_read_b64_tr_b16 a[76:77], v9 offset:16384
 ds_read_b64_tr_b16 a[78:79], v9 offset:17408
 ds_read_b64_tr_b16 a[148:149], v8 offset:24576
 ds_read_b64_tr_b16 a[150:151], v8 offset:25600
 ds_read_b64_tr_b16 a[220:221], v9 offset:24576
 ds_read_b64_tr_b16 a[222:223], v9 offset:25600
 s_waitcnt vmcnt(8) lgkmcnt(0)
 s_barrier
 s_add_u32 m0, s49, 90112
 s_add_u32 s45, s32, 1310720
 buffer_load_dwordx4 v11, s[12:15], s45 offen  lds
 s_add_u32 m0, s49, 94208
 s_add_u32 s45, s32, 1441792
 buffer_load_dwordx4 v11, s[12:15], s45 offen  lds
 s_add_u32 m0, s49, 98304
 s_add_u32 s45, s33, 1310720
 buffer_load_dwordx4 v11, s[16:19], s45 offen  lds
 s_add_u32 m0, s49, 102400
 s_add_u32 s45, s33, 1441792
 buffer_load_dwordx4 v11, s[16:19], s45 offen  lds
 ds_read_b64_tr_b16 a[8:9], v8 offset:32768
 ds_read_b64_tr_b16 a[10:11], v8 offset:33792
 ds_read_b64_tr_b16 a[80:81], v9 offset:32768
 ds_read_b64_tr_b16 a[82:83], v9 offset:33792
 ds_read_b64_tr_b16 a[152:153], v8 offset:40960
 ds_read_b64_tr_b16 a[154:155], v8 offset:41984
 ds_read_b64_tr_b16 a[224:225], v9 offset:40960
 ds_read_b64_tr_b16 a[226:227], v9 offset:41984
 s_waitcnt vmcnt(8) lgkmcnt(0)
 s_barrier
 s_add_u32 m0, s49, 106496
 s_add_u32 s45, s32, 1572864
 buffer_load_dwordx4 v11, s[12:15], s45 offen  lds
 s_add_u32 m0, s49, 110592
 s_add_u32 s45, s32, 1703936
 buffer_load_dwordx4 v11, s[12:15], s45 offen  lds
 s_add_u32 m0, s49, 114688
 s_add_u32 s45, s33, 1572864
 buffer_load_dwordx4 v11, s[16:19], s45 offen  lds
 s_add_u32 m0, s49, 118784
 s_add_u32 s45, s33, 1703936
 buffer_load_dwordx4 v11, s[16:19], s45 offen  lds
 ds_read_b64_tr_b16 a[12:13], v8 offset:49152
 ds_read_b64_tr_b16 a[14:15], v8 offset:50176
 ds_read_b64_tr_b16 a[84:85], v9 offset:49152
 ds_read_b64_tr_b16 a[86:87], v9 offset:50176
 ds_read_b64_tr_b16 a[156:157], v8 offset:57344
 ds_read_b64_tr_b16 a[158:159], v8 offset:58368
 ds_read_b64_tr_b16 a[228:229], v9 offset:57344
 ds_read_b64_tr_b16 a[230:231], v9 offset:58368
 s_waitcnt vmcnt(8) lgkmcnt(0)
 s_barrier
 s_add_u32 m0, s49, 122880
 s_add_u32 s45, s32, 1835008
 buffer_load_dwordx4 v11, s[12:15], s45 offen  lds
 s_add_u32 m0, s49, 126976
 s_add_u32 s45, s32, 1966080
 buffer_load_dwordx4 v11, s[12:15], s45 offen  lds
 s_add_u32 m0, s49, 131072
 s_add_u32 s45, s33, 1835008
 buffer_load_dwordx4 v11, s[16:19], s45 offen  lds
 s_add_u32 m0, s49, 135168
 s_add_u32 s45, s33, 1966080
 buffer_load_dwordx4 v11, s[16:19], s45 offen  lds
 ds_read_b64_tr_b16 a[16:17], v8 offset:0
 ds_read_b64_tr_b16 a[18:19], v8 offset:1024
 ds_read_b64_tr_b16 a[88:89], v9 offset:0
 ds_read_b64_tr_b16 a[90:91], v9 offset:1024
 ds_read_b64_tr_b16 a[160:161], v8 offset:8192
 ds_read_b64_tr_b16 a[162:163], v8 offset:9216
 ds_read_b64_tr_b16 a[232:233], v9 offset:8192
 ds_read_b64_tr_b16 a[234:235], v9 offset:9216
 s_waitcnt vmcnt(8) lgkmcnt(0)
 s_barrier
 s_add_u32 m0, s49, 73728
 s_add_u32 s45, s32, 2097152
 buffer_load_dwordx4 v11, s[12:15], s45 offen  lds
 s_add_u32 m0, s49, 77824
 s_add_u32 s45, s32, 2228224
 buffer_load_dwordx4 v11, s[12:15], s45 offen  lds
 s_add_u32 m0, s49, 81920
 s_add_u32 s45, s33, 2097152
 buffer_load_dwordx4 v11, s[16:19], s45 offen  lds
 s_add_u32 m0, s49, 86016
 s_add_u32 s45, s33, 2228224
 buffer_load_dwordx4 v11, s[16:19], s45 offen  lds
 ds_read_b64_tr_b16 a[20:21], v8 offset:16384
 ds_read_b64_tr_b16 a[22:23], v8 offset:17408
 ds_read_b64_tr_b16 a[92:93], v9 offset:16384
 ds_read_b64_tr_b16 a[94:95], v9 offset:17408
 ds_read_b64_tr_b16 a[164:165], v8 offset:24576
 ds_read_b64_tr_b16 a[166:167], v8 offset:25600
 ds_read_b64_tr_b16 a[236:237], v9 offset:24576
 ds_read_b64_tr_b16 a[238:239], v9 offset:25600
 s_waitcnt vmcnt(8) lgkmcnt(0)
 s_barrier
 s_add_u32 m0, s49, 90112
 s_add_u32 s45, s32, 2359296
 buffer_load_dwordx4 v11, s[12:15], s45 offen  lds
 s_add_u32 m0, s49, 94208
 s_add_u32 s45, s32, 2490368
 buffer_load_dwordx4 v11, s[12:15], s45 offen  lds
 s_add_u32 m0, s49, 98304
 s_add_u32 s45, s33, 2359296
 buffer_load_dwordx4 v11, s[16:19], s45 offen  lds
 s_add_u32 m0, s49, 102400
 s_add_u32 s45, s33, 2490368
 buffer_load_dwordx4 v11, s[16:19], s45 offen  lds
 ds_read_b64_tr_b16 a[24:25], v8 offset:32768
 ds_read_b64_tr_b16 a[26:27], v8 offset:33792
 ds_read_b64_tr_b16 a[96:97], v9 offset:32768
 ds_read_b64_tr_b16 a[98:99], v9 offset:33792
 ds_read_b64_tr_b16 a[168:169], v8 offset:40960
 ds_read_b64_tr_b16 a[170:171], v8 offset:41984
 ds_read_b64_tr_b16 a[240:241], v9 offset:40960
 ds_read_b64_tr_b16 a[242:243], v9 offset:41984
 s_waitcnt vmcnt(8) lgkmcnt(0)
 s_barrier
 s_add_u32 m0, s49, 106496
 s_add_u32 s45, s32, 2621440
 buffer_load_dwordx4 v11, s[12:15], s45 offen  lds
 s_add_u32 m0, s49, 110592
 s_add_u32 s45, s32, 2752512
 buffer_load_dwordx4 v11, s[12:15], s45 offen  lds
 s_add_u32 m0, s49, 114688
 s_add_u32 s45, s33, 2621440
 buffer_load_dwordx4 v11, s[16:19], s45 offen  lds
 s_add_u32 m0, s49, 118784
 s_add_u32 s45, s33, 2752512
 buffer_load_dwordx4 v11, s[16:19], s45 offen  lds
 ds_read_b64_tr_b16 a[28:29], v8 offset:49152
 ds_read_b64_tr_b16 a[30:31], v8 offset:50176
 ds_read_b64_tr_b16 a[100:101], v9 offset:49152
 ds_read_b64_tr_b16 a[102:103], v9 offset:50176
 ds_read_b64_tr_b16 a[172:173], v8 offset:57344
 ds_read_b64_tr_b16 a[174:175], v8 offset:58368
 ds_read_b64_tr_b16 a[244:245], v9 offset:57344
 ds_read_b64_tr_b16 a[246:247], v9 offset:58368
 s_waitcnt vmcnt(8) lgkmcnt(0)
 s_barrier
 s_add_u32 m0, s49, 122880
 s_add_u32 s45, s32, 2883584
 buffer_load_dwordx4 v11, s[12:15], s45 offen  lds
 s_add_u32 m0, s49, 126976
 s_add_u32 s45, s32, 3014656
 buffer_load_dwordx4 v11, s[12:15], s45 offen  lds
 s_add_u32 m0, s49, 131072
 s_add_u32 s45, s33, 2883584
 buffer_load_dwordx4 v11, s[16:19], s45 offen  lds
 s_add_u32 m0, s49, 135168
 s_add_u32 s45, s33, 3014656
 buffer_load_dwordx4 v11, s[16:19], s45 offen  lds
 ds_read_b64_tr_b16 a[32:33], v8 offset:0
 ds_read_b64_tr_b16 a[34:35], v8 offset:1024
 ds_read_b64_tr_b16 a[104:105], v9 offset:0
 ds_read_b64_tr_b16 a[106:107], v9 offset:1024
 ds_read_b64_tr_b16 a[176:177], v8 offset:8192
 ds_read_b64_tr_b16 a[178:179], v8 offset:9216
 ds_read_b64_tr_b16 a[248:249], v9 offset:8192
 ds_read_b64_tr_b16 a[250:251], v9 offset:9216
 s_waitcnt vmcnt(8) lgkmcnt(0)
 s_barrier
 s_add_u32 m0, s49, 73728
 s_add_u32 s45, s32, 3145728
 buffer_load_dwordx4 v11, s[12:15], s45 offen  lds
 s_add_u32 m0, s49, 77824
 s_add_u32 s45, s32, 3276800
 buffer_load_dwordx4 v11, s[12:15], s45 offen  lds
 s_add_u32 m0, s49, 81920
 s_add_u32 s45, s33, 3145728
 buffer_load_dwordx4 v11, s[16:19], s45 offen  lds
 s_add_u32 m0, s49, 86016
 s_add_u32 s45, s33, 3276800
 buffer_load_dwordx4 v11, s[16:19], s45 offen  lds
 ds_read_b64_tr_b16 a[36:37], v8 offset:16384
 ds_read_b64_tr_b16 a[38:39], v8 offset:17408
 ds_read_b64_tr_b16 a[108:109], v9 offset:16384
 ds_read_b64_tr_b16 a[110:111], v9 offset:17408
 ds_read_b64_tr_b16 a[180:181], v8 offset:24576
 ds_read_b64_tr_b16 a[182:183], v8 offset:25600
 ds_read_b64_tr_b16 a[252:253], v9 offset:24576
 ds_read_b64_tr_b16 a[254:255], v9 offset:25600
 s_waitcnt vmcnt(8) lgkmcnt(0)
 s_barrier
 s_add_u32 m0, s49, 90112
 s_add_u32 s45, s32, 3407872
 buffer_load_dwordx4 v11, s[12:15], s45 offen  lds
 s_add_u32 m0, s49, 94208
 s_add_u32 s45, s32, 3538944
 buffer_load_dwordx4 v11, s[12:15], s45 offen  lds
 s_add_u32 m0, s49, 98304
 s_add_u32 s45, s33, 3407872
 buffer_load_dwordx4 v11, s[16:19], s45 offen  lds
 s_add_u32 m0, s49, 102400
 s_add_u32 s45, s33, 3538944
 buffer_load_dwordx4 v11, s[16:19], s45 offen  lds
 ds_read_b64_tr_b16 a[40:41], v8 offset:32768
 ds_read_b64_tr_b16 a[42:43], v8 offset:33792
 ds_read_b64_tr_b16 a[112:113], v9 offset:32768
 ds_read_b64_tr_b16 a[114:115], v9 offset:33792
 ds_read_b64_tr_b16 a[184:185], v8 offset:40960
 ds_read_b64_tr_b16 a[186:187], v8 offset:41984
 ds_read_b64_tr_b16 v[224:225], v9 offset:40960
 ds_read_b64_tr_b16 v[226:227], v9 offset:41984
 s_waitcnt vmcnt(8) lgkmcnt(0)
 s_barrier
 s_add_u32 m0, s49, 106496
 s_add_u32 s45, s32, 3670016
 buffer_load_dwordx4 v11, s[12:15], s45 offen  lds
 s_add_u32 m0, s49, 110592
 s_add_u32 s45, s32, 3801088
 buffer_load_dwordx4 v11, s[12:15], s45 offen  lds
 s_add_u32 m0, s49, 114688
 s_add_u32 s45, s33, 3670016
 buffer_load_dwordx4 v11, s[16:19], s45 offen  lds
 s_add_u32 m0, s49, 118784
 s_add_u32 s45, s33, 3801088
 buffer_load_dwordx4 v11, s[16:19], s45 offen  lds
 ds_read_b64_tr_b16 a[44:45], v8 offset:49152
 ds_read_b64_tr_b16 a[46:47], v8 offset:50176
 ds_read_b64_tr_b16 a[116:117], v9 offset:49152
 ds_read_b64_tr_b16 a[118:119], v9 offset:50176
 ds_read_b64_tr_b16 a[188:189], v8 offset:57344
 ds_read_b64_tr_b16 a[190:191], v8 offset:58368
 ds_read_b64_tr_b16 v[228:229], v9 offset:57344
 ds_read_b64_tr_b16 v[230:231], v9 offset:58368
 s_waitcnt vmcnt(8) lgkmcnt(0)
 s_barrier
 s_add_u32 m0, s49, 122880
 s_add_u32 s45, s32, 3932160
 buffer_load_dwordx4 v11, s[12:15], s45 offen  lds
 s_add_u32 m0, s49, 126976
 s_add_u32 s45, s32, 4063232
 buffer_load_dwordx4 v11, s[12:15], s45 offen  lds
 s_add_u32 m0, s49, 131072
 s_add_u32 s45, s33, 3932160
 buffer_load_dwordx4 v11, s[16:19], s45 offen  lds
 s_add_u32 m0, s49, 135168
 s_add_u32 s45, s33, 4063232
 buffer_load_dwordx4 v11, s[16:19], s45 offen  lds
 ds_read_b64_tr_b16 a[48:49], v8 offset:0
 ds_read_b64_tr_b16 a[50:51], v8 offset:1024
 ds_read_b64_tr_b16 a[120:121], v9 offset:0
 ds_read_b64_tr_b16 a[122:123], v9 offset:1024
 ds_read_b64_tr_b16 a[192:193], v8 offset:8192
 ds_read_b64_tr_b16 a[194:195], v8 offset:9216
 ds_read_b64_tr_b16 v[232:233], v9 offset:8192
 ds_read_b64_tr_b16 v[234:235], v9 offset:9216
 s_waitcnt vmcnt(8) lgkmcnt(0)
 s_barrier
 s_add_u32 m0, s49, 73728
 s_add_u32 s45, s32, 4194304
 buffer_load_dwordx4 v11, s[12:15], s45 offen  lds
 s_add_u32 m0, s49, 77824
 s_add_u32 s45, s32, 4325376
 buffer_load_dwordx4 v11, s[12:15], s45 offen  lds
 s_add_u32 m0, s49, 81920
 s_add_u32 s45, s33, 4194304
 buffer_load_dwordx4 v11, s[16:19], s45 offen  lds
 s_add_u32 m0, s49, 86016
 s_add_u32 s45, s33, 4325376
 buffer_load_dwordx4 v11, s[16:19], s45 offen  lds
 ds_read_b64_tr_b16 a[52:53], v8 offset:16384
 ds_read_b64_tr_b16 a[54:55], v8 offset:17408
 ds_read_b64_tr_b16 a[124:125], v9 offset:16384
 ds_read_b64_tr_b16 a[126:127], v9 offset:17408
 ds_read_b64_tr_b16 a[196:197], v8 offset:24576
 ds_read_b64_tr_b16 a[198:199], v8 offset:25600
 ds_read_b64_tr_b16 v[236:237], v9 offset:24576
 ds_read_b64_tr_b16 v[238:239], v9 offset:25600
 s_waitcnt vmcnt(8) lgkmcnt(0)
 s_barrier
 s_add_u32 m0, s49, 90112
 s_add_u32 s45, s32, 4456448
 buffer_load_dwordx4 v11, s[12:15], s45 offen  lds
 s_add_u32 m0, s49, 94208
 s_add_u32 s45, s32, 4587520
 buffer_load_dwordx4 v11, s[12:15], s45 offen  lds
 s_add_u32 m0, s49, 98304
 s_add_u32 s45, s33, 4456448
 buffer_load_dwordx4 v11, s[16:19], s45 offen  lds
 s_add_u32 m0, s49, 102400
 s_add_u32 s45, s33, 4587520
 buffer_load_dwordx4 v11, s[16:19], s45 offen  lds
 ds_read_b64_tr_b16 a[56:57], v8 offset:32768
 ds_read_b64_tr_b16 a[58:59], v8 offset:33792
 ds_read_b64_tr_b16 a[128:129], v9 offset:32768
 ds_read_b64_tr_b16 a[130:131], v9 offset:33792
 ds_read_b64_tr_b16 a[200:201], v8 offset:40960
 ds_read_b64_tr_b16 a[202:203], v8 offset:41984
 ds_read_b64_tr_b16 v[240:241], v9 offset:40960
 ds_read_b64_tr_b16 v[242:243], v9 offset:41984
 s_waitcnt vmcnt(8) lgkmcnt(0)
 s_barrier
 ds_read_b64_tr_b16 a[60:61], v8 offset:49152
 ds_read_b64_tr_b16 a[62:63], v8 offset:50176
 ds_read_b64_tr_b16 a[132:133], v9 offset:49152
 ds_read_b64_tr_b16 a[134:135], v9 offset:50176
 ds_read_b64_tr_b16 a[204:205], v8 offset:57344
 ds_read_b64_tr_b16 a[206:207], v8 offset:58368
 ds_read_b64_tr_b16 v[244:245], v9 offset:57344
 ds_read_b64_tr_b16 v[246:247], v9 offset:58368
 s_waitcnt vmcnt(4) lgkmcnt(0)
 s_barrier
 ds_read_b64_tr_b16 a[64:65], v8 offset:0
 ds_read_b64_tr_b16 a[66:67], v8 offset:1024
 ds_read_b64_tr_b16 a[136:137], v9 offset:0
 ds_read_b64_tr_b16 a[138:139], v9 offset:1024
 ds_read_b64_tr_b16 a[208:209], v8 offset:8192
 ds_read_b64_tr_b16 a[210:211], v8 offset:9216
 ds_read_b64_tr_b16 v[248:249], v9 offset:8192
 ds_read_b64_tr_b16 v[250:251], v9 offset:9216
 s_waitcnt vmcnt(0) lgkmcnt(0)
 s_barrier
 ds_read_b64_tr_b16 a[68:69], v8 offset:16384
 ds_read_b64_tr_b16 a[70:71], v8 offset:17408
 ds_read_b64_tr_b16 a[140:141], v9 offset:16384
 ds_read_b64_tr_b16 a[142:143], v9 offset:17408
 ds_read_b64_tr_b16 a[212:213], v8 offset:24576
 ds_read_b64_tr_b16 a[214:215], v8 offset:25600
 ds_read_b64_tr_b16 v[252:253], v9 offset:24576
 ds_read_b64_tr_b16 v[254:255], v9 offset:25600
 s_mov_b32 s50, 0x3e0293ee
 s_mov_b32 s42, 0
 s_mov_b32 s43, 0
 s_mov_b32 s44, 73728
 v_mov_b32 v6, v4
 v_mov_b32 v7, v5
 s_mov_b32 s95, 0x40000
 s_cmp_lg_u32 s4, 0
 s_cbranch_scc1 Lfrk_20
 v_min_u32 v21, 1, v0
 v_lshlrev_b32 v21, 28, v21
Lfr_19:
 buffer_load_dword v20, v21, s[28:31], 0 offen offset:128 sc1
 s_waitcnt vmcnt(0)
 v_cmp_eq_u32 vcc, 1, v20
 s_cbranch_vccnz Lfrk_20
 s_sleep 12
 s_sub_u32 s95, s95, 1
 s_cbranch_scc0 Lfr_19
 s_endpgm
Lfrk_20:
 s_lshl_b32 s47, s2, 13
 s_add_u32 s47, s47, 0x8000000
 s_mov_b32 s48, s47
 v_mov_b32 v14, 0
 s_waitcnt vmcnt(0) lgkmcnt(0)
 s_barrier
 ds_read_b128 v[32:35], v6 offset:0
 ds_read_b128 v[36:39], v6 offset:2048
 ds_read_b128 v[40:43], v7 offset:0
 ds_read_b128 v[44:47], v7 offset:2048
 v_lshlrev_b32 v1, 12, v0
 s_lshl_b32 s45, s6, 7
 buffer_load_dword v15, v1, s[8:11], s45 offen
 v_add_u32 v1, 0x100000, v1
 buffer_load_dword v15, v1, s[8:11], s45 offen
 v_add_u32 v1, 0x100000, v1
 buffer_load_dword v15, v1, s[8:11], s45 offen
 v_add_u32 v1, 0x100000, v1
 s_waitcnt lgkmcnt(2)
Lps_loop_21:
 v_mfma_f32_16x16x32_bf16 v[64:67], a[0:3], v[32:35], 0
 ds_read_b128 v[48:51], v6 offset:4096
 v_mfma_f32_16x16x32_bf16 v[72:75], a[72:75], v[32:35], 0
 ds_read_b128 v[52:55], v6 offset:6144
 v_mfma_f32_16x16x32_bf16 v[80:83], a[144:147], v[32:35], 0
 s_add_u32 s41, s40, 4
 v_mfma_f32_16x16x32_bf16 v[88:91], a[216:219], v[32:35], 0
 s_add_u32 s45, s42, 2
 s_mul_i32 s46, s41, 36864
 v_mfma_f32_16x16x32_bf16 v[68:71], a[0:3], v[36:39], 0
 s_cmp_lt_u32 s45, s36
 s_cselect_b32 s46, s46, 0
 v_mfma_f32_16x16x32_bf16 v[76:79], a[72:75], v[36:39], 0
 s_lshl_b32 s49, s4, 10
 s_add_u32 s49, s49, s44
 v_mfma_f32_16x16x32_bf16 v[84:87], a[144:147], v[36:39], 0
 v_mfma_f32_16x16x32_bf16 v[92:95], a[216:219], v[36:39], 0
 s_waitcnt lgkmcnt(2)
 v_mfma_f32_16x16x32_bf16 v[64:67], a[4:7], v[40:43], v[64:67]
 ds_read_b128 v[56:59], v7 offset:4096
 v_mfma_f32_16x16x32_bf16 v[72:75], a[76:79], v[40:43], v[72:75]
 ds_read_b128 v[60:63], v7 offset:6144
 v_mfma_f32_16x16x32_bf16 v[80:83], a[148:151], v[40:43], v[80:83]
 s_add_u32 m0, s49, 0
 v_mfma_f32_16x16x32_bf16 v[88:91], a[220:223], v[40:43], v[88:91]
 buffer_load_dwordx4 v10, s[8:11], s46 offen offset:0  lds
 v_mfma_f32_16x16x32_bf16 v[68:71], a[4:7], v[44:47], v[68:71]
 s_add_u32 m0, s49, 3968
 v_mfma_f32_16x16x32_bf16 v[76:79], a[76:79], v[44:47], v[76:79]
 buffer_load_dwordx4 v10, s[8:11], s46 offen offset:128  lds
 v_mfma_f32_16x16x32_bf16 v[84:87], a[148:151], v[44:47], v[84:87]
 v_mfma_f32_16x16x32_bf16 v[92:95], a[220:223], v[44:47], v[92:95]
 s_waitcnt lgkmcnt(2)
 v_mfma_f32_16x16x32_bf16 v[64:67], a[8:11], v[48:51], v[64:67]
 ds_read_b128 v[32:35], v6 offset:8192
 v_mfma_f32_16x16x32_bf16 v[72:75], a[80:83], v[48:51], v[72:75]
 ds_read_b128 v[36:39], v6 offset:10240
 v_mfma_f32_16x16x32_bf16 v[80:83], a[152:155], v[48:51], v[80:83]
 s_add_u32 m0, s49, 7936
 v_mfma_f32_16x16x32_bf16 v[88:91], a[224:227], v[48:51], v[88:91]
 buffer_load_dwordx4 v10, s[8:11], s46 offen offset:256  lds
 v_mfma_f32_16x16x32_bf16 v[68:71], a[8:11], v[52:55], v[68:71]
 s_add_u32 m0, s49, 11904
 v_mfma_f32_16x16x32_bf16 v[76:79], a[80:83], v[52:55], v[76:79]
 buffer_load_dwordx4 v10, s[8:11], s46 offen offset:384  lds
 v_mfma_f32_16x16x32_bf16 v[84:87], a[152:155], v[52:55], v[84:87]
 v_mfma_f32_16x16x32_bf16 v[92:95], a[224:227], v[52:55], v[92:95]
 s_waitcnt lgkmcnt(2)
 v_mfma_f32_16x16x32_bf16 v[64:67], a[12:15], v[56:59], v[64:67]
 ds_read_b128 v[40:43], v7 offset:8192
 v_mfma_f32_16x16x32_bf16 v[72:75], a[84:87], v[56:59], v[72:75]
 ds_read_b128 v[44:47], v7 offset:10240
 v_mfma_f32_16x16x32_bf16 v[80:83], a[156:159], v[56:59], v[80:83]
 s_add_u32 m0, s49, 15872
 v_mfma_f32_16x16x32_bf16 v[88:91], a[228:231], v[56:59], v[88:91]
 buffer_load_dwordx4 v10, s[8:11], s46 offen offset:512  lds
 v_mfma_f32_16x16x32_bf16 v[68:71], a[12:15], v[60:63], v[68:71]
 s_add_u32 m0, s49, 19840
 v_mfma_f32_16x16x32_bf16 v[76:79], a[84:87], v[60:63], v[76:79]
 buffer_load_dwordx4 v10, s[8:11], s46 offen offset:640  lds
 v_mfma_f32_16x16x32_bf16 v[84:87], a[156:159], v[60:63], v[84:87]
 v_mfma_f32_16x16x32_bf16 v[92:95], a[228:231], v[60:63], v[92:95]
 s_waitcnt lgkmcnt(2)
 v_mfma_f32_16x16x32_bf16 v[64:67], a[16:19], v[32:35], v[64:67]
 ds_read_b128 v[48:51], v6 offset:12288
 v_mfma_f32_16x16x32_bf16 v[72:75], a[88:91], v[32:35], v[72:75]
 ds_read_b128 v[52:55], v6 offset:14336
 v_mfma_f32_16x16x32_bf16 v[80:83], a[160:163], v[32:35], v[80:83]
 s_add_u32 m0, s49, 23808
 v_mfma_f32_16x16x32_bf16 v[88:91], a[232:235], v[32:35], v[88:91]
 buffer_load_dwordx4 v10, s[8:11], s46 offen offset:768  lds
 v_mfma_f32_16x16x32_bf16 v[68:71], a[16:19], v[36:39], v[68:71]
 s_add_u32 m0, s49, 27776
 v_mfma_f32_16x16x32_bf16 v[76:79], a[88:91], v[36:39], v[76:79]
 buffer_load_dwordx4 v10, s[8:11], s46 offen offset:896  lds
 v_mfma_f32_16x16x32_bf16 v[84:87], a[160:163], v[36:39], v[84:87]
 v_mfma_f32_16x16x32_bf16 v[92:95], a[232:235], v[36:39], v[92:95]
 s_waitcnt lgkmcnt(2)
 v_mfma_f32_16x16x32_bf16 v[64:67], a[20:23], v[40:43], v[64:67]
 ds_read_b128 v[56:59], v7 offset:12288
 v_mfma_f32_16x16x32_bf16 v[72:75], a[92:95], v[40:43], v[72:75]
 ds_read_b128 v[60:63], v7 offset:14336
 v_mfma_f32_16x16x32_bf16 v[80:83], a[164:167], v[40:43], v[80:83]
 s_add_u32 m0, s49, 31744
 v_mfma_f32_16x16x32_bf16 v[88:91], a[236:239], v[40:43], v[88:91]
 buffer_load_dwordx4 v10, s[8:11], s46 offen offset:1024  lds
 v_mfma_f32_16x16x32_bf16 v[68:71], a[20:23], v[44:47], v[68:71]
 v_mfma_f32_16x16x32_bf16 v[76:79], a[92:95], v[44:47], v[76:79]
 v_mfma_f32_16x16x32_bf16 v[84:87], a[164:167], v[44:47], v[84:87]
 v_mfma_f32_16x16x32_bf16 v[92:95], a[236:239], v[44:47], v[92:95]
 s_waitcnt lgkmcnt(2)
 v_mfma_f32_16x16x32_bf16 v[64:67], a[24:27], v[48:51], v[64:67]
 ds_read_b128 v[32:35], v6 offset:16384
 v_mul_f32 v96, s50, v96
 v_mfma_f32_16x16x32_bf16 v[72:75], a[96:99], v[48:51], v[72:75]
 ds_read_b128 v[36:39], v6 offset:18432
 v_mfma_f32_16x16x32_bf16 v[80:83], a[168:171], v[48:51], v[80:83]
 v_mul_f32 v97, s50, v97
 v_mfma_f32_16x16x32_bf16 v[88:91], a[240:243], v[48:51], v[88:91]
 v_mul_f32 v98, s50, v98
 v_mfma_f32_16x16x32_bf16 v[68:71], a[24:27], v[52:55], v[68:71]
 v_mul_f32 v99, s50, v99
 v_mfma_f32_16x16x32_bf16 v[76:79], a[96:99], v[52:55], v[76:79]
 v_mul_f32 v104, s50, v104
 v_mfma_f32_16x16x32_bf16 v[84:87], a[168:171], v[52:55], v[84:87]
 v_mul_f32 v105, s50, v105
 v_mfma_f32_16x16x32_bf16 v[92:95], a[240:243], v[52:55], v[92:95]
 s_waitcnt lgkmcnt(2)
 v_mfma_f32_16x16x32_bf16 v[64:67], a[28:31], v[56:59], v[64:67]
 ds_read_b128 v[40:43], v7 offset:16384
 v_mfma_f32_16x16x32_bf16 v[72:75], a[100:103], v[56:59], v[72:75]
 ds_read_b128 v[44:47], v7 offset:18432
 v_mul_f32 v106, s50, v106
 v_mfma_f32_16x16x32_bf16 v[80:83], a[172:175], v[56:59], v[80:83]
 v_mul_f32 v107, s50, v107
 v_mfma_f32_16x16x32_bf16 v[88:91], a[244:247], v[56:59], v[88:91]
 v_cvt_pk_bf16_f32 v16, v96, v97
 v_mfma_f32_16x16x32_bf16 v[68:71], a[28:31], v[60:63], v[68:71]
 v_mfma_f32_16x16x32_bf16 v[76:79], a[100:103], v[60:63], v[76:79]
 v_cvt_pk_bf16_f32 v17, v104, v105
 v_mfma_f32_16x16x32_bf16 v[84:87], a[172:175], v[60:63], v[84:87]
 v_cvt_pk_bf16_f32 v18, v98, v99
 v_mfma_f32_16x16x32_bf16 v[92:95], a[244:247], v[60:63], v[92:95]
 s_waitcnt lgkmcnt(2)
 v_cvt_pk_bf16_f32 v19, v106, v107
 v_mfma_f32_16x16x32_bf16 v[64:67], a[32:35], v[32:35], v[64:67]
 ds_read_b128 v[48:51], v6 offset:20480
 v_mfma_f32_16x16x32_bf16 v[72:75], a[104:107], v[32:35], v[72:75]
 ds_read_b128 v[52:55], v6 offset:22528
 v_mfma_f32_16x16x32_bf16 v[80:83], a[176:179], v[32:35], v[80:83]
 buffer_store_dwordx4 v[16:19], v12, s[20:23], s47 offen offset:0 sc1
 v_mfma_f32_16x16x32_bf16 v[88:91], a[248:251], v[32:35], v[88:91]
 v_mul_f32 v100, s50, v100
 v_mfma_f32_16x16x32_bf16 v[68:71], a[32:35], v[36:39], v[68:71]
 v_mul_f32 v101, s50, v101
 v_mfma_f32_16x16x32_bf16 v[76:79], a[104:107], v[36:39], v[76:79]
 v_mul_f32 v102, s50, v102
 v_mfma_f32_16x16x32_bf16 v[84:87], a[176:179], v[36:39], v[84:87]
 v_mul_f32 v103, s50, v103
 v_mfma_f32_16x16x32_bf16 v[92:95], a[248:251], v[36:39], v[92:95]
 s_waitcnt lgkmcnt(2)
 v_mfma_f32_16x16x32_bf16 v[64:67], a[36:39], v[40:43], v[64:67]
 ds_read_b128 v[56:59], v7 offset:20480
 v_mul_f32 v108, s50, v108
 v_mfma_f32_16x16x32_bf16 v[72:75], a[108:111], v[40:43], v[72:75]
 ds_read_b128 v[60:63], v7 offset:22528
 v_mfma_f32_16x16x32_bf16 v[80:83], a[180:183], v[40:43], v[80:83]
 v_mul_f32 v109, s50, v109
 v_mfma_f32_16x16x32_bf16 v[88:91], a[252:255], v[40:43], v[88:91]
 v_mul_f32 v110, s50, v110
 v_mfma_f32_16x16x32_bf16 v[68:71], a[36:39], v[44:47], v[68:71]
 v_mul_f32 v111, s50, v111
 v_mfma_f32_16x16x32_bf16 v[76:79], a[108:111], v[44:47], v[76:79]
 v_mfma_f32_16x16x32_bf16 v[84:87], a[180:183], v[44:47], v[84:87]
 v_cvt_pk_bf16_f32 v20, v100, v101
 v_mfma_f32_16x16x32_bf16 v[92:95], a[252:255], v[44:47], v[92:95]
 s_waitcnt lgkmcnt(2)
 v_cvt_pk_bf16_f32 v21, v108, v109
 v_mfma_f32_16x16x32_bf16 v[64:67], a[40:43], v[48:51], v[64:67]
 ds_read_b128 v[32:35], v6 offset:24576
 v_mfma_f32_16x16x32_bf16 v[72:75], a[112:115], v[48:51], v[72:75]
 ds_read_b128 v[36:39], v6 offset:26624
 v_cvt_pk_bf16_f32 v22, v102, v103
 v_mfma_f32_16x16x32_bf16 v[80:83], a[184:187], v[48:51], v[80:83]
 v_mfma_f32_16x16x32_bf16 v[88:91], v[224:227], v[48:51], v[88:91]
 v_cvt_pk_bf16_f32 v23, v110, v111
 v_mfma_f32_16x16x32_bf16 v[68:71], a[40:43], v[52:55], v[68:71]
 buffer_store_dwordx4 v[20:23], v12, s[20:23], s47 offen offset:1024 sc1
 v_mfma_f32_16x16x32_bf16 v[76:79], a[112:115], v[52:55], v[76:79]
 v_mul_f32 v112, s50, v112
 v_mfma_f32_16x16x32_bf16 v[84:87], a[184:187], v[52:55], v[84:87]
 v_mul_f32 v113, s50, v113
 v_mfma_f32_16x16x32_bf16 v[92:95], v[224:227], v[52:55], v[92:95]
 s_waitcnt lgkmcnt(2)
 v_mfma_f32_16x16x32_bf16 v[64:67], a[44:47], v[56:59], v[64:67]
 ds_read_b128 v[40:43], v7 offset:24576
 v_mul_f32 v114, s50, v114
 v_mfma_f32_16x16x32_bf16 v[72:75], a[116:119], v[56:59], v[72:75]
 ds_read_b128 v[44:47], v7 offset:26624
 v_mfma_f32_16x16x32_bf16 v[80:83], a[188:191], v[56:59], v[80:83]
 v_mul_f32 v115, s50, v115
 v_mfma_f32_16x16x32_bf16 v[88:91], v[228:231], v[56:59], v[88:91]
 v_mul_f32 v120, s50, v120
 v_mfma_f32_16x16x32_bf16 v[68:71], a[44:47], v[60:63], v[68:71]
 v_mul_f32 v121, s50, v121
 v_mfma_f32_16x16x32_bf16 v[76:79], a[116:119], v[60:63], v[76:79]
 v_mfma_f32_16x16x32_bf16 v[84:87], a[188:191], v[60:63], v[84:87]
 v_mul_f32 v122, s50, v122
 v_mfma_f32_16x16x32_bf16 v[92:95], v[228:231], v[60:63], v[92:95]
 s_waitcnt lgkmcnt(2)
 v_mul_f32 v123, s50, v123
 v_mfma_f32_16x16x32_bf16 v[64:67], a[48:51], v[32:35], v[64:67]
 ds_read_b128 v[48:51], v6 offset:28672
 v_mfma_f32_16x16x32_bf16 v[72:75], a[120:123], v[32:35], v[72:75]
 ds_read_b128 v[52:55], v6 offset:30720
 v_cvt_pk_bf16_f32 v24, v112, v113
 v_mfma_f32_16x16x32_bf16 v[80:83], a[192:195], v[32:35], v[80:83]
 v_mfma_f32_16x16x32_bf16 v[88:91], v[232:235], v[32:35], v[88:91]
 v_cvt_pk_bf16_f32 v25, v120, v121
 v_mfma_f32_16x16x32_bf16 v[68:71], a[48:51], v[36:39], v[68:71]
 v_cvt_pk_bf16_f32 v26, v114, v115
 v_mfma_f32_16x16x32_bf16 v[76:79], a[120:123], v[36:39], v[76:79]
 v_cvt_pk_bf16_f32 v27, v122, v123
 v_mfma_f32_16x16x32_bf16 v[84:87], a[192:195], v[36:39], v[84:87]
 buffer_store_dwordx4 v[24:27], v12, s[20:23], s48 offen offset:0 sc1
 v_mfma_f32_16x16x32_bf16 v[92:95], v[232:235], v[36:39], v[92:95]
 s_waitcnt lgkmcnt(2)
 v_mfma_f32_16x16x32_bf16 v[64:67], a[52:55], v[40:43], v[64:67]
 ds_read_b128 v[56:59], v7 offset:28672
 v_mul_f32 v116, s50, v116
 v_mfma_f32_16x16x32_bf16 v[72:75], a[124:127], v[40:43], v[72:75]
 ds_read_b128 v[60:63], v7 offset:30720
 v_mfma_f32_16x16x32_bf16 v[80:83], a[196:199], v[40:43], v[80:83]
 s_add_u32 s43, s43, 36864
 s_cmp_eq_u32 s43, 147456
 v_mfma_f32_16x16x32_bf16 v[88:91], v[236:239], v[40:43], v[88:91]
 s_cselect_b32 s43, 0, s43
 s_add_u32 s44, s44, 36864
 v_mfma_f32_16x16x32_bf16 v[68:71], a[52:55], v[44:47], v[68:71]
 s_cmp_eq_u32 s44, 147456
 s_cselect_b32 s44, 0, s44
 v_mfma_f32_16x16x32_bf16 v[76:79], a[124:127], v[44:47], v[76:79]
 v_mul_f32 v117, s50, v117
 v_mfma_f32_16x16x32_bf16 v[84:87], a[196:199], v[44:47], v[84:87]
 v_mul_f32 v118, s50, v118
 v_mfma_f32_16x16x32_bf16 v[92:95], v[236:239], v[44:47], v[92:95]
 s_waitcnt lgkmcnt(2)
 v_mfma_f32_16x16x32_bf16 v[64:67], a[56:59], v[48:51], v[64:67]
 ds_read_b128 v[32:35], v6 offset:32768
 v_mul_f32 v119, s50, v119
 v_mfma_f32_16x16x32_bf16 v[72:75], a[128:131], v[48:51], v[72:75]
 ds_read_b128 v[36:39], v6 offset:34816
 v_mfma_f32_16x16x32_bf16 v[80:83], a[200:203], v[48:51], v[80:83]
 v_add_u32 v6, s43, v4
 v_mul_f32 v124, s50, v124
 v_mfma_f32_16x16x32_bf16 v[88:91], v[240:243], v[48:51], v[88:91]
 v_mfma_f32_16x16x32_bf16 v[68:71], a[56:59], v[52:55], v[68:71]
 v_mul_f32 v125, s50, v125
 v_mfma_f32_16x16x32_bf16 v[76:79], a[128:131], v[52:55], v[76:79]
 v_mul_f32 v126, s50, v126
 v_mfma_f32_16x16x32_bf16 v[84:87], a[200:203], v[52:55], v[84:87]
 v_mul_f32 v127, s50, v127
 v_mfma_f32_16x16x32_bf16 v[92:95], v[240:243], v[52:55], v[92:95]
 s_waitcnt lgkmcnt(2)
 v_mfma_f32_16x16x32_bf16 v[64:67], a[60:63], v[56:59], v[64:67]
 ds_read_b128 v[40:43], v7 offset:32768
 v_cvt_pk_bf16_f32 v28, v116, v117
 v_mfma_f32_16x16x32_bf16 v[72:75], a[132:135], v[56:59], v[72:75]
 ds_read_b128 v[44:47], v7 offset:34816
 v_mfma_f32_16x16x32_bf16 v[80:83], a[204:207], v[56:59], v[80:83]
 v_add_u32 v7, s43, v5
 v_cvt_pk_bf16_f32 v29, v124, v125
 v_mfma_f32_16x16x32_bf16 v[88:91], v[244:247], v[56:59], v[88:91]
 v_cvt_pk_bf16_f32 v30, v118, v119
 v_mfma_f32_16x16x32_bf16 v[68:71], a[60:63], v[60:63], v[68:71]
 v_mfma_f32_16x16x32_bf16 v[76:79], a[132:135], v[60:63], v[76:79]
 v_cvt_pk_bf16_f32 v31, v126, v127
 v_mfma_f32_16x16x32_bf16 v[84:87], a[204:207], v[60:63], v[84:87]
 buffer_store_dwordx4 v[28:31], v12, s[20:23], s48 offen offset:1024 sc1
 v_mfma_f32_16x16x32_bf16 v[92:95], v[244:247], v[60:63], v[92:95]
 s_waitcnt lgkmcnt(2)
 v_mfma_f32_16x16x32_bf16 v[64:67], a[64:67], v[32:35], v[64:67]
 s_waitcnt vmcnt(13)
 s_barrier
 ds_read_b128 v[48:51], v6 offset:0
 v_mfma_f32_16x16x32_bf16 v[72:75], a[136:139], v[32:35], v[72:75]
 ds_read_b128 v[52:55], v6 offset:2048
 v_mfma_f32_16x16x32_bf16 v[80:83], a[208:211], v[32:35], v[80:83]
 v_mfma_f32_16x16x32_bf16 v[88:91], v[248:251], v[32:35], v[88:91]
 v_mfma_f32_16x16x32_bf16 v[68:71], a[64:67], v[36:39], v[68:71]
 v_mfma_f32_16x16x32_bf16 v[76:79], a[136:139], v[36:39], v[76:79]
 v_mfma_f32_16x16x32_bf16 v[84:87], a[208:211], v[36:39], v[84:87]
 v_mfma_f32_16x16x32_bf16 v[92:95], v[248:251], v[36:39], v[92:95]
 s_waitcnt lgkmcnt(2)
 v_mfma_f32_16x16x32_bf16 v[64:67], a[68:71], v[40:43], v[64:67]
 ds_read_b128 v[56:59], v7 offset:0
 v_mfma_f32_16x16x32_bf16 v[72:75], a[140:143], v[40:43], v[72:75]
 ds_read_b128 v[60:63], v7 offset:2048
 v_mfma_f32_16x16x32_bf16 v[80:83], a[212:215], v[40:43], v[80:83]
 s_mul_i32 s45, s39, 262144
 s_add_u32 s47, s34, s45
 v_mfma_f32_16x16x32_bf16 v[88:91], v[252:255], v[40:43], v[88:91]
 s_add_u32 s48, s35, s45
 v_mov_b32 v14, s42
 v_mfma_f32_16x16x32_bf16 v[68:71], a[68:71], v[44:47], v[68:71]
 s_mov_b32 s39, s40
 s_mov_b32 s40, s41
 v_mfma_f32_16x16x32_bf16 v[76:79], a[140:143], v[44:47], v[76:79]
 s_add_u32 s42, s42, 1
 v_mfma_f32_16x16x32_bf16 v[84:87], a[212:215], v[44:47], v[84:87]
 v_mfma_f32_16x16x32_bf16 v[92:95], v[252:255], v[44:47], v[92:95]
 s_waitcnt lgkmcnt(2)
 v_mfma_f32_16x16x32_bf16 v[96:99], a[0:3], v[48:51], 0
 ds_read_b128 v[32:35], v6 offset:4096
 v_mfma_f32_16x16x32_bf16 v[104:107], a[72:75], v[48:51], 0
 ds_read_b128 v[36:39], v6 offset:6144
 v_mfma_f32_16x16x32_bf16 v[112:115], a[144:147], v[48:51], 0
 s_add_u32 s41, s40, 4
 v_mfma_f32_16x16x32_bf16 v[120:123], a[216:219], v[48:51], 0
 s_add_u32 s45, s42, 2
 s_mul_i32 s46, s41, 36864
 v_mfma_f32_16x16x32_bf16 v[100:103], a[0:3], v[52:55], 0
 s_cmp_lt_u32 s45, s36
 s_cselect_b32 s46, s46, 0
 v_mfma_f32_16x16x32_bf16 v[108:111], a[72:75], v[52:55], 0
 s_lshl_b32 s49, s4, 10
 s_add_u32 s49, s49, s44
 v_mfma_f32_16x16x32_bf16 v[116:119], a[144:147], v[52:55], 0
 v_mfma_f32_16x16x32_bf16 v[124:127], a[216:219], v[52:55], 0
 s_waitcnt lgkmcnt(2)
 v_mfma_f32_16x16x32_bf16 v[96:99], a[4:7], v[56:59], v[96:99]
 ds_read_b128 v[40:43], v7 offset:4096
 v_mfma_f32_16x16x32_bf16 v[104:107], a[76:79], v[56:59], v[104:107]
 ds_read_b128 v[44:47], v7 offset:6144
 v_mfma_f32_16x16x32_bf16 v[112:115], a[148:151], v[56:59], v[112:115]
 s_add_u32 m0, s49, 0
 v_mfma_f32_16x16x32_bf16 v[120:123], a[220:223], v[56:59], v[120:123]
 buffer_load_dwordx4 v10, s[8:11], s46 offen offset:0  lds
 v_mfma_f32_16x16x32_bf16 v[100:103], a[4:7], v[60:63], v[100:103]
 s_add_u32 m0, s49, 3968
 v_mfma_f32_16x16x32_bf16 v[108:111], a[76:79], v[60:63], v[108:111]
 buffer_load_dwordx4 v10, s[8:11], s46 offen offset:128  lds
 v_mfma_f32_16x16x32_bf16 v[116:119], a[148:151], v[60:63], v[116:119]
 v_mfma_f32_16x16x32_bf16 v[124:127], a[220:223], v[60:63], v[124:127]
 s_waitcnt lgkmcnt(2)
 v_mfma_f32_16x16x32_bf16 v[96:99], a[8:11], v[32:35], v[96:99]
 ds_read_b128 v[48:51], v6 offset:8192
 v_mfma_f32_16x16x32_bf16 v[104:107], a[80:83], v[32:35], v[104:107]
 ds_read_b128 v[52:55], v6 offset:10240
 v_mfma_f32_16x16x32_bf16 v[112:115], a[152:155], v[32:35], v[112:115]
 s_add_u32 m0, s49, 7936
 v_mfma_f32_16x16x32_bf16 v[120:123], a[224:227], v[32:35], v[120:123]
 buffer_load_dwordx4 v10, s[8:11], s46 offen offset:256  lds
 v_mfma_f32_16x16x32_bf16 v[100:103], a[8:11], v[36:39], v[100:103]
 s_add_u32 m0, s49, 11904
 v_mfma_f32_16x16x32_bf16 v[108:111], a[80:83], v[36:39], v[108:111]
 buffer_load_dwordx4 v10, s[8:11], s46 offen offset:384  lds
 v_mfma_f32_16x16x32_bf16 v[116:119], a[152:155], v[36:39], v[116:119]
 v_mfma_f32_16x16x32_bf16 v[124:127], a[224:227], v[36:39], v[124:127]
 s_waitcnt lgkmcnt(2)
 v_mfma_f32_16x16x32_bf16 v[96:99], a[12:15], v[40:43], v[96:99]
 ds_read_b128 v[56:59], v7 offset:8192
 v_mfma_f32_16x16x32_bf16 v[104:107], a[84:87], v[40:43], v[104:107]
 ds_read_b128 v[60:63], v7 offset:10240
 v_mfma_f32_16x16x32_bf16 v[112:115], a[156:159], v[40:43], v[112:115]
 s_add_u32 m0, s49, 15872
 v_mfma_f32_16x16x32_bf16 v[120:123], a[228:231], v[40:43], v[120:123]
 buffer_load_dwordx4 v10, s[8:11], s46 offen offset:512  lds
 v_mfma_f32_16x16x32_bf16 v[100:103], a[12:15], v[44:47], v[100:103]
 s_add_u32 m0, s49, 19840
 v_mfma_f32_16x16x32_bf16 v[108:111], a[84:87], v[44:47], v[108:111]
 buffer_load_dwordx4 v10, s[8:11], s46 offen offset:640  lds
 v_mfma_f32_16x16x32_bf16 v[116:119], a[156:159], v[44:47], v[116:119]
 v_mfma_f32_16x16x32_bf16 v[124:127], a[228:231], v[44:47], v[124:127]
 s_waitcnt lgkmcnt(2)
 v_mfma_f32_16x16x32_bf16 v[96:99], a[16:19], v[48:51], v[96:99]
 ds_read_b128 v[32:35], v6 offset:12288
 v_mfma_f32_16x16x32_bf16 v[104:107], a[88:91], v[48:51], v[104:107]
 ds_read_b128 v[36:39], v6 offset:14336
 v_mfma_f32_16x16x32_bf16 v[112:115], a[160:163], v[48:51], v[112:115]
 s_add_u32 m0, s49, 23808
 v_mfma_f32_16x16x32_bf16 v[120:123], a[232:235], v[48:51], v[120:123]
 buffer_load_dwordx4 v10, s[8:11], s46 offen offset:768  lds
 v_mfma_f32_16x16x32_bf16 v[100:103], a[16:19], v[52:55], v[100:103]
 s_add_u32 m0, s49, 27776
 v_mfma_f32_16x16x32_bf16 v[108:111], a[88:91], v[52:55], v[108:111]
 buffer_load_dwordx4 v10, s[8:11], s46 offen offset:896  lds
 v_mfma_f32_16x16x32_bf16 v[116:119], a[160:163], v[52:55], v[116:119]
 v_mfma_f32_16x16x32_bf16 v[124:127], a[232:235], v[52:55], v[124:127]
 s_waitcnt lgkmcnt(2)
 v_mfma_f32_16x16x32_bf16 v[96:99], a[20:23], v[56:59], v[96:99]
 ds_read_b128 v[40:43], v7 offset:12288
 v_mfma_f32_16x16x32_bf16 v[104:107], a[92:95], v[56:59], v[104:107]
 ds_read_b128 v[44:47], v7 offset:14336
 v_mfma_f32_16x16x32_bf16 v[112:115], a[164:167], v[56:59], v[112:115]
 s_add_u32 m0, s49, 31744
 v_mfma_f32_16x16x32_bf16 v[120:123], a[236:239], v[56:59], v[120:123]
 buffer_load_dwordx4 v10, s[8:11], s46 offen offset:1024  lds
 v_mfma_f32_16x16x32_bf16 v[100:103], a[20:23], v[60:63], v[100:103]
 v_mfma_f32_16x16x32_bf16 v[108:111], a[92:95], v[60:63], v[108:111]
 v_mfma_f32_16x16x32_bf16 v[116:119], a[164:167], v[60:63], v[116:119]
 v_mfma_f32_16x16x32_bf16 v[124:127], a[236:239], v[60:63], v[124:127]
 s_waitcnt lgkmcnt(2)
 v_mfma_f32_16x16x32_bf16 v[96:99], a[24:27], v[32:35], v[96:99]
 ds_read_b128 v[48:51], v6 offset:16384
 v_mul_f32 v64, s50, v64
 v_mfma_f32_16x16x32_bf16 v[104:107], a[96:99], v[32:35], v[104:107]
 ds_read_b128 v[52:55], v6 offset:18432
 v_mfma_f32_16x16x32_bf16 v[112:115], a[168:171], v[32:35], v[112:115]
 v_mul_f32 v65, s50, v65
 v_mfma_f32_16x16x32_bf16 v[120:123], a[240:243], v[32:35], v[120:123]
 v_mul_f32 v66, s50, v66
 v_mfma_f32_16x16x32_bf16 v[100:103], a[24:27], v[36:39], v[100:103]
 v_mul_f32 v67, s50, v67
 v_mfma_f32_16x16x32_bf16 v[108:111], a[96:99], v[36:39], v[108:111]
 v_mul_f32 v72, s50, v72
 v_mfma_f32_16x16x32_bf16 v[116:119], a[168:171], v[36:39], v[116:119]
 v_mul_f32 v73, s50, v73
 v_mfma_f32_16x16x32_bf16 v[124:127], a[240:243], v[36:39], v[124:127]
 s_waitcnt lgkmcnt(2)
 v_mfma_f32_16x16x32_bf16 v[96:99], a[28:31], v[40:43], v[96:99]
 ds_read_b128 v[56:59], v7 offset:16384
 v_mfma_f32_16x16x32_bf16 v[104:107], a[100:103], v[40:43], v[104:107]
 ds_read_b128 v[60:63], v7 offset:18432
 v_mul_f32 v74, s50, v74
 v_mfma_f32_16x16x32_bf16 v[112:115], a[172:175], v[40:43], v[112:115]
 v_mul_f32 v75, s50, v75
 v_mfma_f32_16x16x32_bf16 v[120:123], a[244:247], v[40:43], v[120:123]
 v_cvt_pk_bf16_f32 v16, v64, v65
 v_mfma_f32_16x16x32_bf16 v[100:103], a[28:31], v[44:47], v[100:103]
 v_mfma_f32_16x16x32_bf16 v[108:111], a[100:103], v[44:47], v[108:111]
 v_cvt_pk_bf16_f32 v17, v72, v73
 v_mfma_f32_16x16x32_bf16 v[116:119], a[172:175], v[44:47], v[116:119]
 v_cvt_pk_bf16_f32 v18, v66, v67
 v_mfma_f32_16x16x32_bf16 v[124:127], a[244:247], v[44:47], v[124:127]
 s_waitcnt lgkmcnt(2)
 v_cvt_pk_bf16_f32 v19, v74, v75
 v_mfma_f32_16x16x32_bf16 v[96:99], a[32:35], v[48:51], v[96:99]
 ds_read_b128 v[32:35], v6 offset:20480
 v_mfma_f32_16x16x32_bf16 v[104:107], a[104:107], v[48:51], v[104:107]
 ds_read_b128 v[36:39], v6 offset:22528
 v_mfma_f32_16x16x32_bf16 v[112:115], a[176:179], v[48:51], v[112:115]
 buffer_store_dwordx4 v[16:19], v12, s[20:23], s47 offen offset:0 sc1
 v_mfma_f32_16x16x32_bf16 v[120:123], a[248:251], v[48:51], v[120:123]
 v_mul_f32 v68, s50, v68
 v_mfma_f32_16x16x32_bf16 v[100:103], a[32:35], v[52:55], v[100:103]
 v_mul_f32 v69, s50, v69
 v_mfma_f32_16x16x32_bf16 v[108:111], a[104:107], v[52:55], v[108:111]
 v_mul_f32 v70, s50, v70
 v_mfma_f32_16x16x32_bf16 v[116:119], a[176:179], v[52:55], v[116:119]
 v_mul_f32 v71, s50, v71
 v_mfma_f32_16x16x32_bf16 v[124:127], a[248:251], v[52:55], v[124:127]
 s_waitcnt lgkmcnt(2)
 v_mfma_f32_16x16x32_bf16 v[96:99], a[36:39], v[56:59], v[96:99]
 ds_read_b128 v[40:43], v7 offset:20480
 v_mul_f32 v76, s50, v76
 v_mfma_f32_16x16x32_bf16 v[104:107], a[108:111], v[56:59], v[104:107]
 ds_read_b128 v[44:47], v7 offset:22528
 v_mfma_f32_16x16x32_bf16 v[112:115], a[180:183], v[56:59], v[112:115]
 v_mul_f32 v77, s50, v77
 v_mfma_f32_16x16x32_bf16 v[120:123], a[252:255], v[56:59], v[120:123]
 v_mul_f32 v78, s50, v78
 v_mfma_f32_16x16x32_bf16 v[100:103], a[36:39], v[60:63], v[100:103]
 v_mul_f32 v79, s50, v79
 v_mfma_f32_16x16x32_bf16 v[108:111], a[108:111], v[60:63], v[108:111]
 v_mfma_f32_16x16x32_bf16 v[116:119], a[180:183], v[60:63], v[116:119]
 v_cvt_pk_bf16_f32 v20, v68, v69
 v_mfma_f32_16x16x32_bf16 v[124:127], a[252:255], v[60:63], v[124:127]
 s_waitcnt lgkmcnt(2)
 v_cvt_pk_bf16_f32 v21, v76, v77
 v_mfma_f32_16x16x32_bf16 v[96:99], a[40:43], v[32:35], v[96:99]
 ds_read_b128 v[48:51], v6 offset:24576
 v_mfma_f32_16x16x32_bf16 v[104:107], a[112:115], v[32:35], v[104:107]
 ds_read_b128 v[52:55], v6 offset:26624
 v_cvt_pk_bf16_f32 v22, v70, v71
 v_mfma_f32_16x16x32_bf16 v[112:115], a[184:187], v[32:35], v[112:115]
 v_mfma_f32_16x16x32_bf16 v[120:123], v[224:227], v[32:35], v[120:123]
 v_cvt_pk_bf16_f32 v23, v78, v79
 v_mfma_f32_16x16x32_bf16 v[100:103], a[40:43], v[36:39], v[100:103]
 buffer_store_dwordx4 v[20:23], v12, s[20:23], s47 offen offset:1024 sc1
 v_mfma_f32_16x16x32_bf16 v[108:111], a[112:115], v[36:39], v[108:111]
 v_mul_f32 v80, s50, v80
 v_mfma_f32_16x16x32_bf16 v[116:119], a[184:187], v[36:39], v[116:119]
 v_mul_f32 v81, s50, v81
 v_mfma_f32_16x16x32_bf16 v[124:127], v[224:227], v[36:39], v[124:127]
 s_waitcnt lgkmcnt(2)
 v_mfma_f32_16x16x32_bf16 v[96:99], a[44:47], v[40:43], v[96:99]
 ds_read_b128 v[56:59], v7 offset:24576
 v_mul_f32 v82, s50, v82
 v_mfma_f32_16x16x32_bf16 v[104:107], a[116:119], v[40:43], v[104:107]
 ds_read_b128 v[60:63], v7 offset:26624
 v_mfma_f32_16x16x32_bf16 v[112:115], a[188:191], v[40:43], v[112:115]
 v_mul_f32 v83, s50, v83
 v_mfma_f32_16x16x32_bf16 v[120:123], v[228:231], v[40:43], v[120:123]
 v_mul_f32 v88, s50, v88
 v_mfma_f32_16x16x32_bf16 v[100:103], a[44:47], v[44:47], v[100:103]
 v_mul_f32 v89, s50, v89
 v_mfma_f32_16x16x32_bf16 v[108:111], a[116:119], v[44:47], v[108:111]
 v_mfma_f32_16x16x32_bf16 v[116:119], a[188:191], v[44:47], v[116:119]
 v_mul_f32 v90, s50, v90
 v_mfma_f32_16x16x32_bf16 v[124:127], v[228:231], v[44:47], v[124:127]
 s_waitcnt lgkmcnt(2)
 v_mul_f32 v91, s50, v91
 v_mfma_f32_16x16x32_bf16 v[96:99], a[48:51], v[48:51], v[96:99]
 ds_read_b128 v[32:35], v6 offset:28672
 v_mfma_f32_16x16x32_bf16 v[104:107], a[120:123], v[48:51], v[104:107]
 ds_read_b128 v[36:39], v6 offset:30720
 v_cvt_pk_bf16_f32 v24, v80, v81
 v_mfma_f32_16x16x32_bf16 v[112:115], a[192:195], v[48:51], v[112:115]
 v_mfma_f32_16x16x32_bf16 v[120:123], v[232:235], v[48:51], v[120:123]
 v_cvt_pk_bf16_f32 v25, v88, v89
 v_mfma_f32_16x16x32_bf16 v[100:103], a[48:51], v[52:55], v[100:103]
 v_cvt_pk_bf16_f32 v26, v82, v83
 v_mfma_f32_16x16x32_bf16 v[108:111], a[120:123], v[52:55], v[108:111]
 v_cvt_pk_bf16_f32 v27, v90, v91
 v_mfma_f32_16x16x32_bf16 v[116:119], a[192:195], v[52:55], v[116:119]
 buffer_store_dwordx4 v[24:27], v12, s[20:23], s48 offen offset:0 sc1
 v_mfma_f32_16x16x32_bf16 v[124:127], v[232:235], v[52:55], v[124:127]
 s_waitcnt lgkmcnt(2)
 v_mfma_f32_16x16x32_bf16 v[96:99], a[52:55], v[56:59], v[96:99]
 ds_read_b128 v[40:43], v7 offset:28672
 v_mul_f32 v84, s50, v84
 v_mfma_f32_16x16x32_bf16 v[104:107], a[124:127], v[56:59], v[104:107]
 ds_read_b128 v[44:47], v7 offset:30720
 v_mfma_f32_16x16x32_bf16 v[112:115], a[196:199], v[56:59], v[112:115]
 s_add_u32 s43, s43, 36864
 s_cmp_eq_u32 s43, 147456
 v_mfma_f32_16x16x32_bf16 v[120:123], v[236:239], v[56:59], v[120:123]
 s_cselect_b32 s43, 0, s43
 s_add_u32 s44, s44, 36864
 v_mfma_f32_16x16x32_bf16 v[100:103], a[52:55], v[60:63], v[100:103]
 s_cmp_eq_u32 s44, 147456
 s_cselect_b32 s44, 0, s44
 v_mfma_f32_16x16x32_bf16 v[108:111], a[124:127], v[60:63], v[108:111]
 v_mul_f32 v85, s50, v85
 v_mfma_f32_16x16x32_bf16 v[116:119], a[196:199], v[60:63], v[116:119]
 v_mul_f32 v86, s50, v86
 v_mfma_f32_16x16x32_bf16 v[124:127], v[236:239], v[60:63], v[124:127]
 s_waitcnt lgkmcnt(2)
 v_mfma_f32_16x16x32_bf16 v[96:99], a[56:59], v[32:35], v[96:99]
 ds_read_b128 v[48:51], v6 offset:32768
 v_mul_f32 v87, s50, v87
 v_mfma_f32_16x16x32_bf16 v[104:107], a[128:131], v[32:35], v[104:107]
 ds_read_b128 v[52:55], v6 offset:34816
 v_mfma_f32_16x16x32_bf16 v[112:115], a[200:203], v[32:35], v[112:115]
 v_add_u32 v6, s43, v4
 v_mul_f32 v92, s50, v92
 v_mfma_f32_16x16x32_bf16 v[120:123], v[240:243], v[32:35], v[120:123]
 v_mfma_f32_16x16x32_bf16 v[100:103], a[56:59], v[36:39], v[100:103]
 v_mul_f32 v93, s50, v93
 v_mfma_f32_16x16x32_bf16 v[108:111], a[128:131], v[36:39], v[108:111]
 v_mul_f32 v94, s50, v94
 v_mfma_f32_16x16x32_bf16 v[116:119], a[200:203], v[36:39], v[116:119]
 v_mul_f32 v95, s50, v95
 v_mfma_f32_16x16x32_bf16 v[124:127], v[240:243], v[36:39], v[124:127]
 s_waitcnt lgkmcnt(2)
 v_mfma_f32_16x16x32_bf16 v[96:99], a[60:63], v[40:43], v[96:99]
 ds_read_b128 v[56:59], v7 offset:32768
 v_cvt_pk_bf16_f32 v28, v84, v85
 v_mfma_f32_16x16x32_bf16 v[104:107], a[132:135], v[40:43], v[104:107]
 ds_read_b128 v[60:63], v7 offset:34816
 v_mfma_f32_16x16x32_bf16 v[112:115], a[204:207], v[40:43], v[112:115]
 v_add_u32 v7, s43, v5
 v_cvt_pk_bf16_f32 v29, v92, v93
 v_mfma_f32_16x16x32_bf16 v[120:123], v[244:247], v[40:43], v[120:123]
 v_cvt_pk_bf16_f32 v30, v86, v87
 v_mfma_f32_16x16x32_bf16 v[100:103], a[60:63], v[44:47], v[100:103]
 v_mfma_f32_16x16x32_bf16 v[108:111], a[132:135], v[44:47], v[108:111]
 v_cvt_pk_bf16_f32 v31, v94, v95
 v_mfma_f32_16x16x32_bf16 v[116:119], a[204:207], v[44:47], v[116:119]
 buffer_store_dwordx4 v[28:31], v12, s[20:23], s48 offen offset:1024 sc1
 v_mfma_f32_16x16x32_bf16 v[124:127], v[244:247], v[44:47], v[124:127]
 s_waitcnt lgkmcnt(2)
 v_mfma_f32_16x16x32_bf16 v[96:99], a[64:67], v[48:51], v[96:99]
 s_waitcnt vmcnt(13)
 s_barrier
 ds_read_b128 v[32:35], v6 offset:0
 v_mfma_f32_16x16x32_bf16 v[104:107], a[136:139], v[48:51], v[104:107]
 ds_read_b128 v[36:39], v6 offset:2048
 v_mfma_f32_16x16x32_bf16 v[112:115], a[208:211], v[48:51], v[112:115]
 v_mfma_f32_16x16x32_bf16 v[120:123], v[248:251], v[48:51], v[120:123]
 v_mfma_f32_16x16x32_bf16 v[100:103], a[64:67], v[52:55], v[100:103]
 v_mfma_f32_16x16x32_bf16 v[108:111], a[136:139], v[52:55], v[108:111]
 v_mfma_f32_16x16x32_bf16 v[116:119], a[208:211], v[52:55], v[116:119]
 v_mfma_f32_16x16x32_bf16 v[124:127], v[248:251], v[52:55], v[124:127]
 s_waitcnt lgkmcnt(2)
 v_mfma_f32_16x16x32_bf16 v[96:99], a[68:71], v[56:59], v[96:99]
 ds_read_b128 v[40:43], v7 offset:0
 v_mfma_f32_16x16x32_bf16 v[104:107], a[140:143], v[56:59], v[104:107]
 ds_read_b128 v[44:47], v7 offset:2048
 v_mfma_f32_16x16x32_bf16 v[112:115], a[212:215], v[56:59], v[112:115]
 s_mul_i32 s45, s39, 262144
 s_add_u32 s47, s34, s45
 v_mfma_f32_16x16x32_bf16 v[120:123], v[252:255], v[56:59], v[120:123]
 s_add_u32 s48, s35, s45
 v_mov_b32 v14, s42
 v_mfma_f32_16x16x32_bf16 v[100:103], a[68:71], v[60:63], v[100:103]
 s_mov_b32 s39, s40
 s_mov_b32 s40, s41
 v_mfma_f32_16x16x32_bf16 v[108:111], a[140:143], v[60:63], v[108:111]
 s_add_u32 s42, s42, 1
 s_cmp_lt_u32 s42, s36
 v_mfma_f32_16x16x32_bf16 v[116:119], a[212:215], v[60:63], v[116:119]
 v_mfma_f32_16x16x32_bf16 v[124:127], v[252:255], v[60:63], v[124:127]
 s_waitcnt lgkmcnt(2)
 s_cbranch_scc1 Lps_loop_21
 s_nop 7
 v_mul_f32 v96, s50, v96
 v_mul_f32 v97, s50, v97
 v_mul_f32 v98, s50, v98
 v_mul_f32 v99, s50, v99
 v_mul_f32 v104, s50, v104
 v_mul_f32 v105, s50, v105
 v_mul_f32 v106, s50, v106
 v_mul_f32 v107, s50, v107
 v_cvt_pk_bf16_f32 v16, v96, v97
 v_cvt_pk_bf16_f32 v17, v104, v105
 v_cvt_pk_bf16_f32 v18, v98, v99
 v_cvt_pk_bf16_f32 v19, v106, v107
 buffer_store_dwordx4 v[16:19], v12, s[20:23], s47 offen offset:0 sc1
 v_mul_f32 v100, s50, v100
 v_mul_f32 v101, s50, v101
 v_mul_f32 v102, s50, v102
 v_mul_f32 v103, s50, v103
 v_mul_f32 v108, s50, v108
 v_mul_f32 v109, s50, v109
 v_mul_f32 v110, s50, v110
 v_mul_f32 v111, s50, v111
 v_cvt_pk_bf16_f32 v20, v100, v101
 v_cvt_pk_bf16_f32 v21, v108, v109
 v_cvt_pk_bf16_f32 v22, v102, v103
 v_cvt_pk_bf16_f32 v23, v110, v111
 buffer_store_dwordx4 v[20:23], v12, s[20:23], s47 offen offset:1024 sc1
 v_mul_f32 v112, s50, v112
 v_mul_f32 v113, s50, v113
 v_mul_f32 v114, s50, v114
 v_mul_f32 v115, s50, v115
 v_mul_f32 v120, s50, v120
 v_mul_f32 v121, s50, v121
 v_mul_f32 v122, s50, v122
 v_mul_f32 v123, s50, v123
 v_cvt_pk_bf16_f32 v24, v112, v113
 v_cvt_pk_bf16_f32 v25, v120, v121
 v_cvt_pk_bf16_f32 v26, v114, v115
 v_cvt_pk_bf16_f32 v27, v122, v123
 buffer_store_dwordx4 v[24:27], v12, s[20:23], s48 offen offset:0 sc1
 v_mul_f32 v116, s50, v116
 v_mul_f32 v117, s50, v117
 v_mul_f32 v118, s50, v118
 v_mul_f32 v119, s50, v119
 v_mul_f32 v124, s50, v124
 v_mul_f32 v125, s50, v125
 v_mul_f32 v126, s50, v126
 v_mul_f32 v127, s50, v127
 v_cvt_pk_bf16_f32 v28, v116, v117
 v_cvt_pk_bf16_f32 v29, v124, v125
 v_cvt_pk_bf16_f32 v30, v118, v119
 v_cvt_pk_bf16_f32 v31, v126, v127
 buffer_store_dwordx4 v[28:31], v12, s[20:23], s48 offen offset:1024 sc1
 s_waitcnt vmcnt(0) lgkmcnt(0)
 s_barrier
 v_mov_b32 v14, s36
 buffer_store_dword v14, v13, s[20:23], 0 offen sc1
 s_sub_u32 s3, s5, 2
 s_add_u32 s7, s6, s3
 s_cmp_ge_u32 s7, 30
 s_cbranch_scc1 Lfin
 s_cmp_ge_u32 s6, 16
 s_cbranch_scc1 Lob
 s_load_dwordx2 s[8:9], s[0:1], 48
 s_mov_b32 s10, 0x240000
 s_mov_b32 s11, 0x20000
 s_load_dwordx2 s[12:13], s[0:1], 64
 s_mov_b32 s14, 0x480000
 s_mov_b32 s15, 0x20000
 s_load_dwordx2 s[16:17], s[0:1], 64
 s_mov_b32 s18, 0x480000
 s_mov_b32 s19, 0x20000
 s_lshl_b32 s32, s6, 9
 s_add_u32 s33, s32, 256
 s_mov_b32 s36, 32
 s_mov_b32 s37, s3
 s_lshl_b32 s52, s6, 1
 s_lshl_b32 s7, s3, 4
 s_add_u32 s7, s7, s6
 s_and_b32 s94, s7, 3
 s_lshr_b32 s7, s7, 2
 s_lshl_b32 s7, s7, 5
 s_add_u32 s7, s7, s94
 s_lshl_b32 s7, s7, 2
 s_add_u32 s59, s7, 0x3800
 s_waitcnt lgkmcnt(0)
 v_and_b32 v1, 63, v0
 v_lshrrev_b32 v2, 3, v0
 v_mul_u32_u24 v10, 1152, v2
 v_lshrrev_b32 v2, 4, v0
 v_xor_b32 v2, v2, v0
 v_and_b32 v2, 7, v2
 v_lshl_add_u32 v10, v2, 4, v10
 v_lshrrev_b32 v2, 4, v1
 v_bfe_u32 v3, v1, 1, 3
 v_xor_b32 v2, v2, v3
 v_and_b32 v3, 15, v1
 v_lshlrev_b32 v3, 7, v3
 v_lshl_add_u32 v4, v2, 4, v3
 v_xor_b32 v5, 64, v4
 v_lshrrev_b32 v2, 4, v0
 v_lshlrev_b32 v11, 13, v2
 v_lshrrev_b32 v2, 7, v0
 v_lshrrev_b32 v3, 4, v1
 v_lshl_add_u32 v3, v2, 2, v3
 v_bfe_u32 v2, v1, 1, 3
 v_xor_b32 v2, v2, v3
 v_lshl_add_u32 v11, v2, 5, v11
 v_and_b32 v2, 1, v1
 v_lshl_add_u32 v11, v2, 4, v11
 v_bfe_u32 v2, v1, 2, 3
 v_xor_b32 v3, s4, v2
 v_lshlrev_b32 v3, 5, v3
 v_and_b32 v2, 3, v2
 v_lshl_add_u32 v3, v2, 8, v3
 v_lshrrev_b32 v2, 4, v1
 v_lshl_add_u32 v3, v2, 11, v3
 v_and_b32 v2, 3, v1
 v_lshl_add_u32 v3, v2, 3, v3
 v_add_u32 v8, 73728, v3
 v_xor_b32 v3, 0x80, v3
 v_add_u32 v9, 73728, v3
 s_lshl_b32 s45, s4, 11
 v_lshl_add_u32 v12, v1, 4, s45
 s_mov_b32 s39, s37
 s_add_u32 s40, s39, 2
 s_lshl_b32 s49, s4, 10
 s_mul_i32 s46, s39, 36864
 s_add_u32 m0, s49, 0
 s_nop 0
 buffer_load_dwordx4 v10, s[8:11], s46 offen offset:0  lds
 s_add_u32 m0, s49, 3968
 s_nop 0
 buffer_load_dwordx4 v10, s[8:11], s46 offen offset:128  lds
 s_add_u32 m0, s49, 7936
 s_nop 0
 buffer_load_dwordx4 v10, s[8:11], s46 offen offset:256  lds
 s_add_u32 m0, s49, 11904
 s_nop 0
 buffer_load_dwordx4 v10, s[8:11], s46 offen offset:384  lds
 s_add_u32 m0, s49, 15872
 s_nop 0
 buffer_load_dwordx4 v10, s[8:11], s46 offen offset:512  lds
 s_add_u32 m0, s49, 19840
 s_nop 0
 buffer_load_dwordx4 v10, s[8:11], s46 offen offset:640  lds
 s_add_u32 m0, s49, 23808
 s_nop 0
 buffer_load_dwordx4 v10, s[8:11], s46 offen offset:768  lds
 s_add_u32 m0, s49, 27776
 s_nop 0
 buffer_load_dwordx4 v10, s[8:11], s46 offen offset:896  lds
 s_add_u32 m0, s49, 31744
 s_nop 0
 buffer_load_dwordx4 v10, s[8:11], s46 offen offset:1024  lds
 s_lshl_b32 s49, s4, 10
 s_add_u32 s49, s49, 36864
 s_mul_i32 s46, s40, 36864
 s_add_u32 m0, s49, 0
 s_nop 0
 buffer_load_dwordx4 v10, s[8:11], s46 offen offset:0  lds
 s_add_u32 m0, s49, 3968
 s_nop 0
 buffer_load_dwordx4 v10, s[8:11], s46 offen offset:128  lds
 s_add_u32 m0, s49, 7936
 s_nop 0
 buffer_load_dwordx4 v10, s[8:11], s46 offen offset:256  lds
 s_add_u32 m0, s49, 11904
 s_nop 0
 buffer_load_dwordx4 v10, s[8:11], s46 offen offset:384  lds
 s_add_u32 m0, s49, 15872
 s_nop 0
 buffer_load_dwordx4 v10, s[8:11], s46 offen offset:512  lds
 s_add_u32 m0, s49, 19840
 s_nop 0
 buffer_load_dwordx4 v10, s[8:11], s46 offen offset:640  lds
 s_add_u32 m0, s49, 23808
 s_nop 0
 buffer_load_dwordx4 v10, s[8:11], s46 offen offset:768  lds
 s_add_u32 m0, s49, 27776
 s_nop 0
 buffer_load_dwordx4 v10, s[8:11], s46 offen offset:896  lds
 s_add_u32 m0, s49, 31744
 s_nop 0
 buffer_load_dwordx4 v10, s[8:11], s46 offen offset:1024  lds
 s_lshl_b32 s49, s4, 10
 s_add_u32 m0, s49, 73728
 s_add_u32 s45, s32, 0
 buffer_load_dwordx4 v11, s[12:15], s45 offen  lds
 s_add_u32 m0, s49, 77824
 s_add_u32 s45, s32, 131072
 buffer_load_dwordx4 v11, s[12:15], s45 offen  lds
 s_add_u32 m0, s49, 81920
 s_add_u32 s45, s33, 0
 buffer_load_dwordx4 v11, s[16:19], s45 offen  lds
 s_add_u32 m0, s49, 86016
 s_add_u32 s45, s33, 131072
 buffer_load_dwordx4 v11, s[16:19], s45 offen  lds
 s_add_u32 m0, s49, 90112
 s_add_u32 s45, s32, 262144
 buffer_load_dwordx4 v11, s[12:15], s45 offen  lds
 s_add_u32 m0, s49, 94208
 s_add_u32 s45, s32, 393216
 buffer_load_dwordx4 v11, s[12:15], s45 offen  lds
 s_add_u32 m0, s49, 98304
 s_add_u32 s45, s33, 262144
 buffer_load_dwordx4 v11, s[16:19], s45 offen  lds
 s_add_u32 m0, s49, 102400
 s_add_u32 s45, s33, 393216
 buffer_load_dwordx4 v11, s[16:19], s45 offen  lds
 s_add_u32 m0, s49, 106496
 s_add_u32 s45, s32, 524288
 buffer_load_dwordx4 v11, s[12:15], s45 offen  lds
 s_add_u32 m0, s49, 110592
 s_add_u32 s45, s32, 655360
 buffer_load_dwordx4 v11, s[12:15], s45 offen  lds
 s_add_u32 m0, s49, 114688
 s_add_u32 s45, s33, 524288
 buffer_load_dwordx4 v11, s[16:19], s45 offen  lds
 s_add_u32 m0, s49, 118784
 s_add_u32 s45, s33, 655360
 buffer_load_dwordx4 v11, s[16:19], s45 offen  lds
 s_waitcnt vmcnt(8) lgkmcnt(0)
 s_barrier
 s_add_u32 m0, s49, 122880
 s_add_u32 s45, s32, 786432
 buffer_load_dwordx4 v11, s[12:15], s45 offen  lds
 s_add_u32 m0, s49, 126976
 s_add_u32 s45, s32, 917504
 buffer_load_dwordx4 v11, s[12:15], s45 offen  lds
 s_add_u32 m0, s49, 131072
 s_add_u32 s45, s33, 786432
 buffer_load_dwordx4 v11, s[16:19], s45 offen  lds
 s_add_u32 m0, s49, 135168
 s_add_u32 s45, s33, 917504
 buffer_load_dwordx4 v11, s[16:19], s45 offen  lds
 ds_read_b64_tr_b16 a[0:1], v8 offset:0
 ds_read_b64_tr_b16 a[2:3], v8 offset:1024
 ds_read_b64_tr_b16 a[72:73], v9 offset:0
 ds_read_b64_tr_b16 a[74:75], v9 offset:1024
 ds_read_b64_tr_b16 a[144:145], v8 offset:8192
 ds_read_b64_tr_b16 a[146:147], v8 offset:9216
 ds_read_b64_tr_b16 a[216:217], v9 offset:8192
 ds_read_b64_tr_b16 a[218:219], v9 offset:9216
 s_waitcnt vmcnt(8) lgkmcnt(0)
 s_barrier
 s_add_u32 m0, s49, 73728
 s_add_u32 s45, s32, 1048576
 buffer_load_dwordx4 v11, s[12:15], s45 offen  lds
 s_add_u32 m0, s49, 77824
 s_add_u32 s45, s32, 1179648
 buffer_load_dwordx4 v11, s[12:15], s45 offen  lds
 s_add_u32 m0, s49, 81920
 s_add_u32 s45, s33, 1048576
 buffer_load_dwordx4 v11, s[16:19], s45 offen  lds
 s_add_u32 m0, s49, 86016
 s_add_u32 s45, s33, 1179648
 buffer_load_dwordx4 v11, s[16:19], s45 offen  lds
 ds_read_b64_tr_b16 a[4:5], v8 offset:16384
 ds_read_b64_tr_b16 a[6:7], v8 offset:17408
 ds_read_b64_tr_b16 a[76:77], v9 offset:16384
 ds_read_b64_tr_b16 a[78:79], v9 offset:17408
 ds_read_b64_tr_b16 a[148:149], v8 offset:24576
 ds_read_b64_tr_b16 a[150:151], v8 offset:25600
 ds_read_b64_tr_b16 a[220:221], v9 offset:24576
 ds_read_b64_tr_b16 a[222:223], v9 offset:25600
 s_waitcnt vmcnt(8) lgkmcnt(0)
 s_barrier
 s_add_u32 m0, s49, 90112
 s_add_u32 s45, s32, 1310720
 buffer_load_dwordx4 v11, s[12:15], s45 offen  lds
 s_add_u32 m0, s49, 94208
 s_add_u32 s45, s32, 1441792
 buffer_load_dwordx4 v11, s[12:15], s45 offen  lds
 s_add_u32 m0, s49, 98304
 s_add_u32 s45, s33, 1310720
 buffer_load_dwordx4 v11, s[16:19], s45 offen  lds
 s_add_u32 m0, s49, 102400
 s_add_u32 s45, s33, 1441792
 buffer_load_dwordx4 v11, s[16:19], s45 offen  lds
 ds_read_b64_tr_b16 a[8:9], v8 offset:32768
 ds_read_b64_tr_b16 a[10:11], v8 offset:33792
 ds_read_b64_tr_b16 a[80:81], v9 offset:32768
 ds_read_b64_tr_b16 a[82:83], v9 offset:33792
 ds_read_b64_tr_b16 a[152:153], v8 offset:40960
 ds_read_b64_tr_b16 a[154:155], v8 offset:41984
 ds_read_b64_tr_b16 a[224:225], v9 offset:40960
 ds_read_b64_tr_b16 a[226:227], v9 offset:41984
 s_waitcnt vmcnt(8) lgkmcnt(0)
 s_barrier
 s_add_u32 m0, s49, 106496
 s_add_u32 s45, s32, 1572864
 buffer_load_dwordx4 v11, s[12:15], s45 offen  lds
 s_add_u32 m0, s49, 110592
 s_add_u32 s45, s32, 1703936
 buffer_load_dwordx4 v11, s[12:15], s45 offen  lds
 s_add_u32 m0, s49, 114688
 s_add_u32 s45, s33, 1572864
 buffer_load_dwordx4 v11, s[16:19], s45 offen  lds
 s_add_u32 m0, s49, 118784
 s_add_u32 s45, s33, 1703936
 buffer_load_dwordx4 v11, s[16:19], s45 offen  lds
 ds_read_b64_tr_b16 a[12:13], v8 offset:49152
 ds_read_b64_tr_b16 a[14:15], v8 offset:50176
 ds_read_b64_tr_b16 a[84:85], v9 offset:49152
 ds_read_b64_tr_b16 a[86:87], v9 offset:50176
 ds_read_b64_tr_b16 a[156:157], v8 offset:57344
 ds_read_b64_tr_b16 a[158:159], v8 offset:58368
 ds_read_b64_tr_b16 a[228:229], v9 offset:57344
 ds_read_b64_tr_b16 a[230:231], v9 offset:58368
 s_waitcnt vmcnt(8) lgkmcnt(0)
 s_barrier
 s_add_u32 m0, s49, 122880
 s_add_u32 s45, s32, 1835008
 buffer_load_dwordx4 v11, s[12:15], s45 offen  lds
 s_add_u32 m0, s49, 126976
 s_add_u32 s45, s32, 1966080
 buffer_load_dwordx4 v11, s[12:15], s45 offen  lds
 s_add_u32 m0, s49, 131072
 s_add_u32 s45, s33, 1835008
 buffer_load_dwordx4 v11, s[16:19], s45 offen  lds
 s_add_u32 m0, s49, 135168
 s_add_u32 s45, s33, 1966080
 buffer_load_dwordx4 v11, s[16:19], s45 offen  lds
 ds_read_b64_tr_b16 a[16:17], v8 offset:0
 ds_read_b64_tr_b16 a[18:19], v8 offset:1024
 ds_read_b64_tr_b16 a[88:89], v9 offset:0
 ds_read_b64_tr_b16 a[90:91], v9 offset:1024
 ds_read_b64_tr_b16 a[160:161], v8 offset:8192
 ds_read_b64_tr_b16 a[162:163], v8 offset:9216
 ds_read_b64_tr_b16 a[232:233], v9 offset:8192
 ds_read_b64_tr_b16 a[234:235], v9 offset:9216
 s_waitcnt vmcnt(8) lgkmcnt(0)
 s_barrier
 s_add_u32 m0, s49, 73728
 s_add_u32 s45, s32, 2097152
 buffer_load_dwordx4 v11, s[12:15], s45 offen  lds
 s_add_u32 m0, s49, 77824
 s_add_u32 s45, s32, 2228224
 buffer_load_dwordx4 v11, s[12:15], s45 offen  lds
 s_add_u32 m0, s49, 81920
 s_add_u32 s45, s33, 2097152
 buffer_load_dwordx4 v11, s[16:19], s45 offen  lds
 s_add_u32 m0, s49, 86016
 s_add_u32 s45, s33, 2228224
 buffer_load_dwordx4 v11, s[16:19], s45 offen  lds
 ds_read_b64_tr_b16 a[20:21], v8 offset:16384
 ds_read_b64_tr_b16 a[22:23], v8 offset:17408
 ds_read_b64_tr_b16 a[92:93], v9 offset:16384
 ds_read_b64_tr_b16 a[94:95], v9 offset:17408
 ds_read_b64_tr_b16 a[164:165], v8 offset:24576
 ds_read_b64_tr_b16 a[166:167], v8 offset:25600
 ds_read_b64_tr_b16 a[236:237], v9 offset:24576
 ds_read_b64_tr_b16 a[238:239], v9 offset:25600
 s_waitcnt vmcnt(8) lgkmcnt(0)
 s_barrier
 s_add_u32 m0, s49, 90112
 s_add_u32 s45, s32, 2359296
 buffer_load_dwordx4 v11, s[12:15], s45 offen  lds
 s_add_u32 m0, s49, 94208
 s_add_u32 s45, s32, 2490368
 buffer_load_dwordx4 v11, s[12:15], s45 offen  lds
 s_add_u32 m0, s49, 98304
 s_add_u32 s45, s33, 2359296
 buffer_load_dwordx4 v11, s[16:19], s45 offen  lds
 s_add_u32 m0, s49, 102400
 s_add_u32 s45, s33, 2490368
 buffer_load_dwordx4 v11, s[16:19], s45 offen  lds
 ds_read_b64_tr_b16 a[24:25], v8 offset:32768
 ds_read_b64_tr_b16 a[26:27], v8 offset:33792
 ds_read_b64_tr_b16 a[96:97], v9 offset:32768
 ds_read_b64_tr_b16 a[98:99], v9 offset:33792
 ds_read_b64_tr_b16 a[168:169], v8 offset:40960
 ds_read_b64_tr_b16 a[170:171], v8 offset:41984
 ds_read_b64_tr_b16 a[240:241], v9 offset:40960
 ds_read_b64_tr_b16 a[242:243], v9 offset:41984
 s_waitcnt vmcnt(8) lgkmcnt(0)
 s_barrier
 s_add_u32 m0, s49, 106496
 s_add_u32 s45, s32, 2621440
 buffer_load_dwordx4 v11, s[12:15], s45 offen  lds
 s_add_u32 m0, s49, 110592
 s_add_u32 s45, s32, 2752512
 buffer_load_dwordx4 v11, s[12:15], s45 offen  lds
 s_add_u32 m0, s49, 114688
 s_add_u32 s45, s33, 2621440
 buffer_load_dwordx4 v11, s[16:19], s45 offen  lds
 s_add_u32 m0, s49, 118784
 s_add_u32 s45, s33, 2752512
 buffer_load_dwordx4 v11, s[16:19], s45 offen  lds
 ds_read_b64_tr_b16 a[28:29], v8 offset:49152
 ds_read_b64_tr_b16 a[30:31], v8 offset:50176
 ds_read_b64_tr_b16 a[100:101], v9 offset:49152
 ds_read_b64_tr_b16 a[102:103], v9 offset:50176
 ds_read_b64_tr_b16 a[172:173], v8 offset:57344
 ds_read_b64_tr_b16 a[174:175], v8 offset:58368
 ds_read_b64_tr_b16 a[244:245], v9 offset:57344
 ds_read_b64_tr_b16 a[246:247], v9 offset:58368
 s_waitcnt vmcnt(8) lgkmcnt(0)
 s_barrier
 s_add_u32 m0, s49, 122880
 s_add_u32 s45, s32, 2883584
 buffer_load_dwordx4 v11, s[12:15], s45 offen  lds
 s_add_u32 m0, s49, 126976
 s_add_u32 s45, s32, 3014656
 buffer_load_dwordx4 v11, s[12:15], s45 offen  lds
 s_add_u32 m0, s49, 131072
 s_add_u32 s45, s33, 2883584
 buffer_load_dwordx4 v11, s[16:19], s45 offen  lds
 s_add_u32 m0, s49, 135168
 s_add_u32 s45, s33, 3014656
 buffer_load_dwordx4 v11, s[16:19], s45 offen  lds
 ds_read_b64_tr_b16 a[32:33], v8 offset:0
 ds_read_b64_tr_b16 a[34:35], v8 offset:1024
 ds_read_b64_tr_b16 a[104:105], v9 offset:0
 ds_read_b64_tr_b16 a[106:107], v9 offset:1024
 ds_read_b64_tr_b16 a[176:177], v8 offset:8192
 ds_read_b64_tr_b16 a[178:179], v8 offset:9216
 ds_read_b64_tr_b16 a[248:249], v9 offset:8192
 ds_read_b64_tr_b16 a[250:251], v9 offset:9216
 s_waitcnt vmcnt(8) lgkmcnt(0)
 s_barrier
 s_add_u32 m0, s49, 73728
 s_add_u32 s45, s32, 3145728
 buffer_load_dwordx4 v11, s[12:15], s45 offen  lds
 s_add_u32 m0, s49, 77824
 s_add_u32 s45, s32, 3276800
 buffer_load_dwordx4 v11, s[12:15], s45 offen  lds
 s_add_u32 m0, s49, 81920
 s_add_u32 s45, s33, 3145728
 buffer_load_dwordx4 v11, s[16:19], s45 offen  lds
 s_add_u32 m0, s49, 86016
 s_add_u32 s45, s33, 3276800
 buffer_load_dwordx4 v11, s[16:19], s45 offen  lds
 ds_read_b64_tr_b16 a[36:37], v8 offset:16384
 ds_read_b64_tr_b16 a[38:39], v8 offset:17408
 ds_read_b64_tr_b16 a[108:109], v9 offset:16384
 ds_read_b64_tr_b16 a[110:111], v9 offset:17408
 ds_read_b64_tr_b16 a[180:181], v8 offset:24576
 ds_read_b64_tr_b16 a[182:183], v8 offset:25600
 ds_read_b64_tr_b16 a[252:253], v9 offset:24576
 ds_read_b64_tr_b16 a[254:255], v9 offset:25600
 s_waitcnt vmcnt(8) lgkmcnt(0)
 s_barrier
 s_add_u32 m0, s49, 90112
 s_add_u32 s45, s32, 3407872
 buffer_load_dwordx4 v11, s[12:15], s45 offen  lds
 s_add_u32 m0, s49, 94208
 s_add_u32 s45, s32, 3538944
 buffer_load_dwordx4 v11, s[12:15], s45 offen  lds
 s_add_u32 m0, s49, 98304
 s_add_u32 s45, s33, 3407872
 buffer_load_dwordx4 v11, s[16:19], s45 offen  lds
 s_add_u32 m0, s49, 102400
 s_add_u32 s45, s33, 3538944
 buffer_load_dwordx4 v11, s[16:19], s45 offen  lds
 ds_read_b64_tr_b16 a[40:41], v8 offset:32768
 ds_read_b64_tr_b16 a[42:43], v8 offset:33792
 ds_read_b64_tr_b16 a[112:113], v9 offset:32768
 ds_read_b64_tr_b16 a[114:115], v9 offset:33792
 ds_read_b64_tr_b16 a[184:185], v8 offset:40960
 ds_read_b64_tr_b16 a[186:187], v8 offset:41984
 ds_read_b64_tr_b16 v[224:225], v9 offset:40960
 ds_read_b64_tr_b16 v[226:227], v9 offset:41984
 s_waitcnt vmcnt(8) lgkmcnt(0)
 s_barrier
 s_add_u32 m0, s49, 106496
 s_add_u32 s45, s32, 3670016
 buffer_load_dwordx4 v11, s[12:15], s45 offen  lds
 s_add_u32 m0, s49, 110592
 s_add_u32 s45, s32, 3801088
 buffer_load_dwordx4 v11, s[12:15], s45 offen  lds
 s_add_u32 m0, s49, 114688
 s_add_u32 s45, s33, 3670016
 buffer_load_dwordx4 v11, s[16:19], s45 offen  lds
 s_add_u32 m0, s49, 118784
 s_add_u32 s45, s33, 3801088
 buffer_load_dwordx4 v11, s[16:19], s45 offen  lds
 ds_read_b64_tr_b16 a[44:45], v8 offset:49152
 ds_read_b64_tr_b16 a[46:47], v8 offset:50176
 ds_read_b64_tr_b16 a[116:117], v9 offset:49152
 ds_read_b64_tr_b16 a[118:119], v9 offset:50176
 ds_read_b64_tr_b16 a[188:189], v8 offset:57344
 ds_read_b64_tr_b16 a[190:191], v8 offset:58368
 ds_read_b64_tr_b16 v[228:229], v9 offset:57344
 ds_read_b64_tr_b16 v[230:231], v9 offset:58368
 s_waitcnt vmcnt(8) lgkmcnt(0)
 s_barrier
 s_add_u32 m0, s49, 122880
 s_add_u32 s45, s32, 3932160
 buffer_load_dwordx4 v11, s[12:15], s45 offen  lds
 s_add_u32 m0, s49, 126976
 s_add_u32 s45, s32, 4063232
 buffer_load_dwordx4 v11, s[12:15], s45 offen  lds
 s_add_u32 m0, s49, 131072
 s_add_u32 s45, s33, 3932160
 buffer_load_dwordx4 v11, s[16:19], s45 offen  lds
 s_add_u32 m0, s49, 135168
 s_add_u32 s45, s33, 4063232
 buffer_load_dwordx4 v11, s[16:19], s45 offen  lds
 ds_read_b64_tr_b16 a[48:49], v8 offset:0
 ds_read_b64_tr_b16 a[50:51], v8 offset:1024
 ds_read_b64_tr_b16 a[120:121], v9 offset:0
 ds_read_b64_tr_b16 a[122:123], v9 offset:1024
 ds_read_b64_tr_b16 a[192:193], v8 offset:8192
 ds_read_b64_tr_b16 a[194:195], v8 offset:9216
 ds_read_b64_tr_b16 v[232:233], v9 offset:8192
 ds_read_b64_tr_b16 v[234:235], v9 offset:9216
 s_waitcnt vmcnt(8) lgkmcnt(0)
 s_barrier
 s_add_u32 m0, s49, 73728
 s_add_u32 s45, s32, 4194304
 buffer_load_dwordx4 v11, s[12:15], s45 offen  lds
 s_add_u32 m0, s49, 77824
 s_add_u32 s45, s32, 4325376
 buffer_load_dwordx4 v11, s[12:15], s45 offen  lds
 s_add_u32 m0, s49, 81920
 s_add_u32 s45, s33, 4194304
 buffer_load_dwordx4 v11, s[16:19], s45 offen  lds
 s_add_u32 m0, s49, 86016
 s_add_u32 s45, s33, 4325376
 buffer_load_dwordx4 v11, s[16:19], s45 offen  lds
 ds_read_b64_tr_b16 a[52:53], v8 offset:16384
 ds_read_b64_tr_b16 a[54:55], v8 offset:17408
 ds_read_b64_tr_b16 a[124:125], v9 offset:16384
 ds_read_b64_tr_b16 a[126:127], v9 offset:17408
 ds_read_b64_tr_b16 a[196:197], v8 offset:24576
 ds_read_b64_tr_b16 a[198:199], v8 offset:25600
 ds_read_b64_tr_b16 v[236:237], v9 offset:24576
 ds_read_b64_tr_b16 v[238:239], v9 offset:25600
 s_waitcnt vmcnt(8) lgkmcnt(0)
 s_barrier
 s_add_u32 m0, s49, 90112
 s_add_u32 s45, s32, 4456448
 buffer_load_dwordx4 v11, s[12:15], s45 offen  lds
 s_add_u32 m0, s49, 94208
 s_add_u32 s45, s32, 4587520
 buffer_load_dwordx4 v11, s[12:15], s45 offen  lds
 s_add_u32 m0, s49, 98304
 s_add_u32 s45, s33, 4456448
 buffer_load_dwordx4 v11, s[16:19], s45 offen  lds
 s_add_u32 m0, s49, 102400
 s_add_u32 s45, s33, 4587520
 buffer_load_dwordx4 v11, s[16:19], s45 offen  lds
 ds_read_b64_tr_b16 a[56:57], v8 offset:32768
 ds_read_b64_tr_b16 a[58:59], v8 offset:33792
 ds_read_b64_tr_b16 a[128:129], v9 offset:32768
 ds_read_b64_tr_b16 a[130:131], v9 offset:33792
 ds_read_b64_tr_b16 a[200:201], v8 offset:40960
 ds_read_b64_tr_b16 a[202:203], v8 offset:41984
 ds_read_b64_tr_b16 v[240:241], v9 offset:40960
 ds_read_b64_tr_b16 v[242:243], v9 offset:41984
 s_waitcnt vmcnt(8) lgkmcnt(0)
 s_barrier
 ds_read_b64_tr_b16 a[60:61], v8 offset:49152
 ds_read_b64_tr_b16 a[62:63], v8 offset:50176
 ds_read_b64_tr_b16 a[132:133], v9 offset:49152
 ds_read_b64_tr_b16 a[134:135], v9 offset:50176
 ds_read_b64_tr_b16 a[204:205], v8 offset:57344
 ds_read_b64_tr_b16 a[206:207], v8 offset:58368
 ds_read_b64_tr_b16 v[244:245], v9 offset:57344
 ds_read_b64_tr_b16 v[246:247], v9 offset:58368
 s_waitcnt vmcnt(4) lgkmcnt(0)
 s_barrier
 ds_read_b64_tr_b16 a[64:65], v8 offset:0
 ds_read_b64_tr_b16 a[66:67], v8 offset:1024
 ds_read_b64_tr_b16 a[136:137], v9 offset:0
 ds_read_b64_tr_b16 a[138:139], v9 offset:1024
 ds_read_b64_tr_b16 a[208:209], v8 offset:8192
 ds_read_b64_tr_b16 a[210:211], v8 offset:9216
 ds_read_b64_tr_b16 v[248:249], v9 offset:8192
 ds_read_b64_tr_b16 v[250:251], v9 offset:9216
 s_waitcnt vmcnt(0) lgkmcnt(0)
 s_barrier
 ds_read_b64_tr_b16 a[68:69], v8 offset:16384
 ds_read_b64_tr_b16 a[70:71], v8 offset:17408
 ds_read_b64_tr_b16 a[140:141], v9 offset:16384
 ds_read_b64_tr_b16 a[142:143], v9 offset:17408
 ds_read_b64_tr_b16 a[212:213], v8 offset:24576
 ds_read_b64_tr_b16 a[214:215], v8 offset:25600
 ds_read_b64_tr_b16 v[252:253], v9 offset:24576
 ds_read_b64_tr_b16 v[254:255], v9 offset:25600
 s_mov_b32 s50, 0x3e0293ee
 s_mov_b32 s42, 0
 s_mov_b32 s43, 0
 s_mov_b32 s44, 73728
 v_mov_b32 v6, v4
 v_mov_b32 v7, v5
 v_and_b32 v17, 63, v0
 v_lshlrev_b32 v1, 4, v17
 s_lshl_b32 s45, s4, 11
 s_add_u32 s45, s45, 147456
 v_add_u32 v2, s45, v1
 s_lshr_b32 s53, s4, 1
 s_and_b32 s54, s4, 1
 s_add_u32 s52, s52, s53
 s_lshl_b32 s53, s53, 13
 s_lshl_b32 s54, s54, 10
 s_add_u32 s45, s53, s54
 s_add_u32 s45, s45, 147456
 v_add_u32 v3, s45, v1
 s_lshl_b32 s63, s52, 13
 s_add_u32 s63, s63, s54
 s_add_u32 s63, s63, 0x7000000
 s_lshl_b32 s61, s52, 14
 s_add_u32 s61, s61, 0x3000000
 s_lshl_b32 s62, s52, 12
 s_add_u32 s62, s62, 0x400000
 s_lshl_b32 s57, s52, 7
 s_add_u32 s57, s57, 0x1000
 s_waitcnt lgkmcnt(0)
 v_min_u32 v8, 1, v0
 v_lshlrev_b32 v8, 28, v8
 s_mov_b32 s58, 0x40000
 v_mov_b32 v13, 0
 v_mov_b32 v14, 0
 v_min_u32 v15, 1, v17
 v_lshlrev_b32 v15, 28, v15
 v_bfe_u32 v18, v17, 3, 2
 v_and_b32 v19, 7, v17
 v_lshlrev_b32 v19, 7, v19
 v_lshl_add_u32 v18, v18, 11, v19
 v_lshrrev_b32 v19, 5, v17
 v_lshl_or_b32 v11, v19, 28, v18
 s_mov_b32 s56, s61
 v_mov_b32 v18, 0x44444444
 v_mov_b32 v19, 0xeeeeeeee
 v_and_b32 v20, 2, v17
 v_cmp_eq_u32 vcc, 0, v20
 s_nop 1
 v_cndmask_b32 v12, v19, v18, vcc
 v_mov_b32 v217, 0
 v_mov_b32 v218, 0
 v_mov_b32 v220, 0x3f803f80
 v_mov_b32 v221, 0x3f803f80
 v_mov_b32 v222, 0x3f803f80
 v_mov_b32 v223, 0x3f803f80
 v_and_b32 v18, 15, v17
 v_lshrrev_b32 v19, 4, v17
 v_lshlrev_b32 v19, 2, v19
 v_sub_u32 v18, v18, v19
 s_lshr_b32 s45, s54, 6
 v_add_u32 v18, s45, v18
 v_mov_b32 v19, 0xff800000
 v_cmp_le_i32 vcc, 0, v18
 s_nop 1
 v_cndmask_b32 v208, v19, v13, vcc
 v_cmp_le_i32 vcc, 1, v18
 s_nop 1
 v_cndmask_b32 v209, v19, v13, vcc
 v_cmp_le_i32 vcc, 2, v18
 s_nop 1
 v_cndmask_b32 v210, v19, v13, vcc
 v_cmp_le_i32 vcc, 3, v18
 s_nop 1
 v_cndmask_b32 v211, v19, v13, vcc
 v_cmp_le_i32 vcc, 16, v18
 s_nop 1
 v_cndmask_b32 v212, v19, v13, vcc
 v_cmp_le_i32 vcc, 17, v18
 s_nop 1
 v_cndmask_b32 v213, v19, v13, vcc
 v_cmp_le_i32 vcc, 18, v18
 s_nop 1
 v_cndmask_b32 v214, v19, v13, vcc
 v_cmp_le_i32 vcc, 19, v18
 s_nop 1
 v_cndmask_b32 v215, v19, v13, vcc
Lqs_22:
 buffer_load_dword v16, v15, s[20:23], s57 offen sc1
 s_waitcnt vmcnt(0)
 v_cmp_le_u32 vcc, 1, v16
 s_cbranch_vccnz Lqsk_23
 s_sleep 2
 s_sub_u32 s58, s58, 1
 s_cbranch_scc0 Lqs_22
 s_endpgm
Lqsk_23:
 s_waitcnt vmcnt(0) lgkmcnt(0)
 s_barrier
 ds_read_b128 v[32:35], v6 offset:0
 ds_read_b128 v[36:39], v6 offset:2048
 ds_read_b128 v[40:43], v7 offset:0
 ds_read_b128 v[44:47], v7 offset:2048
 s_waitcnt lgkmcnt(2)
Lqb_loop_24:
 v_mfma_f32_16x16x32_bf16 v[64:67], a[0:3], v[32:35], 0
 ds_read_b128 v[48:51], v6 offset:4096
 v_mfma_f32_16x16x32_bf16 v[72:75], a[72:75], v[32:35], 0
 ds_read_b128 v[52:55], v6 offset:6144
 v_mfma_f32_16x16x32_bf16 v[80:83], a[144:147], v[32:35], 0
 s_add_u32 s41, s40, 2
 v_mfma_f32_16x16x32_bf16 v[88:91], a[216:219], v[32:35], 0
 s_add_u32 s45, s42, 2
 s_mul_i32 s46, s41, 36864
 v_mfma_f32_16x16x32_bf16 v[68:71], a[0:3], v[36:39], 0
 s_cmp_lt_u32 s45, s36
 s_cselect_b32 s46, s46, 0
 v_mfma_f32_16x16x32_bf16 v[76:79], a[72:75], v[36:39], 0
 s_lshl_b32 s49, s4, 10
 s_add_u32 s49, s49, s44
 v_mfma_f32_16x16x32_bf16 v[84:87], a[144:147], v[36:39], 0
 s_lshl_b32 s53, s39, 19
 s_add_u32 s53, s53, s61
 v_mfma_f32_16x16x32_bf16 v[92:95], a[216:219], v[36:39], 0
 s_waitcnt lgkmcnt(2)
 v_mfma_f32_16x16x32_bf16 v[64:67], a[4:7], v[40:43], v[64:67]
 ds_read_b128 v[56:59], v7 offset:4096
 v_mfma_f32_16x16x32_bf16 v[72:75], a[76:79], v[40:43], v[72:75]
 ds_read_b128 v[60:63], v7 offset:6144
 v_mfma_f32_16x16x32_bf16 v[80:83], a[148:151], v[40:43], v[80:83]
 s_add_u32 m0, s49, 0
 v_mfma_f32_16x16x32_bf16 v[88:91], a[220:223], v[40:43], v[88:91]
 buffer_load_dwordx4 v10, s[8:11], s46 offen offset:0  lds
 v_mfma_f32_16x16x32_bf16 v[68:71], a[4:7], v[44:47], v[68:71]
 s_add_u32 m0, s49, 3968
 v_mfma_f32_16x16x32_bf16 v[76:79], a[76:79], v[44:47], v[76:79]
 buffer_load_dwordx4 v10, s[8:11], s46 offen offset:128  lds
 v_mfma_f32_16x16x32_bf16 v[84:87], a[148:151], v[44:47], v[84:87]
 s_lshl_b32 s55, s39, 17
 s_add_u32 s55, s55, s62
 v_mfma_f32_16x16x32_bf16 v[92:95], a[220:223], v[44:47], v[92:95]
 s_waitcnt lgkmcnt(2)
 v_mfma_f32_16x16x32_bf16 v[64:67], a[8:11], v[48:51], v[64:67]
 ds_read_b128 v[32:35], v6 offset:8192
 v_mfma_f32_16x16x32_bf16 v[72:75], a[80:83], v[48:51], v[72:75]
 ds_read_b128 v[36:39], v6 offset:10240
 v_mfma_f32_16x16x32_bf16 v[80:83], a[152:155], v[48:51], v[80:83]
 s_add_u32 m0, s49, 7936
 v_mfma_f32_16x16x32_bf16 v[88:91], a[224:227], v[48:51], v[88:91]
 buffer_load_dwordx4 v10, s[8:11], s46 offen offset:256  lds
 v_mfma_f32_16x16x32_bf16 v[68:71], a[8:11], v[52:55], v[68:71]
 s_add_u32 m0, s49, 11904
 v_mfma_f32_16x16x32_bf16 v[76:79], a[80:83], v[52:55], v[76:79]
 buffer_load_dwordx4 v10, s[8:11], s46 offen offset:384  lds
 v_mfma_f32_16x16x32_bf16 v[84:87], a[152:155], v[52:55], v[84:87]
 v_mfma_f32_16x16x32_bf16 v[92:95], a[224:227], v[52:55], v[92:95]
 s_waitcnt lgkmcnt(2)
 v_mfma_f32_16x16x32_bf16 v[64:67], a[12:15], v[56:59], v[64:67]
 ds_read_b128 v[40:43], v7 offset:8192
 v_mfma_f32_16x16x32_bf16 v[72:75], a[84:87], v[56:59], v[72:75]
 ds_read_b128 v[44:47], v7 offset:10240
 v_mfma_f32_16x16x32_bf16 v[80:83], a[156:159], v[56:59], v[80:83]
 s_add_u32 m0, s49, 15872
 v_mfma_f32_16x16x32_bf16 v[88:91], a[228:231], v[56:59], v[88:91]
 buffer_load_dwordx4 v10, s[8:11], s46 offen offset:512  lds
 v_mfma_f32_16x16x32_bf16 v[68:71], a[12:15], v[60:63], v[68:71]
 s_add_u32 m0, s49, 19840
 v_mfma_f32_16x16x32_bf16 v[76:79], a[84:87], v[60:63], v[76:79]
 buffer_load_dwordx4 v10, s[8:11], s46 offen offset:640  lds
 v_mfma_f32_16x16x32_bf16 v[84:87], a[156:159], v[60:63], v[84:87]
 s_add_u32 s60, s39, 1
 v_mfma_f32_16x16x32_bf16 v[92:95], a[228:231], v[60:63], v[92:95]
 s_waitcnt lgkmcnt(2)
 v_mfma_f32_16x16x32_bf16 v[64:67], a[16:19], v[32:35], v[64:67]
 ds_read_b128 v[48:51], v6 offset:12288
 v_mfma_f32_16x16x32_bf16 v[72:75], a[88:91], v[32:35], v[72:75]
 ds_read_b128 v[52:55], v6 offset:14336
 v_mfma_f32_16x16x32_bf16 v[80:83], a[160:163], v[32:35], v[80:83]
 s_add_u32 m0, s49, 23808
 v_mfma_f32_16x16x32_bf16 v[88:91], a[232:235], v[32:35], v[88:91]
 buffer_load_dwordx4 v10, s[8:11], s46 offen offset:768  lds
 v_mfma_f32_16x16x32_bf16 v[68:71], a[16:19], v[36:39], v[68:71]
 s_add_u32 m0, s49, 27776
 v_mfma_f32_16x16x32_bf16 v[76:79], a[88:91], v[36:39], v[76:79]
 buffer_load_dwordx4 v10, s[8:11], s46 offen offset:896  lds
 v_mfma_f32_16x16x32_bf16 v[84:87], a[160:163], v[36:39], v[84:87]
 v_mfma_f32_16x16x32_bf16 v[92:95], a[232:235], v[36:39], v[92:95]
 s_waitcnt lgkmcnt(2)
 v_mfma_f32_16x16x32_bf16 v[64:67], a[20:23], v[40:43], v[64:67]
 ds_read_b128 v[56:59], v7 offset:12288
 v_mfma_f32_16x16x32_bf16 v[72:75], a[92:95], v[40:43], v[72:75]
 ds_read_b128 v[60:63], v7 offset:14336
 v_mfma_f32_16x16x32_bf16 v[80:83], a[164:167], v[40:43], v[80:83]
 s_add_u32 m0, s49, 31744
 v_mfma_f32_16x16x32_bf16 v[88:91], a[236:239], v[40:43], v[88:91]
 buffer_load_dwordx4 v10, s[8:11], s46 offen offset:1024  lds
 v_mfma_f32_16x16x32_bf16 v[68:71], a[20:23], v[44:47], v[68:71]
 v_mfma_f32_16x16x32_bf16 v[76:79], a[92:95], v[44:47], v[76:79]
 v_mfma_f32_16x16x32_bf16 v[84:87], a[164:167], v[44:47], v[84:87]
 v_mfma_f32_16x16x32_bf16 v[92:95], a[236:239], v[44:47], v[92:95]
 s_waitcnt lgkmcnt(2)
 v_mfma_f32_16x16x32_bf16 v[64:67], a[24:27], v[48:51], v[64:67]
 ds_read_b128 v[32:35], v6 offset:16384
 v_mfma_f32_16x16x32_bf16 v[72:75], a[96:99], v[48:51], v[72:75]
 ds_read_b128 v[36:39], v6 offset:18432
 v_mfma_f32_16x16x32_bf16 v[80:83], a[168:171], v[48:51], v[80:83]
 s_waitcnt vmcnt(9)
 buffer_load_dword v17, v11, s[20:23], s56 offen sc1
 v_mfma_f32_16x16x32_bf16 v[88:91], a[240:243], v[48:51], v[88:91]
 s_barrier
 buffer_store_dword v14, v8, s[20:23], s59 offen sc1
 v_mfma_f32_16x16x32_bf16 v[68:71], a[24:27], v[52:55], v[68:71]
 buffer_load_dword v16, v15, s[20:23], s57 offen sc1
 v_mfma_f32_16x16x32_bf16 v[76:79], a[96:99], v[52:55], v[76:79]
 v_mfma_f32_16x16x32_bf16 v[84:87], a[168:171], v[52:55], v[84:87]
 s_lshl_b32 s56, s39, 18
 s_add_u32 s56, s56, s63
 v_mfma_f32_16x16x32_bf16 v[92:95], a[240:243], v[52:55], v[92:95]
 s_waitcnt lgkmcnt(2)
 v_mfma_f32_16x16x32_bf16 v[64:67], a[28:31], v[56:59], v[64:67]
 ds_read_b128 v[40:43], v7 offset:16384
 v_mfma_f32_16x16x32_bf16 v[72:75], a[100:103], v[56:59], v[72:75]
 ds_read_b128 v[44:47], v7 offset:18432
 v_mfma_f32_16x16x32_bf16 v[80:83], a[172:175], v[56:59], v[80:83]
 buffer_load_dwordx4 v[128:131], v1, s[20:23], s53 offen offset:0 sc1
 v_mfma_f32_16x16x32_bf16 v[88:91], a[244:247], v[56:59], v[88:91]
 v_mfma_f32_16x16x32_bf16 v[68:71], a[28:31], v[60:63], v[68:71]
 buffer_load_dwordx4 v[132:135], v1, s[20:23], s53 offen offset:1024 sc1
 v_mfma_f32_16x16x32_bf16 v[76:79], a[100:103], v[60:63], v[76:79]
 v_mfma_f32_16x16x32_bf16 v[84:87], a[172:175], v[60:63], v[84:87]
 v_mfma_f32_16x16x32_bf16 v[92:95], a[244:247], v[60:63], v[92:95]
 s_waitcnt lgkmcnt(2)
 v_mfma_f32_16x16x32_bf16 v[64:67], a[32:35], v[32:35], v[64:67]
 ds_read_b128 v[48:51], v6 offset:20480
 v_mfma_f32_16x16x32_bf16 v[72:75], a[104:107], v[32:35], v[72:75]
 ds_read_b128 v[52:55], v6 offset:22528
 v_mfma_f32_16x16x32_bf16 v[80:83], a[176:179], v[32:35], v[80:83]
 buffer_load_dwordx4 v[136:139], v1, s[20:23], s53 offen offset:2048 sc1
 v_mfma_f32_16x16x32_bf16 v[88:91], a[248:251], v[32:35], v[88:91]
 v_mfma_f32_16x16x32_bf16 v[68:71], a[32:35], v[36:39], v[68:71]
 buffer_load_dwordx4 v[140:143], v1, s[20:23], s53 offen offset:3072 sc1
 v_mfma_f32_16x16x32_bf16 v[76:79], a[104:107], v[36:39], v[76:79]
 v_mfma_f32_16x16x32_bf16 v[84:87], a[176:179], v[36:39], v[84:87]
 s_add_u32 s53, s53, 4096
 v_mfma_f32_16x16x32_bf16 v[92:95], a[248:251], v[36:39], v[92:95]
 s_waitcnt lgkmcnt(2)
 v_mfma_f32_16x16x32_bf16 v[64:67], a[36:39], v[40:43], v[64:67]
 ds_read_b128 v[56:59], v7 offset:20480
 v_mfma_f32_16x16x32_bf16 v[72:75], a[108:111], v[40:43], v[72:75]
 ds_read_b128 v[60:63], v7 offset:22528
 v_mfma_f32_16x16x32_bf16 v[80:83], a[180:183], v[40:43], v[80:83]
 buffer_load_dwordx4 v[144:147], v1, s[20:23], s53 offen offset:0 sc1
 v_mfma_f32_16x16x32_bf16 v[88:91], a[252:255], v[40:43], v[88:91]
 v_mfma_f32_16x16x32_bf16 v[68:71], a[36:39], v[44:47], v[68:71]
 buffer_load_dwordx4 v[148:151], v1, s[20:23], s53 offen offset:1024 sc1
 v_mfma_f32_16x16x32_bf16 v[76:79], a[108:111], v[44:47], v[76:79]
 v_mfma_f32_16x16x32_bf16 v[84:87], a[180:183], v[44:47], v[84:87]
 v_mfma_f32_16x16x32_bf16 v[92:95], a[252:255], v[44:47], v[92:95]
 s_waitcnt lgkmcnt(2)
 v_mfma_f32_16x16x32_bf16 v[64:67], a[40:43], v[48:51], v[64:67]
 ds_read_b128 v[32:35], v6 offset:24576
 v_mfma_f32_16x16x32_bf16 v[72:75], a[112:115], v[48:51], v[72:75]
 ds_read_b128 v[36:39], v6 offset:26624
 v_mfma_f32_16x16x32_bf16 v[80:83], a[184:187], v[48:51], v[80:83]
 buffer_load_dwordx4 v[152:155], v1, s[20:23], s53 offen offset:2048 sc1
 v_mfma_f32_16x16x32_bf16 v[88:91], v[224:227], v[48:51], v[88:91]
 v_mfma_f32_16x16x32_bf16 v[68:71], a[40:43], v[52:55], v[68:71]
 buffer_load_dwordx4 v[156:159], v1, s[20:23], s53 offen offset:3072 sc1
 v_mfma_f32_16x16x32_bf16 v[76:79], a[112:115], v[52:55], v[76:79]
 v_mfma_f32_16x16x32_bf16 v[84:87], a[184:187], v[52:55], v[84:87]
 s_add_u32 s53, s53, 4096
 v_mfma_f32_16x16x32_bf16 v[92:95], v[224:227], v[52:55], v[92:95]
 s_waitcnt lgkmcnt(2)
 v_mfma_f32_16x16x32_bf16 v[64:67], a[44:47], v[56:59], v[64:67]
 ds_read_b128 v[40:43], v7 offset:24576
 v_mfma_f32_16x16x32_bf16 v[72:75], a[116:119], v[56:59], v[72:75]
 ds_read_b128 v[44:47], v7 offset:26624
 v_mfma_f32_16x16x32_bf16 v[80:83], a[188:191], v[56:59], v[80:83]
 buffer_load_dwordx4 v[160:163], v1, s[20:23], s53 offen offset:0 sc1
 v_mfma_f32_16x16x32_bf16 v[88:91], v[228:231], v[56:59], v[88:91]
 v_mfma_f32_16x16x32_bf16 v[68:71], a[44:47], v[60:63], v[68:71]
 buffer_load_dwordx4 v[164:167], v1, s[20:23], s53 offen offset:1024 sc1
 v_mfma_f32_16x16x32_bf16 v[76:79], a[116:119], v[60:63], v[76:79]
 v_mfma_f32_16x16x32_bf16 v[84:87], a[188:191], v[60:63], v[84:87]
 v_mfma_f32_16x16x32_bf16 v[92:95], v[228:231], v[60:63], v[92:95]
 s_waitcnt lgkmcnt(2)
 v_mfma_f32_16x16x32_bf16 v[64:67], a[48:51], v[32:35], v[64:67]
 ds_read_b128 v[48:51], v6 offset:28672
 v_mfma_f32_16x16x32_bf16 v[72:75], a[120:123], v[32:35], v[72:75]
 ds_read_b128 v[52:55], v6 offset:30720
 v_mfma_f32_16x16x32_bf16 v[80:83], a[192:195], v[32:35], v[80:83]
 buffer_load_dwordx4 v[168:171], v1, s[20:23], s53 offen offset:2048 sc1
 v_mfma_f32_16x16x32_bf16 v[88:91], v[232:235], v[32:35], v[88:91]
 v_mfma_f32_16x16x32_bf16 v[68:71], a[48:51], v[36:39], v[68:71]
 buffer_load_dwordx4 v[172:175], v1, s[20:23], s53 offen offset:3072 sc1
 v_mfma_f32_16x16x32_bf16 v[76:79], a[120:123], v[36:39], v[76:79]
 v_mfma_f32_16x16x32_bf16 v[84:87], a[192:195], v[36:39], v[84:87]
 s_add_u32 s53, s53, 4096
 v_mfma_f32_16x16x32_bf16 v[92:95], v[232:235], v[36:39], v[92:95]
 s_waitcnt lgkmcnt(2)
 v_mfma_f32_16x16x32_bf16 v[64:67], a[52:55], v[40:43], v[64:67]
 ds_read_b128 v[56:59], v7 offset:28672
 v_mfma_f32_16x16x32_bf16 v[72:75], a[124:127], v[40:43], v[72:75]
 ds_read_b128 v[60:63], v7 offset:30720
 v_mfma_f32_16x16x32_bf16 v[80:83], a[196:199], v[40:43], v[80:83]
 s_add_u32 s43, s43, 36864
 s_cmp_eq_u32 s43, 147456
 buffer_load_dwordx4 v[176:179], v1, s[20:23], s53 offen offset:0 sc1
 v_mfma_f32_16x16x32_bf16 v[88:91], v[236:239], v[40:43], v[88:91]
 s_cselect_b32 s43, 0, s43
 s_add_u32 s44, s44, 36864
 v_mfma_f32_16x16x32_bf16 v[68:71], a[52:55], v[44:47], v[68:71]
 s_cmp_eq_u32 s44, 147456
 s_cselect_b32 s44, 0, s44
 buffer_load_dwordx4 v[180:183], v1, s[20:23], s53 offen offset:1024 sc1
 v_mfma_f32_16x16x32_bf16 v[76:79], a[124:127], v[44:47], v[76:79]
 v_mfma_f32_16x16x32_bf16 v[84:87], a[196:199], v[44:47], v[84:87]
 v_mfma_f32_16x16x32_bf16 v[92:95], v[236:239], v[44:47], v[92:95]
 s_waitcnt lgkmcnt(2)
 v_mfma_f32_16x16x32_bf16 v[64:67], a[56:59], v[48:51], v[64:67]
 ds_read_b128 v[32:35], v6 offset:32768
 v_mfma_f32_16x16x32_bf16 v[72:75], a[128:131], v[48:51], v[72:75]
 ds_read_b128 v[36:39], v6 offset:34816
 v_mfma_f32_16x16x32_bf16 v[80:83], a[200:203], v[48:51], v[80:83]
 v_add_u32 v6, s43, v4
 buffer_load_dwordx4 v[184:187], v1, s[20:23], s53 offen offset:2048 sc1
 v_mfma_f32_16x16x32_bf16 v[88:91], v[240:243], v[48:51], v[88:91]
 v_mfma_f32_16x16x32_bf16 v[68:71], a[56:59], v[52:55], v[68:71]
 buffer_load_dwordx4 v[188:191], v1, s[20:23], s53 offen offset:3072 sc1
 v_mfma_f32_16x16x32_bf16 v[76:79], a[128:131], v[52:55], v[76:79]
 v_mfma_f32_16x16x32_bf16 v[84:87], a[200:203], v[52:55], v[84:87]
 v_mfma_f32_16x16x32_bf16 v[92:95], v[240:243], v[52:55], v[92:95]
 s_waitcnt lgkmcnt(2)
 v_mfma_f32_16x16x32_bf16 v[64:67], a[60:63], v[56:59], v[64:67]
 ds_read_b128 v[40:43], v7 offset:32768
 v_mfma_f32_16x16x32_bf16 v[72:75], a[132:135], v[56:59], v[72:75]
 ds_read_b128 v[44:47], v7 offset:34816
 v_mfma_f32_16x16x32_bf16 v[80:83], a[204:207], v[56:59], v[80:83]
 v_add_u32 v7, s43, v5
 v_mfma_f32_16x16x32_bf16 v[88:91], v[244:247], v[56:59], v[88:91]
 v_mfma_f32_16x16x32_bf16 v[68:71], a[60:63], v[60:63], v[68:71]
 v_mfma_f32_16x16x32_bf16 v[76:79], a[132:135], v[60:63], v[76:79]
 v_mfma_f32_16x16x32_bf16 v[84:87], a[204:207], v[60:63], v[84:87]
 v_mfma_f32_16x16x32_bf16 v[92:95], v[244:247], v[60:63], v[92:95]
 s_waitcnt lgkmcnt(2)
 v_mfma_f32_16x16x32_bf16 v[64:67], a[64:67], v[32:35], v[64:67]
 s_waitcnt vmcnt(28)
 s_barrier
 ds_read_b128 v[48:51], v6 offset:0
 v_mfma_f32_16x16x32_bf16 v[72:75], a[136:139], v[32:35], v[72:75]
 ds_read_b128 v[52:55], v6 offset:2048
 v_mfma_f32_16x16x32_bf16 v[80:83], a[208:211], v[32:35], v[80:83]
 v_mfma_f32_16x16x32_bf16 v[88:91], v[248:251], v[32:35], v[88:91]
 s_waitcnt vmcnt(16)
 v_cmp_le_u32 vcc, s60, v16
 v_mfma_f32_16x16x32_bf16 v[68:71], a[64:67], v[36:39], v[68:71]
 v_mfma_f32_16x16x32_bf16 v[76:79], a[136:139], v[36:39], v[76:79]
 s_and_b32 s64, vcc_lo, 1
 s_cbranch_scc0 Lqsk_25
 buffer_load_dwordx4 v[192:195], v1, s[20:23], s55 offen offset:0 sc1
 buffer_load_dwordx4 v[196:199], v1, s[20:23], s55 offen offset:1024 sc1
 buffer_load_dwordx4 v[200:203], v1, s[20:23], s55 offen offset:2048 sc1
 buffer_load_dwordx4 v[204:207], v1, s[20:23], s55 offen offset:3072 sc1
Lqsk_25:
 v_mfma_f32_16x16x32_bf16 v[84:87], a[208:211], v[36:39], v[84:87]
 v_mfma_f32_16x16x32_bf16 v[92:95], v[248:251], v[36:39], v[92:95]
 s_waitcnt lgkmcnt(2)
 v_mfma_f32_16x16x32_bf16 v[64:67], a[68:71], v[40:43], v[64:67]
 ds_read_b128 v[56:59], v7 offset:0
 v_mfma_f32_16x16x32_bf16 v[72:75], a[140:143], v[40:43], v[72:75]
 ds_read_b128 v[60:63], v7 offset:2048
 v_mfma_f32_16x16x32_bf16 v[80:83], a[212:215], v[40:43], v[80:83]
 v_mfma_f32_16x16x32_bf16 v[88:91], v[252:255], v[40:43], v[88:91]
 s_mov_b32 s39, s40
 s_mov_b32 s40, s41
 v_mfma_f32_16x16x32_bf16 v[68:71], a[68:71], v[44:47], v[68:71]
 s_add_u32 s42, s42, 1
 v_mov_b32 v14, s42
 v_mfma_f32_16x16x32_bf16 v[76:79], a[140:143], v[44:47], v[76:79]
 v_mfma_f32_16x16x32_bf16 v[84:87], a[212:215], v[44:47], v[84:87]
 v_mfma_f32_16x16x32_bf16 v[92:95], v[252:255], v[44:47], v[92:95]
 s_waitcnt lgkmcnt(2)
 s_nop 7
 v_cvt_pk_bf16_f32 v16, v64, v72
 v_cvt_pk_bf16_f32 v17, v65, v73
 v_cvt_pk_bf16_f32 v18, v66, v74
 v_cvt_pk_bf16_f32 v19, v67, v75
 ds_write_b128 v2, v[16:19] offset:0
 v_cvt_pk_bf16_f32 v20, v68, v76
 v_cvt_pk_bf16_f32 v21, v69, v77
 v_cvt_pk_bf16_f32 v22, v70, v78
 v_cvt_pk_bf16_f32 v23, v71, v79
 ds_write_b128 v2, v[20:23] offset:1024
 v_cvt_pk_bf16_f32 v24, v80, v88
 v_cvt_pk_bf16_f32 v25, v81, v89
 v_cvt_pk_bf16_f32 v26, v82, v90
 v_cvt_pk_bf16_f32 v27, v83, v91
 ds_write_b128 v2, v[24:27] offset:8192
 v_cvt_pk_bf16_f32 v28, v84, v92
 v_cvt_pk_bf16_f32 v29, v85, v93
 v_cvt_pk_bf16_f32 v30, v86, v94
 v_cvt_pk_bf16_f32 v31, v87, v95
 ds_write_b128 v2, v[28:31] offset:9216
 v_mov_b64 v[120:121], 0
 v_mov_b64 v[122:123], 0
 s_waitcnt lgkmcnt(0)
 s_barrier
 ds_read_b128 v[96:99], v3 offset:0
 ds_read_b128 v[100:103], v3 offset:2048
 ds_read_b128 v[104:107], v3 offset:4096
 ds_read_b128 v[108:111], v3 offset:6144
 s_cmp_lg_u32 s64, 0
 s_cbranch_scc1 Lqpre_26
Lqs_27:
 buffer_load_dword v16, v15, s[20:23], s57 offen sc1
 s_waitcnt vmcnt(0)
 v_cmp_le_u32 vcc, s60, v16
 s_cbranch_vccnz Lqsk_28
 s_sleep 2
 s_sub_u32 s58, s58, 1
 s_cbranch_scc0 Lqs_27
 s_endpgm
Lqsk_28:
 buffer_load_dwordx4 v[192:195], v1, s[20:23], s55 offen offset:0 sc1
 buffer_load_dwordx4 v[196:199], v1, s[20:23], s55 offen offset:1024 sc1
 buffer_load_dwordx4 v[200:203], v1, s[20:23], s55 offen offset:2048 sc1
 buffer_load_dwordx4 v[204:207], v1, s[20:23], s55 offen offset:3072 sc1
Lqpre_26:
 s_waitcnt vmcnt(4) lgkmcnt(0)
 v_mfma_f32_16x16x32_bf16 v[112:115], v[128:131], v[96:99], v[208:211]
 v_mfma_f32_16x16x32_bf16 v[116:119], v[132:135], v[96:99], v[212:215]
 v_mfma_f32_16x16x32_bf16 v[112:115], v[136:139], v[100:103], v[112:115]
 v_mfma_f32_16x16x32_bf16 v[116:119], v[140:143], v[100:103], v[116:119]
 v_mfma_f32_16x16x32_bf16 v[112:115], v[144:147], v[104:107], v[112:115]
 v_mfma_f32_16x16x32_bf16 v[116:119], v[148:151], v[104:107], v[116:119]
 v_mfma_f32_16x16x32_bf16 v[112:115], v[152:155], v[108:111], v[112:115]
 v_mfma_f32_16x16x32_bf16 v[116:119], v[156:159], v[108:111], v[116:119]
 s_nop 7
 v_max3_f32 v24, v112, v113, v114
 v_max3_f32 v24, v24, v115, v116
 v_max3_f32 v24, v24, v117, v118
 v_max_f32 v24, v24, v119
 s_waitcnt vmcnt(2)
 v_mov_b64 v[16:17], v[192:193]
 v_mov_b64 v[18:19], v[196:197]
 s_nop 1
 v_smfmac_f32_16x16x64_bf16 v[120:123], v[16:19], v[96:103], v12
 s_waitcnt vmcnt(0)
 v_mov_b64 v[20:21], v[200:201]
 v_mov_b64 v[22:23], v[204:205]
 s_nop 1
 v_smfmac_f32_16x16x64_bf16 v[120:123], v[20:23], v[104:111], v12
 s_nop 7
 v_add_f32 v120, v120, v122
 v_add_f32 v121, v121, v123
 v_mul_f32 v120, s50, v120
 v_mul_f32 v121, s50, v121
 v_max3_f32 v24, v24, v120, v121
 v_mov_b32 v25, v24
 s_nop 1
 v_permlane16_swap_b32 v24, v25
 v_max_f32 v24, v24, v25
 v_mov_b32 v25, v24
 s_nop 1
 v_permlane32_swap_b32 v24, v25
 v_max_f32 v24, v24, v25
 v_sub_f32 v112, v112, v24
 v_sub_f32 v113, v113, v24
 v_sub_f32 v114, v114, v24
 v_sub_f32 v115, v115, v24
 v_sub_f32 v116, v116, v24
 v_sub_f32 v117, v117, v24
 v_sub_f32 v118, v118, v24
 v_sub_f32 v119, v119, v24
 v_sub_f32 v120, v120, v24
 v_sub_f32 v121, v121, v24
 v_exp_f32 v120, v120
 v_exp_f32 v121, v121
 v_exp_f32 v112, v112
 v_exp_f32 v113, v113
 v_exp_f32 v114, v114
 v_exp_f32 v115, v115
 v_exp_f32 v116, v116
 v_exp_f32 v117, v117
 v_exp_f32 v118, v118
 v_exp_f32 v119, v119
 v_cvt_pk_bf16_f32 v216, v120, v121
 v_cvt_pk_bf16_f32 v219, v120, v121
 v_cvt_pk_bf16_f32 v28, v112, v113
 v_cvt_pk_bf16_f32 v29, v116, v117
 v_cvt_pk_bf16_f32 v30, v114, v115
 v_cvt_pk_bf16_f32 v31, v118, v119
 v_mfma_f32_16x16x16_bf16 v[124:127], v[220:221], v[216:217], 0
 v_mfma_f32_16x16x16_bf16 v[64:67], v[194:195], v[216:217], 0
 v_mfma_f32_16x16x16_bf16 v[68:71], v[194:195], v[218:219], 0
 v_mfma_f32_16x16x16_bf16 v[72:75], v[198:199], v[216:217], 0
 v_mfma_f32_16x16x16_bf16 v[76:79], v[198:199], v[218:219], 0
 v_mfma_f32_16x16x16_bf16 v[80:83], v[202:203], v[216:217], 0
 v_mfma_f32_16x16x16_bf16 v[84:87], v[202:203], v[218:219], 0
 v_mfma_f32_16x16x16_bf16 v[88:91], v[206:207], v[216:217], 0
 v_mfma_f32_16x16x16_bf16 v[92:95], v[206:207], v[218:219], 0
 v_mfma_f32_16x16x32_bf16 v[124:127], v[220:223], v[28:31], v[124:127]
 v_mfma_f32_16x16x32_bf16 v[64:67], v[160:163], v[28:31], v[64:67]
 v_mfma_f32_16x16x32_bf16 v[68:71], v[164:167], v[28:31], v[68:71]
 v_mfma_f32_16x16x32_bf16 v[72:75], v[168:171], v[28:31], v[72:75]
 v_mfma_f32_16x16x32_bf16 v[76:79], v[172:175], v[28:31], v[76:79]
 v_mfma_f32_16x16x32_bf16 v[80:83], v[176:179], v[28:31], v[80:83]
 v_mfma_f32_16x16x32_bf16 v[84:87], v[180:183], v[28:31], v[84:87]
 v_mfma_f32_16x16x32_bf16 v[88:91], v[184:187], v[28:31], v[88:91]
 v_mfma_f32_16x16x32_bf16 v[92:95], v[188:191], v[28:31], v[92:95]
 v_rcp_f32 v124, v124
 s_add_u32 s45, s56, 4096
 v_mul_f32 v64, v64, v124
 v_mul_f32 v65, v65, v124
 v_mul_f32 v66, v66, v124
 v_mul_f32 v67, v67, v124
 v_mul_f32 v68, v68, v124
 v_mul_f32 v69, v69, v124
 v_mul_f32 v70, v70, v124
 v_mul_f32 v71, v71, v124
 v_cvt_pk_bf16_f32 v96, v64, v65
 v_cvt_pk_bf16_f32 v97, v68, v69
 v_cvt_pk_bf16_f32 v98, v66, v67
 v_cvt_pk_bf16_f32 v99, v70, v71
 buffer_store_dwordx4 v[96:99], v1, s[20:23], s56 offen offset:0 sc1
 v_mul_f32 v72, v72, v124
 v_mul_f32 v73, v73, v124
 v_mul_f32 v74, v74, v124
 v_mul_f32 v75, v75, v124
 v_mul_f32 v76, v76, v124
 v_mul_f32 v77, v77, v124
 v_mul_f32 v78, v78, v124
 v_mul_f32 v79, v79, v124
 v_cvt_pk_bf16_f32 v100, v72, v73
 v_cvt_pk_bf16_f32 v101, v76, v77
 v_cvt_pk_bf16_f32 v102, v74, v75
 v_cvt_pk_bf16_f32 v103, v78, v79
 buffer_store_dwordx4 v[100:103], v1, s[20:23], s56 offen offset:2048 sc1
 v_mul_f32 v80, v80, v124
 v_mul_f32 v81, v81, v124
 v_mul_f32 v82, v82, v124
 v_mul_f32 v83, v83, v124
 v_mul_f32 v84, v84, v124
 v_mul_f32 v85, v85, v124
 v_mul_f32 v86, v86, v124
 v_mul_f32 v87, v87, v124
 v_cvt_pk_bf16_f32 v104, v80, v81
 v_cvt_pk_bf16_f32 v105, v84, v85
 v_cvt_pk_bf16_f32 v106, v82, v83
 v_cvt_pk_bf16_f32 v107, v86, v87
 buffer_store_dwordx4 v[104:107], v1, s[20:23], s45 offen offset:0 sc1
 v_mul_f32 v88, v88, v124
 v_mul_f32 v89, v89, v124
 v_mul_f32 v90, v90, v124
 v_mul_f32 v91, v91, v124
 v_mul_f32 v92, v92, v124
 v_mul_f32 v93, v93, v124
 v_mul_f32 v94, v94, v124
 v_mul_f32 v95, v95, v124
 v_cvt_pk_bf16_f32 v108, v88, v89
 v_cvt_pk_bf16_f32 v109, v92, v93
 v_cvt_pk_bf16_f32 v110, v90, v91
 v_cvt_pk_bf16_f32 v111, v94, v95
 buffer_store_dwordx4 v[108:111], v1, s[20:23], s45 offen offset:2048 sc1
 v_mfma_f32_16x16x32_bf16 v[64:67], a[0:3], v[48:51], 0
 ds_read_b128 v[32:35], v6 offset:4096
 v_mfma_f32_16x16x32_bf16 v[72:75], a[72:75], v[48:51], 0
 ds_read_b128 v[36:39], v6 offset:6144
 v_mfma_f32_16x16x32_bf16 v[80:83], a[144:147], v[48:51], 0
 s_add_u32 s41, s40, 2
 v_mfma_f32_16x16x32_bf16 v[88:91], a[216:219], v[48:51], 0
 s_add_u32 s45, s42, 2
 s_mul_i32 s46, s41, 36864
 v_mfma_f32_16x16x32_bf16 v[68:71], a[0:3], v[52:55], 0
 s_cmp_lt_u32 s45, s36
 s_cselect_b32 s46, s46, 0
 v_mfma_f32_16x16x32_bf16 v[76:79], a[72:75], v[52:55], 0
 s_lshl_b32 s49, s4, 10
 s_add_u32 s49, s49, s44
 v_mfma_f32_16x16x32_bf16 v[84:87], a[144:147], v[52:55], 0
 s_lshl_b32 s53, s39, 19
 s_add_u32 s53, s53, s61
 v_mfma_f32_16x16x32_bf16 v[92:95], a[216:219], v[52:55], 0
 s_waitcnt lgkmcnt(2)
 v_mfma_f32_16x16x32_bf16 v[64:67], a[4:7], v[56:59], v[64:67]
 ds_read_b128 v[40:43], v7 offset:4096
 v_mfma_f32_16x16x32_bf16 v[72:75], a[76:79], v[56:59], v[72:75]
 ds_read_b128 v[44:47], v7 offset:6144
 v_mfma_f32_16x16x32_bf16 v[80:83], a[148:151], v[56:59], v[80:83]
 s_add_u32 m0, s49, 0
 v_mfma_f32_16x16x32_bf16 v[88:91], a[220:223], v[56:59], v[88:91]
 buffer_load_dwordx4 v10, s[8:11], s46 offen offset:0  lds
 v_mfma_f32_16x16x32_bf16 v[68:71], a[4:7], v[60:63], v[68:71]
 s_add_u32 m0, s49, 3968
 v_mfma_f32_16x16x32_bf16 v[76:79], a[76:79], v[60:63], v[76:79]
 buffer_load_dwordx4 v10, s[8:11], s46 offen offset:128  lds
 v_mfma_f32_16x16x32_bf16 v[84:87], a[148:151], v[60:63], v[84:87]
 s_lshl_b32 s55, s39, 17
 s_add_u32 s55, s55, s62
 v_mfma_f32_16x16x32_bf16 v[92:95], a[220:223], v[60:63], v[92:95]
 s_waitcnt lgkmcnt(2)
 v_mfma_f32_16x16x32_bf16 v[64:67], a[8:11], v[32:35], v[64:67]
 ds_read_b128 v[48:51], v6 offset:8192
 v_mfma_f32_16x16x32_bf16 v[72:75], a[80:83], v[32:35], v[72:75]
 ds_read_b128 v[52:55], v6 offset:10240
 v_mfma_f32_16x16x32_bf16 v[80:83], a[152:155], v[32:35], v[80:83]
 s_add_u32 m0, s49, 7936
 v_mfma_f32_16x16x32_bf16 v[88:91], a[224:227], v[32:35], v[88:91]
 buffer_load_dwordx4 v10, s[8:11], s46 offen offset:256  lds
 v_mfma_f32_16x16x32_bf16 v[68:71], a[8:11], v[36:39], v[68:71]
 s_add_u32 m0, s49, 11904
 v_mfma_f32_16x16x32_bf16 v[76:79], a[80:83], v[36:39], v[76:79]
 buffer_load_dwordx4 v10, s[8:11], s46 offen offset:384  lds
 v_mfma_f32_16x16x32_bf16 v[84:87], a[152:155], v[36:39], v[84:87]
 v_mfma_f32_16x16x32_bf16 v[92:95], a[224:227], v[36:39], v[92:95]
 s_waitcnt lgkmcnt(2)
 v_mfma_f32_16x16x32_bf16 v[64:67], a[12:15], v[40:43], v[64:67]
 ds_read_b128 v[56:59], v7 offset:8192
 v_mfma_f32_16x16x32_bf16 v[72:75], a[84:87], v[40:43], v[72:75]
 ds_read_b128 v[60:63], v7 offset:10240
 v_mfma_f32_16x16x32_bf16 v[80:83], a[156:159], v[40:43], v[80:83]
 s_add_u32 m0, s49, 15872
 v_mfma_f32_16x16x32_bf16 v[88:91], a[228:231], v[40:43], v[88:91]
 buffer_load_dwordx4 v10, s[8:11], s46 offen offset:512  lds
 v_mfma_f32_16x16x32_bf16 v[68:71], a[12:15], v[44:47], v[68:71]
 s_add_u32 m0, s49, 19840
 v_mfma_f32_16x16x32_bf16 v[76:79], a[84:87], v[44:47], v[76:79]
 buffer_load_dwordx4 v10, s[8:11], s46 offen offset:640  lds
 v_mfma_f32_16x16x32_bf16 v[84:87], a[156:159], v[44:47], v[84:87]
 s_add_u32 s60, s39, 1
 v_mfma_f32_16x16x32_bf16 v[92:95], a[228:231], v[44:47], v[92:95]
 s_waitcnt lgkmcnt(2)
 v_mfma_f32_16x16x32_bf16 v[64:67], a[16:19], v[48:51], v[64:67]
 ds_read_b128 v[32:35], v6 offset:12288
 v_mfma_f32_16x16x32_bf16 v[72:75], a[88:91], v[48:51], v[72:75]
 ds_read_b128 v[36:39], v6 offset:14336
 v_mfma_f32_16x16x32_bf16 v[80:83], a[160:163], v[48:51], v[80:83]
 s_add_u32 m0, s49, 23808
 v_mfma_f32_16x16x32_bf16 v[88:91], a[232:235], v[48:51], v[88:91]
 buffer_load_dwordx4 v10, s[8:11], s46 offen offset:768  lds
 v_mfma_f32_16x16x32_bf16 v[68:71], a[16:19], v[52:55], v[68:71]
 s_add_u32 m0, s49, 27776
 v_mfma_f32_16x16x32_bf16 v[76:79], a[88:91], v[52:55], v[76:79]
 buffer_load_dwordx4 v10, s[8:11], s46 offen offset:896  lds
 v_mfma_f32_16x16x32_bf16 v[84:87], a[160:163], v[52:55], v[84:87]
 v_mfma_f32_16x16x32_bf16 v[92:95], a[232:235], v[52:55], v[92:95]
 s_waitcnt lgkmcnt(2)
 v_mfma_f32_16x16x32_bf16 v[64:67], a[20:23], v[56:59], v[64:67]
 ds_read_b128 v[40:43], v7 offset:12288
 v_mfma_f32_16x16x32_bf16 v[72:75], a[92:95], v[56:59], v[72:75]
 ds_read_b128 v[44:47], v7 offset:14336
 v_mfma_f32_16x16x32_bf16 v[80:83], a[164:167], v[56:59], v[80:83]
 s_add_u32 m0, s49, 31744
 v_mfma_f32_16x16x32_bf16 v[88:91], a[236:239], v[56:59], v[88:91]
 buffer_load_dwordx4 v10, s[8:11], s46 offen offset:1024  lds
 v_mfma_f32_16x16x32_bf16 v[68:71], a[20:23], v[60:63], v[68:71]
 v_mfma_f32_16x16x32_bf16 v[76:79], a[92:95], v[60:63], v[76:79]
 v_mfma_f32_16x16x32_bf16 v[84:87], a[164:167], v[60:63], v[84:87]
 v_mfma_f32_16x16x32_bf16 v[92:95], a[236:239], v[60:63], v[92:95]
 s_waitcnt lgkmcnt(2)
 v_mfma_f32_16x16x32_bf16 v[64:67], a[24:27], v[32:35], v[64:67]
 ds_read_b128 v[48:51], v6 offset:16384
 v_mfma_f32_16x16x32_bf16 v[72:75], a[96:99], v[32:35], v[72:75]
 ds_read_b128 v[52:55], v6 offset:18432
 v_mfma_f32_16x16x32_bf16 v[80:83], a[168:171], v[32:35], v[80:83]
 s_waitcnt vmcnt(9)
 buffer_load_dword v17, v11, s[20:23], s56 offen sc1
 v_mfma_f32_16x16x32_bf16 v[88:91], a[240:243], v[32:35], v[88:91]
 s_barrier
 buffer_store_dword v14, v8, s[20:23], s59 offen sc1
 v_mfma_f32_16x16x32_bf16 v[68:71], a[24:27], v[36:39], v[68:71]
 buffer_load_dword v16, v15, s[20:23], s57 offen sc1
 v_mfma_f32_16x16x32_bf16 v[76:79], a[96:99], v[36:39], v[76:79]
 v_mfma_f32_16x16x32_bf16 v[84:87], a[168:171], v[36:39], v[84:87]
 s_lshl_b32 s56, s39, 18
 s_add_u32 s56, s56, s63
 v_mfma_f32_16x16x32_bf16 v[92:95], a[240:243], v[36:39], v[92:95]
 s_waitcnt lgkmcnt(2)
 v_mfma_f32_16x16x32_bf16 v[64:67], a[28:31], v[40:43], v[64:67]
 ds_read_b128 v[56:59], v7 offset:16384
 v_mfma_f32_16x16x32_bf16 v[72:75], a[100:103], v[40:43], v[72:75]
 ds_read_b128 v[60:63], v7 offset:18432
 v_mfma_f32_16x16x32_bf16 v[80:83], a[172:175], v[40:43], v[80:83]
 buffer_load_dwordx4 v[128:131], v1, s[20:23], s53 offen offset:0 sc1
 v_mfma_f32_16x16x32_bf16 v[88:91], a[244:247], v[40:43], v[88:91]
 v_mfma_f32_16x16x32_bf16 v[68:71], a[28:31], v[44:47], v[68:71]
 buffer_load_dwordx4 v[132:135], v1, s[20:23], s53 offen offset:1024 sc1
 v_mfma_f32_16x16x32_bf16 v[76:79], a[100:103], v[44:47], v[76:79]
 v_mfma_f32_16x16x32_bf16 v[84:87], a[172:175], v[44:47], v[84:87]
 v_mfma_f32_16x16x32_bf16 v[92:95], a[244:247], v[44:47], v[92:95]
 s_waitcnt lgkmcnt(2)
 v_mfma_f32_16x16x32_bf16 v[64:67], a[32:35], v[48:51], v[64:67]
 ds_read_b128 v[32:35], v6 offset:20480
 v_mfma_f32_16x16x32_bf16 v[72:75], a[104:107], v[48:51], v[72:75]
 ds_read_b128 v[36:39], v6 offset:22528
 v_mfma_f32_16x16x32_bf16 v[80:83], a[176:179], v[48:51], v[80:83]
 buffer_load_dwordx4 v[136:139], v1, s[20:23], s53 offen offset:2048 sc1
 v_mfma_f32_16x16x32_bf16 v[88:91], a[248:251], v[48:51], v[88:91]
 v_mfma_f32_16x16x32_bf16 v[68:71], a[32:35], v[52:55], v[68:71]
 buffer_load_dwordx4 v[140:143], v1, s[20:23], s53 offen offset:3072 sc1
 v_mfma_f32_16x16x32_bf16 v[76:79], a[104:107], v[52:55], v[76:79]
 v_mfma_f32_16x16x32_bf16 v[84:87], a[176:179], v[52:55], v[84:87]
 s_add_u32 s53, s53, 4096
 v_mfma_f32_16x16x32_bf16 v[92:95], a[248:251], v[52:55], v[92:95]
 s_waitcnt lgkmcnt(2)
 v_mfma_f32_16x16x32_bf16 v[64:67], a[36:39], v[56:59], v[64:67]
 ds_read_b128 v[40:43], v7 offset:20480
 v_mfma_f32_16x16x32_bf16 v[72:75], a[108:111], v[56:59], v[72:75]
 ds_read_b128 v[44:47], v7 offset:22528
 v_mfma_f32_16x16x32_bf16 v[80:83], a[180:183], v[56:59], v[80:83]
 buffer_load_dwordx4 v[144:147], v1, s[20:23], s53 offen offset:0 sc1
 v_mfma_f32_16x16x32_bf16 v[88:91], a[252:255], v[56:59], v[88:91]
 v_mfma_f32_16x16x32_bf16 v[68:71], a[36:39], v[60:63], v[68:71]
 buffer_load_dwordx4 v[148:151], v1, s[20:23], s53 offen offset:1024 sc1
 v_mfma_f32_16x16x32_bf16 v[76:79], a[108:111], v[60:63], v[76:79]
 v_mfma_f32_16x16x32_bf16 v[84:87], a[180:183], v[60:63], v[84:87]
 v_mfma_f32_16x16x32_bf16 v[92:95], a[252:255], v[60:63], v[92:95]
 s_waitcnt lgkmcnt(2)
 v_mfma_f32_16x16x32_bf16 v[64:67], a[40:43], v[32:35], v[64:67]
 ds_read_b128 v[48:51], v6 offset:24576
 v_mfma_f32_16x16x32_bf16 v[72:75], a[112:115], v[32:35], v[72:75]
 ds_read_b128 v[52:55], v6 offset:26624
 v_mfma_f32_16x16x32_bf16 v[80:83], a[184:187], v[32:35], v[80:83]
 buffer_load_dwordx4 v[152:155], v1, s[20:23], s53 offen offset:2048 sc1
 v_mfma_f32_16x16x32_bf16 v[88:91], v[224:227], v[32:35], v[88:91]
 v_mfma_f32_16x16x32_bf16 v[68:71], a[40:43], v[36:39], v[68:71]
 buffer_load_dwordx4 v[156:159], v1, s[20:23], s53 offen offset:3072 sc1
 v_mfma_f32_16x16x32_bf16 v[76:79], a[112:115], v[36:39], v[76:79]
 v_mfma_f32_16x16x32_bf16 v[84:87], a[184:187], v[36:39], v[84:87]
 s_add_u32 s53, s53, 4096
 v_mfma_f32_16x16x32_bf16 v[92:95], v[224:227], v[36:39], v[92:95]
 s_waitcnt lgkmcnt(2)
 v_mfma_f32_16x16x32_bf16 v[64:67], a[44:47], v[40:43], v[64:67]
 ds_read_b128 v[56:59], v7 offset:24576
 v_mfma_f32_16x16x32_bf16 v[72:75], a[116:119], v[40:43], v[72:75]
 ds_read_b128 v[60:63], v7 offset:26624
 v_mfma_f32_16x16x32_bf16 v[80:83], a[188:191], v[40:43], v[80:83]
 buffer_load_dwordx4 v[160:163], v1, s[20:23], s53 offen offset:0 sc1
 v_mfma_f32_16x16x32_bf16 v[88:91], v[228:231], v[40:43], v[88:91]
 v_mfma_f32_16x16x32_bf16 v[68:71], a[44:47], v[44:47], v[68:71]
 buffer_load_dwordx4 v[164:167], v1, s[20:23], s53 offen offset:1024 sc1
 v_mfma_f32_16x16x32_bf16 v[76:79], a[116:119], v[44:47], v[76:79]
 v_mfma_f32_16x16x32_bf16 v[84:87], a[188:191], v[44:47], v[84:87]
 v_mfma_f32_16x16x32_bf16 v[92:95], v[228:231], v[44:47], v[92:95]
 s_waitcnt lgkmcnt(2)
 v_mfma_f32_16x16x32_bf16 v[64:67], a[48:51], v[48:51], v[64:67]
 ds_read_b128 v[32:35], v6 offset:28672
 v_mfma_f32_16x16x32_bf16 v[72:75], a[120:123], v[48:51], v[72:75]
 ds_read_b128 v[36:39], v6 offset:30720
 v_mfma_f32_16x16x32_bf16 v[80:83], a[192:195], v[48:51], v[80:83]
 buffer_load_dwordx4 v[168:171], v1, s[20:23], s53 offen offset:2048 sc1
 v_mfma_f32_16x16x32_bf16 v[88:91], v[232:235], v[48:51], v[88:91]
 v_mfma_f32_16x16x32_bf16 v[68:71], a[48:51], v[52:55], v[68:71]
 buffer_load_dwordx4 v[172:175], v1, s[20:23], s53 offen offset:3072 sc1
 v_mfma_f32_16x16x32_bf16 v[76:79], a[120:123], v[52:55], v[76:79]
 v_mfma_f32_16x16x32_bf16 v[84:87], a[192:195], v[52:55], v[84:87]
 s_add_u32 s53, s53, 4096
 v_mfma_f32_16x16x32_bf16 v[92:95], v[232:235], v[52:55], v[92:95]
 s_waitcnt lgkmcnt(2)
 v_mfma_f32_16x16x32_bf16 v[64:67], a[52:55], v[56:59], v[64:67]
 ds_read_b128 v[40:43], v7 offset:28672
 v_mfma_f32_16x16x32_bf16 v[72:75], a[124:127], v[56:59], v[72:75]
 ds_read_b128 v[44:47], v7 offset:30720
 v_mfma_f32_16x16x32_bf16 v[80:83], a[196:199], v[56:59], v[80:83]
 s_add_u32 s43, s43, 36864
 s_cmp_eq_u32 s43, 147456
 buffer_load_dwordx4 v[176:179], v1, s[20:23], s53 offen offset:0 sc1
 v_mfma_f32_16x16x32_bf16 v[88:91], v[236:239], v[56:59], v[88:91]
 s_cselect_b32 s43, 0, s43
 s_add_u32 s44, s44, 36864
 v_mfma_f32_16x16x32_bf16 v[68:71], a[52:55], v[60:63], v[68:71]
 s_cmp_eq_u32 s44, 147456
 s_cselect_b32 s44, 0, s44
 buffer_load_dwordx4 v[180:183], v1, s[20:23], s53 offen offset:1024 sc1
 v_mfma_f32_16x16x32_bf16 v[76:79], a[124:127], v[60:63], v[76:79]
 v_mfma_f32_16x16x32_bf16 v[84:87], a[196:199], v[60:63], v[84:87]
 v_mfma_f32_16x16x32_bf16 v[92:95], v[236:239], v[60:63], v[92:95]
 s_waitcnt lgkmcnt(2)
 v_mfma_f32_16x16x32_bf16 v[64:67], a[56:59], v[32:35], v[64:67]
 ds_read_b128 v[48:51], v6 offset:32768
 v_mfma_f32_16x16x32_bf16 v[72:75], a[128:131], v[32:35], v[72:75]
 ds_read_b128 v[52:55], v6 offset:34816
 v_mfma_f32_16x16x32_bf16 v[80:83], a[200:203], v[32:35], v[80:83]
 v_add_u32 v6, s43, v4
 buffer_load_dwordx4 v[184:187], v1, s[20:23], s53 offen offset:2048 sc1
 v_mfma_f32_16x16x32_bf16 v[88:91], v[240:243], v[32:35], v[88:91]
 v_mfma_f32_16x16x32_bf16 v[68:71], a[56:59], v[36:39], v[68:71]
 buffer_load_dwordx4 v[188:191], v1, s[20:23], s53 offen offset:3072 sc1
 v_mfma_f32_16x16x32_bf16 v[76:79], a[128:131], v[36:39], v[76:79]
 v_mfma_f32_16x16x32_bf16 v[84:87], a[200:203], v[36:39], v[84:87]
 v_mfma_f32_16x16x32_bf16 v[92:95], v[240:243], v[36:39], v[92:95]
 s_waitcnt lgkmcnt(2)
 v_mfma_f32_16x16x32_bf16 v[64:67], a[60:63], v[40:43], v[64:67]
 ds_read_b128 v[56:59], v7 offset:32768
 v_mfma_f32_16x16x32_bf16 v[72:75], a[132:135], v[40:43], v[72:75]
 ds_read_b128 v[60:63], v7 offset:34816
 v_mfma_f32_16x16x32_bf16 v[80:83], a[204:207], v[40:43], v[80:83]
 v_add_u32 v7, s43, v5
 v_mfma_f32_16x16x32_bf16 v[88:91], v[244:247], v[40:43], v[88:91]
 v_mfma_f32_16x16x32_bf16 v[68:71], a[60:63], v[44:47], v[68:71]
 v_mfma_f32_16x16x32_bf16 v[76:79], a[132:135], v[44:47], v[76:79]
 v_mfma_f32_16x16x32_bf16 v[84:87], a[204:207], v[44:47], v[84:87]
 v_mfma_f32_16x16x32_bf16 v[92:95], v[244:247], v[44:47], v[92:95]
 s_waitcnt lgkmcnt(2)
 v_mfma_f32_16x16x32_bf16 v[64:67], a[64:67], v[48:51], v[64:67]
 s_waitcnt vmcnt(28)
 s_barrier
 ds_read_b128 v[32:35], v6 offset:0
 v_mfma_f32_16x16x32_bf16 v[72:75], a[136:139], v[48:51], v[72:75]
 ds_read_b128 v[36:39], v6 offset:2048
 v_mfma_f32_16x16x32_bf16 v[80:83], a[208:211], v[48:51], v[80:83]
 v_mfma_f32_16x16x32_bf16 v[88:91], v[248:251], v[48:51], v[88:91]
 s_waitcnt vmcnt(16)
 v_cmp_le_u32 vcc, s60, v16
 v_mfma_f32_16x16x32_bf16 v[68:71], a[64:67], v[52:55], v[68:71]
 v_mfma_f32_16x16x32_bf16 v[76:79], a[136:139], v[52:55], v[76:79]
 s_and_b32 s64, vcc_lo, 1
 s_cbranch_scc0 Lqsk_29
 buffer_load_dwordx4 v[192:195], v1, s[20:23], s55 offen offset:0 sc1
 buffer_load_dwordx4 v[196:199], v1, s[20:23], s55 offen offset:1024 sc1
 buffer_load_dwordx4 v[200:203], v1, s[20:23], s55 offen offset:2048 sc1
 buffer_load_dwordx4 v[204:207], v1, s[20:23], s55 offen offset:3072 sc1
Lqsk_29:
 v_mfma_f32_16x16x32_bf16 v[84:87], a[208:211], v[52:55], v[84:87]
 v_mfma_f32_16x16x32_bf16 v[92:95], v[248:251], v[52:55], v[92:95]
 s_waitcnt lgkmcnt(2)
 v_mfma_f32_16x16x32_bf16 v[64:67], a[68:71], v[56:59], v[64:67]
 ds_read_b128 v[40:43], v7 offset:0
 v_mfma_f32_16x16x32_bf16 v[72:75], a[140:143], v[56:59], v[72:75]
 ds_read_b128 v[44:47], v7 offset:2048
 v_mfma_f32_16x16x32_bf16 v[80:83], a[212:215], v[56:59], v[80:83]
 v_mfma_f32_16x16x32_bf16 v[88:91], v[252:255], v[56:59], v[88:91]
 s_mov_b32 s39, s40
 s_mov_b32 s40, s41
 v_mfma_f32_16x16x32_bf16 v[68:71], a[68:71], v[60:63], v[68:71]
 s_add_u32 s42, s42, 1
 v_mov_b32 v14, s42
 v_mfma_f32_16x16x32_bf16 v[76:79], a[140:143], v[60:63], v[76:79]
 v_mfma_f32_16x16x32_bf16 v[84:87], a[212:215], v[60:63], v[84:87]
 v_mfma_f32_16x16x32_bf16 v[92:95], v[252:255], v[60:63], v[92:95]
 s_waitcnt lgkmcnt(2)
 s_nop 7
 v_cvt_pk_bf16_f32 v16, v64, v72
 v_cvt_pk_bf16_f32 v17, v65, v73
 v_cvt_pk_bf16_f32 v18, v66, v74
 v_cvt_pk_bf16_f32 v19, v67, v75
 ds_write_b128 v2, v[16:19] offset:0
 v_cvt_pk_bf16_f32 v20, v68, v76
 v_cvt_pk_bf16_f32 v21, v69, v77
 v_cvt_pk_bf16_f32 v22, v70, v78
 v_cvt_pk_bf16_f32 v23, v71, v79
 ds_write_b128 v2, v[20:23] offset:1024
 v_cvt_pk_bf16_f32 v24, v80, v88
 v_cvt_pk_bf16_f32 v25, v81, v89
 v_cvt_pk_bf16_f32 v26, v82, v90
 v_cvt_pk_bf16_f32 v27, v83, v91
 ds_write_b128 v2, v[24:27] offset:8192
 v_cvt_pk_bf16_f32 v28, v84, v92
 v_cvt_pk_bf16_f32 v29, v85, v93
 v_cvt_pk_bf16_f32 v30, v86, v94
 v_cvt_pk_bf16_f32 v31, v87, v95
 ds_write_b128 v2, v[28:31] offset:9216
 v_mov_b64 v[120:121], 0
 v_mov_b64 v[122:123], 0
 s_waitcnt lgkmcnt(0)
 s_barrier
 ds_read_b128 v[96:99], v3 offset:0
 ds_read_b128 v[100:103], v3 offset:2048
 ds_read_b128 v[104:107], v3 offset:4096
 ds_read_b128 v[108:111], v3 offset:6144
 s_cmp_lg_u32 s64, 0
 s_cbranch_scc1 Lqpre_30
Lqs_31:
 buffer_load_dword v16, v15, s[20:23], s57 offen sc1
 s_waitcnt vmcnt(0)
 v_cmp_le_u32 vcc, s60, v16
 s_cbranch_vccnz Lqsk_32
 s_sleep 2
 s_sub_u32 s58, s58, 1
 s_cbranch_scc0 Lqs_31
 s_endpgm
Lqsk_32:
 buffer_load_dwordx4 v[192:195], v1, s[20:23], s55 offen offset:0 sc1
 buffer_load_dwordx4 v[196:199], v1, s[20:23], s55 offen offset:1024 sc1
 buffer_load_dwordx4 v[200:203], v1, s[20:23], s55 offen offset:2048 sc1
 buffer_load_dwordx4 v[204:207], v1, s[20:23], s55 offen offset:3072 sc1
Lqpre_30:
 s_waitcnt vmcnt(4) lgkmcnt(0)
 v_mfma_f32_16x16x32_bf16 v[112:115], v[128:131], v[96:99], v[208:211]
 v_mfma_f32_16x16x32_bf16 v[116:119], v[132:135], v[96:99], v[212:215]
 v_mfma_f32_16x16x32_bf16 v[112:115], v[136:139], v[100:103], v[112:115]
 v_mfma_f32_16x16x32_bf16 v[116:119], v[140:143], v[100:103], v[116:119]
 v_mfma_f32_16x16x32_bf16 v[112:115], v[144:147], v[104:107], v[112:115]
 v_mfma_f32_16x16x32_bf16 v[116:119], v[148:151], v[104:107], v[116:119]
 v_mfma_f32_16x16x32_bf16 v[112:115], v[152:155], v[108:111], v[112:115]
 v_mfma_f32_16x16x32_bf16 v[116:119], v[156:159], v[108:111], v[116:119]
 s_nop 7
 v_max3_f32 v24, v112, v113, v114
 v_max3_f32 v24, v24, v115, v116
 v_max3_f32 v24, v24, v117, v118
 v_max_f32 v24, v24, v119
 s_waitcnt vmcnt(2)
 v_mov_b64 v[16:17], v[192:193]
 v_mov_b64 v[18:19], v[196:197]
 s_nop 1
 v_smfmac_f32_16x16x64_bf16 v[120:123], v[16:19], v[96:103], v12
 s_waitcnt vmcnt(0)
 v_mov_b64 v[20:21], v[200:201]
 v_mov_b64 v[22:23], v[204:205]
 s_nop 1
 v_smfmac_f32_16x16x64_bf16 v[120:123], v[20:23], v[104:111], v12
 s_nop 7
 v_add_f32 v120, v120, v122
 v_add_f32 v121, v121, v123
 v_mul_f32 v120, s50, v120
 v_mul_f32 v121, s50, v121
 v_max3_f32 v24, v24, v120, v121
 v_mov_b32 v25, v24
 s_nop 1
 v_permlane16_swap_b32 v24, v25
 v_max_f32 v24, v24, v25
 v_mov_b32 v25, v24
 s_nop 1
 v_permlane32_swap_b32 v24, v25
 v_max_f32 v24, v24, v25
 v_sub_f32 v112, v112, v24
 v_sub_f32 v113, v113, v24
 v_sub_f32 v114, v114, v24
 v_sub_f32 v115, v115, v24
 v_sub_f32 v116, v116, v24
 v_sub_f32 v117, v117, v24
 v_sub_f32 v118, v118, v24
 v_sub_f32 v119, v119, v24
 v_sub_f32 v120, v120, v24
 v_sub_f32 v121, v121, v24
 v_exp_f32 v120, v120
 v_exp_f32 v121, v121
 v_exp_f32 v112, v112
 v_exp_f32 v113, v113
 v_exp_f32 v114, v114
 v_exp_f32 v115, v115
 v_exp_f32 v116, v116
 v_exp_f32 v117, v117
 v_exp_f32 v118, v118
 v_exp_f32 v119, v119
 v_cvt_pk_bf16_f32 v216, v120, v121
 v_cvt_pk_bf16_f32 v219, v120, v121
 v_cvt_pk_bf16_f32 v28, v112, v113
 v_cvt_pk_bf16_f32 v29, v116, v117
 v_cvt_pk_bf16_f32 v30, v114, v115
 v_cvt_pk_bf16_f32 v31, v118, v119
 v_mfma_f32_16x16x16_bf16 v[124:127], v[220:221], v[216:217], 0
 v_mfma_f32_16x16x16_bf16 v[64:67], v[194:195], v[216:217], 0
 v_mfma_f32_16x16x16_bf16 v[68:71], v[194:195], v[218:219], 0
 v_mfma_f32_16x16x16_bf16 v[72:75], v[198:199], v[216:217], 0
 v_mfma_f32_16x16x16_bf16 v[76:79], v[198:199], v[218:219], 0
 v_mfma_f32_16x16x16_bf16 v[80:83], v[202:203], v[216:217], 0
 v_mfma_f32_16x16x16_bf16 v[84:87], v[202:203], v[218:219], 0
 v_mfma_f32_16x16x16_bf16 v[88:91], v[206:207], v[216:217], 0
 v_mfma_f32_16x16x16_bf16 v[92:95], v[206:207], v[218:219], 0
 v_mfma_f32_16x16x32_bf16 v[124:127], v[220:223], v[28:31], v[124:127]
 v_mfma_f32_16x16x32_bf16 v[64:67], v[160:163], v[28:31], v[64:67]
 v_mfma_f32_16x16x32_bf16 v[68:71], v[164:167], v[28:31], v[68:71]
 v_mfma_f32_16x16x32_bf16 v[72:75], v[168:171], v[28:31], v[72:75]
 v_mfma_f32_16x16x32_bf16 v[76:79], v[172:175], v[28:31], v[76:79]
 v_mfma_f32_16x16x32_bf16 v[80:83], v[176:179], v[28:31], v[80:83]
 v_mfma_f32_16x16x32_bf16 v[84:87], v[180:183], v[28:31], v[84:87]
 v_mfma_f32_16x16x32_bf16 v[88:91], v[184:187], v[28:31], v[88:91]
 v_mfma_f32_16x16x32_bf16 v[92:95], v[188:191], v[28:31], v[92:95]
 v_rcp_f32 v124, v124
 s_add_u32 s45, s56, 4096
 v_mul_f32 v64, v64, v124
 v_mul_f32 v65, v65, v124
 v_mul_f32 v66, v66, v124
 v_mul_f32 v67, v67, v124
 v_mul_f32 v68, v68, v124
 v_mul_f32 v69, v69, v124
 v_mul_f32 v70, v70, v124
 v_mul_f32 v71, v71, v124
 v_cvt_pk_bf16_f32 v96, v64, v65
 v_cvt_pk_bf16_f32 v97, v68, v69
 v_cvt_pk_bf16_f32 v98, v66, v67
 v_cvt_pk_bf16_f32 v99, v70, v71
 buffer_store_dwordx4 v[96:99], v1, s[20:23], s56 offen offset:0 sc1
 v_mul_f32 v72, v72, v124
 v_mul_f32 v73, v73, v124
 v_mul_f32 v74, v74, v124
 v_mul_f32 v75, v75, v124
 v_mul_f32 v76, v76, v124
 v_mul_f32 v77, v77, v124
 v_mul_f32 v78, v78, v124
 v_mul_f32 v79, v79, v124
 v_cvt_pk_bf16_f32 v100, v72, v73
 v_cvt_pk_bf16_f32 v101, v76, v77
 v_cvt_pk_bf16_f32 v102, v74, v75
 v_cvt_pk_bf16_f32 v103, v78, v79
 buffer_store_dwordx4 v[100:103], v1, s[20:23], s56 offen offset:2048 sc1
 v_mul_f32 v80, v80, v124
 v_mul_f32 v81, v81, v124
 v_mul_f32 v82, v82, v124
 v_mul_f32 v83, v83, v124
 v_mul_f32 v84, v84, v124
 v_mul_f32 v85, v85, v124
 v_mul_f32 v86, v86, v124
 v_mul_f32 v87, v87, v124
 v_cvt_pk_bf16_f32 v104, v80, v81
 v_cvt_pk_bf16_f32 v105, v84, v85
 v_cvt_pk_bf16_f32 v106, v82, v83
 v_cvt_pk_bf16_f32 v107, v86, v87
 buffer_store_dwordx4 v[104:107], v1, s[20:23], s45 offen offset:0 sc1
 v_mul_f32 v88, v88, v124
 v_mul_f32 v89, v89, v124
 v_mul_f32 v90, v90, v124
 v_mul_f32 v91, v91, v124
 v_mul_f32 v92, v92, v124
 v_mul_f32 v93, v93, v124
 v_mul_f32 v94, v94, v124
 v_mul_f32 v95, v95, v124
 v_cvt_pk_bf16_f32 v108, v88, v89
 v_cvt_pk_bf16_f32 v109, v92, v93
 v_cvt_pk_bf16_f32 v110, v90, v91
 v_cvt_pk_bf16_f32 v111, v94, v95
 buffer_store_dwordx4 v[108:111], v1, s[20:23], s45 offen offset:2048 sc1
 s_cmp_lt_u32 s42, s36
 s_cbranch_scc1 Lqb_loop_24
 s_waitcnt vmcnt(0)
 buffer_load_dword v17, v11, s[20:23], s56 offen sc1
 s_barrier
 buffer_store_dword v14, v8, s[20:23], s59 offen sc1
 s_branch Lfin
Lob:
 s_load_dwordx2 s[8:9], s[0:1], 88
 s_mov_b32 s10, 0x480000
 s_mov_b32 s11, 0x20000
 s_sub_u32 s32, s6, 16
 s_mul_i32 s7, s3, 5
 s_add_u32 s7, s7, s6
 s_sub_u32 s7, s7, 25
 s_cmp_lt_u32 s6, 25
 s_cselect_b32 s32, s32, s7
 s_cselect_b32 s33, s3, 4
 s_cselect_b32 s34, 2, 1
 s_cselect_b32 s39, 6, 4
 s_cselect_b32 s35, 22, 20
 s_cselect_b32 s40, 0, 4
 s_mov_b32 s36, 0x7000000
 s_mov_b32 s37, 1152
 s_lshl_b32 s7, s4, 7
 s_add_u32 s38, s7, 0x3800
 s_mov_b32 s93, 1
 s_mov_b32 s92, 3
 s_mov_b32 s91, 9
 s_mov_b32 s90, 1
Los:
 s_load_dwordx2 s[24:25], s[0:1], 104
 s_mov_b32 s26, 0x480000
 s_mov_b32 s27, 0x20000
 s_waitcnt lgkmcnt(0)
 v_and_b32 v15, 63, v0
 v_lshlrev_b32 v1, 4, v15
 v_and_b32 v3, s92, v15
 v_lshlrev_b32 v3, 2, v3
 v_lshrrev_b32 v14, 4, v15
 v_min_u32 v14, 1, v14
 v_lshl_or_b32 v3, v14, 28, v3
 s_add_u32 s44, s32, s40
 s_and_b32 s44, s44, 7
 s_mov_b32 s50, 0x40000
 s_mul_i32 s49, s4, 40960
 v_add_u32 v5, s49, v1
 v_bfe_u32 v14, v15, 5, 1
 v_bfe_u32 v16, v15, 3, 1
 v_lshl_add_u32 v14, v14, 1, v16
 v_bfe_u32 v16, v15, 4, 1
 v_lshl_add_u32 v14, v16, 6, v14
 v_mul_u32_u24 v14, 1152, v14
 v_bfe_u32 v17, v15, 1, 2
 v_xor_b32 v17, v17, v16
 v_lshlrev_b32 v17, 5, v17
 v_and_b32 v16, 1, v15
 v_lshl_add_u32 v17, v16, 4, v17
 v_add_u32 v8, v14, v17
 v_xor_b32 v17, 64, v17
 v_add_u32 v9, v14, v17
 v_lshrrev_b32 v14, 4, v15
 v_bfe_u32 v16, v15, 2, 2
 v_lshl_add_u32 v14, v14, 3, v16
 v_lshlrev_b32 v14, 7, v14
 v_bfe_u32 v16, v15, 3, 2
 v_lshl_add_u32 v14, v16, 5, v14
 v_and_b32 v16, 3, v15
 v_lshl_add_u32 v14, v16, 3, v14
 v_xor_b32 v16, 0, v14
 v_add_u32 v10, s49, v16
 v_xor_b32 v16, 32, v14
 v_add_u32 v11, s49, v16
 v_xor_b32 v16, 64, v14
 v_add_u32 v12, s49, v16
 v_xor_b32 v16, 96, v14
 v_add_u32 v13, s49, v16
 s_lshl_b32 s47, s32, 7
 s_add_u32 s46, s44, 0
 s_and_b32 s46, s46, 7
 s_lshl_b32 s45, s4, 3
 s_add_u32 s46, s46, s45
 s_mul_i32 s46, s46, 147456
 s_add_u32 s46, s46, s47
 s_add_u32 m0, s49, 8192
 s_add_u32 s45, s46, 0
 buffer_load_dwordx4 v8, s[8:11], s45 offen  lds
 s_add_u32 m0, s49, 9216
 s_add_u32 s45, s46, 4608
 buffer_load_dwordx4 v9, s[8:11], s45 offen  lds
 s_add_u32 m0, s49, 10240
 s_add_u32 s45, s46, 9216
 buffer_load_dwordx4 v8, s[8:11], s45 offen  lds
 s_add_u32 m0, s49, 11264
 s_add_u32 s45, s46, 13824
 buffer_load_dwordx4 v9, s[8:11], s45 offen  lds
 s_add_u32 m0, s49, 12288
 s_add_u32 s45, s46, 18432
 buffer_load_dwordx4 v8, s[8:11], s45 offen  lds
 s_add_u32 m0, s49, 13312
 s_add_u32 s45, s46, 23040
 buffer_load_dwordx4 v9, s[8:11], s45 offen  lds
 s_add_u32 m0, s49, 14336
 s_add_u32 s45, s46, 27648
 buffer_load_dwordx4 v8, s[8:11], s45 offen  lds
 s_add_u32 m0, s49, 15360
 s_add_u32 s45, s46, 32256
 buffer_load_dwordx4 v9, s[8:11], s45 offen  lds
 s_add_u32 m0, s49, 16384
 s_add_u32 s45, s46, 36864
 buffer_load_dwordx4 v8, s[8:11], s45 offen  lds
 s_add_u32 m0, s49, 17408
 s_add_u32 s45, s46, 41472
 buffer_load_dwordx4 v9, s[8:11], s45 offen  lds
 s_add_u32 m0, s49, 18432
 s_add_u32 s45, s46, 46080
 buffer_load_dwordx4 v8, s[8:11], s45 offen  lds
 s_add_u32 m0, s49, 19456
 s_add_u32 s45, s46, 50688
 buffer_load_dwordx4 v9, s[8:11], s45 offen  lds
 s_add_u32 m0, s49, 20480
 s_add_u32 s45, s46, 55296
 buffer_load_dwordx4 v8, s[8:11], s45 offen  lds
 s_add_u32 m0, s49, 21504
 s_add_u32 s45, s46, 59904
 buffer_load_dwordx4 v9, s[8:11], s45 offen  lds
 s_add_u32 m0, s49, 22528
 s_add_u32 s45, s46, 64512
 buffer_load_dwordx4 v8, s[8:11], s45 offen  lds
 s_add_u32 m0, s49, 23552
 s_add_u32 s45, s46, 69120
 buffer_load_dwordx4 v9, s[8:11], s45 offen  lds
 s_add_u32 s46, s44, 1
 s_and_b32 s46, s46, 7
 s_lshl_b32 s45, s4, 3
 s_add_u32 s46, s46, s45
 s_mul_i32 s46, s46, 147456
 s_add_u32 s46, s46, s47
 s_add_u32 m0, s49, 24576
 s_add_u32 s45, s46, 0
 buffer_load_dwordx4 v8, s[8:11], s45 offen  lds
 s_add_u32 m0, s49, 25600
 s_add_u32 s45, s46, 4608
 buffer_load_dwordx4 v9, s[8:11], s45 offen  lds
 s_add_u32 m0, s49, 26624
 s_add_u32 s45, s46, 9216
 buffer_load_dwordx4 v8, s[8:11], s45 offen  lds
 s_add_u32 m0, s49, 27648
 s_add_u32 s45, s46, 13824
 buffer_load_dwordx4 v9, s[8:11], s45 offen  lds
 s_add_u32 m0, s49, 28672
 s_add_u32 s45, s46, 18432
 buffer_load_dwordx4 v8, s[8:11], s45 offen  lds
 s_add_u32 m0, s49, 29696
 s_add_u32 s45, s46, 23040
 buffer_load_dwordx4 v9, s[8:11], s45 offen  lds
 s_add_u32 m0, s49, 30720
 s_add_u32 s45, s46, 27648
 buffer_load_dwordx4 v8, s[8:11], s45 offen  lds
 s_add_u32 m0, s49, 31744
 s_add_u32 s45, s46, 32256
 buffer_load_dwordx4 v9, s[8:11], s45 offen  lds
 s_waitcnt vmcnt(20) lgkmcnt(0)
 s_add_u32 m0, s49, 32768
 s_add_u32 s45, s46, 36864
 buffer_load_dwordx4 v8, s[8:11], s45 offen  lds
 s_add_u32 m0, s49, 33792
 s_add_u32 s45, s46, 41472
 buffer_load_dwordx4 v9, s[8:11], s45 offen  lds
 s_add_u32 m0, s49, 34816
 s_add_u32 s45, s46, 46080
 buffer_load_dwordx4 v8, s[8:11], s45 offen  lds
 s_add_u32 m0, s49, 35840
 s_add_u32 s45, s46, 50688
 buffer_load_dwordx4 v9, s[8:11], s45 offen  lds
 ds_read_b64_tr_b16 a[0:1], v10 offset:8192
 ds_read_b64_tr_b16 a[2:3], v10 offset:8704
 ds_read_b64_tr_b16 a[4:5], v11 offset:8192
 ds_read_b64_tr_b16 a[6:7], v11 offset:8704
 ds_read_b64_tr_b16 a[8:9], v12 offset:8192
 ds_read_b64_tr_b16 a[10:11], v12 offset:8704
 ds_read_b64_tr_b16 v[16:17], v13 offset:8192
 ds_read_b64_tr_b16 v[18:19], v13 offset:8704
 s_waitcnt vmcnt(20) lgkmcnt(0)
 s_add_u32 m0, s49, 36864
 s_add_u32 s45, s46, 55296
 buffer_load_dwordx4 v8, s[8:11], s45 offen  lds
 s_add_u32 m0, s49, 37888
 s_add_u32 s45, s46, 59904
 buffer_load_dwordx4 v9, s[8:11], s45 offen  lds
 s_add_u32 m0, s49, 38912
 s_add_u32 s45, s46, 64512
 buffer_load_dwordx4 v8, s[8:11], s45 offen  lds
 s_add_u32 m0, s49, 39936
 s_add_u32 s45, s46, 69120
 buffer_load_dwordx4 v9, s[8:11], s45 offen  lds
 ds_write_b128 v5, v[16:19] offset:0
 ds_read_b64_tr_b16 a[12:13], v10 offset:12288
 ds_read_b64_tr_b16 a[14:15], v10 offset:12800
 ds_read_b64_tr_b16 a[16:17], v11 offset:12288
 ds_read_b64_tr_b16 a[18:19], v11 offset:12800
 ds_read_b64_tr_b16 a[20:21], v12 offset:12288
 ds_read_b64_tr_b16 a[22:23], v12 offset:12800
 ds_read_b64_tr_b16 v[20:21], v13 offset:12288
 ds_read_b64_tr_b16 v[22:23], v13 offset:12800
 s_waitcnt vmcnt(20) lgkmcnt(0)
 s_add_u32 s46, s44, 2
 s_and_b32 s46, s46, 7
 s_lshl_b32 s45, s4, 3
 s_add_u32 s46, s46, s45
 s_mul_i32 s46, s46, 147456
 s_add_u32 s46, s46, s47
 s_add_u32 m0, s49, 8192
 s_add_u32 s45, s46, 0
 buffer_load_dwordx4 v8, s[8:11], s45 offen  lds
 s_add_u32 m0, s49, 9216
 s_add_u32 s45, s46, 4608
 buffer_load_dwordx4 v9, s[8:11], s45 offen  lds
 s_add_u32 m0, s49, 10240
 s_add_u32 s45, s46, 9216
 buffer_load_dwordx4 v8, s[8:11], s45 offen  lds
 s_add_u32 m0, s49, 11264
 s_add_u32 s45, s46, 13824
 buffer_load_dwordx4 v9, s[8:11], s45 offen  lds
 ds_write_b128 v5, v[20:23] offset:1024
 ds_read_b64_tr_b16 a[24:25], v10 offset:16384
 ds_read_b64_tr_b16 a[26:27], v10 offset:16896
 ds_read_b64_tr_b16 a[28:29], v11 offset:16384
 ds_read_b64_tr_b16 a[30:31], v11 offset:16896
 ds_read_b64_tr_b16 a[32:33], v12 offset:16384
 ds_read_b64_tr_b16 a[34:35], v12 offset:16896
 ds_read_b64_tr_b16 v[16:17], v13 offset:16384
 ds_read_b64_tr_b16 v[18:19], v13 offset:16896
 s_waitcnt vmcnt(20) lgkmcnt(0)
 s_add_u32 m0, s49, 12288
 s_add_u32 s45, s46, 18432
 buffer_load_dwordx4 v8, s[8:11], s45 offen  lds
 s_add_u32 m0, s49, 13312
 s_add_u32 s45, s46, 23040
 buffer_load_dwordx4 v9, s[8:11], s45 offen  lds
 s_add_u32 m0, s49, 14336
 s_add_u32 s45, s46, 27648
 buffer_load_dwordx4 v8, s[8:11], s45 offen  lds
 s_add_u32 m0, s49, 15360
 s_add_u32 s45, s46, 32256
 buffer_load_dwordx4 v9, s[8:11], s45 offen  lds
 ds_write_b128 v5, v[16:19] offset:2048
 ds_read_b64_tr_b16 a[36:37], v10 offset:20480
 ds_read_b64_tr_b16 a[38:39], v10 offset:20992
 ds_read_b64_tr_b16 a[40:41], v11 offset:20480
 ds_read_b64_tr_b16 a[42:43], v11 offset:20992
 ds_read_b64_tr_b16 a[44:45], v12 offset:20480
 ds_read_b64_tr_b16 a[46:47], v12 offset:20992
 ds_read_b64_tr_b16 v[20:21], v13 offset:20480
 ds_read_b64_tr_b16 v[22:23], v13 offset:20992
 s_waitcnt vmcnt(20) lgkmcnt(0)
 s_add_u32 m0, s49, 16384
 s_add_u32 s45, s46, 36864
 buffer_load_dwordx4 v8, s[8:11], s45 offen  lds
 s_add_u32 m0, s49, 17408
 s_add_u32 s45, s46, 41472
 buffer_load_dwordx4 v9, s[8:11], s45 offen  lds
 s_add_u32 m0, s49, 18432
 s_add_u32 s45, s46, 46080
 buffer_load_dwordx4 v8, s[8:11], s45 offen  lds
 s_add_u32 m0, s49, 19456
 s_add_u32 s45, s46, 50688
 buffer_load_dwordx4 v9, s[8:11], s45 offen  lds
 ds_write_b128 v5, v[20:23] offset:3072
 ds_read_b64_tr_b16 a[48:49], v10 offset:24576
 ds_read_b64_tr_b16 a[50:51], v10 offset:25088
 ds_read_b64_tr_b16 a[52:53], v11 offset:24576
 ds_read_b64_tr_b16 a[54:55], v11 offset:25088
 ds_read_b64_tr_b16 a[56:57], v12 offset:24576
 ds_read_b64_tr_b16 a[58:59], v12 offset:25088
 ds_read_b64_tr_b16 v[16:17], v13 offset:24576
 ds_read_b64_tr_b16 v[18:19], v13 offset:25088
 s_waitcnt vmcnt(20) lgkmcnt(0)
 s_add_u32 m0, s49, 20480
 s_add_u32 s45, s46, 55296
 buffer_load_dwordx4 v8, s[8:11], s45 offen  lds
 s_add_u32 m0, s49, 21504
 s_add_u32 s45, s46, 59904
 buffer_load_dwordx4 v9, s[8:11], s45 offen  lds
 s_add_u32 m0, s49, 22528
 s_add_u32 s45, s46, 64512
 buffer_load_dwordx4 v8, s[8:11], s45 offen  lds
 s_add_u32 m0, s49, 23552
 s_add_u32 s45, s46, 69120
 buffer_load_dwordx4 v9, s[8:11], s45 offen  lds
 ds_write_b128 v5, v[16:19] offset:4096
 ds_read_b64_tr_b16 a[60:61], v10 offset:28672
 ds_read_b64_tr_b16 a[62:63], v10 offset:29184
 ds_read_b64_tr_b16 a[64:65], v11 offset:28672
 ds_read_b64_tr_b16 a[66:67], v11 offset:29184
 ds_read_b64_tr_b16 a[68:69], v12 offset:28672
 ds_read_b64_tr_b16 a[70:71], v12 offset:29184
 ds_read_b64_tr_b16 v[20:21], v13 offset:28672
 ds_read_b64_tr_b16 v[22:23], v13 offset:29184
 s_waitcnt vmcnt(20) lgkmcnt(0)
 s_add_u32 s46, s44, 3
 s_and_b32 s46, s46, 7
 s_lshl_b32 s45, s4, 3
 s_add_u32 s46, s46, s45
 s_mul_i32 s46, s46, 147456
 s_add_u32 s46, s46, s47
 s_add_u32 m0, s49, 24576
 s_add_u32 s45, s46, 0
 buffer_load_dwordx4 v8, s[8:11], s45 offen  lds
 s_add_u32 m0, s49, 25600
 s_add_u32 s45, s46, 4608
 buffer_load_dwordx4 v9, s[8:11], s45 offen  lds
 s_add_u32 m0, s49, 26624
 s_add_u32 s45, s46, 9216
 buffer_load_dwordx4 v8, s[8:11], s45 offen  lds
 s_add_u32 m0, s49, 27648
 s_add_u32 s45, s46, 13824
 buffer_load_dwordx4 v9, s[8:11], s45 offen  lds
 ds_write_b128 v5, v[20:23] offset:5120
 ds_read_b64_tr_b16 a[72:73], v10 offset:32768
 ds_read_b64_tr_b16 a[74:75], v10 offset:33280
 ds_read_b64_tr_b16 a[76:77], v11 offset:32768
 ds_read_b64_tr_b16 a[78:79], v11 offset:33280
 ds_read_b64_tr_b16 a[80:81], v12 offset:32768
 ds_read_b64_tr_b16 a[82:83], v12 offset:33280
 ds_read_b64_tr_b16 v[16:17], v13 offset:32768
 ds_read_b64_tr_b16 v[18:19], v13 offset:33280
 s_waitcnt vmcnt(20) lgkmcnt(0)
 s_add_u32 m0, s49, 28672
 s_add_u32 s45, s46, 18432
 buffer_load_dwordx4 v8, s[8:11], s45 offen  lds
 s_add_u32 m0, s49, 29696
 s_add_u32 s45, s46, 23040
 buffer_load_dwordx4 v9, s[8:11], s45 offen  lds
 s_add_u32 m0, s49, 30720
 s_add_u32 s45, s46, 27648
 buffer_load_dwordx4 v8, s[8:11], s45 offen  lds
 s_add_u32 m0, s49, 31744
 s_add_u32 s45, s46, 32256
 buffer_load_dwordx4 v9, s[8:11], s45 offen  lds
 ds_write_b128 v5, v[16:19] offset:6144
 ds_read_b64_tr_b16 a[84:85], v10 offset:36864
 ds_read_b64_tr_b16 a[86:87], v10 offset:37376
 ds_read_b64_tr_b16 a[88:89], v11 offset:36864
 ds_read_b64_tr_b16 a[90:91], v11 offset:37376
 ds_read_b64_tr_b16 a[92:93], v12 offset:36864
 ds_read_b64_tr_b16 a[94:95], v12 offset:37376
 ds_read_b64_tr_b16 v[20:21], v13 offset:36864
 ds_read_b64_tr_b16 v[22:23], v13 offset:37376
 s_waitcnt vmcnt(20) lgkmcnt(0)
 s_add_u32 m0, s49, 32768
 s_add_u32 s45, s46, 36864
 buffer_load_dwordx4 v8, s[8:11], s45 offen  lds
 s_add_u32 m0, s49, 33792
 s_add_u32 s45, s46, 41472
 buffer_load_dwordx4 v9, s[8:11], s45 offen  lds
 s_add_u32 m0, s49, 34816
 s_add_u32 s45, s46, 46080
 buffer_load_dwordx4 v8, s[8:11], s45 offen  lds
 s_add_u32 m0, s49, 35840
 s_add_u32 s45, s46, 50688
 buffer_load_dwordx4 v9, s[8:11], s45 offen  lds
 ds_write_b128 v5, v[20:23] offset:7168
 ds_read_b64_tr_b16 a[96:97], v10 offset:8192
 ds_read_b64_tr_b16 a[98:99], v10 offset:8704
 ds_read_b64_tr_b16 a[100:101], v11 offset:8192
 ds_read_b64_tr_b16 a[102:103], v11 offset:8704
 ds_read_b64_tr_b16 a[104:105], v12 offset:8192
 ds_read_b64_tr_b16 a[106:107], v12 offset:8704
 ds_read_b64_tr_b16 v[32:33], v13 offset:8192
 ds_read_b64_tr_b16 v[34:35], v13 offset:8704
 s_waitcnt vmcnt(20) lgkmcnt(0)
 s_add_u32 m0, s49, 36864
 s_add_u32 s45, s46, 55296
 buffer_load_dwordx4 v8, s[8:11], s45 offen  lds
 s_add_u32 m0, s49, 37888
 s_add_u32 s45, s46, 59904
 buffer_load_dwordx4 v9, s[8:11], s45 offen  lds
 s_add_u32 m0, s49, 38912
 s_add_u32 s45, s46, 64512
 buffer_load_dwordx4 v8, s[8:11], s45 offen  lds
 s_add_u32 m0, s49, 39936
 s_add_u32 s45, s46, 69120
 buffer_load_dwordx4 v9, s[8:11], s45 offen  lds
 ds_read_b64_tr_b16 a[108:109], v10 offset:12288
 ds_read_b64_tr_b16 a[110:111], v10 offset:12800
 ds_read_b64_tr_b16 a[112:113], v11 offset:12288
 ds_read_b64_tr_b16 a[114:115], v11 offset:12800
 ds_read_b64_tr_b16 a[116:117], v12 offset:12288
 ds_read_b64_tr_b16 a[118:119], v12 offset:12800
 ds_read_b64_tr_b16 v[36:37], v13 offset:12288
 ds_read_b64_tr_b16 v[38:39], v13 offset:12800
 s_waitcnt vmcnt(20) lgkmcnt(0)
 s_add_u32 s46, s44, 4
 s_and_b32 s46, s46, 7
 s_lshl_b32 s45, s4, 3
 s_add_u32 s46, s46, s45
 s_mul_i32 s46, s46, 147456
 s_add_u32 s46, s46, s47
 s_add_u32 m0, s49, 8192
 s_add_u32 s45, s46, 0
 buffer_load_dwordx4 v8, s[8:11], s45 offen  lds
 s_add_u32 m0, s49, 9216
 s_add_u32 s45, s46, 4608
 buffer_load_dwordx4 v9, s[8:11], s45 offen  lds
 s_add_u32 m0, s49, 10240
 s_add_u32 s45, s46, 9216
 buffer_load_dwordx4 v8, s[8:11], s45 offen  lds
 s_add_u32 m0, s49, 11264
 s_add_u32 s45, s46, 13824
 buffer_load_dwordx4 v9, s[8:11], s45 offen  lds
 ds_read_b64_tr_b16 a[120:121], v10 offset:16384
 ds_read_b64_tr_b16 a[122:123], v10 offset:16896
 ds_read_b64_tr_b16 a[124:125], v11 offset:16384
 ds_read_b64_tr_b16 a[126:127], v11 offset:16896
 ds_read_b64_tr_b16 a[128:129], v12 offset:16384
 ds_read_b64_tr_b16 a[130:131], v12 offset:16896
 ds_read_b64_tr_b16 v[40:41], v13 offset:16384
 ds_read_b64_tr_b16 v[42:43], v13 offset:16896
 s_waitcnt vmcnt(20) lgkmcnt(0)
 s_add_u32 m0, s49, 12288
 s_add_u32 s45, s46, 18432
 buffer_load_dwordx4 v8, s[8:11], s45 offen  lds
 s_add_u32 m0, s49, 13312
 s_add_u32 s45, s46, 23040
 buffer_load_dwordx4 v9, s[8:11], s45 offen  lds
 s_add_u32 m0, s49, 14336
 s_add_u32 s45, s46, 27648
 buffer_load_dwordx4 v8, s[8:11], s45 offen  lds
 s_add_u32 m0, s49, 15360
 s_add_u32 s45, s46, 32256
 buffer_load_dwordx4 v9, s[8:11], s45 offen  lds
 ds_read_b64_tr_b16 a[132:133], v10 offset:20480
 ds_read_b64_tr_b16 a[134:135], v10 offset:20992
 ds_read_b64_tr_b16 a[136:137], v11 offset:20480
 ds_read_b64_tr_b16 a[138:139], v11 offset:20992
 ds_read_b64_tr_b16 a[140:141], v12 offset:20480
 ds_read_b64_tr_b16 a[142:143], v12 offset:20992
 ds_read_b64_tr_b16 v[44:45], v13 offset:20480
 ds_read_b64_tr_b16 v[46:47], v13 offset:20992
 s_waitcnt vmcnt(20) lgkmcnt(0)
 s_add_u32 m0, s49, 16384
 s_add_u32 s45, s46, 36864
 buffer_load_dwordx4 v8, s[8:11], s45 offen  lds
 s_add_u32 m0, s49, 17408
 s_add_u32 s45, s46, 41472
 buffer_load_dwordx4 v9, s[8:11], s45 offen  lds
 s_add_u32 m0, s49, 18432
 s_add_u32 s45, s46, 46080
 buffer_load_dwordx4 v8, s[8:11], s45 offen  lds
 s_add_u32 m0, s49, 19456
 s_add_u32 s45, s46, 50688
 buffer_load_dwordx4 v9, s[8:11], s45 offen  lds
 ds_read_b64_tr_b16 a[144:145], v10 offset:24576
 ds_read_b64_tr_b16 a[146:147], v10 offset:25088
 ds_read_b64_tr_b16 a[148:149], v11 offset:24576
 ds_read_b64_tr_b16 a[150:151], v11 offset:25088
 ds_read_b64_tr_b16 a[152:153], v12 offset:24576
 ds_read_b64_tr_b16 a[154:155], v12 offset:25088
 ds_read_b64_tr_b16 v[48:49], v13 offset:24576
 ds_read_b64_tr_b16 v[50:51], v13 offset:25088
 s_waitcnt vmcnt(20) lgkmcnt(0)
 s_add_u32 m0, s49, 20480
 s_add_u32 s45, s46, 55296
 buffer_load_dwordx4 v8, s[8:11], s45 offen  lds
 s_add_u32 m0, s49, 21504
 s_add_u32 s45, s46, 59904
 buffer_load_dwordx4 v9, s[8:11], s45 offen  lds
 s_add_u32 m0, s49, 22528
 s_add_u32 s45, s46, 64512
 buffer_load_dwordx4 v8, s[8:11], s45 offen  lds
 s_add_u32 m0, s49, 23552
 s_add_u32 s45, s46, 69120
 buffer_load_dwordx4 v9, s[8:11], s45 offen  lds
 ds_read_b64_tr_b16 a[156:157], v10 offset:28672
 ds_read_b64_tr_b16 a[158:159], v10 offset:29184
 ds_read_b64_tr_b16 a[160:161], v11 offset:28672
 ds_read_b64_tr_b16 a[162:163], v11 offset:29184
 ds_read_b64_tr_b16 a[164:165], v12 offset:28672
 ds_read_b64_tr_b16 a[166:167], v12 offset:29184
 ds_read_b64_tr_b16 v[52:53], v13 offset:28672
 ds_read_b64_tr_b16 v[54:55], v13 offset:29184
 s_waitcnt vmcnt(20) lgkmcnt(0)
 s_add_u32 s46, s44, 5
 s_and_b32 s46, s46, 7
 s_lshl_b32 s45, s4, 3
 s_add_u32 s46, s46, s45
 s_mul_i32 s46, s46, 147456
 s_add_u32 s46, s46, s47
 s_add_u32 m0, s49, 24576
 s_add_u32 s45, s46, 0
 buffer_load_dwordx4 v8, s[8:11], s45 offen  lds
 s_add_u32 m0, s49, 25600
 s_add_u32 s45, s46, 4608
 buffer_load_dwordx4 v9, s[8:11], s45 offen  lds
 s_add_u32 m0, s49, 26624
 s_add_u32 s45, s46, 9216
 buffer_load_dwordx4 v8, s[8:11], s45 offen  lds
 s_add_u32 m0, s49, 27648
 s_add_u32 s45, s46, 13824
 buffer_load_dwordx4 v9, s[8:11], s45 offen  lds
 ds_read_b64_tr_b16 a[168:169], v10 offset:32768
 ds_read_b64_tr_b16 a[170:171], v10 offset:33280
 ds_read_b64_tr_b16 a[172:173], v11 offset:32768
 ds_read_b64_tr_b16 a[174:175], v11 offset:33280
 ds_read_b64_tr_b16 a[176:177], v12 offset:32768
 ds_read_b64_tr_b16 a[178:179], v12 offset:33280
 ds_read_b64_tr_b16 v[56:57], v13 offset:32768
 ds_read_b64_tr_b16 v[58:59], v13 offset:33280
 s_waitcnt vmcnt(20) lgkmcnt(0)
 s_add_u32 m0, s49, 28672
 s_add_u32 s45, s46, 18432
 buffer_load_dwordx4 v8, s[8:11], s45 offen  lds
 s_add_u32 m0, s49, 29696
 s_add_u32 s45, s46, 23040
 buffer_load_dwordx4 v9, s[8:11], s45 offen  lds
 s_add_u32 m0, s49, 30720
 s_add_u32 s45, s46, 27648
 buffer_load_dwordx4 v8, s[8:11], s45 offen  lds
 s_add_u32 m0, s49, 31744
 s_add_u32 s45, s46, 32256
 buffer_load_dwordx4 v9, s[8:11], s45 offen  lds
 ds_read_b64_tr_b16 a[180:181], v10 offset:36864
 ds_read_b64_tr_b16 a[182:183], v10 offset:37376
 ds_read_b64_tr_b16 a[184:185], v11 offset:36864
 ds_read_b64_tr_b16 a[186:187], v11 offset:37376
 ds_read_b64_tr_b16 a[188:189], v12 offset:36864
 ds_read_b64_tr_b16 a[190:191], v12 offset:37376
 ds_read_b64_tr_b16 v[60:61], v13 offset:36864
 ds_read_b64_tr_b16 v[62:63], v13 offset:37376
 s_waitcnt vmcnt(20) lgkmcnt(0)
 s_add_u32 m0, s49, 32768
 s_add_u32 s45, s46, 36864
 buffer_load_dwordx4 v8, s[8:11], s45 offen  lds
 s_add_u32 m0, s49, 33792
 s_add_u32 s45, s46, 41472
 buffer_load_dwordx4 v9, s[8:11], s45 offen  lds
 s_add_u32 m0, s49, 34816
 s_add_u32 s45, s46, 46080
 buffer_load_dwordx4 v8, s[8:11], s45 offen  lds
 s_add_u32 m0, s49, 35840
 s_add_u32 s45, s46, 50688
 buffer_load_dwordx4 v9, s[8:11], s45 offen  lds
 ds_read_b64_tr_b16 a[192:193], v10 offset:8192
 ds_read_b64_tr_b16 a[194:195], v10 offset:8704
 ds_read_b64_tr_b16 a[196:197], v11 offset:8192
 ds_read_b64_tr_b16 a[198:199], v11 offset:8704
 ds_read_b64_tr_b16 a[200:201], v12 offset:8192
 ds_read_b64_tr_b16 a[202:203], v12 offset:8704
 ds_read_b64_tr_b16 v[64:65], v13 offset:8192
 ds_read_b64_tr_b16 v[66:67], v13 offset:8704
 s_waitcnt vmcnt(20) lgkmcnt(0)
 s_add_u32 m0, s49, 36864
 s_add_u32 s45, s46, 55296
 buffer_load_dwordx4 v8, s[8:11], s45 offen  lds
 s_add_u32 m0, s49, 37888
 s_add_u32 s45, s46, 59904
 buffer_load_dwordx4 v9, s[8:11], s45 offen  lds
 s_add_u32 m0, s49, 38912
 s_add_u32 s45, s46, 64512
 buffer_load_dwordx4 v8, s[8:11], s45 offen  lds
 s_add_u32 m0, s49, 39936
 s_add_u32 s45, s46, 69120
 buffer_load_dwordx4 v9, s[8:11], s45 offen  lds
 ds_read_b64_tr_b16 a[204:205], v10 offset:12288
 ds_read_b64_tr_b16 a[206:207], v10 offset:12800
 ds_read_b64_tr_b16 a[208:209], v11 offset:12288
 ds_read_b64_tr_b16 a[210:211], v11 offset:12800
 ds_read_b64_tr_b16 a[212:213], v12 offset:12288
 ds_read_b64_tr_b16 a[214:215], v12 offset:12800
 ds_read_b64_tr_b16 v[68:69], v13 offset:12288
 ds_read_b64_tr_b16 v[70:71], v13 offset:12800
 s_waitcnt vmcnt(20) lgkmcnt(0)
 s_add_u32 s46, s44, 6
 s_and_b32 s46, s46, 7
 s_lshl_b32 s45, s4, 3
 s_add_u32 s46, s46, s45
 s_mul_i32 s46, s46, 147456
 s_add_u32 s46, s46, s47
 s_add_u32 m0, s49, 8192
 s_add_u32 s45, s46, 0
 buffer_load_dwordx4 v8, s[8:11], s45 offen  lds
 s_add_u32 m0, s49, 9216
 s_add_u32 s45, s46, 4608
 buffer_load_dwordx4 v9, s[8:11], s45 offen  lds
 s_add_u32 m0, s49, 10240
 s_add_u32 s45, s46, 9216
 buffer_load_dwordx4 v8, s[8:11], s45 offen  lds
 s_add_u32 m0, s49, 11264
 s_add_u32 s45, s46, 13824
 buffer_load_dwordx4 v9, s[8:11], s45 offen  lds
 ds_read_b64_tr_b16 a[216:217], v10 offset:16384
 ds_read_b64_tr_b16 a[218:219], v10 offset:16896
 ds_read_b64_tr_b16 a[220:221], v11 offset:16384
 ds_read_b64_tr_b16 a[222:223], v11 offset:16896
 ds_read_b64_tr_b16 a[224:225], v12 offset:16384
 ds_read_b64_tr_b16 a[226:227], v12 offset:16896
 ds_read_b64_tr_b16 v[72:73], v13 offset:16384
 ds_read_b64_tr_b16 v[74:75], v13 offset:16896
 s_waitcnt vmcnt(20) lgkmcnt(0)
 s_add_u32 m0, s49, 12288
 s_add_u32 s45, s46, 18432
 buffer_load_dwordx4 v8, s[8:11], s45 offen  lds
 s_add_u32 m0, s49, 13312
 s_add_u32 s45, s46, 23040
 buffer_load_dwordx4 v9, s[8:11], s45 offen  lds
 s_add_u32 m0, s49, 14336
 s_add_u32 s45, s46, 27648
 buffer_load_dwordx4 v8, s[8:11], s45 offen  lds
 s_add_u32 m0, s49, 15360
 s_add_u32 s45, s46, 32256
 buffer_load_dwordx4 v9, s[8:11], s45 offen  lds
 ds_read_b64_tr_b16 a[228:229], v10 offset:20480
 ds_read_b64_tr_b16 a[230:231], v10 offset:20992
 ds_read_b64_tr_b16 a[232:233], v11 offset:20480
 ds_read_b64_tr_b16 a[234:235], v11 offset:20992
 ds_read_b64_tr_b16 a[236:237], v12 offset:20480
 ds_read_b64_tr_b16 a[238:239], v12 offset:20992
 ds_read_b64_tr_b16 v[76:77], v13 offset:20480
 ds_read_b64_tr_b16 v[78:79], v13 offset:20992
 s_waitcnt vmcnt(20) lgkmcnt(0)
 s_add_u32 m0, s49, 16384
 s_add_u32 s45, s46, 36864
 buffer_load_dwordx4 v8, s[8:11], s45 offen  lds
 s_add_u32 m0, s49, 17408
 s_add_u32 s45, s46, 41472
 buffer_load_dwordx4 v9, s[8:11], s45 offen  lds
 s_add_u32 m0, s49, 18432
 s_add_u32 s45, s46, 46080
 buffer_load_dwordx4 v8, s[8:11], s45 offen  lds
 s_add_u32 m0, s49, 19456
 s_add_u32 s45, s46, 50688
 buffer_load_dwordx4 v9, s[8:11], s45 offen  lds
 ds_read_b64_tr_b16 a[240:241], v10 offset:24576
 ds_read_b64_tr_b16 a[242:243], v10 offset:25088
 ds_read_b64_tr_b16 a[244:245], v11 offset:24576
 ds_read_b64_tr_b16 a[246:247], v11 offset:25088
 ds_read_b64_tr_b16 a[248:249], v12 offset:24576
 ds_read_b64_tr_b16 a[250:251], v12 offset:25088
 ds_read_b64_tr_b16 v[80:81], v13 offset:24576
 ds_read_b64_tr_b16 v[82:83], v13 offset:25088
 s_waitcnt vmcnt(20) lgkmcnt(0)
 s_add_u32 m0, s49, 20480
 s_add_u32 s45, s46, 55296
 buffer_load_dwordx4 v8, s[8:11], s45 offen  lds
 s_add_u32 m0, s49, 21504
 s_add_u32 s45, s46, 59904
 buffer_load_dwordx4 v9, s[8:11], s45 offen  lds
 s_add_u32 m0, s49, 22528
 s_add_u32 s45, s46, 64512
 buffer_load_dwordx4 v8, s[8:11], s45 offen  lds
 s_add_u32 m0, s49, 23552
 s_add_u32 s45, s46, 69120
 buffer_load_dwordx4 v9, s[8:11], s45 offen  lds
 ds_read_b64_tr_b16 a[252:253], v10 offset:28672
 ds_read_b64_tr_b16 a[254:255], v10 offset:29184
 ds_read_b64_tr_b16 v[128:129], v11 offset:28672
 ds_read_b64_tr_b16 v[130:131], v11 offset:29184
 ds_read_b64_tr_b16 v[132:133], v12 offset:28672
 ds_read_b64_tr_b16 v[134:135], v12 offset:29184
 ds_read_b64_tr_b16 v[84:85], v13 offset:28672
 ds_read_b64_tr_b16 v[86:87], v13 offset:29184
 s_waitcnt vmcnt(20) lgkmcnt(0)
 s_add_u32 s46, s44, 7
 s_and_b32 s46, s46, 7
 s_lshl_b32 s45, s4, 3
 s_add_u32 s46, s46, s45
 s_mul_i32 s46, s46, 147456
 s_add_u32 s46, s46, s47
 s_add_u32 m0, s49, 24576
 s_add_u32 s45, s46, 0
 buffer_load_dwordx4 v8, s[8:11], s45 offen  lds
 s_add_u32 m0, s49, 25600
 s_add_u32 s45, s46, 4608
 buffer_load_dwordx4 v9, s[8:11], s45 offen  lds
 s_add_u32 m0, s49, 26624
 s_add_u32 s45, s46, 9216
 buffer_load_dwordx4 v8, s[8:11], s45 offen  lds
 s_add_u32 m0, s49, 27648
 s_add_u32 s45, s46, 13824
 buffer_load_dwordx4 v9, s[8:11], s45 offen  lds
 ds_read_b64_tr_b16 v[136:137], v10 offset:32768
 ds_read_b64_tr_b16 v[138:139], v10 offset:33280
 ds_read_b64_tr_b16 v[140:141], v11 offset:32768
 ds_read_b64_tr_b16 v[142:143], v11 offset:33280
 ds_read_b64_tr_b16 v[144:145], v12 offset:32768
 ds_read_b64_tr_b16 v[146:147], v12 offset:33280
 ds_read_b64_tr_b16 v[88:89], v13 offset:32768
 ds_read_b64_tr_b16 v[90:91], v13 offset:33280
 s_waitcnt vmcnt(20) lgkmcnt(0)
 s_add_u32 m0, s49, 28672
 s_add_u32 s45, s46, 18432
 buffer_load_dwordx4 v8, s[8:11], s45 offen  lds
 s_add_u32 m0, s49, 29696
 s_add_u32 s45, s46, 23040
 buffer_load_dwordx4 v9, s[8:11], s45 offen  lds
 s_add_u32 m0, s49, 30720
 s_add_u32 s45, s46, 27648
 buffer_load_dwordx4 v8, s[8:11], s45 offen  lds
 s_add_u32 m0, s49, 31744
 s_add_u32 s45, s46, 32256
 buffer_load_dwordx4 v9, s[8:11], s45 offen  lds
 ds_read_b64_tr_b16 v[148:149], v10 offset:36864
 ds_read_b64_tr_b16 v[150:151], v10 offset:37376
 ds_read_b64_tr_b16 v[152:153], v11 offset:36864
 ds_read_b64_tr_b16 v[154:155], v11 offset:37376
 ds_read_b64_tr_b16 v[156:157], v12 offset:36864
 ds_read_b64_tr_b16 v[158:159], v12 offset:37376
 ds_read_b64_tr_b16 v[92:93], v13 offset:36864
 ds_read_b64_tr_b16 v[94:95], v13 offset:37376
 s_waitcnt vmcnt(20) lgkmcnt(0)
 s_add_u32 m0, s49, 32768
 s_add_u32 s45, s46, 36864
 buffer_load_dwordx4 v8, s[8:11], s45 offen  lds
 s_add_u32 m0, s49, 33792
 s_add_u32 s45, s46, 41472
 buffer_load_dwordx4 v9, s[8:11], s45 offen  lds
 s_add_u32 m0, s49, 34816
 s_add_u32 s45, s46, 46080
 buffer_load_dwordx4 v8, s[8:11], s45 offen  lds
 s_add_u32 m0, s49, 35840
 s_add_u32 s45, s46, 50688
 buffer_load_dwordx4 v9, s[8:11], s45 offen  lds
 ds_read_b64_tr_b16 v[160:161], v10 offset:8192
 ds_read_b64_tr_b16 v[162:163], v10 offset:8704
 ds_read_b64_tr_b16 v[164:165], v11 offset:8192
 ds_read_b64_tr_b16 v[166:167], v11 offset:8704
 ds_read_b64_tr_b16 v[168:169], v12 offset:8192
 ds_read_b64_tr_b16 v[170:171], v12 offset:8704
 ds_read_b64_tr_b16 v[96:97], v13 offset:8192
 ds_read_b64_tr_b16 v[98:99], v13 offset:8704
 s_waitcnt vmcnt(20) lgkmcnt(0)
 s_add_u32 m0, s49, 36864
 s_add_u32 s45, s46, 55296
 buffer_load_dwordx4 v8, s[8:11], s45 offen  lds
 s_add_u32 m0, s49, 37888
 s_add_u32 s45, s46, 59904
 buffer_load_dwordx4 v9, s[8:11], s45 offen  lds
 s_add_u32 m0, s49, 38912
 s_add_u32 s45, s46, 64512
 buffer_load_dwordx4 v8, s[8:11], s45 offen  lds
 s_add_u32 m0, s49, 39936
 s_add_u32 s45, s46, 69120
 buffer_load_dwordx4 v9, s[8:11], s45 offen  lds
 ds_read_b64_tr_b16 v[172:173], v10 offset:12288
 ds_read_b64_tr_b16 v[174:175], v10 offset:12800
 ds_read_b64_tr_b16 v[176:177], v11 offset:12288
 ds_read_b64_tr_b16 v[178:179], v11 offset:12800
 ds_read_b64_tr_b16 v[180:181], v12 offset:12288
 ds_read_b64_tr_b16 v[182:183], v12 offset:12800
 ds_read_b64_tr_b16 v[100:101], v13 offset:12288
 ds_read_b64_tr_b16 v[102:103], v13 offset:12800
 s_waitcnt vmcnt(20) lgkmcnt(0)
 ds_read_b64_tr_b16 v[184:185], v10 offset:16384
 ds_read_b64_tr_b16 v[186:187], v10 offset:16896
 ds_read_b64_tr_b16 v[188:189], v11 offset:16384
 ds_read_b64_tr_b16 v[190:191], v11 offset:16896
 ds_read_b64_tr_b16 v[192:193], v12 offset:16384
 ds_read_b64_tr_b16 v[194:195], v12 offset:16896
 ds_read_b64_tr_b16 v[104:105], v13 offset:16384
 ds_read_b64_tr_b16 v[106:107], v13 offset:16896
 s_waitcnt vmcnt(16) lgkmcnt(0)
 ds_read_b64_tr_b16 v[196:197], v10 offset:20480
 ds_read_b64_tr_b16 v[198:199], v10 offset:20992
 ds_read_b64_tr_b16 v[200:201], v11 offset:20480
 ds_read_b64_tr_b16 v[202:203], v11 offset:20992
 ds_read_b64_tr_b16 v[204:205], v12 offset:20480
 ds_read_b64_tr_b16 v[206:207], v12 offset:20992
 ds_read_b64_tr_b16 v[108:109], v13 offset:20480
 ds_read_b64_tr_b16 v[110:111], v13 offset:20992
 s_waitcnt vmcnt(12) lgkmcnt(0)
 ds_read_b64_tr_b16 v[208:209], v10 offset:24576
 ds_read_b64_tr_b16 v[210:211], v10 offset:25088
 ds_read_b64_tr_b16 v[212:213], v11 offset:24576
 ds_read_b64_tr_b16 v[214:215], v11 offset:25088
 ds_read_b64_tr_b16 v[216:217], v12 offset:24576
 ds_read_b64_tr_b16 v[218:219], v12 offset:25088
 ds_read_b64_tr_b16 v[112:113], v13 offset:24576
 ds_read_b64_tr_b16 v[114:115], v13 offset:25088
 s_waitcnt vmcnt(8) lgkmcnt(0)
 ds_read_b64_tr_b16 v[220:221], v10 offset:28672
 ds_read_b64_tr_b16 v[222:223], v10 offset:29184
 ds_read_b64_tr_b16 v[224:225], v11 offset:28672
 ds_read_b64_tr_b16 v[226:227], v11 offset:29184
 ds_read_b64_tr_b16 v[228:229], v12 offset:28672
 ds_read_b64_tr_b16 v[230:231], v12 offset:29184
 ds_read_b64_tr_b16 v[116:117], v13 offset:28672
 ds_read_b64_tr_b16 v[118:119], v13 offset:29184
 s_waitcnt vmcnt(4) lgkmcnt(0)
 ds_read_b64_tr_b16 v[232:233], v10 offset:32768
 ds_read_b64_tr_b16 v[234:235], v10 offset:33280
 ds_read_b64_tr_b16 v[236:237], v11 offset:32768
 ds_read_b64_tr_b16 v[238:239], v11 offset:33280
 ds_read_b64_tr_b16 v[240:241], v12 offset:32768
 ds_read_b64_tr_b16 v[242:243], v12 offset:33280
 ds_read_b64_tr_b16 v[120:121], v13 offset:32768
 ds_read_b64_tr_b16 v[122:123], v13 offset:33280
 s_waitcnt vmcnt(0) lgkmcnt(0)
 ds_read_b64_tr_b16 v[244:245], v10 offset:36864
 ds_read_b64_tr_b16 v[246:247], v10 offset:37376
 ds_read_b64_tr_b16 v[248:249], v11 offset:36864
 ds_read_b64_tr_b16 v[250:251], v11 offset:37376
 ds_read_b64_tr_b16 v[252:253], v12 offset:36864
 ds_read_b64_tr_b16 v[254:255], v12 offset:37376
 ds_read_b64_tr_b16 v[124:125], v13 offset:36864
 ds_read_b64_tr_b16 v[126:127], v13 offset:37376
 s_waitcnt lgkmcnt(0)
 ds_write_b128 v5, v[32:35] offset:8192
 ds_write_b128 v5, v[36:39] offset:9216
 ds_write_b128 v5, v[40:43] offset:10240
 ds_write_b128 v5, v[44:47] offset:11264
 ds_write_b128 v5, v[48:51] offset:12288
 ds_write_b128 v5, v[52:55] offset:13312
 ds_write_b128 v5, v[56:59] offset:14336
 ds_write_b128 v5, v[60:63] offset:15360
 ds_write_b128 v5, v[64:67] offset:16384
 ds_write_b128 v5, v[68:71] offset:17408
 ds_write_b128 v5, v[72:75] offset:18432
 ds_write_b128 v5, v[76:79] offset:19456
 ds_write_b128 v5, v[80:83] offset:20480
 ds_write_b128 v5, v[84:87] offset:21504
 ds_write_b128 v5, v[88:91] offset:22528
 ds_write_b128 v5, v[92:95] offset:23552
 ds_write_b128 v5, v[96:99] offset:24576
 ds_write_b128 v5, v[100:103] offset:25600
 ds_write_b128 v5, v[104:107] offset:26624
 ds_write_b128 v5, v[108:111] offset:27648
 ds_write_b128 v5, v[112:115] offset:28672
 ds_write_b128 v5, v[116:119] offset:29696
 ds_write_b128 v5, v[120:123] offset:30720
 ds_write_b128 v5, v[124:127] offset:31744
 s_waitcnt lgkmcnt(0)
 v_lshrrev_b32 v13, 2, v15
 v_and_b32 v14, 3, v15
 s_lshr_b32 s45, s4, 1
 s_mul_i32 s45, s45, 36864
 s_and_b32 s46, s4, 1
 s_lshl_b32 s46, s46, 6
 s_add_u32 s45, s45, s46
 s_add_u32 s37, s37, s45
 v_mul_u32_u24 v6, 2304, v13
 v_lshl_add_u32 v6, v14, 4, v6
 v_lshl_add_u32 v13, v14, 2, v13
 v_and_b32 v13, 15, v13
 v_lshlrev_b32 v13, 4, v13
 s_lshl_b32 s45, s4, 11
 v_lshl_add_u32 v12, v14, 9, v13
 v_add_u32 v12, s45, v12
 v_lshrrev_b32 v13, 5, v15
 v_lshl_add_u32 v13, v13, 2, v15
 v_and_b32 v13, 15, v13
 v_and_or_b32 v13, v15, 48, v13
 v_lshlrev_b32 v13, 4, v13
 v_xor_b32 v14, 0x80, v13
 v_add_u32 v15, s49, v14
 v_add_u32 v14, s49, v13
 v_add_u32 v4, 32768, v12
 v_add_u32 v7, 114688, v12
 s_lshl_b32 s45, s32, 7
 s_add_u32 s37, s37, s45
 s_lshl_b32 s45, s4, 16
 s_add_u32 s36, s36, s45
 s_mov_b32 s42, s33
 s_mov_b32 s43, 0
 s_and_b32 s53, s42, s93
 s_lshl_b32 s53, s53, s91
 s_add_u32 s53, s53, s38
 s_lshr_b32 s51, s42, s90
 s_add_u32 s51, s51, 1
 ds_read_b128 v[16:19], v5 offset:0
 ds_read_b128 v[20:23], v5 offset:1024
Los0_33:
 buffer_load_dword v2, v3, s[20:23], s53 offen sc1
 s_waitcnt vmcnt(0)
 v_cmp_gt_u32 vcc, s51, v2
 s_and_b32 s52, vcc_lo, 0xffff
 s_cbranch_scc0 Los0k_34
 s_sleep 4
 s_sub_u32 s50, s50, 1
 s_cbranch_scc0 Los0_33
 s_endpgm
Los0k_34:
 s_lshl_b32 s48, s42, 18
 s_add_u32 s48, s48, s36
 s_add_u32 s52, s44, 0
 s_and_b32 s52, s52, 7
 s_lshl_b32 s52, s52, 13
 s_add_u32 s46, s48, s52
 s_add_u32 s47, s46, 4096
 buffer_load_dwordx4 v[32:35], v1, s[20:23], s46 offen offset:0 sc1
 buffer_load_dwordx4 v[36:39], v1, s[20:23], s46 offen offset:1024 sc1
 buffer_load_dwordx4 v[40:43], v1, s[20:23], s46 offen offset:2048 sc1
 buffer_load_dwordx4 v[44:47], v1, s[20:23], s46 offen offset:3072 sc1
 buffer_load_dwordx4 v[48:51], v1, s[20:23], s47 offen offset:0 sc1
 buffer_load_dwordx4 v[52:55], v1, s[20:23], s47 offen offset:1024 sc1
 buffer_load_dwordx4 v[56:59], v1, s[20:23], s47 offen offset:2048 sc1
 buffer_load_dwordx4 v[60:63], v1, s[20:23], s47 offen offset:3072 sc1
 s_add_u32 s52, s44, 1
 s_and_b32 s52, s52, 7
 s_lshl_b32 s52, s52, 13
 s_add_u32 s46, s48, s52
 s_add_u32 s47, s46, 4096
 buffer_load_dwordx4 v[64:67], v1, s[20:23], s46 offen offset:0 sc1
 buffer_load_dwordx4 v[68:71], v1, s[20:23], s46 offen offset:1024 sc1
 buffer_load_dwordx4 v[72:75], v1, s[20:23], s46 offen offset:2048 sc1
 buffer_load_dwordx4 v[76:79], v1, s[20:23], s46 offen offset:3072 sc1
 buffer_load_dwordx4 v[80:83], v1, s[20:23], s47 offen offset:0 sc1
 buffer_load_dwordx4 v[84:87], v1, s[20:23], s47 offen offset:1024 sc1
 buffer_load_dwordx4 v[88:91], v1, s[20:23], s47 offen offset:2048 sc1
 buffer_load_dwordx4 v[92:95], v1, s[20:23], s47 offen offset:3072 sc1
 .p2align 3
Losl_35:
 s_waitcnt vmcnt(14) lgkmcnt(1)
 v_mfma_f32_16x16x32_bf16 v[96:99], a[0:3], v[32:35], 0
 s_add_u32 s52, s44, 2
 s_and_b32 s52, s52, 7
 v_mfma_f32_16x16x32_bf16 v[100:103], a[4:7], v[32:35], 0
 s_lshl_b32 s52, s52, 13
 s_add_u32 s46, s48, s52
 v_mfma_f32_16x16x32_bf16 v[104:107], a[8:11], v[32:35], 0
 s_add_u32 s47, s46, 4096
 v_mfma_f32_16x16x32_bf16 v[108:111], v[16:19], v[32:35], 0
 buffer_load_dwordx4 v[32:35], v1, s[20:23], s46 offen offset:0 sc1
 v_mfma_f32_16x16x32_bf16 v[112:115], a[0:3], v[36:39], 0
 ds_read_b128 v[24:27], v5 offset:2048
 v_mfma_f32_16x16x32_bf16 v[116:119], a[4:7], v[36:39], 0
 v_mfma_f32_16x16x32_bf16 v[120:123], a[8:11], v[36:39], 0
 v_mfma_f32_16x16x32_bf16 v[124:127], v[16:19], v[36:39], 0
 buffer_load_dwordx4 v[36:39], v1, s[20:23], s46 offen offset:1024 sc1
 s_waitcnt vmcnt(14) lgkmcnt(1)
 v_mfma_f32_16x16x32_bf16 v[96:99], a[12:15], v[40:43], v[96:99]
 s_mov_b32 s41, s42
 s_add_u32 s43, s43, 1
 v_mfma_f32_16x16x32_bf16 v[100:103], a[16:19], v[40:43], v[100:103]
 s_cmp_lt_u32 s43, s35
 s_cselect_b32 s45, s34, 0
 v_mfma_f32_16x16x32_bf16 v[104:107], a[20:23], v[40:43], v[104:107]
 s_xor_b32 s34, s34, s39
 s_add_u32 s42, s42, s45
 v_mfma_f32_16x16x32_bf16 v[108:111], v[20:23], v[40:43], v[108:111]
 buffer_load_dwordx4 v[40:43], v1, s[20:23], s46 offen offset:2048 sc1
 v_mfma_f32_16x16x32_bf16 v[112:115], a[12:15], v[44:47], v[112:115]
 ds_read_b128 v[28:31], v5 offset:3072
 v_mfma_f32_16x16x32_bf16 v[116:119], a[16:19], v[44:47], v[116:119]
 v_mfma_f32_16x16x32_bf16 v[120:123], a[20:23], v[44:47], v[120:123]
 v_mfma_f32_16x16x32_bf16 v[124:127], v[20:23], v[44:47], v[124:127]
 buffer_load_dwordx4 v[44:47], v1, s[20:23], s46 offen offset:3072 sc1
 s_waitcnt vmcnt(14) lgkmcnt(1)
 v_mfma_f32_16x16x32_bf16 v[96:99], a[24:27], v[48:51], v[96:99]
 s_and_b32 s53, s42, s93
 s_lshl_b32 s53, s53, s91
 v_mfma_f32_16x16x32_bf16 v[100:103], a[28:31], v[48:51], v[100:103]
 s_add_u32 s53, s53, s38
 s_lshr_b32 s51, s42, s90
 v_mfma_f32_16x16x32_bf16 v[104:107], a[32:35], v[48:51], v[104:107]
 s_add_u32 s51, s51, 1
 v_mfma_f32_16x16x32_bf16 v[108:111], v[24:27], v[48:51], v[108:111]
 buffer_load_dwordx4 v[48:51], v1, s[20:23], s47 offen offset:0 sc1
 v_mfma_f32_16x16x32_bf16 v[112:115], a[24:27], v[52:55], v[112:115]
 ds_read_b128 v[16:19], v5 offset:4096
 v_mfma_f32_16x16x32_bf16 v[116:119], a[28:31], v[52:55], v[116:119]
 v_mfma_f32_16x16x32_bf16 v[120:123], a[32:35], v[52:55], v[120:123]
 v_mfma_f32_16x16x32_bf16 v[124:127], v[24:27], v[52:55], v[124:127]
 buffer_load_dwordx4 v[52:55], v1, s[20:23], s47 offen offset:1024 sc1
 s_waitcnt vmcnt(14) lgkmcnt(1)
 v_mfma_f32_16x16x32_bf16 v[96:99], a[36:39], v[56:59], v[96:99]
 s_mul_i32 s54, s41, 73728
 s_add_u32 s54, s54, s37
 v_mfma_f32_16x16x32_bf16 v[100:103], a[40:43], v[56:59], v[100:103]
 v_mfma_f32_16x16x32_bf16 v[104:107], a[44:47], v[56:59], v[104:107]
 v_mfma_f32_16x16x32_bf16 v[108:111], v[28:31], v[56:59], v[108:111]
 buffer_load_dwordx4 v[56:59], v1, s[20:23], s47 offen offset:2048 sc1
 v_mfma_f32_16x16x32_bf16 v[112:115], a[36:39], v[60:63], v[112:115]
 ds_read_b128 v[20:23], v5 offset:5120
 v_mfma_f32_16x16x32_bf16 v[116:119], a[40:43], v[60:63], v[116:119]
 v_mfma_f32_16x16x32_bf16 v[120:123], a[44:47], v[60:63], v[120:123]
 v_mfma_f32_16x16x32_bf16 v[124:127], v[28:31], v[60:63], v[124:127]
 buffer_load_dwordx4 v[60:63], v1, s[20:23], s47 offen offset:3072 sc1
 s_waitcnt vmcnt(14) lgkmcnt(1)
 v_mfma_f32_16x16x32_bf16 v[96:99], a[48:51], v[64:67], v[96:99]
 s_add_u32 s52, s44, 3
 s_and_b32 s52, s52, 7
 v_mfma_f32_16x16x32_bf16 v[100:103], a[52:55], v[64:67], v[100:103]
 s_lshl_b32 s52, s52, 13
 s_add_u32 s46, s48, s52
 v_mfma_f32_16x16x32_bf16 v[104:107], a[56:59], v[64:67], v[104:107]
 s_add_u32 s47, s46, 4096
 v_mfma_f32_16x16x32_bf16 v[108:111], v[16:19], v[64:67], v[108:111]
 buffer_load_dwordx4 v[64:67], v1, s[20:23], s46 offen offset:0 sc1
 v_mfma_f32_16x16x32_bf16 v[112:115], a[48:51], v[68:71], v[112:115]
 ds_read_b128 v[24:27], v5 offset:6144
 v_mfma_f32_16x16x32_bf16 v[116:119], a[52:55], v[68:71], v[116:119]
 v_mfma_f32_16x16x32_bf16 v[120:123], a[56:59], v[68:71], v[120:123]
 v_mfma_f32_16x16x32_bf16 v[124:127], v[16:19], v[68:71], v[124:127]
 buffer_load_dwordx4 v[68:71], v1, s[20:23], s46 offen offset:1024 sc1
 s_waitcnt vmcnt(14) lgkmcnt(1)
 v_mfma_f32_16x16x32_bf16 v[96:99], a[60:63], v[72:75], v[96:99]
 v_mfma_f32_16x16x32_bf16 v[100:103], a[64:67], v[72:75], v[100:103]
 v_mfma_f32_16x16x32_bf16 v[104:107], a[68:71], v[72:75], v[104:107]
 v_mfma_f32_16x16x32_bf16 v[108:111], v[20:23], v[72:75], v[108:111]
 buffer_load_dwordx4 v[72:75], v1, s[20:23], s46 offen offset:2048 sc1
 v_mfma_f32_16x16x32_bf16 v[112:115], a[60:63], v[76:79], v[112:115]
 ds_read_b128 v[28:31], v5 offset:7168
 v_mfma_f32_16x16x32_bf16 v[116:119], a[64:67], v[76:79], v[116:119]
 v_mfma_f32_16x16x32_bf16 v[120:123], a[68:71], v[76:79], v[120:123]
 v_mfma_f32_16x16x32_bf16 v[124:127], v[20:23], v[76:79], v[124:127]
 buffer_load_dwordx4 v[76:79], v1, s[20:23], s46 offen offset:3072 sc1
 s_waitcnt vmcnt(14) lgkmcnt(1)
 v_mfma_f32_16x16x32_bf16 v[96:99], a[72:75], v[80:83], v[96:99]
 v_mfma_f32_16x16x32_bf16 v[100:103], a[76:79], v[80:83], v[100:103]
 v_mfma_f32_16x16x32_bf16 v[104:107], a[80:83], v[80:83], v[104:107]
 v_mfma_f32_16x16x32_bf16 v[108:111], v[24:27], v[80:83], v[108:111]
 buffer_load_dwordx4 v[80:83], v1, s[20:23], s47 offen offset:0 sc1
 v_mfma_f32_16x16x32_bf16 v[112:115], a[72:75], v[84:87], v[112:115]
 ds_read_b128 v[16:19], v5 offset:8192
 v_mfma_f32_16x16x32_bf16 v[116:119], a[76:79], v[84:87], v[116:119]
 v_mfma_f32_16x16x32_bf16 v[120:123], a[80:83], v[84:87], v[120:123]
 v_mfma_f32_16x16x32_bf16 v[124:127], v[24:27], v[84:87], v[124:127]
 buffer_load_dwordx4 v[84:87], v1, s[20:23], s47 offen offset:1024 sc1
 s_waitcnt vmcnt(14) lgkmcnt(1)
 v_mfma_f32_16x16x32_bf16 v[96:99], a[84:87], v[88:91], v[96:99]
 v_mfma_f32_16x16x32_bf16 v[100:103], a[88:91], v[88:91], v[100:103]
 v_mfma_f32_16x16x32_bf16 v[104:107], a[92:95], v[88:91], v[104:107]
 v_mfma_f32_16x16x32_bf16 v[108:111], v[28:31], v[88:91], v[108:111]
 buffer_load_dwordx4 v[88:91], v1, s[20:23], s47 offen offset:2048 sc1
 v_mfma_f32_16x16x32_bf16 v[112:115], a[84:87], v[92:95], v[112:115]
 ds_read_b128 v[20:23], v5 offset:9216
 v_mfma_f32_16x16x32_bf16 v[116:119], a[88:91], v[92:95], v[116:119]
 v_mfma_f32_16x16x32_bf16 v[120:123], a[92:95], v[92:95], v[120:123]
 v_mfma_f32_16x16x32_bf16 v[124:127], v[28:31], v[92:95], v[124:127]
 buffer_load_dwordx4 v[92:95], v1, s[20:23], s47 offen offset:3072 sc1
 s_waitcnt vmcnt(14) lgkmcnt(1)
 v_mfma_f32_16x16x32_bf16 v[96:99], a[96:99], v[32:35], v[96:99]
 s_add_u32 s52, s44, 4
 s_and_b32 s52, s52, 7
 v_mfma_f32_16x16x32_bf16 v[100:103], a[100:103], v[32:35], v[100:103]
 s_lshl_b32 s52, s52, 13
 s_add_u32 s46, s48, s52
 v_mfma_f32_16x16x32_bf16 v[104:107], a[104:107], v[32:35], v[104:107]
 s_add_u32 s47, s46, 4096
 v_mfma_f32_16x16x32_bf16 v[108:111], v[16:19], v[32:35], v[108:111]
 buffer_load_dwordx4 v[32:35], v1, s[20:23], s46 offen offset:0 sc1
 v_mfma_f32_16x16x32_bf16 v[112:115], a[96:99], v[36:39], v[112:115]
 ds_read_b128 v[24:27], v5 offset:10240
 v_mfma_f32_16x16x32_bf16 v[116:119], a[100:103], v[36:39], v[116:119]
 v_mfma_f32_16x16x32_bf16 v[120:123], a[104:107], v[36:39], v[120:123]
 v_mfma_f32_16x16x32_bf16 v[124:127], v[16:19], v[36:39], v[124:127]
 buffer_load_dwordx4 v[36:39], v1, s[20:23], s46 offen offset:1024 sc1
 s_waitcnt vmcnt(14) lgkmcnt(1)
 v_mfma_f32_16x16x32_bf16 v[96:99], a[108:111], v[40:43], v[96:99]
 v_mfma_f32_16x16x32_bf16 v[100:103], a[112:115], v[40:43], v[100:103]
 v_mfma_f32_16x16x32_bf16 v[104:107], a[116:119], v[40:43], v[104:107]
 v_mfma_f32_16x16x32_bf16 v[108:111], v[20:23], v[40:43], v[108:111]
 buffer_load_dwordx4 v[40:43], v1, s[20:23], s46 offen offset:2048 sc1
 v_mfma_f32_16x16x32_bf16 v[112:115], a[108:111], v[44:47], v[112:115]
 ds_read_b128 v[28:31], v5 offset:11264
 v_mfma_f32_16x16x32_bf16 v[116:119], a[112:115], v[44:47], v[116:119]
 v_mfma_f32_16x16x32_bf16 v[120:123], a[116:119], v[44:47], v[120:123]
 v_mfma_f32_16x16x32_bf16 v[124:127], v[20:23], v[44:47], v[124:127]
 buffer_load_dwordx4 v[44:47], v1, s[20:23], s46 offen offset:3072 sc1
 s_waitcnt vmcnt(14) lgkmcnt(1)
 v_mfma_f32_16x16x32_bf16 v[96:99], a[120:123], v[48:51], v[96:99]
 s_barrier
 v_mfma_f32_16x16x32_bf16 v[100:103], a[124:127], v[48:51], v[100:103]
 v_mfma_f32_16x16x32_bf16 v[104:107], a[128:131], v[48:51], v[104:107]
 v_mfma_f32_16x16x32_bf16 v[108:111], v[24:27], v[48:51], v[108:111]
 buffer_load_dwordx4 v[48:51], v1, s[20:23], s47 offen offset:0 sc1
 v_mfma_f32_16x16x32_bf16 v[112:115], a[120:123], v[52:55], v[112:115]
 ds_read_b128 v[16:19], v5 offset:12288
 v_mfma_f32_16x16x32_bf16 v[116:119], a[124:127], v[52:55], v[116:119]
 v_mfma_f32_16x16x32_bf16 v[120:123], a[128:131], v[52:55], v[120:123]
 v_mfma_f32_16x16x32_bf16 v[124:127], v[24:27], v[52:55], v[124:127]
 buffer_load_dwordx4 v[52:55], v1, s[20:23], s47 offen offset:1024 sc1
 s_waitcnt vmcnt(14) lgkmcnt(1)
 v_mfma_f32_16x16x32_bf16 v[96:99], a[132:135], v[56:59], v[96:99]
 v_mfma_f32_16x16x32_bf16 v[100:103], a[136:139], v[56:59], v[100:103]
 v_mfma_f32_16x16x32_bf16 v[104:107], a[140:143], v[56:59], v[104:107]
 v_mfma_f32_16x16x32_bf16 v[108:111], v[28:31], v[56:59], v[108:111]
 buffer_load_dwordx4 v[56:59], v1, s[20:23], s47 offen offset:2048 sc1
 v_mfma_f32_16x16x32_bf16 v[112:115], a[132:135], v[60:63], v[112:115]
 ds_read_b128 v[20:23], v5 offset:13312
 v_mfma_f32_16x16x32_bf16 v[116:119], a[136:139], v[60:63], v[116:119]
 v_mfma_f32_16x16x32_bf16 v[120:123], a[140:143], v[60:63], v[120:123]
 v_mfma_f32_16x16x32_bf16 v[124:127], v[28:31], v[60:63], v[124:127]
 buffer_load_dwordx4 v[60:63], v1, s[20:23], s47 offen offset:3072 sc1
 s_waitcnt vmcnt(14) lgkmcnt(1)
 v_mfma_f32_16x16x32_bf16 v[96:99], a[144:147], v[64:67], v[96:99]
 s_add_u32 s52, s44, 5
 s_and_b32 s52, s52, 7
 v_mfma_f32_16x16x32_bf16 v[100:103], a[148:151], v[64:67], v[100:103]
 s_lshl_b32 s52, s52, 13
 s_add_u32 s46, s48, s52
 v_mfma_f32_16x16x32_bf16 v[104:107], a[152:155], v[64:67], v[104:107]
 s_add_u32 s47, s46, 4096
 v_mfma_f32_16x16x32_bf16 v[108:111], v[16:19], v[64:67], v[108:111]
 buffer_load_dwordx4 v[64:67], v1, s[20:23], s46 offen offset:0 sc1
 v_mfma_f32_16x16x32_bf16 v[112:115], a[144:147], v[68:71], v[112:115]
 ds_read_b128 v[24:27], v5 offset:14336
 v_mfma_f32_16x16x32_bf16 v[116:119], a[148:151], v[68:71], v[116:119]
 v_mfma_f32_16x16x32_bf16 v[120:123], a[152:155], v[68:71], v[120:123]
 v_mfma_f32_16x16x32_bf16 v[124:127], v[16:19], v[68:71], v[124:127]
 buffer_load_dwordx4 v[68:71], v1, s[20:23], s46 offen offset:1024 sc1
 s_waitcnt vmcnt(14) lgkmcnt(1)
 v_mfma_f32_16x16x32_bf16 v[96:99], a[156:159], v[72:75], v[96:99]
 buffer_load_dword v2, v3, s[20:23], s53 offen sc1
 v_mfma_f32_16x16x32_bf16 v[100:103], a[160:163], v[72:75], v[100:103]
 v_mfma_f32_16x16x32_bf16 v[104:107], a[164:167], v[72:75], v[104:107]
 v_mfma_f32_16x16x32_bf16 v[108:111], v[20:23], v[72:75], v[108:111]
 buffer_load_dwordx4 v[72:75], v1, s[20:23], s46 offen offset:2048 sc1
 v_mfma_f32_16x16x32_bf16 v[112:115], a[156:159], v[76:79], v[112:115]
 ds_read_b128 v[28:31], v5 offset:15360
 v_mfma_f32_16x16x32_bf16 v[116:119], a[160:163], v[76:79], v[116:119]
 v_mfma_f32_16x16x32_bf16 v[120:123], a[164:167], v[76:79], v[120:123]
 v_mfma_f32_16x16x32_bf16 v[124:127], v[20:23], v[76:79], v[124:127]
 buffer_load_dwordx4 v[76:79], v1, s[20:23], s46 offen offset:3072 sc1
 s_waitcnt vmcnt(14) lgkmcnt(1)
 v_mfma_f32_16x16x32_bf16 v[96:99], a[168:171], v[80:83], v[96:99]
 v_mfma_f32_16x16x32_bf16 v[100:103], a[172:175], v[80:83], v[100:103]
 v_mfma_f32_16x16x32_bf16 v[104:107], a[176:179], v[80:83], v[104:107]
 v_mfma_f32_16x16x32_bf16 v[108:111], v[24:27], v[80:83], v[108:111]
 buffer_load_dwordx4 v[80:83], v1, s[20:23], s47 offen offset:0 sc1
 v_mfma_f32_16x16x32_bf16 v[112:115], a[168:171], v[84:87], v[112:115]
 ds_read_b128 v[16:19], v5 offset:16384
 v_mfma_f32_16x16x32_bf16 v[116:119], a[172:175], v[84:87], v[116:119]
 v_mfma_f32_16x16x32_bf16 v[120:123], a[176:179], v[84:87], v[120:123]
 v_mfma_f32_16x16x32_bf16 v[124:127], v[24:27], v[84:87], v[124:127]
 buffer_load_dwordx4 v[84:87], v1, s[20:23], s47 offen offset:1024 sc1
 s_waitcnt vmcnt(14) lgkmcnt(1)
 v_mfma_f32_16x16x32_bf16 v[96:99], a[180:183], v[88:91], v[96:99]
 v_mfma_f32_16x16x32_bf16 v[100:103], a[184:187], v[88:91], v[100:103]
 v_mfma_f32_16x16x32_bf16 v[104:107], a[188:191], v[88:91], v[104:107]
 v_mfma_f32_16x16x32_bf16 v[108:111], v[28:31], v[88:91], v[108:111]
 buffer_load_dwordx4 v[88:91], v1, s[20:23], s47 offen offset:2048 sc1
 v_mfma_f32_16x16x32_bf16 v[112:115], a[180:183], v[92:95], v[112:115]
 ds_read_b128 v[20:23], v5 offset:17408
 v_mfma_f32_16x16x32_bf16 v[116:119], a[184:187], v[92:95], v[116:119]
 v_mfma_f32_16x16x32_bf16 v[120:123], a[188:191], v[92:95], v[120:123]
 v_mfma_f32_16x16x32_bf16 v[124:127], v[28:31], v[92:95], v[124:127]
 buffer_load_dwordx4 v[92:95], v1, s[20:23], s47 offen offset:3072 sc1
 s_waitcnt vmcnt(14) lgkmcnt(1)
 v_mfma_f32_16x16x32_bf16 v[96:99], a[192:195], v[32:35], v[96:99]
 s_add_u32 s52, s44, 6
 s_and_b32 s52, s52, 7
 v_mfma_f32_16x16x32_bf16 v[100:103], a[196:199], v[32:35], v[100:103]
 s_lshl_b32 s52, s52, 13
 s_add_u32 s46, s48, s52
 v_mfma_f32_16x16x32_bf16 v[104:107], a[200:203], v[32:35], v[104:107]
 s_add_u32 s47, s46, 4096
 v_mfma_f32_16x16x32_bf16 v[108:111], v[16:19], v[32:35], v[108:111]
 buffer_load_dwordx4 v[32:35], v1, s[20:23], s46 offen offset:0 sc1
 v_mfma_f32_16x16x32_bf16 v[112:115], a[192:195], v[36:39], v[112:115]
 ds_read_b128 v[24:27], v5 offset:18432
 v_mfma_f32_16x16x32_bf16 v[116:119], a[196:199], v[36:39], v[116:119]
 v_mfma_f32_16x16x32_bf16 v[120:123], a[200:203], v[36:39], v[120:123]
 v_mfma_f32_16x16x32_bf16 v[124:127], v[16:19], v[36:39], v[124:127]
 buffer_load_dwordx4 v[36:39], v1, s[20:23], s46 offen offset:1024 sc1
 s_waitcnt vmcnt(14) lgkmcnt(1)
 v_mfma_f32_16x16x32_bf16 v[96:99], a[204:207], v[40:43], v[96:99]
 v_mfma_f32_16x16x32_bf16 v[100:103], a[208:211], v[40:43], v[100:103]
 v_mfma_f32_16x16x32_bf16 v[104:107], a[212:215], v[40:43], v[104:107]
 v_mfma_f32_16x16x32_bf16 v[108:111], v[20:23], v[40:43], v[108:111]
 buffer_load_dwordx4 v[40:43], v1, s[20:23], s46 offen offset:2048 sc1
 v_mfma_f32_16x16x32_bf16 v[112:115], a[204:207], v[44:47], v[112:115]
 ds_read_b128 v[28:31], v5 offset:19456
 v_mfma_f32_16x16x32_bf16 v[116:119], a[208:211], v[44:47], v[116:119]
 v_mfma_f32_16x16x32_bf16 v[120:123], a[212:215], v[44:47], v[120:123]
 v_mfma_f32_16x16x32_bf16 v[124:127], v[20:23], v[44:47], v[124:127]
 buffer_load_dwordx4 v[44:47], v1, s[20:23], s46 offen offset:3072 sc1
 s_waitcnt vmcnt(14) lgkmcnt(1)
 v_mfma_f32_16x16x32_bf16 v[96:99], a[216:219], v[48:51], v[96:99]
 v_mfma_f32_16x16x32_bf16 v[100:103], a[220:223], v[48:51], v[100:103]
 v_mfma_f32_16x16x32_bf16 v[104:107], a[224:227], v[48:51], v[104:107]
 v_mfma_f32_16x16x32_bf16 v[108:111], v[24:27], v[48:51], v[108:111]
 buffer_load_dwordx4 v[48:51], v1, s[20:23], s47 offen offset:0 sc1
 v_mfma_f32_16x16x32_bf16 v[112:115], a[216:219], v[52:55], v[112:115]
 ds_read_b128 v[16:19], v5 offset:20480
 v_mfma_f32_16x16x32_bf16 v[116:119], a[220:223], v[52:55], v[116:119]
 v_mfma_f32_16x16x32_bf16 v[120:123], a[224:227], v[52:55], v[120:123]
 v_mfma_f32_16x16x32_bf16 v[124:127], v[24:27], v[52:55], v[124:127]
 buffer_load_dwordx4 v[52:55], v1, s[20:23], s47 offen offset:1024 sc1
 s_waitcnt vmcnt(14) lgkmcnt(1)
 v_mfma_f32_16x16x32_bf16 v[96:99], a[228:231], v[56:59], v[96:99]
 v_mfma_f32_16x16x32_bf16 v[100:103], a[232:235], v[56:59], v[100:103]
 v_mfma_f32_16x16x32_bf16 v[104:107], a[236:239], v[56:59], v[104:107]
 v_mfma_f32_16x16x32_bf16 v[108:111], v[28:31], v[56:59], v[108:111]
 buffer_load_dwordx4 v[56:59], v1, s[20:23], s47 offen offset:2048 sc1
 v_mfma_f32_16x16x32_bf16 v[112:115], a[228:231], v[60:63], v[112:115]
 ds_read_b128 v[20:23], v5 offset:21504
 v_mfma_f32_16x16x32_bf16 v[116:119], a[232:235], v[60:63], v[116:119]
 v_mfma_f32_16x16x32_bf16 v[120:123], a[236:239], v[60:63], v[120:123]
 v_mfma_f32_16x16x32_bf16 v[124:127], v[28:31], v[60:63], v[124:127]
 buffer_load_dwordx4 v[60:63], v1, s[20:23], s47 offen offset:3072 sc1
 s_waitcnt vmcnt(14) lgkmcnt(1)
 v_mfma_f32_16x16x32_bf16 v[96:99], a[240:243], v[64:67], v[96:99]
 s_add_u32 s52, s44, 7
 s_and_b32 s52, s52, 7
 v_mfma_f32_16x16x32_bf16 v[100:103], a[244:247], v[64:67], v[100:103]
 s_lshl_b32 s52, s52, 13
 s_add_u32 s46, s48, s52
 v_mfma_f32_16x16x32_bf16 v[104:107], a[248:251], v[64:67], v[104:107]
 s_add_u32 s47, s46, 4096
 v_mfma_f32_16x16x32_bf16 v[108:111], v[16:19], v[64:67], v[108:111]
 buffer_load_dwordx4 v[64:67], v1, s[20:23], s46 offen offset:0 sc1
 v_mfma_f32_16x16x32_bf16 v[112:115], a[240:243], v[68:71], v[112:115]
 ds_read_b128 v[24:27], v5 offset:22528
 v_mfma_f32_16x16x32_bf16 v[116:119], a[244:247], v[68:71], v[116:119]
 v_mfma_f32_16x16x32_bf16 v[120:123], a[248:251], v[68:71], v[120:123]
 v_mfma_f32_16x16x32_bf16 v[124:127], v[16:19], v[68:71], v[124:127]
 buffer_load_dwordx4 v[68:71], v1, s[20:23], s46 offen offset:1024 sc1
 s_waitcnt vmcnt(14) lgkmcnt(1)
 v_mfma_f32_16x16x32_bf16 v[96:99], a[252:255], v[72:75], v[96:99]
 v_mfma_f32_16x16x32_bf16 v[100:103], v[128:131], v[72:75], v[100:103]
 v_mfma_f32_16x16x32_bf16 v[104:107], v[132:135], v[72:75], v[104:107]
 v_mfma_f32_16x16x32_bf16 v[108:111], v[20:23], v[72:75], v[108:111]
 buffer_load_dwordx4 v[72:75], v1, s[20:23], s46 offen offset:2048 sc1
 v_mfma_f32_16x16x32_bf16 v[112:115], a[252:255], v[76:79], v[112:115]
 ds_read_b128 v[28:31], v5 offset:23552
 v_mfma_f32_16x16x32_bf16 v[116:119], v[128:131], v[76:79], v[116:119]
 v_mfma_f32_16x16x32_bf16 v[120:123], v[132:135], v[76:79], v[120:123]
 v_mfma_f32_16x16x32_bf16 v[124:127], v[20:23], v[76:79], v[124:127]
 buffer_load_dwordx4 v[76:79], v1, s[20:23], s46 offen offset:3072 sc1
 s_waitcnt vmcnt(14) lgkmcnt(1)
 v_mfma_f32_16x16x32_bf16 v[96:99], v[136:139], v[80:83], v[96:99]
 v_cmp_gt_u32 vcc, s51, v2
 v_mfma_f32_16x16x32_bf16 v[100:103], v[140:143], v[80:83], v[100:103]
 v_mfma_f32_16x16x32_bf16 v[104:107], v[144:147], v[80:83], v[104:107]
 v_mfma_f32_16x16x32_bf16 v[108:111], v[24:27], v[80:83], v[108:111]
 buffer_load_dwordx4 v[80:83], v1, s[20:23], s47 offen offset:0 sc1
 v_mfma_f32_16x16x32_bf16 v[112:115], v[136:139], v[84:87], v[112:115]
 ds_read_b128 v[16:19], v5 offset:24576
 v_mfma_f32_16x16x32_bf16 v[116:119], v[140:143], v[84:87], v[116:119]
 v_mfma_f32_16x16x32_bf16 v[120:123], v[144:147], v[84:87], v[120:123]
 v_mfma_f32_16x16x32_bf16 v[124:127], v[24:27], v[84:87], v[124:127]
 buffer_load_dwordx4 v[84:87], v1, s[20:23], s47 offen offset:1024 sc1
 s_waitcnt vmcnt(14) lgkmcnt(1)
 v_mfma_f32_16x16x32_bf16 v[96:99], v[148:151], v[88:91], v[96:99]
 s_and_b32 s52, vcc_lo, 0xffff
 s_cbranch_scc1 Losw_36
Loswk_37:
 v_mfma_f32_16x16x32_bf16 v[100:103], v[152:155], v[88:91], v[100:103]
 s_lshl_b32 s48, s42, 18
 s_add_u32 s48, s48, s36
 v_mfma_f32_16x16x32_bf16 v[104:107], v[156:159], v[88:91], v[104:107]
 v_mfma_f32_16x16x32_bf16 v[108:111], v[28:31], v[88:91], v[108:111]
 buffer_load_dwordx4 v[88:91], v1, s[20:23], s47 offen offset:2048 sc1
 v_mfma_f32_16x16x32_bf16 v[112:115], v[148:151], v[92:95], v[112:115]
 ds_read_b128 v[20:23], v5 offset:25600
 v_mfma_f32_16x16x32_bf16 v[116:119], v[152:155], v[92:95], v[116:119]
 v_mfma_f32_16x16x32_bf16 v[120:123], v[156:159], v[92:95], v[120:123]
 v_mfma_f32_16x16x32_bf16 v[124:127], v[28:31], v[92:95], v[124:127]
 buffer_load_dwordx4 v[92:95], v1, s[20:23], s47 offen offset:3072 sc1
 s_waitcnt vmcnt(14) lgkmcnt(1)
 v_mfma_f32_16x16x32_bf16 v[96:99], v[160:163], v[32:35], v[96:99]
 s_add_u32 s52, s44, 0
 s_and_b32 s52, s52, 7
 v_mfma_f32_16x16x32_bf16 v[100:103], v[164:167], v[32:35], v[100:103]
 s_lshl_b32 s52, s52, 13
 s_add_u32 s46, s48, s52
 v_mfma_f32_16x16x32_bf16 v[104:107], v[168:171], v[32:35], v[104:107]
 s_add_u32 s47, s46, 4096
 v_mfma_f32_16x16x32_bf16 v[108:111], v[16:19], v[32:35], v[108:111]
 buffer_load_dwordx4 v[32:35], v1, s[20:23], s46 offen offset:0 sc1
 v_mfma_f32_16x16x32_bf16 v[112:115], v[160:163], v[36:39], v[112:115]
 ds_read_b128 v[24:27], v5 offset:26624
 v_mfma_f32_16x16x32_bf16 v[116:119], v[164:167], v[36:39], v[116:119]
 v_mfma_f32_16x16x32_bf16 v[120:123], v[168:171], v[36:39], v[120:123]
 v_mfma_f32_16x16x32_bf16 v[124:127], v[16:19], v[36:39], v[124:127]
 buffer_load_dwordx4 v[36:39], v1, s[20:23], s46 offen offset:1024 sc1
 s_waitcnt vmcnt(14) lgkmcnt(1)
 v_mfma_f32_16x16x32_bf16 v[96:99], v[172:175], v[40:43], v[96:99]
 v_mfma_f32_16x16x32_bf16 v[100:103], v[176:179], v[40:43], v[100:103]
 v_mfma_f32_16x16x32_bf16 v[104:107], v[180:183], v[40:43], v[104:107]
 v_mfma_f32_16x16x32_bf16 v[108:111], v[20:23], v[40:43], v[108:111]
 buffer_load_dwordx4 v[40:43], v1, s[20:23], s46 offen offset:2048 sc1
 v_mfma_f32_16x16x32_bf16 v[112:115], v[172:175], v[44:47], v[112:115]
 ds_read_b128 v[28:31], v5 offset:27648
 v_mfma_f32_16x16x32_bf16 v[116:119], v[176:179], v[44:47], v[116:119]
 v_mfma_f32_16x16x32_bf16 v[120:123], v[180:183], v[44:47], v[120:123]
 v_mfma_f32_16x16x32_bf16 v[124:127], v[20:23], v[44:47], v[124:127]
 buffer_load_dwordx4 v[44:47], v1, s[20:23], s46 offen offset:3072 sc1
 s_waitcnt vmcnt(14) lgkmcnt(1)
 v_mfma_f32_16x16x32_bf16 v[96:99], v[184:187], v[48:51], v[96:99]
 v_mfma_f32_16x16x32_bf16 v[100:103], v[188:191], v[48:51], v[100:103]
 v_mfma_f32_16x16x32_bf16 v[104:107], v[192:195], v[48:51], v[104:107]
 v_mfma_f32_16x16x32_bf16 v[108:111], v[24:27], v[48:51], v[108:111]
 buffer_load_dwordx4 v[48:51], v1, s[20:23], s47 offen offset:0 sc1
 v_mfma_f32_16x16x32_bf16 v[112:115], v[184:187], v[52:55], v[112:115]
 ds_read_b128 v[16:19], v5 offset:28672
 v_mfma_f32_16x16x32_bf16 v[116:119], v[188:191], v[52:55], v[116:119]
 v_mfma_f32_16x16x32_bf16 v[120:123], v[192:195], v[52:55], v[120:123]
 v_mfma_f32_16x16x32_bf16 v[124:127], v[24:27], v[52:55], v[124:127]
 buffer_load_dwordx4 v[52:55], v1, s[20:23], s47 offen offset:1024 sc1
 s_waitcnt vmcnt(14) lgkmcnt(1)
 v_mfma_f32_16x16x32_bf16 v[96:99], v[196:199], v[56:59], v[96:99]
 v_mfma_f32_16x16x32_bf16 v[100:103], v[200:203], v[56:59], v[100:103]
 v_mfma_f32_16x16x32_bf16 v[104:107], v[204:207], v[56:59], v[104:107]
 v_mfma_f32_16x16x32_bf16 v[108:111], v[28:31], v[56:59], v[108:111]
 buffer_load_dwordx4 v[56:59], v1, s[20:23], s47 offen offset:2048 sc1
 v_mfma_f32_16x16x32_bf16 v[112:115], v[196:199], v[60:63], v[112:115]
 ds_read_b128 v[20:23], v5 offset:29696
 v_mfma_f32_16x16x32_bf16 v[116:119], v[200:203], v[60:63], v[116:119]
 v_mfma_f32_16x16x32_bf16 v[120:123], v[204:207], v[60:63], v[120:123]
 v_mfma_f32_16x16x32_bf16 v[124:127], v[28:31], v[60:63], v[124:127]
 buffer_load_dwordx4 v[60:63], v1, s[20:23], s47 offen offset:3072 sc1
 s_waitcnt vmcnt(14) lgkmcnt(1)
 v_mfma_f32_16x16x32_bf16 v[96:99], v[208:211], v[64:67], v[96:99]
 s_add_u32 s52, s44, 1
 s_and_b32 s52, s52, 7
 v_mfma_f32_16x16x32_bf16 v[100:103], v[212:215], v[64:67], v[100:103]
 s_lshl_b32 s52, s52, 13
 s_add_u32 s46, s48, s52
 v_mfma_f32_16x16x32_bf16 v[104:107], v[216:219], v[64:67], v[104:107]
 s_add_u32 s47, s46, 4096
 v_mfma_f32_16x16x32_bf16 v[108:111], v[16:19], v[64:67], v[108:111]
 buffer_load_dwordx4 v[64:67], v1, s[20:23], s46 offen offset:0 sc1
 v_mfma_f32_16x16x32_bf16 v[112:115], v[208:211], v[68:71], v[112:115]
 ds_read_b128 v[24:27], v5 offset:30720
 v_mfma_f32_16x16x32_bf16 v[116:119], v[212:215], v[68:71], v[116:119]
 v_mfma_f32_16x16x32_bf16 v[120:123], v[216:219], v[68:71], v[120:123]
 v_mfma_f32_16x16x32_bf16 v[124:127], v[16:19], v[68:71], v[124:127]
 buffer_load_dwordx4 v[68:71], v1, s[20:23], s46 offen offset:1024 sc1
 s_waitcnt vmcnt(14) lgkmcnt(1)
 v_mfma_f32_16x16x32_bf16 v[96:99], v[220:223], v[72:75], v[96:99]
 v_mfma_f32_16x16x32_bf16 v[100:103], v[224:227], v[72:75], v[100:103]
 v_mfma_f32_16x16x32_bf16 v[104:107], v[228:231], v[72:75], v[104:107]
 v_mfma_f32_16x16x32_bf16 v[108:111], v[20:23], v[72:75], v[108:111]
 buffer_load_dwordx4 v[72:75], v1, s[20:23], s46 offen offset:2048 sc1
 v_mfma_f32_16x16x32_bf16 v[112:115], v[220:223], v[76:79], v[112:115]
 ds_read_b128 v[28:31], v5 offset:31744
 v_mfma_f32_16x16x32_bf16 v[116:119], v[224:227], v[76:79], v[116:119]
 v_mfma_f32_16x16x32_bf16 v[120:123], v[228:231], v[76:79], v[120:123]
 v_mfma_f32_16x16x32_bf16 v[124:127], v[20:23], v[76:79], v[124:127]
 buffer_load_dwordx4 v[76:79], v1, s[20:23], s46 offen offset:3072 sc1
 s_waitcnt vmcnt(14) lgkmcnt(1)
 v_mfma_f32_16x16x32_bf16 v[96:99], v[232:235], v[80:83], v[96:99]
 v_mfma_f32_16x16x32_bf16 v[100:103], v[236:239], v[80:83], v[100:103]
 v_mfma_f32_16x16x32_bf16 v[104:107], v[240:243], v[80:83], v[104:107]
 v_mfma_f32_16x16x32_bf16 v[108:111], v[24:27], v[80:83], v[108:111]
 buffer_load_dwordx4 v[80:83], v1, s[20:23], s47 offen offset:0 sc1
 v_mfma_f32_16x16x32_bf16 v[112:115], v[232:235], v[84:87], v[112:115]
 ds_read_b128 v[16:19], v5 offset:0
 v_mfma_f32_16x16x32_bf16 v[116:119], v[236:239], v[84:87], v[116:119]
 v_mfma_f32_16x16x32_bf16 v[120:123], v[240:243], v[84:87], v[120:123]
 v_mfma_f32_16x16x32_bf16 v[124:127], v[24:27], v[84:87], v[124:127]
 buffer_load_dwordx4 v[84:87], v1, s[20:23], s47 offen offset:1024 sc1
 s_waitcnt vmcnt(14) lgkmcnt(1)
 v_mfma_f32_16x16x32_bf16 v[96:99], v[244:247], v[88:91], v[96:99]
 v_mfma_f32_16x16x32_bf16 v[100:103], v[248:251], v[88:91], v[100:103]
 v_mfma_f32_16x16x32_bf16 v[104:107], v[252:255], v[88:91], v[104:107]
 v_mfma_f32_16x16x32_bf16 v[108:111], v[28:31], v[88:91], v[108:111]
 buffer_load_dwordx4 v[88:91], v1, s[20:23], s47 offen offset:2048 sc1
 v_mfma_f32_16x16x32_bf16 v[112:115], v[244:247], v[92:95], v[112:115]
 ds_read_b128 v[20:23], v5 offset:1024
 v_mfma_f32_16x16x32_bf16 v[116:119], v[248:251], v[92:95], v[116:119]
 v_mfma_f32_16x16x32_bf16 v[120:123], v[252:255], v[92:95], v[120:123]
 v_mfma_f32_16x16x32_bf16 v[124:127], v[28:31], v[92:95], v[124:127]
 buffer_load_dwordx4 v[92:95], v1, s[20:23], s47 offen offset:3072 sc1
 s_cmp_lt_u32 s43, s35
 ds_write_b128 v14, v[96:99] offset:32768
 ds_write_b128 v15, v[100:103] offset:33792
 ds_write_b128 v14, v[104:107] offset:34816
 ds_write_b128 v15, v[108:111] offset:35840
 ds_write_b128 v14, v[112:115] offset:36864
 ds_write_b128 v15, v[116:119] offset:37888
 ds_write_b128 v14, v[120:123] offset:38912
 ds_write_b128 v15, v[124:127] offset:39936
 s_waitcnt lgkmcnt(0)
 s_barrier
 ds_read_b128 v[96:99], v4 offset:0
 ds_read_b128 v[100:103], v4 offset:256
 ds_read_b128 v[104:107], v4 offset:40960
 ds_read_b128 v[108:111], v4 offset:41216
 ds_read_b128 v[112:115], v7 offset:0
 ds_read_b128 v[116:119], v7 offset:256
 ds_read_b128 v[120:123], v7 offset:40960
 ds_read_b128 v[124:127], v7 offset:41216
 s_waitcnt lgkmcnt(4)
 v_pk_add_f32 v[96:97], v[96:97], v[104:105]
 v_pk_add_f32 v[98:99], v[98:99], v[106:107]
 v_pk_add_f32 v[100:101], v[100:101], v[108:109]
 v_pk_add_f32 v[102:103], v[102:103], v[110:111]
 s_waitcnt lgkmcnt(2)
 v_pk_add_f32 v[96:97], v[96:97], v[112:113]
 v_pk_add_f32 v[98:99], v[98:99], v[114:115]
 v_pk_add_f32 v[100:101], v[100:101], v[116:117]
 v_pk_add_f32 v[102:103], v[102:103], v[118:119]
 s_waitcnt lgkmcnt(0)
 v_pk_add_f32 v[96:97], v[96:97], v[120:121]
 v_pk_add_f32 v[98:99], v[98:99], v[122:123]
 v_pk_add_f32 v[100:101], v[100:101], v[124:125]
 v_pk_add_f32 v[102:103], v[102:103], v[126:127]
 v_cvt_pk_bf16_f32 v8, v96, v97
 v_cvt_pk_bf16_f32 v9, v98, v99
 v_cvt_pk_bf16_f32 v10, v100, v101
 v_cvt_pk_bf16_f32 v11, v102, v103
 buffer_store_dwordx4 v[8:11], v6, s[24:27], s54 offen
 s_cbranch_scc1 Losl_35
 s_branch Lose_38
Losw_36:
 buffer_load_dword v2, v3, s[20:23], s53 offen sc1
 s_waitcnt vmcnt(0)
 v_cmp_gt_u32 vcc, s51, v2
 s_and_b32 s52, vcc_lo, 0xffff
 s_cbranch_scc0 Loswk_37
 s_sleep 4
 s_sub_u32 s50, s50, 1
 s_cbranch_scc0 Losw_36
 s_endpgm
Lose_38:
 s_waitcnt vmcnt(0)
 s_branch Lfin
Lchain:
 s_load_dwordx2 s[8:9], s[0:1], 64
 s_mov_b32 s10, 0x480000
 s_mov_b32 s11, 0x20000
 s_load_dwordx2 s[12:13], s[0:1], 72
 s_mov_b32 s14, 0x480000
 s_mov_b32 s15, 0x20000
 s_load_dwordx2 s[16:17], s[0:1], 80
 s_mov_b32 s18, 0x480000
 s_mov_b32 s19, 0x20000
 s_load_dwordx2 s[24:25], s[0:1], 88
 s_mov_b32 s26, 0x480000
 s_mov_b32 s27, 0x20000
 s_load_dwordx2 s[28:29], s[0:1], 112
 s_mov_b32 s30, 0x100
 s_mov_b32 s31, 0x20000
 s_load_dwordx2 s[32:33], s[0:1], 56
 s_mov_b32 s34, 0x2400
 s_mov_b32 s35, 0x20000
 v_and_b32 v20, 63, v0
 v_lshlrev_b32 v3, 4, v20
 v_mov_b32 v7, 0
 s_mov_b32 s48, 0xcccccccc
 s_mov_b32 s49, 0xcccccccc
 v_mov_b32 v21, 0x44444444
 v_mov_b32 v22, 0xeeeeeeee
 v_cndmask_b32 v5, v21, v22, s[48:49]
 s_lshl_b32 s47, s4, 10
 s_add_u32 s47, s47, 19456
 v_and_b32 v21, 48, v20
 v_lshl_add_u32 v21, v21, 3, s47
 v_and_b32 v22, 8, v20
 v_lshl_add_u32 v21, v22, 2, v21
 v_and_b32 v22, 1, v20
 v_lshl_add_u32 v21, v22, 4, v21
 v_and_b32 v22, 6, v20
 v_lshl_add_u32 v8, v22, 1, v21
 v_and_b32 v21, 32, v20
 v_lshlrev_b32 v21, 5, v21
 v_and_b32 v22, 12, v20
 v_lshl_add_u32 v21, v22, 5, v21
 v_and_b32 v22, 1, v20
 v_lshl_add_u32 v21, v22, 6, v21
 v_and_b32 v22, 16, v20
 v_lshl_add_u32 v21, v22, 1, v21
 v_and_b32 v22, 2, v20
 v_lshl_add_u32 v9, v22, 3, v21
 v_lshrrev_b32 v21, 4, v0
 v_lshlrev_b32 v21, 7, v21
 v_and_b32 v22, 15, v20
 v_lshl_add_u32 v21, v22, 2, v21
 v_add_u32 v10, 17408, v21
 v_and_b32 v22, 1, v20
 v_and_b32 v21, 12, v20
 v_lshlrev_b32 v21, 5, v21
 v_lshl_add_u32 v21, v22, 6, v21
 v_and_b32 v22, 48, v20
 v_add_u32 v11, v21, v22
 s_mov_b32 s55, 0x3e0293ee
 s_mov_b32 s54, 0x40000
 s_lshl_b32 s47, s6, 6
 s_add_u32 s60, s47, 0x100000
 s_add_u32 s61, s47, 0x101000
 s_add_u32 s62, s47, 0x102000
 s_lshl_b32 s47, s6, 7
 s_add_u32 s56, s47, 0x0
 s_add_u32 s57, s47, 0x1000
 s_mul_i32 s47, s6, 10496
 s_add_u32 s40, s47, 0x102000
 s_lshl_b32 s58, s4, 11
 s_add_u32 s47, s47, s58
 s_add_u32 s39, s47, 0x100000
 s_lshl_b32 s42, s4, 11
 s_add_u32 s41, s42, 0x1e0000
 s_mov_b32 s43, 0x1e2000
 s_lshr_b32 s69, s4, 1
 s_lshl_b32 s69, s69, 11
 s_and_b32 s47, s4, 1
 s_lshl_b32 s47, s47, 3
 s_add_u32 s69, s69, s47
 s_lshl_b32 s47, s6, 5
 s_add_u32 s65, s47, 0x1e2000
 s_add_u32 s66, s47, 0x162000
 s_lshr_b32 s47, s6, 3
 s_lshl_b32 s47, s47, 9
 s_and_b32 s58, s6, 1
 s_lshl_b32 s58, s58, 8
 s_add_u32 s47, s47, s58
 s_and_b32 s58, s6, 6
 s_lshl_b32 s58, s58, 5
 s_add_u32 s47, s47, s58
 s_lshl_b32 s58, s4, 11
 s_add_u32 s47, s47, s58
 s_add_u32 s44, s47, 0x1e0000
 s_add_u32 s45, s47, 0x160000
 s_lshl_b32 s47, s6, 14
 s_add_u32 s37, s47, 0x3000000
 s_add_u32 s67, s37, s58
 s_add_u32 s59, s67, 8192
 s_lshl_b32 s47, s6, 12
 s_add_u32 s38, s47, 0x3e0000
 s_mov_b32 s36, 0
 s_mov_b32 s46, 0
 s_waitcnt lgkmcnt(0)
 v_mov_b32 v20, 0
 v_mov_b32 v21, 0
 v_mov_b32 v22, 0
 v_mov_b32 v23, 0
 v_mov_b32 v27, -1
 v_bfe_u32 v24, v3, 8, 1
 v_bfe_u32 v25, v3, 9, 1
 v_lshl_or_b32 v24, v24, 1, v25
 v_bfe_u32 v25, v3, 5, 1
 v_lshl_or_b32 v24, v24, 1, v25
 v_and_b32 v25, 0xd0, v3
 v_lshlrev_b32 v25, 24, v25
 v_lshl_or_b32 v24, v24, 2, v25
 v_bfe_u32 v26, v3, 8, 2
 v_bfe_u32 v25, v3, 2, 4
 v_lshl_or_b32 v26, v26, 4, v25
 v_and_b32 v25, 0xc0, v3
 v_lshl_or_b32 v26, v25, 24, v26
 buffer_store_dwordx4 v[20:23], v3, s[20:23], s39 offen offset:0 sc1
 buffer_store_dwordx4 v[20:23], v3, s[20:23], s39 offen offset:1024 sc1
 buffer_store_dwordx4 v[20:23], v3, s[20:23], s40 offen offset:0 sc1
 buffer_store_dwordx4 v[20:23], v3, s[20:23], s40 offen offset:1024 sc1
 buffer_store_dword v27, v26, s[20:23], s44 offen sc1
 buffer_store_dword v27, v26, s[20:23], s45 offen sc1
 buffer_store_dword v27, v24, s[20:23], s65 offen sc1
 buffer_store_dword v27, v24, s[20:23], s66 offen sc1
 v_and_b32 v30, 63, v0
 v_bfe_u32 v31, v30, 1, 2
 v_lshrrev_b32 v32, 5, v30
 v_xor_b32 v31, v31, v32
 v_lshlrev_b32 v31, 5, v31
 v_and_b32 v32, 1, v30
 v_lshl_add_u32 v31, v32, 4, v31
 v_xor_b32 v33, 64, v31
 v_lshrrev_b32 v32, 3, v30
 s_lshl_b32 s47, s4, 4
 v_and_b32 v34, 3, v32
 v_lshrrev_b32 v35, 2, v32
 v_lshl_add_u32 v34, v34, 1, v35
 v_add_u32 v34, s47, v34
 v_lshl_add_u32 v12, v34, 13, v31
 v_add_u32 v34, 8, v34
 v_lshl_add_u32 v13, v34, 13, v33
 v_and_b32 v34, 1, v32
 v_lshlrev_b32 v34, 6, v34
 v_and_b32 v35, 6, v32
 s_lshl_b32 s47, s4, 3
 v_add3_u32 v34, v34, v35, s47
 v_lshl_add_u32 v56, v34, 13, v31
 v_mul_u32_u24 v35, 1152, v34
 v_add_u32 v14, v35, v31
 v_add_u32 v34, 1, v34
 v_lshl_add_u32 v57, v34, 13, v33
 v_mul_u32_u24 v35, 1152, v34
 v_add_u32 v15, v35, v33
 v_bfe_u32 v31, v30, 4, 1
 v_bfe_u32 v32, v30, 3, 1
 v_lshl_add_u32 v33, v32, 1, v31
 v_xor_b32 v33, s4, v33
 v_lshlrev_b32 v33, 5, v33
 v_lshl_add_u32 v33, v31, 9, v33
 v_lshl_add_u32 v33, v32, 10, v33
 v_bfe_u32 v31, v30, 2, 1
 v_lshl_add_u32 v33, v31, 7, v33
 v_lshrrev_b32 v31, 5, v30
 v_lshl_add_u32 v33, v31, 11, v33
 v_and_b32 v31, 3, v30
 v_lshl_add_u32 v16, v31, 3, v33
 v_add_u32 v17, 0x10000, v16
 v_add_u32 v18, 0x20000, v16
 v_lshlrev_b32 v60, 4, v0
 v_add_u32 v61, 0x10000, v60
 v_add_u32 v62, 0x20000, v60
 s_lshl_b32 s70, s6, 8
 s_mul_i32 s71, s6, 147456
 s_lshl_b32 s72, s4, 11
 s_lshl_b32 s47, s4, 4
 v_add_u32 v31, s47, v30
 s_lshr_b32 s47, s4, 1
 s_lshl_b32 s47, s47, 5
 v_add_u32 v32, s47, v31
 v_lshrrev_b32 v33, 4, v30
 v_lshlrev_b32 v33, 28, v33
 v_lshl_or_b32 v58, v31, 13, v33
 v_lshl_or_b32 v19, v32, 13, v33
 v_mul_u32_u24 v32, 1152, v32
 v_or_b32 v59, v32, v33
 s_add_u32 m0, s72, 24576
 s_add_u32 s47, s70, 0
 buffer_load_dwordx4 v56, s[8:11], s47 offen  lds
 s_add_u32 m0, s72, 25600
 s_nop 0
 buffer_load_dwordx4 v57, s[8:11], s47 offen  lds
 s_add_u32 m0, s72, 32768
 s_add_u32 s47, s70, 128
 buffer_load_dwordx4 v56, s[8:11], s47 offen  lds
 s_add_u32 m0, s72, 33792
 s_nop 0
 buffer_load_dwordx4 v57, s[8:11], s47 offen  lds
 s_add_u32 m0, s72, 40960
 s_add_u32 s47, s70, 0
 buffer_load_dwordx4 v56, s[12:15], s47 offen  lds
 s_add_u32 m0, s72, 41984
 s_nop 0
 buffer_load_dwordx4 v57, s[12:15], s47 offen  lds
 s_add_u32 m0, s72, 49152
 s_add_u32 s47, s70, 0
 buffer_load_dwordx4 v56, s[16:19], s47 offen  lds
 s_add_u32 m0, s72, 50176
 s_nop 0
 buffer_load_dwordx4 v57, s[16:19], s47 offen  lds
 s_add_u32 m0, s72, 57344
 s_add_u32 s47, s70, 128
 buffer_load_dwordx4 v56, s[16:19], s47 offen  lds
 s_add_u32 m0, s72, 58368
 s_nop 0
 buffer_load_dwordx4 v57, s[16:19], s47 offen  lds
 s_add_u32 m0, s72, 65536
 s_add_u32 s47, s70, 262144
 buffer_load_dwordx4 v56, s[8:11], s47 offen  lds
 s_add_u32 m0, s72, 66560
 s_nop 0
 buffer_load_dwordx4 v57, s[8:11], s47 offen  lds
 s_add_u32 m0, s72, 73728
 s_add_u32 s47, s70, 262272
 buffer_load_dwordx4 v56, s[8:11], s47 offen  lds
 s_add_u32 m0, s72, 74752
 s_nop 0
 buffer_load_dwordx4 v57, s[8:11], s47 offen  lds
 s_add_u32 m0, s72, 81920
 s_add_u32 s47, s70, 262144
 buffer_load_dwordx4 v56, s[12:15], s47 offen  lds
 s_add_u32 m0, s72, 82944
 s_nop 0
 buffer_load_dwordx4 v57, s[12:15], s47 offen  lds
 s_waitcnt vmcnt(14)
 s_waitcnt lgkmcnt(0)
 s_barrier
 s_getreg_b32 s73, hwreg(HW_REG_XCC_ID, 0, 3)
 s_lshl_b32 s73, s73, 3
 s_lshl_b64 s[74:75], 1, s73
 v_mov_b32 v64, s74
 v_mov_b32 v65, s75
 v_mov_b32 v66, 0x7ff00000
 v_cmp_eq_u32 vcc, 0, v0
 s_nop 1
 v_cndmask_b32 v66, v66, v7, vcc
 buffer_atomic_add_x2 v[64:65], v66, s[28:31], 0 offen offset:8
 s_add_u32 m0, s72, 90112
 s_add_u32 s47, s70, 262144
 buffer_load_dwordx4 v56, s[16:19], s47 offen  lds
 s_add_u32 m0, s72, 91136
 s_nop 0
 buffer_load_dwordx4 v57, s[16:19], s47 offen  lds
 ds_read_b64_tr_b16 v[72:73], v16 offset:24576
 ds_read_b64_tr_b16 v[74:75], v16 offset:24832
 ds_read_b64_tr_b16 v[76:77], v16 offset:28672
 ds_read_b64_tr_b16 v[78:79], v16 offset:28928
 s_waitcnt vmcnt(15)
 s_waitcnt lgkmcnt(0)
 s_barrier
 s_add_u32 m0, s72, 98304
 s_add_u32 s47, s70, 262272
 buffer_load_dwordx4 v56, s[16:19], s47 offen  lds
 s_add_u32 m0, s72, 99328
 s_nop 0
 buffer_load_dwordx4 v57, s[16:19], s47 offen  lds
 ds_read_b64_tr_b16 v[80:81], v16 offset:32768
 ds_read_b64_tr_b16 v[82:83], v16 offset:33024
 ds_read_b64_tr_b16 v[84:85], v16 offset:36864
 ds_read_b64_tr_b16 v[86:87], v16 offset:37120
 s_waitcnt vmcnt(15)
 s_waitcnt lgkmcnt(0)
 s_barrier
 s_add_u32 m0, s72, 106496
 s_add_u32 s47, s70, 1048576
 buffer_load_dwordx4 v56, s[8:11], s47 offen  lds
 s_add_u32 m0, s72, 107520
 s_nop 0
 buffer_load_dwordx4 v57, s[8:11], s47 offen  lds
 ds_read_b64_tr_b16 v[88:89], v16 offset:40960
 ds_read_b64_tr_b16 v[90:91], v16 offset:41216
 ds_read_b64_tr_b16 v[92:93], v16 offset:45056
 ds_read_b64_tr_b16 v[94:95], v16 offset:45312
 s_waitcnt vmcnt(15)
 s_waitcnt lgkmcnt(0)
 s_barrier
 s_add_u32 m0, s72, 114688
 s_add_u32 s47, s70, 1048704
 buffer_load_dwordx4 v56, s[8:11], s47 offen  lds
 s_add_u32 m0, s72, 115712
 s_nop 0
 buffer_load_dwordx4 v57, s[8:11], s47 offen  lds
 ds_read_b64_tr_b16 v[96:97], v16 offset:49152
 ds_read_b64_tr_b16 v[98:99], v16 offset:49408
 ds_read_b64_tr_b16 v[100:101], v16 offset:53248
 ds_read_b64_tr_b16 v[102:103], v16 offset:53504
 s_waitcnt vmcnt(15)
 s_waitcnt lgkmcnt(0)
 s_barrier
 s_add_u32 m0, s72, 122880
 s_add_u32 s47, s70, 1048576
 buffer_load_dwordx4 v56, s[12:15], s47 offen  lds
 s_add_u32 m0, s72, 123904
 s_nop 0
 buffer_load_dwordx4 v57, s[12:15], s47 offen  lds
 v_lshrrev_b32 v68, 4, v3
 v_bfe_u32 v69, v68, 2, 2
 v_and_b32 v70, 1, v68
 v_lshl_add_u32 v69, v69, 1, v70
 v_mul_u32_u24 v69, 1152, v69
 v_and_b32 v70, 48, v68
 v_and_b32 v71, 2, v68
 v_lshl_add_u32 v71, v71, 2, v70
 v_lshl_add_u32 v71, v71, 1, v69
 v_add_u32 v69, v70, v69
 s_lshr_b32 s47, s4, 1
 s_lshl_b32 s47, s47, 8
 s_and_b32 s58, s4, 1
 s_lshl_b32 s58, s58, 6
 s_add_u32 s47, s47, s58
 buffer_load_dwordx4 v[20:23], v69, s[32:35], s47 offen offset:0
 buffer_load_dwordx4 v[24:27], v69, s[32:35], s47 offen offset:128
 buffer_load_dwordx4 v[28:31], v69, s[32:35], s47 offen offset:512
 buffer_load_dwordx4 v[32:35], v69, s[32:35], s47 offen offset:640
 buffer_load_dwordx4 v[36:39], v71, s[32:35], 0 offen offset:1024
 ds_read_b64_tr_b16 v[104:105], v16 offset:57344
 ds_read_b64_tr_b16 v[106:107], v16 offset:57600
 ds_read_b64_tr_b16 v[108:109], v16 offset:61440
 ds_read_b64_tr_b16 v[110:111], v16 offset:61696
 s_waitcnt vmcnt(20)
 s_waitcnt lgkmcnt(0)
 s_barrier
 s_add_u32 m0, s72, 131072
 s_add_u32 s47, s70, 1048576
 buffer_load_dwordx4 v56, s[16:19], s47 offen  lds
 s_add_u32 m0, s72, 132096
 s_nop 0
 buffer_load_dwordx4 v57, s[16:19], s47 offen  lds
 ds_read_b64_tr_b16 v[112:113], v17 offset:0
 ds_read_b64_tr_b16 v[114:115], v17 offset:256
 ds_read_b64_tr_b16 v[116:117], v17 offset:4096
 ds_read_b64_tr_b16 v[118:119], v17 offset:4352
 s_waitcnt vmcnt(20)
 s_waitcnt lgkmcnt(0)
 s_barrier
 s_add_u32 m0, s72, 139264
 s_add_u32 s47, s70, 1048704
 buffer_load_dwordx4 v56, s[16:19], s47 offen  lds
 s_add_u32 m0, s72, 140288
 s_nop 0
 buffer_load_dwordx4 v57, s[16:19], s47 offen  lds
 ds_read_b64_tr_b16 v[120:121], v17 offset:8192
 ds_read_b64_tr_b16 v[122:123], v17 offset:8448
 ds_read_b64_tr_b16 v[124:125], v17 offset:12288
 ds_read_b64_tr_b16 v[126:127], v17 offset:12544
 s_waitcnt vmcnt(20)
 s_waitcnt lgkmcnt(0)
 s_barrier
 s_add_u32 m0, s72, 147456
 s_add_u32 s47, s70, 1310720
 buffer_load_dwordx4 v56, s[8:11], s47 offen  lds
 s_add_u32 m0, s72, 148480
 s_nop 0
 buffer_load_dwordx4 v57, s[8:11], s47 offen  lds
 ds_read_b64_tr_b16 v[128:129], v17 offset:16384
 ds_read_b64_tr_b16 v[130:131], v17 offset:16640
 ds_read_b64_tr_b16 v[132:133], v17 offset:20480
 ds_read_b64_tr_b16 v[134:135], v17 offset:20736
 s_waitcnt vmcnt(19)
 s_waitcnt lgkmcnt(0)
 s_barrier
 s_add_u32 m0, s72, 155648
 s_add_u32 s47, s70, 1310848
 buffer_load_dwordx4 v56, s[8:11], s47 offen  lds
 s_add_u32 m0, s72, 156672
 s_nop 0
 buffer_load_dwordx4 v57, s[8:11], s47 offen  lds
 ds_read_b64_tr_b16 v[136:137], v17 offset:24576
 ds_read_b64_tr_b16 v[138:139], v17 offset:24832
 ds_read_b64_tr_b16 v[140:141], v17 offset:28672
 ds_read_b64_tr_b16 v[142:143], v17 offset:28928
 s_waitcnt vmcnt(19)
 s_waitcnt lgkmcnt(0)
 s_barrier
 s_add_u32 m0, s72, 24576
 s_add_u32 s47, s70, 1310720
 buffer_load_dwordx4 v56, s[12:15], s47 offen  lds
 s_add_u32 m0, s72, 25600
 s_nop 0
 buffer_load_dwordx4 v57, s[12:15], s47 offen  lds
 ds_read_b64_tr_b16 v[144:145], v17 offset:32768
 ds_read_b64_tr_b16 v[146:147], v17 offset:33024
 ds_read_b64_tr_b16 v[148:149], v17 offset:36864
 ds_read_b64_tr_b16 v[150:151], v17 offset:37120
 s_waitcnt vmcnt(19)
 s_waitcnt lgkmcnt(0)
 s_barrier
 s_add_u32 m0, s72, 32768
 s_add_u32 s47, s70, 1310720
 buffer_load_dwordx4 v56, s[16:19], s47 offen  lds
 s_add_u32 m0, s72, 33792
 s_nop 0
 buffer_load_dwordx4 v57, s[16:19], s47 offen  lds
 ds_read_b64_tr_b16 v[152:153], v17 offset:40960
 ds_read_b64_tr_b16 v[154:155], v17 offset:41216
 ds_read_b64_tr_b16 v[156:157], v17 offset:45056
 ds_read_b64_tr_b16 v[158:159], v17 offset:45312
 s_waitcnt vmcnt(19)
 s_waitcnt lgkmcnt(0)
 s_barrier
 s_add_u32 m0, s72, 40960
 s_add_u32 s47, s70, 1310848
 buffer_load_dwordx4 v56, s[16:19], s47 offen  lds
 s_add_u32 m0, s72, 41984
 s_nop 0
 buffer_load_dwordx4 v57, s[16:19], s47 offen  lds
 ds_read_b64_tr_b16 v[160:161], v17 offset:49152
 ds_read_b64_tr_b16 v[162:163], v17 offset:49408
 ds_read_b64_tr_b16 v[164:165], v17 offset:53248
 ds_read_b64_tr_b16 v[166:167], v17 offset:53504
 s_waitcnt vmcnt(19)
 s_waitcnt lgkmcnt(0)
 s_barrier
 s_add_u32 m0, s72, 49152
 s_add_u32 s47, s70, 2097152
 buffer_load_dwordx4 v56, s[8:11], s47 offen  lds
 s_add_u32 m0, s72, 50176
 s_nop 0
 buffer_load_dwordx4 v57, s[8:11], s47 offen  lds
 ds_read_b64_tr_b16 v[168:169], v17 offset:57344
 ds_read_b64_tr_b16 v[170:171], v17 offset:57600
 ds_read_b64_tr_b16 v[172:173], v17 offset:61440
 ds_read_b64_tr_b16 v[174:175], v17 offset:61696
 s_waitcnt vmcnt(14)
 s_waitcnt lgkmcnt(0)
 s_barrier
 s_add_u32 m0, s72, 57344
 s_add_u32 s47, s70, 2097280
 buffer_load_dwordx4 v56, s[8:11], s47 offen  lds
 s_add_u32 m0, s72, 58368
 s_nop 0
 buffer_load_dwordx4 v57, s[8:11], s47 offen  lds
 ds_read_b64_tr_b16 v[176:177], v18 offset:0
 ds_read_b64_tr_b16 v[178:179], v18 offset:256
 ds_read_b64_tr_b16 v[180:181], v18 offset:4096
 ds_read_b64_tr_b16 v[182:183], v18 offset:4352
 s_waitcnt vmcnt(14)
 s_waitcnt lgkmcnt(0)
 s_barrier
 s_add_u32 m0, s72, 65536
 s_add_u32 s47, s70, 2097152
 buffer_load_dwordx4 v56, s[12:15], s47 offen  lds
 s_add_u32 m0, s72, 66560
 s_nop 0
 buffer_load_dwordx4 v57, s[12:15], s47 offen  lds
 v_mov_b32 v68, 0x05040100
 v_mov_b32 v69, 0x07060302
 v_cndmask_b32 v70, v68, v69, s[48:49]
 v_perm_b32 v20, v24, v20, v70
 v_perm_b32 v21, v25, v21, v70
 v_perm_b32 v22, v26, v22, v70
 v_perm_b32 v23, v27, v23, v70
 v_perm_b32 v28, v32, v28, v70
 v_perm_b32 v29, v33, v29, v70
 v_perm_b32 v30, v34, v30, v70
 v_perm_b32 v31, v35, v31, v70
 v_perm_b32 v24, v37, v36, v68
 v_perm_b32 v25, v39, v38, v68
 v_perm_b32 v26, v37, v36, v69
 v_perm_b32 v27, v39, v38, v69
 ds_write_b128 v60, v[20:23]
 ds_write_b128 v60, v[28:31] offset:4096
 ds_write_b128 v3, v[24:27] offset:8192
 ds_read_b64_tr_b16 v[184:185], v18 offset:8192
 ds_read_b64_tr_b16 v[186:187], v18 offset:8448
 ds_read_b64_tr_b16 v[188:189], v18 offset:12288
 ds_read_b64_tr_b16 v[190:191], v18 offset:12544
 s_waitcnt vmcnt(14)
 s_waitcnt lgkmcnt(0)
 s_barrier
 s_add_u32 m0, s72, 73728
 s_add_u32 s47, s70, 2097152
 buffer_load_dwordx4 v56, s[16:19], s47 offen  lds
 s_add_u32 m0, s72, 74752
 s_nop 0
 buffer_load_dwordx4 v57, s[16:19], s47 offen  lds
 ds_read_b64_tr_b16 v[192:193], v18 offset:16384
 ds_read_b64_tr_b16 v[194:195], v18 offset:16640
 ds_read_b64_tr_b16 v[196:197], v18 offset:20480
 ds_read_b64_tr_b16 v[198:199], v18 offset:20736
 s_waitcnt vmcnt(14)
 s_waitcnt lgkmcnt(0)
 s_barrier
 s_add_u32 m0, s72, 81920
 s_add_u32 s47, s70, 2097280
 buffer_load_dwordx4 v56, s[16:19], s47 offen  lds
 s_add_u32 m0, s72, 82944
 s_nop 0
 buffer_load_dwordx4 v57, s[16:19], s47 offen  lds
 ds_read_b64_tr_b16 v[200:201], v18 offset:24576
 ds_read_b64_tr_b16 v[202:203], v18 offset:24832
 ds_read_b64_tr_b16 v[204:205], v18 offset:28672
 ds_read_b64_tr_b16 v[206:207], v18 offset:28928
 s_waitcnt vmcnt(14)
 s_waitcnt lgkmcnt(0)
 s_barrier
 s_add_u32 m0, s72, 90112
 s_add_u32 s47, s70, 2359296
 buffer_load_dwordx4 v56, s[8:11], s47 offen  lds
 s_add_u32 m0, s72, 91136
 s_nop 0
 buffer_load_dwordx4 v57, s[8:11], s47 offen  lds
 ds_read_b64_tr_b16 v[208:209], v16 offset:24576
 ds_read_b64_tr_b16 v[210:211], v16 offset:24832
 ds_read_b64_tr_b16 v[212:213], v16 offset:28672
 ds_read_b64_tr_b16 v[214:215], v16 offset:28928
 s_waitcnt vmcnt(14)
 s_waitcnt lgkmcnt(0)
 s_barrier
 s_add_u32 m0, s72, 98304
 s_add_u32 s47, s70, 2359424
 buffer_load_dwordx4 v56, s[8:11], s47 offen  lds
 s_add_u32 m0, s72, 99328
 s_nop 0
 buffer_load_dwordx4 v57, s[8:11], s47 offen  lds
 ds_read_b64_tr_b16 v[216:217], v16 offset:32768
 ds_read_b64_tr_b16 v[218:219], v16 offset:33024
 ds_read_b64_tr_b16 v[220:221], v16 offset:36864
 ds_read_b64_tr_b16 v[222:223], v16 offset:37120
 s_waitcnt vmcnt(14)
 s_waitcnt lgkmcnt(0)
 s_barrier
 s_add_u32 m0, s72, 106496
 s_add_u32 s47, s70, 2359296
 buffer_load_dwordx4 v56, s[12:15], s47 offen  lds
 s_add_u32 m0, s72, 107520
 s_nop 0
 buffer_load_dwordx4 v57, s[12:15], s47 offen  lds
 ds_read_b64_tr_b16 v[224:225], v16 offset:40960
 ds_read_b64_tr_b16 v[226:227], v16 offset:41216
 ds_read_b64_tr_b16 v[228:229], v16 offset:45056
 ds_read_b64_tr_b16 v[230:231], v16 offset:45312
 s_waitcnt vmcnt(14)
 s_waitcnt lgkmcnt(0)
 s_barrier
 s_add_u32 m0, s72, 114688
 s_add_u32 s47, s70, 2359296
 buffer_load_dwordx4 v56, s[16:19], s47 offen  lds
 s_add_u32 m0, s72, 115712
 s_nop 0
 buffer_load_dwordx4 v57, s[16:19], s47 offen  lds
 ds_read_b64_tr_b16 v[232:233], v16 offset:49152
 ds_read_b64_tr_b16 v[234:235], v16 offset:49408
 ds_read_b64_tr_b16 v[236:237], v16 offset:53248
 ds_read_b64_tr_b16 v[238:239], v16 offset:53504
 s_waitcnt vmcnt(14)
 s_waitcnt lgkmcnt(0)
 s_barrier
 s_add_u32 m0, s72, 122880
 s_add_u32 s47, s70, 2359424
 buffer_load_dwordx4 v56, s[16:19], s47 offen  lds
 s_add_u32 m0, s72, 123904
 s_nop 0
 buffer_load_dwordx4 v57, s[16:19], s47 offen  lds
 ds_read_b64_tr_b16 v[240:241], v16 offset:57344
 ds_read_b64_tr_b16 v[242:243], v16 offset:57600
 ds_read_b64_tr_b16 v[244:245], v16 offset:61440
 ds_read_b64_tr_b16 v[246:247], v16 offset:61696
 s_waitcnt vmcnt(14)
 s_waitcnt lgkmcnt(0)
 s_barrier
 s_add_u32 m0, s72, 131072
 s_add_u32 s47, s70, 3145728
 buffer_load_dwordx4 v56, s[8:11], s47 offen  lds
 s_add_u32 m0, s72, 132096
 s_nop 0
 buffer_load_dwordx4 v57, s[8:11], s47 offen  lds
 ds_read_b64_tr_b16 v[248:249], v17 offset:0
 ds_read_b64_tr_b16 v[250:251], v17 offset:256
 ds_read_b64_tr_b16 v[252:253], v17 offset:4096
 ds_read_b64_tr_b16 v[254:255], v17 offset:4352
 s_waitcnt vmcnt(14)
 s_waitcnt lgkmcnt(0)
 s_barrier
 s_add_u32 m0, s72, 139264
 s_add_u32 s47, s70, 3145856
 buffer_load_dwordx4 v56, s[8:11], s47 offen  lds
 s_add_u32 m0, s72, 140288
 s_nop 0
 buffer_load_dwordx4 v57, s[8:11], s47 offen  lds
 ds_read_b64_tr_b16 a[0:1], v17 offset:8192
 ds_read_b64_tr_b16 a[2:3], v17 offset:8448
 ds_read_b64_tr_b16 a[4:5], v17 offset:12288
 ds_read_b64_tr_b16 a[6:7], v17 offset:12544
 s_waitcnt vmcnt(14)
 s_waitcnt lgkmcnt(0)
 s_barrier
 s_add_u32 m0, s72, 147456
 s_add_u32 s47, s70, 3145728
 buffer_load_dwordx4 v56, s[12:15], s47 offen  lds
 s_add_u32 m0, s72, 148480
 s_nop 0
 buffer_load_dwordx4 v57, s[12:15], s47 offen  lds
 ds_read_b64_tr_b16 a[8:9], v17 offset:16384
 ds_read_b64_tr_b16 a[10:11], v17 offset:16640
 ds_read_b64_tr_b16 a[12:13], v17 offset:20480
 ds_read_b64_tr_b16 a[14:15], v17 offset:20736
 s_waitcnt vmcnt(14)
 s_waitcnt lgkmcnt(0)
 s_barrier
 s_add_u32 m0, s72, 155648
 s_add_u32 s47, s70, 3145728
 buffer_load_dwordx4 v56, s[16:19], s47 offen  lds
 s_add_u32 m0, s72, 156672
 s_nop 0
 buffer_load_dwordx4 v57, s[16:19], s47 offen  lds
 ds_read_b64_tr_b16 a[16:17], v17 offset:24576
 ds_read_b64_tr_b16 a[18:19], v17 offset:24832
 ds_read_b64_tr_b16 a[20:21], v17 offset:28672
 ds_read_b64_tr_b16 a[22:23], v17 offset:28928
 s_waitcnt vmcnt(14)
 s_waitcnt lgkmcnt(0)
 s_barrier
 s_add_u32 m0, s72, 24576
 s_add_u32 s47, s70, 3145856
 buffer_load_dwordx4 v56, s[16:19], s47 offen  lds
 s_add_u32 m0, s72, 25600
 s_nop 0
 buffer_load_dwordx4 v57, s[16:19], s47 offen  lds
 ds_read_b64_tr_b16 a[24:25], v17 offset:32768
 ds_read_b64_tr_b16 a[26:27], v17 offset:33024
 ds_read_b64_tr_b16 a[28:29], v17 offset:36864
 ds_read_b64_tr_b16 a[30:31], v17 offset:37120
 s_waitcnt vmcnt(14)
 s_waitcnt lgkmcnt(0)
 s_barrier
 s_add_u32 m0, s72, 32768
 s_add_u32 s47, s70, 3407872
 buffer_load_dwordx4 v56, s[8:11], s47 offen  lds
 s_add_u32 m0, s72, 33792
 s_nop 0
 buffer_load_dwordx4 v57, s[8:11], s47 offen  lds
 ds_read_b64_tr_b16 a[32:33], v17 offset:40960
 ds_read_b64_tr_b16 a[34:35], v17 offset:41216
 ds_read_b64_tr_b16 a[36:37], v17 offset:45056
 ds_read_b64_tr_b16 a[38:39], v17 offset:45312
 s_waitcnt vmcnt(14)
 s_waitcnt lgkmcnt(0)
 s_barrier
 s_add_u32 m0, s72, 40960
 s_add_u32 s47, s70, 3408000
 buffer_load_dwordx4 v56, s[8:11], s47 offen  lds
 s_add_u32 m0, s72, 41984
 s_nop 0
 buffer_load_dwordx4 v57, s[8:11], s47 offen  lds
 ds_read_b64_tr_b16 a[40:41], v17 offset:49152
 ds_read_b64_tr_b16 a[42:43], v17 offset:49408
 ds_read_b64_tr_b16 a[44:45], v17 offset:53248
 ds_read_b64_tr_b16 a[46:47], v17 offset:53504
 s_waitcnt vmcnt(14)
 s_waitcnt lgkmcnt(0)
 s_barrier
 s_add_u32 m0, s72, 49152
 s_add_u32 s47, s70, 3407872
 buffer_load_dwordx4 v56, s[12:15], s47 offen  lds
 s_add_u32 m0, s72, 50176
 s_nop 0
 buffer_load_dwordx4 v57, s[12:15], s47 offen  lds
 ds_read_b64_tr_b16 a[48:49], v17 offset:57344
 ds_read_b64_tr_b16 a[50:51], v17 offset:57600
 ds_read_b64_tr_b16 a[52:53], v17 offset:61440
 ds_read_b64_tr_b16 a[54:55], v17 offset:61696
 s_waitcnt vmcnt(14)
 s_waitcnt lgkmcnt(0)
 s_barrier
 s_add_u32 m0, s72, 57344
 s_add_u32 s47, s70, 3407872
 buffer_load_dwordx4 v56, s[16:19], s47 offen  lds
 s_add_u32 m0, s72, 58368
 s_nop 0
 buffer_load_dwordx4 v57, s[16:19], s47 offen  lds
 v_min_u32 v65, 16, v3
 v_lshlrev_b32 v65, 24, v65
 buffer_load_dwordx4 v[68:71], v65, s[28:31], 0 offen sc1
 ds_read_b64_tr_b16 a[56:57], v18 offset:0
 ds_read_b64_tr_b16 a[58:59], v18 offset:256
 ds_read_b64_tr_b16 a[60:61], v18 offset:4096
 ds_read_b64_tr_b16 a[62:63], v18 offset:4352
 s_waitcnt vmcnt(15)
 s_waitcnt lgkmcnt(0)
 s_barrier
 s_add_u32 m0, s72, 65536
 s_add_u32 s47, s70, 3408000
 buffer_load_dwordx4 v56, s[16:19], s47 offen  lds
 s_add_u32 m0, s72, 66560
 s_nop 0
 buffer_load_dwordx4 v57, s[16:19], s47 offen  lds
 ds_read_b64_tr_b16 a[64:65], v18 offset:8192
 ds_read_b64_tr_b16 a[66:67], v18 offset:8448
 ds_read_b64_tr_b16 a[68:69], v18 offset:12288
 ds_read_b64_tr_b16 a[70:71], v18 offset:12544
 s_waitcnt vmcnt(15)
 s_waitcnt lgkmcnt(0)
 s_barrier
 s_add_u32 m0, s72, 73728
 s_add_u32 s47, s70, 4194304
 buffer_load_dwordx4 v12, s[8:11], s47 offen  lds
 s_add_u32 m0, s72, 74752
 s_nop 0
 buffer_load_dwordx4 v13, s[8:11], s47 offen  lds
 ds_read_b64_tr_b16 a[72:73], v18 offset:16384
 ds_read_b64_tr_b16 a[74:75], v18 offset:16640
 ds_read_b64_tr_b16 a[76:77], v18 offset:20480
 ds_read_b64_tr_b16 a[78:79], v18 offset:20736
 s_waitcnt vmcnt(15)
 s_waitcnt lgkmcnt(0)
 s_barrier
 s_add_u32 m0, s72, 81920
 s_add_u32 s47, s70, 4194432
 buffer_load_dwordx4 v12, s[8:11], s47 offen  lds
 s_add_u32 m0, s72, 82944
 s_nop 0
 buffer_load_dwordx4 v13, s[8:11], s47 offen  lds
 ds_read_b64_tr_b16 a[80:81], v18 offset:24576
 ds_read_b64_tr_b16 a[82:83], v18 offset:24832
 ds_read_b64_tr_b16 a[84:85], v18 offset:28672
 ds_read_b64_tr_b16 a[86:87], v18 offset:28928
 s_waitcnt vmcnt(15)
 s_waitcnt lgkmcnt(0)
 s_barrier
 s_add_u32 m0, s72, 90112
 s_add_u32 s47, s70, 4194304
 buffer_load_dwordx4 v12, s[12:15], s47 offen  lds
 s_add_u32 m0, s72, 91136
 s_nop 0
 buffer_load_dwordx4 v13, s[12:15], s47 offen  lds
 ds_read_b64_tr_b16 a[88:89], v16 offset:24576
 ds_read_b64_tr_b16 a[90:91], v16 offset:24832
 ds_read_b64_tr_b16 a[92:93], v16 offset:28672
 ds_read_b64_tr_b16 a[94:95], v16 offset:28928
 s_waitcnt vmcnt(15)
 s_waitcnt lgkmcnt(0)
 s_barrier
 s_add_u32 m0, s72, 98304
 s_add_u32 s47, s70, 4194304
 buffer_load_dwordx4 v12, s[16:19], s47 offen  lds
 s_add_u32 m0, s72, 99328
 s_nop 0
 buffer_load_dwordx4 v13, s[16:19], s47 offen  lds
 ds_read_b64_tr_b16 a[96:97], v16 offset:32768
 ds_read_b64_tr_b16 a[98:99], v16 offset:33024
 ds_read_b64_tr_b16 a[100:101], v16 offset:36864
 ds_read_b64_tr_b16 a[102:103], v16 offset:37120
 s_waitcnt vmcnt(15)
 s_waitcnt lgkmcnt(0)
 s_barrier
 s_add_u32 m0, s72, 106496
 s_add_u32 s47, s70, 4194432
 buffer_load_dwordx4 v12, s[16:19], s47 offen  lds
 s_add_u32 m0, s72, 107520
 s_nop 0
 buffer_load_dwordx4 v13, s[16:19], s47 offen  lds
 ds_read_b64_tr_b16 a[104:105], v16 offset:40960
 ds_read_b64_tr_b16 a[106:107], v16 offset:41216
 ds_read_b64_tr_b16 a[108:109], v16 offset:45056
 ds_read_b64_tr_b16 a[110:111], v16 offset:45312
 s_waitcnt vmcnt(15)
 s_waitcnt lgkmcnt(0)
 s_barrier
 s_add_u32 m0, s72, 114688
 s_add_u32 s47, s71, 0
 buffer_load_dwordx4 v14, s[24:27], s47 offen  lds
 s_add_u32 m0, s72, 115712
 s_nop 0
 buffer_load_dwordx4 v15, s[24:27], s47 offen  lds
 ds_read_b64_tr_b16 a[112:113], v16 offset:49152
 ds_read_b64_tr_b16 a[114:115], v16 offset:49408
 ds_read_b64_tr_b16 a[116:117], v16 offset:53248
 ds_read_b64_tr_b16 a[118:119], v16 offset:53504
 s_waitcnt vmcnt(15)
 s_waitcnt lgkmcnt(0)
 s_barrier
 s_add_u32 m0, s72, 122880
 s_add_u32 s47, s71, 128
 buffer_load_dwordx4 v14, s[24:27], s47 offen  lds
 s_add_u32 m0, s72, 123904
 s_nop 0
 buffer_load_dwordx4 v15, s[24:27], s47 offen  lds
 ds_read_b64_tr_b16 a[120:121], v16 offset:57344
 ds_read_b64_tr_b16 a[122:123], v16 offset:57600
 ds_read_b64_tr_b16 a[124:125], v16 offset:61440
 ds_read_b64_tr_b16 a[126:127], v16 offset:61696
 s_waitcnt vmcnt(14)
 s_waitcnt lgkmcnt(0)
 s_barrier
 s_add_u32 m0, s72, 131072
 s_add_u32 s47, s71, 256
 buffer_load_dwordx4 v14, s[24:27], s47 offen  lds
 s_add_u32 m0, s72, 132096
 s_nop 0
 buffer_load_dwordx4 v15, s[24:27], s47 offen  lds
 ds_read_b64_tr_b16 a[128:129], v17 offset:0
 ds_read_b64_tr_b16 a[130:131], v17 offset:256
 ds_read_b64_tr_b16 a[132:133], v17 offset:4096
 ds_read_b64_tr_b16 a[134:135], v17 offset:4352
 s_waitcnt vmcnt(14)
 s_waitcnt lgkmcnt(0)
 s_barrier
 s_add_u32 m0, s72, 139264
 s_add_u32 s47, s71, 384
 buffer_load_dwordx4 v14, s[24:27], s47 offen  lds
 s_add_u32 m0, s72, 140288
 s_nop 0
 buffer_load_dwordx4 v15, s[24:27], s47 offen  lds
 s_branch Lhsc_41
Lhs_40:
 buffer_load_dwordx4 v[68:71], v65, s[28:31], 0 offen sc1
 s_waitcnt vmcnt(0)
Lhsc_41:
 v_sad_u8 v69, v70, 0, 0
 v_sad_u8 v69, v71, 0, v69
 v_lshrrev_b32 v69, 5, v69
 v_min_u32 v68, v68, v69
 v_cmp_ne_u32 vcc, 0, v68
 s_cbranch_vccnz Lhsok_42
 s_sub_u32 s54, s54, 1
 s_cbranch_scc0 Lhs_40
 s_endpgm
Lhsok_42:
 v_readfirstlane_b32 s74, v70
 v_readfirstlane_b32 s75, v71
 buffer_load_dwordx4 v[20:23], v3, s[20:23], s39 offen offset:0 sc1
 buffer_load_dwordx4 v[20:23], v3, s[20:23], s39 offen offset:1024 sc1
 buffer_load_dwordx4 v[20:23], v3, s[20:23], s40 offen offset:0 sc1
 buffer_load_dwordx4 v[20:23], v3, s[20:23], s40 offen offset:1024 sc1
 v_lshlrev_b32 v67, 6, v0
 ds_read_b64_tr_b16 a[136:137], v17 offset:8192
 ds_read_b64_tr_b16 a[138:139], v17 offset:8448
 ds_read_b64_tr_b16 a[140:141], v17 offset:12288
 ds_read_b64_tr_b16 a[142:143], v17 offset:12544
 s_waitcnt vmcnt(18)
 s_waitcnt lgkmcnt(0)
 s_barrier
 s_add_u32 m0, s72, 147456
 s_add_u32 s47, s71, 512
 buffer_load_dwordx4 v14, s[24:27], s47 offen  lds
 s_add_u32 m0, s72, 148480
 s_nop 0
 buffer_load_dwordx4 v15, s[24:27], s47 offen  lds
 ds_read_b64_tr_b16 a[144:145], v17 offset:16384
 ds_read_b64_tr_b16 a[146:147], v17 offset:16640
 ds_read_b64_tr_b16 a[148:149], v17 offset:20480
 ds_read_b64_tr_b16 a[150:151], v17 offset:20736
 s_waitcnt vmcnt(18)
 s_waitcnt lgkmcnt(0)
 s_barrier
 s_add_u32 m0, s72, 155648
 s_add_u32 s47, s71, 640
 buffer_load_dwordx4 v14, s[24:27], s47 offen  lds
 s_add_u32 m0, s72, 156672
 s_nop 0
 buffer_load_dwordx4 v15, s[24:27], s47 offen  lds
 ds_read_b64_tr_b16 a[152:153], v17 offset:24576
 ds_read_b64_tr_b16 a[154:155], v17 offset:24832
 ds_read_b64_tr_b16 a[156:157], v17 offset:28672
 ds_read_b64_tr_b16 a[158:159], v17 offset:28928
 s_waitcnt vmcnt(18)
 s_waitcnt lgkmcnt(0)
 s_barrier
 s_add_u32 m0, s72, 24576
 s_add_u32 s47, s71, 768
 buffer_load_dwordx4 v14, s[24:27], s47 offen  lds
 s_add_u32 m0, s72, 25600
 s_nop 0
 buffer_load_dwordx4 v15, s[24:27], s47 offen  lds
 ds_read_b64_tr_b16 a[160:161], v17 offset:32768
 ds_read_b64_tr_b16 a[162:163], v17 offset:33024
 ds_read_b64_tr_b16 a[164:165], v17 offset:36864
 ds_read_b64_tr_b16 a[166:167], v17 offset:37120
 s_waitcnt vmcnt(18)
 s_waitcnt lgkmcnt(0)
 s_barrier
 s_add_u32 m0, s72, 32768
 s_add_u32 s47, s71, 896
 buffer_load_dwordx4 v14, s[24:27], s47 offen  lds
 s_add_u32 m0, s72, 33792
 s_nop 0
 buffer_load_dwordx4 v15, s[24:27], s47 offen  lds
 ds_read_b64_tr_b16 a[168:169], v17 offset:40960
 ds_read_b64_tr_b16 a[170:171], v17 offset:41216
 ds_read_b64_tr_b16 a[172:173], v17 offset:45056
 ds_read_b64_tr_b16 a[174:175], v17 offset:45312
 s_waitcnt vmcnt(18)
 s_waitcnt lgkmcnt(0)
 s_barrier
 s_add_u32 m0, s72, 40960
 s_add_u32 s47, s71, 37760
 buffer_load_dwordx4 v14, s[24:27], s47 offen  lds
 s_add_u32 m0, s72, 41984
 s_nop 0
 buffer_load_dwordx4 v15, s[24:27], s47 offen  lds
 ds_read_b64_tr_b16 a[176:177], v17 offset:49152
 ds_read_b64_tr_b16 a[178:179], v17 offset:49408
 ds_read_b64_tr_b16 a[180:181], v17 offset:53248
 ds_read_b64_tr_b16 a[182:183], v17 offset:53504
 s_waitcnt vmcnt(18)
 s_waitcnt lgkmcnt(0)
 s_barrier
 s_add_u32 m0, s72, 49152
 s_add_u32 s47, s71, 1024
 buffer_load_dwordx4 v14, s[24:27], s47 offen  lds
 s_add_u32 m0, s72, 50176
 s_nop 0
 buffer_load_dwordx4 v15, s[24:27], s47 offen  lds
 ds_read_b64_tr_b16 a[184:185], v17 offset:57344
 ds_read_b64_tr_b16 a[186:187], v17 offset:57600
 ds_read_b64_tr_b16 a[188:189], v17 offset:61440
 ds_read_b64_tr_b16 a[190:191], v17 offset:61696
 s_waitcnt vmcnt(18)
 s_waitcnt lgkmcnt(0)
 s_barrier
 s_add_u32 m0, s72, 57344
 s_add_u32 s47, s70, 1310848
 buffer_load_dwordx4 v56, s[12:15], s47 offen  lds
 s_add_u32 m0, s72, 58368
 s_nop 0
 buffer_load_dwordx4 v57, s[12:15], s47 offen  lds
 ds_read_b64_tr_b16 a[192:193], v18 offset:0
 ds_read_b64_tr_b16 a[194:195], v18 offset:256
 ds_read_b64_tr_b16 a[196:197], v18 offset:4096
 ds_read_b64_tr_b16 a[198:199], v18 offset:4352
 s_waitcnt vmcnt(18)
 s_waitcnt lgkmcnt(0)
 s_barrier
 s_add_u32 m0, s72, 65536
 s_add_u32 s47, s70, 2097280
 buffer_load_dwordx4 v56, s[12:15], s47 offen  lds
 s_add_u32 m0, s72, 66560
 s_nop 0
 buffer_load_dwordx4 v57, s[12:15], s47 offen  lds
 s_lshl_b32 s47, s6, 2
 s_add_u32 s47, s47, 0x4000
 v_mov_b32 v64, 1
 buffer_store_dword v64, v66, s[20:23], s47 offen
 ds_read_b64_tr_b16 a[200:201], v18 offset:8192
 ds_read_b64_tr_b16 a[202:203], v18 offset:8448
 ds_read_b64_tr_b16 a[204:205], v18 offset:12288
 ds_read_b64_tr_b16 a[206:207], v18 offset:12544
 s_waitcnt vmcnt(15)
 s_waitcnt lgkmcnt(0)
 s_barrier
 s_add_u32 m0, s72, 73728
 s_add_u32 s47, s70, 2359424
 buffer_load_dwordx4 v56, s[12:15], s47 offen  lds
 s_add_u32 m0, s72, 74752
 s_nop 0
 buffer_load_dwordx4 v57, s[12:15], s47 offen  lds
 ds_read_b64_tr_b16 a[208:209], v18 offset:16384
 ds_read_b64_tr_b16 a[210:211], v18 offset:16640
 ds_read_b64_tr_b16 a[212:213], v18 offset:20480
 ds_read_b64_tr_b16 a[214:215], v18 offset:20736
 s_waitcnt vmcnt(15)
 s_waitcnt lgkmcnt(0)
 s_barrier
 s_add_u32 m0, s72, 81920
 s_add_u32 s47, s70, 3145856
 buffer_load_dwordx4 v56, s[12:15], s47 offen  lds
 s_add_u32 m0, s72, 82944
 s_nop 0
 buffer_load_dwordx4 v57, s[12:15], s47 offen  lds
 ds_read_b64_tr_b16 a[216:217], v18 offset:24576
 ds_read_b64_tr_b16 a[218:219], v18 offset:24832
 ds_read_b64_tr_b16 a[220:221], v18 offset:28672
 ds_read_b64_tr_b16 a[222:223], v18 offset:28928
 s_waitcnt vmcnt(15)
 s_waitcnt lgkmcnt(0)
 s_barrier
 s_add_u32 m0, s72, 90112
 s_add_u32 s47, s70, 3408000
 buffer_load_dwordx4 v56, s[12:15], s47 offen  lds
 s_add_u32 m0, s72, 91136
 s_nop 0
 buffer_load_dwordx4 v57, s[12:15], s47 offen  lds
 ds_read_b64_tr_b16 a[224:225], v16 offset:24576
 ds_read_b64_tr_b16 a[226:227], v16 offset:24832
 ds_read_b64_tr_b16 a[228:229], v16 offset:28672
 ds_read_b64_tr_b16 a[230:231], v16 offset:28928
 s_waitcnt vmcnt(15)
 s_waitcnt lgkmcnt(0)
 s_barrier
 s_add_u32 m0, s72, 98304
 s_add_u32 s47, s71, 37888
 buffer_load_dwordx4 v14, s[24:27], s47 offen  lds
 s_add_u32 m0, s72, 99328
 s_nop 0
 buffer_load_dwordx4 v15, s[24:27], s47 offen  lds
 s_and_b32 s47, s6, 29
 s_cbranch_scc1 Lgt_43
 buffer_store_dword v64, v66, s[28:31], 0 offen offset:128 sc1
Lgt_43:
 ds_read_b64_tr_b16 a[232:233], v16 offset:32768
 ds_read_b64_tr_b16 a[234:235], v16 offset:33024
 ds_read_b64_tr_b16 a[236:237], v16 offset:36864
 ds_read_b64_tr_b16 a[238:239], v16 offset:37120
 s_waitcnt vmcnt(15)
 s_waitcnt lgkmcnt(0)
 s_barrier
 s_add_u32 m0, s72, 106496
 s_add_u32 s47, s71, 36864
 buffer_load_dwordx4 v14, s[24:27], s47 offen  lds
 s_add_u32 m0, s72, 107520
 s_nop 0
 buffer_load_dwordx4 v15, s[24:27], s47 offen  lds
 ds_read_b64_tr_b16 a[240:241], v16 offset:40960
 ds_read_b64_tr_b16 a[242:243], v16 offset:41216
 ds_read_b64_tr_b16 a[244:245], v16 offset:45056
 ds_read_b64_tr_b16 a[246:247], v16 offset:45312
 s_waitcnt vmcnt(15)
 s_waitcnt lgkmcnt(0)
 s_barrier
 s_add_u32 m0, s72, 114688
 s_add_u32 s47, s71, 36992
 buffer_load_dwordx4 v14, s[24:27], s47 offen  lds
 s_add_u32 m0, s72, 115712
 s_nop 0
 buffer_load_dwordx4 v15, s[24:27], s47 offen  lds
 ds_read_b64_tr_b16 a[248:249], v16 offset:49152
 ds_read_b64_tr_b16 a[250:251], v16 offset:49408
 ds_read_b64_tr_b16 a[252:253], v16 offset:53248
 ds_read_b64_tr_b16 a[254:255], v16 offset:53504
 s_waitcnt vmcnt(15)
 s_waitcnt lgkmcnt(0)
 s_barrier
 s_add_u32 m0, s72, 122880
 s_add_u32 s47, s71, 37120
 buffer_load_dwordx4 v14, s[24:27], s47 offen  lds
 s_add_u32 m0, s72, 123904
 s_nop 0
 buffer_load_dwordx4 v15, s[24:27], s47 offen  lds
 v_lshrrev_b32 v68, 2, v3
 s_mov_b32 s47, 0x4000
 buffer_load_dword v68, v68, s[20:23], s47 offen sc1
 ds_read_b64_tr_b16 v[48:49], v16 offset:57344
 ds_read_b64_tr_b16 v[50:51], v16 offset:57600
 ds_read_b64_tr_b16 v[52:53], v16 offset:61440
 ds_read_b64_tr_b16 v[54:55], v16 offset:61696
 s_waitcnt vmcnt(16)
 s_waitcnt lgkmcnt(0)
 s_barrier
 s_add_u32 m0, s72, 131072
 s_add_u32 s47, s71, 37248
 buffer_load_dwordx4 v14, s[24:27], s47 offen  lds
 s_add_u32 m0, s72, 132096
 s_nop 0
 buffer_load_dwordx4 v15, s[24:27], s47 offen  lds
 ds_write_b128 v60, v[48:51] offset:57344
 ds_write_b128 v60, v[52:55] offset:61440
 ds_read_b64_tr_b16 v[40:41], v17 offset:0
 ds_read_b64_tr_b16 v[42:43], v17 offset:256
 ds_read_b64_tr_b16 v[44:45], v17 offset:4096
 ds_read_b64_tr_b16 v[46:47], v17 offset:4352
 s_waitcnt vmcnt(15)
 s_waitcnt lgkmcnt(0)
 s_barrier
 s_add_u32 m0, s72, 139264
 s_add_u32 s47, s71, 37376
 buffer_load_dwordx4 v14, s[24:27], s47 offen  lds
 s_add_u32 m0, s72, 140288
 s_nop 0
 buffer_load_dwordx4 v15, s[24:27], s47 offen  lds
 ds_write_b128 v61, v[40:43] offset:0
 ds_write_b128 v61, v[44:47] offset:4096
 ds_read_b64_tr_b16 v[48:49], v17 offset:8192
 ds_read_b64_tr_b16 v[50:51], v17 offset:8448
 ds_read_b64_tr_b16 v[52:53], v17 offset:12288
 ds_read_b64_tr_b16 v[54:55], v17 offset:12544
 s_waitcnt vmcnt(15)
 s_waitcnt lgkmcnt(0)
 s_barrier
 s_add_u32 m0, s72, 147456
 s_add_u32 s47, s71, 37504
 buffer_load_dwordx4 v14, s[24:27], s47 offen  lds
 s_add_u32 m0, s72, 148480
 s_nop 0
 buffer_load_dwordx4 v15, s[24:27], s47 offen  lds
 ds_write_b128 v61, v[48:51] offset:8192
 ds_write_b128 v61, v[52:55] offset:12288
 ds_read_b64_tr_b16 v[40:41], v17 offset:16384
 ds_read_b64_tr_b16 v[42:43], v17 offset:16640
 ds_read_b64_tr_b16 v[44:45], v17 offset:20480
 ds_read_b64_tr_b16 v[46:47], v17 offset:20736
 s_waitcnt vmcnt(15)
 s_waitcnt lgkmcnt(0)
 s_barrier
 s_add_u32 m0, s72, 155648
 s_add_u32 s47, s71, 37632
 buffer_load_dwordx4 v14, s[24:27], s47 offen  lds
 s_add_u32 m0, s72, 156672
 s_nop 0
 buffer_load_dwordx4 v15, s[24:27], s47 offen  lds
 ds_write_b128 v61, v[40:43] offset:16384
 ds_write_b128 v61, v[44:47] offset:20480
 ds_read_b64_tr_b16 v[48:49], v17 offset:24576
 ds_read_b64_tr_b16 v[50:51], v17 offset:24832
 ds_read_b64_tr_b16 v[52:53], v17 offset:28672
 ds_read_b64_tr_b16 v[54:55], v17 offset:28928
 s_waitcnt vmcnt(15)
 s_waitcnt lgkmcnt(0)
 s_barrier
 s_add_u32 m0, s72, 24576
 s_add_u32 s47, s70, 4194432
 buffer_load_dwordx4 v12, s[12:15], s47 offen  lds
 s_add_u32 m0, s72, 25600
 s_nop 0
 buffer_load_dwordx4 v13, s[12:15], s47 offen  lds
 ds_write_b128 v61, v[48:51] offset:24576
 ds_write_b128 v61, v[52:55] offset:28672
 ds_read_b64_tr_b16 v[40:41], v17 offset:32768
 ds_read_b64_tr_b16 v[42:43], v17 offset:33024
 ds_read_b64_tr_b16 v[44:45], v17 offset:36864
 ds_read_b64_tr_b16 v[46:47], v17 offset:37120
 s_waitcnt vmcnt(15)
 s_waitcnt lgkmcnt(0)
 s_barrier
 s_add_u32 m0, s72, 32768
 s_add_u32 s47, s70, 128
 buffer_load_dwordx4 v56, s[12:15], s47 offen  lds
 s_add_u32 m0, s72, 33792
 s_nop 0
 buffer_load_dwordx4 v57, s[12:15], s47 offen  lds
 ds_write_b128 v61, v[40:43] offset:32768
 ds_write_b128 v61, v[44:47] offset:36864
 ds_read_b64_tr_b16 v[48:49], v17 offset:40960
 ds_read_b64_tr_b16 v[50:51], v17 offset:41216
 ds_read_b64_tr_b16 v[52:53], v17 offset:45056
 ds_read_b64_tr_b16 v[54:55], v17 offset:45312
 s_waitcnt vmcnt(15)
 s_waitcnt lgkmcnt(0)
 s_barrier
 s_add_u32 m0, s72, 40960
 s_add_u32 s47, s70, 262272
 buffer_load_dwordx4 v56, s[12:15], s47 offen  lds
 s_add_u32 m0, s72, 41984
 s_nop 0
 buffer_load_dwordx4 v57, s[12:15], s47 offen  lds
 ds_write_b128 v61, v[48:51] offset:40960
 ds_write_b128 v61, v[52:55] offset:45056
 ds_read_b64_tr_b16 v[40:41], v17 offset:49152
 ds_read_b64_tr_b16 v[42:43], v17 offset:49408
 ds_read_b64_tr_b16 v[44:45], v17 offset:53248
 ds_read_b64_tr_b16 v[46:47], v17 offset:53504
 s_waitcnt vmcnt(15)
 s_waitcnt lgkmcnt(0)
 s_barrier
 s_add_u32 m0, s72, 49152
 s_add_u32 s47, s70, 1048704
 buffer_load_dwordx4 v56, s[12:15], s47 offen  lds
 s_add_u32 m0, s72, 50176
 s_nop 0
 buffer_load_dwordx4 v57, s[12:15], s47 offen  lds
 buffer_load_dword v1, v65, s[20:23], s56 offen sc1
 ds_write_b128 v61, v[40:43] offset:49152
 ds_write_b128 v61, v[44:47] offset:53248
 ds_read_b64_tr_b16 v[48:49], v17 offset:57344
 ds_read_b64_tr_b16 v[50:51], v17 offset:57600
 ds_read_b64_tr_b16 v[52:53], v17 offset:61440
 ds_read_b64_tr_b16 v[54:55], v17 offset:61696
 s_waitcnt vmcnt(15)
 s_waitcnt lgkmcnt(0)
 s_barrier
 v_cmp_ne_u32 vcc, 0, v68
 s_mov_b32 s77, vcc_lo
 s_add_u32 s58, s6, 1
 s_and_b32 s58, s58, 31
 s_bitcmp1_b32 s77, s58
 s_cbranch_scc1 Lhlp_44
 s_lshl_b32 s76, s58, 8
 s_mul_i32 s80, s58, 147456
 s_add_u32 s47, s76, 2359424
 buffer_load_dword v63, v19, s[12:15], s47 offen
 s_add_u32 s47, s80, 37888
 buffer_load_dword v63, v59, s[24:27], s47 offen
 s_add_u32 s47, s80, 37120
 buffer_load_dword v63, v59, s[24:27], s47 offen
 s_add_u32 s47, s80, 37504
 buffer_load_dword v63, v59, s[24:27], s47 offen
 s_add_u32 s47, s76, 128
 buffer_load_dword v63, v19, s[12:15], s47 offen
Lhlp_44:
 s_add_u32 s58, s6, 2
 s_and_b32 s58, s58, 31
 s_bitcmp1_b32 s77, s58
 s_cbranch_scc1 Lhlp_45
 s_lshl_b32 s76, s58, 8
 s_mul_i32 s80, s58, 147456
 s_add_u32 s47, s76, 3145856
 buffer_load_dword v63, v19, s[12:15], s47 offen
 s_add_u32 s47, s80, 36864
 buffer_load_dword v63, v59, s[24:27], s47 offen
 s_add_u32 s47, s80, 37248
 buffer_load_dword v63, v59, s[24:27], s47 offen
 s_add_u32 s47, s80, 37632
 buffer_load_dword v63, v59, s[24:27], s47 offen
 s_add_u32 s47, s76, 262272
 buffer_load_dword v63, v19, s[12:15], s47 offen
Lhlp_45:
 s_add_u32 s58, s6, 3
 s_and_b32 s58, s58, 31
 s_bitcmp1_b32 s77, s58
 s_cbranch_scc1 Lhlp_46
 s_lshl_b32 s76, s58, 8
 s_mul_i32 s80, s58, 147456
 s_add_u32 s47, s76, 3408000
 buffer_load_dword v63, v19, s[12:15], s47 offen
 s_add_u32 s47, s80, 36992
 buffer_load_dword v63, v59, s[24:27], s47 offen
 s_add_u32 s47, s80, 37376
 buffer_load_dword v63, v59, s[24:27], s47 offen
 s_add_u32 s47, s76, 4194432
 buffer_load_dword v63, v58, s[12:15], s47 offen
 s_add_u32 s47, s76, 1048704
 buffer_load_dword v63, v19, s[12:15], s47 offen
Lhlp_46:
 ds_write_b128 v61, v[48:51] offset:57344
 ds_write_b128 v61, v[52:55] offset:61440
 ds_read_b64_tr_b16 v[40:41], v18 offset:0
 ds_read_b64_tr_b16 v[42:43], v18 offset:256
 ds_read_b64_tr_b16 v[44:45], v18 offset:4096
 ds_read_b64_tr_b16 v[46:47], v18 offset:4352
 s_waitcnt vmcnt(13)
 s_waitcnt lgkmcnt(0)
 s_barrier
 ds_write_b128 v62, v[40:43] offset:0
 ds_write_b128 v62, v[44:47] offset:4096
 ds_read_b64_tr_b16 v[48:49], v18 offset:8192
 ds_read_b64_tr_b16 v[50:51], v18 offset:8448
 ds_read_b64_tr_b16 v[52:53], v18 offset:12288
 ds_read_b64_tr_b16 v[54:55], v18 offset:12544
 s_waitcnt vmcnt(11)
 s_waitcnt lgkmcnt(0)
 s_barrier
 ds_write_b128 v62, v[48:51] offset:8192
 ds_write_b128 v62, v[52:55] offset:12288
 ds_read_b64_tr_b16 v[40:41], v18 offset:16384
 ds_read_b64_tr_b16 v[42:43], v18 offset:16640
 ds_read_b64_tr_b16 v[44:45], v18 offset:20480
 ds_read_b64_tr_b16 v[46:47], v18 offset:20736
 s_waitcnt vmcnt(9)
 s_waitcnt lgkmcnt(0)
 s_barrier
 ds_write_b128 v62, v[40:43] offset:16384
 ds_write_b128 v62, v[44:47] offset:20480
 ds_read_b64_tr_b16 v[48:49], v18 offset:24576
 ds_read_b64_tr_b16 v[50:51], v18 offset:24832
 ds_read_b64_tr_b16 v[52:53], v18 offset:28672
 ds_read_b64_tr_b16 v[54:55], v18 offset:28928
 s_waitcnt vmcnt(7)
 s_waitcnt lgkmcnt(0)
 s_barrier
 ds_write_b128 v62, v[48:51] offset:24576
 ds_write_b128 v62, v[52:55] offset:28672
 ds_read_b64_tr_b16 v[40:41], v16 offset:24576
 ds_read_b64_tr_b16 v[42:43], v16 offset:24832
 ds_read_b64_tr_b16 v[44:45], v16 offset:28672
 ds_read_b64_tr_b16 v[46:47], v16 offset:28928
 s_waitcnt vmcnt(5)
 s_waitcnt lgkmcnt(0)
 s_barrier
 ds_write_b128 v60, v[40:43] offset:24576
 ds_write_b128 v60, v[44:47] offset:28672
 ds_read_b64_tr_b16 v[48:49], v16 offset:32768
 ds_read_b64_tr_b16 v[50:51], v16 offset:33024
 ds_read_b64_tr_b16 v[52:53], v16 offset:36864
 ds_read_b64_tr_b16 v[54:55], v16 offset:37120
 s_waitcnt vmcnt(3)
 s_waitcnt lgkmcnt(0)
 s_barrier
 ds_write_b128 v60, v[48:51] offset:32768
 ds_write_b128 v60, v[52:55] offset:36864
 ds_read_b64_tr_b16 v[40:41], v16 offset:40960
 ds_read_b64_tr_b16 v[42:43], v16 offset:41216
 ds_read_b64_tr_b16 v[44:45], v16 offset:45056
 ds_read_b64_tr_b16 v[46:47], v16 offset:45312
 s_waitcnt vmcnt(1)
 s_waitcnt lgkmcnt(0)
 s_barrier
 ds_write_b128 v60, v[40:43] offset:40960
 ds_write_b128 v60, v[44:47] offset:45056
 ds_read_b64_tr_b16 v[48:49], v16 offset:49152
 ds_read_b64_tr_b16 v[50:51], v16 offset:49408
 ds_read_b64_tr_b16 v[52:53], v16 offset:53248
 ds_read_b64_tr_b16 v[54:55], v16 offset:53504
 s_waitcnt lgkmcnt(0)
 s_barrier
 ds_write_b128 v60, v[48:51] offset:49152
 ds_write_b128 v60, v[52:55] offset:53248
 v_lshlrev_b32 v0, 4, v0
 s_waitcnt vmcnt(0)
 v_cmp_le_u32 vcc, 2, v1
 s_cbranch_vccnz Lpbk_47
Lpb0_48:
 buffer_load_dword v1, v7, s[20:23], s56 offen sc1
 s_waitcnt vmcnt(0)
 v_cmp_le_u32 vcc, 2, v1
 s_cbranch_vccnz Lpb0ok_49
 s_sub_u32 s54, s54, 1
 s_cbranch_scc0 Lpb0_48
 s_endpgm
Lpb0ok_49:
Lpbk_47:
 s_lshl_b32 s47, s4, 11
 s_add_u32 m0, s47, 9216
 s_add_u32 s68, s37, 0x80000
 buffer_load_dwordx4 v3, s[20:23], s67 offen offset:0 sc1 lds
 buffer_load_dwordx4 v3, s[20:23], s67 offen offset:1024 sc1 lds
 buffer_load_dword v12, v67, s[20:23], s37 offen sc1
 buffer_load_dword v12, v67, s[20:23], s68 offen sc1
 v_mov_b64 v[68:69], 0
 v_mov_b64 v[70:71], 0
 s_add_u32 s68, s68, 0x80000
 s_mov_b32 s24, 0xf000f
 s_mov_b32 s25, 0xf000f
 s_mov_b32 s26, 0xf000f0
 s_mov_b32 s27, 0xf000f0
 s_mov_b32 s28, 0xf000f00
 s_mov_b32 s29, 0xf000f00
 s_mov_b32 s30, 0xf000f000
 s_mov_b32 s31, 0xf000f000
 s_mov_b32 s32, 0xaaaaaaaa
 s_mov_b32 s33, 0xaaaaaaaa
 s_mov_b32 s34, 0x3f803f80
 s_mov_b32 s35, 0x3f803f80
 s_mov_b32 s70, -1
 s_mov_b32 s71, 0
 s_lshl_b32 s47, s4, 12
 s_add_u32 s68, s68, s47
 v_mov_b32 v2, 0
 v_mov_b32 v4, 0
 s_waitcnt lgkmcnt(0)
 ds_read_b128 v[20:23], v0 offset:24576
 ds_read_b128 v[24:27], v0 offset:28672
 ds_read_b128 v[28:31], v0 offset:32768
 ds_read_b128 v[32:35], v0 offset:36864
 v_mov_b64 v[36:37], 0
 v_mov_b64 v[38:39], 0
 v_mov_b64 v[40:41], 0
 v_mov_b64 v[42:43], 0
 v_mov_b64 v[44:45], 0
 v_mov_b64 v[46:47], 0
 v_mov_b64 v[48:49], 0
 v_mov_b64 v[50:51], 0
 v_lshl_add_u32 v1, v3, 3, s68
 v_mov_b32 v6, s56
 v_cndmask_b32 v1, v6, v1, s[70:71]
 v_min_u32 v6, 16, v0
 v_lshlrev_b32 v6, 24, v6
 s_max_u32 s47, s36, 1
 v_add_u32 v2, -1, s47
 s_xor_b32 s44, s44, 0x80000
 s_xor_b32 s45, s45, 0x80000
 s_xor_b32 s65, s65, 0x80000
 s_xor_b32 s66, s66, 0x80000
 s_xor_b32 s41, s41, 0x80000
 s_xor_b32 s43, s43, 0x80000
 s_lshr_b64 s[74:75], s[74:75], s73
 s_and_b32 s74, s74, 0xff
 s_cmp_eq_u32 s74, 32
 s_waitcnt vmcnt(2)
 s_cbranch_scc0 Lslow_50
 .p2align 3
Lstep_52:
 s_mov_b64 exec, -1
 s_waitcnt lgkmcnt(0)
 s_barrier
 ds_read_b128 v[52:55], v3 offset:8192
 ds_read_b128 v[56:59], v3 offset:0
 ds_read_b128 v[60:63], v3 offset:1024
 buffer_store_dwordx4 v[64:67], v0, s[20:23], s38 offen sc1
 s_waitcnt lgkmcnt(2)
 v_smfmac_f32_16x16x64_bf16 v[36:39], v[52:55], a[136:143], v5
 v_smfmac_f32_16x16x64_bf16 v[40:43], v[52:55], a[144:151], v5
 buffer_store_dword v2, v6, s[20:23], s57 offen sc1
 v_smfmac_f32_16x16x64_bf16 v[44:47], v[52:55], a[152:159], v5
 s_waitcnt lgkmcnt(1)
 v_smfmac_f32_16x16x64_bf16 v[48:51], v[52:55], v[20:27], v5
 v_smfmac_f32_16x16x64_bf16 v[36:39], v[56:59], v[72:79], v5
 ds_read_b128 v[20:23], v0 offset:40960
 v_mov_b64 v[64:65], 0
 v_smfmac_f32_16x16x64_bf16 v[40:43], v[56:59], v[80:87], v5
 ds_read_b128 v[24:27], v0 offset:45056
 v_mov_b64 v[66:67], 0
 v_smfmac_f32_16x16x64_bf16 v[44:47], v[56:59], v[88:95], v5
 ds_read_b128 v[52:55], v3 offset:2048
 s_waitcnt lgkmcnt(3)
 v_smfmac_f32_16x16x64_bf16 v[48:51], v[56:59], v[28:35], v5
 v_smfmac_f32_16x16x64_bf16 v[36:39], v[60:63], v[112:119], v5
 ds_read_b128 v[28:31], v0 offset:49152
 v_smfmac_f32_16x16x64_bf16 v[40:43], v[60:63], v[120:127], v5
 ds_read_b128 v[32:35], v0 offset:53248
 v_smfmac_f32_16x16x64_bf16 v[44:47], v[60:63], v[128:135], v5
 ds_read_b128 v[56:59], v3 offset:3072
 v_smfmac_f32_16x16x64_bf16 v[64:67], v[60:63], v[136:143], v5
 v_smfmac_f32_16x16x64_bf16 v[68:71], v[60:63], v[144:151], v5
 s_waitcnt lgkmcnt(3)
 v_smfmac_f32_16x16x64_bf16 v[48:51], v[60:63], v[20:27], v5
 v_smfmac_f32_16x16x64_bf16 v[36:39], v[52:55], v[152:159], v5
 ds_read_b128 v[20:23], v0 offset:57344
 v_smfmac_f32_16x16x64_bf16 v[40:43], v[52:55], v[160:167], v5
 ds_read_b128 v[24:27], v0 offset:61440
 v_smfmac_f32_16x16x64_bf16 v[44:47], v[52:55], v[168:175], v5
 v_smfmac_f32_16x16x64_bf16 v[64:67], v[52:55], v[176:183], v5
 v_smfmac_f32_16x16x64_bf16 v[68:71], v[52:55], v[184:191], v5
 s_waitcnt lgkmcnt(2)
 v_add_u32 v0, 0x10000, v0
 v_smfmac_f32_16x16x64_bf16 v[48:51], v[52:55], v[28:35], v5
 s_branch Ljoin_55
 .p2align 3
LstepB_54:
 s_mov_b64 exec, -1
 buffer_load_dwordx4 v[12:15], v3, s[20:23], s41 offen offset:0 sc1
 buffer_load_dwordx4 v[16:19], v3, s[20:23], s41 offen offset:1024 sc1
 s_waitcnt lgkmcnt(0)
 s_barrier
 ds_read_b128 v[52:55], v3 offset:8192
 ds_read_b128 v[56:59], v3 offset:0
 ds_read_b128 v[60:63], v3 offset:1024
 buffer_store_dwordx4 v[64:67], v0, s[20:23], s38 offen sc1
 s_waitcnt lgkmcnt(2)
 v_smfmac_f32_16x16x64_bf16 v[36:39], v[52:55], a[136:143], v5
 v_smfmac_f32_16x16x64_bf16 v[40:43], v[52:55], a[144:151], v5
 v_smfmac_f32_16x16x64_bf16 v[44:47], v[52:55], a[152:159], v5
 s_waitcnt lgkmcnt(1)
 v_smfmac_f32_16x16x64_bf16 v[48:51], v[52:55], v[20:27], v5
 s_waitcnt vmcnt(3)
 v_smfmac_f32_16x16x64_bf16 v[36:39], v[56:59], v[72:79], v5
 ds_read_b128 v[20:23], v0 offset:40960
 v_mov_b64 v[64:65], 0
 v_smfmac_f32_16x16x64_bf16 v[40:43], v[56:59], v[80:87], v5
 ds_read_b128 v[24:27], v0 offset:45056
 v_mov_b64 v[66:67], 0
 v_smfmac_f32_16x16x64_bf16 v[44:47], v[56:59], v[88:95], v5
 ds_read_b128 v[52:55], v3 offset:2048
 s_waitcnt lgkmcnt(3)
 v_smfmac_f32_16x16x64_bf16 v[48:51], v[56:59], v[28:35], v5
 v_mov_b64 v[68:69], 0
 v_smfmac_f32_16x16x64_bf16 v[36:39], v[60:63], v[112:119], v5
 ds_read_b128 v[28:31], v0 offset:49152
 v_mov_b64 v[70:71], 0
 v_smfmac_f32_16x16x64_bf16 v[40:43], v[60:63], v[120:127], v5
 ds_read_b128 v[32:35], v0 offset:53248
 v_smfmac_f32_16x16x64_bf16 v[44:47], v[60:63], v[128:135], v5
 ds_read_b128 v[56:59], v3 offset:3072
 v_smfmac_f32_16x16x64_bf16 v[64:67], v[60:63], v[136:143], v5
 s_waitcnt vmcnt(1)
 ds_write_b128 v4, v[12:15] offset:0
 v_smfmac_f32_16x16x64_bf16 v[68:71], v[60:63], v[144:151], v5
 s_waitcnt lgkmcnt(4)
 v_smfmac_f32_16x16x64_bf16 v[48:51], v[60:63], v[20:27], v5
 ds_write_b128 v4, v[16:19] offset:1024
 v_max3_u32 v2, v12, v13, v14
 v_smfmac_f32_16x16x64_bf16 v[36:39], v[52:55], v[152:159], v5
 ds_read_b128 v[20:23], v0 offset:57344
 v_max3_u32 v2, v2, v15, v16
 v_smfmac_f32_16x16x64_bf16 v[40:43], v[52:55], v[160:167], v5
 ds_read_b128 v[24:27], v0 offset:61440
 v_max3_u32 v2, v2, v17, v18
 v_smfmac_f32_16x16x64_bf16 v[44:47], v[52:55], v[168:175], v5
 v_max_u32 v2, v2, v19
 v_smfmac_f32_16x16x64_bf16 v[64:67], v[52:55], v[176:183], v5
 v_cmp_eq_u32 vcc, -1, v2
 v_smfmac_f32_16x16x64_bf16 v[68:71], v[52:55], v[184:191], v5
 s_waitcnt lgkmcnt(4)
 v_add_u32 v0, 0x10000, v0
 v_smfmac_f32_16x16x64_bf16 v[48:51], v[52:55], v[28:35], v5
 s_cbranch_vccnz Lyr_56
Lyb_57:
 s_waitcnt lgkmcnt(2)
Ljoin_55:
 v_smfmac_f32_16x16x64_bf16 v[36:39], v[56:59], v[192:199], v5
 ds_read_b128 v[28:31], v0 offset:0
 buffer_load_dwordx4 v[12:15], v3, s[20:23], s59 offen offset:0 sc1
 v_smfmac_f32_16x16x64_bf16 v[40:43], v[56:59], v[200:207], v5
 ds_read_b128 v[32:35], v0 offset:4096
 buffer_load_dwordx4 v[16:19], v3, s[20:23], s59 offen offset:1024 sc1
 v_smfmac_f32_16x16x64_bf16 v[44:47], v[56:59], v[208:215], v5
 s_barrier
 ds_read_b128 v[60:63], v3 offset:4096
 v_smfmac_f32_16x16x64_bf16 v[64:67], v[56:59], v[216:223], v5
 ds_read_b128 v[52:55], v3 offset:5120
 v_smfmac_f32_16x16x64_bf16 v[68:71], v[56:59], v[224:231], v5
 s_waitcnt lgkmcnt(4)
 v_smfmac_f32_16x16x64_bf16 v[48:51], v[56:59], v[20:27], v5
 buffer_load_dword v1, v1, s[20:23], 0 offen sc1
 s_waitcnt lgkmcnt(1)
 v_smfmac_f32_16x16x64_bf16 v[36:39], v[60:63], v[232:239], v5
 ds_read_b128 v[20:23], v0 offset:8192
 v_smfmac_f32_16x16x64_bf16 v[40:43], v[60:63], v[240:247], v5
 ds_read_b128 v[24:27], v0 offset:12288
 v_smfmac_f32_16x16x64_bf16 v[44:47], v[60:63], v[248:255], v5
 ds_read_b128 v[56:59], v3 offset:6144
 s_waitcnt lgkmcnt(3)
 v_smfmac_f32_16x16x64_bf16 v[48:51], v[60:63], v[28:35], v5
 v_smfmac_f32_16x16x64_bf16 v[36:39], v[52:55], a[16:23], v5
 ds_read_b128 v[28:31], v0 offset:16384
 v_smfmac_f32_16x16x64_bf16 v[40:43], v[52:55], a[24:31], v5
 ds_read_b128 v[32:35], v0 offset:20480
 v_smfmac_f32_16x16x64_bf16 v[44:47], v[52:55], a[32:39], v5
 ds_read_b128 v[60:63], v3 offset:7168
 s_waitcnt lgkmcnt(3)
 v_smfmac_f32_16x16x64_bf16 v[48:51], v[52:55], v[20:27], v5
 v_smfmac_f32_16x16x64_bf16 v[36:39], v[56:59], a[56:63], v5
 ds_read_b128 v[20:23], v0 offset:24576
 v_smfmac_f32_16x16x64_bf16 v[40:43], v[56:59], a[64:71], v5
 ds_read_b128 v[24:27], v0 offset:28672
 s_waitcnt lgkmcnt(2)
 v_smfmac_f32_16x16x64_bf16 v[36:39], v[60:63], a[96:103], v5
 v_smfmac_f32_16x16x64_bf16 v[40:43], v[60:63], a[104:111], v5
 v_smfmac_f32_16x16x64_bf16 v[64:67], v[52:55], a[40:47], v5
 s_nop 0
 v_add_f32 v36, v36, v38
 v_smfmac_f32_16x16x64_bf16 v[68:71], v[52:55], a[48:55], v5
 ds_read_b128 v[52:55], v3 offset:8192
 v_add_f32 v37, v37, v39
 v_smfmac_f32_16x16x64_bf16 v[44:47], v[56:59], a[72:79], v5
 v_add_f32 v40, v40, v42
 v_add_f32 v41, v41, v43
 v_smfmac_f32_16x16x64_bf16 v[48:51], v[56:59], v[28:35], v5
 s_waitcnt lgkmcnt(1)
 v_cvt_pk_bf16_f32 v36, v36, v40
 v_smfmac_f32_16x16x64_bf16 v[44:47], v[60:63], a[112:119], v5
 ds_read_b128 v[32:35], v3 offset:11264
 v_cvt_pk_bf16_f32 v37, v37, v41
 v_smfmac_f32_16x16x64_bf16 v[48:51], v[60:63], v[20:27], v5
 ds_write2_b32 v10, v36, v37 offset0:0 offset1:16
 v_smfmac_f32_16x16x64_bf16 v[64:67], v[56:59], a[80:87], v5
 ds_read_b128 v[20:23], v3 offset:9216
 v_add_f32 v44, v44, v46
 v_add_f32 v45, v45, v47
 v_smfmac_f32_16x16x64_bf16 v[68:71], v[56:59], a[88:95], v5
 s_waitcnt lgkmcnt(3)
 v_add_f32 v48, v48, v50
 v_add_f32 v49, v49, v51
 v_cvt_pk_bf16_f32 v44, v44, v48
 v_cvt_pk_bf16_f32 v45, v45, v49
 ds_write2_b32 v8, v44, v45 offset0:0 offset1:16
 v_smfmac_f32_16x16x64_bf16 v[64:67], v[52:55], a[160:167], v5
 ds_read_b128 v[56:59], v3 offset:0
 v_mov_b64 v[28:29], 0
 v_smfmac_f32_16x16x64_bf16 v[68:71], v[52:55], a[168:175], v5
 ds_read_b128 v[52:55], v3 offset:4096
 v_mov_b64 v[30:31], 0
 v_smfmac_f32_16x16x64_bf16 v[64:67], v[60:63], a[120:127], v5
 ds_read_b128 v[24:27], v3 offset:10240
 v_smfmac_f32_16x16x64_bf16 v[68:71], v[60:63], a[128:135], v5
 s_waitcnt lgkmcnt(3)
 s_barrier
 ds_read_b128 v[36:39], v11 offset:17408
 s_waitcnt lgkmcnt(3)
 v_smfmac_f32_16x16x64_bf16 v[64:67], v[56:59], v[96:103], v5
 ds_read_b128 v[40:43], v11 offset:17920
 s_waitcnt lgkmcnt(3)
 v_smfmac_f32_16x16x64_bf16 v[68:71], v[56:59], v[104:111], v5
 ds_read_b128 v[60:63], v9 offset:19456
 ds_read_b128 v[44:47], v11 offset:18432
 v_smfmac_f32_16x16x64_bf16 v[64:67], v[52:55], a[0:7], v5
 ds_read_b128 v[48:51], v11 offset:18944
 v_smfmac_f32_16x16x64_bf16 v[68:71], v[52:55], a[8:15], v5
 ds_read_b128 v[52:55], v3 offset:12288
 s_waitcnt lgkmcnt(5)
 v_mfma_f32_16x16x32_bf16 v[20:23], v[20:23], v[36:39], 0
 ds_read_b128 v[56:59], v9 offset:21504
 v_mfma_f32_16x16x32_bf16 v[24:27], v[24:27], v[36:39], 0
 v_add_f32 v64, v64, v66
 v_add_f32 v65, v65, v67
 s_waitcnt lgkmcnt(5)
 v_mfma_f32_16x16x32_bf16 v[20:23], v[32:35], v[40:43], v[20:23]
 ds_read_b128 v[32:35], v3 offset:13312
 v_cvt_pk_bf16_f32 v2, v64, v65
 v_add_f32 v68, v68, v70
 s_waitcnt lgkmcnt(5)
 v_smfmac_f32_16x16x64_bf16 v[28:31], v[60:63], v[36:43], v5
 ds_read_b128 v[60:63], v3 offset:14336
 ds_read_b128 v[36:39], v3 offset:15360
 v_add_f32 v69, v69, v71
 s_waitcnt lgkmcnt(4)
 v_mfma_f32_16x16x32_bf16 v[24:27], v[52:55], v[40:43], v[24:27]
 ds_read_b128 v[52:55], v3 offset:16384
 v_cvt_pk_bf16_f32 v4, v68, v69
 s_waitcnt lgkmcnt(4)
 v_smfmac_f32_16x16x64_bf16 v[28:31], v[56:59], v[44:51], v5
 ds_read_b128 v[40:43], v0 offset:36864
 s_waitcnt lgkmcnt(4)
 v_mfma_f32_16x16x32_bf16 v[20:23], v[32:35], v[44:47], v[20:23]
 v_mov_b64 v[32:33], s[34:35]
 v_mov_b64 v[34:35], s[34:35]
 s_waitcnt lgkmcnt(3)
 v_mfma_f32_16x16x32_bf16 v[24:27], v[60:63], v[44:47], v[24:27]
 ds_read_b128 v[44:47], v0 offset:40960
 v_add_f32 v28, v28, v30
 v_add_f32 v29, v29, v31
 s_waitcnt lgkmcnt(3)
 v_mfma_f32_16x16x32_bf16 v[20:23], v[36:39], v[48:51], v[20:23]
 ds_read_b128 v[36:39], v0 offset:32768
 v_cndmask_b32 v28, v28, v29, s[48:49]
 v_mul_f32 v28, s55, v28
 s_waitcnt lgkmcnt(3)
 v_mfma_f32_16x16x32_bf16 v[24:27], v[52:55], v[48:51], v[24:27]
 ds_read_b128 v[48:51], v0 offset:45056
 v_exp_f32 v28, v28
 v_mov_b64 v[64:65], 0
 v_cndmask_b32 v29, 0, v28, s[48:49]
 v_cndmask_b32 v28, v28, 0, s[48:49]
 v_cvt_pk_bf16_f32 v6, v28, v29
 v_mov_b64 v[66:67], 0
 v_mov_b64 v[68:69], 0
 v_cndmask_b32 v20, v20, v24, s[48:49]
 v_cndmask_b32 v21, v21, v25, s[48:49]
 v_cndmask_b32 v22, v22, v26, s[48:49]
 v_cndmask_b32 v23, v23, v27, s[48:49]
 v_mfma_f32_16x16x16_bf16 v[60:63], v[6:7], v[32:33], 0
 s_waitcnt vmcnt(1)
 v_exp_f32 v20, v20
 v_mfma_f32_16x16x16_bf16 v[52:55], v[6:7], v[2:3], 0
 s_cmp_eq_u32 s36, 63
 v_exp_f32 v21, v21
 v_mfma_f32_16x16x16_bf16 v[56:59], v[6:7], v[4:5], 0
 v_exp_f32 v22, v22
 v_exp_f32 v23, v23
 v_cvt_pk_bf16_f32 v30, v20, v21
 v_cvt_pk_bf16_f32 v31, v22, v23
 v_mov_b64 v[70:71], 0
 v_mov_b64 v[20:21], 0
 v_smfmac_f32_16x16x32_bf16 v[60:63], v[30:31], v[32:35], v5
 v_mov_b64 v[22:23], 0
 v_mov_b64 v[24:25], 0
 v_smfmac_f32_16x16x32_bf16 v[52:55], v[30:31], v[12:15], v5
 v_mov_b64 v[26:27], 0
 v_smfmac_f32_16x16x32_bf16 v[56:59], v[30:31], v[16:19], v5
 s_nop 0
 v_add_f32 v60, v60, v62
 v_add_f32 v61, v61, v63
 v_rcp_f32 v60, v60
 v_rcp_f32 v61, v61
 v_add_f32 v52, v52, v54
 v_add_f32 v53, v53, v55
 v_mul_f32 v52, v52, v60
 v_mul_f32 v53, v53, v61
 v_add_f32 v56, v56, v58
 v_add_f32 v57, v57, v59
 v_mul_f32 v56, v56, v60
 v_mul_f32 v57, v57, v61
 v_cvt_pk_bf16_f32 v52, v52, v56
 v_cvt_pk_bf16_f32 v53, v53, v57
 ds_write2_b32 v8, v52, v53 offset0:128 offset1:144
 v_subrev_u32 v60, 0x21800000, v60
 v_subrev_u32 v61, 0x21800000, v61
 v_max_u32 v60, v60, v61
 v_cmp_lt_u32 vcc, 0x3c000000, v60
 s_cbranch_scc1 Lchexit_51
 v_mov_b64 v[28:29], 0
 v_mov_b64 v[30:31], 0
 v_mov_b64 v[32:33], 0
 v_mov_b64 v[34:35], 0
 s_cbranch_vccnz Lmx_58
Lmxb_59:
 s_waitcnt lgkmcnt(0)
 v_bfe_u32 v6, v0, 7, 5
 s_barrier
 ds_read_b128 v[52:55], v9 offset:19968
 v_mul_u32_u24 v6, 10496, v6
 ds_read_b128 v[56:59], v9 offset:22016
 ds_read_b128 v[12:15], v0 offset:49152
 v_bfe_u32 v60, v3, 4, 3
 ds_read_b128 v[16:19], v0 offset:53248
 s_add_u32 s67, s67, 0x80000
 v_lshl_add_u32 v6, v60, 3, v6
 s_xor_b32 s46, s46, 0x1
 s_add_u32 s59, s59, 0x80000
 v_mov_b64 v[60:61], 0
 s_add_u32 s38, s38, 0x20000
 v_mov_b64 v[62:63], 0
 s_waitcnt lgkmcnt(3)
 v_smfmac_f32_16x16x64_bf16 v[64:67], v[52:55], a[248:255], v5
 buffer_load_dwordx4 v3, s[20:23], s67 offen offset:0 sc1 lds
 v_smfmac_f32_16x16x64_bf16 v[68:71], v[52:55], a[176:183], v5
 s_waitcnt lgkmcnt(2)
 s_cmp_lt_u32 s36, 61
 v_smfmac_f32_16x16x64_bf16 v[64:67], v[56:59], v[36:43], v5
 ds_read_b128 v[36:39], v0 offset:57344
 buffer_load_dwordx4 v3, s[20:23], s67 offen offset:1024 sc1 lds
 v_smfmac_f32_16x16x64_bf16 v[20:23], v[52:55], a[184:191], v5
 ds_read_b128 v[40:43], v0 offset:61440
 s_cselect_b32 s47, 0x80000, 0
 v_add_u32 v0, 0x10000, v0
 v_smfmac_f32_16x16x64_bf16 v[68:71], v[56:59], v[44:51], v5
 ds_read_b128 v[44:47], v0 offset:0
 s_add_u32 s68, s68, s47
 v_add_f32 v64, v64, v66
 v_add_f32 v65, v65, v67
 v_cvt_pk_bf16_f32 v65, v65, v65
 v_smfmac_f32_16x16x64_bf16 v[24:27], v[52:55], a[192:199], v5
 ds_read_b128 v[48:51], v0 offset:4096
 s_waitcnt lgkmcnt(4)
 v_cvt_pk_bf16_f32 v64, v64, v64
 v_and_or_b32 v65, v65, -2, s46
 v_smfmac_f32_16x16x64_bf16 v[20:23], v[56:59], v[12:19], v5
 ds_read_b128 v[12:15], v0 offset:8192
 buffer_store_dwordx2 v[64:65], v6, s[20:23], s62 offen
 v_add_f32 v68, v68, v70
 v_add_f32 v69, v69, v71
 v_smfmac_f32_16x16x64_bf16 v[28:31], v[52:55], a[200:207], v5
 ds_read_b128 v[16:19], v0 offset:12288
 s_waitcnt lgkmcnt(4)
 v_mov_b64 v[64:65], 0
 v_mov_b64 v[66:67], 0
 v_smfmac_f32_16x16x64_bf16 v[24:27], v[56:59], v[36:43], v5
 ds_read_b128 v[36:39], v0 offset:16384
 s_add_u32 s36, s36, 1
 v_add_f32 v20, v20, v22
 v_add_f32 v21, v21, v23
 v_cvt_pk_bf16_f32 v69, v69, v21
 v_smfmac_f32_16x16x64_bf16 v[32:35], v[52:55], a[208:215], v5
 ds_read_b128 v[40:43], v0 offset:20480
 s_waitcnt lgkmcnt(4)
 v_cvt_pk_bf16_f32 v68, v68, v20
 v_and_or_b32 v69, v69, -2, s46
 v_smfmac_f32_16x16x64_bf16 v[28:31], v[56:59], v[44:51], v5
 ds_read_b128 v[44:47], v0 offset:24576
 buffer_store_dwordx2 v[68:69], v6, s[20:23], s60 offen offset:0
 v_add_f32 v24, v24, v26
 v_add_f32 v25, v25, v27
 v_smfmac_f32_16x16x64_bf16 v[60:63], v[52:55], a[216:223], v5
 ds_read_b128 v[48:51], v0 offset:28672
 s_waitcnt lgkmcnt(4)
 v_mov_b64 v[20:21], 0
 v_mov_b64 v[22:23], 0
 v_smfmac_f32_16x16x64_bf16 v[32:35], v[56:59], v[12:19], v5
 s_add_u32 s58, s36, 2
 s_min_u32 s58, s58, 64
 v_add_f32 v28, v28, v30
 v_add_f32 v29, v29, v31
 v_cvt_pk_bf16_f32 v25, v25, v29
 v_smfmac_f32_16x16x64_bf16 v[64:67], v[52:55], a[224:231], v5
 s_waitcnt lgkmcnt(2)
 s_xor_b32 s44, s44, 0x80000
 v_cvt_pk_bf16_f32 v24, v24, v28
 v_and_or_b32 v25, v25, -2, s46
 v_smfmac_f32_16x16x64_bf16 v[60:63], v[56:59], v[36:43], v5
 buffer_store_dwordx2 v[24:25], v6, s[20:23], s60 offen offset:2048
 v_add_f32 v32, v32, v34
 v_smfmac_f32_16x16x64_bf16 v[20:23], v[52:55], a[232:239], v5
 s_waitcnt lgkmcnt(0)
 s_xor_b32 s45, s45, 0x80000
 v_add_f32 v33, v33, v35
 v_smfmac_f32_16x16x64_bf16 v[64:67], v[56:59], v[44:51], v5
 s_xor_b32 s65, s65, 0x80000
 s_xor_b32 s66, s66, 0x80000
 v_add_f32 v60, v60, v62
 v_add_f32 v61, v61, v63
 v_smfmac_f32_16x16x64_bf16 v[20:23], v[56:59], a[240:247], v5
 s_cmp_eq_u32 s4, 0
 v_cvt_pk_bf16_f32 v33, v33, v61
 v_cvt_pk_bf16_f32 v32, v32, v60
 v_and_or_b32 v33, v33, -2, s46
 buffer_store_dwordx2 v[32:33], v6, s[20:23], s61 offen offset:0
 v_add_f32 v64, v64, v66
 v_add_f32 v65, v65, v67
 s_nop 0
 v_add_f32 v20, v20, v22
 v_add_f32 v21, v21, v23
 v_cvt_pk_bf16_f32 v65, v65, v21
 v_cvt_pk_bf16_f32 v64, v64, v20
 v_and_or_b32 v65, v65, -2, s46
 buffer_store_dwordx2 v[64:65], v6, s[20:23], s61 offen offset:2048
 s_cbranch_scc1 LwH_60
 s_cmp_eq_u32 s4, 1
 s_cbranch_scc1 Lw_61
 s_cmp_eq_u32 s4, 2
 s_cbranch_scc1 Lw_62
 s_xor_b32 s41, s41, 0x80000
 s_xor_b32 s43, s43, 0x80000
 v_mov_b32 v47, 0x3f80
 v_cndmask_b32 v47, v47, 1.0, s[32:33]
 v_cndmask_b32 v44, 0, v47, s[24:25]
 v_cndmask_b32 v45, 0, v47, s[26:27]
 v_cndmask_b32 v46, 0, v47, s[28:29]
 v_cndmask_b32 v47, 0, v47, s[30:31]
 v_bfe_u32 v52, v3, 8, 2
 v_bfe_u32 v58, v3, 2, 4
 v_lshl_or_b32 v52, v52, 4, v58
 v_and_b32 v58, 0xc0, v3
 v_lshl_or_b32 v52, v58, 24, v52
 v_subrev_u32 v0, 0x20000, v0
 v_mov_b32 v59, -1
 v_add_u32 v54, s42, v3
 v_add_u32 v58, s69, v9
 ds_read_b64 v[64:65], v58 offset:19456
 v_mov_b32 v66, v2
 v_mov_b32 v67, v4
 v_mov_b64 v[68:69], 0
 v_mov_b64 v[70:71], 0
 ds_read_b128 v[20:23], v0 offset:24576
 ds_read_b128 v[24:27], v0 offset:28672
 ds_read_b128 v[28:31], v0 offset:32768
 ds_read_b128 v[32:35], v0 offset:36864
 s_waitcnt vmcnt(0)
 buffer_load_dwordx4 v[36:39], v3, s[20:23], s39 offen offset:0 sc1
 buffer_load_dwordx4 v[40:43], v3, s[20:23], s39 offen offset:1024 sc1
 s_nop 15
 s_nop 10
 buffer_load_dwordx4 v[12:15], v3, s[20:23], s39 offen offset:0 sc1
 buffer_load_dwordx4 v[16:19], v3, s[20:23], s39 offen offset:1024 sc1
 s_waitcnt vmcnt(3)
 v_mfma_f32_16x16x32_bf16 v[48:51], v[44:47], v[36:39], 0
 s_waitcnt vmcnt(2)
 v_mfma_f32_16x16x32_bf16 v[48:51], v[44:47], v[40:43], v[48:51]
 v_bitop3_b32 v55, v37, v39, s46 bitop3:0x7e
 v_bitop3_b32 v56, v41, v43, s46 bitop3:0x7e
 v_bitop3_b32 v55, v55, 1, v56 bitop3:0xc8
 v_cmp_ne_u32 vcc, 0, v55
 s_nop 3
 v_add_f32_dpp v48, v48, v48 row_ror:4 row_mask:0xf bank_mask:0xf
 v_add_f32_dpp v49, v49, v49 row_ror:4 row_mask:0xf bank_mask:0xf
 s_cbranch_vccnz Lr2_64
 v_add_f32_dpp v48, v48, v48 row_ror:8 row_mask:0xf bank_mask:0xf
 v_add_f32_dpp v49, v49, v49 row_ror:8 row_mask:0xf bank_mask:0xf
 v_cvt_pk_bf16_f32 v48, v48, v49
 buffer_store_dword v48, v52, s[20:23], s44 offen
Lb1_65:
 buffer_store_dword v59, v52, s[20:23], s45 offen
 v_cmp_gt_u32 vcc, s58, v1
 v_mov_b64 v[36:37], 0
 v_mov_b64 v[38:39], 0
 v_mov_b64 v[40:41], 0
 v_mov_b64 v[42:43], 0
 v_mov_b64 v[44:45], 0
 v_mov_b64 v[46:47], 0
 v_mov_b64 v[48:49], 0
 v_mov_b64 v[50:51], 0
 s_cmp_lg_u32 vcc_hi, 0
 s_cbranch_scc1 Lfw_67
Lfok_66:
 v_lshl_add_u32 v1, v3, 3, s68
 v_mov_b32 v6, s56
 v_cndmask_b32 v1, v6, v1, s[70:71]
 v_mov_b32 v4, v54
 s_waitcnt vmcnt(0)
 s_nop 15
 s_nop 15
 s_nop 11
 s_branch LstepB_54
Lw_62:
 s_xor_b32 s41, s41, 0x80000
 s_xor_b32 s43, s43, 0x80000
 v_mov_b32 v47, 0x3f80
 v_cndmask_b32 v47, v47, 1.0, s[32:33]
 v_cndmask_b32 v44, 0, v47, s[24:25]
 v_cndmask_b32 v45, 0, v47, s[26:27]
 v_cndmask_b32 v46, 0, v47, s[28:29]
 v_cndmask_b32 v47, 0, v47, s[30:31]
 v_bfe_u32 v52, v3, 8, 2
 v_bfe_u32 v58, v3, 2, 4
 v_lshl_or_b32 v52, v52, 4, v58
 v_and_b32 v58, 0xc0, v3
 v_lshl_or_b32 v52, v58, 24, v52
 v_subrev_u32 v0, 0x20000, v0
 v_mov_b32 v59, -1
 v_add_u32 v54, s42, v3
 v_add_u32 v58, s69, v9
 ds_read_b64 v[64:65], v58 offset:19456
 v_mov_b32 v66, v2
 v_mov_b32 v67, v4
 v_mov_b64 v[68:69], 0
 v_mov_b64 v[70:71], 0
 ds_read_b128 v[20:23], v0 offset:24576
 ds_read_b128 v[24:27], v0 offset:28672
 ds_read_b128 v[28:31], v0 offset:32768
 ds_read_b128 v[32:35], v0 offset:36864
 s_waitcnt vmcnt(1)
 buffer_load_dwordx4 v[36:39], v3, s[20:23], s39 offen offset:0 sc1
 buffer_load_dwordx4 v[40:43], v3, s[20:23], s39 offen offset:1024 sc1
 s_nop 15
 s_nop 10
 buffer_load_dwordx4 v[12:15], v3, s[20:23], s39 offen offset:0 sc1
 buffer_load_dwordx4 v[16:19], v3, s[20:23], s39 offen offset:1024 sc1
 s_waitcnt vmcnt(3)
 v_mfma_f32_16x16x32_bf16 v[48:51], v[44:47], v[36:39], 0
 s_waitcnt vmcnt(2)
 v_mfma_f32_16x16x32_bf16 v[48:51], v[44:47], v[40:43], v[48:51]
 v_bitop3_b32 v55, v37, v39, s46 bitop3:0x7e
 v_bitop3_b32 v56, v41, v43, s46 bitop3:0x7e
 v_bitop3_b32 v55, v55, 1, v56 bitop3:0xc8
 v_cmp_ne_u32 vcc, 0, v55
 s_nop 3
 v_add_f32_dpp v48, v48, v48 row_ror:4 row_mask:0xf bank_mask:0xf
 v_add_f32_dpp v49, v49, v49 row_ror:4 row_mask:0xf bank_mask:0xf
 s_cbranch_vccnz Lr2_70
 v_add_f32_dpp v48, v48, v48 row_ror:8 row_mask:0xf bank_mask:0xf
 v_add_f32_dpp v49, v49, v49 row_ror:8 row_mask:0xf bank_mask:0xf
 v_cvt_pk_bf16_f32 v48, v48, v49
 buffer_store_dword v48, v52, s[20:23], s44 offen
Lb1_71:
 buffer_store_dword v59, v52, s[20:23], s45 offen
 v_cmp_gt_u32 vcc, s58, v1
 v_mov_b64 v[36:37], 0
 v_mov_b64 v[38:39], 0
 v_mov_b64 v[40:41], 0
 v_mov_b64 v[42:43], 0
 v_mov_b64 v[44:45], 0
 v_mov_b64 v[46:47], 0
 v_mov_b64 v[48:49], 0
 v_mov_b64 v[50:51], 0
 s_cmp_lg_u32 vcc_hi, 0
 s_cbranch_scc1 Lfw_73
Lfok_72:
 v_lshl_add_u32 v1, v3, 3, s68
 v_mov_b32 v6, s56
 v_cndmask_b32 v1, v6, v1, s[70:71]
 v_mov_b32 v4, v54
 s_nop 7
 buffer_load_dwordx4 v[68:71], v3, s[20:23], s43 offen offset:0 sc1
 s_nop 15
 s_nop 7
Lp2_74:
 buffer_load_dwordx4 v[68:71], v3, s[20:23], s43 offen offset:0 sc1
 s_waitcnt vmcnt(1)
 v_max3_u32 v55, v68, v69, v70
 v_max_u32 v55, v55, v71
 ds_write_b128 v3, v[68:71] offset:8192
 v_cmpx_eq_u32 vcc, -1, v55
 s_cbranch_execz LstepB_54
 buffer_load_dwordx4 v[68:71], v3, s[20:23], s43 offen offset:0 sc1
 s_waitcnt vmcnt(1)
 v_max3_u32 v55, v68, v69, v70
 v_max_u32 v55, v55, v71
 ds_write_b128 v3, v[68:71] offset:8192
 v_cmpx_eq_u32 vcc, -1, v55
 s_cbranch_execz LstepB_54
 buffer_load_dwordx4 v[68:71], v3, s[20:23], s43 offen offset:0 sc1
 s_waitcnt vmcnt(1)
 v_max3_u32 v55, v68, v69, v70
 v_max_u32 v55, v55, v71
 ds_write_b128 v3, v[68:71] offset:8192
 v_cmpx_eq_u32 vcc, -1, v55
 s_cbranch_execz LstepB_54
 s_sub_u32 s54, s54, 1
 s_cbranch_scc0 Lp2_74
 s_endpgm
Lw_61:
 s_waitcnt vmcnt(2)
 buffer_load_dwordx4 v[36:39], v3, s[20:23], s39 offen offset:0 sc1
 buffer_load_dwordx4 v[40:43], v3, s[20:23], s39 offen offset:1024 sc1
 s_xor_b32 s41, s41, 0x80000
 s_xor_b32 s43, s43, 0x80000
 v_mov_b32 v47, 0x3f80
 v_cndmask_b32 v47, v47, 1.0, s[32:33]
 v_cndmask_b32 v44, 0, v47, s[24:25]
 v_cndmask_b32 v45, 0, v47, s[26:27]
 v_cndmask_b32 v46, 0, v47, s[28:29]
 v_cndmask_b32 v47, 0, v47, s[30:31]
 v_bfe_u32 v52, v3, 8, 2
 v_bfe_u32 v58, v3, 2, 4
 v_lshl_or_b32 v52, v52, 4, v58
 v_and_b32 v58, 0xc0, v3
 v_lshl_or_b32 v52, v58, 24, v52
 v_subrev_u32 v0, 0x20000, v0
 v_mov_b32 v59, -1
 v_add_u32 v54, s42, v3
 v_add_u32 v58, s69, v9
 ds_read_b64 v[64:65], v58 offset:19456
 v_mov_b32 v66, v2
 v_mov_b32 v67, v4
 v_mov_b64 v[68:69], 0
 v_mov_b64 v[70:71], 0
 ds_read_b128 v[20:23], v0 offset:24576
 ds_read_b128 v[24:27], v0 offset:28672
 ds_read_b128 v[28:31], v0 offset:32768
 ds_read_b128 v[32:35], v0 offset:36864
 s_nop 3
 buffer_load_dwordx4 v[12:15], v3, s[20:23], s39 offen offset:0 sc1
 buffer_load_dwordx4 v[16:19], v3, s[20:23], s39 offen offset:1024 sc1
 s_waitcnt vmcnt(3)
 v_mfma_f32_16x16x32_bf16 v[48:51], v[44:47], v[36:39], 0
 s_waitcnt vmcnt(2)
 v_mfma_f32_16x16x32_bf16 v[48:51], v[44:47], v[40:43], v[48:51]
 v_bitop3_b32 v55, v37, v39, s46 bitop3:0x7e
 v_bitop3_b32 v56, v41, v43, s46 bitop3:0x7e
 v_bitop3_b32 v55, v55, 1, v56 bitop3:0xc8
 v_cmp_ne_u32 vcc, 0, v55
 s_nop 3
 v_add_f32_dpp v48, v48, v48 row_ror:4 row_mask:0xf bank_mask:0xf
 v_add_f32_dpp v49, v49, v49 row_ror:4 row_mask:0xf bank_mask:0xf
 s_cbranch_vccnz Lr2_76
 v_add_f32_dpp v48, v48, v48 row_ror:8 row_mask:0xf bank_mask:0xf
 v_add_f32_dpp v49, v49, v49 row_ror:8 row_mask:0xf bank_mask:0xf
 v_cvt_pk_bf16_f32 v48, v48, v49
 buffer_store_dword v48, v52, s[20:23], s44 offen
Lb1_77:
 buffer_store_dword v59, v52, s[20:23], s45 offen
 v_cmp_gt_u32 vcc, s58, v1
 v_mov_b64 v[36:37], 0
 v_mov_b64 v[38:39], 0
 v_mov_b64 v[40:41], 0
 v_mov_b64 v[42:43], 0
 v_mov_b64 v[44:45], 0
 v_mov_b64 v[46:47], 0
 v_mov_b64 v[48:49], 0
 v_mov_b64 v[50:51], 0
 s_cmp_lg_u32 vcc_hi, 0
 s_cbranch_scc1 Lfw_79
Lfok_78:
 v_lshl_add_u32 v1, v3, 3, s68
 v_mov_b32 v6, s56
 v_cndmask_b32 v1, v6, v1, s[70:71]
 v_min_u32 v6, 16, v0
 v_lshlrev_b32 v6, 24, v6
 s_max_u32 s47, s36, 1
 v_add_u32 v2, -1, s47
 s_nop 15
 s_nop 0
 buffer_load_dwordx4 v[12:15], v3, s[20:23], s41 offen offset:0 sc1
 buffer_load_dwordx4 v[16:19], v3, s[20:23], s41 offen offset:1024 sc1
 s_nop 15
 s_nop 7
Lp2_80:
 buffer_load_dwordx4 v[12:15], v3, s[20:23], s41 offen offset:0 sc1
 buffer_load_dwordx4 v[16:19], v3, s[20:23], s41 offen offset:1024 sc1
 s_waitcnt vmcnt(2)
 v_max3_u32 v55, v12, v13, v14
 v_max3_u32 v55, v55, v15, v16
 v_max3_u32 v55, v55, v17, v18
 v_max_u32 v55, v55, v19
 ds_write_b128 v54, v[12:15] offset:0
 ds_write_b128 v54, v[16:19] offset:1024
 v_cmpx_eq_u32 vcc, -1, v55
 s_cbranch_execz Lstep_52
 buffer_load_dwordx4 v[12:15], v3, s[20:23], s41 offen offset:0 sc1
 buffer_load_dwordx4 v[16:19], v3, s[20:23], s41 offen offset:1024 sc1
 s_waitcnt vmcnt(2)
 v_max3_u32 v55, v12, v13, v14
 v_max3_u32 v55, v55, v15, v16
 v_max3_u32 v55, v55, v17, v18
 v_max_u32 v55, v55, v19
 ds_write_b128 v54, v[12:15] offset:0
 ds_write_b128 v54, v[16:19] offset:1024
 v_cmpx_eq_u32 vcc, -1, v55
 s_cbranch_execz Lstep_52
 buffer_load_dwordx4 v[12:15], v3, s[20:23], s41 offen offset:0 sc1
 buffer_load_dwordx4 v[16:19], v3, s[20:23], s41 offen offset:1024 sc1
 s_waitcnt vmcnt(2)
 v_max3_u32 v55, v12, v13, v14
 v_max3_u32 v55, v55, v15, v16
 v_max3_u32 v55, v55, v17, v18
 v_max_u32 v55, v55, v19
 ds_write_b128 v54, v[12:15] offset:0
 ds_write_b128 v54, v[16:19] offset:1024
 v_cmpx_eq_u32 vcc, -1, v55
 s_cbranch_execz Lstep_52
 s_sub_u32 s54, s54, 1
 s_cbranch_scc0 Lp2_80
 s_endpgm
LwH_60:
 v_bfe_u32 v53, v3, 8, 1
 v_bfe_u32 v58, v3, 9, 1
 v_lshl_or_b32 v53, v53, 1, v58
 v_bfe_u32 v58, v3, 5, 1
 v_lshl_or_b32 v53, v53, 1, v58
 v_and_b32 v58, 0xd0, v3
 v_lshlrev_b32 v58, 24, v58
 v_lshl_or_b32 v53, v53, 2, v58
 s_waitcnt vmcnt(3)
 s_nop 7
 buffer_load_dwordx4 v[20:23], v3, s[20:23], s40 offen offset:0 sc1
 buffer_load_dwordx4 v[24:27], v3, s[20:23], s40 offen offset:1024 sc1
 buffer_load_dwordx4 v[36:39], v3, s[20:23], s39 offen offset:0 sc1
 buffer_load_dwordx4 v[40:43], v3, s[20:23], s39 offen offset:1024 sc1
 s_xor_b32 s41, s41, 0x80000
 s_xor_b32 s43, s43, 0x80000
 v_mov_b32 v47, 0x3f80
 v_cndmask_b32 v47, v47, 1.0, s[32:33]
 v_cndmask_b32 v44, 0, v47, s[24:25]
 v_cndmask_b32 v45, 0, v47, s[26:27]
 v_cndmask_b32 v46, 0, v47, s[28:29]
 v_cndmask_b32 v47, 0, v47, s[30:31]
 v_bfe_u32 v52, v3, 8, 2
 v_bfe_u32 v58, v3, 2, 4
 v_lshl_or_b32 v52, v52, 4, v58
 v_and_b32 v58, 0xc0, v3
 v_lshl_or_b32 v52, v58, 24, v52
 v_subrev_u32 v0, 0x20000, v0
 v_mov_b32 v59, -1
 v_add_u32 v54, s42, v3
 v_add_u32 v58, s69, v9
 ds_read_b64 v[64:65], v58 offset:19456
 v_mov_b32 v66, v2
 v_mov_b32 v67, v4
 v_mov_b64 v[68:69], 0
 v_mov_b64 v[70:71], 0
 s_waitcnt vmcnt(2)
 v_mfma_f32_16x16x32_bf16 v[28:31], v[44:47], v[20:23], 0
 v_mfma_f32_16x16x32_bf16 v[28:31], v[44:47], v[24:27], v[28:31]
 s_waitcnt vmcnt(1)
 v_mfma_f32_16x16x32_bf16 v[48:51], v[44:47], v[36:39], 0
 s_waitcnt vmcnt(0)
 v_mfma_f32_16x16x32_bf16 v[48:51], v[44:47], v[40:43], v[48:51]
 v_bitop3_b32 v55, v37, v39, s46 bitop3:0x7e
 v_bitop3_b32 v56, v41, v43, s46 bitop3:0x7e
 v_bitop3_b32 v57, v21, v23, s46 bitop3:0x7e
 v_or3_b32 v55, v55, v56, v57
 v_bitop3_b32 v56, v25, v27, s46 bitop3:0x7e
 v_bitop3_b32 v55, v55, 1, v56 bitop3:0xc8
 v_cmp_ne_u32 vcc, 0, v55
 v_add_f32_dpp v29, v29, v29 row_ror:4 row_mask:0xf bank_mask:0xf
 v_add_f32_dpp v48, v48, v48 row_ror:4 row_mask:0xf bank_mask:0xf
 v_add_f32_dpp v49, v49, v49 row_ror:4 row_mask:0xf bank_mask:0xf
 v_add_f32_dpp v29, v29, v29 row_ror:8 row_mask:0xf bank_mask:0xf
 v_add_f32_dpp v48, v48, v48 row_ror:8 row_mask:0xf bank_mask:0xf
 v_add_f32_dpp v49, v49, v49 row_ror:8 row_mask:0xf bank_mask:0xf
 s_cbranch_vccnz Lr1_81
 v_cvt_pk_bf16_f32 v48, v48, v49
 buffer_store_dword v48, v52, s[20:23], s44 offen
 v_mov_b32_dpp v30, v29 quad_perm:[1,0,3,2] row_mask:0xf bank_mask:0xf
 v_cvt_pk_bf16_f32 v29, v29, v30
 buffer_store_dword v29, v53, s[20:23], s65 offen
Lb1_82:
 buffer_store_dword v59, v52, s[20:23], s45 offen
 buffer_store_dword v59, v53, s[20:23], s66 offen
 v_cmp_gt_u32 vcc, s58, v1
 ds_read_b128 v[20:23], v0 offset:24576
 ds_read_b128 v[24:27], v0 offset:28672
 ds_read_b128 v[28:31], v0 offset:32768
 ds_read_b128 v[32:35], v0 offset:36864
 v_mov_b64 v[36:37], 0
 v_mov_b64 v[38:39], 0
 v_mov_b64 v[40:41], 0
 v_mov_b64 v[42:43], 0
 v_mov_b64 v[44:45], 0
 v_mov_b64 v[46:47], 0
 v_mov_b64 v[48:49], 0
 v_mov_b64 v[50:51], 0
 s_cmp_lg_u32 vcc_hi, 0
 s_cbranch_scc1 Lfw_84
Lfok_83:
 v_lshl_add_u32 v1, v3, 3, s68
 v_mov_b32 v6, s56
 v_cndmask_b32 v1, v6, v1, s[70:71]
 v_min_u32 v6, 16, v0
 v_lshlrev_b32 v6, 24, v6
 s_max_u32 s47, s36, 1
 v_add_u32 v2, -1, s47
 s_nop 10
 buffer_load_dwordx4 v[12:15], v3, s[20:23], s41 offen offset:0 sc1
 buffer_load_dwordx4 v[16:19], v3, s[20:23], s41 offen offset:1024 sc1
 s_nop 15
 s_nop 7
Lp2_85:
 buffer_load_dwordx4 v[12:15], v3, s[20:23], s41 offen offset:0 sc1
 buffer_load_dwordx4 v[16:19], v3, s[20:23], s41 offen offset:1024 sc1
 s_waitcnt vmcnt(2)
 v_max3_u32 v55, v12, v13, v14
 v_max3_u32 v55, v55, v15, v16
 v_max3_u32 v55, v55, v17, v18
 v_max_u32 v55, v55, v19
 ds_write_b128 v54, v[12:15] offset:0
 ds_write_b128 v54, v[16:19] offset:1024
 v_cmpx_eq_u32 vcc, -1, v55
 s_cbranch_execz Lstep_52
 buffer_load_dwordx4 v[12:15], v3, s[20:23], s41 offen offset:0 sc1
 buffer_load_dwordx4 v[16:19], v3, s[20:23], s41 offen offset:1024 sc1
 s_waitcnt vmcnt(2)
 v_max3_u32 v55, v12, v13, v14
 v_max3_u32 v55, v55, v15, v16
 v_max3_u32 v55, v55, v17, v18
 v_max_u32 v55, v55, v19
 ds_write_b128 v54, v[12:15] offset:0
 ds_write_b128 v54, v[16:19] offset:1024
 v_cmpx_eq_u32 vcc, -1, v55
 s_cbranch_execz Lstep_52
 buffer_load_dwordx4 v[12:15], v3, s[20:23], s41 offen offset:0 sc1
 buffer_load_dwordx4 v[16:19], v3, s[20:23], s41 offen offset:1024 sc1
 s_waitcnt vmcnt(2)
 v_max3_u32 v55, v12, v13, v14
 v_max3_u32 v55, v55, v15, v16
 v_max3_u32 v55, v55, v17, v18
 v_max_u32 v55, v55, v19
 ds_write_b128 v54, v[12:15] offset:0
 ds_write_b128 v54, v[16:19] offset:1024
 v_cmpx_eq_u32 vcc, -1, v55
 s_cbranch_execz Lstep_52
 s_sub_u32 s54, s54, 1
 s_cbranch_scc0 Lp2_85
 s_endpgm
Lr1_81:
 s_mov_b64 exec, vcc
Lrt_86:
 buffer_load_dwordx4 v[20:23], v3, s[20:23], s40 offen offset:0 sc1
 buffer_load_dwordx4 v[24:27], v3, s[20:23], s40 offen offset:1024 sc1
 buffer_load_dwordx4 v[36:39], v3, s[20:23], s39 offen offset:0 sc1
 buffer_load_dwordx4 v[40:43], v3, s[20:23], s39 offen offset:1024 sc1
 s_waitcnt vmcnt(4)
 v_bitop3_b32 v55, v37, v39, s46 bitop3:0x7e
 v_bitop3_b32 v56, v41, v43, s46 bitop3:0x7e
 v_bitop3_b32 v57, v21, v23, s46 bitop3:0x7e
 v_or3_b32 v55, v55, v56, v57
 v_bitop3_b32 v56, v25, v27, s46 bitop3:0x7e
 v_bitop3_b32 v55, v55, 1, v56 bitop3:0xc8
 v_cmpx_ne_u32 vcc, 0, v55
 s_cbranch_execz Lrte_87
 buffer_load_dwordx4 v[20:23], v3, s[20:23], s40 offen offset:0 sc1
 buffer_load_dwordx4 v[24:27], v3, s[20:23], s40 offen offset:1024 sc1
 buffer_load_dwordx4 v[36:39], v3, s[20:23], s39 offen offset:0 sc1
 buffer_load_dwordx4 v[40:43], v3, s[20:23], s39 offen offset:1024 sc1
 s_waitcnt vmcnt(4)
 v_bitop3_b32 v55, v37, v39, s46 bitop3:0x7e
 v_bitop3_b32 v56, v41, v43, s46 bitop3:0x7e
 v_bitop3_b32 v57, v21, v23, s46 bitop3:0x7e
 v_or3_b32 v55, v55, v56, v57
 v_bitop3_b32 v56, v25, v27, s46 bitop3:0x7e
 v_bitop3_b32 v55, v55, 1, v56 bitop3:0xc8
 v_cmpx_ne_u32 vcc, 0, v55
 s_cbranch_execz Lrte_87
 buffer_load_dwordx4 v[20:23], v3, s[20:23], s40 offen offset:0 sc1
 buffer_load_dwordx4 v[24:27], v3, s[20:23], s40 offen offset:1024 sc1
 buffer_load_dwordx4 v[36:39], v3, s[20:23], s39 offen offset:0 sc1
 buffer_load_dwordx4 v[40:43], v3, s[20:23], s39 offen offset:1024 sc1
 s_waitcnt vmcnt(4)
 v_bitop3_b32 v55, v37, v39, s46 bitop3:0x7e
 v_bitop3_b32 v56, v41, v43, s46 bitop3:0x7e
 v_bitop3_b32 v57, v21, v23, s46 bitop3:0x7e
 v_or3_b32 v55, v55, v56, v57
 v_bitop3_b32 v56, v25, v27, s46 bitop3:0x7e
 v_bitop3_b32 v55, v55, 1, v56 bitop3:0xc8
 v_cmpx_ne_u32 vcc, 0, v55
 s_cbranch_execz Lrte_87
 s_sub_u32 s54, s54, 1
 s_cbranch_scc0 Lrt_86
 s_endpgm
Lrte_87:
 s_mov_b64 exec, -1
 s_nop 2
 v_mfma_f32_16x16x32_bf16 v[28:31], v[44:47], v[20:23], 0
 v_mfma_f32_16x16x32_bf16 v[28:31], v[44:47], v[24:27], v[28:31]
 v_mfma_f32_16x16x32_bf16 v[48:51], v[44:47], v[36:39], 0
 v_mfma_f32_16x16x32_bf16 v[48:51], v[44:47], v[40:43], v[48:51]
 s_nop 6
 v_add_f32_dpp v29, v29, v29 row_ror:4 row_mask:0xf bank_mask:0xf
 v_add_f32_dpp v48, v48, v48 row_ror:4 row_mask:0xf bank_mask:0xf
 v_add_f32_dpp v49, v49, v49 row_ror:4 row_mask:0xf bank_mask:0xf
 v_add_f32_dpp v29, v29, v29 row_ror:8 row_mask:0xf bank_mask:0xf
 v_add_f32_dpp v48, v48, v48 row_ror:8 row_mask:0xf bank_mask:0xf
 v_add_f32_dpp v49, v49, v49 row_ror:8 row_mask:0xf bank_mask:0xf
 v_cvt_pk_bf16_f32 v48, v48, v49
 buffer_store_dword v48, v52, s[20:23], s44 offen
 v_mov_b32_dpp v30, v29 quad_perm:[1,0,3,2] row_mask:0xf bank_mask:0xf
 v_cvt_pk_bf16_f32 v29, v29, v30
 buffer_store_dword v29, v53, s[20:23], s65 offen
 s_waitcnt vmcnt(2)
 s_branch Lb1_82
Lyr_56:
 s_mov_b64 exec, vcc
Lrt_88:
 buffer_load_dwordx4 v[12:15], v3, s[20:23], s41 offen offset:0 sc1
 buffer_load_dwordx4 v[16:19], v3, s[20:23], s41 offen offset:1024 sc1
 s_waitcnt vmcnt(2)
 v_max3_u32 v2, v12, v13, v14
 v_max3_u32 v2, v2, v15, v16
 v_max3_u32 v2, v2, v17, v18
 v_max_u32 v2, v2, v19
 v_cmpx_eq_u32 vcc, -1, v2
 s_cbranch_execz Lrte_89
 buffer_load_dwordx4 v[12:15], v3, s[20:23], s41 offen offset:0 sc1
 buffer_load_dwordx4 v[16:19], v3, s[20:23], s41 offen offset:1024 sc1
 s_waitcnt vmcnt(2)
 v_max3_u32 v2, v12, v13, v14
 v_max3_u32 v2, v2, v15, v16
 v_max3_u32 v2, v2, v17, v18
 v_max_u32 v2, v2, v19
 v_cmpx_eq_u32 vcc, -1, v2
 s_cbranch_execz Lrte_89
 buffer_load_dwordx4 v[12:15], v3, s[20:23], s41 offen offset:0 sc1
 buffer_load_dwordx4 v[16:19], v3, s[20:23], s41 offen offset:1024 sc1
 s_waitcnt vmcnt(2)
 v_max3_u32 v2, v12, v13, v14
 v_max3_u32 v2, v2, v15, v16
 v_max3_u32 v2, v2, v17, v18
 v_max_u32 v2, v2, v19
 v_cmpx_eq_u32 vcc, -1, v2
 s_cbranch_execz Lrte_89
 s_sub_u32 s54, s54, 1
 s_cbranch_scc0 Lrt_88
 s_endpgm
Lrte_89:
 s_mov_b64 exec, -1
 ds_write_b128 v4, v[12:15] offset:0
 ds_write_b128 v4, v[16:19] offset:1024
 s_waitcnt lgkmcnt(0)
 s_branch Lyb_57
Lmx_58:
 s_waitcnt lgkmcnt(0)
 ds_read_b128 v[36:39], v11 offset:17408
 ds_read_b128 v[40:43], v11 offset:17920
 ds_read_b128 v[44:47], v11 offset:18432
 ds_read_b128 v[48:51], v11 offset:18944
 v_mov_b64 v[28:29], 0
 v_mov_b64 v[30:31], 0
 ds_read_b128 v[52:55], v3 offset:9216
 ds_read_b128 v[56:59], v3 offset:10240
 s_waitcnt lgkmcnt(0)
 v_mfma_f32_16x16x32_bf16 v[20:23], v[52:55], v[36:39], 0
 v_mfma_f32_16x16x32_bf16 v[24:27], v[56:59], v[36:39], 0
 ds_read_b128 v[52:55], v3 offset:11264
 ds_read_b128 v[56:59], v3 offset:12288
 s_waitcnt lgkmcnt(0)
 v_mfma_f32_16x16x32_bf16 v[20:23], v[52:55], v[40:43], v[20:23]
 v_mfma_f32_16x16x32_bf16 v[24:27], v[56:59], v[40:43], v[24:27]
 ds_read_b128 v[52:55], v3 offset:13312
 ds_read_b128 v[56:59], v3 offset:14336
 s_waitcnt lgkmcnt(0)
 v_mfma_f32_16x16x32_bf16 v[20:23], v[52:55], v[44:47], v[20:23]
 v_mfma_f32_16x16x32_bf16 v[24:27], v[56:59], v[44:47], v[24:27]
 ds_read_b128 v[52:55], v3 offset:15360
 ds_read_b128 v[56:59], v3 offset:16384
 s_waitcnt lgkmcnt(0)
 v_mfma_f32_16x16x32_bf16 v[20:23], v[52:55], v[48:51], v[20:23]
 v_mfma_f32_16x16x32_bf16 v[24:27], v[56:59], v[48:51], v[24:27]
 ds_read_b128 v[52:55], v9 offset:19456
 ds_read_b128 v[56:59], v9 offset:21504
 s_waitcnt lgkmcnt(0)
 v_smfmac_f32_16x16x64_bf16 v[28:31], v[52:55], v[36:43], v5
 v_smfmac_f32_16x16x64_bf16 v[28:31], v[56:59], v[44:51], v5
 ds_read_b128 v[36:39], v0 offset:32768
 ds_read_b128 v[40:43], v0 offset:36864
 ds_read_b128 v[44:47], v0 offset:40960
 ds_read_b128 v[48:51], v0 offset:45056
 v_mov_b64 v[32:33], s[34:35]
 v_mov_b64 v[34:35], s[34:35]
 s_nop 1
 v_add_f32 v28, v28, v30
 v_add_f32 v29, v29, v31
 v_mul_f32 v28, s55, v28
 v_mul_f32 v29, s55, v29
 v_max_f32 v30, v28, v29
 v_cndmask_b32 v28, v28, v29, s[48:49]
 v_max3_f32 v30, v30, v20, v21
 v_max3_f32 v30, v30, v22, v23
 v_max3_f32 v30, v30, v24, v25
 v_max3_f32 v31, v30, v26, v27
 v_max3_f32 v29, v30, v26, v27
 v_cndmask_b32 v20, v20, v24, s[48:49]
 v_cndmask_b32 v21, v21, v25, s[48:49]
 v_permlane16_swap_b32 v31, v29
 v_max_f32 v30, v31, v29
 v_max_f32 v6, v31, v29
 v_cndmask_b32 v22, v22, v26, s[48:49]
 v_cndmask_b32 v23, v23, v27, s[48:49]
 v_permlane32_swap_b32 v30, v6
 v_max_f32 v30, v30, v6
 v_sub_f32 v28, v28, v30
 v_sub_f32 v20, v20, v30
 v_sub_f32 v21, v21, v30
 v_sub_f32 v22, v22, v30
 v_sub_f32 v23, v23, v30
 v_exp_f32 v28, v28
 v_exp_f32 v20, v20
 v_exp_f32 v21, v21
 v_exp_f32 v22, v22
 v_exp_f32 v23, v23
 v_cndmask_b32 v29, 0, v28, s[48:49]
 v_cndmask_b32 v28, v28, 0, s[48:49]
 v_cvt_pk_bf16_f32 v6, v28, v29
 v_cvt_pk_bf16_f32 v30, v20, v21
 v_cvt_pk_bf16_f32 v31, v22, v23
 v_mfma_f32_16x16x16_bf16 v[60:63], v[6:7], v[32:33], 0
 v_mfma_f32_16x16x16_bf16 v[52:55], v[6:7], v[2:3], 0
 v_mfma_f32_16x16x16_bf16 v[56:59], v[6:7], v[4:5], 0
 v_smfmac_f32_16x16x32_bf16 v[60:63], v[30:31], v[32:35], v5
 v_smfmac_f32_16x16x32_bf16 v[52:55], v[30:31], v[12:15], v5
 v_smfmac_f32_16x16x32_bf16 v[56:59], v[30:31], v[16:19], v5
 s_nop 0
 v_add_f32 v60, v60, v62
 v_add_f32 v61, v61, v63
 v_rcp_f32 v60, v60
 v_rcp_f32 v61, v61
 v_add_f32 v52, v52, v54
 v_add_f32 v53, v53, v55
 v_mul_f32 v52, v52, v60
 v_mul_f32 v53, v53, v61
 v_add_f32 v56, v56, v58
 v_add_f32 v57, v57, v59
 v_mul_f32 v56, v56, v60
 v_mul_f32 v57, v57, v61
 v_cvt_pk_bf16_f32 v52, v52, v56
 v_cvt_pk_bf16_f32 v53, v53, v57
 ds_write2_b32 v8, v52, v53 offset0:128 offset1:144
 v_mov_b64 v[20:21], 0
 v_mov_b64 v[22:23], 0
 v_mov_b64 v[24:25], 0
 v_mov_b64 v[26:27], 0
 v_mov_b64 v[28:29], 0
 v_mov_b64 v[30:31], 0
 v_mov_b64 v[32:33], 0
 v_mov_b64 v[34:35], 0
 s_waitcnt lgkmcnt(0)
 s_branch Lmxb_59
Lr2_64:
 s_waitcnt vmcnt(1)
 v_mfma_f32_16x16x32_bf16 v[48:51], v[44:47], v[12:15], 0
 s_waitcnt vmcnt(0)
 v_mfma_f32_16x16x32_bf16 v[48:51], v[44:47], v[16:19], v[48:51]
 v_bitop3_b32 v55, v13, v15, s46 bitop3:0x7e
 v_bitop3_b32 v56, v17, v19, s46 bitop3:0x7e
 v_bitop3_b32 v55, v55, 1, v56 bitop3:0xc8
 v_cmp_ne_u32 vcc, 0, v55
 s_nop 3
 v_add_f32_dpp v48, v48, v48 row_ror:4 row_mask:0xf bank_mask:0xf
 v_add_f32_dpp v49, v49, v49 row_ror:4 row_mask:0xf bank_mask:0xf
 s_cbranch_vccnz Lr1_63
 v_add_f32_dpp v48, v48, v48 row_ror:8 row_mask:0xf bank_mask:0xf
 v_add_f32_dpp v49, v49, v49 row_ror:8 row_mask:0xf bank_mask:0xf
 v_cvt_pk_bf16_f32 v48, v48, v49
 buffer_store_dword v48, v52, s[20:23], s44 offen
 s_branch Lb1_65
Lr1_63:
 s_mov_b64 exec, vcc
Lrt_90:
 buffer_load_dwordx4 v[12:15], v3, s[20:23], s39 offen offset:0 sc1
 buffer_load_dwordx4 v[16:19], v3, s[20:23], s39 offen offset:1024 sc1
 s_waitcnt vmcnt(2)
 v_bitop3_b32 v55, v13, v15, s46 bitop3:0x7e
 v_bitop3_b32 v56, v17, v19, s46 bitop3:0x7e
 v_bitop3_b32 v55, v55, 1, v56 bitop3:0xc8
 v_cmpx_ne_u32 vcc, 0, v55
 s_cbranch_execz Lrte_91
 buffer_load_dwordx4 v[12:15], v3, s[20:23], s39 offen offset:0 sc1
 buffer_load_dwordx4 v[16:19], v3, s[20:23], s39 offen offset:1024 sc1
 s_waitcnt vmcnt(2)
 v_bitop3_b32 v55, v13, v15, s46 bitop3:0x7e
 v_bitop3_b32 v56, v17, v19, s46 bitop3:0x7e
 v_bitop3_b32 v55, v55, 1, v56 bitop3:0xc8
 v_cmpx_ne_u32 vcc, 0, v55
 s_cbranch_execz Lrte_91
 buffer_load_dwordx4 v[12:15], v3, s[20:23], s39 offen offset:0 sc1
 buffer_load_dwordx4 v[16:19], v3, s[20:23], s39 offen offset:1024 sc1
 s_waitcnt vmcnt(2)
 v_bitop3_b32 v55, v13, v15, s46 bitop3:0x7e
 v_bitop3_b32 v56, v17, v19, s46 bitop3:0x7e
 v_bitop3_b32 v55, v55, 1, v56 bitop3:0xc8
 v_cmpx_ne_u32 vcc, 0, v55
 s_cbranch_execz Lrte_91
 s_sub_u32 s54, s54, 1
 s_cbranch_scc0 Lrt_90
 s_endpgm
Lrte_91:
 s_mov_b64 exec, -1
 s_nop 2
 v_mfma_f32_16x16x32_bf16 v[48:51], v[44:47], v[12:15], 0
 v_mfma_f32_16x16x32_bf16 v[48:51], v[44:47], v[16:19], v[48:51]
 s_nop 7
 v_add_f32_dpp v48, v48, v48 row_ror:4 row_mask:0xf bank_mask:0xf
 v_add_f32_dpp v49, v49, v49 row_ror:4 row_mask:0xf bank_mask:0xf
 s_nop 0
 v_add_f32_dpp v48, v48, v48 row_ror:8 row_mask:0xf bank_mask:0xf
 v_add_f32_dpp v49, v49, v49 row_ror:8 row_mask:0xf bank_mask:0xf
 v_cvt_pk_bf16_f32 v48, v48, v49
 buffer_store_dword v48, v52, s[20:23], s44 offen
 s_branch Lb1_65
Lr2_70:
 s_waitcnt vmcnt(1)
 v_mfma_f32_16x16x32_bf16 v[48:51], v[44:47], v[12:15], 0
 s_waitcnt vmcnt(0)
 v_mfma_f32_16x16x32_bf16 v[48:51], v[44:47], v[16:19], v[48:51]
 v_bitop3_b32 v55, v13, v15, s46 bitop3:0x7e
 v_bitop3_b32 v56, v17, v19, s46 bitop3:0x7e
 v_bitop3_b32 v55, v55, 1, v56 bitop3:0xc8
 v_cmp_ne_u32 vcc, 0, v55
 s_nop 3
 v_add_f32_dpp v48, v48, v48 row_ror:4 row_mask:0xf bank_mask:0xf
 v_add_f32_dpp v49, v49, v49 row_ror:4 row_mask:0xf bank_mask:0xf
 s_cbranch_vccnz Lr1_69
 v_add_f32_dpp v48, v48, v48 row_ror:8 row_mask:0xf bank_mask:0xf
 v_add_f32_dpp v49, v49, v49 row_ror:8 row_mask:0xf bank_mask:0xf
 v_cvt_pk_bf16_f32 v48, v48, v49
 buffer_store_dword v48, v52, s[20:23], s44 offen
 s_branch Lb1_71
Lr1_69:
 s_mov_b64 exec, vcc
Lrt_92:
 buffer_load_dwordx4 v[12:15], v3, s[20:23], s39 offen offset:0 sc1
 buffer_load_dwordx4 v[16:19], v3, s[20:23], s39 offen offset:1024 sc1
 s_waitcnt vmcnt(2)
 v_bitop3_b32 v55, v13, v15, s46 bitop3:0x7e
 v_bitop3_b32 v56, v17, v19, s46 bitop3:0x7e
 v_bitop3_b32 v55, v55, 1, v56 bitop3:0xc8
 v_cmpx_ne_u32 vcc, 0, v55
 s_cbranch_execz Lrte_93
 buffer_load_dwordx4 v[12:15], v3, s[20:23], s39 offen offset:0 sc1
 buffer_load_dwordx4 v[16:19], v3, s[20:23], s39 offen offset:1024 sc1
 s_waitcnt vmcnt(2)
 v_bitop3_b32 v55, v13, v15, s46 bitop3:0x7e
 v_bitop3_b32 v56, v17, v19, s46 bitop3:0x7e
 v_bitop3_b32 v55, v55, 1, v56 bitop3:0xc8
 v_cmpx_ne_u32 vcc, 0, v55
 s_cbranch_execz Lrte_93
 buffer_load_dwordx4 v[12:15], v3, s[20:23], s39 offen offset:0 sc1
 buffer_load_dwordx4 v[16:19], v3, s[20:23], s39 offen offset:1024 sc1
 s_waitcnt vmcnt(2)
 v_bitop3_b32 v55, v13, v15, s46 bitop3:0x7e
 v_bitop3_b32 v56, v17, v19, s46 bitop3:0x7e
 v_bitop3_b32 v55, v55, 1, v56 bitop3:0xc8
 v_cmpx_ne_u32 vcc, 0, v55
 s_cbranch_execz Lrte_93
 s_sub_u32 s54, s54, 1
 s_cbranch_scc0 Lrt_92
 s_endpgm
Lrte_93:
 s_mov_b64 exec, -1
 s_nop 2
 v_mfma_f32_16x16x32_bf16 v[48:51], v[44:47], v[12:15], 0
 v_mfma_f32_16x16x32_bf16 v[48:51], v[44:47], v[16:19], v[48:51]
 s_nop 7
 v_add_f32_dpp v48, v48, v48 row_ror:4 row_mask:0xf bank_mask:0xf
 v_add_f32_dpp v49, v49, v49 row_ror:4 row_mask:0xf bank_mask:0xf
 s_nop 0
 v_add_f32_dpp v48, v48, v48 row_ror:8 row_mask:0xf bank_mask:0xf
 v_add_f32_dpp v49, v49, v49 row_ror:8 row_mask:0xf bank_mask:0xf
 v_cvt_pk_bf16_f32 v48, v48, v49
 buffer_store_dword v48, v52, s[20:23], s44 offen
 s_branch Lb1_71
Lr2_76:
 s_waitcnt vmcnt(1)
 v_mfma_f32_16x16x32_bf16 v[48:51], v[44:47], v[12:15], 0
 s_waitcnt vmcnt(0)
 v_mfma_f32_16x16x32_bf16 v[48:51], v[44:47], v[16:19], v[48:51]
 v_bitop3_b32 v55, v13, v15, s46 bitop3:0x7e
 v_bitop3_b32 v56, v17, v19, s46 bitop3:0x7e
 v_bitop3_b32 v55, v55, 1, v56 bitop3:0xc8
 v_cmp_ne_u32 vcc, 0, v55
 s_nop 3
 v_add_f32_dpp v48, v48, v48 row_ror:4 row_mask:0xf bank_mask:0xf
 v_add_f32_dpp v49, v49, v49 row_ror:4 row_mask:0xf bank_mask:0xf
 s_cbranch_vccnz Lr1_75
 v_add_f32_dpp v48, v48, v48 row_ror:8 row_mask:0xf bank_mask:0xf
 v_add_f32_dpp v49, v49, v49 row_ror:8 row_mask:0xf bank_mask:0xf
 v_cvt_pk_bf16_f32 v48, v48, v49
 buffer_store_dword v48, v52, s[20:23], s44 offen
 s_branch Lb1_77
Lr1_75:
 s_mov_b64 exec, vcc
Lrt_94:
 buffer_load_dwordx4 v[12:15], v3, s[20:23], s39 offen offset:0 sc1
 buffer_load_dwordx4 v[16:19], v3, s[20:23], s39 offen offset:1024 sc1
 s_waitcnt vmcnt(2)
 v_bitop3_b32 v55, v13, v15, s46 bitop3:0x7e
 v_bitop3_b32 v56, v17, v19, s46 bitop3:0x7e
 v_bitop3_b32 v55, v55, 1, v56 bitop3:0xc8
 v_cmpx_ne_u32 vcc, 0, v55
 s_cbranch_execz Lrte_95
 buffer_load_dwordx4 v[12:15], v3, s[20:23], s39 offen offset:0 sc1
 buffer_load_dwordx4 v[16:19], v3, s[20:23], s39 offen offset:1024 sc1
 s_waitcnt vmcnt(2)
 v_bitop3_b32 v55, v13, v15, s46 bitop3:0x7e
 v_bitop3_b32 v56, v17, v19, s46 bitop3:0x7e
 v_bitop3_b32 v55, v55, 1, v56 bitop3:0xc8
 v_cmpx_ne_u32 vcc, 0, v55
 s_cbranch_execz Lrte_95
 buffer_load_dwordx4 v[12:15], v3, s[20:23], s39 offen offset:0 sc1
 buffer_load_dwordx4 v[16:19], v3, s[20:23], s39 offen offset:1024 sc1
 s_waitcnt vmcnt(2)
 v_bitop3_b32 v55, v13, v15, s46 bitop3:0x7e
 v_bitop3_b32 v56, v17, v19, s46 bitop3:0x7e
 v_bitop3_b32 v55, v55, 1, v56 bitop3:0xc8
 v_cmpx_ne_u32 vcc, 0, v55
 s_cbranch_execz Lrte_95
 s_sub_u32 s54, s54, 1
 s_cbranch_scc0 Lrt_94
 s_endpgm
Lrte_95:
 s_mov_b64 exec, -1
 s_nop 2
 v_mfma_f32_16x16x32_bf16 v[48:51], v[44:47], v[12:15], 0
 v_mfma_f32_16x16x32_bf16 v[48:51], v[44:47], v[16:19], v[48:51]
 s_nop 7
 v_add_f32_dpp v48, v48, v48 row_ror:4 row_mask:0xf bank_mask:0xf
 v_add_f32_dpp v49, v49, v49 row_ror:4 row_mask:0xf bank_mask:0xf
 s_nop 0
 v_add_f32_dpp v48, v48, v48 row_ror:8 row_mask:0xf bank_mask:0xf
 v_add_f32_dpp v49, v49, v49 row_ror:8 row_mask:0xf bank_mask:0xf
 v_cvt_pk_bf16_f32 v48, v48, v49
 buffer_store_dword v48, v52, s[20:23], s44 offen
 s_branch Lb1_77
Lfw_67:
Lpb_96:
 buffer_load_dword v1, v7, s[20:23], s56 offen sc1
 s_waitcnt vmcnt(0)
 v_cmp_le_u32 vcc, s58, v1
 s_cbranch_vccnz Lpbok_97
 s_sub_u32 s54, s54, 1
 s_cbranch_scc0 Lpb_96
 s_endpgm
Lpbok_97:
 s_branch Lfok_66
Lfw_73:
Lpb_98:
 buffer_load_dword v1, v7, s[20:23], s56 offen sc1
 s_waitcnt vmcnt(0)
 v_cmp_le_u32 vcc, s58, v1
 s_cbranch_vccnz Lpbok_99
 s_sub_u32 s54, s54, 1
 s_cbranch_scc0 Lpb_98
 s_endpgm
Lpbok_99:
 s_branch Lfok_72
Lfw_79:
Lpb_100:
 buffer_load_dword v1, v7, s[20:23], s56 offen sc1
 s_waitcnt vmcnt(0)
 v_cmp_le_u32 vcc, s58, v1
 s_cbranch_vccnz Lpbok_101
 s_sub_u32 s54, s54, 1
 s_cbranch_scc0 Lpb_100
 s_endpgm
Lpbok_101:
 s_branch Lfok_78
Lfw_84:
Lpb_102:
 buffer_load_dword v1, v7, s[20:23], s56 offen sc1
 s_waitcnt vmcnt(0)
 v_cmp_le_u32 vcc, s58, v1
 s_cbranch_vccnz Lpbok_103
 s_sub_u32 s54, s54, 1
 s_cbranch_scc0 Lpb_102
 s_endpgm
Lpbok_103:
 s_branch Lfok_83
Lfail_53:
 s_endpgm
Lslow_50:
 .p2align 3
Lstep_104:
 s_mov_b64 exec, -1
 s_waitcnt lgkmcnt(0)
 s_barrier
 ds_read_b128 v[52:55], v3 offset:8192
 ds_read_b128 v[56:59], v3 offset:0
 ds_read_b128 v[60:63], v3 offset:1024
 buffer_store_dwordx4 v[64:67], v0, s[20:23], s38 offen sc1
 s_waitcnt lgkmcnt(2)
 v_smfmac_f32_16x16x64_bf16 v[36:39], v[52:55], a[136:143], v5
 v_smfmac_f32_16x16x64_bf16 v[40:43], v[52:55], a[144:151], v5
 buffer_store_dword v2, v6, s[20:23], s57 offen sc1
 v_smfmac_f32_16x16x64_bf16 v[44:47], v[52:55], a[152:159], v5
 s_waitcnt lgkmcnt(1)
 v_smfmac_f32_16x16x64_bf16 v[48:51], v[52:55], v[20:27], v5
 v_smfmac_f32_16x16x64_bf16 v[36:39], v[56:59], v[72:79], v5
 ds_read_b128 v[20:23], v0 offset:40960
 v_mov_b64 v[64:65], 0
 v_smfmac_f32_16x16x64_bf16 v[40:43], v[56:59], v[80:87], v5
 ds_read_b128 v[24:27], v0 offset:45056
 v_mov_b64 v[66:67], 0
 v_smfmac_f32_16x16x64_bf16 v[44:47], v[56:59], v[88:95], v5
 ds_read_b128 v[52:55], v3 offset:2048
 s_waitcnt lgkmcnt(3)
 v_smfmac_f32_16x16x64_bf16 v[48:51], v[56:59], v[28:35], v5
 v_smfmac_f32_16x16x64_bf16 v[36:39], v[60:63], v[112:119], v5
 ds_read_b128 v[28:31], v0 offset:49152
 v_smfmac_f32_16x16x64_bf16 v[40:43], v[60:63], v[120:127], v5
 ds_read_b128 v[32:35], v0 offset:53248
 v_smfmac_f32_16x16x64_bf16 v[44:47], v[60:63], v[128:135], v5
 ds_read_b128 v[56:59], v3 offset:3072
 v_smfmac_f32_16x16x64_bf16 v[64:67], v[60:63], v[136:143], v5
 v_smfmac_f32_16x16x64_bf16 v[68:71], v[60:63], v[144:151], v5
 s_waitcnt lgkmcnt(3)
 v_smfmac_f32_16x16x64_bf16 v[48:51], v[60:63], v[20:27], v5
 v_smfmac_f32_16x16x64_bf16 v[36:39], v[52:55], v[152:159], v5
 ds_read_b128 v[20:23], v0 offset:57344
 v_smfmac_f32_16x16x64_bf16 v[40:43], v[52:55], v[160:167], v5
 ds_read_b128 v[24:27], v0 offset:61440
 v_smfmac_f32_16x16x64_bf16 v[44:47], v[52:55], v[168:175], v5
 v_smfmac_f32_16x16x64_bf16 v[64:67], v[52:55], v[176:183], v5
 v_smfmac_f32_16x16x64_bf16 v[68:71], v[52:55], v[184:191], v5
 s_waitcnt lgkmcnt(2)
 v_add_u32 v0, 0x10000, v0
 v_smfmac_f32_16x16x64_bf16 v[48:51], v[52:55], v[28:35], v5
 s_branch Ljoin_107
 .p2align 3
LstepB_106:
 s_mov_b64 exec, -1
 buffer_load_dwordx4 v[12:15], v3, s[20:23], s41 offen offset:0 sc1
 buffer_load_dwordx4 v[16:19], v3, s[20:23], s41 offen offset:1024 sc1
 s_waitcnt lgkmcnt(0)
 s_barrier
 ds_read_b128 v[52:55], v3 offset:8192
 ds_read_b128 v[56:59], v3 offset:0
 ds_read_b128 v[60:63], v3 offset:1024
 buffer_store_dwordx4 v[64:67], v0, s[20:23], s38 offen sc1
 s_waitcnt lgkmcnt(2)
 v_smfmac_f32_16x16x64_bf16 v[36:39], v[52:55], a[136:143], v5
 v_smfmac_f32_16x16x64_bf16 v[40:43], v[52:55], a[144:151], v5
 v_smfmac_f32_16x16x64_bf16 v[44:47], v[52:55], a[152:159], v5
 s_waitcnt lgkmcnt(1)
 v_smfmac_f32_16x16x64_bf16 v[48:51], v[52:55], v[20:27], v5
 s_waitcnt vmcnt(3)
 v_smfmac_f32_16x16x64_bf16 v[36:39], v[56:59], v[72:79], v5
 ds_read_b128 v[20:23], v0 offset:40960
 v_mov_b64 v[64:65], 0
 v_smfmac_f32_16x16x64_bf16 v[40:43], v[56:59], v[80:87], v5
 ds_read_b128 v[24:27], v0 offset:45056
 v_mov_b64 v[66:67], 0
 v_smfmac_f32_16x16x64_bf16 v[44:47], v[56:59], v[88:95], v5
 ds_read_b128 v[52:55], v3 offset:2048
 s_waitcnt lgkmcnt(3)
 v_smfmac_f32_16x16x64_bf16 v[48:51], v[56:59], v[28:35], v5
 v_mov_b64 v[68:69], 0
 v_smfmac_f32_16x16x64_bf16 v[36:39], v[60:63], v[112:119], v5
 ds_read_b128 v[28:31], v0 offset:49152
 v_mov_b64 v[70:71], 0
 v_smfmac_f32_16x16x64_bf16 v[40:43], v[60:63], v[120:127], v5
 ds_read_b128 v[32:35], v0 offset:53248
 v_smfmac_f32_16x16x64_bf16 v[44:47], v[60:63], v[128:135], v5
 ds_read_b128 v[56:59], v3 offset:3072
 v_smfmac_f32_16x16x64_bf16 v[64:67], v[60:63], v[136:143], v5
 s_waitcnt vmcnt(1)
 ds_write_b128 v4, v[12:15] offset:0
 v_smfmac_f32_16x16x64_bf16 v[68:71], v[60:63], v[144:151], v5
 s_waitcnt lgkmcnt(4)
 v_smfmac_f32_16x16x64_bf16 v[48:51], v[60:63], v[20:27], v5
 ds_write_b128 v4, v[16:19] offset:1024
 v_max3_u32 v2, v12, v13, v14
 v_smfmac_f32_16x16x64_bf16 v[36:39], v[52:55], v[152:159], v5
 ds_read_b128 v[20:23], v0 offset:57344
 v_max3_u32 v2, v2, v15, v16
 v_smfmac_f32_16x16x64_bf16 v[40:43], v[52:55], v[160:167], v5
 ds_read_b128 v[24:27], v0 offset:61440
 v_max3_u32 v2, v2, v17, v18
 v_smfmac_f32_16x16x64_bf16 v[44:47], v[52:55], v[168:175], v5
 v_max_u32 v2, v2, v19
 v_smfmac_f32_16x16x64_bf16 v[64:67], v[52:55], v[176:183], v5
 v_cmp_eq_u32 vcc, -1, v2
 v_smfmac_f32_16x16x64_bf16 v[68:71], v[52:55], v[184:191], v5
 s_waitcnt lgkmcnt(4)
 v_add_u32 v0, 0x10000, v0
 v_smfmac_f32_16x16x64_bf16 v[48:51], v[52:55], v[28:35], v5
 s_cbranch_vccnz Lyr_108
Lyb_109:
 s_waitcnt lgkmcnt(2)
Ljoin_107:
 v_smfmac_f32_16x16x64_bf16 v[36:39], v[56:59], v[192:199], v5
 ds_read_b128 v[28:31], v0 offset:0
 buffer_load_dwordx4 v[12:15], v3, s[20:23], s59 offen offset:0 sc1
 v_smfmac_f32_16x16x64_bf16 v[40:43], v[56:59], v[200:207], v5
 ds_read_b128 v[32:35], v0 offset:4096
 buffer_load_dwordx4 v[16:19], v3, s[20:23], s59 offen offset:1024 sc1
 v_smfmac_f32_16x16x64_bf16 v[44:47], v[56:59], v[208:215], v5
 s_barrier
 ds_read_b128 v[60:63], v3 offset:4096
 v_smfmac_f32_16x16x64_bf16 v[64:67], v[56:59], v[216:223], v5
 ds_read_b128 v[52:55], v3 offset:5120
 v_smfmac_f32_16x16x64_bf16 v[68:71], v[56:59], v[224:231], v5
 s_waitcnt lgkmcnt(4)
 v_smfmac_f32_16x16x64_bf16 v[48:51], v[56:59], v[20:27], v5
 buffer_load_dword v1, v1, s[20:23], 0 offen sc1
 s_waitcnt lgkmcnt(1)
 v_smfmac_f32_16x16x64_bf16 v[36:39], v[60:63], v[232:239], v5
 ds_read_b128 v[20:23], v0 offset:8192
 v_smfmac_f32_16x16x64_bf16 v[40:43], v[60:63], v[240:247], v5
 ds_read_b128 v[24:27], v0 offset:12288
 v_smfmac_f32_16x16x64_bf16 v[44:47], v[60:63], v[248:255], v5
 ds_read_b128 v[56:59], v3 offset:6144
 s_waitcnt lgkmcnt(3)
 v_smfmac_f32_16x16x64_bf16 v[48:51], v[60:63], v[28:35], v5
 v_smfmac_f32_16x16x64_bf16 v[36:39], v[52:55], a[16:23], v5
 ds_read_b128 v[28:31], v0 offset:16384
 v_smfmac_f32_16x16x64_bf16 v[40:43], v[52:55], a[24:31], v5
 ds_read_b128 v[32:35], v0 offset:20480
 v_smfmac_f32_16x16x64_bf16 v[44:47], v[52:55], a[32:39], v5
 ds_read_b128 v[60:63], v3 offset:7168
 s_waitcnt lgkmcnt(3)
 v_smfmac_f32_16x16x64_bf16 v[48:51], v[52:55], v[20:27], v5
 v_smfmac_f32_16x16x64_bf16 v[36:39], v[56:59], a[56:63], v5
 ds_read_b128 v[20:23], v0 offset:24576
 v_smfmac_f32_16x16x64_bf16 v[40:43], v[56:59], a[64:71], v5
 ds_read_b128 v[24:27], v0 offset:28672
 s_waitcnt lgkmcnt(2)
 v_smfmac_f32_16x16x64_bf16 v[36:39], v[60:63], a[96:103], v5
 v_smfmac_f32_16x16x64_bf16 v[40:43], v[60:63], a[104:111], v5
 v_smfmac_f32_16x16x64_bf16 v[64:67], v[52:55], a[40:47], v5
 s_nop 0
 v_add_f32 v36, v36, v38
 v_smfmac_f32_16x16x64_bf16 v[68:71], v[52:55], a[48:55], v5
 ds_read_b128 v[52:55], v3 offset:8192
 v_add_f32 v37, v37, v39
 v_smfmac_f32_16x16x64_bf16 v[44:47], v[56:59], a[72:79], v5
 v_add_f32 v40, v40, v42
 v_add_f32 v41, v41, v43
 v_smfmac_f32_16x16x64_bf16 v[48:51], v[56:59], v[28:35], v5
 s_waitcnt lgkmcnt(1)
 v_cvt_pk_bf16_f32 v36, v36, v40
 v_smfmac_f32_16x16x64_bf16 v[44:47], v[60:63], a[112:119], v5
 ds_read_b128 v[32:35], v3 offset:11264
 v_cvt_pk_bf16_f32 v37, v37, v41
 v_smfmac_f32_16x16x64_bf16 v[48:51], v[60:63], v[20:27], v5
 ds_write2_b32 v10, v36, v37 offset0:0 offset1:16
 v_smfmac_f32_16x16x64_bf16 v[64:67], v[56:59], a[80:87], v5
 ds_read_b128 v[20:23], v3 offset:9216
 v_add_f32 v44, v44, v46
 v_add_f32 v45, v45, v47
 v_smfmac_f32_16x16x64_bf16 v[68:71], v[56:59], a[88:95], v5
 s_waitcnt lgkmcnt(3)
 v_add_f32 v48, v48, v50
 v_add_f32 v49, v49, v51
 v_cvt_pk_bf16_f32 v44, v44, v48
 v_cvt_pk_bf16_f32 v45, v45, v49
 ds_write2_b32 v8, v44, v45 offset0:0 offset1:16
 v_smfmac_f32_16x16x64_bf16 v[64:67], v[52:55], a[160:167], v5
 ds_read_b128 v[56:59], v3 offset:0
 v_mov_b64 v[28:29], 0
 v_smfmac_f32_16x16x64_bf16 v[68:71], v[52:55], a[168:175], v5
 ds_read_b128 v[52:55], v3 offset:4096
 v_mov_b64 v[30:31], 0
 v_smfmac_f32_16x16x64_bf16 v[64:67], v[60:63], a[120:127], v5
 ds_read_b128 v[24:27], v3 offset:10240
 v_smfmac_f32_16x16x64_bf16 v[68:71], v[60:63], a[128:135], v5
 s_waitcnt lgkmcnt(3)
 s_barrier
 ds_read_b128 v[36:39], v11 offset:17408
 s_waitcnt lgkmcnt(3)
 v_smfmac_f32_16x16x64_bf16 v[64:67], v[56:59], v[96:103], v5
 ds_read_b128 v[40:43], v11 offset:17920
 s_waitcnt lgkmcnt(3)
 v_smfmac_f32_16x16x64_bf16 v[68:71], v[56:59], v[104:111], v5
 ds_read_b128 v[60:63], v9 offset:19456
 ds_read_b128 v[44:47], v11 offset:18432
 v_smfmac_f32_16x16x64_bf16 v[64:67], v[52:55], a[0:7], v5
 ds_read_b128 v[48:51], v11 offset:18944
 v_smfmac_f32_16x16x64_bf16 v[68:71], v[52:55], a[8:15], v5
 ds_read_b128 v[52:55], v3 offset:12288
 s_waitcnt lgkmcnt(5)
 v_mfma_f32_16x16x32_bf16 v[20:23], v[20:23], v[36:39], 0
 ds_read_b128 v[56:59], v9 offset:21504
 v_mfma_f32_16x16x32_bf16 v[24:27], v[24:27], v[36:39], 0
 v_add_f32 v64, v64, v66
 v_add_f32 v65, v65, v67
 s_waitcnt lgkmcnt(5)
 v_mfma_f32_16x16x32_bf16 v[20:23], v[32:35], v[40:43], v[20:23]
 ds_read_b128 v[32:35], v3 offset:13312
 v_cvt_pk_bf16_f32 v2, v64, v65
 v_add_f32 v68, v68, v70
 s_waitcnt lgkmcnt(5)
 v_smfmac_f32_16x16x64_bf16 v[28:31], v[60:63], v[36:43], v5
 ds_read_b128 v[60:63], v3 offset:14336
 ds_read_b128 v[36:39], v3 offset:15360
 v_add_f32 v69, v69, v71
 s_waitcnt lgkmcnt(4)
 v_mfma_f32_16x16x32_bf16 v[24:27], v[52:55], v[40:43], v[24:27]
 ds_read_b128 v[52:55], v3 offset:16384
 v_cvt_pk_bf16_f32 v4, v68, v69
 s_waitcnt lgkmcnt(4)
 v_smfmac_f32_16x16x64_bf16 v[28:31], v[56:59], v[44:51], v5
 ds_read_b128 v[40:43], v0 offset:36864
 s_waitcnt lgkmcnt(4)
 v_mfma_f32_16x16x32_bf16 v[20:23], v[32:35], v[44:47], v[20:23]
 v_mov_b64 v[32:33], s[34:35]
 v_mov_b64 v[34:35], s[34:35]
 s_waitcnt lgkmcnt(3)
 v_mfma_f32_16x16x32_bf16 v[24:27], v[60:63], v[44:47], v[24:27]
 ds_read_b128 v[44:47], v0 offset:40960
 v_add_f32 v28, v28, v30
 v_add_f32 v29, v29, v31
 s_waitcnt lgkmcnt(3)
 v_mfma_f32_16x16x32_bf16 v[20:23], v[36:39], v[48:51], v[20:23]
 ds_read_b128 v[36:39], v0 offset:32768
 v_cndmask_b32 v28, v28, v29, s[48:49]
 v_mul_f32 v28, s55, v28
 s_waitcnt lgkmcnt(3)
 v_mfma_f32_16x16x32_bf16 v[24:27], v[52:55], v[48:51], v[24:27]
 ds_read_b128 v[48:51], v0 offset:45056
 v_exp_f32 v28, v28
 v_mov_b64 v[64:65], 0
 v_cndmask_b32 v29, 0, v28, s[48:49]
 v_cndmask_b32 v28, v28, 0, s[48:49]
 v_cvt_pk_bf16_f32 v6, v28, v29
 v_mov_b64 v[66:67], 0
 v_mov_b64 v[68:69], 0
 v_cndmask_b32 v20, v20, v24, s[48:49]
 v_cndmask_b32 v21, v21, v25, s[48:49]
 v_cndmask_b32 v22, v22, v26, s[48:49]
 v_cndmask_b32 v23, v23, v27, s[48:49]
 v_mfma_f32_16x16x16_bf16 v[60:63], v[6:7], v[32:33], 0
 s_waitcnt vmcnt(1)
 v_exp_f32 v20, v20
 v_mfma_f32_16x16x16_bf16 v[52:55], v[6:7], v[2:3], 0
 s_cmp_eq_u32 s36, 63
 v_exp_f32 v21, v21
 v_mfma_f32_16x16x16_bf16 v[56:59], v[6:7], v[4:5], 0
 v_exp_f32 v22, v22
 v_exp_f32 v23, v23
 v_cvt_pk_bf16_f32 v30, v20, v21
 v_cvt_pk_bf16_f32 v31, v22, v23
 v_mov_b64 v[70:71], 0
 v_mov_b64 v[20:21], 0
 v_smfmac_f32_16x16x32_bf16 v[60:63], v[30:31], v[32:35], v5
 v_mov_b64 v[22:23], 0
 v_mov_b64 v[24:25], 0
 v_smfmac_f32_16x16x32_bf16 v[52:55], v[30:31], v[12:15], v5
 v_mov_b64 v[26:27], 0
 v_smfmac_f32_16x16x32_bf16 v[56:59], v[30:31], v[16:19], v5
 s_nop 0
 v_add_f32 v60, v60, v62
 v_add_f32 v61, v61, v63
 v_rcp_f32 v60, v60
 v_rcp_f32 v61, v61
 v_add_f32 v52, v52, v54
 v_add_f32 v53, v53, v55
 v_mul_f32 v52, v52, v60
 v_mul_f32 v53, v53, v61
 v_add_f32 v56, v56, v58
 v_add_f32 v57, v57, v59
 v_mul_f32 v56, v56, v60
 v_mul_f32 v57, v57, v61
 v_cvt_pk_bf16_f32 v52, v52, v56
 v_cvt_pk_bf16_f32 v53, v53, v57
 ds_write2_b32 v8, v52, v53 offset0:128 offset1:144
 v_subrev_u32 v60, 0x21800000, v60
 v_subrev_u32 v61, 0x21800000, v61
 v_max_u32 v60, v60, v61
 v_cmp_lt_u32 vcc, 0x3c000000, v60
 s_cbranch_scc1 Lchexit_51
 v_mov_b64 v[28:29], 0
 v_mov_b64 v[30:31], 0
 v_mov_b64 v[32:33], 0
 v_mov_b64 v[34:35], 0
 s_cbranch_vccnz Lmx_110
Lmxb_111:
 s_waitcnt lgkmcnt(0)
 v_bfe_u32 v6, v0, 7, 5
 s_barrier
 ds_read_b128 v[52:55], v9 offset:19968
 v_mul_u32_u24 v6, 10496, v6
 ds_read_b128 v[56:59], v9 offset:22016
 ds_read_b128 v[12:15], v0 offset:49152
 v_bfe_u32 v60, v3, 4, 3
 ds_read_b128 v[16:19], v0 offset:53248
 s_add_u32 s67, s67, 0x80000
 v_lshl_add_u32 v6, v60, 3, v6
 s_xor_b32 s46, s46, 0x1
 s_add_u32 s59, s59, 0x80000
 v_mov_b64 v[60:61], 0
 s_add_u32 s38, s38, 0x20000
 v_mov_b64 v[62:63], 0
 s_waitcnt lgkmcnt(3)
 v_smfmac_f32_16x16x64_bf16 v[64:67], v[52:55], a[248:255], v5
 buffer_load_dwordx4 v3, s[20:23], s67 offen offset:0 sc1 lds
 v_smfmac_f32_16x16x64_bf16 v[68:71], v[52:55], a[176:183], v5
 s_waitcnt lgkmcnt(2)
 s_cmp_lt_u32 s36, 61
 v_smfmac_f32_16x16x64_bf16 v[64:67], v[56:59], v[36:43], v5
 ds_read_b128 v[36:39], v0 offset:57344
 buffer_load_dwordx4 v3, s[20:23], s67 offen offset:1024 sc1 lds
 v_smfmac_f32_16x16x64_bf16 v[20:23], v[52:55], a[184:191], v5
 ds_read_b128 v[40:43], v0 offset:61440
 s_cselect_b32 s47, 0x80000, 0
 v_add_u32 v0, 0x10000, v0
 v_smfmac_f32_16x16x64_bf16 v[68:71], v[56:59], v[44:51], v5
 ds_read_b128 v[44:47], v0 offset:0
 s_add_u32 s68, s68, s47
 v_add_f32 v64, v64, v66
 v_add_f32 v65, v65, v67
 v_cvt_pk_bf16_f32 v65, v65, v65
 v_smfmac_f32_16x16x64_bf16 v[24:27], v[52:55], a[192:199], v5
 ds_read_b128 v[48:51], v0 offset:4096
 s_waitcnt lgkmcnt(4)
 v_cvt_pk_bf16_f32 v64, v64, v64
 v_and_or_b32 v65, v65, -2, s46
 v_smfmac_f32_16x16x64_bf16 v[20:23], v[56:59], v[12:19], v5
 ds_read_b128 v[12:15], v0 offset:8192
 buffer_store_dwordx2 v[64:65], v6, s[20:23], s62 offen sc1
 v_add_f32 v68, v68, v70
 v_add_f32 v69, v69, v71
 v_smfmac_f32_16x16x64_bf16 v[28:31], v[52:55], a[200:207], v5
 ds_read_b128 v[16:19], v0 offset:12288
 s_waitcnt lgkmcnt(4)
 v_mov_b64 v[64:65], 0
 v_mov_b64 v[66:67], 0
 v_smfmac_f32_16x16x64_bf16 v[24:27], v[56:59], v[36:43], v5
 ds_read_b128 v[36:39], v0 offset:16384
 s_add_u32 s36, s36, 1
 v_add_f32 v20, v20, v22
 v_add_f32 v21, v21, v23
 v_cvt_pk_bf16_f32 v69, v69, v21
 v_smfmac_f32_16x16x64_bf16 v[32:35], v[52:55], a[208:215], v5
 ds_read_b128 v[40:43], v0 offset:20480
 s_waitcnt lgkmcnt(4)
 v_cvt_pk_bf16_f32 v68, v68, v20
 v_and_or_b32 v69, v69, -2, s46
 v_smfmac_f32_16x16x64_bf16 v[28:31], v[56:59], v[44:51], v5
 ds_read_b128 v[44:47], v0 offset:24576
 buffer_store_dwordx2 v[68:69], v6, s[20:23], s60 offen offset:0 sc1
 v_add_f32 v24, v24, v26
 v_add_f32 v25, v25, v27
 v_smfmac_f32_16x16x64_bf16 v[60:63], v[52:55], a[216:223], v5
 ds_read_b128 v[48:51], v0 offset:28672
 s_waitcnt lgkmcnt(4)
 v_mov_b64 v[20:21], 0
 v_mov_b64 v[22:23], 0
 v_smfmac_f32_16x16x64_bf16 v[32:35], v[56:59], v[12:19], v5
 s_add_u32 s58, s36, 2
 s_min_u32 s58, s58, 64
 v_add_f32 v28, v28, v30
 v_add_f32 v29, v29, v31
 v_cvt_pk_bf16_f32 v25, v25, v29
 v_smfmac_f32_16x16x64_bf16 v[64:67], v[52:55], a[224:231], v5
 s_waitcnt lgkmcnt(2)
 s_xor_b32 s44, s44, 0x80000
 v_cvt_pk_bf16_f32 v24, v24, v28
 v_and_or_b32 v25, v25, -2, s46
 v_smfmac_f32_16x16x64_bf16 v[60:63], v[56:59], v[36:43], v5
 buffer_store_dwordx2 v[24:25], v6, s[20:23], s60 offen offset:2048 sc1
 v_add_f32 v32, v32, v34
 v_smfmac_f32_16x16x64_bf16 v[20:23], v[52:55], a[232:239], v5
 s_waitcnt lgkmcnt(0)
 s_xor_b32 s45, s45, 0x80000
 v_add_f32 v33, v33, v35
 v_smfmac_f32_16x16x64_bf16 v[64:67], v[56:59], v[44:51], v5
 s_xor_b32 s65, s65, 0x80000
 s_xor_b32 s66, s66, 0x80000
 v_add_f32 v60, v60, v62
 v_add_f32 v61, v61, v63
 v_smfmac_f32_16x16x64_bf16 v[20:23], v[56:59], a[240:247], v5
 s_cmp_eq_u32 s4, 0
 v_cvt_pk_bf16_f32 v33, v33, v61
 v_cvt_pk_bf16_f32 v32, v32, v60
 v_and_or_b32 v33, v33, -2, s46
 buffer_store_dwordx2 v[32:33], v6, s[20:23], s61 offen offset:0 sc1
 v_add_f32 v64, v64, v66
 v_add_f32 v65, v65, v67
 s_nop 0
 v_add_f32 v20, v20, v22
 v_add_f32 v21, v21, v23
 v_cvt_pk_bf16_f32 v65, v65, v21
 v_cvt_pk_bf16_f32 v64, v64, v20
 v_and_or_b32 v65, v65, -2, s46
 buffer_store_dwordx2 v[64:65], v6, s[20:23], s61 offen offset:2048 sc1
 s_cbranch_scc1 LwH_112
 s_cmp_eq_u32 s4, 1
 s_cbranch_scc1 Lw_113
 s_cmp_eq_u32 s4, 2
 s_cbranch_scc1 Lw_114
 s_xor_b32 s41, s41, 0x80000
 s_xor_b32 s43, s43, 0x80000
 v_mov_b32 v47, 0x3f80
 v_cndmask_b32 v47, v47, 1.0, s[32:33]
 v_cndmask_b32 v44, 0, v47, s[24:25]
 v_cndmask_b32 v45, 0, v47, s[26:27]
 v_cndmask_b32 v46, 0, v47, s[28:29]
 v_cndmask_b32 v47, 0, v47, s[30:31]
 v_bfe_u32 v52, v3, 8, 2
 v_bfe_u32 v58, v3, 2, 4
 v_lshl_or_b32 v52, v52, 4, v58
 v_and_b32 v58, 0xc0, v3
 v_lshl_or_b32 v52, v58, 24, v52
 v_subrev_u32 v0, 0x20000, v0
 v_mov_b32 v59, -1
 v_add_u32 v54, s42, v3
 v_add_u32 v58, s69, v9
 ds_read_b64 v[64:65], v58 offset:19456
 v_mov_b32 v66, v2
 v_mov_b32 v67, v4
 v_mov_b64 v[68:69], 0
 v_mov_b64 v[70:71], 0
 ds_read_b128 v[20:23], v0 offset:24576
 ds_read_b128 v[24:27], v0 offset:28672
 ds_read_b128 v[28:31], v0 offset:32768
 ds_read_b128 v[32:35], v0 offset:36864
 s_waitcnt vmcnt(0)
 buffer_load_dwordx4 v[36:39], v3, s[20:23], s39 offen offset:0 sc1
 buffer_load_dwordx4 v[40:43], v3, s[20:23], s39 offen offset:1024 sc1
 s_nop 15
 s_nop 10
 buffer_load_dwordx4 v[12:15], v3, s[20:23], s39 offen offset:0 sc1
 buffer_load_dwordx4 v[16:19], v3, s[20:23], s39 offen offset:1024 sc1
 s_waitcnt vmcnt(3)
 v_mfma_f32_16x16x32_bf16 v[48:51], v[44:47], v[36:39], 0
 s_waitcnt vmcnt(2)
 v_mfma_f32_16x16x32_bf16 v[48:51], v[44:47], v[40:43], v[48:51]
 v_bitop3_b32 v55, v37, v39, s46 bitop3:0x7e
 v_bitop3_b32 v56, v41, v43, s46 bitop3:0x7e
 v_bitop3_b32 v55, v55, 1, v56 bitop3:0xc8
 v_cmp_ne_u32 vcc, 0, v55
 s_nop 3
 v_add_f32_dpp v48, v48, v48 row_ror:4 row_mask:0xf bank_mask:0xf
 v_add_f32_dpp v49, v49, v49 row_ror:4 row_mask:0xf bank_mask:0xf
 s_cbranch_vccnz Lr2_116
 v_add_f32_dpp v48, v48, v48 row_ror:8 row_mask:0xf bank_mask:0xf
 v_add_f32_dpp v49, v49, v49 row_ror:8 row_mask:0xf bank_mask:0xf
 v_cvt_pk_bf16_f32 v48, v48, v49
 buffer_store_dword v48, v52, s[20:23], s44 offen sc1
Lb1_117:
 buffer_store_dword v59, v52, s[20:23], s45 offen sc1
 v_cmp_gt_u32 vcc, s58, v1
 v_mov_b64 v[36:37], 0
 v_mov_b64 v[38:39], 0
 v_mov_b64 v[40:41], 0
 v_mov_b64 v[42:43], 0
 v_mov_b64 v[44:45], 0
 v_mov_b64 v[46:47], 0
 v_mov_b64 v[48:49], 0
 v_mov_b64 v[50:51], 0
 s_cmp_lg_u32 vcc_hi, 0
 s_cbranch_scc1 Lfw_119
Lfok_118:
 v_lshl_add_u32 v1, v3, 3, s68
 v_mov_b32 v6, s56
 v_cndmask_b32 v1, v6, v1, s[70:71]
 v_mov_b32 v4, v54
 s_waitcnt vmcnt(0)
 s_nop 15
 s_nop 15
 s_nop 11
 s_branch LstepB_106
Lw_114:
 s_xor_b32 s41, s41, 0x80000
 s_xor_b32 s43, s43, 0x80000
 v_mov_b32 v47, 0x3f80
 v_cndmask_b32 v47, v47, 1.0, s[32:33]
 v_cndmask_b32 v44, 0, v47, s[24:25]
 v_cndmask_b32 v45, 0, v47, s[26:27]
 v_cndmask_b32 v46, 0, v47, s[28:29]
 v_cndmask_b32 v47, 0, v47, s[30:31]
 v_bfe_u32 v52, v3, 8, 2
 v_bfe_u32 v58, v3, 2, 4
 v_lshl_or_b32 v52, v52, 4, v58
 v_and_b32 v58, 0xc0, v3
 v_lshl_or_b32 v52, v58, 24, v52
 v_subrev_u32 v0, 0x20000, v0
 v_mov_b32 v59, -1
 v_add_u32 v54, s42, v3
 v_add_u32 v58, s69, v9
 ds_read_b64 v[64:65], v58 offset:19456
 v_mov_b32 v66, v2
 v_mov_b32 v67, v4
 v_mov_b64 v[68:69], 0
 v_mov_b64 v[70:71], 0
 ds_read_b128 v[20:23], v0 offset:24576
 ds_read_b128 v[24:27], v0 offset:28672
 ds_read_b128 v[28:31], v0 offset:32768
 ds_read_b128 v[32:35], v0 offset:36864
 s_waitcnt vmcnt(1)
 buffer_load_dwordx4 v[36:39], v3, s[20:23], s39 offen offset:0 sc1
 buffer_load_dwordx4 v[40:43], v3, s[20:23], s39 offen offset:1024 sc1
 s_nop 15
 s_nop 10
 buffer_load_dwordx4 v[12:15], v3, s[20:23], s39 offen offset:0 sc1
 buffer_load_dwordx4 v[16:19], v3, s[20:23], s39 offen offset:1024 sc1
 s_waitcnt vmcnt(3)
 v_mfma_f32_16x16x32_bf16 v[48:51], v[44:47], v[36:39], 0
 s_waitcnt vmcnt(2)
 v_mfma_f32_16x16x32_bf16 v[48:51], v[44:47], v[40:43], v[48:51]
 v_bitop3_b32 v55, v37, v39, s46 bitop3:0x7e
 v_bitop3_b32 v56, v41, v43, s46 bitop3:0x7e
 v_bitop3_b32 v55, v55, 1, v56 bitop3:0xc8
 v_cmp_ne_u32 vcc, 0, v55
 s_nop 3
 v_add_f32_dpp v48, v48, v48 row_ror:4 row_mask:0xf bank_mask:0xf
 v_add_f32_dpp v49, v49, v49 row_ror:4 row_mask:0xf bank_mask:0xf
 s_cbranch_vccnz Lr2_122
 v_add_f32_dpp v48, v48, v48 row_ror:8 row_mask:0xf bank_mask:0xf
 v_add_f32_dpp v49, v49, v49 row_ror:8 row_mask:0xf bank_mask:0xf
 v_cvt_pk_bf16_f32 v48, v48, v49
 buffer_store_dword v48, v52, s[20:23], s44 offen sc1
Lb1_123:
 buffer_store_dword v59, v52, s[20:23], s45 offen sc1
 v_cmp_gt_u32 vcc, s58, v1
 v_mov_b64 v[36:37], 0
 v_mov_b64 v[38:39], 0
 v_mov_b64 v[40:41], 0
 v_mov_b64 v[42:43], 0
 v_mov_b64 v[44:45], 0
 v_mov_b64 v[46:47], 0
 v_mov_b64 v[48:49], 0
 v_mov_b64 v[50:51], 0
 s_cmp_lg_u32 vcc_hi, 0
 s_cbranch_scc1 Lfw_125
Lfok_124:
 v_lshl_add_u32 v1, v3, 3, s68
 v_mov_b32 v6, s56
 v_cndmask_b32 v1, v6, v1, s[70:71]
 v_mov_b32 v4, v54
 s_nop 7
 buffer_load_dwordx4 v[68:71], v3, s[20:23], s43 offen offset:0 sc1
 s_nop 15
 s_nop 7
Lp2_126:
 buffer_load_dwordx4 v[68:71], v3, s[20:23], s43 offen offset:0 sc1
 s_waitcnt vmcnt(1)
 v_max3_u32 v55, v68, v69, v70
 v_max_u32 v55, v55, v71
 ds_write_b128 v3, v[68:71] offset:8192
 v_cmpx_eq_u32 vcc, -1, v55
 s_cbranch_execz LstepB_106
 buffer_load_dwordx4 v[68:71], v3, s[20:23], s43 offen offset:0 sc1
 s_waitcnt vmcnt(1)
 v_max3_u32 v55, v68, v69, v70
 v_max_u32 v55, v55, v71
 ds_write_b128 v3, v[68:71] offset:8192
 v_cmpx_eq_u32 vcc, -1, v55
 s_cbranch_execz LstepB_106
 buffer_load_dwordx4 v[68:71], v3, s[20:23], s43 offen offset:0 sc1
 s_waitcnt vmcnt(1)
 v_max3_u32 v55, v68, v69, v70
 v_max_u32 v55, v55, v71
 ds_write_b128 v3, v[68:71] offset:8192
 v_cmpx_eq_u32 vcc, -1, v55
 s_cbranch_execz LstepB_106
 s_sub_u32 s54, s54, 1
 s_cbranch_scc0 Lp2_126
 s_endpgm
Lw_113:
 s_waitcnt vmcnt(2)
 buffer_load_dwordx4 v[36:39], v3, s[20:23], s39 offen offset:0 sc1
 buffer_load_dwordx4 v[40:43], v3, s[20:23], s39 offen offset:1024 sc1
 s_xor_b32 s41, s41, 0x80000
 s_xor_b32 s43, s43, 0x80000
 v_mov_b32 v47, 0x3f80
 v_cndmask_b32 v47, v47, 1.0, s[32:33]
 v_cndmask_b32 v44, 0, v47, s[24:25]
 v_cndmask_b32 v45, 0, v47, s[26:27]
 v_cndmask_b32 v46, 0, v47, s[28:29]
 v_cndmask_b32 v47, 0, v47, s[30:31]
 v_bfe_u32 v52, v3, 8, 2
 v_bfe_u32 v58, v3, 2, 4
 v_lshl_or_b32 v52, v52, 4, v58
 v_and_b32 v58, 0xc0, v3
 v_lshl_or_b32 v52, v58, 24, v52
 v_subrev_u32 v0, 0x20000, v0
 v_mov_b32 v59, -1
 v_add_u32 v54, s42, v3
 v_add_u32 v58, s69, v9
 ds_read_b64 v[64:65], v58 offset:19456
 v_mov_b32 v66, v2
 v_mov_b32 v67, v4
 v_mov_b64 v[68:69], 0
 v_mov_b64 v[70:71], 0
 ds_read_b128 v[20:23], v0 offset:24576
 ds_read_b128 v[24:27], v0 offset:28672
 ds_read_b128 v[28:31], v0 offset:32768
 ds_read_b128 v[32:35], v0 offset:36864
 s_nop 3
 buffer_load_dwordx4 v[12:15], v3, s[20:23], s39 offen offset:0 sc1
 buffer_load_dwordx4 v[16:19], v3, s[20:23], s39 offen offset:1024 sc1
 s_waitcnt vmcnt(3)
 v_mfma_f32_16x16x32_bf16 v[48:51], v[44:47], v[36:39], 0
 s_waitcnt vmcnt(2)
 v_mfma_f32_16x16x32_bf16 v[48:51], v[44:47], v[40:43], v[48:51]
 v_bitop3_b32 v55, v37, v39, s46 bitop3:0x7e
 v_bitop3_b32 v56, v41, v43, s46 bitop3:0x7e
 v_bitop3_b32 v55, v55, 1, v56 bitop3:0xc8
 v_cmp_ne_u32 vcc, 0, v55
 s_nop 3
 v_add_f32_dpp v48, v48, v48 row_ror:4 row_mask:0xf bank_mask:0xf
 v_add_f32_dpp v49, v49, v49 row_ror:4 row_mask:0xf bank_mask:0xf
 s_cbranch_vccnz Lr2_128
 v_add_f32_dpp v48, v48, v48 row_ror:8 row_mask:0xf bank_mask:0xf
 v_add_f32_dpp v49, v49, v49 row_ror:8 row_mask:0xf bank_mask:0xf
 v_cvt_pk_bf16_f32 v48, v48, v49
 buffer_store_dword v48, v52, s[20:23], s44 offen sc1
Lb1_129:
 buffer_store_dword v59, v52, s[20:23], s45 offen sc1
 v_cmp_gt_u32 vcc, s58, v1
 v_mov_b64 v[36:37], 0
 v_mov_b64 v[38:39], 0
 v_mov_b64 v[40:41], 0
 v_mov_b64 v[42:43], 0
 v_mov_b64 v[44:45], 0
 v_mov_b64 v[46:47], 0
 v_mov_b64 v[48:49], 0
 v_mov_b64 v[50:51], 0
 s_cmp_lg_u32 vcc_hi, 0
 s_cbranch_scc1 Lfw_131
Lfok_130:
 v_lshl_add_u32 v1, v3, 3, s68
 v_mov_b32 v6, s56
 v_cndmask_b32 v1, v6, v1, s[70:71]
 v_min_u32 v6, 16, v0
 v_lshlrev_b32 v6, 24, v6
 s_max_u32 s47, s36, 1
 v_add_u32 v2, -1, s47
 s_nop 15
 s_nop 0
 buffer_load_dwordx4 v[12:15], v3, s[20:23], s41 offen offset:0 sc1
 buffer_load_dwordx4 v[16:19], v3, s[20:23], s41 offen offset:1024 sc1
 s_nop 15
 s_nop 7
Lp2_132:
 buffer_load_dwordx4 v[12:15], v3, s[20:23], s41 offen offset:0 sc1
 buffer_load_dwordx4 v[16:19], v3, s[20:23], s41 offen offset:1024 sc1
 s_waitcnt vmcnt(2)
 v_max3_u32 v55, v12, v13, v14
 v_max3_u32 v55, v55, v15, v16
 v_max3_u32 v55, v55, v17, v18
 v_max_u32 v55, v55, v19
 ds_write_b128 v54, v[12:15] offset:0
 ds_write_b128 v54, v[16:19] offset:1024
 v_cmpx_eq_u32 vcc, -1, v55
 s_cbranch_execz Lstep_104
 buffer_load_dwordx4 v[12:15], v3, s[20:23], s41 offen offset:0 sc1
 buffer_load_dwordx4 v[16:19], v3, s[20:23], s41 offen offset:1024 sc1
 s_waitcnt vmcnt(2)
 v_max3_u32 v55, v12, v13, v14
 v_max3_u32 v55, v55, v15, v16
 v_max3_u32 v55, v55, v17, v18
 v_max_u32 v55, v55, v19
 ds_write_b128 v54, v[12:15] offset:0
 ds_write_b128 v54, v[16:19] offset:1024
 v_cmpx_eq_u32 vcc, -1, v55
 s_cbranch_execz Lstep_104
 buffer_load_dwordx4 v[12:15], v3, s[20:23], s41 offen offset:0 sc1
 buffer_load_dwordx4 v[16:19], v3, s[20:23], s41 offen offset:1024 sc1
 s_waitcnt vmcnt(2)
 v_max3_u32 v55, v12, v13, v14
 v_max3_u32 v55, v55, v15, v16
 v_max3_u32 v55, v55, v17, v18
 v_max_u32 v55, v55, v19
 ds_write_b128 v54, v[12:15] offset:0
 ds_write_b128 v54, v[16:19] offset:1024
 v_cmpx_eq_u32 vcc, -1, v55
 s_cbranch_execz Lstep_104
 s_sub_u32 s54, s54, 1
 s_cbranch_scc0 Lp2_132
 s_endpgm
LwH_112:
 v_bfe_u32 v53, v3, 8, 1
 v_bfe_u32 v58, v3, 9, 1
 v_lshl_or_b32 v53, v53, 1, v58
 v_bfe_u32 v58, v3, 5, 1
 v_lshl_or_b32 v53, v53, 1, v58
 v_and_b32 v58, 0xd0, v3
 v_lshlrev_b32 v58, 24, v58
 v_lshl_or_b32 v53, v53, 2, v58
 s_waitcnt vmcnt(3)
 s_nop 7
 buffer_load_dwordx4 v[20:23], v3, s[20:23], s40 offen offset:0 sc1
 buffer_load_dwordx4 v[24:27], v3, s[20:23], s40 offen offset:1024 sc1
 buffer_load_dwordx4 v[36:39], v3, s[20:23], s39 offen offset:0 sc1
 buffer_load_dwordx4 v[40:43], v3, s[20:23], s39 offen offset:1024 sc1
 s_xor_b32 s41, s41, 0x80000
 s_xor_b32 s43, s43, 0x80000
 v_mov_b32 v47, 0x3f80
 v_cndmask_b32 v47, v47, 1.0, s[32:33]
 v_cndmask_b32 v44, 0, v47, s[24:25]
 v_cndmask_b32 v45, 0, v47, s[26:27]
 v_cndmask_b32 v46, 0, v47, s[28:29]
 v_cndmask_b32 v47, 0, v47, s[30:31]
 v_bfe_u32 v52, v3, 8, 2
 v_bfe_u32 v58, v3, 2, 4
 v_lshl_or_b32 v52, v52, 4, v58
 v_and_b32 v58, 0xc0, v3
 v_lshl_or_b32 v52, v58, 24, v52
 v_subrev_u32 v0, 0x20000, v0
 v_mov_b32 v59, -1
 v_add_u32 v54, s42, v3
 v_add_u32 v58, s69, v9
 ds_read_b64 v[64:65], v58 offset:19456
 v_mov_b32 v66, v2
 v_mov_b32 v67, v4
 v_mov_b64 v[68:69], 0
 v_mov_b64 v[70:71], 0
 s_waitcnt vmcnt(2)
 v_mfma_f32_16x16x32_bf16 v[28:31], v[44:47], v[20:23], 0
 v_mfma_f32_16x16x32_bf16 v[28:31], v[44:47], v[24:27], v[28:31]
 s_waitcnt vmcnt(1)
 v_mfma_f32_16x16x32_bf16 v[48:51], v[44:47], v[36:39], 0
 s_waitcnt vmcnt(0)
 v_mfma_f32_16x16x32_bf16 v[48:51], v[44:47], v[40:43], v[48:51]
 v_bitop3_b32 v55, v37, v39, s46 bitop3:0x7e
 v_bitop3_b32 v56, v41, v43, s46 bitop3:0x7e
 v_bitop3_b32 v57, v21, v23, s46 bitop3:0x7e
 v_or3_b32 v55, v55, v56, v57
 v_bitop3_b32 v56, v25, v27, s46 bitop3:0x7e
 v_bitop3_b32 v55, v55, 1, v56 bitop3:0xc8
 v_cmp_ne_u32 vcc, 0, v55
 v_add_f32_dpp v29, v29, v29 row_ror:4 row_mask:0xf bank_mask:0xf
 v_add_f32_dpp v48, v48, v48 row_ror:4 row_mask:0xf bank_mask:0xf
 v_add_f32_dpp v49, v49, v49 row_ror:4 row_mask:0xf bank_mask:0xf
 v_add_f32_dpp v29, v29, v29 row_ror:8 row_mask:0xf bank_mask:0xf
 v_add_f32_dpp v48, v48, v48 row_ror:8 row_mask:0xf bank_mask:0xf
 v_add_f32_dpp v49, v49, v49 row_ror:8 row_mask:0xf bank_mask:0xf
 s_cbranch_vccnz Lr1_133
 v_cvt_pk_bf16_f32 v48, v48, v49
 buffer_store_dword v48, v52, s[20:23], s44 offen sc1
 v_mov_b32_dpp v30, v29 quad_perm:[1,0,3,2] row_mask:0xf bank_mask:0xf
 v_cvt_pk_bf16_f32 v29, v29, v30
 buffer_store_dword v29, v53, s[20:23], s65 offen sc1
Lb1_134:
 buffer_store_dword v59, v52, s[20:23], s45 offen sc1
 buffer_store_dword v59, v53, s[20:23], s66 offen sc1
 v_cmp_gt_u32 vcc, s58, v1
 ds_read_b128 v[20:23], v0 offset:24576
 ds_read_b128 v[24:27], v0 offset:28672
 ds_read_b128 v[28:31], v0 offset:32768
 ds_read_b128 v[32:35], v0 offset:36864
 v_mov_b64 v[36:37], 0
 v_mov_b64 v[38:39], 0
 v_mov_b64 v[40:41], 0
 v_mov_b64 v[42:43], 0
 v_mov_b64 v[44:45], 0
 v_mov_b64 v[46:47], 0
 v_mov_b64 v[48:49], 0
 v_mov_b64 v[50:51], 0
 s_cmp_lg_u32 vcc_hi, 0
 s_cbranch_scc1 Lfw_136
Lfok_135:
 v_lshl_add_u32 v1, v3, 3, s68
 v_mov_b32 v6, s56
 v_cndmask_b32 v1, v6, v1, s[70:71]
 v_min_u32 v6, 16, v0
 v_lshlrev_b32 v6, 24, v6
 s_max_u32 s47, s36, 1
 v_add_u32 v2, -1, s47
 s_nop 10
 buffer_load_dwordx4 v[12:15], v3, s[20:23], s41 offen offset:0 sc1
 buffer_load_dwordx4 v[16:19], v3, s[20:23], s41 offen offset:1024 sc1
 s_nop 15
 s_nop 7
Lp2_137:
 buffer_load_dwordx4 v[12:15], v3, s[20:23], s41 offen offset:0 sc1
 buffer_load_dwordx4 v[16:19], v3, s[20:23], s41 offen offset:1024 sc1
 s_waitcnt vmcnt(2)
 v_max3_u32 v55, v12, v13, v14
 v_max3_u32 v55, v55, v15, v16
 v_max3_u32 v55, v55, v17, v18
 v_max_u32 v55, v55, v19
 ds_write_b128 v54, v[12:15] offset:0
 ds_write_b128 v54, v[16:19] offset:1024
 v_cmpx_eq_u32 vcc, -1, v55
 s_cbranch_execz Lstep_104
 buffer_load_dwordx4 v[12:15], v3, s[20:23], s41 offen offset:0 sc1
 buffer_load_dwordx4 v[16:19], v3, s[20:23], s41 offen offset:1024 sc1
 s_waitcnt vmcnt(2)
 v_max3_u32 v55, v12, v13, v14
 v_max3_u32 v55, v55, v15, v16
 v_max3_u32 v55, v55, v17, v18
 v_max_u32 v55, v55, v19
 ds_write_b128 v54, v[12:15] offset:0
 ds_write_b128 v54, v[16:19] offset:1024
 v_cmpx_eq_u32 vcc, -1, v55
 s_cbranch_execz Lstep_104
 buffer_load_dwordx4 v[12:15], v3, s[20:23], s41 offen offset:0 sc1
 buffer_load_dwordx4 v[16:19], v3, s[20:23], s41 offen offset:1024 sc1
 s_waitcnt vmcnt(2)
 v_max3_u32 v55, v12, v13, v14
 v_max3_u32 v55, v55, v15, v16
 v_max3_u32 v55, v55, v17, v18
 v_max_u32 v55, v55, v19
 ds_write_b128 v54, v[12:15] offset:0
 ds_write_b128 v54, v[16:19] offset:1024
 v_cmpx_eq_u32 vcc, -1, v55
 s_cbranch_execz Lstep_104
 s_sub_u32 s54, s54, 1
 s_cbranch_scc0 Lp2_137
 s_endpgm
Lr1_133:
 s_mov_b64 exec, vcc
Lrt_138:
 buffer_load_dwordx4 v[20:23], v3, s[20:23], s40 offen offset:0 sc1
 buffer_load_dwordx4 v[24:27], v3, s[20:23], s40 offen offset:1024 sc1
 buffer_load_dwordx4 v[36:39], v3, s[20:23], s39 offen offset:0 sc1
 buffer_load_dwordx4 v[40:43], v3, s[20:23], s39 offen offset:1024 sc1
 s_waitcnt vmcnt(4)
 v_bitop3_b32 v55, v37, v39, s46 bitop3:0x7e
 v_bitop3_b32 v56, v41, v43, s46 bitop3:0x7e
 v_bitop3_b32 v57, v21, v23, s46 bitop3:0x7e
 v_or3_b32 v55, v55, v56, v57
 v_bitop3_b32 v56, v25, v27, s46 bitop3:0x7e
 v_bitop3_b32 v55, v55, 1, v56 bitop3:0xc8
 v_cmpx_ne_u32 vcc, 0, v55
 s_cbranch_execz Lrte_139
 buffer_load_dwordx4 v[20:23], v3, s[20:23], s40 offen offset:0 sc1
 buffer_load_dwordx4 v[24:27], v3, s[20:23], s40 offen offset:1024 sc1
 buffer_load_dwordx4 v[36:39], v3, s[20:23], s39 offen offset:0 sc1
 buffer_load_dwordx4 v[40:43], v3, s[20:23], s39 offen offset:1024 sc1
 s_waitcnt vmcnt(4)
 v_bitop3_b32 v55, v37, v39, s46 bitop3:0x7e
 v_bitop3_b32 v56, v41, v43, s46 bitop3:0x7e
 v_bitop3_b32 v57, v21, v23, s46 bitop3:0x7e
 v_or3_b32 v55, v55, v56, v57
 v_bitop3_b32 v56, v25, v27, s46 bitop3:0x7e
 v_bitop3_b32 v55, v55, 1, v56 bitop3:0xc8
 v_cmpx_ne_u32 vcc, 0, v55
 s_cbranch_execz Lrte_139
 buffer_load_dwordx4 v[20:23], v3, s[20:23], s40 offen offset:0 sc1
 buffer_load_dwordx4 v[24:27], v3, s[20:23], s40 offen offset:1024 sc1
 buffer_load_dwordx4 v[36:39], v3, s[20:23], s39 offen offset:0 sc1
 buffer_load_dwordx4 v[40:43], v3, s[20:23], s39 offen offset:1024 sc1
 s_waitcnt vmcnt(4)
 v_bitop3_b32 v55, v37, v39, s46 bitop3:0x7e
 v_bitop3_b32 v56, v41, v43, s46 bitop3:0x7e
 v_bitop3_b32 v57, v21, v23, s46 bitop3:0x7e
 v_or3_b32 v55, v55, v56, v57
 v_bitop3_b32 v56, v25, v27, s46 bitop3:0x7e
 v_bitop3_b32 v55, v55, 1, v56 bitop3:0xc8
 v_cmpx_ne_u32 vcc, 0, v55
 s_cbranch_execz Lrte_139
 s_sub_u32 s54, s54, 1
 s_cbranch_scc0 Lrt_138
 s_endpgm
Lrte_139:
 s_mov_b64 exec, -1
 s_nop 2
 v_mfma_f32_16x16x32_bf16 v[28:31], v[44:47], v[20:23], 0
 v_mfma_f32_16x16x32_bf16 v[28:31], v[44:47], v[24:27], v[28:31]
 v_mfma_f32_16x16x32_bf16 v[48:51], v[44:47], v[36:39], 0
 v_mfma_f32_16x16x32_bf16 v[48:51], v[44:47], v[40:43], v[48:51]
 s_nop 6
 v_add_f32_dpp v29, v29, v29 row_ror:4 row_mask:0xf bank_mask:0xf
 v_add_f32_dpp v48, v48, v48 row_ror:4 row_mask:0xf bank_mask:0xf
 v_add_f32_dpp v49, v49, v49 row_ror:4 row_mask:0xf bank_mask:0xf
 v_add_f32_dpp v29, v29, v29 row_ror:8 row_mask:0xf bank_mask:0xf
 v_add_f32_dpp v48, v48, v48 row_ror:8 row_mask:0xf bank_mask:0xf
 v_add_f32_dpp v49, v49, v49 row_ror:8 row_mask:0xf bank_mask:0xf
 v_cvt_pk_bf16_f32 v48, v48, v49
 buffer_store_dword v48, v52, s[20:23], s44 offen sc1
 v_mov_b32_dpp v30, v29 quad_perm:[1,0,3,2] row_mask:0xf bank_mask:0xf
 v_cvt_pk_bf16_f32 v29, v29, v30
 buffer_store_dword v29, v53, s[20:23], s65 offen sc1
 s_waitcnt vmcnt(2)
 s_branch Lb1_134
Lyr_108:
 s_mov_b64 exec, vcc
Lrt_140:
 buffer_load_dwordx4 v[12:15], v3, s[20:23], s41 offen offset:0 sc1
 buffer_load_dwordx4 v[16:19], v3, s[20:23], s41 offen offset:1024 sc1
 s_waitcnt vmcnt(2)
 v_max3_u32 v2, v12, v13, v14
 v_max3_u32 v2, v2, v15, v16
 v_max3_u32 v2, v2, v17, v18
 v_max_u32 v2, v2, v19
 v_cmpx_eq_u32 vcc, -1, v2
 s_cbranch_execz Lrte_141
 buffer_load_dwordx4 v[12:15], v3, s[20:23], s41 offen offset:0 sc1
 buffer_load_dwordx4 v[16:19], v3, s[20:23], s41 offen offset:1024 sc1
 s_waitcnt vmcnt(2)
 v_max3_u32 v2, v12, v13, v14
 v_max3_u32 v2, v2, v15, v16
 v_max3_u32 v2, v2, v17, v18
 v_max_u32 v2, v2, v19
 v_cmpx_eq_u32 vcc, -1, v2
 s_cbranch_execz Lrte_141
 buffer_load_dwordx4 v[12:15], v3, s[20:23], s41 offen offset:0 sc1
 buffer_load_dwordx4 v[16:19], v3, s[20:23], s41 offen offset:1024 sc1
 s_waitcnt vmcnt(2)
 v_max3_u32 v2, v12, v13, v14
 v_max3_u32 v2, v2, v15, v16
 v_max3_u32 v2, v2, v17, v18
 v_max_u32 v2, v2, v19
 v_cmpx_eq_u32 vcc, -1, v2
 s_cbranch_execz Lrte_141
 s_sub_u32 s54, s54, 1
 s_cbranch_scc0 Lrt_140
 s_endpgm
Lrte_141:
 s_mov_b64 exec, -1
 ds_write_b128 v4, v[12:15] offset:0
 ds_write_b128 v4, v[16:19] offset:1024
 s_waitcnt lgkmcnt(0)
 s_branch Lyb_109
Lmx_110:
 s_waitcnt lgkmcnt(0)
 ds_read_b128 v[36:39], v11 offset:17408
 ds_read_b128 v[40:43], v11 offset:17920
 ds_read_b128 v[44:47], v11 offset:18432
 ds_read_b128 v[48:51], v11 offset:18944
 v_mov_b64 v[28:29], 0
 v_mov_b64 v[30:31], 0
 ds_read_b128 v[52:55], v3 offset:9216
 ds_read_b128 v[56:59], v3 offset:10240
 s_waitcnt lgkmcnt(0)
 v_mfma_f32_16x16x32_bf16 v[20:23], v[52:55], v[36:39], 0
 v_mfma_f32_16x16x32_bf16 v[24:27], v[56:59], v[36:39], 0
 ds_read_b128 v[52:55], v3 offset:11264
 ds_read_b128 v[56:59], v3 offset:12288
 s_waitcnt lgkmcnt(0)
 v_mfma_f32_16x16x32_bf16 v[20:23], v[52:55], v[40:43], v[20:23]
 v_mfma_f32_16x16x32_bf16 v[24:27], v[56:59], v[40:43], v[24:27]
 ds_read_b128 v[52:55], v3 offset:13312
 ds_read_b128 v[56:59], v3 offset:14336
 s_waitcnt lgkmcnt(0)
 v_mfma_f32_16x16x32_bf16 v[20:23], v[52:55], v[44:47], v[20:23]
 v_mfma_f32_16x16x32_bf16 v[24:27], v[56:59], v[44:47], v[24:27]
 ds_read_b128 v[52:55], v3 offset:15360
 ds_read_b128 v[56:59], v3 offset:16384
 s_waitcnt lgkmcnt(0)
 v_mfma_f32_16x16x32_bf16 v[20:23], v[52:55], v[48:51], v[20:23]
 v_mfma_f32_16x16x32_bf16 v[24:27], v[56:59], v[48:51], v[24:27]
 ds_read_b128 v[52:55], v9 offset:19456
 ds_read_b128 v[56:59], v9 offset:21504
 s_waitcnt lgkmcnt(0)
 v_smfmac_f32_16x16x64_bf16 v[28:31], v[52:55], v[36:43], v5
 v_smfmac_f32_16x16x64_bf16 v[28:31], v[56:59], v[44:51], v5
 ds_read_b128 v[36:39], v0 offset:32768
 ds_read_b128 v[40:43], v0 offset:36864
 ds_read_b128 v[44:47], v0 offset:40960
 ds_read_b128 v[48:51], v0 offset:45056
 v_mov_b64 v[32:33], s[34:35]
 v_mov_b64 v[34:35], s[34:35]
 s_nop 1
 v_add_f32 v28, v28, v30
 v_add_f32 v29, v29, v31
 v_mul_f32 v28, s55, v28
 v_mul_f32 v29, s55, v29
 v_max_f32 v30, v28, v29
 v_cndmask_b32 v28, v28, v29, s[48:49]
 v_max3_f32 v30, v30, v20, v21
 v_max3_f32 v30, v30, v22, v23
 v_max3_f32 v30, v30, v24, v25
 v_max3_f32 v31, v30, v26, v27
 v_max3_f32 v29, v30, v26, v27
 v_cndmask_b32 v20, v20, v24, s[48:49]
 v_cndmask_b32 v21, v21, v25, s[48:49]
 v_permlane16_swap_b32 v31, v29
 v_max_f32 v30, v31, v29
 v_max_f32 v6, v31, v29
 v_cndmask_b32 v22, v22, v26, s[48:49]
 v_cndmask_b32 v23, v23, v27, s[48:49]
 v_permlane32_swap_b32 v30, v6
 v_max_f32 v30, v30, v6
 v_sub_f32 v28, v28, v30
 v_sub_f32 v20, v20, v30
 v_sub_f32 v21, v21, v30
 v_sub_f32 v22, v22, v30
 v_sub_f32 v23, v23, v30
 v_exp_f32 v28, v28
 v_exp_f32 v20, v20
 v_exp_f32 v21, v21
 v_exp_f32 v22, v22
 v_exp_f32 v23, v23
 v_cndmask_b32 v29, 0, v28, s[48:49]
 v_cndmask_b32 v28, v28, 0, s[48:49]
 v_cvt_pk_bf16_f32 v6, v28, v29
 v_cvt_pk_bf16_f32 v30, v20, v21
 v_cvt_pk_bf16_f32 v31, v22, v23
 v_mfma_f32_16x16x16_bf16 v[60:63], v[6:7], v[32:33], 0
 v_mfma_f32_16x16x16_bf16 v[52:55], v[6:7], v[2:3], 0
 v_mfma_f32_16x16x16_bf16 v[56:59], v[6:7], v[4:5], 0
 v_smfmac_f32_16x16x32_bf16 v[60:63], v[30:31], v[32:35], v5
 v_smfmac_f32_16x16x32_bf16 v[52:55], v[30:31], v[12:15], v5
 v_smfmac_f32_16x16x32_bf16 v[56:59], v[30:31], v[16:19], v5
 s_nop 0
 v_add_f32 v60, v60, v62
 v_add_f32 v61, v61, v63
 v_rcp_f32 v60, v60
 v_rcp_f32 v61, v61
 v_add_f32 v52, v52, v54
 v_add_f32 v53, v53, v55
 v_mul_f32 v52, v52, v60
 v_mul_f32 v53, v53, v61
 v_add_f32 v56, v56, v58
 v_add_f32 v57, v57, v59
 v_mul_f32 v56, v56, v60
 v_mul_f32 v57, v57, v61
 v_cvt_pk_bf16_f32 v52, v52, v56
 v_cvt_pk_bf16_f32 v53, v53, v57
 ds_write2_b32 v8, v52, v53 offset0:128 offset1:144
 v_mov_b64 v[20:21], 0
 v_mov_b64 v[22:23], 0
 v_mov_b64 v[24:25], 0
 v_mov_b64 v[26:27], 0
 v_mov_b64 v[28:29], 0
 v_mov_b64 v[30:31], 0
 v_mov_b64 v[32:33], 0
 v_mov_b64 v[34:35], 0
 s_waitcnt lgkmcnt(0)
 s_branch Lmxb_111
Lr2_116:
 s_waitcnt vmcnt(1)
 v_mfma_f32_16x16x32_bf16 v[48:51], v[44:47], v[12:15], 0
 s_waitcnt vmcnt(0)
 v_mfma_f32_16x16x32_bf16 v[48:51], v[44:47], v[16:19], v[48:51]
 v_bitop3_b32 v55, v13, v15, s46 bitop3:0x7e
 v_bitop3_b32 v56, v17, v19, s46 bitop3:0x7e
 v_bitop3_b32 v55, v55, 1, v56 bitop3:0xc8
 v_cmp_ne_u32 vcc, 0, v55
 s_nop 3
 v_add_f32_dpp v48, v48, v48 row_ror:4 row_mask:0xf bank_mask:0xf
 v_add_f32_dpp v49, v49, v49 row_ror:4 row_mask:0xf bank_mask:0xf
 s_cbranch_vccnz Lr1_115
 v_add_f32_dpp v48, v48, v48 row_ror:8 row_mask:0xf bank_mask:0xf
 v_add_f32_dpp v49, v49, v49 row_ror:8 row_mask:0xf bank_mask:0xf
 v_cvt_pk_bf16_f32 v48, v48, v49
 buffer_store_dword v48, v52, s[20:23], s44 offen sc1
 s_branch Lb1_117
Lr1_115:
 s_mov_b64 exec, vcc
Lrt_142:
 buffer_load_dwordx4 v[12:15], v3, s[20:23], s39 offen offset:0 sc1
 buffer_load_dwordx4 v[16:19], v3, s[20:23], s39 offen offset:1024 sc1
 s_waitcnt vmcnt(2)
 v_bitop3_b32 v55, v13, v15, s46 bitop3:0x7e
 v_bitop3_b32 v56, v17, v19, s46 bitop3:0x7e
 v_bitop3_b32 v55, v55, 1, v56 bitop3:0xc8
 v_cmpx_ne_u32 vcc, 0, v55
 s_cbranch_execz Lrte_143
 buffer_load_dwordx4 v[12:15], v3, s[20:23], s39 offen offset:0 sc1
 buffer_load_dwordx4 v[16:19], v3, s[20:23], s39 offen offset:1024 sc1
 s_waitcnt vmcnt(2)
 v_bitop3_b32 v55, v13, v15, s46 bitop3:0x7e
 v_bitop3_b32 v56, v17, v19, s46 bitop3:0x7e
 v_bitop3_b32 v55, v55, 1, v56 bitop3:0xc8
 v_cmpx_ne_u32 vcc, 0, v55
 s_cbranch_execz Lrte_143
 buffer_load_dwordx4 v[12:15], v3, s[20:23], s39 offen offset:0 sc1
 buffer_load_dwordx4 v[16:19], v3, s[20:23], s39 offen offset:1024 sc1
 s_waitcnt vmcnt(2)
 v_bitop3_b32 v55, v13, v15, s46 bitop3:0x7e
 v_bitop3_b32 v56, v17, v19, s46 bitop3:0x7e
 v_bitop3_b32 v55, v55, 1, v56 bitop3:0xc8
 v_cmpx_ne_u32 vcc, 0, v55
 s_cbranch_execz Lrte_143
 s_sub_u32 s54, s54, 1
 s_cbranch_scc0 Lrt_142
 s_endpgm
Lrte_143:
 s_mov_b64 exec, -1
 s_nop 2
 v_mfma_f32_16x16x32_bf16 v[48:51], v[44:47], v[12:15], 0
 v_mfma_f32_16x16x32_bf16 v[48:51], v[44:47], v[16:19], v[48:51]
 s_nop 7
 v_add_f32_dpp v48, v48, v48 row_ror:4 row_mask:0xf bank_mask:0xf
 v_add_f32_dpp v49, v49, v49 row_ror:4 row_mask:0xf bank_mask:0xf
 s_nop 0
 v_add_f32_dpp v48, v48, v48 row_ror:8 row_mask:0xf bank_mask:0xf
 v_add_f32_dpp v49, v49, v49 row_ror:8 row_mask:0xf bank_mask:0xf
 v_cvt_pk_bf16_f32 v48, v48, v49
 buffer_store_dword v48, v52, s[20:23], s44 offen sc1
 s_branch Lb1_117
Lr2_122:
 s_waitcnt vmcnt(1)
 v_mfma_f32_16x16x32_bf16 v[48:51], v[44:47], v[12:15], 0
 s_waitcnt vmcnt(0)
 v_mfma_f32_16x16x32_bf16 v[48:51], v[44:47], v[16:19], v[48:51]
 v_bitop3_b32 v55, v13, v15, s46 bitop3:0x7e
 v_bitop3_b32 v56, v17, v19, s46 bitop3:0x7e
 v_bitop3_b32 v55, v55, 1, v56 bitop3:0xc8
 v_cmp_ne_u32 vcc, 0, v55
 s_nop 3
 v_add_f32_dpp v48, v48, v48 row_ror:4 row_mask:0xf bank_mask:0xf
 v_add_f32_dpp v49, v49, v49 row_ror:4 row_mask:0xf bank_mask:0xf
 s_cbranch_vccnz Lr1_121
 v_add_f32_dpp v48, v48, v48 row_ror:8 row_mask:0xf bank_mask:0xf
 v_add_f32_dpp v49, v49, v49 row_ror:8 row_mask:0xf bank_mask:0xf
 v_cvt_pk_bf16_f32 v48, v48, v49
 buffer_store_dword v48, v52, s[20:23], s44 offen sc1
 s_branch Lb1_123
Lr1_121:
 s_mov_b64 exec, vcc
Lrt_144:
 buffer_load_dwordx4 v[12:15], v3, s[20:23], s39 offen offset:0 sc1
 buffer_load_dwordx4 v[16:19], v3, s[20:23], s39 offen offset:1024 sc1
 s_waitcnt vmcnt(2)
 v_bitop3_b32 v55, v13, v15, s46 bitop3:0x7e
 v_bitop3_b32 v56, v17, v19, s46 bitop3:0x7e
 v_bitop3_b32 v55, v55, 1, v56 bitop3:0xc8
 v_cmpx_ne_u32 vcc, 0, v55
 s_cbranch_execz Lrte_145
 buffer_load_dwordx4 v[12:15], v3, s[20:23], s39 offen offset:0 sc1
 buffer_load_dwordx4 v[16:19], v3, s[20:23], s39 offen offset:1024 sc1
 s_waitcnt vmcnt(2)
 v_bitop3_b32 v55, v13, v15, s46 bitop3:0x7e
 v_bitop3_b32 v56, v17, v19, s46 bitop3:0x7e
 v_bitop3_b32 v55, v55, 1, v56 bitop3:0xc8
 v_cmpx_ne_u32 vcc, 0, v55
 s_cbranch_execz Lrte_145
 buffer_load_dwordx4 v[12:15], v3, s[20:23], s39 offen offset:0 sc1
 buffer_load_dwordx4 v[16:19], v3, s[20:23], s39 offen offset:1024 sc1
 s_waitcnt vmcnt(2)
 v_bitop3_b32 v55, v13, v15, s46 bitop3:0x7e
 v_bitop3_b32 v56, v17, v19, s46 bitop3:0x7e
 v_bitop3_b32 v55, v55, 1, v56 bitop3:0xc8
 v_cmpx_ne_u32 vcc, 0, v55
 s_cbranch_execz Lrte_145
 s_sub_u32 s54, s54, 1
 s_cbranch_scc0 Lrt_144
 s_endpgm
Lrte_145:
 s_mov_b64 exec, -1
 s_nop 2
 v_mfma_f32_16x16x32_bf16 v[48:51], v[44:47], v[12:15], 0
 v_mfma_f32_16x16x32_bf16 v[48:51], v[44:47], v[16:19], v[48:51]
 s_nop 7
 v_add_f32_dpp v48, v48, v48 row_ror:4 row_mask:0xf bank_mask:0xf
 v_add_f32_dpp v49, v49, v49 row_ror:4 row_mask:0xf bank_mask:0xf
 s_nop 0
 v_add_f32_dpp v48, v48, v48 row_ror:8 row_mask:0xf bank_mask:0xf
 v_add_f32_dpp v49, v49, v49 row_ror:8 row_mask:0xf bank_mask:0xf
 v_cvt_pk_bf16_f32 v48, v48, v49
 buffer_store_dword v48, v52, s[20:23], s44 offen sc1
 s_branch Lb1_123
Lr2_128:
 s_waitcnt vmcnt(1)
 v_mfma_f32_16x16x32_bf16 v[48:51], v[44:47], v[12:15], 0
 s_waitcnt vmcnt(0)
 v_mfma_f32_16x16x32_bf16 v[48:51], v[44:47], v[16:19], v[48:51]
 v_bitop3_b32 v55, v13, v15, s46 bitop3:0x7e
 v_bitop3_b32 v56, v17, v19, s46 bitop3:0x7e
 v_bitop3_b32 v55, v55, 1, v56 bitop3:0xc8
 v_cmp_ne_u32 vcc, 0, v55
 s_nop 3
 v_add_f32_dpp v48, v48, v48 row_ror:4 row_mask:0xf bank_mask:0xf
 v_add_f32_dpp v49, v49, v49 row_ror:4 row_mask:0xf bank_mask:0xf
 s_cbranch_vccnz Lr1_127
 v_add_f32_dpp v48, v48, v48 row_ror:8 row_mask:0xf bank_mask:0xf
 v_add_f32_dpp v49, v49, v49 row_ror:8 row_mask:0xf bank_mask:0xf
 v_cvt_pk_bf16_f32 v48, v48, v49
 buffer_store_dword v48, v52, s[20:23], s44 offen sc1
 s_branch Lb1_129
Lr1_127:
 s_mov_b64 exec, vcc
Lrt_146:
 buffer_load_dwordx4 v[12:15], v3, s[20:23], s39 offen offset:0 sc1
 buffer_load_dwordx4 v[16:19], v3, s[20:23], s39 offen offset:1024 sc1
 s_waitcnt vmcnt(2)
 v_bitop3_b32 v55, v13, v15, s46 bitop3:0x7e
 v_bitop3_b32 v56, v17, v19, s46 bitop3:0x7e
 v_bitop3_b32 v55, v55, 1, v56 bitop3:0xc8
 v_cmpx_ne_u32 vcc, 0, v55
 s_cbranch_execz Lrte_147
 buffer_load_dwordx4 v[12:15], v3, s[20:23], s39 offen offset:0 sc1
 buffer_load_dwordx4 v[16:19], v3, s[20:23], s39 offen offset:1024 sc1
 s_waitcnt vmcnt(2)
 v_bitop3_b32 v55, v13, v15, s46 bitop3:0x7e
 v_bitop3_b32 v56, v17, v19, s46 bitop3:0x7e
 v_bitop3_b32 v55, v55, 1, v56 bitop3:0xc8
 v_cmpx_ne_u32 vcc, 0, v55
 s_cbranch_execz Lrte_147
 buffer_load_dwordx4 v[12:15], v3, s[20:23], s39 offen offset:0 sc1
 buffer_load_dwordx4 v[16:19], v3, s[20:23], s39 offen offset:1024 sc1
 s_waitcnt vmcnt(2)
 v_bitop3_b32 v55, v13, v15, s46 bitop3:0x7e
 v_bitop3_b32 v56, v17, v19, s46 bitop3:0x7e
 v_bitop3_b32 v55, v55, 1, v56 bitop3:0xc8
 v_cmpx_ne_u32 vcc, 0, v55
 s_cbranch_execz Lrte_147
 s_sub_u32 s54, s54, 1
 s_cbranch_scc0 Lrt_146
 s_endpgm
Lrte_147:
 s_mov_b64 exec, -1
 s_nop 2
 v_mfma_f32_16x16x32_bf16 v[48:51], v[44:47], v[12:15], 0
 v_mfma_f32_16x16x32_bf16 v[48:51], v[44:47], v[16:19], v[48:51]
 s_nop 7
 v_add_f32_dpp v48, v48, v48 row_ror:4 row_mask:0xf bank_mask:0xf
 v_add_f32_dpp v49, v49, v49 row_ror:4 row_mask:0xf bank_mask:0xf
 s_nop 0
 v_add_f32_dpp v48, v48, v48 row_ror:8 row_mask:0xf bank_mask:0xf
 v_add_f32_dpp v49, v49, v49 row_ror:8 row_mask:0xf bank_mask:0xf
 v_cvt_pk_bf16_f32 v48, v48, v49
 buffer_store_dword v48, v52, s[20:23], s44 offen sc1
 s_branch Lb1_129
Lfw_119:
Lpb_148:
 buffer_load_dword v1, v7, s[20:23], s56 offen sc1
 s_waitcnt vmcnt(0)
 v_cmp_le_u32 vcc, s58, v1
 s_cbranch_vccnz Lpbok_149
 s_sub_u32 s54, s54, 1
 s_cbranch_scc0 Lpb_148
 s_endpgm
Lpbok_149:
 s_branch Lfok_118
Lfw_125:
Lpb_150:
 buffer_load_dword v1, v7, s[20:23], s56 offen sc1
 s_waitcnt vmcnt(0)
 v_cmp_le_u32 vcc, s58, v1
 s_cbranch_vccnz Lpbok_151
 s_sub_u32 s54, s54, 1
 s_cbranch_scc0 Lpb_150
 s_endpgm
Lpbok_151:
 s_branch Lfok_124
Lfw_131:
Lpb_152:
 buffer_load_dword v1, v7, s[20:23], s56 offen sc1
 s_waitcnt vmcnt(0)
 v_cmp_le_u32 vcc, s58, v1
 s_cbranch_vccnz Lpbok_153
 s_sub_u32 s54, s54, 1
 s_cbranch_scc0 Lpb_152
 s_endpgm
Lpbok_153:
 s_branch Lfok_130
Lfw_136:
Lpb_154:
 buffer_load_dword v1, v7, s[20:23], s56 offen sc1
 s_waitcnt vmcnt(0)
 v_cmp_le_u32 vcc, s58, v1
 s_cbranch_vccnz Lpbok_155
 s_sub_u32 s54, s54, 1
 s_cbranch_scc0 Lpb_154
 s_endpgm
Lpbok_155:
 s_branch Lfok_135
Lfail_105:
 s_endpgm
Lchexit_51:
 s_add_u32 s38, s38, 0x10000
 v_add_u32 v6, s69, v9
 ds_read_b64 v[64:65], v6 offset:19456
 v_mov_b32 v66, v2
 v_mov_b32 v67, v4
 s_waitcnt lgkmcnt(0)
 buffer_store_dwordx4 v[64:67], v0, s[20:23], s38 offen sc1
 s_waitcnt vmcnt(0) lgkmcnt(0)
 s_barrier
 v_subrev_u32 v0, 0x10000, v0
 v_min_u32 v0, 16, v0
 v_lshlrev_b32 v0, 24, v0
 v_mov_b32 v6, 64
 buffer_store_dword v6, v0, s[20:23], s57 offen sc1
Lfin:
Lend:
 s_endpgm
.section .rodata,"a"
.p2align 6
.amdhsa_kernel concat_heads__compressed_kv_cla__memory_aug_recurrent_mem_tr__prompt_kernel
  .amdhsa_next_free_vgpr 512
  .amdhsa_next_free_sgpr 102
  .amdhsa_accum_offset 256
  .amdhsa_group_segment_fixed_size 0
  .amdhsa_kernarg_size 128
  .amdhsa_user_sgpr_count 2
  .amdhsa_user_sgpr_kernarg_segment_ptr 1
  .amdhsa_system_sgpr_workgroup_id_x 1
  .amdhsa_float_denorm_mode_32 3
.end_amdhsa_kernel
```

```asm
; @launch grid=(256,1,1) block=(256,1,1) lds=163840
.amdgcn_target "amdgcn-amd-amdhsa--gfx950"
.text
.globl concat_heads__compressed_kv_cla__memory_aug_recurrent_mem_tr__prompt_kernel
.p2align 8
.type concat_heads__compressed_kv_cla__memory_aug_recurrent_mem_tr__prompt_kernel,@function
concat_heads__compressed_kv_cla__memory_aug_recurrent_mem_tr__prompt_kernel:
 s_cmp_ge_u32 s2, 256
 s_cbranch_scc1 Lend
 s_load_dwordx2 s[20:21], s[0:1], 120
 s_mov_b32 s22, 0x10000000
 s_mov_b32 s23, 0x20000
 s_load_dwordx2 s[28:29], s[0:1], 112
 s_mov_b32 s30, 0x100
 s_mov_b32 s31, 0x20000
 v_lshrrev_b32 v1, 6, v0
 s_lshr_b32 s6, s2, 3
 v_readfirstlane_b32 s4, v1
 s_getreg_b32 s73, hwreg(HW_REG_XCC_ID, 0, 3)
 s_sub_u32 s88, s73, s2
 s_and_b32 s88, s88, 7
 s_add_u32 s88, s88, 1
 s_mov_b32 s95, 0x40000
 s_waitcnt lgkmcnt(0)
 s_cmp_eq_u32 s2, 0
 s_cbranch_scc0 Lrole
 v_min_u32 v1, 1, v0
 v_lshlrev_b32 v1, 28, v1
 v_mov_b32 v2, s88
 buffer_store_dword v2, v1, s[28:31], 0 offen offset:4 sc1
Lrole:
 s_add_u32 s5, s2, s88
 s_sub_u32 s5, s5, 1
 s_and_b32 s5, s5, 7
 s_lshl_b32 s5, s5, 2
 s_lshr_b32 s5, 0x37654120, s5
 s_and_b32 s5, s5, 7
 s_cmp_eq_u32 s5, 0
 s_cbranch_scc1 Lchain
 s_cmp_eq_u32 s5, 1
 s_cbranch_scc1 Lpb
 s_cmp_lt_u32 s5, 4
 s_cbranch_scc1 Lqa
 s_load_dwordx2 s[8:9], s[0:1], 8
 s_mov_b32 s10, 0x200000
 s_mov_b32 s11, 0x20000
 s_load_dwordx2 s[12:13], s[0:1], 24
 s_mov_b32 s14, 0x400000
 s_mov_b32 s15, 0x20000
 s_load_dwordx2 s[16:17], s[0:1], 32
 s_mov_b32 s18, 0x400000
 s_mov_b32 s19, 0x20000
 s_sub_u32 s3, s5, 4
 s_lshl_b32 s3, s3, 3
 s_lshr_b32 s7, s6, 2
 s_add_u32 s3, s3, s7
 s_lshl_b32 s32, s3, 8
 s_mov_b32 s33, s32
 s_lshl_b32 s34, s3, 14
 s_add_u32 s34, s34, 0x1000000
 s_add_u32 s35, s34, 8192
 s_mov_b32 s36, 16
 s_and_b32 s37, s6, 3
 s_lshl_b32 s7, s3, 5
 s_add_u32 s7, s7, s37
 s_lshl_b32 s7, s7, 2
 s_add_u32 s7, s7, 0x2000
 v_min_u32 v1, 1, v0
 v_lshlrev_b32 v1, 28, v1
 v_add_u32 v13, s7, v1
 s_waitcnt lgkmcnt(0)
 v_and_b32 v1, 63, v0
 v_lshrrev_b32 v2, 3, v0
 v_mul_u32_u24 v10, 1024, v2
 v_lshrrev_b32 v2, 4, v0
 v_xor_b32 v2, v2, v0
 v_and_b32 v2, 7, v2
 v_lshl_add_u32 v10, v2, 4, v10
 v_lshrrev_b32 v2, 4, v1
 v_bfe_u32 v3, v1, 1, 3
 v_xor_b32 v2, v2, v3
 v_and_b32 v3, 15, v1
 v_lshlrev_b32 v3, 7, v3
 v_lshl_add_u32 v4, v2, 4, v3
 v_xor_b32 v5, 64, v4
 v_lshrrev_b32 v2, 4, v0
 v_lshlrev_b32 v11, 13, v2
 v_lshrrev_b32 v2, 7, v0
 v_lshrrev_b32 v3, 4, v1
 v_lshl_add_u32 v3, v2, 2, v3
 v_bfe_u32 v2, v1, 1, 3
 v_xor_b32 v2, v2, v3
 v_lshl_add_u32 v11, v2, 5, v11
 v_and_b32 v2, 1, v1
 v_lshl_add_u32 v11, v2, 4, v11
 v_bfe_u32 v2, v1, 2, 3
 v_xor_b32 v3, s4, v2
 v_lshlrev_b32 v3, 5, v3
 v_and_b32 v2, 3, v2
 v_lshl_add_u32 v3, v2, 8, v3
 v_lshrrev_b32 v2, 4, v1
 v_lshl_add_u32 v3, v2, 11, v3
 v_and_b32 v2, 3, v1
 v_lshl_add_u32 v3, v2, 3, v3
 v_add_u32 v8, 65536, v3
 v_xor_b32 v3, 0x80, v3
 v_add_u32 v9, 65536, v3
 s_lshl_b32 s45, s4, 11
 v_lshl_add_u32 v12, v1, 4, s45
 s_mov_b32 s39, s37
 s_add_u32 s40, s39, 4
 s_lshl_b32 s49, s4, 10
 s_mul_i32 s46, s39, 32768
 s_add_u32 m0, s49, 0
 s_nop 0
 buffer_load_dwordx4 v10, s[8:11], s46 offen offset:0  lds
 s_add_u32 m0, s49, 3968
 s_nop 0
 buffer_load_dwordx4 v10, s[8:11], s46 offen offset:128  lds
 s_add_u32 m0, s49, 7936
 s_nop 0
 buffer_load_dwordx4 v10, s[8:11], s46 offen offset:256  lds
 s_add_u32 m0, s49, 11904
 s_nop 0
 buffer_load_dwordx4 v10, s[8:11], s46 offen offset:384  lds
 s_add_u32 m0, s49, 15872
 s_nop 0
 buffer_load_dwordx4 v10, s[8:11], s46 offen offset:512  lds
 s_add_u32 m0, s49, 19840
 s_nop 0
 buffer_load_dwordx4 v10, s[8:11], s46 offen offset:640  lds
 s_add_u32 m0, s49, 23808
 s_nop 0
 buffer_load_dwordx4 v10, s[8:11], s46 offen offset:768  lds
 s_add_u32 m0, s49, 27776
 s_nop 0
 buffer_load_dwordx4 v10, s[8:11], s46 offen offset:896  lds
 s_lshl_b32 s49, s4, 10
 s_add_u32 s49, s49, 32768
 s_mul_i32 s46, s40, 32768
 s_add_u32 m0, s49, 0
 s_nop 0
 buffer_load_dwordx4 v10, s[8:11], s46 offen offset:0  lds
 s_add_u32 m0, s49, 3968
 s_nop 0
 buffer_load_dwordx4 v10, s[8:11], s46 offen offset:128  lds
 s_add_u32 m0, s49, 7936
 s_nop 0
 buffer_load_dwordx4 v10, s[8:11], s46 offen offset:256  lds
 s_add_u32 m0, s49, 11904
 s_nop 0
 buffer_load_dwordx4 v10, s[8:11], s46 offen offset:384  lds
 s_add_u32 m0, s49, 15872
 s_nop 0
 buffer_load_dwordx4 v10, s[8:11], s46 offen offset:512  lds
 s_add_u32 m0, s49, 19840
 s_nop 0
 buffer_load_dwordx4 v10, s[8:11], s46 offen offset:640  lds
 s_add_u32 m0, s49, 23808
 s_nop 0
 buffer_load_dwordx4 v10, s[8:11], s46 offen offset:768  lds
 s_add_u32 m0, s49, 27776
 s_nop 0
 buffer_load_dwordx4 v10, s[8:11], s46 offen offset:896  lds
 s_lshl_b32 s49, s4, 10
 s_add_u32 m0, s49, 65536
 s_add_u32 s45, s32, 0
 buffer_load_dwordx4 v11, s[12:15], s45 offen  lds
 s_add_u32 m0, s49, 69632
 s_add_u32 s45, s32, 131072
 buffer_load_dwordx4 v11, s[12:15], s45 offen  lds
 s_add_u32 m0, s49, 73728
 s_add_u32 s45, s33, 0
 buffer_load_dwordx4 v11, s[16:19], s45 offen  lds
 s_add_u32 m0, s49, 77824
 s_add_u32 s45, s33, 131072
 buffer_load_dwordx4 v11, s[16:19], s45 offen  lds
 s_add_u32 m0, s49, 81920
 s_add_u32 s45, s32, 262144
 buffer_load_dwordx4 v11, s[12:15], s45 offen  lds
 s_add_u32 m0, s49, 86016
 s_add_u32 s45, s32, 393216
 buffer_load_dwordx4 v11, s[12:15], s45 offen  lds
 s_add_u32 m0, s49, 90112
 s_add_u32 s45, s33, 262144
 buffer_load_dwordx4 v11, s[16:19], s45 offen  lds
 s_add_u32 m0, s49, 94208
 s_add_u32 s45, s33, 393216
 buffer_load_dwordx4 v11, s[16:19], s45 offen  lds
 s_add_u32 m0, s49, 98304
 s_add_u32 s45, s32, 524288
 buffer_load_dwordx4 v11, s[12:15], s45 offen  lds
 s_add_u32 m0, s49, 102400
 s_add_u32 s45, s32, 655360
 buffer_load_dwordx4 v11, s[12:15], s45 offen  lds
 s_add_u32 m0, s49, 106496
 s_add_u32 s45, s33, 524288
 buffer_load_dwordx4 v11, s[16:19], s45 offen  lds
 s_add_u32 m0, s49, 110592
 s_add_u32 s45, s33, 655360
 buffer_load_dwordx4 v11, s[16:19], s45 offen  lds
 s_waitcnt vmcnt(8) lgkmcnt(0)
 s_barrier
 s_add_u32 m0, s49, 114688
 s_add_u32 s45, s32, 786432
 buffer_load_dwordx4 v11, s[12:15], s45 offen  lds
 s_add_u32 m0, s49, 118784
 s_add_u32 s45, s32, 917504
 buffer_load_dwordx4 v11, s[12:15], s45 offen  lds
 s_add_u32 m0, s49, 122880
 s_add_u32 s45, s33, 786432
 buffer_load_dwordx4 v11, s[16:19], s45 offen  lds
 s_add_u32 m0, s49, 126976
 s_add_u32 s45, s33, 917504
 buffer_load_dwordx4 v11, s[16:19], s45 offen  lds
 ds_read_b64_tr_b16 a[0:1], v8 offset:0
 ds_read_b64_tr_b16 a[2:3], v8 offset:1024
 ds_read_b64_tr_b16 a[64:65], v9 offset:0
 ds_read_b64_tr_b16 a[66:67], v9 offset:1024
 ds_read_b64_tr_b16 a[128:129], v8 offset:8192
 ds_read_b64_tr_b16 a[130:131], v8 offset:9216
 ds_read_b64_tr_b16 a[192:193], v9 offset:8192
 ds_read_b64_tr_b16 a[194:195], v9 offset:9216
 s_waitcnt vmcnt(8) lgkmcnt(0)
 s_barrier
 s_add_u32 m0, s49, 65536
 s_add_u32 s45, s32, 1048576
 buffer_load_dwordx4 v11, s[12:15], s45 offen  lds
 s_add_u32 m0, s49, 69632
 s_add_u32 s45, s32, 1179648
 buffer_load_dwordx4 v11, s[12:15], s45 offen  lds
 s_add_u32 m0, s49, 73728
 s_add_u32 s45, s33, 1048576
 buffer_load_dwordx4 v11, s[16:19], s45 offen  lds
 s_add_u32 m0, s49, 77824
 s_add_u32 s45, s33, 1179648
 buffer_load_dwordx4 v11, s[16:19], s45 offen  lds
 ds_read_b64_tr_b16 a[4:5], v8 offset:16384
 ds_read_b64_tr_b16 a[6:7], v8 offset:17408
 ds_read_b64_tr_b16 a[68:69], v9 offset:16384
 ds_read_b64_tr_b16 a[70:71], v9 offset:17408
 ds_read_b64_tr_b16 a[132:133], v8 offset:24576
 ds_read_b64_tr_b16 a[134:135], v8 offset:25600
 ds_read_b64_tr_b16 a[196:197], v9 offset:24576
 ds_read_b64_tr_b16 a[198:199], v9 offset:25600
 s_waitcnt vmcnt(8) lgkmcnt(0)
 s_barrier
 s_add_u32 m0, s49, 81920
 s_add_u32 s45, s32, 1310720
 buffer_load_dwordx4 v11, s[12:15], s45 offen  lds
 s_add_u32 m0, s49, 86016
 s_add_u32 s45, s32, 1441792
 buffer_load_dwordx4 v11, s[12:15], s45 offen  lds
 s_add_u32 m0, s49, 90112
 s_add_u32 s45, s33, 1310720
 buffer_load_dwordx4 v11, s[16:19], s45 offen  lds
 s_add_u32 m0, s49, 94208
 s_add_u32 s45, s33, 1441792
 buffer_load_dwordx4 v11, s[16:19], s45 offen  lds
 ds_read_b64_tr_b16 a[8:9], v8 offset:32768
 ds_read_b64_tr_b16 a[10:11], v8 offset:33792
 ds_read_b64_tr_b16 a[72:73], v9 offset:32768
 ds_read_b64_tr_b16 a[74:75], v9 offset:33792
 ds_read_b64_tr_b16 a[136:137], v8 offset:40960
 ds_read_b64_tr_b16 a[138:139], v8 offset:41984
 ds_read_b64_tr_b16 a[200:201], v9 offset:40960
 ds_read_b64_tr_b16 a[202:203], v9 offset:41984
 s_waitcnt vmcnt(8) lgkmcnt(0)
 s_barrier
 s_add_u32 m0, s49, 98304
 s_add_u32 s45, s32, 1572864
 buffer_load_dwordx4 v11, s[12:15], s45 offen  lds
 s_add_u32 m0, s49, 102400
 s_add_u32 s45, s32, 1703936
 buffer_load_dwordx4 v11, s[12:15], s45 offen  lds
 s_add_u32 m0, s49, 106496
 s_add_u32 s45, s33, 1572864
 buffer_load_dwordx4 v11, s[16:19], s45 offen  lds
 s_add_u32 m0, s49, 110592
 s_add_u32 s45, s33, 1703936
 buffer_load_dwordx4 v11, s[16:19], s45 offen  lds
 ds_read_b64_tr_b16 a[12:13], v8 offset:49152
 ds_read_b64_tr_b16 a[14:15], v8 offset:50176
 ds_read_b64_tr_b16 a[76:77], v9 offset:49152
 ds_read_b64_tr_b16 a[78:79], v9 offset:50176
 ds_read_b64_tr_b16 a[140:141], v8 offset:57344
 ds_read_b64_tr_b16 a[142:143], v8 offset:58368
 ds_read_b64_tr_b16 a[204:205], v9 offset:57344
 ds_read_b64_tr_b16 a[206:207], v9 offset:58368
 s_waitcnt vmcnt(8) lgkmcnt(0)
 s_barrier
 s_add_u32 m0, s49, 114688
 s_add_u32 s45, s32, 1835008
 buffer_load_dwordx4 v11, s[12:15], s45 offen  lds
 s_add_u32 m0, s49, 118784
 s_add_u32 s45, s32, 1966080
 buffer_load_dwordx4 v11, s[12:15], s45 offen  lds
 s_add_u32 m0, s49, 122880
 s_add_u32 s45, s33, 1835008
 buffer_load_dwordx4 v11, s[16:19], s45 offen  lds
 s_add_u32 m0, s49, 126976
 s_add_u32 s45, s33, 1966080
 buffer_load_dwordx4 v11, s[16:19], s45 offen  lds
 ds_read_b64_tr_b16 a[16:17], v8 offset:0
 ds_read_b64_tr_b16 a[18:19], v8 offset:1024
 ds_read_b64_tr_b16 a[80:81], v9 offset:0
 ds_read_b64_tr_b16 a[82:83], v9 offset:1024
 ds_read_b64_tr_b16 a[144:145], v8 offset:8192
 ds_read_b64_tr_b16 a[146:147], v8 offset:9216
 ds_read_b64_tr_b16 a[208:209], v9 offset:8192
 ds_read_b64_tr_b16 a[210:211], v9 offset:9216
 s_waitcnt vmcnt(8) lgkmcnt(0)
 s_barrier
 s_add_u32 m0, s49, 65536
 s_add_u32 s45, s32, 2097152
 buffer_load_dwordx4 v11, s[12:15], s45 offen  lds
 s_add_u32 m0, s49, 69632
 s_add_u32 s45, s32, 2228224
 buffer_load_dwordx4 v11, s[12:15], s45 offen  lds
 s_add_u32 m0, s49, 73728
 s_add_u32 s45, s33, 2097152
 buffer_load_dwordx4 v11, s[16:19], s45 offen  lds
 s_add_u32 m0, s49, 77824
 s_add_u32 s45, s33, 2228224
 buffer_load_dwordx4 v11, s[16:19], s45 offen  lds
 ds_read_b64_tr_b16 a[20:21], v8 offset:16384
 ds_read_b64_tr_b16 a[22:23], v8 offset:17408
 ds_read_b64_tr_b16 a[84:85], v9 offset:16384
 ds_read_b64_tr_b16 a[86:87], v9 offset:17408
 ds_read_b64_tr_b16 a[148:149], v8 offset:24576
 ds_read_b64_tr_b16 a[150:151], v8 offset:25600
 ds_read_b64_tr_b16 a[212:213], v9 offset:24576
 ds_read_b64_tr_b16 a[214:215], v9 offset:25600
 s_waitcnt vmcnt(8) lgkmcnt(0)
 s_barrier
 s_add_u32 m0, s49, 81920
 s_add_u32 s45, s32, 2359296
 buffer_load_dwordx4 v11, s[12:15], s45 offen  lds
 s_add_u32 m0, s49, 86016
 s_add_u32 s45, s32, 2490368
 buffer_load_dwordx4 v11, s[12:15], s45 offen  lds
 s_add_u32 m0, s49, 90112
 s_add_u32 s45, s33, 2359296
 buffer_load_dwordx4 v11, s[16:19], s45 offen  lds
 s_add_u32 m0, s49, 94208
 s_add_u32 s45, s33, 2490368
 buffer_load_dwordx4 v11, s[16:19], s45 offen  lds
 ds_read_b64_tr_b16 a[24:25], v8 offset:32768
 ds_read_b64_tr_b16 a[26:27], v8 offset:33792
 ds_read_b64_tr_b16 a[88:89], v9 offset:32768
 ds_read_b64_tr_b16 a[90:91], v9 offset:33792
 ds_read_b64_tr_b16 a[152:153], v8 offset:40960
 ds_read_b64_tr_b16 a[154:155], v8 offset:41984
 ds_read_b64_tr_b16 a[216:217], v9 offset:40960
 ds_read_b64_tr_b16 a[218:219], v9 offset:41984
 s_waitcnt vmcnt(8) lgkmcnt(0)
 s_barrier
 s_add_u32 m0, s49, 98304
 s_add_u32 s45, s32, 2621440
 buffer_load_dwordx4 v11, s[12:15], s45 offen  lds
 s_add_u32 m0, s49, 102400
 s_add_u32 s45, s32, 2752512
 buffer_load_dwordx4 v11, s[12:15], s45 offen  lds
 s_add_u32 m0, s49, 106496
 s_add_u32 s45, s33, 2621440
 buffer_load_dwordx4 v11, s[16:19], s45 offen  lds
 s_add_u32 m0, s49, 110592
 s_add_u32 s45, s33, 2752512
 buffer_load_dwordx4 v11, s[16:19], s45 offen  lds
 ds_read_b64_tr_b16 a[28:29], v8 offset:49152
 ds_read_b64_tr_b16 a[30:31], v8 offset:50176
 ds_read_b64_tr_b16 a[92:93], v9 offset:49152
 ds_read_b64_tr_b16 a[94:95], v9 offset:50176
 ds_read_b64_tr_b16 a[156:157], v8 offset:57344
 ds_read_b64_tr_b16 a[158:159], v8 offset:58368
 ds_read_b64_tr_b16 a[220:221], v9 offset:57344
 ds_read_b64_tr_b16 a[222:223], v9 offset:58368
 s_waitcnt vmcnt(8) lgkmcnt(0)
 s_barrier
 s_add_u32 m0, s49, 114688
 s_add_u32 s45, s32, 2883584
 buffer_load_dwordx4 v11, s[12:15], s45 offen  lds
 s_add_u32 m0, s49, 118784
 s_add_u32 s45, s32, 3014656
 buffer_load_dwordx4 v11, s[12:15], s45 offen  lds
 s_add_u32 m0, s49, 122880
 s_add_u32 s45, s33, 2883584
 buffer_load_dwordx4 v11, s[16:19], s45 offen  lds
 s_add_u32 m0, s49, 126976
 s_add_u32 s45, s33, 3014656
 buffer_load_dwordx4 v11, s[16:19], s45 offen  lds
 ds_read_b64_tr_b16 a[32:33], v8 offset:0
 ds_read_b64_tr_b16 a[34:35], v8 offset:1024
 ds_read_b64_tr_b16 a[96:97], v9 offset:0
 ds_read_b64_tr_b16 a[98:99], v9 offset:1024
 ds_read_b64_tr_b16 a[160:161], v8 offset:8192
 ds_read_b64_tr_b16 a[162:163], v8 offset:9216
 ds_read_b64_tr_b16 a[224:225], v9 offset:8192
 ds_read_b64_tr_b16 a[226:227], v9 offset:9216
 s_waitcnt vmcnt(8) lgkmcnt(0)
 s_barrier
 s_add_u32 m0, s49, 65536
 s_add_u32 s45, s32, 3145728
 buffer_load_dwordx4 v11, s[12:15], s45 offen  lds
 s_add_u32 m0, s49, 69632
 s_add_u32 s45, s32, 3276800
 buffer_load_dwordx4 v11, s[12:15], s45 offen  lds
 s_add_u32 m0, s49, 73728
 s_add_u32 s45, s33, 3145728
 buffer_load_dwordx4 v11, s[16:19], s45 offen  lds
 s_add_u32 m0, s49, 77824
 s_add_u32 s45, s33, 3276800
 buffer_load_dwordx4 v11, s[16:19], s45 offen  lds
 ds_read_b64_tr_b16 a[36:37], v8 offset:16384
 ds_read_b64_tr_b16 a[38:39], v8 offset:17408
 ds_read_b64_tr_b16 a[100:101], v9 offset:16384
 ds_read_b64_tr_b16 a[102:103], v9 offset:17408
 ds_read_b64_tr_b16 a[164:165], v8 offset:24576
 ds_read_b64_tr_b16 a[166:167], v8 offset:25600
 ds_read_b64_tr_b16 a[228:229], v9 offset:24576
 ds_read_b64_tr_b16 a[230:231], v9 offset:25600
 s_waitcnt vmcnt(8) lgkmcnt(0)
 s_barrier
 s_add_u32 m0, s49, 81920
 s_add_u32 s45, s32, 3407872
 buffer_load_dwordx4 v11, s[12:15], s45 offen  lds
 s_add_u32 m0, s49, 86016
 s_add_u32 s45, s32, 3538944
 buffer_load_dwordx4 v11, s[12:15], s45 offen  lds
 s_add_u32 m0, s49, 90112
 s_add_u32 s45, s33, 3407872
 buffer_load_dwordx4 v11, s[16:19], s45 offen  lds
 s_add_u32 m0, s49, 94208
 s_add_u32 s45, s33, 3538944
 buffer_load_dwordx4 v11, s[16:19], s45 offen  lds
 ds_read_b64_tr_b16 a[40:41], v8 offset:32768
 ds_read_b64_tr_b16 a[42:43], v8 offset:33792
 ds_read_b64_tr_b16 a[104:105], v9 offset:32768
 ds_read_b64_tr_b16 a[106:107], v9 offset:33792
 ds_read_b64_tr_b16 a[168:169], v8 offset:40960
 ds_read_b64_tr_b16 a[170:171], v8 offset:41984
 ds_read_b64_tr_b16 a[232:233], v9 offset:40960
 ds_read_b64_tr_b16 a[234:235], v9 offset:41984
 s_waitcnt vmcnt(8) lgkmcnt(0)
 s_barrier
 s_add_u32 m0, s49, 98304
 s_add_u32 s45, s32, 3670016
 buffer_load_dwordx4 v11, s[12:15], s45 offen  lds
 s_add_u32 m0, s49, 102400
 s_add_u32 s45, s32, 3801088
 buffer_load_dwordx4 v11, s[12:15], s45 offen  lds
 s_add_u32 m0, s49, 106496
 s_add_u32 s45, s33, 3670016
 buffer_load_dwordx4 v11, s[16:19], s45 offen  lds
 s_add_u32 m0, s49, 110592
 s_add_u32 s45, s33, 3801088
 buffer_load_dwordx4 v11, s[16:19], s45 offen  lds
 ds_read_b64_tr_b16 a[44:45], v8 offset:49152
 ds_read_b64_tr_b16 a[46:47], v8 offset:50176
 ds_read_b64_tr_b16 a[108:109], v9 offset:49152
 ds_read_b64_tr_b16 a[110:111], v9 offset:50176
 ds_read_b64_tr_b16 a[172:173], v8 offset:57344
 ds_read_b64_tr_b16 a[174:175], v8 offset:58368
 ds_read_b64_tr_b16 a[236:237], v9 offset:57344
 ds_read_b64_tr_b16 a[238:239], v9 offset:58368
 s_waitcnt vmcnt(8) lgkmcnt(0)
 s_barrier
 s_add_u32 m0, s49, 114688
 s_add_u32 s45, s32, 3932160
 buffer_load_dwordx4 v11, s[12:15], s45 offen  lds
 s_add_u32 m0, s49, 118784
 s_add_u32 s45, s32, 4063232
 buffer_load_dwordx4 v11, s[12:15], s45 offen  lds
 s_add_u32 m0, s49, 122880
 s_add_u32 s45, s33, 3932160
 buffer_load_dwordx4 v11, s[16:19], s45 offen  lds
 s_add_u32 m0, s49, 126976
 s_add_u32 s45, s33, 4063232
 buffer_load_dwordx4 v11, s[16:19], s45 offen  lds
 ds_read_b64_tr_b16 a[48:49], v8 offset:0
 ds_read_b64_tr_b16 a[50:51], v8 offset:1024
 ds_read_b64_tr_b16 a[112:113], v9 offset:0
 ds_read_b64_tr_b16 a[114:115], v9 offset:1024
 ds_read_b64_tr_b16 a[176:177], v8 offset:8192
 ds_read_b64_tr_b16 a[178:179], v8 offset:9216
 ds_read_b64_tr_b16 a[240:241], v9 offset:8192
 ds_read_b64_tr_b16 a[242:243], v9 offset:9216
 s_waitcnt vmcnt(8) lgkmcnt(0)
 s_barrier
 ds_read_b64_tr_b16 a[52:53], v8 offset:16384
 ds_read_b64_tr_b16 a[54:55], v8 offset:17408
 ds_read_b64_tr_b16 a[116:117], v9 offset:16384
 ds_read_b64_tr_b16 a[118:119], v9 offset:17408
 ds_read_b64_tr_b16 a[180:181], v8 offset:24576
 ds_read_b64_tr_b16 a[182:183], v8 offset:25600
 ds_read_b64_tr_b16 a[244:245], v9 offset:24576
 ds_read_b64_tr_b16 a[246:247], v9 offset:25600
 s_waitcnt vmcnt(4) lgkmcnt(0)
 s_barrier
 ds_read_b64_tr_b16 a[56:57], v8 offset:32768
 ds_read_b64_tr_b16 a[58:59], v8 offset:33792
 ds_read_b64_tr_b16 a[120:121], v9 offset:32768
 ds_read_b64_tr_b16 a[122:123], v9 offset:33792
 ds_read_b64_tr_b16 a[184:185], v8 offset:40960
 ds_read_b64_tr_b16 a[186:187], v8 offset:41984
 ds_read_b64_tr_b16 a[248:249], v9 offset:40960
 ds_read_b64_tr_b16 a[250:251], v9 offset:41984
 s_waitcnt vmcnt(0) lgkmcnt(0)
 s_barrier
 ds_read_b64_tr_b16 a[60:61], v8 offset:49152
 ds_read_b64_tr_b16 a[62:63], v8 offset:50176
 ds_read_b64_tr_b16 a[124:125], v9 offset:49152
 ds_read_b64_tr_b16 a[126:127], v9 offset:50176
 ds_read_b64_tr_b16 a[188:189], v8 offset:57344
 ds_read_b64_tr_b16 a[190:191], v8 offset:58368
 ds_read_b64_tr_b16 a[252:253], v9 offset:57344
 ds_read_b64_tr_b16 a[254:255], v9 offset:58368
 s_mov_b32 s50, 0x3e0293ee
 s_mov_b32 s42, 0
 s_mov_b32 s43, 0
 s_mov_b32 s44, 65536
 v_mov_b32 v6, v4
 v_mov_b32 v7, v5
Lrh_3:
 v_mbcnt_lo_u32_b32 v21, -1, 0
 v_min_u32 v21, 1, v21
 v_lshlrev_b32 v21, 28, v21
 buffer_load_dword v20, v21, s[28:31], 0 offen offset:4 sc1
 s_waitcnt vmcnt(0)
Lrhc_4:
 v_readfirstlane_b32 s89, v20
 s_cmp_eq_u32 s89, s88
 s_cbranch_scc1 Lrhk_5
 s_cmp_lg_u32 s89, 0
 s_cbranch_scc1 Lredo
 s_sub_u32 s95, s95, 1
 s_cbranch_scc0 Lrh_3
 s_endpgm
Lrhk_5:
 s_cmp_lg_u32 s4, 0
 s_cbranch_scc1 Lfrk_2
 v_min_u32 v21, 1, v0
 v_lshlrev_b32 v21, 28, v21
Lfr_1:
 buffer_load_dword v20, v21, s[28:31], 0 offen offset:128 sc1
 s_waitcnt vmcnt(0)
 v_cmp_eq_u32 vcc, 1, v20
 s_cbranch_vccnz Lfrk_2
 s_sleep 12
 s_sub_u32 s95, s95, 1
 s_cbranch_scc0 Lfr_1
 s_endpgm
Lfrk_2:
 s_lshl_b32 s47, s2, 13
 s_add_u32 s47, s47, 0x8000000
 s_mov_b32 s48, s47
 v_mov_b32 v14, 0
 s_waitcnt vmcnt(0) lgkmcnt(0)
 s_barrier
 ds_read_b128 v[32:35], v6 offset:0
 ds_read_b128 v[36:39], v6 offset:2048
 ds_read_b128 v[40:43], v7 offset:0
 ds_read_b128 v[44:47], v7 offset:2048
 v_lshlrev_b32 v1, 12, v0
 s_lshl_b32 s45, s6, 7
 buffer_load_dword v15, v1, s[8:11], s45 offen
 v_add_u32 v1, 0x100000, v1
 buffer_load_dword v15, v1, s[8:11], s45 offen
 v_add_u32 v1, 0x100000, v1
 s_waitcnt lgkmcnt(2)
Lps_loop_6:
 v_mfma_f32_16x16x32_bf16 v[64:67], a[0:3], v[32:35], 0
 ds_read_b128 v[48:51], v6 offset:4096
 v_mfma_f32_16x16x32_bf16 v[72:75], a[64:67], v[32:35], 0
 ds_read_b128 v[52:55], v6 offset:6144
 v_mfma_f32_16x16x32_bf16 v[80:83], v[32:35], a[128:131], 0
 s_add_u32 s41, s40, 4
 v_mfma_f32_16x16x32_bf16 v[88:91], v[32:35], a[192:195], 0
 s_add_u32 s45, s42, 2
 s_mul_i32 s46, s41, 32768
 v_mfma_f32_16x16x32_bf16 v[68:71], a[0:3], v[36:39], 0
 s_cmp_lt_u32 s45, s36
 s_cselect_b32 s46, s46, 0
 v_mfma_f32_16x16x32_bf16 v[76:79], a[64:67], v[36:39], 0
 s_lshl_b32 s49, s4, 10
 s_add_u32 s49, s49, s44
 v_mfma_f32_16x16x32_bf16 v[84:87], v[36:39], a[128:131], 0
 v_mfma_f32_16x16x32_bf16 v[92:95], v[36:39], a[192:195], 0
 s_waitcnt lgkmcnt(2)
 v_mfma_f32_16x16x32_bf16 v[64:67], a[4:7], v[40:43], v[64:67]
 ds_read_b128 v[56:59], v7 offset:4096
 v_mfma_f32_16x16x32_bf16 v[72:75], a[68:71], v[40:43], v[72:75]
 ds_read_b128 v[60:63], v7 offset:6144
 v_mfma_f32_16x16x32_bf16 v[80:83], v[40:43], a[132:135], v[80:83]
 s_add_u32 m0, s49, 0
 v_mfma_f32_16x16x32_bf16 v[88:91], v[40:43], a[196:199], v[88:91]
 buffer_load_dwordx4 v10, s[8:11], s46 offen offset:0  lds
 v_mfma_f32_16x16x32_bf16 v[68:71], a[4:7], v[44:47], v[68:71]
 s_add_u32 m0, s49, 3968
 v_mfma_f32_16x16x32_bf16 v[76:79], a[68:71], v[44:47], v[76:79]
 buffer_load_dwordx4 v10, s[8:11], s46 offen offset:128  lds
 v_mfma_f32_16x16x32_bf16 v[84:87], v[44:47], a[132:135], v[84:87]
 v_mfma_f32_16x16x32_bf16 v[92:95], v[44:47], a[196:199], v[92:95]
 s_waitcnt lgkmcnt(2)
 v_mfma_f32_16x16x32_bf16 v[64:67], a[8:11], v[48:51], v[64:67]
 ds_read_b128 v[32:35], v6 offset:8192
 v_mfma_f32_16x16x32_bf16 v[72:75], a[72:75], v[48:51], v[72:75]
 ds_read_b128 v[36:39], v6 offset:10240
 v_mfma_f32_16x16x32_bf16 v[80:83], v[48:51], a[136:139], v[80:83]
 s_add_u32 m0, s49, 7936
 v_mfma_f32_16x16x32_bf16 v[88:91], v[48:51], a[200:203], v[88:91]
 buffer_load_dwordx4 v10, s[8:11], s46 offen offset:256  lds
 v_mfma_f32_16x16x32_bf16 v[68:71], a[8:11], v[52:55], v[68:71]
 s_add_u32 m0, s49, 11904
 v_mfma_f32_16x16x32_bf16 v[76:79], a[72:75], v[52:55], v[76:79]
 buffer_load_dwordx4 v10, s[8:11], s46 offen offset:384  lds
 v_mfma_f32_16x16x32_bf16 v[84:87], v[52:55], a[136:139], v[84:87]
 v_mfma_f32_16x16x32_bf16 v[92:95], v[52:55], a[200:203], v[92:95]
 s_waitcnt lgkmcnt(2)
 v_mfma_f32_16x16x32_bf16 v[64:67], a[12:15], v[56:59], v[64:67]
 ds_read_b128 v[40:43], v7 offset:8192
 v_mfma_f32_16x16x32_bf16 v[72:75], a[76:79], v[56:59], v[72:75]
 ds_read_b128 v[44:47], v7 offset:10240
 v_mfma_f32_16x16x32_bf16 v[80:83], v[56:59], a[140:143], v[80:83]
 s_add_u32 m0, s49, 15872
 v_mfma_f32_16x16x32_bf16 v[88:91], v[56:59], a[204:207], v[88:91]
 buffer_load_dwordx4 v10, s[8:11], s46 offen offset:512  lds
 v_mfma_f32_16x16x32_bf16 v[68:71], a[12:15], v[60:63], v[68:71]
 s_add_u32 m0, s49, 19840
 v_mfma_f32_16x16x32_bf16 v[76:79], a[76:79], v[60:63], v[76:79]
 buffer_load_dwordx4 v10, s[8:11], s46 offen offset:640  lds
 v_mfma_f32_16x16x32_bf16 v[84:87], v[60:63], a[140:143], v[84:87]
 v_mfma_f32_16x16x32_bf16 v[92:95], v[60:63], a[204:207], v[92:95]
 s_waitcnt lgkmcnt(2)
 v_mfma_f32_16x16x32_bf16 v[64:67], a[16:19], v[32:35], v[64:67]
 ds_read_b128 v[48:51], v6 offset:12288
 v_mfma_f32_16x16x32_bf16 v[72:75], a[80:83], v[32:35], v[72:75]
 ds_read_b128 v[52:55], v6 offset:14336
 v_mfma_f32_16x16x32_bf16 v[80:83], v[32:35], a[144:147], v[80:83]
 s_add_u32 m0, s49, 23808
 v_mfma_f32_16x16x32_bf16 v[88:91], v[32:35], a[208:211], v[88:91]
 buffer_load_dwordx4 v10, s[8:11], s46 offen offset:768  lds
 v_mfma_f32_16x16x32_bf16 v[68:71], a[16:19], v[36:39], v[68:71]
 s_add_u32 m0, s49, 27776
 v_mfma_f32_16x16x32_bf16 v[76:79], a[80:83], v[36:39], v[76:79]
 buffer_load_dwordx4 v10, s[8:11], s46 offen offset:896  lds
 v_mfma_f32_16x16x32_bf16 v[84:87], v[36:39], a[144:147], v[84:87]
 v_mfma_f32_16x16x32_bf16 v[92:95], v[36:39], a[208:211], v[92:95]
 s_waitcnt lgkmcnt(2)
 v_mfma_f32_16x16x32_bf16 v[64:67], a[20:23], v[40:43], v[64:67]
 ds_read_b128 v[56:59], v7 offset:12288
 v_mfma_f32_16x16x32_bf16 v[72:75], a[84:87], v[40:43], v[72:75]
 ds_read_b128 v[60:63], v7 offset:14336
 v_mfma_f32_16x16x32_bf16 v[80:83], v[40:43], a[148:151], v[80:83]
 v_mfma_f32_16x16x32_bf16 v[88:91], v[40:43], a[212:215], v[88:91]
 v_mfma_f32_16x16x32_bf16 v[68:71], a[20:23], v[44:47], v[68:71]
 v_mfma_f32_16x16x32_bf16 v[76:79], a[84:87], v[44:47], v[76:79]
 v_mfma_f32_16x16x32_bf16 v[84:87], v[44:47], a[148:151], v[84:87]
 v_mfma_f32_16x16x32_bf16 v[92:95], v[44:47], a[212:215], v[92:95]
 s_waitcnt lgkmcnt(2)
 v_mfma_f32_16x16x32_bf16 v[64:67], a[24:27], v[48:51], v[64:67]
 ds_read_b128 v[32:35], v6 offset:16384
 v_mfma_f32_16x16x32_bf16 v[72:75], a[88:91], v[48:51], v[72:75]
 ds_read_b128 v[36:39], v6 offset:18432
 v_mfma_f32_16x16x32_bf16 v[80:83], v[48:51], a[152:155], v[80:83]
 v_cvt_pk_bf16_f32 v16, v96, v97
 v_mfma_f32_16x16x32_bf16 v[88:91], v[48:51], a[216:219], v[88:91]
 v_cvt_pk_bf16_f32 v17, v104, v105
 v_mfma_f32_16x16x32_bf16 v[68:71], a[24:27], v[52:55], v[68:71]
 v_mfma_f32_16x16x32_bf16 v[76:79], a[88:91], v[52:55], v[76:79]
 v_cvt_pk_bf16_f32 v18, v98, v99
 v_mfma_f32_16x16x32_bf16 v[84:87], v[52:55], a[152:155], v[84:87]
 v_mfma_f32_16x16x32_bf16 v[92:95], v[52:55], a[216:219], v[92:95]
 s_waitcnt lgkmcnt(2)
 v_mfma_f32_16x16x32_bf16 v[64:67], a[28:31], v[56:59], v[64:67]
 ds_read_b128 v[40:43], v7 offset:16384
 v_mfma_f32_16x16x32_bf16 v[72:75], a[92:95], v[56:59], v[72:75]
 ds_read_b128 v[44:47], v7 offset:18432
 v_mfma_f32_16x16x32_bf16 v[80:83], v[56:59], a[156:159], v[80:83]
 v_cvt_pk_bf16_f32 v19, v106, v107
 v_mfma_f32_16x16x32_bf16 v[88:91], v[56:59], a[220:223], v[88:91]
 v_mfma_f32_16x16x32_bf16 v[68:71], a[28:31], v[60:63], v[68:71]
 buffer_store_dwordx4 v[16:19], v12, s[20:23], s47 offen offset:0 sc1
 v_mfma_f32_16x16x32_bf16 v[76:79], a[92:95], v[60:63], v[76:79]
 v_cvt_pk_bf16_f32 v20, v100, v101
 v_mfma_f32_16x16x32_bf16 v[84:87], v[60:63], a[156:159], v[84:87]
 v_mfma_f32_16x16x32_bf16 v[92:95], v[60:63], a[220:223], v[92:95]
 s_waitcnt lgkmcnt(2)
 v_mfma_f32_16x16x32_bf16 v[64:67], a[32:35], v[32:35], v[64:67]
 ds_read_b128 v[48:51], v6 offset:20480
 v_mfma_f32_16x16x32_bf16 v[72:75], a[96:99], v[32:35], v[72:75]
 ds_read_b128 v[52:55], v6 offset:22528
 v_mfma_f32_16x16x32_bf16 v[80:83], v[32:35], a[160:163], v[80:83]
 v_cvt_pk_bf16_f32 v21, v108, v109
 v_mfma_f32_16x16x32_bf16 v[88:91], v[32:35], a[224:227], v[88:91]
 v_mfma_f32_16x16x32_bf16 v[68:71], a[32:35], v[36:39], v[68:71]
 v_cvt_pk_bf16_f32 v22, v102, v103
 v_mfma_f32_16x16x32_bf16 v[76:79], a[96:99], v[36:39], v[76:79]
 v_mfma_f32_16x16x32_bf16 v[84:87], v[36:39], a[160:163], v[84:87]
 v_cvt_pk_bf16_f32 v23, v110, v111
 v_mfma_f32_16x16x32_bf16 v[92:95], v[36:39], a[224:227], v[92:95]
 s_waitcnt lgkmcnt(2)
 v_mfma_f32_16x16x32_bf16 v[64:67], a[36:39], v[40:43], v[64:67]
 ds_read_b128 v[56:59], v7 offset:20480
 v_mfma_f32_16x16x32_bf16 v[72:75], a[100:103], v[40:43], v[72:75]
 ds_read_b128 v[60:63], v7 offset:22528
 v_mfma_f32_16x16x32_bf16 v[80:83], v[40:43], a[164:167], v[80:83]
 buffer_store_dwordx4 v[20:23], v12, s[20:23], s47 offen offset:1024 sc1
 v_mfma_f32_16x16x32_bf16 v[88:91], v[40:43], a[228:231], v[88:91]
 v_mfma_f32_16x16x32_bf16 v[68:71], a[36:39], v[44:47], v[68:71]
 v_cvt_pk_bf16_f32 v24, v112, v113
 v_mfma_f32_16x16x32_bf16 v[76:79], a[100:103], v[44:47], v[76:79]
 v_mfma_f32_16x16x32_bf16 v[84:87], v[44:47], a[164:167], v[84:87]
 v_cvt_pk_bf16_f32 v25, v116, v117
 v_mfma_f32_16x16x32_bf16 v[92:95], v[44:47], a[228:231], v[92:95]
 s_waitcnt lgkmcnt(2)
 v_mfma_f32_16x16x32_bf16 v[64:67], a[40:43], v[48:51], v[64:67]
 ds_read_b128 v[32:35], v6 offset:24576
 v_mfma_f32_16x16x32_bf16 v[72:75], a[104:107], v[48:51], v[72:75]
 ds_read_b128 v[36:39], v6 offset:26624
 v_mfma_f32_16x16x32_bf16 v[80:83], v[48:51], a[168:171], v[80:83]
 v_mfma_f32_16x16x32_bf16 v[88:91], v[48:51], a[232:235], v[88:91]
 v_cvt_pk_bf16_f32 v26, v114, v115
 v_mfma_f32_16x16x32_bf16 v[68:71], a[40:43], v[52:55], v[68:71]
 v_cvt_pk_bf16_f32 v27, v118, v119
 v_mfma_f32_16x16x32_bf16 v[76:79], a[104:107], v[52:55], v[76:79]
 v_mfma_f32_16x16x32_bf16 v[84:87], v[52:55], a[168:171], v[84:87]
 buffer_store_dwordx4 v[24:27], v12, s[20:23], s48 offen offset:0 sc1
 v_mfma_f32_16x16x32_bf16 v[92:95], v[52:55], a[232:235], v[92:95]
 s_waitcnt lgkmcnt(2)
 v_mfma_f32_16x16x32_bf16 v[64:67], a[44:47], v[56:59], v[64:67]
 ds_read_b128 v[40:43], v7 offset:24576
 v_mfma_f32_16x16x32_bf16 v[72:75], a[108:111], v[56:59], v[72:75]
 ds_read_b128 v[44:47], v7 offset:26624
 v_mfma_f32_16x16x32_bf16 v[80:83], v[56:59], a[172:175], v[80:83]
 s_add_u32 s43, s43, 32768
 s_cmp_eq_u32 s43, 131072
 v_mfma_f32_16x16x32_bf16 v[88:91], v[56:59], a[236:239], v[88:91]
 s_cselect_b32 s43, 0, s43
 s_add_u32 s44, s44, 32768
 v_mfma_f32_16x16x32_bf16 v[68:71], a[44:47], v[60:63], v[68:71]
 s_cmp_eq_u32 s44, 131072
 s_cselect_b32 s44, 0, s44
 v_mfma_f32_16x16x32_bf16 v[76:79], a[108:111], v[60:63], v[76:79]
 v_mfma_f32_16x16x32_bf16 v[84:87], v[60:63], a[172:175], v[84:87]
 v_cvt_pk_bf16_f32 v28, v120, v121
 v_mfma_f32_16x16x32_bf16 v[92:95], v[60:63], a[236:239], v[92:95]
 s_waitcnt lgkmcnt(2)
 v_mfma_f32_16x16x32_bf16 v[64:67], a[48:51], v[32:35], v[64:67]
 ds_read_b128 v[48:51], v6 offset:28672
 v_mfma_f32_16x16x32_bf16 v[72:75], a[112:115], v[32:35], v[72:75]
 ds_read_b128 v[52:55], v6 offset:30720
 v_mfma_f32_16x16x32_bf16 v[80:83], v[32:35], a[176:179], v[80:83]
 v_add_u32 v6, s43, v4
 v_mfma_f32_16x16x32_bf16 v[88:91], v[32:35], a[240:243], v[88:91]
 v_mfma_f32_16x16x32_bf16 v[68:71], a[48:51], v[36:39], v[68:71]
 v_cvt_pk_bf16_f32 v29, v124, v125
 v_mfma_f32_16x16x32_bf16 v[76:79], a[112:115], v[36:39], v[76:79]
 v_cvt_pk_bf16_f32 v30, v122, v123
 v_mfma_f32_16x16x32_bf16 v[84:87], v[36:39], a[176:179], v[84:87]
 v_mfma_f32_16x16x32_bf16 v[92:95], v[36:39], a[240:243], v[92:95]
 s_waitcnt lgkmcnt(2)
 v_mfma_f32_16x16x32_bf16 v[64:67], a[52:55], v[40:43], v[64:67]
 ds_read_b128 v[56:59], v7 offset:28672
 v_mfma_f32_16x16x32_bf16 v[72:75], a[116:119], v[40:43], v[72:75]
 ds_read_b128 v[60:63], v7 offset:30720
 v_mfma_f32_16x16x32_bf16 v[80:83], v[40:43], a[180:183], v[80:83]
 v_add_u32 v7, s43, v5
 v_mfma_f32_16x16x32_bf16 v[88:91], v[40:43], a[244:247], v[88:91]
 v_cvt_pk_bf16_f32 v31, v126, v127
 v_mfma_f32_16x16x32_bf16 v[68:71], a[52:55], v[44:47], v[68:71]
 v_mfma_f32_16x16x32_bf16 v[76:79], a[116:119], v[44:47], v[76:79]
 buffer_store_dwordx4 v[28:31], v12, s[20:23], s48 offen offset:1024 sc1
 v_mfma_f32_16x16x32_bf16 v[84:87], v[44:47], a[180:183], v[84:87]
 v_mfma_f32_16x16x32_bf16 v[92:95], v[44:47], a[244:247], v[92:95]
 s_waitcnt lgkmcnt(2)
 v_mfma_f32_16x16x32_bf16 v[64:67], a[56:59], v[48:51], v[64:67]
 s_waitcnt vmcnt(12)
 s_barrier
 ds_read_b128 v[32:35], v6 offset:0
 v_mfma_f32_16x16x32_bf16 v[72:75], a[120:123], v[48:51], v[72:75]
 ds_read_b128 v[36:39], v6 offset:2048
 v_mfma_f32_16x16x32_bf16 v[80:83], v[48:51], a[184:187], v[80:83]
 v_mfma_f32_16x16x32_bf16 v[88:91], v[48:51], a[248:251], v[88:91]
 v_mfma_f32_16x16x32_bf16 v[68:71], a[56:59], v[52:55], v[68:71]
 v_mfma_f32_16x16x32_bf16 v[76:79], a[120:123], v[52:55], v[76:79]
 v_mfma_f32_16x16x32_bf16 v[84:87], v[52:55], a[184:187], v[84:87]
 v_mfma_f32_16x16x32_bf16 v[92:95], v[52:55], a[248:251], v[92:95]
 s_waitcnt lgkmcnt(2)
 v_mfma_f32_16x16x32_bf16 v[64:67], a[60:63], v[56:59], v[64:67]
 ds_read_b128 v[40:43], v7 offset:0
 v_mfma_f32_16x16x32_bf16 v[72:75], a[124:127], v[56:59], v[72:75]
 ds_read_b128 v[44:47], v7 offset:2048
 v_mfma_f32_16x16x32_bf16 v[80:83], v[56:59], a[188:191], v[80:83]
 s_mul_i32 s45, s39, 524288
 s_add_u32 s47, s34, s45
 v_mfma_f32_16x16x32_bf16 v[88:91], v[56:59], a[252:255], v[88:91]
 s_add_u32 s48, s35, s45
 v_mov_b32 v14, s42
 v_mfma_f32_16x16x32_bf16 v[68:71], a[60:63], v[60:63], v[68:71]
 s_mov_b32 s39, s40
 s_mov_b32 s40, s41
 v_mfma_f32_16x16x32_bf16 v[76:79], a[124:127], v[60:63], v[76:79]
 s_add_u32 s42, s42, 1
 v_mfma_f32_16x16x32_bf16 v[84:87], v[60:63], a[188:191], v[84:87]
 v_mfma_f32_16x16x32_bf16 v[92:95], v[60:63], a[252:255], v[92:95]
 s_waitcnt lgkmcnt(2)
 v_mfma_f32_16x16x32_bf16 v[96:99], a[0:3], v[32:35], 0
 ds_read_b128 v[48:51], v6 offset:4096
 v_mfma_f32_16x16x32_bf16 v[104:107], a[64:67], v[32:35], 0
 ds_read_b128 v[52:55], v6 offset:6144
 v_mfma_f32_16x16x32_bf16 v[112:115], v[32:35], a[128:131], 0
 s_add_u32 s41, s40, 4
 v_mfma_f32_16x16x32_bf16 v[120:123], v[32:35], a[192:195], 0
 s_add_u32 s45, s42, 2
 s_mul_i32 s46, s41, 32768
 v_mfma_f32_16x16x32_bf16 v[100:103], a[0:3], v[36:39], 0
 s_cmp_lt_u32 s45, s36
 s_cselect_b32 s46, s46, 0
 v_mfma_f32_16x16x32_bf16 v[108:111], a[64:67], v[36:39], 0
 s_lshl_b32 s49, s4, 10
 s_add_u32 s49, s49, s44
 v_mfma_f32_16x16x32_bf16 v[116:119], v[36:39], a[128:131], 0
 v_mfma_f32_16x16x32_bf16 v[124:127], v[36:39], a[192:195], 0
 s_waitcnt lgkmcnt(2)
 v_mfma_f32_16x16x32_bf16 v[96:99], a[4:7], v[40:43], v[96:99]
 ds_read_b128 v[56:59], v7 offset:4096
 v_mfma_f32_16x16x32_bf16 v[104:107], a[68:71], v[40:43], v[104:107]
 ds_read_b128 v[60:63], v7 offset:6144
 v_mfma_f32_16x16x32_bf16 v[112:115], v[40:43], a[132:135], v[112:115]
 s_add_u32 m0, s49, 0
 v_mfma_f32_16x16x32_bf16 v[120:123], v[40:43], a[196:199], v[120:123]
 buffer_load_dwordx4 v10, s[8:11], s46 offen offset:0  lds
 v_mfma_f32_16x16x32_bf16 v[100:103], a[4:7], v[44:47], v[100:103]
 s_add_u32 m0, s49, 3968
 v_mfma_f32_16x16x32_bf16 v[108:111], a[68:71], v[44:47], v[108:111]
 buffer_load_dwordx4 v10, s[8:11], s46 offen offset:128  lds
 v_mfma_f32_16x16x32_bf16 v[116:119], v[44:47], a[132:135], v[116:119]
 v_mfma_f32_16x16x32_bf16 v[124:127], v[44:47], a[196:199], v[124:127]
 s_waitcnt lgkmcnt(2)
 v_mfma_f32_16x16x32_bf16 v[96:99], a[8:11], v[48:51], v[96:99]
 ds_read_b128 v[32:35], v6 offset:8192
 v_mfma_f32_16x16x32_bf16 v[104:107], a[72:75], v[48:51], v[104:107]
 ds_read_b128 v[36:39], v6 offset:10240
 v_mfma_f32_16x16x32_bf16 v[112:115], v[48:51], a[136:139], v[112:115]
 s_add_u32 m0, s49, 7936
 v_mfma_f32_16x16x32_bf16 v[120:123], v[48:51], a[200:203], v[120:123]
 buffer_load_dwordx4 v10, s[8:11], s46 offen offset:256  lds
 v_mfma_f32_16x16x32_bf16 v[100:103], a[8:11], v[52:55], v[100:103]
 s_add_u32 m0, s49, 11904
 v_mfma_f32_16x16x32_bf16 v[108:111], a[72:75], v[52:55], v[108:111]
 buffer_load_dwordx4 v10, s[8:11], s46 offen offset:384  lds
 v_mfma_f32_16x16x32_bf16 v[116:119], v[52:55], a[136:139], v[116:119]
 v_mfma_f32_16x16x32_bf16 v[124:127], v[52:55], a[200:203], v[124:127]
 s_waitcnt lgkmcnt(2)
 v_mfma_f32_16x16x32_bf16 v[96:99], a[12:15], v[56:59], v[96:99]
 ds_read_b128 v[40:43], v7 offset:8192
 v_mfma_f32_16x16x32_bf16 v[104:107], a[76:79], v[56:59], v[104:107]
 ds_read_b128 v[44:47], v7 offset:10240
 v_mfma_f32_16x16x32_bf16 v[112:115], v[56:59], a[140:143], v[112:115]
 s_add_u32 m0, s49, 15872
 v_mfma_f32_16x16x32_bf16 v[120:123], v[56:59], a[204:207], v[120:123]
 buffer_load_dwordx4 v10, s[8:11], s46 offen offset:512  lds
 v_mfma_f32_16x16x32_bf16 v[100:103], a[12:15], v[60:63], v[100:103]
 s_add_u32 m0, s49, 19840
 v_mfma_f32_16x16x32_bf16 v[108:111], a[76:79], v[60:63], v[108:111]
 buffer_load_dwordx4 v10, s[8:11], s46 offen offset:640  lds
 v_mfma_f32_16x16x32_bf16 v[116:119], v[60:63], a[140:143], v[116:119]
 v_mfma_f32_16x16x32_bf16 v[124:127], v[60:63], a[204:207], v[124:127]
 s_waitcnt lgkmcnt(2)
 v_mfma_f32_16x16x32_bf16 v[96:99], a[16:19], v[32:35], v[96:99]
 ds_read_b128 v[48:51], v6 offset:12288
 v_mfma_f32_16x16x32_bf16 v[104:107], a[80:83], v[32:35], v[104:107]
 ds_read_b128 v[52:55], v6 offset:14336
 v_mfma_f32_16x16x32_bf16 v[112:115], v[32:35], a[144:147], v[112:115]
 s_add_u32 m0, s49, 23808
 v_mfma_f32_16x16x32_bf16 v[120:123], v[32:35], a[208:211], v[120:123]
 buffer_load_dwordx4 v10, s[8:11], s46 offen offset:768  lds
 v_mfma_f32_16x16x32_bf16 v[100:103], a[16:19], v[36:39], v[100:103]
 s_add_u32 m0, s49, 27776
 v_mfma_f32_16x16x32_bf16 v[108:111], a[80:83], v[36:39], v[108:111]
 buffer_load_dwordx4 v10, s[8:11], s46 offen offset:896  lds
 v_mfma_f32_16x16x32_bf16 v[116:119], v[36:39], a[144:147], v[116:119]
 v_mfma_f32_16x16x32_bf16 v[124:127], v[36:39], a[208:211], v[124:127]
 s_waitcnt lgkmcnt(2)
 v_mfma_f32_16x16x32_bf16 v[96:99], a[20:23], v[40:43], v[96:99]
 ds_read_b128 v[56:59], v7 offset:12288
 v_mfma_f32_16x16x32_bf16 v[104:107], a[84:87], v[40:43], v[104:107]
 ds_read_b128 v[60:63], v7 offset:14336
 v_mfma_f32_16x16x32_bf16 v[112:115], v[40:43], a[148:151], v[112:115]
 v_mfma_f32_16x16x32_bf16 v[120:123], v[40:43], a[212:215], v[120:123]
 v_mfma_f32_16x16x32_bf16 v[100:103], a[20:23], v[44:47], v[100:103]
 v_mfma_f32_16x16x32_bf16 v[108:111], a[84:87], v[44:47], v[108:111]
 v_mfma_f32_16x16x32_bf16 v[116:119], v[44:47], a[148:151], v[116:119]
 v_mfma_f32_16x16x32_bf16 v[124:127], v[44:47], a[212:215], v[124:127]
 s_waitcnt lgkmcnt(2)
 v_mfma_f32_16x16x32_bf16 v[96:99], a[24:27], v[48:51], v[96:99]
 ds_read_b128 v[32:35], v6 offset:16384
 v_mfma_f32_16x16x32_bf16 v[104:107], a[88:91], v[48:51], v[104:107]
 ds_read_b128 v[36:39], v6 offset:18432
 v_mfma_f32_16x16x32_bf16 v[112:115], v[48:51], a[152:155], v[112:115]
 v_cvt_pk_bf16_f32 v16, v64, v65
 v_mfma_f32_16x16x32_bf16 v[120:123], v[48:51], a[216:219], v[120:123]
 v_cvt_pk_bf16_f32 v17, v72, v73
 v_mfma_f32_16x16x32_bf16 v[100:103], a[24:27], v[52:55], v[100:103]
 v_mfma_f32_16x16x32_bf16 v[108:111], a[88:91], v[52:55], v[108:111]
 v_cvt_pk_bf16_f32 v18, v66, v67
 v_mfma_f32_16x16x32_bf16 v[116:119], v[52:55], a[152:155], v[116:119]
 v_mfma_f32_16x16x32_bf16 v[124:127], v[52:55], a[216:219], v[124:127]
 s_waitcnt lgkmcnt(2)
 v_mfma_f32_16x16x32_bf16 v[96:99], a[28:31], v[56:59], v[96:99]
 ds_read_b128 v[40:43], v7 offset:16384
 v_mfma_f32_16x16x32_bf16 v[104:107], a[92:95], v[56:59], v[104:107]
 ds_read_b128 v[44:47], v7 offset:18432
 v_mfma_f32_16x16x32_bf16 v[112:115], v[56:59], a[156:159], v[112:115]
 v_cvt_pk_bf16_f32 v19, v74, v75
 v_mfma_f32_16x16x32_bf16 v[120:123], v[56:59], a[220:223], v[120:123]
 v_mfma_f32_16x16x32_bf16 v[100:103], a[28:31], v[60:63], v[100:103]
 buffer_store_dwordx4 v[16:19], v12, s[20:23], s47 offen offset:0 sc1
 v_mfma_f32_16x16x32_bf16 v[108:111], a[92:95], v[60:63], v[108:111]
 v_cvt_pk_bf16_f32 v20, v68, v69
 v_mfma_f32_16x16x32_bf16 v[116:119], v[60:63], a[156:159], v[116:119]
 v_mfma_f32_16x16x32_bf16 v[124:127], v[60:63], a[220:223], v[124:127]
 s_waitcnt lgkmcnt(2)
 v_mfma_f32_16x16x32_bf16 v[96:99], a[32:35], v[32:35], v[96:99]
 ds_read_b128 v[48:51], v6 offset:20480
 v_mfma_f32_16x16x32_bf16 v[104:107], a[96:99], v[32:35], v[104:107]
 ds_read_b128 v[52:55], v6 offset:22528
 v_mfma_f32_16x16x32_bf16 v[112:115], v[32:35], a[160:163], v[112:115]
 v_cvt_pk_bf16_f32 v21, v76, v77
 v_mfma_f32_16x16x32_bf16 v[120:123], v[32:35], a[224:227], v[120:123]
 v_mfma_f32_16x16x32_bf16 v[100:103], a[32:35], v[36:39], v[100:103]
 v_cvt_pk_bf16_f32 v22, v70, v71
 v_mfma_f32_16x16x32_bf16 v[108:111], a[96:99], v[36:39], v[108:111]
 v_mfma_f32_16x16x32_bf16 v[116:119], v[36:39], a[160:163], v[116:119]
 v_cvt_pk_bf16_f32 v23, v78, v79
 v_mfma_f32_16x16x32_bf16 v[124:127], v[36:39], a[224:227], v[124:127]
 s_waitcnt lgkmcnt(2)
 v_mfma_f32_16x16x32_bf16 v[96:99], a[36:39], v[40:43], v[96:99]
 ds_read_b128 v[56:59], v7 offset:20480
 v_mfma_f32_16x16x32_bf16 v[104:107], a[100:103], v[40:43], v[104:107]
 ds_read_b128 v[60:63], v7 offset:22528
 v_mfma_f32_16x16x32_bf16 v[112:115], v[40:43], a[164:167], v[112:115]
 buffer_store_dwordx4 v[20:23], v12, s[20:23], s47 offen offset:1024 sc1
 v_mfma_f32_16x16x32_bf16 v[120:123], v[40:43], a[228:231], v[120:123]
 v_mfma_f32_16x16x32_bf16 v[100:103], a[36:39], v[44:47], v[100:103]
 v_cvt_pk_bf16_f32 v24, v80, v81
 v_mfma_f32_16x16x32_bf16 v[108:111], a[100:103], v[44:47], v[108:111]
 v_mfma_f32_16x16x32_bf16 v[116:119], v[44:47], a[164:167], v[116:119]
 v_cvt_pk_bf16_f32 v25, v84, v85
 v_mfma_f32_16x16x32_bf16 v[124:127], v[44:47], a[228:231], v[124:127]
 s_waitcnt lgkmcnt(2)
 v_mfma_f32_16x16x32_bf16 v[96:99], a[40:43], v[48:51], v[96:99]
 ds_read_b128 v[32:35], v6 offset:24576
 v_mfma_f32_16x16x32_bf16 v[104:107], a[104:107], v[48:51], v[104:107]
 ds_read_b128 v[36:39], v6 offset:26624
 v_mfma_f32_16x16x32_bf16 v[112:115], v[48:51], a[168:171], v[112:115]
 v_mfma_f32_16x16x32_bf16 v[120:123], v[48:51], a[232:235], v[120:123]
 v_cvt_pk_bf16_f32 v26, v82, v83
 v_mfma_f32_16x16x32_bf16 v[100:103], a[40:43], v[52:55], v[100:103]
 v_cvt_pk_bf16_f32 v27, v86, v87
 v_mfma_f32_16x16x32_bf16 v[108:111], a[104:107], v[52:55], v[108:111]
 v_mfma_f32_16x16x32_bf16 v[116:119], v[52:55], a[168:171], v[116:119]
 buffer_store_dwordx4 v[24:27], v12, s[20:23], s48 offen offset:0 sc1
 v_mfma_f32_16x16x32_bf16 v[124:127], v[52:55], a[232:235], v[124:127]
 s_waitcnt lgkmcnt(2)
 v_mfma_f32_16x16x32_bf16 v[96:99], a[44:47], v[56:59], v[96:99]
 ds_read_b128 v[40:43], v7 offset:24576
 v_mfma_f32_16x16x32_bf16 v[104:107], a[108:111], v[56:59], v[104:107]
 ds_read_b128 v[44:47], v7 offset:26624
 v_mfma_f32_16x16x32_bf16 v[112:115], v[56:59], a[172:175], v[112:115]
 s_add_u32 s43, s43, 32768
 s_cmp_eq_u32 s43, 131072
 v_mfma_f32_16x16x32_bf16 v[120:123], v[56:59], a[236:239], v[120:123]
 s_cselect_b32 s43, 0, s43
 s_add_u32 s44, s44, 32768
 v_mfma_f32_16x16x32_bf16 v[100:103], a[44:47], v[60:63], v[100:103]
 s_cmp_eq_u32 s44, 131072
 s_cselect_b32 s44, 0, s44
 v_mfma_f32_16x16x32_bf16 v[108:111], a[108:111], v[60:63], v[108:111]
 v_mfma_f32_16x16x32_bf16 v[116:119], v[60:63], a[172:175], v[116:119]
 v_cvt_pk_bf16_f32 v28, v88, v89
 v_mfma_f32_16x16x32_bf16 v[124:127], v[60:63], a[236:239], v[124:127]
 s_waitcnt lgkmcnt(2)
 v_mfma_f32_16x16x32_bf16 v[96:99], a[48:51], v[32:35], v[96:99]
 ds_read_b128 v[48:51], v6 offset:28672
 v_mfma_f32_16x16x32_bf16 v[104:107], a[112:115], v[32:35], v[104:107]
 ds_read_b128 v[52:55], v6 offset:30720
 v_mfma_f32_16x16x32_bf16 v[112:115], v[32:35], a[176:179], v[112:115]
 v_add_u32 v6, s43, v4
 v_mfma_f32_16x16x32_bf16 v[120:123], v[32:35], a[240:243], v[120:123]
 v_mfma_f32_16x16x32_bf16 v[100:103], a[48:51], v[36:39], v[100:103]
 v_cvt_pk_bf16_f32 v29, v92, v93
 v_mfma_f32_16x16x32_bf16 v[108:111], a[112:115], v[36:39], v[108:111]
 v_cvt_pk_bf16_f32 v30, v90, v91
 v_mfma_f32_16x16x32_bf16 v[116:119], v[36:39], a[176:179], v[116:119]
 v_mfma_f32_16x16x32_bf16 v[124:127], v[36:39], a[240:243], v[124:127]
 s_waitcnt lgkmcnt(2)
 v_mfma_f32_16x16x32_bf16 v[96:99], a[52:55], v[40:43], v[96:99]
 ds_read_b128 v[56:59], v7 offset:28672
 v_mfma_f32_16x16x32_bf16 v[104:107], a[116:119], v[40:43], v[104:107]
 ds_read_b128 v[60:63], v7 offset:30720
 v_mfma_f32_16x16x32_bf16 v[112:115], v[40:43], a[180:183], v[112:115]
 v_add_u32 v7, s43, v5
 v_mfma_f32_16x16x32_bf16 v[120:123], v[40:43], a[244:247], v[120:123]
 v_cvt_pk_bf16_f32 v31, v94, v95
 v_mfma_f32_16x16x32_bf16 v[100:103], a[52:55], v[44:47], v[100:103]
 v_mfma_f32_16x16x32_bf16 v[108:111], a[116:119], v[44:47], v[108:111]
 buffer_store_dwordx4 v[28:31], v12, s[20:23], s48 offen offset:1024 sc1
 v_mfma_f32_16x16x32_bf16 v[116:119], v[44:47], a[180:183], v[116:119]
 v_mfma_f32_16x16x32_bf16 v[124:127], v[44:47], a[244:247], v[124:127]
 s_waitcnt lgkmcnt(2)
 v_mfma_f32_16x16x32_bf16 v[96:99], a[56:59], v[48:51], v[96:99]
 s_waitcnt vmcnt(12)
 s_barrier
 ds_read_b128 v[32:35], v6 offset:0
 v_mfma_f32_16x16x32_bf16 v[104:107], a[120:123], v[48:51], v[104:107]
 ds_read_b128 v[36:39], v6 offset:2048
 v_mfma_f32_16x16x32_bf16 v[112:115], v[48:51], a[184:187], v[112:115]
 v_mfma_f32_16x16x32_bf16 v[120:123], v[48:51], a[248:251], v[120:123]
 v_mfma_f32_16x16x32_bf16 v[100:103], a[56:59], v[52:55], v[100:103]
 v_mfma_f32_16x16x32_bf16 v[108:111], a[120:123], v[52:55], v[108:111]
 v_mfma_f32_16x16x32_bf16 v[116:119], v[52:55], a[184:187], v[116:119]
 v_mfma_f32_16x16x32_bf16 v[124:127], v[52:55], a[248:251], v[124:127]
 s_waitcnt lgkmcnt(2)
 v_mfma_f32_16x16x32_bf16 v[96:99], a[60:63], v[56:59], v[96:99]
 ds_read_b128 v[40:43], v7 offset:0
 v_mfma_f32_16x16x32_bf16 v[104:107], a[124:127], v[56:59], v[104:107]
 ds_read_b128 v[44:47], v7 offset:2048
 v_mfma_f32_16x16x32_bf16 v[112:115], v[56:59], a[188:191], v[112:115]
 s_mul_i32 s45, s39, 524288
 s_add_u32 s47, s34, s45
 v_mfma_f32_16x16x32_bf16 v[120:123], v[56:59], a[252:255], v[120:123]
 s_add_u32 s48, s35, s45
 v_mov_b32 v14, s42
 v_mfma_f32_16x16x32_bf16 v[100:103], a[60:63], v[60:63], v[100:103]
 s_mov_b32 s39, s40
 s_mov_b32 s40, s41
 v_mfma_f32_16x16x32_bf16 v[108:111], a[124:127], v[60:63], v[108:111]
 s_add_u32 s42, s42, 1
 s_cmp_lt_u32 s42, s36
 v_mfma_f32_16x16x32_bf16 v[116:119], v[60:63], a[188:191], v[116:119]
 v_mfma_f32_16x16x32_bf16 v[124:127], v[60:63], a[252:255], v[124:127]
 s_waitcnt lgkmcnt(2)
 s_cbranch_scc1 Lps_loop_6
 s_nop 7
 v_cvt_pk_bf16_f32 v16, v96, v97
 v_cvt_pk_bf16_f32 v17, v104, v105
 v_cvt_pk_bf16_f32 v18, v98, v99
 v_cvt_pk_bf16_f32 v19, v106, v107
 buffer_store_dwordx4 v[16:19], v12, s[20:23], s47 offen offset:0 sc1
 v_cvt_pk_bf16_f32 v20, v100, v101
 v_cvt_pk_bf16_f32 v21, v108, v109
 v_cvt_pk_bf16_f32 v22, v102, v103
 v_cvt_pk_bf16_f32 v23, v110, v111
 buffer_store_dwordx4 v[20:23], v12, s[20:23], s47 offen offset:1024 sc1
 v_cvt_pk_bf16_f32 v24, v112, v113
 v_cvt_pk_bf16_f32 v25, v116, v117
 v_cvt_pk_bf16_f32 v26, v114, v115
 v_cvt_pk_bf16_f32 v27, v118, v119
 buffer_store_dwordx4 v[24:27], v12, s[20:23], s48 offen offset:0 sc1
 v_cvt_pk_bf16_f32 v28, v120, v121
 v_cvt_pk_bf16_f32 v29, v124, v125
 v_cvt_pk_bf16_f32 v30, v122, v123
 v_cvt_pk_bf16_f32 v31, v126, v127
 buffer_store_dwordx4 v[28:31], v12, s[20:23], s48 offen offset:1024 sc1
 s_waitcnt vmcnt(0) lgkmcnt(0)
 s_barrier
 v_mov_b32 v14, s36
 buffer_store_dword v14, v13, s[20:23], 0 offen sc1
 s_mov_b32 s32, s3
 s_and_b32 s33, s6, 3
 s_sub_u32 s34, 7, s33
 v_and_b32 v1, 63, v0
 v_lshlrev_b32 v1, 4, v1
 v_mov_b32 v4, 0xff800000
 v_min_u32 v5, 1, v0
 v_lshlrev_b32 v5, 28, v5
 v_mov_b32 v6, 0x3f803f80
 v_accvgpr_write_b32 a192, v6
 v_accvgpr_write_b32 a193, v6
 v_accvgpr_write_b32 a194, v6
 v_accvgpr_write_b32 a195, v6
 s_mov_b32 s52, 0xfff0ffff
 s_mov_b32 s53, 0xf000ff00
 s_mov_b32 s54, 0xffe0fffe
 s_mov_b32 s55, 0xe000fe00
 s_mov_b32 s56, 0xffc0fffc
 s_mov_b32 s57, 0xc000fc00
 s_mov_b32 s58, 0xff80fff8
 s_mov_b32 s59, 0x8000f800
 s_mov_b32 s73, 0x53800000
 s_mov_b32 s74, 0x21800000
 s_lshl_b32 s50, s4, 12
 s_lshl_b32 s45, s32, 14
 s_add_u32 s45, s45, s50
 s_add_u32 s45, s45, 0x1000000
 s_lshl_b32 s36, s33, 3
 s_add_u32 s36, s36, 8
 s_lshl_b32 s47, s34, 3
 s_add_u32 s47, s47, 8
 s_mov_b32 s35, 0
 s_mov_b32 s38, 0
 s_mov_b32 s46, 0
 s_lshl_b32 s7, s3, 7
 s_add_u32 s7, s7, 0x2000
 s_lshr_b32 s94, s3, 1
 s_lshl_b32 s94, s94, 7
 s_add_u32 s94, s94, 0x3000
 v_mov_b32 v8, 0
Law_7:
 buffer_load_dwordx4 v[16:19], v8, s[20:23], s7 offen sc1
 buffer_load_dwordx4 v[20:23], v8, s[20:23], s94 offen sc1
 s_waitcnt vmcnt(0)
 v_min3_u32 v16, v16, v17, v18
 v_min3_u32 v16, v16, v19, v20
 v_min3_u32 v16, v16, v21, v22
 v_min_u32 v16, v16, v23
 v_cmp_le_u32 vcc, 16, v16
 s_cbranch_vccnz Lawk_8
 s_sleep 2
 s_sub_u32 s95, s95, 1
 s_cbranch_scc0 Law_7
 s_endpgm
Lawk_8:
 s_lshl_b32 s37, s35, 19
 s_add_u32 m0, s38, s50
 s_add_u32 s37, s37, s45
 buffer_load_dwordx4 v1, s[20:23], s37 offen offset:0 sc1 lds
 buffer_load_dwordx4 v1, s[20:23], s37 offen offset:1024 sc1 lds
 buffer_load_dwordx4 v1, s[20:23], s37 offen offset:2048 sc1 lds
 buffer_load_dwordx4 v1, s[20:23], s37 offen offset:3072 sc1 lds
 s_add_u32 s38, s38, 0x4000
 s_and_b32 s38, s38, 0x1ffff
 s_add_u32 s35, s35, 1
 s_cmp_eq_u32 s35, s36
 s_cselect_b32 s36, s47, s36
 s_cselect_b32 s35, 0, s35
 s_lshl_b32 s44, s33, 3
 s_add_u32 s44, s44, s4
 s_lshl_b32 s44, s44, 5
 s_add_u32 s44, s44, s32
 s_lshl_b32 s44, s44, 13
 s_add_u32 s44, s44, 0x5000000
 buffer_load_dwordx4 a[0:3], v1, s[20:23], s44 offen offset:0 sc1
 buffer_load_dwordx4 a[16:19], v1, s[20:23], s44 offen offset:1024 sc1
 buffer_load_dwordx4 a[4:7], v1, s[20:23], s44 offen offset:2048 sc1
 buffer_load_dwordx4 a[20:23], v1, s[20:23], s44 offen offset:3072 sc1
 s_add_u32 s44, s44, 4096
 buffer_load_dwordx4 a[8:11], v1, s[20:23], s44 offen offset:0 sc1
 buffer_load_dwordx4 a[24:27], v1, s[20:23], s44 offen offset:1024 sc1
 buffer_load_dwordx4 a[12:15], v1, s[20:23], s44 offen offset:2048 sc1
 buffer_load_dwordx4 a[28:31], v1, s[20:23], s44 offen offset:3072 sc1
 s_lshl_b32 s44, s33, 3
 s_add_u32 s44, s44, 7
 s_sub_u32 s44, s44, s4
 s_lshl_b32 s44, s44, 5
 s_add_u32 s44, s44, s32
 s_lshl_b32 s44, s44, 13
 s_add_u32 s44, s44, 0x5000000
 buffer_load_dwordx4 a[32:35], v1, s[20:23], s44 offen offset:0 sc1
 buffer_load_dwordx4 a[48:51], v1, s[20:23], s44 offen offset:1024 sc1
 buffer_load_dwordx4 a[36:39], v1, s[20:23], s44 offen offset:2048 sc1
 buffer_load_dwordx4 a[52:55], v1, s[20:23], s44 offen offset:3072 sc1
 s_add_u32 s44, s44, 4096
 buffer_load_dwordx4 a[40:43], v1, s[20:23], s44 offen offset:0 sc1
 buffer_load_dwordx4 a[56:59], v1, s[20:23], s44 offen offset:1024 sc1
 buffer_load_dwordx4 a[44:47], v1, s[20:23], s44 offen offset:2048 sc1
 buffer_load_dwordx4 a[60:63], v1, s[20:23], s44 offen offset:3072 sc1
 s_lshl_b32 s37, s35, 19
 s_add_u32 m0, s38, s50
 s_add_u32 s37, s37, s45
 buffer_load_dwordx4 v1, s[20:23], s37 offen offset:0 sc1 lds
 buffer_load_dwordx4 v1, s[20:23], s37 offen offset:1024 sc1 lds
 buffer_load_dwordx4 v1, s[20:23], s37 offen offset:2048 sc1 lds
 buffer_load_dwordx4 v1, s[20:23], s37 offen offset:3072 sc1 lds
 s_add_u32 s38, s38, 0x4000
 s_and_b32 s38, s38, 0x1ffff
 s_add_u32 s35, s35, 1
 s_cmp_eq_u32 s35, s36
 s_cselect_b32 s36, s47, s36
 s_cselect_b32 s35, 0, s35
 s_lshl_b32 s37, s35, 19
 s_add_u32 m0, s38, s50
 s_add_u32 s37, s37, s45
 buffer_load_dwordx4 v1, s[20:23], s37 offen offset:0 sc1 lds
 buffer_load_dwordx4 v1, s[20:23], s37 offen offset:1024 sc1 lds
 buffer_load_dwordx4 v1, s[20:23], s37 offen offset:2048 sc1 lds
 buffer_load_dwordx4 v1, s[20:23], s37 offen offset:3072 sc1 lds
 s_add_u32 s38, s38, 0x4000
 s_and_b32 s38, s38, 0x1ffff
 s_add_u32 s35, s35, 1
 s_cmp_eq_u32 s35, s36
 s_cselect_b32 s36, s47, s36
 s_cselect_b32 s35, 0, s35
 s_lshl_b32 s37, s35, 19
 s_add_u32 m0, s38, s50
 s_add_u32 s37, s37, s45
 buffer_load_dwordx4 v1, s[20:23], s37 offen offset:0 sc1 lds
 buffer_load_dwordx4 v1, s[20:23], s37 offen offset:1024 sc1 lds
 buffer_load_dwordx4 v1, s[20:23], s37 offen offset:2048 sc1 lds
 buffer_load_dwordx4 v1, s[20:23], s37 offen offset:3072 sc1 lds
 s_add_u32 s38, s38, 0x4000
 s_and_b32 s38, s38, 0x1ffff
 s_add_u32 s35, s35, 1
 s_cmp_eq_u32 s35, s36
 s_cselect_b32 s36, s47, s36
 s_cselect_b32 s35, 0, s35
 s_lshl_b32 s37, s35, 19
 s_add_u32 m0, s38, s50
 s_add_u32 s37, s37, s45
 buffer_load_dwordx4 v1, s[20:23], s37 offen offset:0 sc1 lds
 buffer_load_dwordx4 v1, s[20:23], s37 offen offset:1024 sc1 lds
 buffer_load_dwordx4 v1, s[20:23], s37 offen offset:2048 sc1 lds
 buffer_load_dwordx4 v1, s[20:23], s37 offen offset:3072 sc1 lds
 s_add_u32 s38, s38, 0x4000
 s_and_b32 s38, s38, 0x1ffff
 s_add_u32 s35, s35, 1
 s_cmp_eq_u32 s35, s36
 s_cselect_b32 s36, s47, s36
 s_cselect_b32 s35, 0, s35
 s_lshl_b32 s37, s35, 19
 s_add_u32 m0, s38, s50
 s_add_u32 s37, s37, s45
 buffer_load_dwordx4 v1, s[20:23], s37 offen offset:0 sc1 lds
 buffer_load_dwordx4 v1, s[20:23], s37 offen offset:1024 sc1 lds
 buffer_load_dwordx4 v1, s[20:23], s37 offen offset:2048 sc1 lds
 buffer_load_dwordx4 v1, s[20:23], s37 offen offset:3072 sc1 lds
 s_add_u32 s38, s38, 0x4000
 s_and_b32 s38, s38, 0x1ffff
 s_add_u32 s35, s35, 1
 s_cmp_eq_u32 s35, s36
 s_cselect_b32 s36, s47, s36
 s_cselect_b32 s35, 0, s35
 s_lshl_b32 s37, s35, 19
 s_add_u32 m0, s38, s50
 s_add_u32 s37, s37, s45
 buffer_load_dwordx4 v1, s[20:23], s37 offen offset:0 sc1 lds
 buffer_load_dwordx4 v1, s[20:23], s37 offen offset:1024 sc1 lds
 buffer_load_dwordx4 v1, s[20:23], s37 offen offset:2048 sc1 lds
 buffer_load_dwordx4 v1, s[20:23], s37 offen offset:3072 sc1 lds
 s_add_u32 s38, s38, 0x4000
 s_and_b32 s38, s38, 0x1ffff
 s_add_u32 s35, s35, 1
 s_cmp_eq_u32 s35, s36
 s_cselect_b32 s36, s47, s36
 s_cselect_b32 s35, 0, s35
 s_lshl_b32 s44, s34, 3
 s_add_u32 s44, s44, s4
 s_lshl_b32 s44, s44, 5
 s_add_u32 s44, s44, s32
 s_lshl_b32 s44, s44, 13
 s_add_u32 s44, s44, 0x5000000
 buffer_load_dwordx4 a[64:67], v1, s[20:23], s44 offen offset:0 sc1
 buffer_load_dwordx4 a[80:83], v1, s[20:23], s44 offen offset:1024 sc1
 buffer_load_dwordx4 a[68:71], v1, s[20:23], s44 offen offset:2048 sc1
 buffer_load_dwordx4 a[84:87], v1, s[20:23], s44 offen offset:3072 sc1
 s_add_u32 s44, s44, 4096
 buffer_load_dwordx4 a[72:75], v1, s[20:23], s44 offen offset:0 sc1
 buffer_load_dwordx4 a[88:91], v1, s[20:23], s44 offen offset:1024 sc1
 buffer_load_dwordx4 a[76:79], v1, s[20:23], s44 offen offset:2048 sc1
 buffer_load_dwordx4 a[92:95], v1, s[20:23], s44 offen offset:3072 sc1
 s_lshl_b32 s44, s34, 3
 s_add_u32 s44, s44, 7
 s_sub_u32 s44, s44, s4
 s_lshl_b32 s44, s44, 5
 s_add_u32 s44, s44, s32
 s_lshl_b32 s44, s44, 13
 s_add_u32 s44, s44, 0x5000000
 buffer_load_dwordx4 a[96:99], v1, s[20:23], s44 offen offset:0 sc1
 buffer_load_dwordx4 a[112:115], v1, s[20:23], s44 offen offset:1024 sc1
 buffer_load_dwordx4 a[100:103], v1, s[20:23], s44 offen offset:2048 sc1
 buffer_load_dwordx4 a[116:119], v1, s[20:23], s44 offen offset:3072 sc1
 s_add_u32 s44, s44, 4096
 buffer_load_dwordx4 a[104:107], v1, s[20:23], s44 offen offset:0 sc1
 buffer_load_dwordx4 a[120:123], v1, s[20:23], s44 offen offset:1024 sc1
 buffer_load_dwordx4 a[108:111], v1, s[20:23], s44 offen offset:2048 sc1
 buffer_load_dwordx4 a[124:127], v1, s[20:23], s44 offen offset:3072 sc1
 s_waitcnt vmcnt(40)
 s_barrier
 v_mov_b32 v2, v1
 ds_read_b128 a[128:131], v2 offset:0
 ds_read_b128 a[132:135], v2 offset:1024
 ds_read_b128 a[136:139], v2 offset:2048
 ds_read_b128 a[140:143], v2 offset:3072
 ds_read_b128 a[144:147], v2 offset:4096
 ds_read_b128 a[148:151], v2 offset:5120
 ds_read_b128 a[152:155], v2 offset:6144
 ds_read_b128 a[156:159], v2 offset:7168
 s_mov_b32 s39, 0
 s_add_u32 s39, s39, 0x4000
 s_and_b32 s39, s39, 0x1ffff
 v_mov_b32 v3, v2
 v_add_u32 v2, s39, v1
 s_mov_b32 s72, 0x8000000
Lablk_9:
 s_lshl_b32 s43, s33, 3
 s_add_u32 s41, s43, s4
 s_add_u32 s42, s43, 7
 s_sub_u32 s42, s42, s4
 s_mov_b32 s49, 0
 s_waitcnt lgkmcnt(0)
 v_mfma_f32_16x16x32_bf16 v[48:51], a[128:131], a[0:3], 0
 s_cmp_lt_u32 s49, s41
 v_mov_b64 v[176:177], 0
 v_mov_b64 v[178:179], 0
 v_mfma_f32_16x16x32_bf16 v[56:59], a[128:131], a[16:19], 0
 s_cselect_b64 s[68:69], -1, 0
 v_mov_b64 v[180:181], 0
 v_mov_b64 v[182:183], 0
 v_mfma_f32_16x16x32_bf16 v[64:67], a[128:131], a[32:35], 0
 v_mfma_f32_16x16x32_bf16 v[72:75], a[128:131], a[48:51], 0
 s_cmp_le_u32 s49, s41
 v_mov_b64 v[184:185], 0
 v_mov_b64 v[186:187], 0
 v_mfma_f32_16x16x32_bf16 v[48:51], a[136:139], a[4:7], v[48:51]
 v_mfma_f32_16x16x32_bf16 v[56:59], a[136:139], a[20:23], v[56:59]
 s_cselect_b64 s[70:71], -1, 0
 v_mov_b64 v[188:189], 0
 v_mov_b64 v[190:191], 0
 v_mfma_f32_16x16x32_bf16 v[64:67], a[136:139], a[36:39], v[64:67]
 v_mfma_f32_16x16x32_bf16 v[72:75], a[136:139], a[52:55], v[72:75]
 s_cmp_eq_u32 s49, s41
 v_mov_b64 v[192:193], 0
 v_mov_b64 v[194:195], 0
 v_mfma_f32_16x16x32_bf16 v[48:51], a[144:147], a[8:11], v[48:51]
 s_cselect_b64 s[60:61], s[52:53], s[68:69]
 v_mfma_f32_16x16x32_bf16 v[56:59], a[144:147], a[24:27], v[56:59]
 v_mov_b64 v[196:197], 0
 v_mov_b64 v[198:199], 0
 v_mfma_f32_16x16x32_bf16 v[64:67], a[144:147], a[40:43], v[64:67]
 s_cselect_b64 s[62:63], s[54:55], s[68:69]
 v_mfma_f32_16x16x32_bf16 v[72:75], a[144:147], a[56:59], v[72:75]
 v_mov_b64 v[200:201], 0
 v_mov_b64 v[202:203], 0
 v_mfma_f32_16x16x32_bf16 v[48:51], a[152:155], a[12:15], v[48:51]
 s_cselect_b64 s[64:65], s[56:57], s[68:69]
 v_mfma_f32_16x16x32_bf16 v[56:59], a[152:155], a[28:31], v[56:59]
 v_mov_b64 v[204:205], 0
 v_mov_b64 v[206:207], 0
 v_mfma_f32_16x16x32_bf16 v[64:67], a[152:155], a[44:47], v[64:67]
 s_cselect_b64 s[66:67], s[58:59], s[68:69]
 v_mfma_f32_16x16x32_bf16 v[72:75], a[152:155], a[60:63], v[72:75]
 s_nop 4
 v_max3_f32 v12, v48, v49, v50
 v_max3_f32 v13, v56, v57, v58
 v_max3_f32 v14, v64, v65, v66
 v_max3_f32 v15, v72, v73, v74
 v_max_f32 v12, v12, v51
 v_max_f32 v13, v13, v59
 v_max_f32 v14, v14, v67
 v_max_f32 v15, v15, v75
 v_mov_b32 v6, v12
 v_mov_b32 v7, v13
 v_mov_b32 v8, v14
 v_mov_b32 v9, v15
 v_permlane16_swap_b32 v12, v6
 v_permlane16_swap_b32 v13, v7
 v_permlane16_swap_b32 v14, v8
 v_permlane16_swap_b32 v15, v9
 v_max_f32 v12, v12, v6
 v_max_f32 v13, v13, v7
 v_max_f32 v14, v14, v8
 v_max_f32 v15, v15, v9
 v_mov_b32 v6, v12
 v_mov_b32 v7, v13
 v_mov_b32 v8, v14
 v_mov_b32 v9, v15
 v_permlane32_swap_b32 v12, v6
 v_permlane32_swap_b32 v13, v7
 v_permlane32_swap_b32 v14, v8
 v_permlane32_swap_b32 v15, v9
 v_max_f32 v12, v12, v6
 v_max_f32 v13, v13, v7
 v_max_f32 v14, v14, v8
 v_max_f32 v15, v15, v9
 v_sub_f32 v12, 0, v12
 v_sub_f32 v13, 0, v13
 v_sub_f32 v14, 0, v14
 v_sub_f32 v15, 0, v15
 v_cndmask_b32 v80, v4, v12, s[60:61]
 v_cndmask_b32 v81, v4, v12, s[62:63]
 v_cndmask_b32 v82, v4, v12, s[64:65]
 v_cndmask_b32 v83, v4, v12, s[66:67]
 v_cndmask_b32 v84, v4, v12, s[68:69]
 v_cndmask_b32 v85, v4, v12, s[68:69]
 v_cndmask_b32 v86, v4, v12, s[68:69]
 v_cndmask_b32 v87, v4, v12, s[68:69]
 v_cndmask_b32 v88, v4, v13, s[70:71]
 v_cndmask_b32 v89, v4, v13, s[70:71]
 v_cndmask_b32 v90, v4, v13, s[70:71]
 v_cndmask_b32 v91, v4, v13, s[70:71]
 v_cndmask_b32 v92, v4, v13, s[60:61]
 v_cndmask_b32 v93, v4, v13, s[62:63]
 v_cndmask_b32 v94, v4, v13, s[64:65]
 v_cndmask_b32 v95, v4, v13, s[66:67]
 v_mov_b32 v96, v14
 v_mov_b32 v97, v14
 v_mov_b32 v98, v14
 v_mov_b32 v99, v14
 v_mov_b32 v100, v14
 v_mov_b32 v101, v14
 v_mov_b32 v102, v14
 v_mov_b32 v103, v14
 v_mov_b32 v104, v15
 v_mov_b32 v105, v15
 v_mov_b32 v106, v15
 v_mov_b32 v107, v15
 v_mov_b32 v108, v15
 v_mov_b32 v109, v15
 v_mov_b32 v110, v15
 v_mov_b32 v111, v15
 v_mov_b32 v6, 1
 s_waitcnt lgkmcnt(0)
 v_mfma_f32_16x16x32_bf16 v[48:51], a[128:131], a[0:3], v[80:83]
 ds_read_b128 a[160:163], v3 offset:8192
 v_mov_b64 v[208:209], 0
 v_mov_b64 v[210:211], 0
 v_mfma_f32_16x16x32_bf16 v[56:59], a[128:131], a[16:19], v[88:91]
 v_mov_b64 v[212:213], 0
 v_mov_b64 v[214:215], 0
 v_mfma_f32_16x16x32_bf16 v[52:55], a[132:135], a[0:3], v[84:87]
 ds_read_b128 a[164:167], v3 offset:9216
 v_mfma_f32_16x16x32_bf16 v[60:63], a[132:135], a[16:19], v[92:95]
 v_mov_b64 v[216:217], 0
 v_mov_b64 v[218:219], 0
 v_mfma_f32_16x16x32_bf16 v[48:51], a[136:139], a[4:7], v[48:51]
 ds_read_b128 a[168:171], v3 offset:10240
 v_mov_b64 v[220:221], 0
 v_mov_b64 v[222:223], 0
 v_mfma_f32_16x16x32_bf16 v[56:59], a[136:139], a[20:23], v[56:59]
 v_mfma_f32_16x16x32_bf16 v[52:55], a[140:143], a[4:7], v[52:55]
 ds_read_b128 a[172:175], v3 offset:11264
 v_mov_b64 v[224:225], 0
 v_mov_b64 v[226:227], 0
 v_mfma_f32_16x16x32_bf16 v[60:63], a[140:143], a[20:23], v[60:63]
 v_mov_b64 v[228:229], 0
 v_mov_b64 v[230:231], 0
 v_mfma_f32_16x16x32_bf16 v[48:51], a[144:147], a[8:11], v[48:51]
 ds_read_b128 a[176:179], v3 offset:12288
 v_mfma_f32_16x16x32_bf16 v[56:59], a[144:147], a[24:27], v[56:59]
 v_mov_b64 v[232:233], 0
 v_mov_b64 v[234:235], 0
 v_mfma_f32_16x16x32_bf16 v[52:55], a[148:151], a[8:11], v[52:55]
 ds_read_b128 a[180:183], v3 offset:13312
 v_mov_b64 v[236:237], 0
 v_mov_b64 v[238:239], 0
 v_mfma_f32_16x16x32_bf16 v[60:63], a[148:151], a[24:27], v[60:63]
 v_mfma_f32_16x16x32_bf16 v[48:51], a[152:155], a[12:15], v[48:51]
 ds_read_b128 a[184:187], v3 offset:14336
 v_mov_b64 v[40:41], 0
 v_mov_b64 v[42:43], 0
 v_mfma_f32_16x16x32_bf16 v[56:59], a[152:155], a[28:31], v[56:59]
 v_mov_b64 v[44:45], 0
 v_mov_b64 v[46:47], 0
 v_mfma_f32_16x16x32_bf16 v[52:55], a[156:159], a[12:15], v[52:55]
 ds_read_b128 a[188:191], v3 offset:15360
 v_mfma_f32_16x16x32_bf16 v[60:63], a[156:159], a[28:31], v[60:63]
 v_mfma_f32_16x16x32_bf16 v[64:67], a[128:131], a[32:35], v[96:99]
 s_waitcnt vmcnt(0)
 s_barrier
 buffer_store_dword v6, v5, s[20:23], s72 offen sc1
 v_mfma_f32_16x16x32_bf16 v[72:75], a[128:131], a[48:51], v[104:107]
 ds_read_b128 a[128:131], v2 offset:0
 v_mfma_f32_16x16x32_bf16 v[68:71], a[132:135], a[32:35], v[100:103]
 s_add_u32 s49, s49, 1
 v_mfma_f32_16x16x32_bf16 v[76:79], a[132:135], a[48:51], v[108:111]
 ds_read_b128 a[132:135], v2 offset:1024
 v_exp_f32 v48, v48
 v_exp_f32 v49, v49
 v_mfma_f32_16x16x32_bf16 v[64:67], a[136:139], a[36:39], v[64:67]
 s_cmp_lt_u32 s49, s41
 v_exp_f32 v52, v52
 v_exp_f32 v53, v53
 v_mfma_f32_16x16x32_bf16 v[72:75], a[136:139], a[52:55], v[72:75]
 ds_read_b128 a[136:139], v2 offset:2048
 v_exp_f32 v50, v50
 v_mfma_f32_16x16x32_bf16 v[68:71], a[140:143], a[36:39], v[68:71]
 s_cselect_b64 s[68:69], -1, 0
 v_cvt_pk_bf16_f32 v16, v48, v49
 v_cvt_pk_bf16_f32 v17, v52, v53
 v_exp_f32 v51, v51
 v_mfma_f32_16x16x32_bf16 v[76:79], a[140:143], a[52:55], v[76:79]
 ds_read_b128 a[140:143], v2 offset:3072
 v_exp_f32 v54, v54
 v_exp_f32 v55, v55
 v_mfma_f32_16x16x32_bf16 v[64:67], a[144:147], a[40:43], v[64:67]
 v_cvt_pk_bf16_f32 v18, v50, v51
 v_cvt_pk_bf16_f32 v19, v54, v55
 v_mfma_f32_16x16x32_bf16 v[72:75], a[144:147], a[56:59], v[72:75]
 ds_read_b128 a[144:147], v2 offset:4096
 v_exp_f32 v56, v56
 v_exp_f32 v57, v57
 v_mfma_f32_16x16x32_bf16 v[68:71], a[148:151], a[40:43], v[68:71]
 s_cmp_le_u32 s49, s41
 v_exp_f32 v60, v60
 v_exp_f32 v61, v61
 v_mfma_f32_16x16x32_bf16 v[76:79], a[148:151], a[56:59], v[76:79]
 ds_read_b128 a[148:151], v2 offset:5120
 v_exp_f32 v58, v58
 v_mfma_f32_16x16x32_bf16 v[64:67], a[152:155], a[44:47], v[64:67]
 s_cselect_b64 s[70:71], -1, 0
 v_cvt_pk_bf16_f32 v20, v56, v57
 v_cvt_pk_bf16_f32 v21, v60, v61
 v_exp_f32 v59, v59
 v_mfma_f32_16x16x32_bf16 v[72:75], a[152:155], a[60:63], v[72:75]
 ds_read_b128 a[152:155], v2 offset:6144
 v_exp_f32 v62, v62
 v_exp_f32 v63, v63
 v_mfma_f32_16x16x32_bf16 v[68:71], a[156:159], a[44:47], v[68:71]
 v_cvt_pk_bf16_f32 v22, v58, v59
 v_cvt_pk_bf16_f32 v23, v62, v63
 v_mfma_f32_16x16x32_bf16 v[76:79], a[156:159], a[60:63], v[76:79]
 ds_read_b128 a[156:159], v2 offset:7168
 s_waitcnt lgkmcnt(8)
 v_mfma_f32_16x16x32_bf16 v[112:115], a[160:163], v[16:19], 0
 s_add_u32 s39, s39, 0x4000
 s_and_b32 s39, s39, 0x1ffff
 v_mfma_f32_16x16x32_bf16 v[144:147], a[160:163], v[20:23], 0
 s_cmp_eq_u32 s49, s41
 v_mfma_f32_16x16x32_bf16 v[116:119], a[164:167], v[16:19], 0
 s_cselect_b64 s[60:61], s[52:53], s[68:69]
 v_mfma_f32_16x16x32_bf16 v[148:151], a[164:167], v[20:23], 0
 s_cselect_b64 s[62:63], s[54:55], s[68:69]
 v_mov_b32 v3, v2
 v_add_u32 v2, s39, v1
 v_exp_f32 v64, v64
 v_mfma_f32_16x16x32_bf16 v[120:123], a[168:171], v[16:19], 0
 s_cselect_b64 s[64:65], s[56:57], s[68:69]
 v_exp_f32 v65, v65
 v_mfma_f32_16x16x32_bf16 v[152:155], a[168:171], v[20:23], 0
 s_cselect_b64 s[66:67], s[58:59], s[68:69]
 v_exp_f32 v68, v68
 v_mfma_f32_16x16x32_bf16 v[124:127], a[172:175], v[16:19], 0
 s_lshl_b32 s37, s35, 19
 v_exp_f32 v69, v69
 v_exp_f32 v66, v66
 v_mfma_f32_16x16x32_bf16 v[156:159], a[172:175], v[20:23], 0
 s_add_u32 m0, s38, s50
 v_cvt_pk_bf16_f32 v24, v64, v65
 v_cvt_pk_bf16_f32 v25, v68, v69
 v_mfma_f32_16x16x32_bf16 v[128:131], a[176:179], v[16:19], 0
 s_add_u32 s37, s37, s45
 v_exp_f32 v67, v67
 v_mfma_f32_16x16x32_bf16 v[160:163], a[176:179], v[20:23], 0
 buffer_load_dwordx4 v1, s[20:23], s37 offen offset:0 sc1 lds
 buffer_load_dwordx4 v1, s[20:23], s37 offen offset:1024 sc1 lds
 v_exp_f32 v70, v70
 v_mfma_f32_16x16x32_bf16 v[132:135], a[180:183], v[16:19], 0
 buffer_load_dwordx4 v1, s[20:23], s37 offen offset:2048 sc1 lds
 v_exp_f32 v71, v71
 v_cvt_pk_bf16_f32 v26, v66, v67
 v_cvt_pk_bf16_f32 v27, v70, v71
 v_mfma_f32_16x16x32_bf16 v[164:167], a[180:183], v[20:23], 0
 buffer_load_dwordx4 v1, s[20:23], s37 offen offset:3072 sc1 lds
 v_cndmask_b32 v80, v4, v12, s[60:61]
 v_cndmask_b32 v81, v4, v12, s[62:63]
 v_mfma_f32_16x16x32_bf16 v[136:139], a[184:187], v[16:19], 0
 s_add_u32 s38, s38, 0x4000
 v_cndmask_b32 v82, v4, v12, s[64:65]
 v_cndmask_b32 v83, v4, v12, s[66:67]
 v_mfma_f32_16x16x32_bf16 v[168:171], a[184:187], v[20:23], 0
 s_and_b32 s38, s38, 0x1ffff
 v_cndmask_b32 v84, v4, v12, s[68:69]
 v_cndmask_b32 v85, v4, v12, s[68:69]
 v_mfma_f32_16x16x32_bf16 v[140:143], a[188:191], v[16:19], 0
 s_add_u32 s35, s35, 1
 v_cndmask_b32 v86, v4, v12, s[68:69]
 v_cndmask_b32 v87, v4, v12, s[68:69]
 v_cndmask_b32 v88, v4, v13, s[70:71]
 v_cndmask_b32 v89, v4, v13, s[70:71]
 v_mfma_f32_16x16x32_bf16 v[172:175], a[188:191], v[20:23], 0
 s_cmp_eq_u32 s35, s36
 v_cndmask_b32 v90, v4, v13, s[70:71]
 v_cndmask_b32 v91, v4, v13, s[70:71]
 v_mfma_f32_16x16x32_bf16 v[32:35], a[192:195], v[16:19], 0
 s_cselect_b32 s36, s47, s36
 v_cndmask_b32 v92, v4, v13, s[60:61]
 v_cndmask_b32 v93, v4, v13, s[62:63]
 v_mfma_f32_16x16x32_bf16 v[36:39], a[192:195], v[20:23], 0
 s_cselect_b32 s35, 0, s35
 v_cndmask_b32 v94, v4, v13, s[64:65]
 v_cndmask_b32 v95, v4, v13, s[66:67]
 s_cmp_eq_u32 s43, 0
 s_cbranch_scc1 Lamk_14
 s_sub_u32 s40, s43, 1
 .p2align 3
Lapl_13:
 s_waitcnt lgkmcnt(0)
 v_mfma_f32_16x16x32_bf16 v[48:51], a[128:131], a[0:3], v[80:83]
 v_exp_f32 v72, v72
 v_mfma_f32_16x16x32_bf16 v[56:59], a[128:131], a[16:19], v[88:91]
 v_exp_f32 v73, v73
 v_mfma_f32_16x16x32_bf16 v[52:55], a[132:135], a[0:3], v[84:87]
 v_mfma_f32_16x16x32_bf16 v[60:63], a[132:135], a[16:19], v[92:95]
 v_exp_f32 v76, v76
 v_mfma_f32_16x16x32_bf16 v[48:51], a[136:139], a[4:7], v[48:51]
 v_exp_f32 v77, v77
 v_mfma_f32_16x16x32_bf16 v[56:59], a[136:139], a[20:23], v[56:59]
 v_mfma_f32_16x16x32_bf16 v[52:55], a[140:143], a[4:7], v[52:55]
 v_exp_f32 v74, v74
 v_mfma_f32_16x16x32_bf16 v[60:63], a[140:143], a[20:23], v[60:63]
 v_cvt_pk_bf16_f32 v28, v72, v73
 v_cvt_pk_bf16_f32 v29, v76, v77
 v_mfma_f32_16x16x32_bf16 v[48:51], a[144:147], a[8:11], v[48:51]
 v_mfma_f32_16x16x32_bf16 v[56:59], a[144:147], a[24:27], v[56:59]
 v_exp_f32 v75, v75
 v_mfma_f32_16x16x32_bf16 v[52:55], a[148:151], a[8:11], v[52:55]
 v_exp_f32 v78, v78
 v_mfma_f32_16x16x32_bf16 v[60:63], a[148:151], a[24:27], v[60:63]
 v_mfma_f32_16x16x32_bf16 v[48:51], a[152:155], a[12:15], v[48:51]
 v_exp_f32 v79, v79
 v_mfma_f32_16x16x32_bf16 v[56:59], a[152:155], a[28:31], v[56:59]
 v_cvt_pk_bf16_f32 v30, v74, v75
 v_cvt_pk_bf16_f32 v31, v78, v79
 v_mfma_f32_16x16x32_bf16 v[52:55], a[156:159], a[12:15], v[52:55]
 v_mfma_f32_16x16x32_bf16 v[60:63], a[156:159], a[28:31], v[60:63]
 v_mfma_f32_16x16x32_bf16 v[176:179], a[160:163], v[24:27], v[176:179]
 v_mfma_f32_16x16x32_bf16 v[208:211], a[160:163], v[28:31], v[208:211]
 ds_read_b128 a[160:163], v3 offset:8192
 v_mfma_f32_16x16x32_bf16 v[180:183], a[164:167], v[24:27], v[180:183]
 v_mfma_f32_16x16x32_bf16 v[212:215], a[164:167], v[28:31], v[212:215]
 ds_read_b128 a[164:167], v3 offset:9216
 v_exp_f32 v48, v48
 v_mfma_f32_16x16x32_bf16 v[184:187], a[168:171], v[24:27], v[184:187]
 v_exp_f32 v49, v49
 v_mfma_f32_16x16x32_bf16 v[216:219], a[168:171], v[28:31], v[216:219]
 ds_read_b128 a[168:171], v3 offset:10240
 v_exp_f32 v52, v52
 v_mfma_f32_16x16x32_bf16 v[188:191], a[172:175], v[24:27], v[188:191]
 v_mfma_f32_16x16x32_bf16 v[220:223], a[172:175], v[28:31], v[220:223]
 ds_read_b128 a[172:175], v3 offset:11264
 v_exp_f32 v53, v53
 v_mfma_f32_16x16x32_bf16 v[192:195], a[176:179], v[24:27], v[192:195]
 v_exp_f32 v50, v50
 v_mfma_f32_16x16x32_bf16 v[224:227], a[176:179], v[28:31], v[224:227]
 ds_read_b128 a[176:179], v3 offset:12288
 v_mfma_f32_16x16x32_bf16 v[196:199], a[180:183], v[24:27], v[196:199]
 v_cvt_pk_bf16_f32 v16, v48, v49
 v_cvt_pk_bf16_f32 v17, v52, v53
 v_mfma_f32_16x16x32_bf16 v[228:231], a[180:183], v[28:31], v[228:231]
 ds_read_b128 a[180:183], v3 offset:13312
 v_exp_f32 v51, v51
 v_mfma_f32_16x16x32_bf16 v[200:203], a[184:187], v[24:27], v[200:203]
 v_exp_f32 v54, v54
 v_mfma_f32_16x16x32_bf16 v[232:235], a[184:187], v[28:31], v[232:235]
 ds_read_b128 a[184:187], v3 offset:14336
 v_mfma_f32_16x16x32_bf16 v[204:207], a[188:191], v[24:27], v[204:207]
 v_exp_f32 v55, v55
 v_mfma_f32_16x16x32_bf16 v[236:239], a[188:191], v[28:31], v[236:239]
 ds_read_b128 a[188:191], v3 offset:15360
 v_cvt_pk_bf16_f32 v18, v50, v51
 v_cvt_pk_bf16_f32 v19, v54, v55
 v_mfma_f32_16x16x32_bf16 v[40:43], a[192:195], v[24:27], v[40:43]
 v_mfma_f32_16x16x32_bf16 v[44:47], a[192:195], v[28:31], v[44:47]
 v_mfma_f32_16x16x32_bf16 v[64:67], a[128:131], a[32:35], v[96:99]
 s_waitcnt vmcnt(20)
 s_barrier
 v_exp_f32 v56, v56
 v_mfma_f32_16x16x32_bf16 v[72:75], a[128:131], a[48:51], v[104:107]
 ds_read_b128 a[128:131], v2 offset:0
 v_exp_f32 v57, v57
 v_mfma_f32_16x16x32_bf16 v[68:71], a[132:135], a[32:35], v[100:103]
 s_add_u32 s39, s39, 0x4000
 v_mfma_f32_16x16x32_bf16 v[76:79], a[132:135], a[48:51], v[108:111]
 ds_read_b128 a[132:135], v2 offset:1024
 v_exp_f32 v60, v60
 v_mfma_f32_16x16x32_bf16 v[64:67], a[136:139], a[36:39], v[64:67]
 v_exp_f32 v61, v61
 v_mfma_f32_16x16x32_bf16 v[72:75], a[136:139], a[52:55], v[72:75]
 ds_read_b128 a[136:139], v2 offset:2048
 v_mfma_f32_16x16x32_bf16 v[68:71], a[140:143], a[36:39], v[68:71]
 v_exp_f32 v58, v58
 v_mfma_f32_16x16x32_bf16 v[76:79], a[140:143], a[52:55], v[76:79]
 ds_read_b128 a[140:143], v2 offset:3072
 v_cvt_pk_bf16_f32 v20, v56, v57
 v_cvt_pk_bf16_f32 v21, v60, v61
 v_mfma_f32_16x16x32_bf16 v[64:67], a[144:147], a[40:43], v[64:67]
 s_and_b32 s39, s39, 0x1ffff
 v_mfma_f32_16x16x32_bf16 v[72:75], a[144:147], a[56:59], v[72:75]
 ds_read_b128 a[144:147], v2 offset:4096
 v_exp_f32 v59, v59
 v_mfma_f32_16x16x32_bf16 v[68:71], a[148:151], a[40:43], v[68:71]
 v_exp_f32 v62, v62
 v_mfma_f32_16x16x32_bf16 v[76:79], a[148:151], a[56:59], v[76:79]
 ds_read_b128 a[148:151], v2 offset:5120
 v_mfma_f32_16x16x32_bf16 v[64:67], a[152:155], a[44:47], v[64:67]
 v_exp_f32 v63, v63
 v_mfma_f32_16x16x32_bf16 v[72:75], a[152:155], a[60:63], v[72:75]
 ds_read_b128 a[152:155], v2 offset:6144
 v_cvt_pk_bf16_f32 v22, v58, v59
 v_cvt_pk_bf16_f32 v23, v62, v63
 v_mfma_f32_16x16x32_bf16 v[68:71], a[156:159], a[44:47], v[68:71]
 v_mfma_f32_16x16x32_bf16 v[76:79], a[156:159], a[60:63], v[76:79]
 ds_read_b128 a[156:159], v2 offset:7168
 s_waitcnt lgkmcnt(8)
 v_mfma_f32_16x16x32_bf16 v[112:115], a[160:163], v[16:19], v[112:115]
 s_lshl_b32 s37, s35, 19
 v_mov_b32 v3, v2
 v_add_u32 v2, s39, v1
 v_mfma_f32_16x16x32_bf16 v[144:147], a[160:163], v[20:23], v[144:147]
 s_add_u32 m0, s38, s50
 v_mfma_f32_16x16x32_bf16 v[116:119], a[164:167], v[16:19], v[116:119]
 s_add_u32 s37, s37, s45
 v_mfma_f32_16x16x32_bf16 v[148:151], a[164:167], v[20:23], v[148:151]
 buffer_load_dwordx4 v1, s[20:23], s37 offen offset:0 sc1 lds
 v_exp_f32 v64, v64
 v_mfma_f32_16x16x32_bf16 v[120:123], a[168:171], v[16:19], v[120:123]
 buffer_load_dwordx4 v1, s[20:23], s37 offen offset:1024 sc1 lds
 v_mfma_f32_16x16x32_bf16 v[152:155], a[168:171], v[20:23], v[152:155]
 v_exp_f32 v65, v65
 v_mfma_f32_16x16x32_bf16 v[124:127], a[172:175], v[16:19], v[124:127]
 buffer_load_dwordx4 v1, s[20:23], s37 offen offset:2048 sc1 lds
 v_exp_f32 v68, v68
 v_mfma_f32_16x16x32_bf16 v[156:159], a[172:175], v[20:23], v[156:159]
 buffer_load_dwordx4 v1, s[20:23], s37 offen offset:3072 sc1 lds
 v_exp_f32 v69, v69
 v_mfma_f32_16x16x32_bf16 v[128:131], a[176:179], v[16:19], v[128:131]
 s_add_u32 s38, s38, 0x4000
 v_mfma_f32_16x16x32_bf16 v[160:163], a[176:179], v[20:23], v[160:163]
 s_and_b32 s38, s38, 0x1ffff
 v_exp_f32 v66, v66
 v_mfma_f32_16x16x32_bf16 v[132:135], a[180:183], v[16:19], v[132:135]
 s_add_u32 s35, s35, 1
 v_cvt_pk_bf16_f32 v24, v64, v65
 v_cvt_pk_bf16_f32 v25, v68, v69
 v_mfma_f32_16x16x32_bf16 v[164:167], a[180:183], v[20:23], v[164:167]
 v_exp_f32 v67, v67
 v_mfma_f32_16x16x32_bf16 v[136:139], a[184:187], v[16:19], v[136:139]
 s_cmp_eq_u32 s35, s36
 v_mfma_f32_16x16x32_bf16 v[168:171], a[184:187], v[20:23], v[168:171]
 s_cselect_b32 s36, s47, s36
 v_exp_f32 v70, v70
 v_mfma_f32_16x16x32_bf16 v[140:143], a[188:191], v[16:19], v[140:143]
 s_cselect_b32 s35, 0, s35
 v_exp_f32 v71, v71
 v_mfma_f32_16x16x32_bf16 v[172:175], a[188:191], v[20:23], v[172:175]
 s_add_u32 s49, s49, 1
 v_cvt_pk_bf16_f32 v26, v66, v67
 v_cvt_pk_bf16_f32 v27, v70, v71
 v_mfma_f32_16x16x32_bf16 v[32:35], a[192:195], v[16:19], v[32:35]
 s_cmp_lt_u32 s49, s40
 v_mfma_f32_16x16x32_bf16 v[36:39], a[192:195], v[20:23], v[36:39]
 s_cbranch_scc1 Lapl_13
Lamk_14:
 s_add_u32 s40, s43, 4
 .p2align 3
Lamk_16:
 s_waitcnt lgkmcnt(0)
 v_mfma_f32_16x16x32_bf16 v[48:51], a[128:131], a[0:3], v[80:83]
 s_add_u32 s49, s49, 1
 v_exp_f32 v72, v72
 v_mfma_f32_16x16x32_bf16 v[56:59], a[128:131], a[16:19], v[88:91]
 s_cmp_lt_u32 s49, s41
 v_exp_f32 v73, v73
 v_mfma_f32_16x16x32_bf16 v[52:55], a[132:135], a[0:3], v[84:87]
 v_mfma_f32_16x16x32_bf16 v[60:63], a[132:135], a[16:19], v[92:95]
 s_cselect_b64 s[68:69], -1, 0
 v_exp_f32 v76, v76
 v_mfma_f32_16x16x32_bf16 v[48:51], a[136:139], a[4:7], v[48:51]
 s_cmp_le_u32 s49, s41
 v_exp_f32 v77, v77
 v_mfma_f32_16x16x32_bf16 v[56:59], a[136:139], a[20:23], v[56:59]
 v_mfma_f32_16x16x32_bf16 v[52:55], a[140:143], a[4:7], v[52:55]
 s_cselect_b64 s[70:71], -1, 0
 v_exp_f32 v74, v74
 v_mfma_f32_16x16x32_bf16 v[60:63], a[140:143], a[20:23], v[60:63]
 v_cvt_pk_bf16_f32 v28, v72, v73
 v_cvt_pk_bf16_f32 v29, v76, v77
 v_mfma_f32_16x16x32_bf16 v[48:51], a[144:147], a[8:11], v[48:51]
 s_cmp_eq_u32 s49, s41
 v_mfma_f32_16x16x32_bf16 v[56:59], a[144:147], a[24:27], v[56:59]
 s_cselect_b64 s[60:61], s[52:53], s[68:69]
 v_exp_f32 v75, v75
 v_mfma_f32_16x16x32_bf16 v[52:55], a[148:151], a[8:11], v[52:55]
 v_exp_f32 v78, v78
 v_mfma_f32_16x16x32_bf16 v[60:63], a[148:151], a[24:27], v[60:63]
 s_cselect_b64 s[62:63], s[54:55], s[68:69]
 v_mfma_f32_16x16x32_bf16 v[48:51], a[152:155], a[12:15], v[48:51]
 s_cselect_b64 s[64:65], s[56:57], s[68:69]
 v_exp_f32 v79, v79
 v_mfma_f32_16x16x32_bf16 v[56:59], a[152:155], a[28:31], v[56:59]
 v_cvt_pk_bf16_f32 v30, v74, v75
 v_cvt_pk_bf16_f32 v31, v78, v79
 v_mfma_f32_16x16x32_bf16 v[52:55], a[156:159], a[12:15], v[52:55]
 s_cselect_b64 s[66:67], s[58:59], s[68:69]
 v_mfma_f32_16x16x32_bf16 v[60:63], a[156:159], a[28:31], v[60:63]
 v_mfma_f32_16x16x32_bf16 v[176:179], a[160:163], v[24:27], v[176:179]
 v_mfma_f32_16x16x32_bf16 v[208:211], a[160:163], v[28:31], v[208:211]
 ds_read_b128 a[160:163], v3 offset:8192
 v_mfma_f32_16x16x32_bf16 v[180:183], a[164:167], v[24:27], v[180:183]
 v_mfma_f32_16x16x32_bf16 v[212:215], a[164:167], v[28:31], v[212:215]
 ds_read_b128 a[164:167], v3 offset:9216
 v_exp_f32 v48, v48
 v_mfma_f32_16x16x32_bf16 v[184:187], a[168:171], v[24:27], v[184:187]
 v_exp_f32 v49, v49
 v_mfma_f32_16x16x32_bf16 v[216:219], a[168:171], v[28:31], v[216:219]
 ds_read_b128 a[168:171], v3 offset:10240
 v_exp_f32 v52, v52
 v_mfma_f32_16x16x32_bf16 v[188:191], a[172:175], v[24:27], v[188:191]
 v_exp_f32 v53, v53
 v_mfma_f32_16x16x32_bf16 v[220:223], a[172:175], v[28:31], v[220:223]
 ds_read_b128 a[172:175], v3 offset:11264
 v_exp_f32 v50, v50
 v_mfma_f32_16x16x32_bf16 v[192:195], a[176:179], v[24:27], v[192:195]
 v_cvt_pk_bf16_f32 v16, v48, v49
 v_cvt_pk_bf16_f32 v17, v52, v53
 v_mfma_f32_16x16x32_bf16 v[224:227], a[176:179], v[28:31], v[224:227]
 ds_read_b128 a[176:179], v3 offset:12288
 v_exp_f32 v51, v51
 v_mfma_f32_16x16x32_bf16 v[196:199], a[180:183], v[24:27], v[196:199]
 v_exp_f32 v54, v54
 v_mfma_f32_16x16x32_bf16 v[228:231], a[180:183], v[28:31], v[228:231]
 ds_read_b128 a[180:183], v3 offset:13312
 v_exp_f32 v55, v55
 v_mfma_f32_16x16x32_bf16 v[200:203], a[184:187], v[24:27], v[200:203]
 v_cvt_pk_bf16_f32 v18, v50, v51
 v_cvt_pk_bf16_f32 v19, v54, v55
 v_mfma_f32_16x16x32_bf16 v[232:235], a[184:187], v[28:31], v[232:235]
 ds_read_b128 a[184:187], v3 offset:14336
 v_cndmask_b32 v80, v4, v12, s[60:61]
 v_cndmask_b32 v81, v4, v12, s[62:63]
 v_mfma_f32_16x16x32_bf16 v[204:207], a[188:191], v[24:27], v[204:207]
 v_cndmask_b32 v82, v4, v12, s[64:65]
 v_cndmask_b32 v83, v4, v12, s[66:67]
 v_mfma_f32_16x16x32_bf16 v[236:239], a[188:191], v[28:31], v[236:239]
 ds_read_b128 a[188:191], v3 offset:15360
 v_cndmask_b32 v84, v4, v12, s[68:69]
 v_cndmask_b32 v85, v4, v12, s[68:69]
 v_mfma_f32_16x16x32_bf16 v[40:43], a[192:195], v[24:27], v[40:43]
 v_cndmask_b32 v86, v4, v12, s[68:69]
 v_cndmask_b32 v87, v4, v12, s[68:69]
 v_mfma_f32_16x16x32_bf16 v[44:47], a[192:195], v[28:31], v[44:47]
 v_mfma_f32_16x16x32_bf16 v[64:67], a[128:131], a[32:35], v[96:99]
 s_waitcnt vmcnt(20)
 s_barrier
 v_exp_f32 v56, v56
 v_mfma_f32_16x16x32_bf16 v[72:75], a[128:131], a[48:51], v[104:107]
 ds_read_b128 a[128:131], v2 offset:0
 v_exp_f32 v57, v57
 v_mfma_f32_16x16x32_bf16 v[68:71], a[132:135], a[32:35], v[100:103]
 s_add_u32 s39, s39, 0x4000
 v_exp_f32 v60, v60
 v_mfma_f32_16x16x32_bf16 v[76:79], a[132:135], a[48:51], v[108:111]
 ds_read_b128 a[132:135], v2 offset:1024
 v_exp_f32 v61, v61
 v_mfma_f32_16x16x32_bf16 v[64:67], a[136:139], a[36:39], v[64:67]
 v_exp_f32 v58, v58
 v_mfma_f32_16x16x32_bf16 v[72:75], a[136:139], a[52:55], v[72:75]
 ds_read_b128 a[136:139], v2 offset:2048
 v_cvt_pk_bf16_f32 v20, v56, v57
 v_cvt_pk_bf16_f32 v21, v60, v61
 v_mfma_f32_16x16x32_bf16 v[68:71], a[140:143], a[36:39], v[68:71]
 v_exp_f32 v59, v59
 v_mfma_f32_16x16x32_bf16 v[76:79], a[140:143], a[52:55], v[76:79]
 ds_read_b128 a[140:143], v2 offset:3072
 v_exp_f32 v62, v62
 v_mfma_f32_16x16x32_bf16 v[64:67], a[144:147], a[40:43], v[64:67]
 s_and_b32 s39, s39, 0x1ffff
 v_exp_f32 v63, v63
 v_mfma_f32_16x16x32_bf16 v[72:75], a[144:147], a[56:59], v[72:75]
 ds_read_b128 a[144:147], v2 offset:4096
 v_cvt_pk_bf16_f32 v22, v58, v59
 v_cvt_pk_bf16_f32 v23, v62, v63
 v_mfma_f32_16x16x32_bf16 v[68:71], a[148:151], a[40:43], v[68:71]
 v_cndmask_b32 v88, v4, v13, s[70:71]
 v_cndmask_b32 v89, v4, v13, s[70:71]
 v_mfma_f32_16x16x32_bf16 v[76:79], a[148:151], a[56:59], v[76:79]
 ds_read_b128 a[148:151], v2 offset:5120
 v_cndmask_b32 v90, v4, v13, s[70:71]
 v_cndmask_b32 v91, v4, v13, s[70:71]
 v_mfma_f32_16x16x32_bf16 v[64:67], a[152:155], a[44:47], v[64:67]
 v_cndmask_b32 v92, v4, v13, s[60:61]
 v_cndmask_b32 v93, v4, v13, s[62:63]
 v_mfma_f32_16x16x32_bf16 v[72:75], a[152:155], a[60:63], v[72:75]
 ds_read_b128 a[152:155], v2 offset:6144
 v_cndmask_b32 v94, v4, v13, s[64:65]
 v_cndmask_b32 v95, v4, v13, s[66:67]
 v_mfma_f32_16x16x32_bf16 v[68:71], a[156:159], a[44:47], v[68:71]
 v_mfma_f32_16x16x32_bf16 v[76:79], a[156:159], a[60:63], v[76:79]
 ds_read_b128 a[156:159], v2 offset:7168
 s_waitcnt lgkmcnt(8)
 v_mfma_f32_16x16x32_bf16 v[112:115], a[160:163], v[16:19], v[112:115]
 s_lshl_b32 s37, s35, 19
 v_mov_b32 v3, v2
 v_add_u32 v2, s39, v1
 v_mfma_f32_16x16x32_bf16 v[144:147], a[160:163], v[20:23], v[144:147]
 s_add_u32 m0, s38, s50
 v_mfma_f32_16x16x32_bf16 v[116:119], a[164:167], v[16:19], v[116:119]
 s_add_u32 s37, s37, s45
 v_mfma_f32_16x16x32_bf16 v[148:151], a[164:167], v[20:23], v[148:151]
 buffer_load_dwordx4 v1, s[20:23], s37 offen offset:0 sc1 lds
 v_exp_f32 v64, v64
 v_mfma_f32_16x16x32_bf16 v[120:123], a[168:171], v[16:19], v[120:123]
 v_mfma_f32_16x16x32_bf16 v[152:155], a[168:171], v[20:23], v[152:155]
 buffer_load_dwordx4 v1, s[20:23], s37 offen offset:1024 sc1 lds
 v_exp_f32 v65, v65
 v_mfma_f32_16x16x32_bf16 v[124:127], a[172:175], v[16:19], v[124:127]
 buffer_load_dwordx4 v1, s[20:23], s37 offen offset:2048 sc1 lds
 v_exp_f32 v68, v68
 v_mfma_f32_16x16x32_bf16 v[156:159], a[172:175], v[20:23], v[156:159]
 buffer_load_dwordx4 v1, s[20:23], s37 offen offset:3072 sc1 lds
 v_exp_f32 v69, v69
 v_mfma_f32_16x16x32_bf16 v[128:131], a[176:179], v[16:19], v[128:131]
 v_mfma_f32_16x16x32_bf16 v[160:163], a[176:179], v[20:23], v[160:163]
 s_add_u32 s38, s38, 0x4000
 v_exp_f32 v66, v66
 v_mfma_f32_16x16x32_bf16 v[132:135], a[180:183], v[16:19], v[132:135]
 s_and_b32 s38, s38, 0x1ffff
 v_cvt_pk_bf16_f32 v24, v64, v65
 v_cvt_pk_bf16_f32 v25, v68, v69
 v_mfma_f32_16x16x32_bf16 v[164:167], a[180:183], v[20:23], v[164:167]
 s_add_u32 s35, s35, 1
 v_exp_f32 v67, v67
 v_mfma_f32_16x16x32_bf16 v[136:139], a[184:187], v[16:19], v[136:139]
 s_cmp_eq_u32 s35, s36
 v_mfma_f32_16x16x32_bf16 v[168:171], a[184:187], v[20:23], v[168:171]
 v_exp_f32 v70, v70
 v_mfma_f32_16x16x32_bf16 v[140:143], a[188:191], v[16:19], v[140:143]
 s_cselect_b32 s36, s47, s36
 v_exp_f32 v71, v71
 v_mfma_f32_16x16x32_bf16 v[172:175], a[188:191], v[20:23], v[172:175]
 s_cselect_b32 s35, 0, s35
 v_cvt_pk_bf16_f32 v26, v66, v67
 v_cvt_pk_bf16_f32 v27, v70, v71
 v_mfma_f32_16x16x32_bf16 v[32:35], a[192:195], v[16:19], v[32:35]
 s_cmp_lt_u32 s49, s40
 v_mfma_f32_16x16x32_bf16 v[36:39], a[192:195], v[20:23], v[36:39]
 s_cbranch_scc1 Lamk_16
 s_add_u32 s40, s43, 8
 s_cmp_lt_u32 s49, s42
 s_cselect_b64 s[68:69], -1, 0
 s_cmp_le_u32 s49, s42
 s_cselect_b64 s[70:71], -1, 0
 s_cmp_eq_u32 s49, s42
 s_cselect_b64 s[60:61], s[52:53], s[68:69]
 s_cselect_b64 s[62:63], s[54:55], s[68:69]
 s_cselect_b64 s[64:65], s[56:57], s[68:69]
 s_cselect_b64 s[66:67], s[58:59], s[68:69]
 v_mfma_f32_16x16x32_bf16 v[176:179], a[160:163], v[24:27], v[176:179]
 v_cndmask_b32 v96, v4, v14, s[60:61]
 v_cndmask_b32 v97, v4, v14, s[62:63]
 v_mfma_f32_16x16x32_bf16 v[180:183], a[164:167], v[24:27], v[180:183]
 v_cndmask_b32 v98, v4, v14, s[64:65]
 v_cndmask_b32 v99, v4, v14, s[66:67]
 v_mfma_f32_16x16x32_bf16 v[184:187], a[168:171], v[24:27], v[184:187]
 v_cndmask_b32 v100, v4, v14, s[68:69]
 v_cndmask_b32 v101, v4, v14, s[68:69]
 v_mfma_f32_16x16x32_bf16 v[188:191], a[172:175], v[24:27], v[188:191]
 v_exp_f32 v72, v72
 v_mfma_f32_16x16x32_bf16 v[192:195], a[176:179], v[24:27], v[192:195]
 v_exp_f32 v73, v73
 v_mfma_f32_16x16x32_bf16 v[196:199], a[180:183], v[24:27], v[196:199]
 v_exp_f32 v76, v76
 v_mfma_f32_16x16x32_bf16 v[200:203], a[184:187], v[24:27], v[200:203]
 v_exp_f32 v77, v77
 v_mfma_f32_16x16x32_bf16 v[204:207], a[188:191], v[24:27], v[204:207]
 v_exp_f32 v74, v74
 v_mfma_f32_16x16x32_bf16 v[40:43], a[192:195], v[24:27], v[40:43]
 v_cndmask_b32 v102, v4, v14, s[68:69]
 v_cndmask_b32 v103, v4, v14, s[68:69]
 s_nop 0
 .p2align 3
Lam1_15:
 s_waitcnt lgkmcnt(0)
 v_mfma_f32_16x16x32_bf16 v[64:67], a[128:131], a[32:35], v[96:99]
 v_cvt_pk_bf16_f32 v28, v72, v73
 v_cvt_pk_bf16_f32 v29, v76, v77
 v_mfma_f32_16x16x32_bf16 v[68:71], a[132:135], a[32:35], v[100:103]
 v_exp_f32 v75, v75
 v_mfma_f32_16x16x32_bf16 v[64:67], a[136:139], a[36:39], v[64:67]
 v_exp_f32 v78, v78
 v_mfma_f32_16x16x32_bf16 v[68:71], a[140:143], a[36:39], v[68:71]
 v_exp_f32 v79, v79
 v_mfma_f32_16x16x32_bf16 v[64:67], a[144:147], a[40:43], v[64:67]
 v_cvt_pk_bf16_f32 v30, v74, v75
 v_cvt_pk_bf16_f32 v31, v78, v79
 v_mfma_f32_16x16x32_bf16 v[68:71], a[148:151], a[40:43], v[68:71]
 v_cndmask_b32 v104, v4, v15, s[70:71]
 v_cndmask_b32 v105, v4, v15, s[70:71]
 v_mfma_f32_16x16x32_bf16 v[64:67], a[152:155], a[44:47], v[64:67]
 v_mfma_f32_16x16x32_bf16 v[68:71], a[156:159], a[44:47], v[68:71]
 v_mfma_f32_16x16x32_bf16 v[208:211], a[160:163], v[28:31], v[208:211]
 ds_read_b128 a[160:163], v3 offset:8192
 v_cndmask_b32 v106, v4, v15, s[70:71]
 v_cndmask_b32 v107, v4, v15, s[70:71]
 v_mfma_f32_16x16x32_bf16 v[212:215], a[164:167], v[28:31], v[212:215]
 ds_read_b128 a[164:167], v3 offset:9216
 v_cndmask_b32 v108, v4, v15, s[60:61]
 v_cndmask_b32 v109, v4, v15, s[62:63]
 v_mfma_f32_16x16x32_bf16 v[216:219], a[168:171], v[28:31], v[216:219]
 ds_read_b128 a[168:171], v3 offset:10240
 v_cndmask_b32 v110, v4, v15, s[64:65]
 v_cndmask_b32 v111, v4, v15, s[66:67]
 v_mfma_f32_16x16x32_bf16 v[220:223], a[172:175], v[28:31], v[220:223]
 ds_read_b128 a[172:175], v3 offset:11264
 v_exp_f32 v64, v64
 v_mfma_f32_16x16x32_bf16 v[224:227], a[176:179], v[28:31], v[224:227]
 ds_read_b128 a[176:179], v3 offset:12288
 v_exp_f32 v65, v65
 v_mfma_f32_16x16x32_bf16 v[228:231], a[180:183], v[28:31], v[228:231]
 ds_read_b128 a[180:183], v3 offset:13312
 v_exp_f32 v68, v68
 v_mfma_f32_16x16x32_bf16 v[232:235], a[184:187], v[28:31], v[232:235]
 ds_read_b128 a[184:187], v3 offset:14336
 v_exp_f32 v69, v69
 v_mfma_f32_16x16x32_bf16 v[236:239], a[188:191], v[28:31], v[236:239]
 ds_read_b128 a[188:191], v3 offset:15360
 v_exp_f32 v66, v66
 v_mfma_f32_16x16x32_bf16 v[44:47], a[192:195], v[28:31], v[44:47]
 v_mfma_f32_16x16x32_bf16 v[72:75], a[128:131], a[48:51], v[104:107]
 s_waitcnt vmcnt(20)
 s_barrier
 ds_read_b128 a[128:131], v2 offset:0
 s_add_u32 s39, s39, 0x4000
 v_cvt_pk_bf16_f32 v24, v64, v65
 v_cvt_pk_bf16_f32 v25, v68, v69
 v_mfma_f32_16x16x32_bf16 v[76:79], a[132:135], a[48:51], v[108:111]
 ds_read_b128 a[132:135], v2 offset:1024
 v_exp_f32 v67, v67
 v_mfma_f32_16x16x32_bf16 v[72:75], a[136:139], a[52:55], v[72:75]
 ds_read_b128 a[136:139], v2 offset:2048
 v_exp_f32 v70, v70
 v_mfma_f32_16x16x32_bf16 v[76:79], a[140:143], a[52:55], v[76:79]
 ds_read_b128 a[140:143], v2 offset:3072
 v_mfma_f32_16x16x32_bf16 v[72:75], a[144:147], a[56:59], v[72:75]
 ds_read_b128 a[144:147], v2 offset:4096
 s_and_b32 s39, s39, 0x1ffff
 v_exp_f32 v71, v71
 v_mfma_f32_16x16x32_bf16 v[76:79], a[148:151], a[56:59], v[76:79]
 ds_read_b128 a[148:151], v2 offset:5120
 v_cvt_pk_bf16_f32 v26, v66, v67
 v_cvt_pk_bf16_f32 v27, v70, v71
 v_mfma_f32_16x16x32_bf16 v[72:75], a[152:155], a[60:63], v[72:75]
 ds_read_b128 a[152:155], v2 offset:6144
 v_mfma_f32_16x16x32_bf16 v[76:79], a[156:159], a[60:63], v[76:79]
 ds_read_b128 a[156:159], v2 offset:7168
 s_waitcnt lgkmcnt(8)
 s_add_u32 s49, s49, 1
 s_cmp_lt_u32 s49, s42
 s_cselect_b64 s[68:69], -1, 0
 s_cmp_le_u32 s49, s42
 s_cselect_b64 s[70:71], -1, 0
 s_cmp_eq_u32 s49, s42
 s_cselect_b64 s[60:61], s[52:53], s[68:69]
 s_cselect_b64 s[62:63], s[54:55], s[68:69]
 s_cselect_b64 s[64:65], s[56:57], s[68:69]
 s_cselect_b64 s[66:67], s[58:59], s[68:69]
 v_mfma_f32_16x16x32_bf16 v[176:179], a[160:163], v[24:27], v[176:179]
 s_lshl_b32 s37, s35, 19
 s_add_u32 m0, s38, s50
 v_mov_b32 v3, v2
 v_add_u32 v2, s39, v1
 v_cndmask_b32 v96, v4, v14, s[60:61]
 v_cndmask_b32 v97, v4, v14, s[62:63]
 v_mfma_f32_16x16x32_bf16 v[180:183], a[164:167], v[24:27], v[180:183]
 s_add_u32 s37, s37, s45
 buffer_load_dwordx4 v1, s[20:23], s37 offen offset:0 sc1 lds
 v_cndmask_b32 v98, v4, v14, s[64:65]
 v_cndmask_b32 v99, v4, v14, s[66:67]
 v_mfma_f32_16x16x32_bf16 v[184:187], a[168:171], v[24:27], v[184:187]
 buffer_load_dwordx4 v1, s[20:23], s37 offen offset:1024 sc1 lds
 v_exp_f32 v72, v72
 v_mfma_f32_16x16x32_bf16 v[188:191], a[172:175], v[24:27], v[188:191]
 buffer_load_dwordx4 v1, s[20:23], s37 offen offset:2048 sc1 lds
 buffer_load_dwordx4 v1, s[20:23], s37 offen offset:3072 sc1 lds
 v_exp_f32 v73, v73
 v_mfma_f32_16x16x32_bf16 v[192:195], a[176:179], v[24:27], v[192:195]
 s_add_u32 s38, s38, 0x4000
 v_exp_f32 v76, v76
 v_mfma_f32_16x16x32_bf16 v[196:199], a[180:183], v[24:27], v[196:199]
 s_and_b32 s38, s38, 0x1ffff
 s_add_u32 s35, s35, 1
 v_exp_f32 v77, v77
 v_mfma_f32_16x16x32_bf16 v[200:203], a[184:187], v[24:27], v[200:203]
 s_cmp_eq_u32 s35, s36
 v_exp_f32 v74, v74
 v_mfma_f32_16x16x32_bf16 v[204:207], a[188:191], v[24:27], v[204:207]
 s_cselect_b32 s36, s47, s36
 s_cselect_b32 s35, 0, s35
 v_cndmask_b32 v100, v4, v14, s[68:69]
 v_cndmask_b32 v101, v4, v14, s[68:69]
 v_mfma_f32_16x16x32_bf16 v[40:43], a[192:195], v[24:27], v[40:43]
 s_cmp_lt_u32 s49, s40
 v_cndmask_b32 v102, v4, v14, s[68:69]
 v_cndmask_b32 v103, v4, v14, s[68:69]
 s_cbranch_scc1 Lam1_15
 v_cvt_pk_bf16_f32 v28, v72, v73
 v_cvt_pk_bf16_f32 v29, v76, v77
 v_exp_f32 v75, v75
 v_exp_f32 v78, v78
 v_exp_f32 v79, v79
 v_cvt_pk_bf16_f32 v30, v74, v75
 v_cvt_pk_bf16_f32 v31, v78, v79
 s_nop 1
 v_mfma_f32_16x16x32_bf16 v[44:47], a[192:195], v[28:31], v[44:47]
 v_mfma_f32_16x16x32_bf16 v[208:211], a[160:163], v[28:31], v[208:211]
 v_mfma_f32_16x16x32_bf16 v[212:215], a[164:167], v[28:31], v[212:215]
 v_mfma_f32_16x16x32_bf16 v[216:219], a[168:171], v[28:31], v[216:219]
 v_mfma_f32_16x16x32_bf16 v[220:223], a[172:175], v[28:31], v[220:223]
 v_mfma_f32_16x16x32_bf16 v[224:227], a[176:179], v[28:31], v[224:227]
 v_mfma_f32_16x16x32_bf16 v[228:231], a[180:183], v[28:31], v[228:231]
 v_mfma_f32_16x16x32_bf16 v[232:235], a[184:187], v[28:31], v[232:235]
 v_mfma_f32_16x16x32_bf16 v[236:239], a[188:191], v[28:31], v[236:239]
 v_cmp_ngt_f32 s[60:61], s73, v32
 v_cmp_nlt_f32 vcc, s74, v32
 s_or_b64 s[60:61], s[60:61], vcc
 v_cmp_ngt_f32 s[62:63], s73, v36
 v_cmp_nlt_f32 vcc, s74, v36
 s_or_b64 s[62:63], s[62:63], vcc
 v_cmp_ngt_f32 s[64:65], s73, v40
 v_cmp_nlt_f32 vcc, s74, v40
 s_or_b64 s[64:65], s[64:65], vcc
 v_cmp_ngt_f32 s[66:67], s73, v44
 v_cmp_nlt_f32 vcc, s74, v44
 s_or_b64 s[66:67], s[66:67], vcc
 s_or_b64 s[60:61], s[60:61], s[62:63]
 s_or_b64 s[64:65], s[64:65], s[66:67]
 s_or_b64 s[60:61], s[60:61], s[64:65]
 s_cbranch_scc1 Laslow_10
Laback_11:
 v_rcp_f32 v32, v32
 v_rcp_f32 v36, v36
 v_rcp_f32 v40, v40
 v_rcp_f32 v44, v44
 s_lshl_b32 s40, s41, 5
 s_add_u32 s40, s40, s32
 s_lshl_b32 s40, s40, 13
 s_add_u32 s40, s40, 0x6000000
 s_add_u32 s44, s40, 4096
 v_pk_mul_f32 v[112:113], v[112:113], v[32:33] op_sel_hi:[1,0]
 v_pk_mul_f32 v[114:115], v[114:115], v[32:33] op_sel_hi:[1,0]
 v_pk_mul_f32 v[116:117], v[116:117], v[32:33] op_sel_hi:[1,0]
 v_pk_mul_f32 v[118:119], v[118:119], v[32:33] op_sel_hi:[1,0]
 v_cvt_pk_bf16_f32 v240, v112, v113
 v_cvt_pk_bf16_f32 v241, v116, v117
 v_cvt_pk_bf16_f32 v242, v114, v115
 v_cvt_pk_bf16_f32 v243, v118, v119
 buffer_store_dwordx4 v[240:243], v1, s[20:23], s40 offen offset:0 sc1
 v_pk_mul_f32 v[120:121], v[120:121], v[32:33] op_sel_hi:[1,0]
 v_pk_mul_f32 v[122:123], v[122:123], v[32:33] op_sel_hi:[1,0]
 v_pk_mul_f32 v[124:125], v[124:125], v[32:33] op_sel_hi:[1,0]
 v_pk_mul_f32 v[126:127], v[126:127], v[32:33] op_sel_hi:[1,0]
 v_cvt_pk_bf16_f32 v244, v120, v121
 v_cvt_pk_bf16_f32 v245, v124, v125
 v_cvt_pk_bf16_f32 v246, v122, v123
 v_cvt_pk_bf16_f32 v247, v126, v127
 buffer_store_dwordx4 v[244:247], v1, s[20:23], s40 offen offset:2048 sc1
 v_pk_mul_f32 v[128:129], v[128:129], v[32:33] op_sel_hi:[1,0]
 v_pk_mul_f32 v[130:131], v[130:131], v[32:33] op_sel_hi:[1,0]
 v_pk_mul_f32 v[132:133], v[132:133], v[32:33] op_sel_hi:[1,0]
 v_pk_mul_f32 v[134:135], v[134:135], v[32:33] op_sel_hi:[1,0]
 v_cvt_pk_bf16_f32 v248, v128, v129
 v_cvt_pk_bf16_f32 v249, v132, v133
 v_cvt_pk_bf16_f32 v250, v130, v131
 v_cvt_pk_bf16_f32 v251, v134, v135
 buffer_store_dwordx4 v[248:251], v1, s[20:23], s44 offen offset:0 sc1
 v_pk_mul_f32 v[136:137], v[136:137], v[32:33] op_sel_hi:[1,0]
 v_pk_mul_f32 v[138:139], v[138:139], v[32:33] op_sel_hi:[1,0]
 v_pk_mul_f32 v[140:141], v[140:141], v[32:33] op_sel_hi:[1,0]
 v_pk_mul_f32 v[142:143], v[142:143], v[32:33] op_sel_hi:[1,0]
 v_cvt_pk_bf16_f32 v252, v136, v137
 v_cvt_pk_bf16_f32 v253, v140, v141
 v_cvt_pk_bf16_f32 v254, v138, v139
 v_cvt_pk_bf16_f32 v255, v142, v143
 buffer_store_dwordx4 v[252:255], v1, s[20:23], s44 offen offset:2048 sc1
 v_pk_mul_f32 v[144:145], v[144:145], v[36:37] op_sel_hi:[1,0]
 v_pk_mul_f32 v[146:147], v[146:147], v[36:37] op_sel_hi:[1,0]
 v_pk_mul_f32 v[148:149], v[148:149], v[36:37] op_sel_hi:[1,0]
 v_pk_mul_f32 v[150:151], v[150:151], v[36:37] op_sel_hi:[1,0]
 v_cvt_pk_bf16_f32 v240, v144, v145
 v_cvt_pk_bf16_f32 v241, v148, v149
 v_cvt_pk_bf16_f32 v242, v146, v147
 v_cvt_pk_bf16_f32 v243, v150, v151
 buffer_store_dwordx4 v[240:243], v1, s[20:23], s40 offen offset:1024 sc1
 v_pk_mul_f32 v[152:153], v[152:153], v[36:37] op_sel_hi:[1,0]
 v_pk_mul_f32 v[154:155], v[154:155], v[36:37] op_sel_hi:[1,0]
 v_pk_mul_f32 v[156:157], v[156:157], v[36:37] op_sel_hi:[1,0]
 v_pk_mul_f32 v[158:159], v[158:159], v[36:37] op_sel_hi:[1,0]
 v_cvt_pk_bf16_f32 v244, v152, v153
 v_cvt_pk_bf16_f32 v245, v156, v157
 v_cvt_pk_bf16_f32 v246, v154, v155
 v_cvt_pk_bf16_f32 v247, v158, v159
 buffer_store_dwordx4 v[244:247], v1, s[20:23], s40 offen offset:3072 sc1
 v_pk_mul_f32 v[160:161], v[160:161], v[36:37] op_sel_hi:[1,0]
 v_pk_mul_f32 v[162:163], v[162:163], v[36:37] op_sel_hi:[1,0]
 v_pk_mul_f32 v[164:165], v[164:165], v[36:37] op_sel_hi:[1,0]
 v_pk_mul_f32 v[166:167], v[166:167], v[36:37] op_sel_hi:[1,0]
 v_cvt_pk_bf16_f32 v248, v160, v161
 v_cvt_pk_bf16_f32 v249, v164, v165
 v_cvt_pk_bf16_f32 v250, v162, v163
 v_cvt_pk_bf16_f32 v251, v166, v167
 buffer_store_dwordx4 v[248:251], v1, s[20:23], s44 offen offset:1024 sc1
 v_pk_mul_f32 v[168:169], v[168:169], v[36:37] op_sel_hi:[1,0]
 v_pk_mul_f32 v[170:171], v[170:171], v[36:37] op_sel_hi:[1,0]
 v_pk_mul_f32 v[172:173], v[172:173], v[36:37] op_sel_hi:[1,0]
 v_pk_mul_f32 v[174:175], v[174:175], v[36:37] op_sel_hi:[1,0]
 v_cvt_pk_bf16_f32 v252, v168, v169
 v_cvt_pk_bf16_f32 v253, v172, v173
 v_cvt_pk_bf16_f32 v254, v170, v171
 v_cvt_pk_bf16_f32 v255, v174, v175
 buffer_store_dwordx4 v[252:255], v1, s[20:23], s44 offen offset:3072 sc1
 s_lshl_b32 s40, s42, 5
 s_add_u32 s40, s40, s32
 s_lshl_b32 s40, s40, 13
 s_add_u32 s40, s40, 0x6000000
 s_add_u32 s44, s40, 4096
 v_pk_mul_f32 v[176:177], v[176:177], v[40:41] op_sel_hi:[1,0]
 v_pk_mul_f32 v[178:179], v[178:179], v[40:41] op_sel_hi:[1,0]
 v_pk_mul_f32 v[180:181], v[180:181], v[40:41] op_sel_hi:[1,0]
 v_pk_mul_f32 v[182:183], v[182:183], v[40:41] op_sel_hi:[1,0]
 v_cvt_pk_bf16_f32 v240, v176, v177
 v_cvt_pk_bf16_f32 v241, v180, v181
 v_cvt_pk_bf16_f32 v242, v178, v179
 v_cvt_pk_bf16_f32 v243, v182, v183
 buffer_store_dwordx4 v[240:243], v1, s[20:23], s40 offen offset:0 sc1
 v_pk_mul_f32 v[184:185], v[184:185], v[40:41] op_sel_hi:[1,0]
 v_pk_mul_f32 v[186:187], v[186:187], v[40:41] op_sel_hi:[1,0]
 v_pk_mul_f32 v[188:189], v[188:189], v[40:41] op_sel_hi:[1,0]
 v_pk_mul_f32 v[190:191], v[190:191], v[40:41] op_sel_hi:[1,0]
 v_cvt_pk_bf16_f32 v244, v184, v185
 v_cvt_pk_bf16_f32 v245, v188, v189
 v_cvt_pk_bf16_f32 v246, v186, v187
 v_cvt_pk_bf16_f32 v247, v190, v191
 buffer_store_dwordx4 v[244:247], v1, s[20:23], s40 offen offset:2048 sc1
 v_pk_mul_f32 v[192:193], v[192:193], v[40:41] op_sel_hi:[1,0]
 v_pk_mul_f32 v[194:195], v[194:195], v[40:41] op_sel_hi:[1,0]
 v_pk_mul_f32 v[196:197], v[196:197], v[40:41] op_sel_hi:[1,0]
 v_pk_mul_f32 v[198:199], v[198:199], v[40:41] op_sel_hi:[1,0]
 v_cvt_pk_bf16_f32 v248, v192, v193
 v_cvt_pk_bf16_f32 v249, v196, v197
 v_cvt_pk_bf16_f32 v250, v194, v195
 v_cvt_pk_bf16_f32 v251, v198, v199
 buffer_store_dwordx4 v[248:251], v1, s[20:23], s44 offen offset:0 sc1
 v_pk_mul_f32 v[200:201], v[200:201], v[40:41] op_sel_hi:[1,0]
 v_pk_mul_f32 v[202:203], v[202:203], v[40:41] op_sel_hi:[1,0]
 v_pk_mul_f32 v[204:205], v[204:205], v[40:41] op_sel_hi:[1,0]
 v_pk_mul_f32 v[206:207], v[206:207], v[40:41] op_sel_hi:[1,0]
 v_cvt_pk_bf16_f32 v252, v200, v201
 v_cvt_pk_bf16_f32 v253, v204, v205
 v_cvt_pk_bf16_f32 v254, v202, v203
 v_cvt_pk_bf16_f32 v255, v206, v207
 buffer_store_dwordx4 v[252:255], v1, s[20:23], s44 offen offset:2048 sc1
 v_pk_mul_f32 v[208:209], v[208:209], v[44:45] op_sel_hi:[1,0]
 v_pk_mul_f32 v[210:211], v[210:211], v[44:45] op_sel_hi:[1,0]
 v_pk_mul_f32 v[212:213], v[212:213], v[44:45] op_sel_hi:[1,0]
 v_pk_mul_f32 v[214:215], v[214:215], v[44:45] op_sel_hi:[1,0]
 v_cvt_pk_bf16_f32 v240, v208, v209
 v_cvt_pk_bf16_f32 v241, v212, v213
 v_cvt_pk_bf16_f32 v242, v210, v211
 v_cvt_pk_bf16_f32 v243, v214, v215
 buffer_store_dwordx4 v[240:243], v1, s[20:23], s40 offen offset:1024 sc1
 v_pk_mul_f32 v[216:217], v[216:217], v[44:45] op_sel_hi:[1,0]
 v_pk_mul_f32 v[218:219], v[218:219], v[44:45] op_sel_hi:[1,0]
 v_pk_mul_f32 v[220:221], v[220:221], v[44:45] op_sel_hi:[1,0]
 v_pk_mul_f32 v[222:223], v[222:223], v[44:45] op_sel_hi:[1,0]
 v_cvt_pk_bf16_f32 v244, v216, v217
 v_cvt_pk_bf16_f32 v245, v220, v221
 v_cvt_pk_bf16_f32 v246, v218, v219
 v_cvt_pk_bf16_f32 v247, v222, v223
 buffer_store_dwordx4 v[244:247], v1, s[20:23], s40 offen offset:3072 sc1
 v_pk_mul_f32 v[224:225], v[224:225], v[44:45] op_sel_hi:[1,0]
 v_pk_mul_f32 v[226:227], v[226:227], v[44:45] op_sel_hi:[1,0]
 v_pk_mul_f32 v[228:229], v[228:229], v[44:45] op_sel_hi:[1,0]
 v_pk_mul_f32 v[230:231], v[230:231], v[44:45] op_sel_hi:[1,0]
 v_cvt_pk_bf16_f32 v248, v224, v225
 v_cvt_pk_bf16_f32 v249, v228, v229
 v_cvt_pk_bf16_f32 v250, v226, v227
 v_cvt_pk_bf16_f32 v251, v230, v231
 buffer_store_dwordx4 v[248:251], v1, s[20:23], s44 offen offset:1024 sc1
 v_pk_mul_f32 v[232:233], v[232:233], v[44:45] op_sel_hi:[1,0]
 v_pk_mul_f32 v[234:235], v[234:235], v[44:45] op_sel_hi:[1,0]
 v_pk_mul_f32 v[236:237], v[236:237], v[44:45] op_sel_hi:[1,0]
 v_pk_mul_f32 v[238:239], v[238:239], v[44:45] op_sel_hi:[1,0]
 v_cvt_pk_bf16_f32 v252, v232, v233
 v_cvt_pk_bf16_f32 v253, v236, v237
 v_cvt_pk_bf16_f32 v254, v234, v235
 v_cvt_pk_bf16_f32 v255, v238, v239
 buffer_store_dwordx4 v[252:255], v1, s[20:23], s44 offen offset:3072 sc1
 s_lshl_b32 s72, s33, 5
 s_add_u32 s72, s72, s32
 s_lshl_b32 s72, s72, 2
 s_add_u32 s72, s72, 0x3c00
 s_cmp_eq_u32 s46, 1
 s_cbranch_scc1 Ladone_12
 s_mov_b32 s46, 1
 s_mov_b32 s33, s34
 v_accvgpr_mov_b32 a0, a64
 v_accvgpr_mov_b32 a1, a65
 v_accvgpr_mov_b32 a2, a66
 v_accvgpr_mov_b32 a3, a67
 v_accvgpr_mov_b32 a4, a68
 v_accvgpr_mov_b32 a5, a69
 v_accvgpr_mov_b32 a6, a70
 v_accvgpr_mov_b32 a7, a71
 v_accvgpr_mov_b32 a8, a72
 v_accvgpr_mov_b32 a9, a73
 v_accvgpr_mov_b32 a10, a74
 v_accvgpr_mov_b32 a11, a75
 v_accvgpr_mov_b32 a12, a76
 v_accvgpr_mov_b32 a13, a77
 v_accvgpr_mov_b32 a14, a78
 v_accvgpr_mov_b32 a15, a79
 v_accvgpr_mov_b32 a16, a80
 v_accvgpr_mov_b32 a17, a81
 v_accvgpr_mov_b32 a18, a82
 v_accvgpr_mov_b32 a19, a83
 v_accvgpr_mov_b32 a20, a84
 v_accvgpr_mov_b32 a21, a85
 v_accvgpr_mov_b32 a22, a86
 v_accvgpr_mov_b32 a23, a87
 v_accvgpr_mov_b32 a24, a88
 v_accvgpr_mov_b32 a25, a89
 v_accvgpr_mov_b32 a26, a90
 v_accvgpr_mov_b32 a27, a91
 v_accvgpr_mov_b32 a28, a92
 v_accvgpr_mov_b32 a29, a93
 v_accvgpr_mov_b32 a30, a94
 v_accvgpr_mov_b32 a31, a95
 v_accvgpr_mov_b32 a32, a96
 v_accvgpr_mov_b32 a33, a97
 v_accvgpr_mov_b32 a34, a98
 v_accvgpr_mov_b32 a35, a99
 v_accvgpr_mov_b32 a36, a100
 v_accvgpr_mov_b32 a37, a101
 v_accvgpr_mov_b32 a38, a102
 v_accvgpr_mov_b32 a39, a103
 v_accvgpr_mov_b32 a40, a104
 v_accvgpr_mov_b32 a41, a105
 v_accvgpr_mov_b32 a42, a106
 v_accvgpr_mov_b32 a43, a107
 v_accvgpr_mov_b32 a44, a108
 v_accvgpr_mov_b32 a45, a109
 v_accvgpr_mov_b32 a46, a110
 v_accvgpr_mov_b32 a47, a111
 v_accvgpr_mov_b32 a48, a112
 v_accvgpr_mov_b32 a49, a113
 v_accvgpr_mov_b32 a50, a114
 v_accvgpr_mov_b32 a51, a115
 v_accvgpr_mov_b32 a52, a116
 v_accvgpr_mov_b32 a53, a117
 v_accvgpr_mov_b32 a54, a118
 v_accvgpr_mov_b32 a55, a119
 v_accvgpr_mov_b32 a56, a120
 v_accvgpr_mov_b32 a57, a121
 v_accvgpr_mov_b32 a58, a122
 v_accvgpr_mov_b32 a59, a123
 v_accvgpr_mov_b32 a60, a124
 v_accvgpr_mov_b32 a61, a125
 v_accvgpr_mov_b32 a62, a126
 v_accvgpr_mov_b32 a63, a127
 s_branch Lablk_9
Laslow_10:
 s_waitcnt vmcnt(0) lgkmcnt(0)
 v_mov_b32 v12, 0
 v_mov_b32 v240, v4
 v_mov_b32 v13, 0
 v_mov_b32 v241, v4
 v_mov_b32 v14, 0
 v_mov_b32 v242, v4
 v_mov_b32 v15, 0
 v_mov_b32 v243, v4
 s_mov_b32 s49, 0
Lsl_17:
 s_lshl_b32 s37, s49, 19
 s_add_u32 s37, s37, s45
 s_sub_u32 s37, s37, s50
 s_add_u32 s44, s37, 0
 buffer_load_dwordx4 a[128:131], v1, s[20:23], s44 offen offset:0 sc1
 buffer_load_dwordx4 a[132:135], v1, s[20:23], s44 offen offset:1024 sc1
 buffer_load_dwordx4 a[136:139], v1, s[20:23], s44 offen offset:2048 sc1
 buffer_load_dwordx4 a[140:143], v1, s[20:23], s44 offen offset:3072 sc1
 s_add_u32 s44, s37, 4096
 buffer_load_dwordx4 a[144:147], v1, s[20:23], s44 offen offset:0 sc1
 buffer_load_dwordx4 a[148:151], v1, s[20:23], s44 offen offset:1024 sc1
 buffer_load_dwordx4 a[152:155], v1, s[20:23], s44 offen offset:2048 sc1
 buffer_load_dwordx4 a[156:159], v1, s[20:23], s44 offen offset:3072 sc1
 s_cmp_lt_u32 s49, s41
 s_cselect_b64 s[68:69], -1, 0
 s_cmp_le_u32 s49, s41
 s_cselect_b64 s[70:71], -1, 0
 s_cmp_eq_u32 s49, s41
 s_cselect_b64 s[60:61], s[52:53], s[68:69]
 s_cselect_b64 s[62:63], s[54:55], s[68:69]
 s_cselect_b64 s[64:65], s[56:57], s[68:69]
 s_cselect_b64 s[66:67], s[58:59], s[68:69]
 v_cndmask_b32 v80, v4, v12, s[60:61]
 v_cndmask_b32 v81, v4, v12, s[62:63]
 v_cndmask_b32 v82, v4, v12, s[64:65]
 v_cndmask_b32 v83, v4, v12, s[66:67]
 v_cndmask_b32 v84, v4, v12, s[68:69]
 v_cndmask_b32 v85, v4, v12, s[68:69]
 v_cndmask_b32 v86, v4, v12, s[68:69]
 v_cndmask_b32 v87, v4, v12, s[68:69]
 v_cndmask_b32 v88, v4, v13, s[70:71]
 v_cndmask_b32 v89, v4, v13, s[70:71]
 v_cndmask_b32 v90, v4, v13, s[70:71]
 v_cndmask_b32 v91, v4, v13, s[70:71]
 v_cndmask_b32 v92, v4, v13, s[60:61]
 v_cndmask_b32 v93, v4, v13, s[62:63]
 v_cndmask_b32 v94, v4, v13, s[64:65]
 v_cndmask_b32 v95, v4, v13, s[66:67]
 s_cmp_lt_u32 s49, s42
 s_cselect_b64 s[68:69], -1, 0
 s_cmp_le_u32 s49, s42
 s_cselect_b64 s[70:71], -1, 0
 s_cmp_eq_u32 s49, s42
 s_cselect_b64 s[60:61], s[52:53], s[68:69]
 s_cselect_b64 s[62:63], s[54:55], s[68:69]
 s_cselect_b64 s[64:65], s[56:57], s[68:69]
 s_cselect_b64 s[66:67], s[58:59], s[68:69]
 v_cndmask_b32 v96, v4, v14, s[60:61]
 v_cndmask_b32 v97, v4, v14, s[62:63]
 v_cndmask_b32 v98, v4, v14, s[64:65]
 v_cndmask_b32 v99, v4, v14, s[66:67]
 v_cndmask_b32 v100, v4, v14, s[68:69]
 v_cndmask_b32 v101, v4, v14, s[68:69]
 v_cndmask_b32 v102, v4, v14, s[68:69]
 v_cndmask_b32 v103, v4, v14, s[68:69]
 v_cndmask_b32 v104, v4, v15, s[70:71]
 v_cndmask_b32 v105, v4, v15, s[70:71]
 v_cndmask_b32 v106, v4, v15, s[70:71]
 v_cndmask_b32 v107, v4, v15, s[70:71]
 v_cndmask_b32 v108, v4, v15, s[60:61]
 v_cndmask_b32 v109, v4, v15, s[62:63]
 v_cndmask_b32 v110, v4, v15, s[64:65]
 v_cndmask_b32 v111, v4, v15, s[66:67]
 s_waitcnt vmcnt(0)
 s_nop 0
 v_mfma_f32_16x16x32_bf16 v[48:51], a[128:131], a[0:3], v[80:83]
 v_mfma_f32_16x16x32_bf16 v[56:59], a[128:131], a[16:19], v[88:91]
 v_mfma_f32_16x16x32_bf16 v[64:67], a[128:131], a[32:35], v[96:99]
 v_mfma_f32_16x16x32_bf16 v[72:75], a[128:131], a[48:51], v[104:107]
 v_mfma_f32_16x16x32_bf16 v[52:55], a[132:135], a[0:3], v[84:87]
 v_mfma_f32_16x16x32_bf16 v[60:63], a[132:135], a[16:19], v[92:95]
 v_mfma_f32_16x16x32_bf16 v[68:71], a[132:135], a[32:35], v[100:103]
 v_mfma_f32_16x16x32_bf16 v[76:79], a[132:135], a[48:51], v[108:111]
 v_mfma_f32_16x16x32_bf16 v[48:51], a[136:139], a[4:7], v[48:51]
 v_mfma_f32_16x16x32_bf16 v[56:59], a[136:139], a[20:23], v[56:59]
 v_mfma_f32_16x16x32_bf16 v[64:67], a[136:139], a[36:39], v[64:67]
 v_mfma_f32_16x16x32_bf16 v[72:75], a[136:139], a[52:55], v[72:75]
 v_mfma_f32_16x16x32_bf16 v[52:55], a[140:143], a[4:7], v[52:55]
 v_mfma_f32_16x16x32_bf16 v[60:63], a[140:143], a[20:23], v[60:63]
 v_mfma_f32_16x16x32_bf16 v[68:71], a[140:143], a[36:39], v[68:71]
 v_mfma_f32_16x16x32_bf16 v[76:79], a[140:143], a[52:55], v[76:79]
 v_mfma_f32_16x16x32_bf16 v[48:51], a[144:147], a[8:11], v[48:51]
 v_mfma_f32_16x16x32_bf16 v[56:59], a[144:147], a[24:27], v[56:59]
 v_mfma_f32_16x16x32_bf16 v[64:67], a[144:147], a[40:43], v[64:67]
 v_mfma_f32_16x16x32_bf16 v[72:75], a[144:147], a[56:59], v[72:75]
 v_mfma_f32_16x16x32_bf16 v[52:55], a[148:151], a[8:11], v[52:55]
 v_mfma_f32_16x16x32_bf16 v[60:63], a[148:151], a[24:27], v[60:63]
 v_mfma_f32_16x16x32_bf16 v[68:71], a[148:151], a[40:43], v[68:71]
 v_mfma_f32_16x16x32_bf16 v[76:79], a[148:151], a[56:59], v[76:79]
 v_mfma_f32_16x16x32_bf16 v[48:51], a[152:155], a[12:15], v[48:51]
 v_mfma_f32_16x16x32_bf16 v[56:59], a[152:155], a[28:31], v[56:59]
 v_mfma_f32_16x16x32_bf16 v[64:67], a[152:155], a[44:47], v[64:67]
 v_mfma_f32_16x16x32_bf16 v[72:75], a[152:155], a[60:63], v[72:75]
 v_mfma_f32_16x16x32_bf16 v[52:55], a[156:159], a[12:15], v[52:55]
 v_mfma_f32_16x16x32_bf16 v[60:63], a[156:159], a[28:31], v[60:63]
 v_mfma_f32_16x16x32_bf16 v[68:71], a[156:159], a[44:47], v[68:71]
 v_mfma_f32_16x16x32_bf16 v[76:79], a[156:159], a[60:63], v[76:79]
 s_nop 7
 v_max3_f32 v240, v240, v48, v49
 v_max3_f32 v240, v240, v50, v51
 v_max3_f32 v240, v240, v52, v53
 v_max3_f32 v240, v240, v54, v55
 v_max3_f32 v241, v241, v56, v57
 v_max3_f32 v241, v241, v58, v59
 v_max3_f32 v241, v241, v60, v61
 v_max3_f32 v241, v241, v62, v63
 v_max3_f32 v242, v242, v64, v65
 v_max3_f32 v242, v242, v66, v67
 v_max3_f32 v242, v242, v68, v69
 v_max3_f32 v242, v242, v70, v71
 v_max3_f32 v243, v243, v72, v73
 v_max3_f32 v243, v243, v74, v75
 v_max3_f32 v243, v243, v76, v77
 v_max3_f32 v243, v243, v78, v79
 s_add_u32 s49, s49, 1
 s_cmp_le_u32 s49, s42
 s_cbranch_scc1 Lsl_17
 v_mov_b32 v244, v240
 v_mov_b32 v245, v241
 v_mov_b32 v246, v242
 v_mov_b32 v247, v243
 v_permlane16_swap_b32 v240, v244
 v_permlane16_swap_b32 v241, v245
 v_permlane16_swap_b32 v242, v246
 v_permlane16_swap_b32 v243, v247
 v_max_f32 v240, v240, v244
 v_max_f32 v241, v241, v245
 v_max_f32 v242, v242, v246
 v_max_f32 v243, v243, v247
 v_mov_b32 v244, v240
 v_mov_b32 v245, v241
 v_mov_b32 v246, v242
 v_mov_b32 v247, v243
 v_permlane32_swap_b32 v240, v244
 v_permlane32_swap_b32 v241, v245
 v_permlane32_swap_b32 v242, v246
 v_permlane32_swap_b32 v243, v247
 v_max_f32 v240, v240, v244
 v_max_f32 v241, v241, v245
 v_max_f32 v242, v242, v246
 v_max_f32 v243, v243, v247
 v_sub_f32 v12, 0, v240
 v_sub_f32 v13, 0, v241
 v_sub_f32 v14, 0, v242
 v_sub_f32 v15, 0, v243
 v_mov_b64 v[112:113], 0
 v_mov_b64 v[114:115], 0
 v_mov_b64 v[116:117], 0
 v_mov_b64 v[118:119], 0
 v_mov_b64 v[120:121], 0
 v_mov_b64 v[122:123], 0
 v_mov_b64 v[124:125], 0
 v_mov_b64 v[126:127], 0
 v_mov_b64 v[128:129], 0
 v_mov_b64 v[130:131], 0
 v_mov_b64 v[132:133], 0
 v_mov_b64 v[134:135], 0
 v_mov_b64 v[136:137], 0
 v_mov_b64 v[138:139], 0
 v_mov_b64 v[140:141], 0
 v_mov_b64 v[142:143], 0
 v_mov_b64 v[144:145], 0
 v_mov_b64 v[146:147], 0
 v_mov_b64 v[148:149], 0
 v_mov_b64 v[150:151], 0
 v_mov_b64 v[152:153], 0
 v_mov_b64 v[154:155], 0
 v_mov_b64 v[156:157], 0
 v_mov_b64 v[158:159], 0
 v_mov_b64 v[160:161], 0
 v_mov_b64 v[162:163], 0
 v_mov_b64 v[164:165], 0
 v_mov_b64 v[166:167], 0
 v_mov_b64 v[168:169], 0
 v_mov_b64 v[170:171], 0
 v_mov_b64 v[172:173], 0
 v_mov_b64 v[174:175], 0
 v_mov_b64 v[176:177], 0
 v_mov_b64 v[178:179], 0
 v_mov_b64 v[180:181], 0
 v_mov_b64 v[182:183], 0
 v_mov_b64 v[184:185], 0
 v_mov_b64 v[186:187], 0
 v_mov_b64 v[188:189], 0
 v_mov_b64 v[190:191], 0
 v_mov_b64 v[192:193], 0
 v_mov_b64 v[194:195], 0
 v_mov_b64 v[196:197], 0
 v_mov_b64 v[198:199], 0
 v_mov_b64 v[200:201], 0
 v_mov_b64 v[202:203], 0
 v_mov_b64 v[204:205], 0
 v_mov_b64 v[206:207], 0
 v_mov_b64 v[208:209], 0
 v_mov_b64 v[210:211], 0
 v_mov_b64 v[212:213], 0
 v_mov_b64 v[214:215], 0
 v_mov_b64 v[216:217], 0
 v_mov_b64 v[218:219], 0
 v_mov_b64 v[220:221], 0
 v_mov_b64 v[222:223], 0
 v_mov_b64 v[224:225], 0
 v_mov_b64 v[226:227], 0
 v_mov_b64 v[228:229], 0
 v_mov_b64 v[230:231], 0
 v_mov_b64 v[232:233], 0
 v_mov_b64 v[234:235], 0
 v_mov_b64 v[236:237], 0
 v_mov_b64 v[238:239], 0
 v_mov_b64 v[32:33], 0
 v_mov_b64 v[34:35], 0
 v_mov_b64 v[36:37], 0
 v_mov_b64 v[38:39], 0
 v_mov_b64 v[40:41], 0
 v_mov_b64 v[42:43], 0
 v_mov_b64 v[44:45], 0
 v_mov_b64 v[46:47], 0
 s_mov_b32 s49, 0
Lsl_18:
 s_lshl_b32 s37, s49, 19
 s_add_u32 s37, s37, s45
 s_sub_u32 s37, s37, s50
 s_add_u32 s44, s37, 0
 buffer_load_dwordx4 a[128:131], v1, s[20:23], s44 offen offset:0 sc1
 buffer_load_dwordx4 a[132:135], v1, s[20:23], s44 offen offset:1024 sc1
 buffer_load_dwordx4 a[136:139], v1, s[20:23], s44 offen offset:2048 sc1
 buffer_load_dwordx4 a[140:143], v1, s[20:23], s44 offen offset:3072 sc1
 s_add_u32 s44, s37, 4096
 buffer_load_dwordx4 a[144:147], v1, s[20:23], s44 offen offset:0 sc1
 buffer_load_dwordx4 a[148:151], v1, s[20:23], s44 offen offset:1024 sc1
 buffer_load_dwordx4 a[152:155], v1, s[20:23], s44 offen offset:2048 sc1
 buffer_load_dwordx4 a[156:159], v1, s[20:23], s44 offen offset:3072 sc1
 s_add_u32 s44, s37, 8192
 buffer_load_dwordx4 a[160:163], v1, s[20:23], s44 offen offset:0 sc1
 buffer_load_dwordx4 a[164:167], v1, s[20:23], s44 offen offset:1024 sc1
 buffer_load_dwordx4 a[168:171], v1, s[20:23], s44 offen offset:2048 sc1
 buffer_load_dwordx4 a[172:175], v1, s[20:23], s44 offen offset:3072 sc1
 s_add_u32 s44, s37, 12288
 buffer_load_dwordx4 a[176:179], v1, s[20:23], s44 offen offset:0 sc1
 buffer_load_dwordx4 a[180:183], v1, s[20:23], s44 offen offset:1024 sc1
 buffer_load_dwordx4 a[184:187], v1, s[20:23], s44 offen offset:2048 sc1
 buffer_load_dwordx4 a[188:191], v1, s[20:23], s44 offen offset:3072 sc1
 s_cmp_lt_u32 s49, s41
 s_cselect_b64 s[68:69], -1, 0
 s_cmp_le_u32 s49, s41
 s_cselect_b64 s[70:71], -1, 0
 s_cmp_eq_u32 s49, s41
 s_cselect_b64 s[60:61], s[52:53], s[68:69]
 s_cselect_b64 s[62:63], s[54:55], s[68:69]
 s_cselect_b64 s[64:65], s[56:57], s[68:69]
 s_cselect_b64 s[66:67], s[58:59], s[68:69]
 v_cndmask_b32 v80, v4, v12, s[60:61]
 v_cndmask_b32 v81, v4, v12, s[62:63]
 v_cndmask_b32 v82, v4, v12, s[64:65]
 v_cndmask_b32 v83, v4, v12, s[66:67]
 v_cndmask_b32 v84, v4, v12, s[68:69]
 v_cndmask_b32 v85, v4, v12, s[68:69]
 v_cndmask_b32 v86, v4, v12, s[68:69]
 v_cndmask_b32 v87, v4, v12, s[68:69]
 v_cndmask_b32 v88, v4, v13, s[70:71]
 v_cndmask_b32 v89, v4, v13, s[70:71]
 v_cndmask_b32 v90, v4, v13, s[70:71]
 v_cndmask_b32 v91, v4, v13, s[70:71]
 v_cndmask_b32 v92, v4, v13, s[60:61]
 v_cndmask_b32 v93, v4, v13, s[62:63]
 v_cndmask_b32 v94, v4, v13, s[64:65]
 v_cndmask_b32 v95, v4, v13, s[66:67]
 s_cmp_lt_u32 s49, s42
 s_cselect_b64 s[68:69], -1, 0
 s_cmp_le_u32 s49, s42
 s_cselect_b64 s[70:71], -1, 0
 s_cmp_eq_u32 s49, s42
 s_cselect_b64 s[60:61], s[52:53], s[68:69]
 s_cselect_b64 s[62:63], s[54:55], s[68:69]
 s_cselect_b64 s[64:65], s[56:57], s[68:69]
 s_cselect_b64 s[66:67], s[58:59], s[68:69]
 v_cndmask_b32 v96, v4, v14, s[60:61]
 v_cndmask_b32 v97, v4, v14, s[62:63]
 v_cndmask_b32 v98, v4, v14, s[64:65]
 v_cndmask_b32 v99, v4, v14, s[66:67]
 v_cndmask_b32 v100, v4, v14, s[68:69]
 v_cndmask_b32 v101, v4, v14, s[68:69]
 v_cndmask_b32 v102, v4, v14, s[68:69]
 v_cndmask_b32 v103, v4, v14, s[68:69]
 v_cndmask_b32 v104, v4, v15, s[70:71]
 v_cndmask_b32 v105, v4, v15, s[70:71]
 v_cndmask_b32 v106, v4, v15, s[70:71]
 v_cndmask_b32 v107, v4, v15, s[70:71]
 v_cndmask_b32 v108, v4, v15, s[60:61]
 v_cndmask_b32 v109, v4, v15, s[62:63]
 v_cndmask_b32 v110, v4, v15, s[64:65]
 v_cndmask_b32 v111, v4, v15, s[66:67]
 s_waitcnt vmcnt(0)
 s_nop 0
 v_mfma_f32_16x16x32_bf16 v[48:51], a[128:131], a[0:3], v[80:83]
 v_mfma_f32_16x16x32_bf16 v[56:59], a[128:131], a[16:19], v[88:91]
 v_mfma_f32_16x16x32_bf16 v[64:67], a[128:131], a[32:35], v[96:99]
 v_mfma_f32_16x16x32_bf16 v[72:75], a[128:131], a[48:51], v[104:107]
 v_mfma_f32_16x16x32_bf16 v[52:55], a[132:135], a[0:3], v[84:87]
 v_mfma_f32_16x16x32_bf16 v[60:63], a[132:135], a[16:19], v[92:95]
 v_mfma_f32_16x16x32_bf16 v[68:71], a[132:135], a[32:35], v[100:103]
 v_mfma_f32_16x16x32_bf16 v[76:79], a[132:135], a[48:51], v[108:111]
 v_mfma_f32_16x16x32_bf16 v[48:51], a[136:139], a[4:7], v[48:51]
 v_mfma_f32_16x16x32_bf16 v[56:59], a[136:139], a[20:23], v[56:59]
 v_mfma_f32_16x16x32_bf16 v[64:67], a[136:139], a[36:39], v[64:67]
 v_mfma_f32_16x16x32_bf16 v[72:75], a[136:139], a[52:55], v[72:75]
 v_mfma_f32_16x16x32_bf16 v[52:55], a[140:143], a[4:7], v[52:55]
 v_mfma_f32_16x16x32_bf16 v[60:63], a[140:143], a[20:23], v[60:63]
 v_mfma_f32_16x16x32_bf16 v[68:71], a[140:143], a[36:39], v[68:71]
 v_mfma_f32_16x16x32_bf16 v[76:79], a[140:143], a[52:55], v[76:79]
 v_mfma_f32_16x16x32_bf16 v[48:51], a[144:147], a[8:11], v[48:51]
 v_mfma_f32_16x16x32_bf16 v[56:59], a[144:147], a[24:27], v[56:59]
 v_mfma_f32_16x16x32_bf16 v[64:67], a[144:147], a[40:43], v[64:67]
 v_mfma_f32_16x16x32_bf16 v[72:75], a[144:147], a[56:59], v[72:75]
 v_mfma_f32_16x16x32_bf16 v[52:55], a[148:151], a[8:11], v[52:55]
 v_mfma_f32_16x16x32_bf16 v[60:63], a[148:151], a[24:27], v[60:63]
 v_mfma_f32_16x16x32_bf16 v[68:71], a[148:151], a[40:43], v[68:71]
 v_mfma_f32_16x16x32_bf16 v[76:79], a[148:151], a[56:59], v[76:79]
 v_mfma_f32_16x16x32_bf16 v[48:51], a[152:155], a[12:15], v[48:51]
 v_mfma_f32_16x16x32_bf16 v[56:59], a[152:155], a[28:31], v[56:59]
 v_mfma_f32_16x16x32_bf16 v[64:67], a[152:155], a[44:47], v[64:67]
 v_mfma_f32_16x16x32_bf16 v[72:75], a[152:155], a[60:63], v[72:75]
 v_mfma_f32_16x16x32_bf16 v[52:55], a[156:159], a[12:15], v[52:55]
 v_mfma_f32_16x16x32_bf16 v[60:63], a[156:159], a[28:31], v[60:63]
 v_mfma_f32_16x16x32_bf16 v[68:71], a[156:159], a[44:47], v[68:71]
 v_mfma_f32_16x16x32_bf16 v[76:79], a[156:159], a[60:63], v[76:79]
 s_nop 7
 v_exp_f32 v48, v48
 v_exp_f32 v49, v49
 v_exp_f32 v52, v52
 v_exp_f32 v53, v53
 v_exp_f32 v50, v50
 v_cvt_pk_bf16_f32 v16, v48, v49
 v_cvt_pk_bf16_f32 v17, v52, v53
 v_exp_f32 v51, v51
 v_exp_f32 v54, v54
 v_exp_f32 v55, v55
 v_cvt_pk_bf16_f32 v18, v50, v51
 v_cvt_pk_bf16_f32 v19, v54, v55
 v_exp_f32 v56, v56
 v_exp_f32 v57, v57
 v_exp_f32 v60, v60
 v_exp_f32 v61, v61
 v_exp_f32 v58, v58
 v_cvt_pk_bf16_f32 v20, v56, v57
 v_cvt_pk_bf16_f32 v21, v60, v61
 v_exp_f32 v59, v59
 v_exp_f32 v62, v62
 v_exp_f32 v63, v63
 v_cvt_pk_bf16_f32 v22, v58, v59
 v_cvt_pk_bf16_f32 v23, v62, v63
 v_exp_f32 v64, v64
 v_exp_f32 v65, v65
 v_exp_f32 v68, v68
 v_exp_f32 v69, v69
 v_exp_f32 v66, v66
 v_cvt_pk_bf16_f32 v24, v64, v65
 v_cvt_pk_bf16_f32 v25, v68, v69
 v_exp_f32 v67, v67
 v_exp_f32 v70, v70
 v_exp_f32 v71, v71
 v_cvt_pk_bf16_f32 v26, v66, v67
 v_cvt_pk_bf16_f32 v27, v70, v71
 v_exp_f32 v72, v72
 v_exp_f32 v73, v73
 v_exp_f32 v76, v76
 v_exp_f32 v77, v77
 v_exp_f32 v74, v74
 v_cvt_pk_bf16_f32 v28, v72, v73
 v_cvt_pk_bf16_f32 v29, v76, v77
 v_exp_f32 v75, v75
 v_exp_f32 v78, v78
 v_exp_f32 v79, v79
 v_cvt_pk_bf16_f32 v30, v74, v75
 v_cvt_pk_bf16_f32 v31, v78, v79
 s_nop 1
 v_mfma_f32_16x16x32_bf16 v[112:115], a[160:163], v[16:19], v[112:115]
 v_mfma_f32_16x16x32_bf16 v[144:147], a[160:163], v[20:23], v[144:147]
 v_mfma_f32_16x16x32_bf16 v[176:179], a[160:163], v[24:27], v[176:179]
 v_mfma_f32_16x16x32_bf16 v[208:211], a[160:163], v[28:31], v[208:211]
 v_mfma_f32_16x16x32_bf16 v[116:119], a[164:167], v[16:19], v[116:119]
 v_mfma_f32_16x16x32_bf16 v[148:151], a[164:167], v[20:23], v[148:151]
 v_mfma_f32_16x16x32_bf16 v[180:183], a[164:167], v[24:27], v[180:183]
 v_mfma_f32_16x16x32_bf16 v[212:215], a[164:167], v[28:31], v[212:215]
 v_mfma_f32_16x16x32_bf16 v[120:123], a[168:171], v[16:19], v[120:123]
 v_mfma_f32_16x16x32_bf16 v[152:155], a[168:171], v[20:23], v[152:155]
 v_mfma_f32_16x16x32_bf16 v[184:187], a[168:171], v[24:27], v[184:187]
 v_mfma_f32_16x16x32_bf16 v[216:219], a[168:171], v[28:31], v[216:219]
 v_mfma_f32_16x16x32_bf16 v[124:127], a[172:175], v[16:19], v[124:127]
 v_mfma_f32_16x16x32_bf16 v[156:159], a[172:175], v[20:23], v[156:159]
 v_mfma_f32_16x16x32_bf16 v[188:191], a[172:175], v[24:27], v[188:191]
 v_mfma_f32_16x16x32_bf16 v[220:223], a[172:175], v[28:31], v[220:223]
 v_mfma_f32_16x16x32_bf16 v[128:131], a[176:179], v[16:19], v[128:131]
 v_mfma_f32_16x16x32_bf16 v[160:163], a[176:179], v[20:23], v[160:163]
 v_mfma_f32_16x16x32_bf16 v[192:195], a[176:179], v[24:27], v[192:195]
 v_mfma_f32_16x16x32_bf16 v[224:227], a[176:179], v[28:31], v[224:227]
 v_mfma_f32_16x16x32_bf16 v[132:135], a[180:183], v[16:19], v[132:135]
 v_mfma_f32_16x16x32_bf16 v[164:167], a[180:183], v[20:23], v[164:167]
 v_mfma_f32_16x16x32_bf16 v[196:199], a[180:183], v[24:27], v[196:199]
 v_mfma_f32_16x16x32_bf16 v[228:231], a[180:183], v[28:31], v[228:231]
 v_mfma_f32_16x16x32_bf16 v[136:139], a[184:187], v[16:19], v[136:139]
 v_mfma_f32_16x16x32_bf16 v[168:171], a[184:187], v[20:23], v[168:171]
 v_mfma_f32_16x16x32_bf16 v[200:203], a[184:187], v[24:27], v[200:203]
 v_mfma_f32_16x16x32_bf16 v[232:235], a[184:187], v[28:31], v[232:235]
 v_mfma_f32_16x16x32_bf16 v[140:143], a[188:191], v[16:19], v[140:143]
 v_mfma_f32_16x16x32_bf16 v[172:175], a[188:191], v[20:23], v[172:175]
 v_mfma_f32_16x16x32_bf16 v[204:207], a[188:191], v[24:27], v[204:207]
 v_mfma_f32_16x16x32_bf16 v[236:239], a[188:191], v[28:31], v[236:239]
 v_mfma_f32_16x16x32_bf16 v[32:35], a[192:195], v[16:19], v[32:35]
 v_mfma_f32_16x16x32_bf16 v[36:39], a[192:195], v[20:23], v[36:39]
 v_mfma_f32_16x16x32_bf16 v[40:43], a[192:195], v[24:27], v[40:43]
 v_mfma_f32_16x16x32_bf16 v[44:47], a[192:195], v[28:31], v[44:47]
 s_add_u32 s49, s49, 1
 s_cmp_le_u32 s49, s42
 s_cbranch_scc1 Lsl_18
 ds_read_b128 a[128:131], v3 offset:0
 ds_read_b128 a[132:135], v3 offset:1024
 ds_read_b128 a[136:139], v3 offset:2048
 ds_read_b128 a[140:143], v3 offset:3072
 ds_read_b128 a[144:147], v3 offset:4096
 ds_read_b128 a[148:151], v3 offset:5120
 ds_read_b128 a[152:155], v3 offset:6144
 ds_read_b128 a[156:159], v3 offset:7168
 s_branch Laback_11
Ladone_12:
 s_waitcnt vmcnt(0) lgkmcnt(0)
 s_barrier
 v_mov_b32 v6, 1
 buffer_store_dword v6, v5, s[20:23], s72 offen sc1
 s_cmp_ge_u32 s6, 27
 s_cbranch_scc1 Lfin
 s_load_dwordx2 s[8:9], s[0:1], 40
 s_mov_b32 s10, 0x480000
 s_mov_b32 s11, 0x20000
 s_mul_i32 s7, s6, 29
 s_lshr_b32 s7, s7, 8
 s_mul_i32 s94, s7, 9
 s_sub_u32 s32, s6, s94
 s_mul_i32 s40, s7, 3
 s_lshl_b32 s7, s7, 2
 s_add_u32 s7, s7, s5
 s_sub_u32 s33, s7, 4
 s_mov_b32 s34, 12
 s_cmp_lt_u32 s33, 4
 s_cselect_b32 s35, 6, 5
 s_mov_b32 s36, 0x6000000
 s_mov_b32 s37, 0
 s_lshl_b32 s38, s4, 5
 s_add_u32 s38, s38, 0x3c00
 s_mov_b32 s39, 0
 s_mov_b32 s93, 0x38
 s_mov_b32 s92, 7
 s_mov_b32 s91, 4
 s_mov_b32 s90, 31
 s_branch Los
Lpb:
 s_load_dwordx2 s[8:9], s[0:1], 48
 s_mov_b32 s10, 0x240000
 s_mov_b32 s11, 0x20000
 s_load_dwordx2 s[12:13], s[0:1], 72
 s_mov_b32 s14, 0x480000
 s_mov_b32 s15, 0x20000
 s_load_dwordx2 s[16:17], s[0:1], 80
 s_mov_b32 s18, 0x480000
 s_mov_b32 s19, 0x20000
 s_lshl_b32 s32, s6, 8
 s_mov_b32 s33, s32
 s_lshl_b32 s34, s6, 14
 s_add_u32 s34, s34, 0x3000000
 s_add_u32 s35, s34, 8192
 s_mov_b32 s36, 64
 s_mov_b32 s37, 0
 s_lshl_b32 s7, s6, 7
 s_add_u32 s7, s7, 0x0
 v_min_u32 v1, 1, v0
 v_lshlrev_b32 v1, 28, v1
 v_add_u32 v13, s7, v1
 s_waitcnt lgkmcnt(0)
 v_and_b32 v1, 63, v0
 v_lshrrev_b32 v2, 3, v0
 v_mul_u32_u24 v10, 1152, v2
 v_lshrrev_b32 v2, 4, v0
 v_xor_b32 v2, v2, v0
 v_and_b32 v2, 7, v2
 v_lshl_add_u32 v10, v2, 4, v10
 v_lshrrev_b32 v2, 4, v1
 v_bfe_u32 v3, v1, 1, 3
 v_xor_b32 v2, v2, v3
 v_and_b32 v3, 15, v1
 v_lshlrev_b32 v3, 7, v3
 v_lshl_add_u32 v4, v2, 4, v3
 v_xor_b32 v5, 64, v4
 v_lshrrev_b32 v2, 4, v0
 v_lshlrev_b32 v11, 13, v2
 v_lshrrev_b32 v2, 7, v0
 v_lshrrev_b32 v3, 4, v1
 v_lshl_add_u32 v3, v2, 2, v3
 v_bfe_u32 v2, v1, 1, 3
 v_xor_b32 v2, v2, v3
 v_lshl_add_u32 v11, v2, 5, v11
 v_and_b32 v2, 1, v1
 v_lshl_add_u32 v11, v2, 4, v11
 v_bfe_u32 v2, v1, 2, 3
 v_xor_b32 v3, s4, v2
 v_lshlrev_b32 v3, 5, v3
 v_and_b32 v2, 3, v2
 v_lshl_add_u32 v3, v2, 8, v3
 v_lshrrev_b32 v2, 4, v1
 v_lshl_add_u32 v3, v2, 11, v3
 v_and_b32 v2, 3, v1
 v_lshl_add_u32 v3, v2, 3, v3
 v_add_u32 v8, 73728, v3
 v_xor_b32 v3, 0x80, v3
 v_add_u32 v9, 73728, v3
 s_lshl_b32 s45, s4, 11
 v_lshl_add_u32 v12, v1, 4, s45
 s_mov_b32 s39, s37
 s_add_u32 s40, s39, 1
 s_lshl_b32 s49, s4, 10
 s_mul_i32 s46, s39, 36864
 s_add_u32 m0, s49, 0
 s_nop 0
 buffer_load_dwordx4 v10, s[8:11], s46 offen offset:0  lds
 s_add_u32 m0, s49, 3968
 s_nop 0
 buffer_load_dwordx4 v10, s[8:11], s46 offen offset:128  lds
 s_add_u32 m0, s49, 7936
 s_nop 0
 buffer_load_dwordx4 v10, s[8:11], s46 offen offset:256  lds
 s_add_u32 m0, s49, 11904
 s_nop 0
 buffer_load_dwordx4 v10, s[8:11], s46 offen offset:384  lds
 s_add_u32 m0, s49, 15872
 s_nop 0
 buffer_load_dwordx4 v10, s[8:11], s46 offen offset:512  lds
 s_add_u32 m0, s49, 19840
 s_nop 0
 buffer_load_dwordx4 v10, s[8:11], s46 offen offset:640  lds
 s_add_u32 m0, s49, 23808
 s_nop 0
 buffer_load_dwordx4 v10, s[8:11], s46 offen offset:768  lds
 s_add_u32 m0, s49, 27776
 s_nop 0
 buffer_load_dwordx4 v10, s[8:11], s46 offen offset:896  lds
 s_add_u32 m0, s49, 31744
 s_nop 0
 buffer_load_dwordx4 v10, s[8:11], s46 offen offset:1024  lds
 s_lshl_b32 s49, s4, 10
 s_add_u32 s49, s49, 36864
 s_mul_i32 s46, s40, 36864
 s_add_u32 m0, s49, 0
 s_nop 0
 buffer_load_dwordx4 v10, s[8:11], s46 offen offset:0  lds
 s_add_u32 m0, s49, 3968
 s_nop 0
 buffer_load_dwordx4 v10, s[8:11], s46 offen offset:128  lds
 s_add_u32 m0, s49, 7936
 s_nop 0
 buffer_load_dwordx4 v10, s[8:11], s46 offen offset:256  lds
 s_add_u32 m0, s49, 11904
 s_nop 0
 buffer_load_dwordx4 v10, s[8:11], s46 offen offset:384  lds
 s_add_u32 m0, s49, 15872
 s_nop 0
 buffer_load_dwordx4 v10, s[8:11], s46 offen offset:512  lds
 s_add_u32 m0, s49, 19840
 s_nop 0
 buffer_load_dwordx4 v10, s[8:11], s46 offen offset:640  lds
 s_add_u32 m0, s49, 23808
 s_nop 0
 buffer_load_dwordx4 v10, s[8:11], s46 offen offset:768  lds
 s_add_u32 m0, s49, 27776
 s_nop 0
 buffer_load_dwordx4 v10, s[8:11], s46 offen offset:896  lds
 s_add_u32 m0, s49, 31744
 s_nop 0
 buffer_load_dwordx4 v10, s[8:11], s46 offen offset:1024  lds
 s_lshl_b32 s49, s4, 10
 s_add_u32 m0, s49, 73728
 s_add_u32 s45, s32, 0
 buffer_load_dwordx4 v11, s[12:15], s45 offen  lds
 s_add_u32 m0, s49, 77824
 s_add_u32 s45, s32, 131072
 buffer_load_dwordx4 v11, s[12:15], s45 offen  lds
 s_add_u32 m0, s49, 81920
 s_add_u32 s45, s33, 0
 buffer_load_dwordx4 v11, s[16:19], s45 offen  lds
 s_add_u32 m0, s49, 86016
 s_add_u32 s45, s33, 131072
 buffer_load_dwordx4 v11, s[16:19], s45 offen  lds
 s_add_u32 m0, s49, 90112
 s_add_u32 s45, s32, 262144
 buffer_load_dwordx4 v11, s[12:15], s45 offen  lds
 s_add_u32 m0, s49, 94208
 s_add_u32 s45, s32, 393216
 buffer_load_dwordx4 v11, s[12:15], s45 offen  lds
 s_add_u32 m0, s49, 98304
 s_add_u32 s45, s33, 262144
 buffer_load_dwordx4 v11, s[16:19], s45 offen  lds
 s_add_u32 m0, s49, 102400
 s_add_u32 s45, s33, 393216
 buffer_load_dwordx4 v11, s[16:19], s45 offen  lds
 s_add_u32 m0, s49, 106496
 s_add_u32 s45, s32, 524288
 buffer_load_dwordx4 v11, s[12:15], s45 offen  lds
 s_add_u32 m0, s49, 110592
 s_add_u32 s45, s32, 655360
 buffer_load_dwordx4 v11, s[12:15], s45 offen  lds
 s_add_u32 m0, s49, 114688
 s_add_u32 s45, s33, 524288
 buffer_load_dwordx4 v11, s[16:19], s45 offen  lds
 s_add_u32 m0, s49, 118784
 s_add_u32 s45, s33, 655360
 buffer_load_dwordx4 v11, s[16:19], s45 offen  lds
 s_waitcnt vmcnt(8) lgkmcnt(0)
 s_barrier
 s_add_u32 m0, s49, 122880
 s_add_u32 s45, s32, 786432
 buffer_load_dwordx4 v11, s[12:15], s45 offen  lds
 s_add_u32 m0, s49, 126976
 s_add_u32 s45, s32, 917504
 buffer_load_dwordx4 v11, s[12:15], s45 offen  lds
 s_add_u32 m0, s49, 131072
 s_add_u32 s45, s33, 786432
 buffer_load_dwordx4 v11, s[16:19], s45 offen  lds
 s_add_u32 m0, s49, 135168
 s_add_u32 s45, s33, 917504
 buffer_load_dwordx4 v11, s[16:19], s45 offen  lds
 ds_read_b64_tr_b16 a[0:1], v8 offset:0
 ds_read_b64_tr_b16 a[2:3], v8 offset:1024
 ds_read_b64_tr_b16 a[72:73], v9 offset:0
 ds_read_b64_tr_b16 a[74:75], v9 offset:1024
 ds_read_b64_tr_b16 a[144:145], v8 offset:8192
 ds_read_b64_tr_b16 a[146:147], v8 offset:9216
 ds_read_b64_tr_b16 a[216:217], v9 offset:8192
 ds_read_b64_tr_b16 a[218:219], v9 offset:9216
 s_waitcnt vmcnt(8) lgkmcnt(0)
 s_barrier
 s_add_u32 m0, s49, 73728
 s_add_u32 s45, s32, 1048576
 buffer_load_dwordx4 v11, s[12:15], s45 offen  lds
 s_add_u32 m0, s49, 77824
 s_add_u32 s45, s32, 1179648
 buffer_load_dwordx4 v11, s[12:15], s45 offen  lds
 s_add_u32 m0, s49, 81920
 s_add_u32 s45, s33, 1048576
 buffer_load_dwordx4 v11, s[16:19], s45 offen  lds
 s_add_u32 m0, s49, 86016
 s_add_u32 s45, s33, 1179648
 buffer_load_dwordx4 v11, s[16:19], s45 offen  lds
 ds_read_b64_tr_b16 a[4:5], v8 offset:16384
 ds_read_b64_tr_b16 a[6:7], v8 offset:17408
 ds_read_b64_tr_b16 a[76:77], v9 offset:16384
 ds_read_b64_tr_b16 a[78:79], v9 offset:17408
 ds_read_b64_tr_b16 a[148:149], v8 offset:24576
 ds_read_b64_tr_b16 a[150:151], v8 offset:25600
 ds_read_b64_tr_b16 a[220:221], v9 offset:24576
 ds_read_b64_tr_b16 a[222:223], v9 offset:25600
 s_waitcnt vmcnt(8) lgkmcnt(0)
 s_barrier
 s_add_u32 m0, s49, 90112
 s_add_u32 s45, s32, 1310720
 buffer_load_dwordx4 v11, s[12:15], s45 offen  lds
 s_add_u32 m0, s49, 94208
 s_add_u32 s45, s32, 1441792
 buffer_load_dwordx4 v11, s[12:15], s45 offen  lds
 s_add_u32 m0, s49, 98304
 s_add_u32 s45, s33, 1310720
 buffer_load_dwordx4 v11, s[16:19], s45 offen  lds
 s_add_u32 m0, s49, 102400
 s_add_u32 s45, s33, 1441792
 buffer_load_dwordx4 v11, s[16:19], s45 offen  lds
 ds_read_b64_tr_b16 a[8:9], v8 offset:32768
 ds_read_b64_tr_b16 a[10:11], v8 offset:33792
 ds_read_b64_tr_b16 a[80:81], v9 offset:32768
 ds_read_b64_tr_b16 a[82:83], v9 offset:33792
 ds_read_b64_tr_b16 a[152:153], v8 offset:40960
 ds_read_b64_tr_b16 a[154:155], v8 offset:41984
 ds_read_b64_tr_b16 a[224:225], v9 offset:40960
 ds_read_b64_tr_b16 a[226:227], v9 offset:41984
 s_waitcnt vmcnt(8) lgkmcnt(0)
 s_barrier
 s_add_u32 m0, s49, 106496
 s_add_u32 s45, s32, 1572864
 buffer_load_dwordx4 v11, s[12:15], s45 offen  lds
 s_add_u32 m0, s49, 110592
 s_add_u32 s45, s32, 1703936
 buffer_load_dwordx4 v11, s[12:15], s45 offen  lds
 s_add_u32 m0, s49, 114688
 s_add_u32 s45, s33, 1572864
 buffer_load_dwordx4 v11, s[16:19], s45 offen  lds
 s_add_u32 m0, s49, 118784
 s_add_u32 s45, s33, 1703936
 buffer_load_dwordx4 v11, s[16:19], s45 offen  lds
 ds_read_b64_tr_b16 a[12:13], v8 offset:49152
 ds_read_b64_tr_b16 a[14:15], v8 offset:50176
 ds_read_b64_tr_b16 a[84:85], v9 offset:49152
 ds_read_b64_tr_b16 a[86:87], v9 offset:50176
 ds_read_b64_tr_b16 a[156:157], v8 offset:57344
 ds_read_b64_tr_b16 a[158:159], v8 offset:58368
 ds_read_b64_tr_b16 a[228:229], v9 offset:57344
 ds_read_b64_tr_b16 a[230:231], v9 offset:58368
 s_waitcnt vmcnt(8) lgkmcnt(0)
 s_barrier
 s_add_u32 m0, s49, 122880
 s_add_u32 s45, s32, 1835008
 buffer_load_dwordx4 v11, s[12:15], s45 offen  lds
 s_add_u32 m0, s49, 126976
 s_add_u32 s45, s32, 1966080
 buffer_load_dwordx4 v11, s[12:15], s45 offen  lds
 s_add_u32 m0, s49, 131072
 s_add_u32 s45, s33, 1835008
 buffer_load_dwordx4 v11, s[16:19], s45 offen  lds
 s_add_u32 m0, s49, 135168
 s_add_u32 s45, s33, 1966080
 buffer_load_dwordx4 v11, s[16:19], s45 offen  lds
 ds_read_b64_tr_b16 a[16:17], v8 offset:0
 ds_read_b64_tr_b16 a[18:19], v8 offset:1024
 ds_read_b64_tr_b16 a[88:89], v9 offset:0
 ds_read_b64_tr_b16 a[90:91], v9 offset:1024
 ds_read_b64_tr_b16 a[160:161], v8 offset:8192
 ds_read_b64_tr_b16 a[162:163], v8 offset:9216
 ds_read_b64_tr_b16 a[232:233], v9 offset:8192
 ds_read_b64_tr_b16 a[234:235], v9 offset:9216
 s_waitcnt vmcnt(8) lgkmcnt(0)
 s_barrier
 s_add_u32 m0, s49, 73728
 s_add_u32 s45, s32, 2097152
 buffer_load_dwordx4 v11, s[12:15], s45 offen  lds
 s_add_u32 m0, s49, 77824
 s_add_u32 s45, s32, 2228224
 buffer_load_dwordx4 v11, s[12:15], s45 offen  lds
 s_add_u32 m0, s49, 81920
 s_add_u32 s45, s33, 2097152
 buffer_load_dwordx4 v11, s[16:19], s45 offen  lds
 s_add_u32 m0, s49, 86016
 s_add_u32 s45, s33, 2228224
 buffer_load_dwordx4 v11, s[16:19], s45 offen  lds
 ds_read_b64_tr_b16 a[20:21], v8 offset:16384
 ds_read_b64_tr_b16 a[22:23], v8 offset:17408
 ds_read_b64_tr_b16 a[92:93], v9 offset:16384
 ds_read_b64_tr_b16 a[94:95], v9 offset:17408
 ds_read_b64_tr_b16 a[164:165], v8 offset:24576
 ds_read_b64_tr_b16 a[166:167], v8 offset:25600
 ds_read_b64_tr_b16 a[236:237], v9 offset:24576
 ds_read_b64_tr_b16 a[238:239], v9 offset:25600
 s_waitcnt vmcnt(8) lgkmcnt(0)
 s_barrier
 s_add_u32 m0, s49, 90112
 s_add_u32 s45, s32, 2359296
 buffer_load_dwordx4 v11, s[12:15], s45 offen  lds
 s_add_u32 m0, s49, 94208
 s_add_u32 s45, s32, 2490368
 buffer_load_dwordx4 v11, s[12:15], s45 offen  lds
 s_add_u32 m0, s49, 98304
 s_add_u32 s45, s33, 2359296
 buffer_load_dwordx4 v11, s[16:19], s45 offen  lds
 s_add_u32 m0, s49, 102400
 s_add_u32 s45, s33, 2490368
 buffer_load_dwordx4 v11, s[16:19], s45 offen  lds
 ds_read_b64_tr_b16 a[24:25], v8 offset:32768
 ds_read_b64_tr_b16 a[26:27], v8 offset:33792
 ds_read_b64_tr_b16 a[96:97], v9 offset:32768
 ds_read_b64_tr_b16 a[98:99], v9 offset:33792
 ds_read_b64_tr_b16 a[168:169], v8 offset:40960
 ds_read_b64_tr_b16 a[170:171], v8 offset:41984
 ds_read_b64_tr_b16 a[240:241], v9 offset:40960
 ds_read_b64_tr_b16 a[242:243], v9 offset:41984
 s_waitcnt vmcnt(8) lgkmcnt(0)
 s_barrier
 s_add_u32 m0, s49, 106496
 s_add_u32 s45, s32, 2621440
 buffer_load_dwordx4 v11, s[12:15], s45 offen  lds
 s_add_u32 m0, s49, 110592
 s_add_u32 s45, s32, 2752512
 buffer_load_dwordx4 v11, s[12:15], s45 offen  lds
 s_add_u32 m0, s49, 114688
 s_add_u32 s45, s33, 2621440
 buffer_load_dwordx4 v11, s[16:19], s45 offen  lds
 s_add_u32 m0, s49, 118784
 s_add_u32 s45, s33, 2752512
 buffer_load_dwordx4 v11, s[16:19], s45 offen  lds
 ds_read_b64_tr_b16 a[28:29], v8 offset:49152
 ds_read_b64_tr_b16 a[30:31], v8 offset:50176
 ds_read_b64_tr_b16 a[100:101], v9 offset:49152
 ds_read_b64_tr_b16 a[102:103], v9 offset:50176
 ds_read_b64_tr_b16 a[172:173], v8 offset:57344
 ds_read_b64_tr_b16 a[174:175], v8 offset:58368
 ds_read_b64_tr_b16 a[244:245], v9 offset:57344
 ds_read_b64_tr_b16 a[246:247], v9 offset:58368
 s_waitcnt vmcnt(8) lgkmcnt(0)
 s_barrier
 s_add_u32 m0, s49, 122880
 s_add_u32 s45, s32, 2883584
 buffer_load_dwordx4 v11, s[12:15], s45 offen  lds
 s_add_u32 m0, s49, 126976
 s_add_u32 s45, s32, 3014656
 buffer_load_dwordx4 v11, s[12:15], s45 offen  lds
 s_add_u32 m0, s49, 131072
 s_add_u32 s45, s33, 2883584
 buffer_load_dwordx4 v11, s[16:19], s45 offen  lds
 s_add_u32 m0, s49, 135168
 s_add_u32 s45, s33, 3014656
 buffer_load_dwordx4 v11, s[16:19], s45 offen  lds
 ds_read_b64_tr_b16 a[32:33], v8 offset:0
 ds_read_b64_tr_b16 a[34:35], v8 offset:1024
 ds_read_b64_tr_b16 a[104:105], v9 offset:0
 ds_read_b64_tr_b16 a[106:107], v9 offset:1024
 ds_read_b64_tr_b16 a[176:177], v8 offset:8192
 ds_read_b64_tr_b16 a[178:179], v8 offset:9216
 ds_read_b64_tr_b16 a[248:249], v9 offset:8192
 ds_read_b64_tr_b16 a[250:251], v9 offset:9216
 s_waitcnt vmcnt(8) lgkmcnt(0)
 s_barrier
 s_add_u32 m0, s49, 73728
 s_add_u32 s45, s32, 3145728
 buffer_load_dwordx4 v11, s[12:15], s45 offen  lds
 s_add_u32 m0, s49, 77824
 s_add_u32 s45, s32, 3276800
 buffer_load_dwordx4 v11, s[12:15], s45 offen  lds
 s_add_u32 m0, s49, 81920
 s_add_u32 s45, s33, 3145728
 buffer_load_dwordx4 v11, s[16:19], s45 offen  lds
 s_add_u32 m0, s49, 86016
 s_add_u32 s45, s33, 3276800
 buffer_load_dwordx4 v11, s[16:19], s45 offen  lds
 ds_read_b64_tr_b16 a[36:37], v8 offset:16384
 ds_read_b64_tr_b16 a[38:39], v8 offset:17408
 ds_read_b64_tr_b16 a[108:109], v9 offset:16384
 ds_read_b64_tr_b16 a[110:111], v9 offset:17408
 ds_read_b64_tr_b16 a[180:181], v8 offset:24576
 ds_read_b64_tr_b16 a[182:183], v8 offset:25600
 ds_read_b64_tr_b16 a[252:253], v9 offset:24576
 ds_read_b64_tr_b16 a[254:255], v9 offset:25600
 s_waitcnt vmcnt(8) lgkmcnt(0)
 s_barrier
 s_add_u32 m0, s49, 90112
 s_add_u32 s45, s32, 3407872
 buffer_load_dwordx4 v11, s[12:15], s45 offen  lds
 s_add_u32 m0, s49, 94208
 s_add_u32 s45, s32, 3538944
 buffer_load_dwordx4 v11, s[12:15], s45 offen  lds
 s_add_u32 m0, s49, 98304
 s_add_u32 s45, s33, 3407872
 buffer_load_dwordx4 v11, s[16:19], s45 offen  lds
 s_add_u32 m0, s49, 102400
 s_add_u32 s45, s33, 3538944
 buffer_load_dwordx4 v11, s[16:19], s45 offen  lds
 ds_read_b64_tr_b16 a[40:41], v8 offset:32768
 ds_read_b64_tr_b16 a[42:43], v8 offset:33792
 ds_read_b64_tr_b16 a[112:113], v9 offset:32768
 ds_read_b64_tr_b16 a[114:115], v9 offset:33792
 ds_read_b64_tr_b16 a[184:185], v8 offset:40960
 ds_read_b64_tr_b16 a[186:187], v8 offset:41984
 ds_read_b64_tr_b16 v[224:225], v9 offset:40960
 ds_read_b64_tr_b16 v[226:227], v9 offset:41984
 s_waitcnt vmcnt(8) lgkmcnt(0)
 s_barrier
 s_add_u32 m0, s49, 106496
 s_add_u32 s45, s32, 3670016
 buffer_load_dwordx4 v11, s[12:15], s45 offen  lds
 s_add_u32 m0, s49, 110592
 s_add_u32 s45, s32, 3801088
 buffer_load_dwordx4 v11, s[12:15], s45 offen  lds
 s_add_u32 m0, s49, 114688
 s_add_u32 s45, s33, 3670016
 buffer_load_dwordx4 v11, s[16:19], s45 offen  lds
 s_add_u32 m0, s49, 118784
 s_add_u32 s45, s33, 3801088
 buffer_load_dwordx4 v11, s[16:19], s45 offen  lds
 ds_read_b64_tr_b16 a[44:45], v8 offset:49152
 ds_read_b64_tr_b16 a[46:47], v8 offset:50176
 ds_read_b64_tr_b16 a[116:117], v9 offset:49152
 ds_read_b64_tr_b16 a[118:119], v9 offset:50176
 ds_read_b64_tr_b16 a[188:189], v8 offset:57344
 ds_read_b64_tr_b16 a[190:191], v8 offset:58368
 ds_read_b64_tr_b16 v[228:229], v9 offset:57344
 ds_read_b64_tr_b16 v[230:231], v9 offset:58368
 s_waitcnt vmcnt(8) lgkmcnt(0)
 s_barrier
 s_add_u32 m0, s49, 122880
 s_add_u32 s45, s32, 3932160
 buffer_load_dwordx4 v11, s[12:15], s45 offen  lds
 s_add_u32 m0, s49, 126976
 s_add_u32 s45, s32, 4063232
 buffer_load_dwordx4 v11, s[12:15], s45 offen  lds
 s_add_u32 m0, s49, 131072
 s_add_u32 s45, s33, 3932160
 buffer_load_dwordx4 v11, s[16:19], s45 offen  lds
 s_add_u32 m0, s49, 135168
 s_add_u32 s45, s33, 4063232
 buffer_load_dwordx4 v11, s[16:19], s45 offen  lds
 ds_read_b64_tr_b16 a[48:49], v8 offset:0
 ds_read_b64_tr_b16 a[50:51], v8 offset:1024
 ds_read_b64_tr_b16 a[120:121], v9 offset:0
 ds_read_b64_tr_b16 a[122:123], v9 offset:1024
 ds_read_b64_tr_b16 a[192:193], v8 offset:8192
 ds_read_b64_tr_b16 a[194:195], v8 offset:9216
 ds_read_b64_tr_b16 v[232:233], v9 offset:8192
 ds_read_b64_tr_b16 v[234:235], v9 offset:9216
 s_waitcnt vmcnt(8) lgkmcnt(0)
 s_barrier
 s_add_u32 m0, s49, 73728
 s_add_u32 s45, s32, 4194304
 buffer_load_dwordx4 v11, s[12:15], s45 offen  lds
 s_add_u32 m0, s49, 77824
 s_add_u32 s45, s32, 4325376
 buffer_load_dwordx4 v11, s[12:15], s45 offen  lds
 s_add_u32 m0, s49, 81920
 s_add_u32 s45, s33, 4194304
 buffer_load_dwordx4 v11, s[16:19], s45 offen  lds
 s_add_u32 m0, s49, 86016
 s_add_u32 s45, s33, 4325376
 buffer_load_dwordx4 v11, s[16:19], s45 offen  lds
 ds_read_b64_tr_b16 a[52:53], v8 offset:16384
 ds_read_b64_tr_b16 a[54:55], v8 offset:17408
 ds_read_b64_tr_b16 a[124:125], v9 offset:16384
 ds_read_b64_tr_b16 a[126:127], v9 offset:17408
 ds_read_b64_tr_b16 a[196:197], v8 offset:24576
 ds_read_b64_tr_b16 a[198:199], v8 offset:25600
 ds_read_b64_tr_b16 v[236:237], v9 offset:24576
 ds_read_b64_tr_b16 v[238:239], v9 offset:25600
 s_waitcnt vmcnt(8) lgkmcnt(0)
 s_barrier
 s_add_u32 m0, s49, 90112
 s_add_u32 s45, s32, 4456448
 buffer_load_dwordx4 v11, s[12:15], s45 offen  lds
 s_add_u32 m0, s49, 94208
 s_add_u32 s45, s32, 4587520
 buffer_load_dwordx4 v11, s[12:15], s45 offen  lds
 s_add_u32 m0, s49, 98304
 s_add_u32 s45, s33, 4456448
 buffer_load_dwordx4 v11, s[16:19], s45 offen  lds
 s_add_u32 m0, s49, 102400
 s_add_u32 s45, s33, 4587520
 buffer_load_dwordx4 v11, s[16:19], s45 offen  lds
 ds_read_b64_tr_b16 a[56:57], v8 offset:32768
 ds_read_b64_tr_b16 a[58:59], v8 offset:33792
 ds_read_b64_tr_b16 a[128:129], v9 offset:32768
 ds_read_b64_tr_b16 a[130:131], v9 offset:33792
 ds_read_b64_tr_b16 a[200:201], v8 offset:40960
 ds_read_b64_tr_b16 a[202:203], v8 offset:41984
 ds_read_b64_tr_b16 v[240:241], v9 offset:40960
 ds_read_b64_tr_b16 v[242:243], v9 offset:41984
 s_waitcnt vmcnt(8) lgkmcnt(0)
 s_barrier
 ds_read_b64_tr_b16 a[60:61], v8 offset:49152
 ds_read_b64_tr_b16 a[62:63], v8 offset:50176
 ds_read_b64_tr_b16 a[132:133], v9 offset:49152
 ds_read_b64_tr_b16 a[134:135], v9 offset:50176
 ds_read_b64_tr_b16 a[204:205], v8 offset:57344
 ds_read_b64_tr_b16 a[206:207], v8 offset:58368
 ds_read_b64_tr_b16 v[244:245], v9 offset:57344
 ds_read_b64_tr_b16 v[246:247], v9 offset:58368
 s_waitcnt vmcnt(4) lgkmcnt(0)
 s_barrier
 ds_read_b64_tr_b16 a[64:65], v8 offset:0
 ds_read_b64_tr_b16 a[66:67], v8 offset:1024
 ds_read_b64_tr_b16 a[136:137], v9 offset:0
 ds_read_b64_tr_b16 a[138:139], v9 offset:1024
 ds_read_b64_tr_b16 a[208:209], v8 offset:8192
 ds_read_b64_tr_b16 a[210:211], v8 offset:9216
 ds_read_b64_tr_b16 v[248:249], v9 offset:8192
 ds_read_b64_tr_b16 v[250:251], v9 offset:9216
 s_waitcnt vmcnt(0) lgkmcnt(0)
 s_barrier
 ds_read_b64_tr_b16 a[68:69], v8 offset:16384
 ds_read_b64_tr_b16 a[70:71], v8 offset:17408
 ds_read_b64_tr_b16 a[140:141], v9 offset:16384
 ds_read_b64_tr_b16 a[142:143], v9 offset:17408
 ds_read_b64_tr_b16 a[212:213], v8 offset:24576
 ds_read_b64_tr_b16 a[214:215], v8 offset:25600
 ds_read_b64_tr_b16 v[252:253], v9 offset:24576
 ds_read_b64_tr_b16 v[254:255], v9 offset:25600
 s_mov_b32 s50, 0x3e0293ee
 s_mov_b32 s42, 0
 s_mov_b32 s43, 0
 s_mov_b32 s44, 73728
 v_mov_b32 v6, v4
 v_mov_b32 v7, v5
Lrh_21:
 v_mbcnt_lo_u32_b32 v21, -1, 0
 v_min_u32 v21, 1, v21
 v_lshlrev_b32 v21, 28, v21
 buffer_load_dword v20, v21, s[28:31], 0 offen offset:4 sc1
 s_waitcnt vmcnt(0)
Lrhc_22:
 v_readfirstlane_b32 s89, v20
 s_cmp_eq_u32 s89, s88
 s_cbranch_scc1 Lrhk_23
 s_cmp_lg_u32 s89, 0
 s_cbranch_scc1 Lredo
 s_sub_u32 s95, s95, 1
 s_cbranch_scc0 Lrh_21
 s_endpgm
Lrhk_23:
 s_cmp_lg_u32 s4, 0
 s_cbranch_scc1 Lfrk_20
 v_min_u32 v21, 1, v0
 v_lshlrev_b32 v21, 28, v21
Lfr_19:
 buffer_load_dword v20, v21, s[28:31], 0 offen offset:0 sc1
 s_waitcnt vmcnt(0)
 v_cmp_eq_u32 vcc, 1, v20
 s_cbranch_vccnz Lfrk_20
 s_sub_u32 s95, s95, 1
 s_cbranch_scc0 Lfr_19
 s_endpgm
Lfrk_20:
 s_lshl_b32 s47, s2, 13
 s_add_u32 s47, s47, 0x8000000
 s_mov_b32 s48, s47
 v_mov_b32 v14, 0
 s_waitcnt vmcnt(0) lgkmcnt(0)
 s_barrier
 ds_read_b128 v[32:35], v6 offset:0
 ds_read_b128 v[36:39], v6 offset:2048
 ds_read_b128 v[40:43], v7 offset:0
 ds_read_b128 v[44:47], v7 offset:2048
 v_lshlrev_b32 v1, 12, v0
 s_lshl_b32 s45, s6, 7
 buffer_load_dword v15, v1, s[8:11], s45 offen
 v_add_u32 v1, 0x100000, v1
 buffer_load_dword v15, v1, s[8:11], s45 offen
 v_add_u32 v1, 0x100000, v1
 buffer_load_dword v15, v1, s[8:11], s45 offen
 v_add_u32 v1, 0x100000, v1
 s_waitcnt lgkmcnt(2)
Lps_loop_24:
 v_mfma_f32_16x16x32_bf16 v[64:67], a[0:3], v[32:35], 0
 ds_read_b128 v[48:51], v6 offset:4096
 v_mfma_f32_16x16x32_bf16 v[72:75], a[72:75], v[32:35], 0
 ds_read_b128 v[52:55], v6 offset:6144
 v_mfma_f32_16x16x32_bf16 v[80:83], v[32:35], a[144:147], 0
 s_add_u32 s41, s40, 1
 v_mfma_f32_16x16x32_bf16 v[88:91], v[32:35], a[216:219], 0
 s_add_u32 s45, s42, 2
 s_mul_i32 s46, s41, 36864
 v_mfma_f32_16x16x32_bf16 v[68:71], a[0:3], v[36:39], 0
 s_cmp_lt_u32 s45, s36
 s_cselect_b32 s46, s46, 0
 v_mfma_f32_16x16x32_bf16 v[76:79], a[72:75], v[36:39], 0
 s_lshl_b32 s49, s4, 10
 s_add_u32 s49, s49, s44
 v_mfma_f32_16x16x32_bf16 v[84:87], v[36:39], a[144:147], 0
 v_mul_f32 v96, s50, v96
 v_mul_f32 v97, s50, v97
 v_mfma_f32_16x16x32_bf16 v[92:95], v[36:39], a[216:219], 0
 s_waitcnt lgkmcnt(2)
 v_mfma_f32_16x16x32_bf16 v[64:67], a[4:7], v[40:43], v[64:67]
 ds_read_b128 v[56:59], v7 offset:4096
 v_mul_f32 v98, s50, v98
 v_mfma_f32_16x16x32_bf16 v[72:75], a[76:79], v[40:43], v[72:75]
 ds_read_b128 v[60:63], v7 offset:6144
 v_mul_f32 v99, s50, v99
 v_mfma_f32_16x16x32_bf16 v[80:83], v[40:43], a[148:151], v[80:83]
 v_mul_f32 v104, s50, v104
 v_mfma_f32_16x16x32_bf16 v[88:91], v[40:43], a[220:223], v[88:91]
 v_mul_f32 v105, s50, v105
 v_mfma_f32_16x16x32_bf16 v[68:71], a[4:7], v[44:47], v[68:71]
 v_mul_f32 v106, s50, v106
 v_mul_f32 v107, s50, v107
 v_mfma_f32_16x16x32_bf16 v[76:79], a[76:79], v[44:47], v[76:79]
 v_cvt_pk_bf16_f32 v16, v96, v104
 v_mfma_f32_16x16x32_bf16 v[84:87], v[44:47], a[148:151], v[84:87]
 v_cvt_pk_bf16_f32 v17, v97, v105
 v_mfma_f32_16x16x32_bf16 v[92:95], v[44:47], a[220:223], v[92:95]
 s_waitcnt lgkmcnt(2)
 v_cvt_pk_bf16_f32 v18, v98, v106
 v_mfma_f32_16x16x32_bf16 v[64:67], a[8:11], v[48:51], v[64:67]
 ds_read_b128 v[32:35], v6 offset:8192
 v_cvt_pk_bf16_f32 v19, v99, v107
 v_mfma_f32_16x16x32_bf16 v[72:75], a[80:83], v[48:51], v[72:75]
 ds_read_b128 v[36:39], v6 offset:10240
 v_mfma_f32_16x16x32_bf16 v[80:83], v[48:51], a[152:155], v[80:83]
 buffer_store_dwordx4 v[16:19], v12, s[20:23], s47 offen offset:0 sc1
 v_mul_f32 v100, s50, v100
 v_mfma_f32_16x16x32_bf16 v[88:91], v[48:51], a[224:227], v[88:91]
 v_mul_f32 v101, s50, v101
 v_mfma_f32_16x16x32_bf16 v[68:71], a[8:11], v[52:55], v[68:71]
 v_mul_f32 v102, s50, v102
 v_mfma_f32_16x16x32_bf16 v[76:79], a[80:83], v[52:55], v[76:79]
 v_mul_f32 v103, s50, v103
 v_mul_f32 v108, s50, v108
 v_mfma_f32_16x16x32_bf16 v[84:87], v[52:55], a[152:155], v[84:87]
 v_mul_f32 v109, s50, v109
 v_mfma_f32_16x16x32_bf16 v[92:95], v[52:55], a[224:227], v[92:95]
 s_waitcnt lgkmcnt(2)
 v_mfma_f32_16x16x32_bf16 v[64:67], a[12:15], v[56:59], v[64:67]
 ds_read_b128 v[40:43], v7 offset:8192
 v_mul_f32 v110, s50, v110
 v_mfma_f32_16x16x32_bf16 v[72:75], a[84:87], v[56:59], v[72:75]
 ds_read_b128 v[44:47], v7 offset:10240
 v_mul_f32 v111, s50, v111
 v_mfma_f32_16x16x32_bf16 v[80:83], v[56:59], a[156:159], v[80:83]
 v_cvt_pk_bf16_f32 v20, v100, v108
 v_mfma_f32_16x16x32_bf16 v[88:91], v[56:59], a[228:231], v[88:91]
 v_cvt_pk_bf16_f32 v21, v101, v109
 v_mfma_f32_16x16x32_bf16 v[68:71], a[12:15], v[60:63], v[68:71]
 v_cvt_pk_bf16_f32 v22, v102, v110
 v_cvt_pk_bf16_f32 v23, v103, v111
 v_mfma_f32_16x16x32_bf16 v[76:79], a[84:87], v[60:63], v[76:79]
 buffer_store_dwordx4 v[20:23], v12, s[20:23], s47 offen offset:1024 sc1
 v_mfma_f32_16x16x32_bf16 v[84:87], v[60:63], a[156:159], v[84:87]
 v_cvt_pk_bf16_f32 v24, v112, v113
 v_mfma_f32_16x16x32_bf16 v[92:95], v[60:63], a[228:231], v[92:95]
 s_waitcnt lgkmcnt(2)
 v_cvt_pk_bf16_f32 v25, v116, v117
 v_mfma_f32_16x16x32_bf16 v[64:67], a[16:19], v[32:35], v[64:67]
 ds_read_b128 v[48:51], v6 offset:12288
 v_cvt_pk_bf16_f32 v26, v114, v115
 v_mfma_f32_16x16x32_bf16 v[72:75], a[88:91], v[32:35], v[72:75]
 ds_read_b128 v[52:55], v6 offset:14336
 v_mfma_f32_16x16x32_bf16 v[80:83], v[32:35], a[160:163], v[80:83]
 v_cvt_pk_bf16_f32 v27, v118, v119
 buffer_store_dwordx4 v[24:27], v12, s[20:23], s48 offen offset:0 sc1
 v_mfma_f32_16x16x32_bf16 v[88:91], v[32:35], a[232:235], v[88:91]
 v_cvt_pk_bf16_f32 v28, v120, v121
 v_mfma_f32_16x16x32_bf16 v[68:71], a[16:19], v[36:39], v[68:71]
 v_cvt_pk_bf16_f32 v29, v124, v125
 v_mfma_f32_16x16x32_bf16 v[76:79], a[88:91], v[36:39], v[76:79]
 v_cvt_pk_bf16_f32 v30, v122, v123
 v_cvt_pk_bf16_f32 v31, v126, v127
 v_mfma_f32_16x16x32_bf16 v[84:87], v[36:39], a[160:163], v[84:87]
 buffer_store_dwordx4 v[28:31], v12, s[20:23], s48 offen offset:1024 sc1
 v_mfma_f32_16x16x32_bf16 v[92:95], v[36:39], a[232:235], v[92:95]
 s_waitcnt lgkmcnt(2)
 v_mfma_f32_16x16x32_bf16 v[64:67], a[20:23], v[40:43], v[64:67]
 ds_read_b128 v[56:59], v7 offset:12288
 v_mfma_f32_16x16x32_bf16 v[72:75], a[92:95], v[40:43], v[72:75]
 ds_read_b128 v[60:63], v7 offset:14336
 v_mfma_f32_16x16x32_bf16 v[80:83], v[40:43], a[164:167], v[80:83]
 s_add_u32 m0, s49, 0
 v_mfma_f32_16x16x32_bf16 v[88:91], v[40:43], a[236:239], v[88:91]
 buffer_load_dwordx4 v10, s[8:11], s46 offen offset:0  lds
 v_mfma_f32_16x16x32_bf16 v[68:71], a[20:23], v[44:47], v[68:71]
 s_add_u32 m0, s49, 3968
 v_mfma_f32_16x16x32_bf16 v[76:79], a[92:95], v[44:47], v[76:79]
 buffer_load_dwordx4 v10, s[8:11], s46 offen offset:128  lds
 v_mfma_f32_16x16x32_bf16 v[84:87], v[44:47], a[164:167], v[84:87]
 v_mfma_f32_16x16x32_bf16 v[92:95], v[44:47], a[236:239], v[92:95]
 s_waitcnt lgkmcnt(2)
 v_mfma_f32_16x16x32_bf16 v[64:67], a[24:27], v[48:51], v[64:67]
 ds_read_b128 v[32:35], v6 offset:16384
 v_mfma_f32_16x16x32_bf16 v[72:75], a[96:99], v[48:51], v[72:75]
 ds_read_b128 v[36:39], v6 offset:18432
 v_mfma_f32_16x16x32_bf16 v[80:83], v[48:51], a[168:171], v[80:83]
 s_add_u32 m0, s49, 7936
 v_mfma_f32_16x16x32_bf16 v[88:91], v[48:51], a[240:243], v[88:91]
 buffer_load_dwordx4 v10, s[8:11], s46 offen offset:256  lds
 v_mfma_f32_16x16x32_bf16 v[68:71], a[24:27], v[52:55], v[68:71]
 s_add_u32 m0, s49, 11904
 v_mfma_f32_16x16x32_bf16 v[76:79], a[96:99], v[52:55], v[76:79]
 buffer_load_dwordx4 v10, s[8:11], s46 offen offset:384  lds
 v_mfma_f32_16x16x32_bf16 v[84:87], v[52:55], a[168:171], v[84:87]
 v_mfma_f32_16x16x32_bf16 v[92:95], v[52:55], a[240:243], v[92:95]
 s_waitcnt lgkmcnt(2)
 v_mfma_f32_16x16x32_bf16 v[64:67], a[28:31], v[56:59], v[64:67]
 ds_read_b128 v[40:43], v7 offset:16384
 v_mfma_f32_16x16x32_bf16 v[72:75], a[100:103], v[56:59], v[72:75]
 ds_read_b128 v[44:47], v7 offset:18432
 v_mfma_f32_16x16x32_bf16 v[80:83], v[56:59], a[172:175], v[80:83]
 s_add_u32 m0, s49, 15872
 v_mfma_f32_16x16x32_bf16 v[88:91], v[56:59], a[244:247], v[88:91]
 buffer_load_dwordx4 v10, s[8:11], s46 offen offset:512  lds
 v_mfma_f32_16x16x32_bf16 v[68:71], a[28:31], v[60:63], v[68:71]
 s_add_u32 m0, s49, 19840
 v_mfma_f32_16x16x32_bf16 v[76:79], a[100:103], v[60:63], v[76:79]
 buffer_load_dwordx4 v10, s[8:11], s46 offen offset:640  lds
 v_mfma_f32_16x16x32_bf16 v[84:87], v[60:63], a[172:175], v[84:87]
 v_mfma_f32_16x16x32_bf16 v[92:95], v[60:63], a[244:247], v[92:95]
 s_waitcnt lgkmcnt(2)
 v_mfma_f32_16x16x32_bf16 v[64:67], a[32:35], v[32:35], v[64:67]
 ds_read_b128 v[48:51], v6 offset:20480
 v_mfma_f32_16x16x32_bf16 v[72:75], a[104:107], v[32:35], v[72:75]
 ds_read_b128 v[52:55], v6 offset:22528
 v_mfma_f32_16x16x32_bf16 v[80:83], v[32:35], a[176:179], v[80:83]
 s_add_u32 m0, s49, 23808
 v_mfma_f32_16x16x32_bf16 v[88:91], v[32:35], a[248:251], v[88:91]
 buffer_load_dwordx4 v10, s[8:11], s46 offen offset:768  lds
 v_mfma_f32_16x16x32_bf16 v[68:71], a[32:35], v[36:39], v[68:71]
 s_add_u32 m0, s49, 27776
 v_mfma_f32_16x16x32_bf16 v[76:79], a[104:107], v[36:39], v[76:79]
 buffer_load_dwordx4 v10, s[8:11], s46 offen offset:896  lds
 v_mfma_f32_16x16x32_bf16 v[84:87], v[36:39], a[176:179], v[84:87]
 v_mfma_f32_16x16x32_bf16 v[92:95], v[36:39], a[248:251], v[92:95]
 s_waitcnt lgkmcnt(2)
 v_mfma_f32_16x16x32_bf16 v[64:67], a[36:39], v[40:43], v[64:67]
 ds_read_b128 v[56:59], v7 offset:20480
 v_mfma_f32_16x16x32_bf16 v[72:75], a[108:111], v[40:43], v[72:75]
 ds_read_b128 v[60:63], v7 offset:22528
 v_mfma_f32_16x16x32_bf16 v[80:83], v[40:43], a[180:183], v[80:83]
 s_add_u32 m0, s49, 31744
 v_mfma_f32_16x16x32_bf16 v[88:91], v[40:43], a[252:255], v[88:91]
 buffer_load_dwordx4 v10, s[8:11], s46 offen offset:1024  lds
 v_mfma_f32_16x16x32_bf16 v[68:71], a[36:39], v[44:47], v[68:71]
 v_mfma_f32_16x16x32_bf16 v[76:79], a[108:111], v[44:47], v[76:79]
 v_mfma_f32_16x16x32_bf16 v[84:87], v[44:47], a[180:183], v[84:87]
 v_mfma_f32_16x16x32_bf16 v[92:95], v[44:47], a[252:255], v[92:95]
 s_waitcnt lgkmcnt(2)
 v_mfma_f32_16x16x32_bf16 v[64:67], a[40:43], v[48:51], v[64:67]
 ds_read_b128 v[32:35], v6 offset:24576
 v_mfma_f32_16x16x32_bf16 v[72:75], a[112:115], v[48:51], v[72:75]
 ds_read_b128 v[36:39], v6 offset:26624
 v_mfma_f32_16x16x32_bf16 v[80:83], v[48:51], a[184:187], v[80:83]
 v_mfma_f32_16x16x32_bf16 v[88:91], v[48:51], v[224:227], v[88:91]
 v_mfma_f32_16x16x32_bf16 v[68:71], a[40:43], v[52:55], v[68:71]
 v_mfma_f32_16x16x32_bf16 v[76:79], a[112:115], v[52:55], v[76:79]
 v_mfma_f32_16x16x32_bf16 v[84:87], v[52:55], a[184:187], v[84:87]
 v_mfma_f32_16x16x32_bf16 v[92:95], v[52:55], v[224:227], v[92:95]
 s_waitcnt lgkmcnt(2)
 v_mfma_f32_16x16x32_bf16 v[64:67], a[44:47], v[56:59], v[64:67]
 ds_read_b128 v[40:43], v7 offset:24576
 v_mfma_f32_16x16x32_bf16 v[72:75], a[116:119], v[56:59], v[72:75]
 ds_read_b128 v[44:47], v7 offset:26624
 v_mfma_f32_16x16x32_bf16 v[80:83], v[56:59], a[188:191], v[80:83]
 v_mfma_f32_16x16x32_bf16 v[88:91], v[56:59], v[228:231], v[88:91]
 v_mfma_f32_16x16x32_bf16 v[68:71], a[44:47], v[60:63], v[68:71]
 v_mfma_f32_16x16x32_bf16 v[76:79], a[116:119], v[60:63], v[76:79]
 v_mfma_f32_16x16x32_bf16 v[84:87], v[60:63], a[188:191], v[84:87]
 v_mfma_f32_16x16x32_bf16 v[92:95], v[60:63], v[228:231], v[92:95]
 s_waitcnt lgkmcnt(2)
 v_mfma_f32_16x16x32_bf16 v[64:67], a[48:51], v[32:35], v[64:67]
 ds_read_b128 v[48:51], v6 offset:28672
 v_mfma_f32_16x16x32_bf16 v[72:75], a[120:123], v[32:35], v[72:75]
 ds_read_b128 v[52:55], v6 offset:30720
 v_mfma_f32_16x16x32_bf16 v[80:83], v[32:35], a[192:195], v[80:83]
 v_mfma_f32_16x16x32_bf16 v[88:91], v[32:35], v[232:235], v[88:91]
 v_mfma_f32_16x16x32_bf16 v[68:71], a[48:51], v[36:39], v[68:71]
 v_mfma_f32_16x16x32_bf16 v[76:79], a[120:123], v[36:39], v[76:79]
 v_mfma_f32_16x16x32_bf16 v[84:87], v[36:39], a[192:195], v[84:87]
 v_mfma_f32_16x16x32_bf16 v[92:95], v[36:39], v[232:235], v[92:95]
 s_waitcnt lgkmcnt(2)
 v_mfma_f32_16x16x32_bf16 v[64:67], a[52:55], v[40:43], v[64:67]
 ds_read_b128 v[56:59], v7 offset:28672
 v_mfma_f32_16x16x32_bf16 v[72:75], a[124:127], v[40:43], v[72:75]
 ds_read_b128 v[60:63], v7 offset:30720
 v_mfma_f32_16x16x32_bf16 v[80:83], v[40:43], a[196:199], v[80:83]
 s_add_u32 s43, s43, 36864
 s_cmp_eq_u32 s43, 147456
 v_mfma_f32_16x16x32_bf16 v[88:91], v[40:43], v[236:239], v[88:91]
 s_cselect_b32 s43, 0, s43
 s_add_u32 s44, s44, 36864
 v_mfma_f32_16x16x32_bf16 v[68:71], a[52:55], v[44:47], v[68:71]
 s_cmp_eq_u32 s44, 147456
 s_cselect_b32 s44, 0, s44
 v_mfma_f32_16x16x32_bf16 v[76:79], a[124:127], v[44:47], v[76:79]
 v_mfma_f32_16x16x32_bf16 v[84:87], v[44:47], a[196:199], v[84:87]
 v_mfma_f32_16x16x32_bf16 v[92:95], v[44:47], v[236:239], v[92:95]
 s_waitcnt lgkmcnt(2)
 v_mfma_f32_16x16x32_bf16 v[64:67], a[56:59], v[48:51], v[64:67]
 ds_read_b128 v[32:35], v6 offset:32768
 v_mfma_f32_16x16x32_bf16 v[72:75], a[128:131], v[48:51], v[72:75]
 ds_read_b128 v[36:39], v6 offset:34816
 v_mfma_f32_16x16x32_bf16 v[80:83], v[48:51], a[200:203], v[80:83]
 v_add_u32 v6, s43, v4
 v_mfma_f32_16x16x32_bf16 v[88:91], v[48:51], v[240:243], v[88:91]
 v_mfma_f32_16x16x32_bf16 v[68:71], a[56:59], v[52:55], v[68:71]
 v_mfma_f32_16x16x32_bf16 v[76:79], a[128:131], v[52:55], v[76:79]
 v_mfma_f32_16x16x32_bf16 v[84:87], v[52:55], a[200:203], v[84:87]
 v_mfma_f32_16x16x32_bf16 v[92:95], v[52:55], v[240:243], v[92:95]
 s_waitcnt lgkmcnt(2)
 v_mfma_f32_16x16x32_bf16 v[64:67], a[60:63], v[56:59], v[64:67]
 ds_read_b128 v[40:43], v7 offset:32768
 v_mfma_f32_16x16x32_bf16 v[72:75], a[132:135], v[56:59], v[72:75]
 ds_read_b128 v[44:47], v7 offset:34816
 v_mfma_f32_16x16x32_bf16 v[80:83], v[56:59], a[204:207], v[80:83]
 v_add_u32 v7, s43, v5
 v_mfma_f32_16x16x32_bf16 v[88:91], v[56:59], v[244:247], v[88:91]
 v_mfma_f32_16x16x32_bf16 v[68:71], a[60:63], v[60:63], v[68:71]
 v_mfma_f32_16x16x32_bf16 v[76:79], a[132:135], v[60:63], v[76:79]
 v_mfma_f32_16x16x32_bf16 v[84:87], v[60:63], a[204:207], v[84:87]
 v_mfma_f32_16x16x32_bf16 v[92:95], v[60:63], v[244:247], v[92:95]
 s_waitcnt lgkmcnt(2)
 v_mfma_f32_16x16x32_bf16 v[64:67], a[64:67], v[32:35], v[64:67]
 s_waitcnt vmcnt(9)
 s_barrier
 ds_read_b128 v[48:51], v6 offset:0
 v_mfma_f32_16x16x32_bf16 v[72:75], a[136:139], v[32:35], v[72:75]
 ds_read_b128 v[52:55], v6 offset:2048
 v_mfma_f32_16x16x32_bf16 v[80:83], v[32:35], a[208:211], v[80:83]
 buffer_store_dword v14, v13, s[20:23], 0 offen sc1
 v_mfma_f32_16x16x32_bf16 v[88:91], v[32:35], v[248:251], v[88:91]
 v_mfma_f32_16x16x32_bf16 v[68:71], a[64:67], v[36:39], v[68:71]
 v_mfma_f32_16x16x32_bf16 v[76:79], a[136:139], v[36:39], v[76:79]
 v_mfma_f32_16x16x32_bf16 v[84:87], v[36:39], a[208:211], v[84:87]
 v_mfma_f32_16x16x32_bf16 v[92:95], v[36:39], v[248:251], v[92:95]
 s_waitcnt lgkmcnt(2)
 v_mfma_f32_16x16x32_bf16 v[64:67], a[68:71], v[40:43], v[64:67]
 ds_read_b128 v[56:59], v7 offset:0
 v_mfma_f32_16x16x32_bf16 v[72:75], a[140:143], v[40:43], v[72:75]
 ds_read_b128 v[60:63], v7 offset:2048
 v_mfma_f32_16x16x32_bf16 v[80:83], v[40:43], a[212:215], v[80:83]
 s_mul_i32 s45, s39, 524288
 s_add_u32 s47, s34, s45
 v_mfma_f32_16x16x32_bf16 v[88:91], v[40:43], v[252:255], v[88:91]
 s_add_u32 s48, s35, s45
 v_add_u32 v14, 1, v14
 v_mfma_f32_16x16x32_bf16 v[68:71], a[68:71], v[44:47], v[68:71]
 s_mov_b32 s39, s40
 s_mov_b32 s40, s41
 v_mfma_f32_16x16x32_bf16 v[76:79], a[140:143], v[44:47], v[76:79]
 s_add_u32 s42, s42, 1
 v_mfma_f32_16x16x32_bf16 v[84:87], v[44:47], a[212:215], v[84:87]
 v_mfma_f32_16x16x32_bf16 v[92:95], v[44:47], v[252:255], v[92:95]
 s_waitcnt lgkmcnt(2)
 v_mfma_f32_16x16x32_bf16 v[96:99], a[0:3], v[48:51], 0
 ds_read_b128 v[32:35], v6 offset:4096
 v_mfma_f32_16x16x32_bf16 v[104:107], a[72:75], v[48:51], 0
 ds_read_b128 v[36:39], v6 offset:6144
 v_mfma_f32_16x16x32_bf16 v[112:115], v[48:51], a[144:147], 0
 s_add_u32 s41, s40, 1
 v_mfma_f32_16x16x32_bf16 v[120:123], v[48:51], a[216:219], 0
 s_add_u32 s45, s42, 2
 s_mul_i32 s46, s41, 36864
 v_mfma_f32_16x16x32_bf16 v[100:103], a[0:3], v[52:55], 0
 s_cmp_lt_u32 s45, s36
 s_cselect_b32 s46, s46, 0
 v_mfma_f32_16x16x32_bf16 v[108:111], a[72:75], v[52:55], 0
 s_lshl_b32 s49, s4, 10
 s_add_u32 s49, s49, s44
 v_mfma_f32_16x16x32_bf16 v[116:119], v[52:55], a[144:147], 0
 v_mul_f32 v64, s50, v64
 v_mul_f32 v65, s50, v65
 v_mfma_f32_16x16x32_bf16 v[124:127], v[52:55], a[216:219], 0
 s_waitcnt lgkmcnt(2)
 v_mfma_f32_16x16x32_bf16 v[96:99], a[4:7], v[56:59], v[96:99]
 ds_read_b128 v[40:43], v7 offset:4096
 v_mul_f32 v66, s50, v66
 v_mfma_f32_16x16x32_bf16 v[104:107], a[76:79], v[56:59], v[104:107]
 ds_read_b128 v[44:47], v7 offset:6144
 v_mul_f32 v67, s50, v67
 v_mfma_f32_16x16x32_bf16 v[112:115], v[56:59], a[148:151], v[112:115]
 v_mul_f32 v72, s50, v72
 v_mfma_f32_16x16x32_bf16 v[120:123], v[56:59], a[220:223], v[120:123]
 v_mul_f32 v73, s50, v73
 v_mfma_f32_16x16x32_bf16 v[100:103], a[4:7], v[60:63], v[100:103]
 v_mul_f32 v74, s50, v74
 v_mul_f32 v75, s50, v75
 v_mfma_f32_16x16x32_bf16 v[108:111], a[76:79], v[60:63], v[108:111]
 v_cvt_pk_bf16_f32 v16, v64, v72
 v_mfma_f32_16x16x32_bf16 v[116:119], v[60:63], a[148:151], v[116:119]
 v_cvt_pk_bf16_f32 v17, v65, v73
 v_mfma_f32_16x16x32_bf16 v[124:127], v[60:63], a[220:223], v[124:127]
 s_waitcnt lgkmcnt(2)
 v_cvt_pk_bf16_f32 v18, v66, v74
 v_mfma_f32_16x16x32_bf16 v[96:99], a[8:11], v[32:35], v[96:99]
 ds_read_b128 v[48:51], v6 offset:8192
 v_cvt_pk_bf16_f32 v19, v67, v75
 v_mfma_f32_16x16x32_bf16 v[104:107], a[80:83], v[32:35], v[104:107]
 ds_read_b128 v[52:55], v6 offset:10240
 v_mfma_f32_16x16x32_bf16 v[112:115], v[32:35], a[152:155], v[112:115]
 buffer_store_dwordx4 v[16:19], v12, s[20:23], s47 offen offset:0 sc1
 v_mul_f32 v68, s50, v68
 v_mfma_f32_16x16x32_bf16 v[120:123], v[32:35], a[224:227], v[120:123]
 v_mul_f32 v69, s50, v69
 v_mfma_f32_16x16x32_bf16 v[100:103], a[8:11], v[36:39], v[100:103]
 v_mul_f32 v70, s50, v70
 v_mfma_f32_16x16x32_bf16 v[108:111], a[80:83], v[36:39], v[108:111]
 v_mul_f32 v71, s50, v71
 v_mul_f32 v76, s50, v76
 v_mfma_f32_16x16x32_bf16 v[116:119], v[36:39], a[152:155], v[116:119]
 v_mul_f32 v77, s50, v77
 v_mfma_f32_16x16x32_bf16 v[124:127], v[36:39], a[224:227], v[124:127]
 s_waitcnt lgkmcnt(2)
 v_mfma_f32_16x16x32_bf16 v[96:99], a[12:15], v[40:43], v[96:99]
 ds_read_b128 v[56:59], v7 offset:8192
 v_mul_f32 v78, s50, v78
 v_mfma_f32_16x16x32_bf16 v[104:107], a[84:87], v[40:43], v[104:107]
 ds_read_b128 v[60:63], v7 offset:10240
 v_mul_f32 v79, s50, v79
 v_mfma_f32_16x16x32_bf16 v[112:115], v[40:43], a[156:159], v[112:115]
 v_cvt_pk_bf16_f32 v20, v68, v76
 v_mfma_f32_16x16x32_bf16 v[120:123], v[40:43], a[228:231], v[120:123]
 v_cvt_pk_bf16_f32 v21, v69, v77
 v_mfma_f32_16x16x32_bf16 v[100:103], a[12:15], v[44:47], v[100:103]
 v_cvt_pk_bf16_f32 v22, v70, v78
 v_cvt_pk_bf16_f32 v23, v71, v79
 v_mfma_f32_16x16x32_bf16 v[108:111], a[84:87], v[44:47], v[108:111]
 buffer_store_dwordx4 v[20:23], v12, s[20:23], s47 offen offset:1024 sc1
 v_mfma_f32_16x16x32_bf16 v[116:119], v[44:47], a[156:159], v[116:119]
 v_cvt_pk_bf16_f32 v24, v80, v81
 v_mfma_f32_16x16x32_bf16 v[124:127], v[44:47], a[228:231], v[124:127]
 s_waitcnt lgkmcnt(2)
 v_cvt_pk_bf16_f32 v25, v84, v85
 v_mfma_f32_16x16x32_bf16 v[96:99], a[16:19], v[48:51], v[96:99]
 ds_read_b128 v[32:35], v6 offset:12288
 v_cvt_pk_bf16_f32 v26, v82, v83
 v_mfma_f32_16x16x32_bf16 v[104:107], a[88:91], v[48:51], v[104:107]
 ds_read_b128 v[36:39], v6 offset:14336
 v_mfma_f32_16x16x32_bf16 v[112:115], v[48:51], a[160:163], v[112:115]
 v_cvt_pk_bf16_f32 v27, v86, v87
 buffer_store_dwordx4 v[24:27], v12, s[20:23], s48 offen offset:0 sc1
 v_mfma_f32_16x16x32_bf16 v[120:123], v[48:51], a[232:235], v[120:123]
 v_cvt_pk_bf16_f32 v28, v88, v89
 v_mfma_f32_16x16x32_bf16 v[100:103], a[16:19], v[52:55], v[100:103]
 v_cvt_pk_bf16_f32 v29, v92, v93
 v_mfma_f32_16x16x32_bf16 v[108:111], a[88:91], v[52:55], v[108:111]
 v_cvt_pk_bf16_f32 v30, v90, v91
 v_cvt_pk_bf16_f32 v31, v94, v95
 v_mfma_f32_16x16x32_bf16 v[116:119], v[52:55], a[160:163], v[116:119]
 buffer_store_dwordx4 v[28:31], v12, s[20:23], s48 offen offset:1024 sc1
 v_mfma_f32_16x16x32_bf16 v[124:127], v[52:55], a[232:235], v[124:127]
 s_waitcnt lgkmcnt(2)
 v_mfma_f32_16x16x32_bf16 v[96:99], a[20:23], v[56:59], v[96:99]
 ds_read_b128 v[40:43], v7 offset:12288
 v_mfma_f32_16x16x32_bf16 v[104:107], a[92:95], v[56:59], v[104:107]
 ds_read_b128 v[44:47], v7 offset:14336
 v_mfma_f32_16x16x32_bf16 v[112:115], v[56:59], a[164:167], v[112:115]
 s_add_u32 m0, s49, 0
 v_mfma_f32_16x16x32_bf16 v[120:123], v[56:59], a[236:239], v[120:123]
 buffer_load_dwordx4 v10, s[8:11], s46 offen offset:0  lds
 v_mfma_f32_16x16x32_bf16 v[100:103], a[20:23], v[60:63], v[100:103]
 s_add_u32 m0, s49, 3968
 v_mfma_f32_16x16x32_bf16 v[108:111], a[92:95], v[60:63], v[108:111]
 buffer_load_dwordx4 v10, s[8:11], s46 offen offset:128  lds
 v_mfma_f32_16x16x32_bf16 v[116:119], v[60:63], a[164:167], v[116:119]
 v_mfma_f32_16x16x32_bf16 v[124:127], v[60:63], a[236:239], v[124:127]
 s_waitcnt lgkmcnt(2)
 v_mfma_f32_16x16x32_bf16 v[96:99], a[24:27], v[32:35], v[96:99]
 ds_read_b128 v[48:51], v6 offset:16384
 v_mfma_f32_16x16x32_bf16 v[104:107], a[96:99], v[32:35], v[104:107]
 ds_read_b128 v[52:55], v6 offset:18432
 v_mfma_f32_16x16x32_bf16 v[112:115], v[32:35], a[168:171], v[112:115]
 s_add_u32 m0, s49, 7936
 v_mfma_f32_16x16x32_bf16 v[120:123], v[32:35], a[240:243], v[120:123]
 buffer_load_dwordx4 v10, s[8:11], s46 offen offset:256  lds
 v_mfma_f32_16x16x32_bf16 v[100:103], a[24:27], v[36:39], v[100:103]
 s_add_u32 m0, s49, 11904
 v_mfma_f32_16x16x32_bf16 v[108:111], a[96:99], v[36:39], v[108:111]
 buffer_load_dwordx4 v10, s[8:11], s46 offen offset:384  lds
 v_mfma_f32_16x16x32_bf16 v[116:119], v[36:39], a[168:171], v[116:119]
 v_mfma_f32_16x16x32_bf16 v[124:127], v[36:39], a[240:243], v[124:127]
 s_waitcnt lgkmcnt(2)
 v_mfma_f32_16x16x32_bf16 v[96:99], a[28:31], v[40:43], v[96:99]
 ds_read_b128 v[56:59], v7 offset:16384
 v_mfma_f32_16x16x32_bf16 v[104:107], a[100:103], v[40:43], v[104:107]
 ds_read_b128 v[60:63], v7 offset:18432
 v_mfma_f32_16x16x32_bf16 v[112:115], v[40:43], a[172:175], v[112:115]
 s_add_u32 m0, s49, 15872
 v_mfma_f32_16x16x32_bf16 v[120:123], v[40:43], a[244:247], v[120:123]
 buffer_load_dwordx4 v10, s[8:11], s46 offen offset:512  lds
 v_mfma_f32_16x16x32_bf16 v[100:103], a[28:31], v[44:47], v[100:103]
 s_add_u32 m0, s49, 19840
 v_mfma_f32_16x16x32_bf16 v[108:111], a[100:103], v[44:47], v[108:111]
 buffer_load_dwordx4 v10, s[8:11], s46 offen offset:640  lds
 v_mfma_f32_16x16x32_bf16 v[116:119], v[44:47], a[172:175], v[116:119]
 v_mfma_f32_16x16x32_bf16 v[124:127], v[44:47], a[244:247], v[124:127]
 s_waitcnt lgkmcnt(2)
 v_mfma_f32_16x16x32_bf16 v[96:99], a[32:35], v[48:51], v[96:99]
 ds_read_b128 v[32:35], v6 offset:20480
 v_mfma_f32_16x16x32_bf16 v[104:107], a[104:107], v[48:51], v[104:107]
 ds_read_b128 v[36:39], v6 offset:22528
 v_mfma_f32_16x16x32_bf16 v[112:115], v[48:51], a[176:179], v[112:115]
 s_add_u32 m0, s49, 23808
 v_mfma_f32_16x16x32_bf16 v[120:123], v[48:51], a[248:251], v[120:123]
 buffer_load_dwordx4 v10, s[8:11], s46 offen offset:768  lds
 v_mfma_f32_16x16x32_bf16 v[100:103], a[32:35], v[52:55], v[100:103]
 s_add_u32 m0, s49, 27776
 v_mfma_f32_16x16x32_bf16 v[108:111], a[104:107], v[52:55], v[108:111]
 buffer_load_dwordx4 v10, s[8:11], s46 offen offset:896  lds
 v_mfma_f32_16x16x32_bf16 v[116:119], v[52:55], a[176:179], v[116:119]
 v_mfma_f32_16x16x32_bf16 v[124:127], v[52:55], a[248:251], v[124:127]
 s_waitcnt lgkmcnt(2)
 v_mfma_f32_16x16x32_bf16 v[96:99], a[36:39], v[56:59], v[96:99]
 ds_read_b128 v[40:43], v7 offset:20480
 v_mfma_f32_16x16x32_bf16 v[104:107], a[108:111], v[56:59], v[104:107]
 ds_read_b128 v[44:47], v7 offset:22528
 v_mfma_f32_16x16x32_bf16 v[112:115], v[56:59], a[180:183], v[112:115]
 s_add_u32 m0, s49, 31744
 v_mfma_f32_16x16x32_bf16 v[120:123], v[56:59], a[252:255], v[120:123]
 buffer_load_dwordx4 v10, s[8:11], s46 offen offset:1024  lds
 v_mfma_f32_16x16x32_bf16 v[100:103], a[36:39], v[60:63], v[100:103]
 v_mfma_f32_16x16x32_bf16 v[108:111], a[108:111], v[60:63], v[108:111]
 v_mfma_f32_16x16x32_bf16 v[116:119], v[60:63], a[180:183], v[116:119]
 v_mfma_f32_16x16x32_bf16 v[124:127], v[60:63], a[252:255], v[124:127]
 s_waitcnt lgkmcnt(2)
 v_mfma_f32_16x16x32_bf16 v[96:99], a[40:43], v[32:35], v[96:99]
 ds_read_b128 v[48:51], v6 offset:24576
 v_mfma_f32_16x16x32_bf16 v[104:107], a[112:115], v[32:35], v[104:107]
 ds_read_b128 v[52:55], v6 offset:26624
 v_mfma_f32_16x16x32_bf16 v[112:115], v[32:35], a[184:187], v[112:115]
 v_mfma_f32_16x16x32_bf16 v[120:123], v[32:35], v[224:227], v[120:123]
 v_mfma_f32_16x16x32_bf16 v[100:103], a[40:43], v[36:39], v[100:103]
 v_mfma_f32_16x16x32_bf16 v[108:111], a[112:115], v[36:39], v[108:111]
 v_mfma_f32_16x16x32_bf16 v[116:119], v[36:39], a[184:187], v[116:119]
 v_mfma_f32_16x16x32_bf16 v[124:127], v[36:39], v[224:227], v[124:127]
 s_waitcnt lgkmcnt(2)
 v_mfma_f32_16x16x32_bf16 v[96:99], a[44:47], v[40:43], v[96:99]
 ds_read_b128 v[56:59], v7 offset:24576
 v_mfma_f32_16x16x32_bf16 v[104:107], a[116:119], v[40:43], v[104:107]
 ds_read_b128 v[60:63], v7 offset:26624
 v_mfma_f32_16x16x32_bf16 v[112:115], v[40:43], a[188:191], v[112:115]
 v_mfma_f32_16x16x32_bf16 v[120:123], v[40:43], v[228:231], v[120:123]
 v_mfma_f32_16x16x32_bf16 v[100:103], a[44:47], v[44:47], v[100:103]
 v_mfma_f32_16x16x32_bf16 v[108:111], a[116:119], v[44:47], v[108:111]
 v_mfma_f32_16x16x32_bf16 v[116:119], v[44:47], a[188:191], v[116:119]
 v_mfma_f32_16x16x32_bf16 v[124:127], v[44:47], v[228:231], v[124:127]
 s_waitcnt lgkmcnt(2)
 v_mfma_f32_16x16x32_bf16 v[96:99], a[48:51], v[48:51], v[96:99]
 ds_read_b128 v[32:35], v6 offset:28672
 v_mfma_f32_16x16x32_bf16 v[104:107], a[120:123], v[48:51], v[104:107]
 ds_read_b128 v[36:39], v6 offset:30720
 v_mfma_f32_16x16x32_bf16 v[112:115], v[48:51], a[192:195], v[112:115]
 v_mfma_f32_16x16x32_bf16 v[120:123], v[48:51], v[232:235], v[120:123]
 v_mfma_f32_16x16x32_bf16 v[100:103], a[48:51], v[52:55], v[100:103]
 v_mfma_f32_16x16x32_bf16 v[108:111], a[120:123], v[52:55], v[108:111]
 v_mfma_f32_16x16x32_bf16 v[116:119], v[52:55], a[192:195], v[116:119]
 v_mfma_f32_16x16x32_bf16 v[124:127], v[52:55], v[232:235], v[124:127]
 s_waitcnt lgkmcnt(2)
 v_mfma_f32_16x16x32_bf16 v[96:99], a[52:55], v[56:59], v[96:99]
 ds_read_b128 v[40:43], v7 offset:28672
 v_mfma_f32_16x16x32_bf16 v[104:107], a[124:127], v[56:59], v[104:107]
 ds_read_b128 v[44:47], v7 offset:30720
 v_mfma_f32_16x16x32_bf16 v[112:115], v[56:59], a[196:199], v[112:115]
 s_add_u32 s43, s43, 36864
 s_cmp_eq_u32 s43, 147456
 v_mfma_f32_16x16x32_bf16 v[120:123], v[56:59], v[236:239], v[120:123]
 s_cselect_b32 s43, 0, s43
 s_add_u32 s44, s44, 36864
 v_mfma_f32_16x16x32_bf16 v[100:103], a[52:55], v[60:63], v[100:103]
 s_cmp_eq_u32 s44, 147456
 s_cselect_b32 s44, 0, s44
 v_mfma_f32_16x16x32_bf16 v[108:111], a[124:127], v[60:63], v[108:111]
 v_mfma_f32_16x16x32_bf16 v[116:119], v[60:63], a[196:199], v[116:119]
 v_mfma_f32_16x16x32_bf16 v[124:127], v[60:63], v[236:239], v[124:127]
 s_waitcnt lgkmcnt(2)
 v_mfma_f32_16x16x32_bf16 v[96:99], a[56:59], v[32:35], v[96:99]
 ds_read_b128 v[48:51], v6 offset:32768
 v_mfma_f32_16x16x32_bf16 v[104:107], a[128:131], v[32:35], v[104:107]
 ds_read_b128 v[52:55], v6 offset:34816
 v_mfma_f32_16x16x32_bf16 v[112:115], v[32:35], a[200:203], v[112:115]
 v_add_u32 v6, s43, v4
 v_mfma_f32_16x16x32_bf16 v[120:123], v[32:35], v[240:243], v[120:123]
 v_mfma_f32_16x16x32_bf16 v[100:103], a[56:59], v[36:39], v[100:103]
 v_mfma_f32_16x16x32_bf16 v[108:111], a[128:131], v[36:39], v[108:111]
 v_mfma_f32_16x16x32_bf16 v[116:119], v[36:39], a[200:203], v[116:119]
 v_mfma_f32_16x16x32_bf16 v[124:127], v[36:39], v[240:243], v[124:127]
 s_waitcnt lgkmcnt(2)
 v_mfma_f32_16x16x32_bf16 v[96:99], a[60:63], v[40:43], v[96:99]
 ds_read_b128 v[56:59], v7 offset:32768
 v_mfma_f32_16x16x32_bf16 v[104:107], a[132:135], v[40:43], v[104:107]
 ds_read_b128 v[60:63], v7 offset:34816
 v_mfma_f32_16x16x32_bf16 v[112:115], v[40:43], a[204:207], v[112:115]
 v_add_u32 v7, s43, v5
 v_mfma_f32_16x16x32_bf16 v[120:123], v[40:43], v[244:247], v[120:123]
 v_mfma_f32_16x16x32_bf16 v[100:103], a[60:63], v[44:47], v[100:103]
 v_mfma_f32_16x16x32_bf16 v[108:111], a[132:135], v[44:47], v[108:111]
 v_mfma_f32_16x16x32_bf16 v[116:119], v[44:47], a[204:207], v[116:119]
 v_mfma_f32_16x16x32_bf16 v[124:127], v[44:47], v[244:247], v[124:127]
 s_waitcnt lgkmcnt(2)
 v_mfma_f32_16x16x32_bf16 v[96:99], a[64:67], v[48:51], v[96:99]
 s_waitcnt vmcnt(9)
 s_barrier
 ds_read_b128 v[32:35], v6 offset:0
 v_mfma_f32_16x16x32_bf16 v[104:107], a[136:139], v[48:51], v[104:107]
 ds_read_b128 v[36:39], v6 offset:2048
 v_mfma_f32_16x16x32_bf16 v[112:115], v[48:51], a[208:211], v[112:115]
 buffer_store_dword v14, v13, s[20:23], 0 offen sc1
 v_mfma_f32_16x16x32_bf16 v[120:123], v[48:51], v[248:251], v[120:123]
 v_mfma_f32_16x16x32_bf16 v[100:103], a[64:67], v[52:55], v[100:103]
 v_mfma_f32_16x16x32_bf16 v[108:111], a[136:139], v[52:55], v[108:111]
 v_mfma_f32_16x16x32_bf16 v[116:119], v[52:55], a[208:211], v[116:119]
 v_mfma_f32_16x16x32_bf16 v[124:127], v[52:55], v[248:251], v[124:127]
 s_waitcnt lgkmcnt(2)
 v_mfma_f32_16x16x32_bf16 v[96:99], a[68:71], v[56:59], v[96:99]
 ds_read_b128 v[40:43], v7 offset:0
 v_mfma_f32_16x16x32_bf16 v[104:107], a[140:143], v[56:59], v[104:107]
 ds_read_b128 v[44:47], v7 offset:2048
 v_mfma_f32_16x16x32_bf16 v[112:115], v[56:59], a[212:215], v[112:115]
 s_mul_i32 s45, s39, 524288
 s_add_u32 s47, s34, s45
 v_mfma_f32_16x16x32_bf16 v[120:123], v[56:59], v[252:255], v[120:123]
 s_add_u32 s48, s35, s45
 v_add_u32 v14, 1, v14
 v_mfma_f32_16x16x32_bf16 v[100:103], a[68:71], v[60:63], v[100:103]
 s_mov_b32 s39, s40
 s_mov_b32 s40, s41
 v_mfma_f32_16x16x32_bf16 v[108:111], a[140:143], v[60:63], v[108:111]
 s_add_u32 s42, s42, 1
 s_cmp_lt_u32 s42, s36
 v_mfma_f32_16x16x32_bf16 v[116:119], v[60:63], a[212:215], v[116:119]
 v_mfma_f32_16x16x32_bf16 v[124:127], v[60:63], v[252:255], v[124:127]
 s_waitcnt lgkmcnt(2)
 s_cbranch_scc1 Lps_loop_24
 s_nop 7
 v_mul_f32 v96, s50, v96
 v_mul_f32 v97, s50, v97
 v_mul_f32 v98, s50, v98
 v_mul_f32 v99, s50, v99
 v_mul_f32 v104, s50, v104
 v_mul_f32 v105, s50, v105
 v_mul_f32 v106, s50, v106
 v_mul_f32 v107, s50, v107
 v_cvt_pk_bf16_f32 v16, v96, v104
 v_cvt_pk_bf16_f32 v17, v97, v105
 v_cvt_pk_bf16_f32 v18, v98, v106
 v_cvt_pk_bf16_f32 v19, v99, v107
 buffer_store_dwordx4 v[16:19], v12, s[20:23], s47 offen offset:0 sc1
 v_mul_f32 v100, s50, v100
 v_mul_f32 v101, s50, v101
 v_mul_f32 v102, s50, v102
 v_mul_f32 v103, s50, v103
 v_mul_f32 v108, s50, v108
 v_mul_f32 v109, s50, v109
 v_mul_f32 v110, s50, v110
 v_mul_f32 v111, s50, v111
 v_cvt_pk_bf16_f32 v20, v100, v108
 v_cvt_pk_bf16_f32 v21, v101, v109
 v_cvt_pk_bf16_f32 v22, v102, v110
 v_cvt_pk_bf16_f32 v23, v103, v111
 buffer_store_dwordx4 v[20:23], v12, s[20:23], s47 offen offset:1024 sc1
 v_cvt_pk_bf16_f32 v24, v112, v113
 v_cvt_pk_bf16_f32 v25, v116, v117
 v_cvt_pk_bf16_f32 v26, v114, v115
 v_cvt_pk_bf16_f32 v27, v118, v119
 buffer_store_dwordx4 v[24:27], v12, s[20:23], s48 offen offset:0 sc1
 v_cvt_pk_bf16_f32 v28, v120, v121
 v_cvt_pk_bf16_f32 v29, v124, v125
 v_cvt_pk_bf16_f32 v30, v122, v123
 v_cvt_pk_bf16_f32 v31, v126, v127
 buffer_store_dwordx4 v[28:31], v12, s[20:23], s48 offen offset:1024 sc1
 s_waitcnt vmcnt(0) lgkmcnt(0)
 s_barrier
 v_mov_b32 v14, s36
 buffer_store_dword v14, v13, s[20:23], 0 offen sc1
 s_branch Lfin
Lqa:
 s_load_dwordx2 s[8:9], s[0:1], 0
 s_mov_b32 s10, 0x240000
 s_mov_b32 s11, 0x20000
 s_load_dwordx2 s[12:13], s[0:1], 16
 s_mov_b32 s14, 0x480000
 s_mov_b32 s15, 0x20000
 s_load_dwordx2 s[16:17], s[0:1], 16
 s_mov_b32 s18, 0x480000
 s_mov_b32 s19, 0x20000
 s_lshl_b32 s7, s5, 5
 s_add_u32 s7, s7, s6
 s_cmp_eq_u32 s7, 127
 s_cbranch_scc0 Lqa1
Lrh_25:
 v_mbcnt_lo_u32_b32 v5, -1, 0
 v_min_u32 v5, 1, v5
 v_lshlrev_b32 v5, 28, v5
 buffer_load_dword v4, v5, s[28:31], 0 offen offset:4 sc1
 s_waitcnt vmcnt(0)
Lrhc_26:
 v_readfirstlane_b32 s89, v4
 s_cmp_eq_u32 s89, s88
 s_cbranch_scc1 Lrhk_27
 s_cmp_lg_u32 s89, 0
 s_cbranch_scc1 Lredo
 s_sub_u32 s95, s95, 1
 s_cbranch_scc0 Lrh_25
 s_endpgm
Lrhk_27:
 v_mov_b32 v4, 0
 v_mov_b32 v5, 0
 v_mov_b32 v6, 0
 v_mov_b32 v7, 0
 v_lshlrev_b32 v1, 4, v0
 s_mov_b32 s7, 0
 buffer_store_dwordx4 v[4:7], v1, s[20:23], s7 offen sc1
 s_mov_b32 s7, 4096
 buffer_store_dwordx4 v[4:7], v1, s[20:23], s7 offen sc1
 s_mov_b32 s7, 8192
 buffer_store_dwordx4 v[4:7], v1, s[20:23], s7 offen sc1
 s_mov_b32 s7, 12288
 buffer_store_dwordx4 v[4:7], v1, s[20:23], s7 offen sc1
 s_mov_b32 s7, 16384
 buffer_store_dwordx4 v[4:7], v1, s[20:23], s7 offen sc1
 v_min_u32 v1, 1, v0
 v_lshlrev_b32 v1, 28, v1
 v_mov_b32 v2, 1
 s_waitcnt vmcnt(0)
 s_barrier
 buffer_store_dword v2, v1, s[28:31], 0 offen sc1
Lqa1:
 s_sub_u32 s3, s5, 2
 s_lshl_b32 s3, s3, 3
 s_lshr_b32 s7, s6, 2
 s_add_u32 s3, s3, s7
 s_lshl_b32 s32, s3, 9
 s_add_u32 s33, s32, 256
 s_lshl_b32 s34, s3, 14
 s_add_u32 s34, s34, 0x5000000
 s_add_u32 s35, s34, 8192
 s_mov_b32 s36, 16
 s_and_b32 s37, s6, 3
 s_lshl_b32 s7, s3, 5
 s_add_u32 s7, s7, s37
 s_lshl_b32 s7, s7, 2
 s_add_u32 s7, s7, 0x3000
 v_min_u32 v1, 1, v0
 v_lshlrev_b32 v1, 28, v1
 v_add_u32 v13, s7, v1
 s_waitcnt lgkmcnt(0)
 v_and_b32 v1, 63, v0
 v_lshrrev_b32 v2, 3, v0
 v_mul_u32_u24 v10, 1152, v2
 v_lshrrev_b32 v2, 4, v0
 v_xor_b32 v2, v2, v0
 v_and_b32 v2, 7, v2
 v_lshl_add_u32 v10, v2, 4, v10
 v_lshrrev_b32 v2, 4, v1
 v_bfe_u32 v3, v1, 1, 3
 v_xor_b32 v2, v2, v3
 v_and_b32 v3, 15, v1
 v_lshlrev_b32 v3, 7, v3
 v_lshl_add_u32 v4, v2, 4, v3
 v_xor_b32 v5, 64, v4
 v_lshrrev_b32 v2, 4, v0
 v_lshlrev_b32 v11, 13, v2
 v_lshrrev_b32 v2, 7, v0
 v_lshrrev_b32 v3, 4, v1
 v_lshl_add_u32 v3, v2, 2, v3
 v_bfe_u32 v2, v1, 1, 3
 v_xor_b32 v2, v2, v3
 v_lshl_add_u32 v11, v2, 5, v11
 v_and_b32 v2, 1, v1
 v_lshl_add_u32 v11, v2, 4, v11
 v_bfe_u32 v2, v1, 2, 3
 v_xor_b32 v3, s4, v2
 v_lshlrev_b32 v3, 5, v3
 v_and_b32 v2, 3, v2
 v_lshl_add_u32 v3, v2, 8, v3
 v_lshrrev_b32 v2, 4, v1
 v_lshl_add_u32 v3, v2, 11, v3
 v_and_b32 v2, 3, v1
 v_lshl_add_u32 v3, v2, 3, v3
 v_add_u32 v8, 73728, v3
 v_xor_b32 v3, 0x80, v3
 v_add_u32 v9, 73728, v3
 s_lshl_b32 s45, s4, 11
 v_lshl_add_u32 v12, v1, 4, s45
 s_mov_b32 s39, s37
 s_add_u32 s40, s39, 4
 s_lshl_b32 s49, s4, 10
 s_mul_i32 s46, s39, 36864
 s_add_u32 m0, s49, 0
 s_nop 0
 buffer_load_dwordx4 v10, s[8:11], s46 offen offset:0  lds
 s_add_u32 m0, s49, 3968
 s_nop 0
 buffer_load_dwordx4 v10, s[8:11], s46 offen offset:128  lds
 s_add_u32 m0, s49, 7936
 s_nop 0
 buffer_load_dwordx4 v10, s[8:11], s46 offen offset:256  lds
 s_add_u32 m0, s49, 11904
 s_nop 0
 buffer_load_dwordx4 v10, s[8:11], s46 offen offset:384  lds
 s_add_u32 m0, s49, 15872
 s_nop 0
 buffer_load_dwordx4 v10, s[8:11], s46 offen offset:512  lds
 s_add_u32 m0, s49, 19840
 s_nop 0
 buffer_load_dwordx4 v10, s[8:11], s46 offen offset:640  lds
 s_add_u32 m0, s49, 23808
 s_nop 0
 buffer_load_dwordx4 v10, s[8:11], s46 offen offset:768  lds
 s_add_u32 m0, s49, 27776
 s_nop 0
 buffer_load_dwordx4 v10, s[8:11], s46 offen offset:896  lds
 s_add_u32 m0, s49, 31744
 s_nop 0
 buffer_load_dwordx4 v10, s[8:11], s46 offen offset:1024  lds
 s_lshl_b32 s49, s4, 10
 s_add_u32 s49, s49, 36864
 s_mul_i32 s46, s40, 36864
 s_add_u32 m0, s49, 0
 s_nop 0
 buffer_load_dwordx4 v10, s[8:11], s46 offen offset:0  lds
 s_add_u32 m0, s49, 3968
 s_nop 0
 buffer_load_dwordx4 v10, s[8:11], s46 offen offset:128  lds
 s_add_u32 m0, s49, 7936
 s_nop 0
 buffer_load_dwordx4 v10, s[8:11], s46 offen offset:256  lds
 s_add_u32 m0, s49, 11904
 s_nop 0
 buffer_load_dwordx4 v10, s[8:11], s46 offen offset:384  lds
 s_add_u32 m0, s49, 15872
 s_nop 0
 buffer_load_dwordx4 v10, s[8:11], s46 offen offset:512  lds
 s_add_u32 m0, s49, 19840
 s_nop 0
 buffer_load_dwordx4 v10, s[8:11], s46 offen offset:640  lds
 s_add_u32 m0, s49, 23808
 s_nop 0
 buffer_load_dwordx4 v10, s[8:11], s46 offen offset:768  lds
 s_add_u32 m0, s49, 27776
 s_nop 0
 buffer_load_dwordx4 v10, s[8:11], s46 offen offset:896  lds
 s_add_u32 m0, s49, 31744
 s_nop 0
 buffer_load_dwordx4 v10, s[8:11], s46 offen offset:1024  lds
 s_lshl_b32 s49, s4, 10
 s_add_u32 m0, s49, 73728
 s_add_u32 s45, s32, 0
 buffer_load_dwordx4 v11, s[12:15], s45 offen  lds
 s_add_u32 m0, s49, 77824
 s_add_u32 s45, s32, 131072
 buffer_load_dwordx4 v11, s[12:15], s45 offen  lds
 s_add_u32 m0, s49, 81920
 s_add_u32 s45, s33, 0
 buffer_load_dwordx4 v11, s[16:19], s45 offen  lds
 s_add_u32 m0, s49, 86016
 s_add_u32 s45, s33, 131072
 buffer_load_dwordx4 v11, s[16:19], s45 offen  lds
 s_add_u32 m0, s49, 90112
 s_add_u32 s45, s32, 262144
 buffer_load_dwordx4 v11, s[12:15], s45 offen  lds
 s_add_u32 m0, s49, 94208
 s_add_u32 s45, s32, 393216
 buffer_load_dwordx4 v11, s[12:15], s45 offen  lds
 s_add_u32 m0, s49, 98304
 s_add_u32 s45, s33, 262144
 buffer_load_dwordx4 v11, s[16:19], s45 offen  lds
 s_add_u32 m0, s49, 102400
 s_add_u32 s45, s33, 393216
 buffer_load_dwordx4 v11, s[16:19], s45 offen  lds
 s_add_u32 m0, s49, 106496
 s_add_u32 s45, s32, 524288
 buffer_load_dwordx4 v11, s[12:15], s45 offen  lds
 s_add_u32 m0, s49, 110592
 s_add_u32 s45, s32, 655360
 buffer_load_dwordx4 v11, s[12:15], s45 offen  lds
 s_add_u32 m0, s49, 114688
 s_add_u32 s45, s33, 524288
 buffer_load_dwordx4 v11, s[16:19], s45 offen  lds
 s_add_u32 m0, s49, 118784
 s_add_u32 s45, s33, 655360
 buffer_load_dwordx4 v11, s[16:19], s45 offen  lds
 s_waitcnt vmcnt(8) lgkmcnt(0)
 s_barrier
 s_add_u32 m0, s49, 122880
 s_add_u32 s45, s32, 786432
 buffer_load_dwordx4 v11, s[12:15], s45 offen  lds
 s_add_u32 m0, s49, 126976
 s_add_u32 s45, s32, 917504
 buffer_load_dwordx4 v11, s[12:15], s45 offen  lds
 s_add_u32 m0, s49, 131072
 s_add_u32 s45, s33, 786432
 buffer_load_dwordx4 v11, s[16:19], s45 offen  lds
 s_add_u32 m0, s49, 135168
 s_add_u32 s45, s33, 917504
 buffer_load_dwordx4 v11, s[16:19], s45 offen  lds
 ds_read_b64_tr_b16 a[0:1], v8 offset:0
 ds_read_b64_tr_b16 a[2:3], v8 offset:1024
 ds_read_b64_tr_b16 a[72:73], v9 offset:0
 ds_read_b64_tr_b16 a[74:75], v9 offset:1024
 ds_read_b64_tr_b16 a[144:145], v8 offset:8192
 ds_read_b64_tr_b16 a[146:147], v8 offset:9216
 ds_read_b64_tr_b16 a[216:217], v9 offset:8192
 ds_read_b64_tr_b16 a[218:219], v9 offset:9216
 s_waitcnt vmcnt(8) lgkmcnt(0)
 s_barrier
 s_add_u32 m0, s49, 73728
 s_add_u32 s45, s32, 1048576
 buffer_load_dwordx4 v11, s[12:15], s45 offen  lds
 s_add_u32 m0, s49, 77824
 s_add_u32 s45, s32, 1179648
 buffer_load_dwordx4 v11, s[12:15], s45 offen  lds
 s_add_u32 m0, s49, 81920
 s_add_u32 s45, s33, 1048576
 buffer_load_dwordx4 v11, s[16:19], s45 offen  lds
 s_add_u32 m0, s49, 86016
 s_add_u32 s45, s33, 1179648
 buffer_load_dwordx4 v11, s[16:19], s45 offen  lds
 ds_read_b64_tr_b16 a[4:5], v8 offset:16384
 ds_read_b64_tr_b16 a[6:7], v8 offset:17408
 ds_read_b64_tr_b16 a[76:77], v9 offset:16384
 ds_read_b64_tr_b16 a[78:79], v9 offset:17408
 ds_read_b64_tr_b16 a[148:149], v8 offset:24576
 ds_read_b64_tr_b16 a[150:151], v8 offset:25600
 ds_read_b64_tr_b16 a[220:221], v9 offset:24576
 ds_read_b64_tr_b16 a[222:223], v9 offset:25600
 s_waitcnt vmcnt(8) lgkmcnt(0)
 s_barrier
 s_add_u32 m0, s49, 90112
 s_add_u32 s45, s32, 1310720
 buffer_load_dwordx4 v11, s[12:15], s45 offen  lds
 s_add_u32 m0, s49, 94208
 s_add_u32 s45, s32, 1441792
 buffer_load_dwordx4 v11, s[12:15], s45 offen  lds
 s_add_u32 m0, s49, 98304
 s_add_u32 s45, s33, 1310720
 buffer_load_dwordx4 v11, s[16:19], s45 offen  lds
 s_add_u32 m0, s49, 102400
 s_add_u32 s45, s33, 1441792
 buffer_load_dwordx4 v11, s[16:19], s45 offen  lds
 ds_read_b64_tr_b16 a[8:9], v8 offset:32768
 ds_read_b64_tr_b16 a[10:11], v8 offset:33792
 ds_read_b64_tr_b16 a[80:81], v9 offset:32768
 ds_read_b64_tr_b16 a[82:83], v9 offset:33792
 ds_read_b64_tr_b16 a[152:153], v8 offset:40960
 ds_read_b64_tr_b16 a[154:155], v8 offset:41984
 ds_read_b64_tr_b16 a[224:225], v9 offset:40960
 ds_read_b64_tr_b16 a[226:227], v9 offset:41984
 s_waitcnt vmcnt(8) lgkmcnt(0)
 s_barrier
 s_add_u32 m0, s49, 106496
 s_add_u32 s45, s32, 1572864
 buffer_load_dwordx4 v11, s[12:15], s45 offen  lds
 s_add_u32 m0, s49, 110592
 s_add_u32 s45, s32, 1703936
 buffer_load_dwordx4 v11, s[12:15], s45 offen  lds
 s_add_u32 m0, s49, 114688
 s_add_u32 s45, s33, 1572864
 buffer_load_dwordx4 v11, s[16:19], s45 offen  lds
 s_add_u32 m0, s49, 118784
 s_add_u32 s45, s33, 1703936
 buffer_load_dwordx4 v11, s[16:19], s45 offen  lds
 ds_read_b64_tr_b16 a[12:13], v8 offset:49152
 ds_read_b64_tr_b16 a[14:15], v8 offset:50176
 ds_read_b64_tr_b16 a[84:85], v9 offset:49152
 ds_read_b64_tr_b16 a[86:87], v9 offset:50176
 ds_read_b64_tr_b16 a[156:157], v8 offset:57344
 ds_read_b64_tr_b16 a[158:159], v8 offset:58368
 ds_read_b64_tr_b16 a[228:229], v9 offset:57344
 ds_read_b64_tr_b16 a[230:231], v9 offset:58368
 s_waitcnt vmcnt(8) lgkmcnt(0)
 s_barrier
 s_add_u32 m0, s49, 122880
 s_add_u32 s45, s32, 1835008
 buffer_load_dwordx4 v11, s[12:15], s45 offen  lds
 s_add_u32 m0, s49, 126976
 s_add_u32 s45, s32, 1966080
 buffer_load_dwordx4 v11, s[12:15], s45 offen  lds
 s_add_u32 m0, s49, 131072
 s_add_u32 s45, s33, 1835008
 buffer_load_dwordx4 v11, s[16:19], s45 offen  lds
 s_add_u32 m0, s49, 135168
 s_add_u32 s45, s33, 1966080
 buffer_load_dwordx4 v11, s[16:19], s45 offen  lds
 ds_read_b64_tr_b16 a[16:17], v8 offset:0
 ds_read_b64_tr_b16 a[18:19], v8 offset:1024
 ds_read_b64_tr_b16 a[88:89], v9 offset:0
 ds_read_b64_tr_b16 a[90:91], v9 offset:1024
 ds_read_b64_tr_b16 a[160:161], v8 offset:8192
 ds_read_b64_tr_b16 a[162:163], v8 offset:9216
 ds_read_b64_tr_b16 a[232:233], v9 offset:8192
 ds_read_b64_tr_b16 a[234:235], v9 offset:9216
 s_waitcnt vmcnt(8) lgkmcnt(0)
 s_barrier
 s_add_u32 m0, s49, 73728
 s_add_u32 s45, s32, 2097152
 buffer_load_dwordx4 v11, s[12:15], s45 offen  lds
 s_add_u32 m0, s49, 77824
 s_add_u32 s45, s32, 2228224
 buffer_load_dwordx4 v11, s[12:15], s45 offen  lds
 s_add_u32 m0, s49, 81920
 s_add_u32 s45, s33, 2097152
 buffer_load_dwordx4 v11, s[16:19], s45 offen  lds
 s_add_u32 m0, s49, 86016
 s_add_u32 s45, s33, 2228224
 buffer_load_dwordx4 v11, s[16:19], s45 offen  lds
 ds_read_b64_tr_b16 a[20:21], v8 offset:16384
 ds_read_b64_tr_b16 a[22:23], v8 offset:17408
 ds_read_b64_tr_b16 a[92:93], v9 offset:16384
 ds_read_b64_tr_b16 a[94:95], v9 offset:17408
 ds_read_b64_tr_b16 a[164:165], v8 offset:24576
 ds_read_b64_tr_b16 a[166:167], v8 offset:25600
 ds_read_b64_tr_b16 a[236:237], v9 offset:24576
 ds_read_b64_tr_b16 a[238:239], v9 offset:25600
 s_waitcnt vmcnt(8) lgkmcnt(0)
 s_barrier
 s_add_u32 m0, s49, 90112
 s_add_u32 s45, s32, 2359296
 buffer_load_dwordx4 v11, s[12:15], s45 offen  lds
 s_add_u32 m0, s49, 94208
 s_add_u32 s45, s32, 2490368
 buffer_load_dwordx4 v11, s[12:15], s45 offen  lds
 s_add_u32 m0, s49, 98304
 s_add_u32 s45, s33, 2359296
 buffer_load_dwordx4 v11, s[16:19], s45 offen  lds
 s_add_u32 m0, s49, 102400
 s_add_u32 s45, s33, 2490368
 buffer_load_dwordx4 v11, s[16:19], s45 offen  lds
 ds_read_b64_tr_b16 a[24:25], v8 offset:32768
 ds_read_b64_tr_b16 a[26:27], v8 offset:33792
 ds_read_b64_tr_b16 a[96:97], v9 offset:32768
 ds_read_b64_tr_b16 a[98:99], v9 offset:33792
 ds_read_b64_tr_b16 a[168:169], v8 offset:40960
 ds_read_b64_tr_b16 a[170:171], v8 offset:41984
 ds_read_b64_tr_b16 a[240:241], v9 offset:40960
 ds_read_b64_tr_b16 a[242:243], v9 offset:41984
 s_waitcnt vmcnt(8) lgkmcnt(0)
 s_barrier
 s_add_u32 m0, s49, 106496
 s_add_u32 s45, s32, 2621440
 buffer_load_dwordx4 v11, s[12:15], s45 offen  lds
 s_add_u32 m0, s49, 110592
 s_add_u32 s45, s32, 2752512
 buffer_load_dwordx4 v11, s[12:15], s45 offen  lds
 s_add_u32 m0, s49, 114688
 s_add_u32 s45, s33, 2621440
 buffer_load_dwordx4 v11, s[16:19], s45 offen  lds
 s_add_u32 m0, s49, 118784
 s_add_u32 s45, s33, 2752512
 buffer_load_dwordx4 v11, s[16:19], s45 offen  lds
 ds_read_b64_tr_b16 a[28:29], v8 offset:49152
 ds_read_b64_tr_b16 a[30:31], v8 offset:50176
 ds_read_b64_tr_b16 a[100:101], v9 offset:49152
 ds_read_b64_tr_b16 a[102:103], v9 offset:50176
 ds_read_b64_tr_b16 a[172:173], v8 offset:57344
 ds_read_b64_tr_b16 a[174:175], v8 offset:58368
 ds_read_b64_tr_b16 a[244:245], v9 offset:57344
 ds_read_b64_tr_b16 a[246:247], v9 offset:58368
 s_waitcnt vmcnt(8) lgkmcnt(0)
 s_barrier
 s_add_u32 m0, s49, 122880
 s_add_u32 s45, s32, 2883584
 buffer_load_dwordx4 v11, s[12:15], s45 offen  lds
 s_add_u32 m0, s49, 126976
 s_add_u32 s45, s32, 3014656
 buffer_load_dwordx4 v11, s[12:15], s45 offen  lds
 s_add_u32 m0, s49, 131072
 s_add_u32 s45, s33, 2883584
 buffer_load_dwordx4 v11, s[16:19], s45 offen  lds
 s_add_u32 m0, s49, 135168
 s_add_u32 s45, s33, 3014656
 buffer_load_dwordx4 v11, s[16:19], s45 offen  lds
 ds_read_b64_tr_b16 a[32:33], v8 offset:0
 ds_read_b64_tr_b16 a[34:35], v8 offset:1024
 ds_read_b64_tr_b16 a[104:105], v9 offset:0
 ds_read_b64_tr_b16 a[106:107], v9 offset:1024
 ds_read_b64_tr_b16 a[176:177], v8 offset:8192
 ds_read_b64_tr_b16 a[178:179], v8 offset:9216
 ds_read_b64_tr_b16 a[248:249], v9 offset:8192
 ds_read_b64_tr_b16 a[250:251], v9 offset:9216
 s_waitcnt vmcnt(8) lgkmcnt(0)
 s_barrier
 s_add_u32 m0, s49, 73728
 s_add_u32 s45, s32, 3145728
 buffer_load_dwordx4 v11, s[12:15], s45 offen  lds
 s_add_u32 m0, s49, 77824
 s_add_u32 s45, s32, 3276800
 buffer_load_dwordx4 v11, s[12:15], s45 offen  lds
 s_add_u32 m0, s49, 81920
 s_add_u32 s45, s33, 3145728
 buffer_load_dwordx4 v11, s[16:19], s45 offen  lds
 s_add_u32 m0, s49, 86016
 s_add_u32 s45, s33, 3276800
 buffer_load_dwordx4 v11, s[16:19], s45 offen  lds
 ds_read_b64_tr_b16 a[36:37], v8 offset:16384
 ds_read_b64_tr_b16 a[38:39], v8 offset:17408
 ds_read_b64_tr_b16 a[108:109], v9 offset:16384
 ds_read_b64_tr_b16 a[110:111], v9 offset:17408
 ds_read_b64_tr_b16 a[180:181], v8 offset:24576
 ds_read_b64_tr_b16 a[182:183], v8 offset:25600
 ds_read_b64_tr_b16 a[252:253], v9 offset:24576
 ds_read_b64_tr_b16 a[254:255], v9 offset:25600
 s_waitcnt vmcnt(8) lgkmcnt(0)
 s_barrier
 s_add_u32 m0, s49, 90112
 s_add_u32 s45, s32, 3407872
 buffer_load_dwordx4 v11, s[12:15], s45 offen  lds
 s_add_u32 m0, s49, 94208
 s_add_u32 s45, s32, 3538944
 buffer_load_dwordx4 v11, s[12:15], s45 offen  lds
 s_add_u32 m0, s49, 98304
 s_add_u32 s45, s33, 3407872
 buffer_load_dwordx4 v11, s[16:19], s45 offen  lds
 s_add_u32 m0, s49, 102400
 s_add_u32 s45, s33, 3538944
 buffer_load_dwordx4 v11, s[16:19], s45 offen  lds
 ds_read_b64_tr_b16 a[40:41], v8 offset:32768
 ds_read_b64_tr_b16 a[42:43], v8 offset:33792
 ds_read_b64_tr_b16 a[112:113], v9 offset:32768
 ds_read_b64_tr_b16 a[114:115], v9 offset:33792
 ds_read_b64_tr_b16 a[184:185], v8 offset:40960
 ds_read_b64_tr_b16 a[186:187], v8 offset:41984
 ds_read_b64_tr_b16 v[224:225], v9 offset:40960
 ds_read_b64_tr_b16 v[226:227], v9 offset:41984
 s_waitcnt vmcnt(8) lgkmcnt(0)
 s_barrier
 s_add_u32 m0, s49, 106496
 s_add_u32 s45, s32, 3670016
 buffer_load_dwordx4 v11, s[12:15], s45 offen  lds
 s_add_u32 m0, s49, 110592
 s_add_u32 s45, s32, 3801088
 buffer_load_dwordx4 v11, s[12:15], s45 offen  lds
 s_add_u32 m0, s49, 114688
 s_add_u32 s45, s33, 3670016
 buffer_load_dwordx4 v11, s[16:19], s45 offen  lds
 s_add_u32 m0, s49, 118784
 s_add_u32 s45, s33, 3801088
 buffer_load_dwordx4 v11, s[16:19], s45 offen  lds
 ds_read_b64_tr_b16 a[44:45], v8 offset:49152
 ds_read_b64_tr_b16 a[46:47], v8 offset:50176
 ds_read_b64_tr_b16 a[116:117], v9 offset:49152
 ds_read_b64_tr_b16 a[118:119], v9 offset:50176
 ds_read_b64_tr_b16 a[188:189], v8 offset:57344
 ds_read_b64_tr_b16 a[190:191], v8 offset:58368
 ds_read_b64_tr_b16 v[228:229], v9 offset:57344
 ds_read_b64_tr_b16 v[230:231], v9 offset:58368
 s_waitcnt vmcnt(8) lgkmcnt(0)
 s_barrier
 s_add_u32 m0, s49, 122880
 s_add_u32 s45, s32, 3932160
 buffer_load_dwordx4 v11, s[12:15], s45 offen  lds
 s_add_u32 m0, s49, 126976
 s_add_u32 s45, s32, 4063232
 buffer_load_dwordx4 v11, s[12:15], s45 offen  lds
 s_add_u32 m0, s49, 131072
 s_add_u32 s45, s33, 3932160
 buffer_load_dwordx4 v11, s[16:19], s45 offen  lds
 s_add_u32 m0, s49, 135168
 s_add_u32 s45, s33, 4063232
 buffer_load_dwordx4 v11, s[16:19], s45 offen  lds
 ds_read_b64_tr_b16 a[48:49], v8 offset:0
 ds_read_b64_tr_b16 a[50:51], v8 offset:1024
 ds_read_b64_tr_b16 a[120:121], v9 offset:0
 ds_read_b64_tr_b16 a[122:123], v9 offset:1024
 ds_read_b64_tr_b16 a[192:193], v8 offset:8192
 ds_read_b64_tr_b16 a[194:195], v8 offset:9216
 ds_read_b64_tr_b16 v[232:233], v9 offset:8192
 ds_read_b64_tr_b16 v[234:235], v9 offset:9216
 s_waitcnt vmcnt(8) lgkmcnt(0)
 s_barrier
 s_add_u32 m0, s49, 73728
 s_add_u32 s45, s32, 4194304
 buffer_load_dwordx4 v11, s[12:15], s45 offen  lds
 s_add_u32 m0, s49, 77824
 s_add_u32 s45, s32, 4325376
 buffer_load_dwordx4 v11, s[12:15], s45 offen  lds
 s_add_u32 m0, s49, 81920
 s_add_u32 s45, s33, 4194304
 buffer_load_dwordx4 v11, s[16:19], s45 offen  lds
 s_add_u32 m0, s49, 86016
 s_add_u32 s45, s33, 4325376
 buffer_load_dwordx4 v11, s[16:19], s45 offen  lds
 ds_read_b64_tr_b16 a[52:53], v8 offset:16384
 ds_read_b64_tr_b16 a[54:55], v8 offset:17408
 ds_read_b64_tr_b16 a[124:125], v9 offset:16384
 ds_read_b64_tr_b16 a[126:127], v9 offset:17408
 ds_read_b64_tr_b16 a[196:197], v8 offset:24576
 ds_read_b64_tr_b16 a[198:199], v8 offset:25600
 ds_read_b64_tr_b16 v[236:237], v9 offset:24576
 ds_read_b64_tr_b16 v[238:239], v9 offset:25600
 s_waitcnt vmcnt(8) lgkmcnt(0)
 s_barrier
 s_add_u32 m0, s49, 90112
 s_add_u32 s45, s32, 4456448
 buffer_load_dwordx4 v11, s[12:15], s45 offen  lds
 s_add_u32 m0, s49, 94208
 s_add_u32 s45, s32, 4587520
 buffer_load_dwordx4 v11, s[12:15], s45 offen  lds
 s_add_u32 m0, s49, 98304
 s_add_u32 s45, s33, 4456448
 buffer_load_dwordx4 v11, s[16:19], s45 offen  lds
 s_add_u32 m0, s49, 102400
 s_add_u32 s45, s33, 4587520
 buffer_load_dwordx4 v11, s[16:19], s45 offen  lds
 ds_read_b64_tr_b16 a[56:57], v8 offset:32768
 ds_read_b64_tr_b16 a[58:59], v8 offset:33792
 ds_read_b64_tr_b16 a[128:129], v9 offset:32768
 ds_read_b64_tr_b16 a[130:131], v9 offset:33792
 ds_read_b64_tr_b16 a[200:201], v8 offset:40960
 ds_read_b64_tr_b16 a[202:203], v8 offset:41984
 ds_read_b64_tr_b16 v[240:241], v9 offset:40960
 ds_read_b64_tr_b16 v[242:243], v9 offset:41984
 s_waitcnt vmcnt(8) lgkmcnt(0)
 s_barrier
 ds_read_b64_tr_b16 a[60:61], v8 offset:49152
 ds_read_b64_tr_b16 a[62:63], v8 offset:50176
 ds_read_b64_tr_b16 a[132:133], v9 offset:49152
 ds_read_b64_tr_b16 a[134:135], v9 offset:50176
 ds_read_b64_tr_b16 a[204:205], v8 offset:57344
 ds_read_b64_tr_b16 a[206:207], v8 offset:58368
 ds_read_b64_tr_b16 v[244:245], v9 offset:57344
 ds_read_b64_tr_b16 v[246:247], v9 offset:58368
 s_waitcnt vmcnt(4) lgkmcnt(0)
 s_barrier
 ds_read_b64_tr_b16 a[64:65], v8 offset:0
 ds_read_b64_tr_b16 a[66:67], v8 offset:1024
 ds_read_b64_tr_b16 a[136:137], v9 offset:0
 ds_read_b64_tr_b16 a[138:139], v9 offset:1024
 ds_read_b64_tr_b16 a[208:209], v8 offset:8192
 ds_read_b64_tr_b16 a[210:211], v8 offset:9216
 ds_read_b64_tr_b16 v[248:249], v9 offset:8192
 ds_read_b64_tr_b16 v[250:251], v9 offset:9216
 s_waitcnt vmcnt(0) lgkmcnt(0)
 s_barrier
 ds_read_b64_tr_b16 a[68:69], v8 offset:16384
 ds_read_b64_tr_b16 a[70:71], v8 offset:17408
 ds_read_b64_tr_b16 a[140:141], v9 offset:16384
 ds_read_b64_tr_b16 a[142:143], v9 offset:17408
 ds_read_b64_tr_b16 a[212:213], v8 offset:24576
 ds_read_b64_tr_b16 a[214:215], v8 offset:25600
 ds_read_b64_tr_b16 v[252:253], v9 offset:24576
 ds_read_b64_tr_b16 v[254:255], v9 offset:25600
 s_mov_b32 s50, 0x3e0293ee
 s_mov_b32 s42, 0
 s_mov_b32 s43, 0
 s_mov_b32 s44, 73728
 v_mov_b32 v6, v4
 v_mov_b32 v7, v5
Lrh_30:
 v_mbcnt_lo_u32_b32 v21, -1, 0
 v_min_u32 v21, 1, v21
 v_lshlrev_b32 v21, 28, v21
 buffer_load_dword v20, v21, s[28:31], 0 offen offset:4 sc1
 s_waitcnt vmcnt(0)
Lrhc_31:
 v_readfirstlane_b32 s89, v20
 s_cmp_eq_u32 s89, s88
 s_cbranch_scc1 Lrhk_32
 s_cmp_lg_u32 s89, 0
 s_cbranch_scc1 Lredo
 s_sub_u32 s95, s95, 1
 s_cbranch_scc0 Lrh_30
 s_endpgm
Lrhk_32:
 s_cmp_lg_u32 s4, 0
 s_cbranch_scc1 Lfrk_29
 v_min_u32 v21, 1, v0
 v_lshlrev_b32 v21, 28, v21
Lfr_28:
 buffer_load_dword v20, v21, s[28:31], 0 offen offset:128 sc1
 s_waitcnt vmcnt(0)
 v_cmp_eq_u32 vcc, 1, v20
 s_cbranch_vccnz Lfrk_29
 s_sleep 12
 s_sub_u32 s95, s95, 1
 s_cbranch_scc0 Lfr_28
 s_endpgm
Lfrk_29:
 s_lshl_b32 s47, s2, 13
 s_add_u32 s47, s47, 0x8000000
 s_mov_b32 s48, s47
 v_mov_b32 v14, 0
 s_waitcnt vmcnt(0) lgkmcnt(0)
 s_barrier
 ds_read_b128 v[32:35], v6 offset:0
 ds_read_b128 v[36:39], v6 offset:2048
 ds_read_b128 v[40:43], v7 offset:0
 ds_read_b128 v[44:47], v7 offset:2048
 v_lshlrev_b32 v1, 12, v0
 s_lshl_b32 s45, s6, 7
 buffer_load_dword v15, v1, s[8:11], s45 offen
 v_add_u32 v1, 0x100000, v1
 buffer_load_dword v15, v1, s[8:11], s45 offen
 v_add_u32 v1, 0x100000, v1
 buffer_load_dword v15, v1, s[8:11], s45 offen
 v_add_u32 v1, 0x100000, v1
 s_waitcnt lgkmcnt(2)
Lps_loop_33:
 v_mfma_f32_16x16x32_bf16 v[64:67], a[0:3], v[32:35], 0
 ds_read_b128 v[48:51], v6 offset:4096
 v_mfma_f32_16x16x32_bf16 v[72:75], a[72:75], v[32:35], 0
 ds_read_b128 v[52:55], v6 offset:6144
 v_mfma_f32_16x16x32_bf16 v[80:83], a[144:147], v[32:35], 0
 s_add_u32 s41, s40, 4
 v_mfma_f32_16x16x32_bf16 v[88:91], a[216:219], v[32:35], 0
 s_add_u32 s45, s42, 2
 s_mul_i32 s46, s41, 36864
 v_mfma_f32_16x16x32_bf16 v[68:71], a[0:3], v[36:39], 0
 s_cmp_lt_u32 s45, s36
 s_cselect_b32 s46, s46, 0
 v_mfma_f32_16x16x32_bf16 v[76:79], a[72:75], v[36:39], 0
 s_lshl_b32 s49, s4, 10
 s_add_u32 s49, s49, s44
 v_mfma_f32_16x16x32_bf16 v[84:87], a[144:147], v[36:39], 0
 v_mfma_f32_16x16x32_bf16 v[92:95], a[216:219], v[36:39], 0
 s_waitcnt lgkmcnt(2)
 v_mfma_f32_16x16x32_bf16 v[64:67], a[4:7], v[40:43], v[64:67]
 ds_read_b128 v[56:59], v7 offset:4096
 v_mfma_f32_16x16x32_bf16 v[72:75], a[76:79], v[40:43], v[72:75]
 ds_read_b128 v[60:63], v7 offset:6144
 v_mfma_f32_16x16x32_bf16 v[80:83], a[148:151], v[40:43], v[80:83]
 s_add_u32 m0, s49, 0
 v_mfma_f32_16x16x32_bf16 v[88:91], a[220:223], v[40:43], v[88:91]
 buffer_load_dwordx4 v10, s[8:11], s46 offen offset:0  lds
 v_mfma_f32_16x16x32_bf16 v[68:71], a[4:7], v[44:47], v[68:71]
 s_add_u32 m0, s49, 3968
 v_mfma_f32_16x16x32_bf16 v[76:79], a[76:79], v[44:47], v[76:79]
 buffer_load_dwordx4 v10, s[8:11], s46 offen offset:128  lds
 v_mfma_f32_16x16x32_bf16 v[84:87], a[148:151], v[44:47], v[84:87]
 v_mfma_f32_16x16x32_bf16 v[92:95], a[220:223], v[44:47], v[92:95]
 s_waitcnt lgkmcnt(2)
 v_mfma_f32_16x16x32_bf16 v[64:67], a[8:11], v[48:51], v[64:67]
 ds_read_b128 v[32:35], v6 offset:8192
 v_mfma_f32_16x16x32_bf16 v[72:75], a[80:83], v[48:51], v[72:75]
 ds_read_b128 v[36:39], v6 offset:10240
 v_mfma_f32_16x16x32_bf16 v[80:83], a[152:155], v[48:51], v[80:83]
 s_add_u32 m0, s49, 7936
 v_mfma_f32_16x16x32_bf16 v[88:91], a[224:227], v[48:51], v[88:91]
 buffer_load_dwordx4 v10, s[8:11], s46 offen offset:256  lds
 v_mfma_f32_16x16x32_bf16 v[68:71], a[8:11], v[52:55], v[68:71]
 s_add_u32 m0, s49, 11904
 v_mfma_f32_16x16x32_bf16 v[76:79], a[80:83], v[52:55], v[76:79]
 buffer_load_dwordx4 v10, s[8:11], s46 offen offset:384  lds
 v_mfma_f32_16x16x32_bf16 v[84:87], a[152:155], v[52:55], v[84:87]
 v_mfma_f32_16x16x32_bf16 v[92:95], a[224:227], v[52:55], v[92:95]
 s_waitcnt lgkmcnt(2)
 v_mfma_f32_16x16x32_bf16 v[64:67], a[12:15], v[56:59], v[64:67]
 ds_read_b128 v[40:43], v7 offset:8192
 v_mfma_f32_16x16x32_bf16 v[72:75], a[84:87], v[56:59], v[72:75]
 ds_read_b128 v[44:47], v7 offset:10240
 v_mfma_f32_16x16x32_bf16 v[80:83], a[156:159], v[56:59], v[80:83]
 s_add_u32 m0, s49, 15872
 v_mfma_f32_16x16x32_bf16 v[88:91], a[228:231], v[56:59], v[88:91]
 buffer_load_dwordx4 v10, s[8:11], s46 offen offset:512  lds
 v_mfma_f32_16x16x32_bf16 v[68:71], a[12:15], v[60:63], v[68:71]
 s_add_u32 m0, s49, 19840
 v_mfma_f32_16x16x32_bf16 v[76:79], a[84:87], v[60:63], v[76:79]
 buffer_load_dwordx4 v10, s[8:11], s46 offen offset:640  lds
 v_mfma_f32_16x16x32_bf16 v[84:87], a[156:159], v[60:63], v[84:87]
 v_mfma_f32_16x16x32_bf16 v[92:95], a[228:231], v[60:63], v[92:95]
 s_waitcnt lgkmcnt(2)
 v_mfma_f32_16x16x32_bf16 v[64:67], a[16:19], v[32:35], v[64:67]
 ds_read_b128 v[48:51], v6 offset:12288
 v_mfma_f32_16x16x32_bf16 v[72:75], a[88:91], v[32:35], v[72:75]
 ds_read_b128 v[52:55], v6 offset:14336
 v_mfma_f32_16x16x32_bf16 v[80:83], a[160:163], v[32:35], v[80:83]
 s_add_u32 m0, s49, 23808
 v_mfma_f32_16x16x32_bf16 v[88:91], a[232:235], v[32:35], v[88:91]
 buffer_load_dwordx4 v10, s[8:11], s46 offen offset:768  lds
 v_mfma_f32_16x16x32_bf16 v[68:71], a[16:19], v[36:39], v[68:71]
 s_add_u32 m0, s49, 27776
 v_mfma_f32_16x16x32_bf16 v[76:79], a[88:91], v[36:39], v[76:79]
 buffer_load_dwordx4 v10, s[8:11], s46 offen offset:896  lds
 v_mfma_f32_16x16x32_bf16 v[84:87], a[160:163], v[36:39], v[84:87]
 v_mfma_f32_16x16x32_bf16 v[92:95], a[232:235], v[36:39], v[92:95]
 s_waitcnt lgkmcnt(2)
 v_mfma_f32_16x16x32_bf16 v[64:67], a[20:23], v[40:43], v[64:67]
 ds_read_b128 v[56:59], v7 offset:12288
 v_mfma_f32_16x16x32_bf16 v[72:75], a[92:95], v[40:43], v[72:75]
 ds_read_b128 v[60:63], v7 offset:14336
 v_mfma_f32_16x16x32_bf16 v[80:83], a[164:167], v[40:43], v[80:83]
 s_add_u32 m0, s49, 31744
 v_mfma_f32_16x16x32_bf16 v[88:91], a[236:239], v[40:43], v[88:91]
 buffer_load_dwordx4 v10, s[8:11], s46 offen offset:1024  lds
 v_mfma_f32_16x16x32_bf16 v[68:71], a[20:23], v[44:47], v[68:71]
 v_mfma_f32_16x16x32_bf16 v[76:79], a[92:95], v[44:47], v[76:79]
 v_mfma_f32_16x16x32_bf16 v[84:87], a[164:167], v[44:47], v[84:87]
 v_mfma_f32_16x16x32_bf16 v[92:95], a[236:239], v[44:47], v[92:95]
 s_waitcnt lgkmcnt(2)
 v_mfma_f32_16x16x32_bf16 v[64:67], a[24:27], v[48:51], v[64:67]
 ds_read_b128 v[32:35], v6 offset:16384
 v_mul_f32 v96, s50, v96
 v_mfma_f32_16x16x32_bf16 v[72:75], a[96:99], v[48:51], v[72:75]
 ds_read_b128 v[36:39], v6 offset:18432
 v_mfma_f32_16x16x32_bf16 v[80:83], a[168:171], v[48:51], v[80:83]
 v_mul_f32 v97, s50, v97
 v_mfma_f32_16x16x32_bf16 v[88:91], a[240:243], v[48:51], v[88:91]
 v_mul_f32 v98, s50, v98
 v_mfma_f32_16x16x32_bf16 v[68:71], a[24:27], v[52:55], v[68:71]
 v_mul_f32 v99, s50, v99
 v_mfma_f32_16x16x32_bf16 v[76:79], a[96:99], v[52:55], v[76:79]
 v_mul_f32 v104, s50, v104
 v_mfma_f32_16x16x32_bf16 v[84:87], a[168:171], v[52:55], v[84:87]
 v_mul_f32 v105, s50, v105
 v_mfma_f32_16x16x32_bf16 v[92:95], a[240:243], v[52:55], v[92:95]
 s_waitcnt lgkmcnt(2)
 v_mfma_f32_16x16x32_bf16 v[64:67], a[28:31], v[56:59], v[64:67]
 ds_read_b128 v[40:43], v7 offset:16384
 v_mfma_f32_16x16x32_bf16 v[72:75], a[100:103], v[56:59], v[72:75]
 ds_read_b128 v[44:47], v7 offset:18432
 v_mul_f32 v106, s50, v106
 v_mfma_f32_16x16x32_bf16 v[80:83], a[172:175], v[56:59], v[80:83]
 v_mul_f32 v107, s50, v107
 v_mfma_f32_16x16x32_bf16 v[88:91], a[244:247], v[56:59], v[88:91]
 v_cvt_pk_bf16_f32 v16, v96, v97
 v_mfma_f32_16x16x32_bf16 v[68:71], a[28:31], v[60:63], v[68:71]
 v_mfma_f32_16x16x32_bf16 v[76:79], a[100:103], v[60:63], v[76:79]
 v_cvt_pk_bf16_f32 v17, v104, v105
 v_mfma_f32_16x16x32_bf16 v[84:87], a[172:175], v[60:63], v[84:87]
 v_cvt_pk_bf16_f32 v18, v98, v99
 v_mfma_f32_16x16x32_bf16 v[92:95], a[244:247], v[60:63], v[92:95]
 s_waitcnt lgkmcnt(2)
 v_cvt_pk_bf16_f32 v19, v106, v107
 v_mfma_f32_16x16x32_bf16 v[64:67], a[32:35], v[32:35], v[64:67]
 ds_read_b128 v[48:51], v6 offset:20480
 v_mfma_f32_16x16x32_bf16 v[72:75], a[104:107], v[32:35], v[72:75]
 ds_read_b128 v[52:55], v6 offset:22528
 v_mfma_f32_16x16x32_bf16 v[80:83], a[176:179], v[32:35], v[80:83]
 buffer_store_dwordx4 v[16:19], v12, s[20:23], s47 offen offset:0 sc1
 v_mfma_f32_16x16x32_bf16 v[88:91], a[248:251], v[32:35], v[88:91]
 v_mul_f32 v100, s50, v100
 v_mfma_f32_16x16x32_bf16 v[68:71], a[32:35], v[36:39], v[68:71]
 v_mul_f32 v101, s50, v101
 v_mfma_f32_16x16x32_bf16 v[76:79], a[104:107], v[36:39], v[76:79]
 v_mul_f32 v102, s50, v102
 v_mfma_f32_16x16x32_bf16 v[84:87], a[176:179], v[36:39], v[84:87]
 v_mul_f32 v103, s50, v103
 v_mfma_f32_16x16x32_bf16 v[92:95], a[248:251], v[36:39], v[92:95]
 s_waitcnt lgkmcnt(2)
 v_mfma_f32_16x16x32_bf16 v[64:67], a[36:39], v[40:43], v[64:67]
 ds_read_b128 v[56:59], v7 offset:20480
 v_mul_f32 v108, s50, v108
 v_mfma_f32_16x16x32_bf16 v[72:75], a[108:111], v[40:43], v[72:75]
 ds_read_b128 v[60:63], v7 offset:22528
 v_mfma_f32_16x16x32_bf16 v[80:83], a[180:183], v[40:43], v[80:83]
 v_mul_f32 v109, s50, v109
 v_mfma_f32_16x16x32_bf16 v[88:91], a[252:255], v[40:43], v[88:91]
 v_mul_f32 v110, s50, v110
 v_mfma_f32_16x16x32_bf16 v[68:71], a[36:39], v[44:47], v[68:71]
 v_mul_f32 v111, s50, v111
 v_mfma_f32_16x16x32_bf16 v[76:79], a[108:111], v[44:47], v[76:79]
 v_mfma_f32_16x16x32_bf16 v[84:87], a[180:183], v[44:47], v[84:87]
 v_cvt_pk_bf16_f32 v20, v100, v101
 v_mfma_f32_16x16x32_bf16 v[92:95], a[252:255], v[44:47], v[92:95]
 s_waitcnt lgkmcnt(2)
 v_cvt_pk_bf16_f32 v21, v108, v109
 v_mfma_f32_16x16x32_bf16 v[64:67], a[40:43], v[48:51], v[64:67]
 ds_read_b128 v[32:35], v6 offset:24576
 v_mfma_f32_16x16x32_bf16 v[72:75], a[112:115], v[48:51], v[72:75]
 ds_read_b128 v[36:39], v6 offset:26624
 v_cvt_pk_bf16_f32 v22, v102, v103
 v_mfma_f32_16x16x32_bf16 v[80:83], a[184:187], v[48:51], v[80:83]
 v_mfma_f32_16x16x32_bf16 v[88:91], v[224:227], v[48:51], v[88:91]
 v_cvt_pk_bf16_f32 v23, v110, v111
 v_mfma_f32_16x16x32_bf16 v[68:71], a[40:43], v[52:55], v[68:71]
 buffer_store_dwordx4 v[20:23], v12, s[20:23], s47 offen offset:1024 sc1
 v_mfma_f32_16x16x32_bf16 v[76:79], a[112:115], v[52:55], v[76:79]
 v_mul_f32 v112, s50, v112
 v_mfma_f32_16x16x32_bf16 v[84:87], a[184:187], v[52:55], v[84:87]
 v_mul_f32 v113, s50, v113
 v_mfma_f32_16x16x32_bf16 v[92:95], v[224:227], v[52:55], v[92:95]
 s_waitcnt lgkmcnt(2)
 v_mfma_f32_16x16x32_bf16 v[64:67], a[44:47], v[56:59], v[64:67]
 ds_read_b128 v[40:43], v7 offset:24576
 v_mul_f32 v114, s50, v114
 v_mfma_f32_16x16x32_bf16 v[72:75], a[116:119], v[56:59], v[72:75]
 ds_read_b128 v[44:47], v7 offset:26624
 v_mfma_f32_16x16x32_bf16 v[80:83], a[188:191], v[56:59], v[80:83]
 v_mul_f32 v115, s50, v115
 v_mfma_f32_16x16x32_bf16 v[88:91], v[228:231], v[56:59], v[88:91]
 v_mul_f32 v120, s50, v120
 v_mfma_f32_16x16x32_bf16 v[68:71], a[44:47], v[60:63], v[68:71]
 v_mul_f32 v121, s50, v121
 v_mfma_f32_16x16x32_bf16 v[76:79], a[116:119], v[60:63], v[76:79]
 v_mfma_f32_16x16x32_bf16 v[84:87], a[188:191], v[60:63], v[84:87]
 v_mul_f32 v122, s50, v122
 v_mfma_f32_16x16x32_bf16 v[92:95], v[228:231], v[60:63], v[92:95]
 s_waitcnt lgkmcnt(2)
 v_mul_f32 v123, s50, v123
 v_mfma_f32_16x16x32_bf16 v[64:67], a[48:51], v[32:35], v[64:67]
 ds_read_b128 v[48:51], v6 offset:28672
 v_mfma_f32_16x16x32_bf16 v[72:75], a[120:123], v[32:35], v[72:75]
 ds_read_b128 v[52:55], v6 offset:30720
 v_cvt_pk_bf16_f32 v24, v112, v113
 v_mfma_f32_16x16x32_bf16 v[80:83], a[192:195], v[32:35], v[80:83]
 v_mfma_f32_16x16x32_bf16 v[88:91], v[232:235], v[32:35], v[88:91]
 v_cvt_pk_bf16_f32 v25, v120, v121
 v_mfma_f32_16x16x32_bf16 v[68:71], a[48:51], v[36:39], v[68:71]
 v_cvt_pk_bf16_f32 v26, v114, v115
 v_mfma_f32_16x16x32_bf16 v[76:79], a[120:123], v[36:39], v[76:79]
 v_cvt_pk_bf16_f32 v27, v122, v123
 v_mfma_f32_16x16x32_bf16 v[84:87], a[192:195], v[36:39], v[84:87]
 buffer_store_dwordx4 v[24:27], v12, s[20:23], s48 offen offset:0 sc1
 v_mfma_f32_16x16x32_bf16 v[92:95], v[232:235], v[36:39], v[92:95]
 s_waitcnt lgkmcnt(2)
 v_mfma_f32_16x16x32_bf16 v[64:67], a[52:55], v[40:43], v[64:67]
 ds_read_b128 v[56:59], v7 offset:28672
 v_mul_f32 v116, s50, v116
 v_mfma_f32_16x16x32_bf16 v[72:75], a[124:127], v[40:43], v[72:75]
 ds_read_b128 v[60:63], v7 offset:30720
 v_mfma_f32_16x16x32_bf16 v[80:83], a[196:199], v[40:43], v[80:83]
 s_add_u32 s43, s43, 36864
 s_cmp_eq_u32 s43, 147456
 v_mfma_f32_16x16x32_bf16 v[88:91], v[236:239], v[40:43], v[88:91]
 s_cselect_b32 s43, 0, s43
 s_add_u32 s44, s44, 36864
 v_mfma_f32_16x16x32_bf16 v[68:71], a[52:55], v[44:47], v[68:71]
 s_cmp_eq_u32 s44, 147456
 s_cselect_b32 s44, 0, s44
 v_mfma_f32_16x16x32_bf16 v[76:79], a[124:127], v[44:47], v[76:79]
 v_mul_f32 v117, s50, v117
 v_mfma_f32_16x16x32_bf16 v[84:87], a[196:199], v[44:47], v[84:87]
 v_mul_f32 v118, s50, v118
 v_mfma_f32_16x16x32_bf16 v[92:95], v[236:239], v[44:47], v[92:95]
 s_waitcnt lgkmcnt(2)
 v_mfma_f32_16x16x32_bf16 v[64:67], a[56:59], v[48:51], v[64:67]
 ds_read_b128 v[32:35], v6 offset:32768
 v_mul_f32 v119, s50, v119
 v_mfma_f32_16x16x32_bf16 v[72:75], a[128:131], v[48:51], v[72:75]
 ds_read_b128 v[36:39], v6 offset:34816
 v_mfma_f32_16x16x32_bf16 v[80:83], a[200:203], v[48:51], v[80:83]
 v_add_u32 v6, s43, v4
 v_mul_f32 v124, s50, v124
 v_mfma_f32_16x16x32_bf16 v[88:91], v[240:243], v[48:51], v[88:91]
 v_mfma_f32_16x16x32_bf16 v[68:71], a[56:59], v[52:55], v[68:71]
 v_mul_f32 v125, s50, v125
 v_mfma_f32_16x16x32_bf16 v[76:79], a[128:131], v[52:55], v[76:79]
 v_mul_f32 v126, s50, v126
 v_mfma_f32_16x16x32_bf16 v[84:87], a[200:203], v[52:55], v[84:87]
 v_mul_f32 v127, s50, v127
 v_mfma_f32_16x16x32_bf16 v[92:95], v[240:243], v[52:55], v[92:95]
 s_waitcnt lgkmcnt(2)
 v_mfma_f32_16x16x32_bf16 v[64:67], a[60:63], v[56:59], v[64:67]
 ds_read_b128 v[40:43], v7 offset:32768
 v_cvt_pk_bf16_f32 v28, v116, v117
 v_mfma_f32_16x16x32_bf16 v[72:75], a[132:135], v[56:59], v[72:75]
 ds_read_b128 v[44:47], v7 offset:34816
 v_mfma_f32_16x16x32_bf16 v[80:83], a[204:207], v[56:59], v[80:83]
 v_add_u32 v7, s43, v5
 v_cvt_pk_bf16_f32 v29, v124, v125
 v_mfma_f32_16x16x32_bf16 v[88:91], v[244:247], v[56:59], v[88:91]
 v_cvt_pk_bf16_f32 v30, v118, v119
 v_mfma_f32_16x16x32_bf16 v[68:71], a[60:63], v[60:63], v[68:71]
 v_mfma_f32_16x16x32_bf16 v[76:79], a[132:135], v[60:63], v[76:79]
 v_cvt_pk_bf16_f32 v31, v126, v127
 v_mfma_f32_16x16x32_bf16 v[84:87], a[204:207], v[60:63], v[84:87]
 buffer_store_dwordx4 v[28:31], v12, s[20:23], s48 offen offset:1024 sc1
 v_mfma_f32_16x16x32_bf16 v[92:95], v[244:247], v[60:63], v[92:95]
 s_waitcnt lgkmcnt(2)
 v_mfma_f32_16x16x32_bf16 v[64:67], a[64:67], v[32:35], v[64:67]
 s_waitcnt vmcnt(13)
 s_barrier
 ds_read_b128 v[48:51], v6 offset:0
 v_mfma_f32_16x16x32_bf16 v[72:75], a[136:139], v[32:35], v[72:75]
 ds_read_b128 v[52:55], v6 offset:2048
 v_mfma_f32_16x16x32_bf16 v[80:83], a[208:211], v[32:35], v[80:83]
 v_mfma_f32_16x16x32_bf16 v[88:91], v[248:251], v[32:35], v[88:91]
 v_mfma_f32_16x16x32_bf16 v[68:71], a[64:67], v[36:39], v[68:71]
 v_mfma_f32_16x16x32_bf16 v[76:79], a[136:139], v[36:39], v[76:79]
 v_mfma_f32_16x16x32_bf16 v[84:87], a[208:211], v[36:39], v[84:87]
 v_mfma_f32_16x16x32_bf16 v[92:95], v[248:251], v[36:39], v[92:95]
 s_waitcnt lgkmcnt(2)
 v_mfma_f32_16x16x32_bf16 v[64:67], a[68:71], v[40:43], v[64:67]
 ds_read_b128 v[56:59], v7 offset:0
 v_mfma_f32_16x16x32_bf16 v[72:75], a[140:143], v[40:43], v[72:75]
 ds_read_b128 v[60:63], v7 offset:2048
 v_mfma_f32_16x16x32_bf16 v[80:83], a[212:215], v[40:43], v[80:83]
 s_mul_i32 s45, s39, 262144
 s_add_u32 s47, s34, s45
 v_mfma_f32_16x16x32_bf16 v[88:91], v[252:255], v[40:43], v[88:91]
 s_add_u32 s48, s35, s45
 v_mov_b32 v14, s42
 v_mfma_f32_16x16x32_bf16 v[68:71], a[68:71], v[44:47], v[68:71]
 s_mov_b32 s39, s40
 s_mov_b32 s40, s41
 v_mfma_f32_16x16x32_bf16 v[76:79], a[140:143], v[44:47], v[76:79]
 s_add_u32 s42, s42, 1
 v_mfma_f32_16x16x32_bf16 v[84:87], a[212:215], v[44:47], v[84:87]
 v_mfma_f32_16x16x32_bf16 v[92:95], v[252:255], v[44:47], v[92:95]
 s_waitcnt lgkmcnt(2)
 v_mfma_f32_16x16x32_bf16 v[96:99], a[0:3], v[48:51], 0
 ds_read_b128 v[32:35], v6 offset:4096
 v_mfma_f32_16x16x32_bf16 v[104:107], a[72:75], v[48:51], 0
 ds_read_b128 v[36:39], v6 offset:6144
 v_mfma_f32_16x16x32_bf16 v[112:115], a[144:147], v[48:51], 0
 s_add_u32 s41, s40, 4
 v_mfma_f32_16x16x32_bf16 v[120:123], a[216:219], v[48:51], 0
 s_add_u32 s45, s42, 2
 s_mul_i32 s46, s41, 36864
 v_mfma_f32_16x16x32_bf16 v[100:103], a[0:3], v[52:55], 0
 s_cmp_lt_u32 s45, s36
 s_cselect_b32 s46, s46, 0
 v_mfma_f32_16x16x32_bf16 v[108:111], a[72:75], v[52:55], 0
 s_lshl_b32 s49, s4, 10
 s_add_u32 s49, s49, s44
 v_mfma_f32_16x16x32_bf16 v[116:119], a[144:147], v[52:55], 0
 v_mfma_f32_16x16x32_bf16 v[124:127], a[216:219], v[52:55], 0
 s_waitcnt lgkmcnt(2)
 v_mfma_f32_16x16x32_bf16 v[96:99], a[4:7], v[56:59], v[96:99]
 ds_read_b128 v[40:43], v7 offset:4096
 v_mfma_f32_16x16x32_bf16 v[104:107], a[76:79], v[56:59], v[104:107]
 ds_read_b128 v[44:47], v7 offset:6144
 v_mfma_f32_16x16x32_bf16 v[112:115], a[148:151], v[56:59], v[112:115]
 s_add_u32 m0, s49, 0
 v_mfma_f32_16x16x32_bf16 v[120:123], a[220:223], v[56:59], v[120:123]
 buffer_load_dwordx4 v10, s[8:11], s46 offen offset:0  lds
 v_mfma_f32_16x16x32_bf16 v[100:103], a[4:7], v[60:63], v[100:103]
 s_add_u32 m0, s49, 3968
 v_mfma_f32_16x16x32_bf16 v[108:111], a[76:79], v[60:63], v[108:111]
 buffer_load_dwordx4 v10, s[8:11], s46 offen offset:128  lds
 v_mfma_f32_16x16x32_bf16 v[116:119], a[148:151], v[60:63], v[116:119]
 v_mfma_f32_16x16x32_bf16 v[124:127], a[220:223], v[60:63], v[124:127]
 s_waitcnt lgkmcnt(2)
 v_mfma_f32_16x16x32_bf16 v[96:99], a[8:11], v[32:35], v[96:99]
 ds_read_b128 v[48:51], v6 offset:8192
 v_mfma_f32_16x16x32_bf16 v[104:107], a[80:83], v[32:35], v[104:107]
 ds_read_b128 v[52:55], v6 offset:10240
 v_mfma_f32_16x16x32_bf16 v[112:115], a[152:155], v[32:35], v[112:115]
 s_add_u32 m0, s49, 7936
 v_mfma_f32_16x16x32_bf16 v[120:123], a[224:227], v[32:35], v[120:123]
 buffer_load_dwordx4 v10, s[8:11], s46 offen offset:256  lds
 v_mfma_f32_16x16x32_bf16 v[100:103], a[8:11], v[36:39], v[100:103]
 s_add_u32 m0, s49, 11904
 v_mfma_f32_16x16x32_bf16 v[108:111], a[80:83], v[36:39], v[108:111]
 buffer_load_dwordx4 v10, s[8:11], s46 offen offset:384  lds
 v_mfma_f32_16x16x32_bf16 v[116:119], a[152:155], v[36:39], v[116:119]
 v_mfma_f32_16x16x32_bf16 v[124:127], a[224:227], v[36:39], v[124:127]
 s_waitcnt lgkmcnt(2)
 v_mfma_f32_16x16x32_bf16 v[96:99], a[12:15], v[40:43], v[96:99]
 ds_read_b128 v[56:59], v7 offset:8192
 v_mfma_f32_16x16x32_bf16 v[104:107], a[84:87], v[40:43], v[104:107]
 ds_read_b128 v[60:63], v7 offset:10240
 v_mfma_f32_16x16x32_bf16 v[112:115], a[156:159], v[40:43], v[112:115]
 s_add_u32 m0, s49, 15872
 v_mfma_f32_16x16x32_bf16 v[120:123], a[228:231], v[40:43], v[120:123]
 buffer_load_dwordx4 v10, s[8:11], s46 offen offset:512  lds
 v_mfma_f32_16x16x32_bf16 v[100:103], a[12:15], v[44:47], v[100:103]
 s_add_u32 m0, s49, 19840
 v_mfma_f32_16x16x32_bf16 v[108:111], a[84:87], v[44:47], v[108:111]
 buffer_load_dwordx4 v10, s[8:11], s46 offen offset:640  lds
 v_mfma_f32_16x16x32_bf16 v[116:119], a[156:159], v[44:47], v[116:119]
 v_mfma_f32_16x16x32_bf16 v[124:127], a[228:231], v[44:47], v[124:127]
 s_waitcnt lgkmcnt(2)
 v_mfma_f32_16x16x32_bf16 v[96:99], a[16:19], v[48:51], v[96:99]
 ds_read_b128 v[32:35], v6 offset:12288
 v_mfma_f32_16x16x32_bf16 v[104:107], a[88:91], v[48:51], v[104:107]
 ds_read_b128 v[36:39], v6 offset:14336
 v_mfma_f32_16x16x32_bf16 v[112:115], a[160:163], v[48:51], v[112:115]
 s_add_u32 m0, s49, 23808
 v_mfma_f32_16x16x32_bf16 v[120:123], a[232:235], v[48:51], v[120:123]
 buffer_load_dwordx4 v10, s[8:11], s46 offen offset:768  lds
 v_mfma_f32_16x16x32_bf16 v[100:103], a[16:19], v[52:55], v[100:103]
 s_add_u32 m0, s49, 27776
 v_mfma_f32_16x16x32_bf16 v[108:111], a[88:91], v[52:55], v[108:111]
 buffer_load_dwordx4 v10, s[8:11], s46 offen offset:896  lds
 v_mfma_f32_16x16x32_bf16 v[116:119], a[160:163], v[52:55], v[116:119]
 v_mfma_f32_16x16x32_bf16 v[124:127], a[232:235], v[52:55], v[124:127]
 s_waitcnt lgkmcnt(2)
 v_mfma_f32_16x16x32_bf16 v[96:99], a[20:23], v[56:59], v[96:99]
 ds_read_b128 v[40:43], v7 offset:12288
 v_mfma_f32_16x16x32_bf16 v[104:107], a[92:95], v[56:59], v[104:107]
 ds_read_b128 v[44:47], v7 offset:14336
 v_mfma_f32_16x16x32_bf16 v[112:115], a[164:167], v[56:59], v[112:115]
 s_add_u32 m0, s49, 31744
 v_mfma_f32_16x16x32_bf16 v[120:123], a[236:239], v[56:59], v[120:123]
 buffer_load_dwordx4 v10, s[8:11], s46 offen offset:1024  lds
 v_mfma_f32_16x16x32_bf16 v[100:103], a[20:23], v[60:63], v[100:103]
 v_mfma_f32_16x16x32_bf16 v[108:111], a[92:95], v[60:63], v[108:111]
 v_mfma_f32_16x16x32_bf16 v[116:119], a[164:167], v[60:63], v[116:119]
 v_mfma_f32_16x16x32_bf16 v[124:127], a[236:239], v[60:63], v[124:127]
 s_waitcnt lgkmcnt(2)
 v_mfma_f32_16x16x32_bf16 v[96:99], a[24:27], v[32:35], v[96:99]
 ds_read_b128 v[48:51], v6 offset:16384
 v_mul_f32 v64, s50, v64
 v_mfma_f32_16x16x32_bf16 v[104:107], a[96:99], v[32:35], v[104:107]
 ds_read_b128 v[52:55], v6 offset:18432
 v_mfma_f32_16x16x32_bf16 v[112:115], a[168:171], v[32:35], v[112:115]
 v_mul_f32 v65, s50, v65
 v_mfma_f32_16x16x32_bf16 v[120:123], a[240:243], v[32:35], v[120:123]
 v_mul_f32 v66, s50, v66
 v_mfma_f32_16x16x32_bf16 v[100:103], a[24:27], v[36:39], v[100:103]
 v_mul_f32 v67, s50, v67
 v_mfma_f32_16x16x32_bf16 v[108:111], a[96:99], v[36:39], v[108:111]
 v_mul_f32 v72, s50, v72
 v_mfma_f32_16x16x32_bf16 v[116:119], a[168:171], v[36:39], v[116:119]
 v_mul_f32 v73, s50, v73
 v_mfma_f32_16x16x32_bf16 v[124:127], a[240:243], v[36:39], v[124:127]
 s_waitcnt lgkmcnt(2)
 v_mfma_f32_16x16x32_bf16 v[96:99], a[28:31], v[40:43], v[96:99]
 ds_read_b128 v[56:59], v7 offset:16384
 v_mfma_f32_16x16x32_bf16 v[104:107], a[100:103], v[40:43], v[104:107]
 ds_read_b128 v[60:63], v7 offset:18432
 v_mul_f32 v74, s50, v74
 v_mfma_f32_16x16x32_bf16 v[112:115], a[172:175], v[40:43], v[112:115]
 v_mul_f32 v75, s50, v75
 v_mfma_f32_16x16x32_bf16 v[120:123], a[244:247], v[40:43], v[120:123]
 v_cvt_pk_bf16_f32 v16, v64, v65
 v_mfma_f32_16x16x32_bf16 v[100:103], a[28:31], v[44:47], v[100:103]
 v_mfma_f32_16x16x32_bf16 v[108:111], a[100:103], v[44:47], v[108:111]
 v_cvt_pk_bf16_f32 v17, v72, v73
 v_mfma_f32_16x16x32_bf16 v[116:119], a[172:175], v[44:47], v[116:119]
 v_cvt_pk_bf16_f32 v18, v66, v67
 v_mfma_f32_16x16x32_bf16 v[124:127], a[244:247], v[44:47], v[124:127]
 s_waitcnt lgkmcnt(2)
 v_cvt_pk_bf16_f32 v19, v74, v75
 v_mfma_f32_16x16x32_bf16 v[96:99], a[32:35], v[48:51], v[96:99]
 ds_read_b128 v[32:35], v6 offset:20480
 v_mfma_f32_16x16x32_bf16 v[104:107], a[104:107], v[48:51], v[104:107]
 ds_read_b128 v[36:39], v6 offset:22528
 v_mfma_f32_16x16x32_bf16 v[112:115], a[176:179], v[48:51], v[112:115]
 buffer_store_dwordx4 v[16:19], v12, s[20:23], s47 offen offset:0 sc1
 v_mfma_f32_16x16x32_bf16 v[120:123], a[248:251], v[48:51], v[120:123]
 v_mul_f32 v68, s50, v68
 v_mfma_f32_16x16x32_bf16 v[100:103], a[32:35], v[52:55], v[100:103]
 v_mul_f32 v69, s50, v69
 v_mfma_f32_16x16x32_bf16 v[108:111], a[104:107], v[52:55], v[108:111]
 v_mul_f32 v70, s50, v70
 v_mfma_f32_16x16x32_bf16 v[116:119], a[176:179], v[52:55], v[116:119]
 v_mul_f32 v71, s50, v71
 v_mfma_f32_16x16x32_bf16 v[124:127], a[248:251], v[52:55], v[124:127]
 s_waitcnt lgkmcnt(2)
 v_mfma_f32_16x16x32_bf16 v[96:99], a[36:39], v[56:59], v[96:99]
 ds_read_b128 v[40:43], v7 offset:20480
 v_mul_f32 v76, s50, v76
 v_mfma_f32_16x16x32_bf16 v[104:107], a[108:111], v[56:59], v[104:107]
 ds_read_b128 v[44:47], v7 offset:22528
 v_mfma_f32_16x16x32_bf16 v[112:115], a[180:183], v[56:59], v[112:115]
 v_mul_f32 v77, s50, v77
 v_mfma_f32_16x16x32_bf16 v[120:123], a[252:255], v[56:59], v[120:123]
 v_mul_f32 v78, s50, v78
 v_mfma_f32_16x16x32_bf16 v[100:103], a[36:39], v[60:63], v[100:103]
 v_mul_f32 v79, s50, v79
 v_mfma_f32_16x16x32_bf16 v[108:111], a[108:111], v[60:63], v[108:111]
 v_mfma_f32_16x16x32_bf16 v[116:119], a[180:183], v[60:63], v[116:119]
 v_cvt_pk_bf16_f32 v20, v68, v69
 v_mfma_f32_16x16x32_bf16 v[124:127], a[252:255], v[60:63], v[124:127]
 s_waitcnt lgkmcnt(2)
 v_cvt_pk_bf16_f32 v21, v76, v77
 v_mfma_f32_16x16x32_bf16 v[96:99], a[40:43], v[32:35], v[96:99]
 ds_read_b128 v[48:51], v6 offset:24576
 v_mfma_f32_16x16x32_bf16 v[104:107], a[112:115], v[32:35], v[104:107]
 ds_read_b128 v[52:55], v6 offset:26624
 v_cvt_pk_bf16_f32 v22, v70, v71
 v_mfma_f32_16x16x32_bf16 v[112:115], a[184:187], v[32:35], v[112:115]
 v_mfma_f32_16x16x32_bf16 v[120:123], v[224:227], v[32:35], v[120:123]
 v_cvt_pk_bf16_f32 v23, v78, v79
 v_mfma_f32_16x16x32_bf16 v[100:103], a[40:43], v[36:39], v[100:103]
 buffer_store_dwordx4 v[20:23], v12, s[20:23], s47 offen offset:1024 sc1
 v_mfma_f32_16x16x32_bf16 v[108:111], a[112:115], v[36:39], v[108:111]
 v_mul_f32 v80, s50, v80
 v_mfma_f32_16x16x32_bf16 v[116:119], a[184:187], v[36:39], v[116:119]
 v_mul_f32 v81, s50, v81
 v_mfma_f32_16x16x32_bf16 v[124:127], v[224:227], v[36:39], v[124:127]
 s_waitcnt lgkmcnt(2)
 v_mfma_f32_16x16x32_bf16 v[96:99], a[44:47], v[40:43], v[96:99]
 ds_read_b128 v[56:59], v7 offset:24576
 v_mul_f32 v82, s50, v82
 v_mfma_f32_16x16x32_bf16 v[104:107], a[116:119], v[40:43], v[104:107]
 ds_read_b128 v[60:63], v7 offset:26624
 v_mfma_f32_16x16x32_bf16 v[112:115], a[188:191], v[40:43], v[112:115]
 v_mul_f32 v83, s50, v83
 v_mfma_f32_16x16x32_bf16 v[120:123], v[228:231], v[40:43], v[120:123]
 v_mul_f32 v88, s50, v88
 v_mfma_f32_16x16x32_bf16 v[100:103], a[44:47], v[44:47], v[100:103]
 v_mul_f32 v89, s50, v89
 v_mfma_f32_16x16x32_bf16 v[108:111], a[116:119], v[44:47], v[108:111]
 v_mfma_f32_16x16x32_bf16 v[116:119], a[188:191], v[44:47], v[116:119]
 v_mul_f32 v90, s50, v90
 v_mfma_f32_16x16x32_bf16 v[124:127], v[228:231], v[44:47], v[124:127]
 s_waitcnt lgkmcnt(2)
 v_mul_f32 v91, s50, v91
 v_mfma_f32_16x16x32_bf16 v[96:99], a[48:51], v[48:51], v[96:99]
 ds_read_b128 v[32:35], v6 offset:28672
 v_mfma_f32_16x16x32_bf16 v[104:107], a[120:123], v[48:51], v[104:107]
 ds_read_b128 v[36:39], v6 offset:30720
 v_cvt_pk_bf16_f32 v24, v80, v81
 v_mfma_f32_16x16x32_bf16 v[112:115], a[192:195], v[48:51], v[112:115]
 v_mfma_f32_16x16x32_bf16 v[120:123], v[232:235], v[48:51], v[120:123]
 v_cvt_pk_bf16_f32 v25, v88, v89
 v_mfma_f32_16x16x32_bf16 v[100:103], a[48:51], v[52:55], v[100:103]
 v_cvt_pk_bf16_f32 v26, v82, v83
 v_mfma_f32_16x16x32_bf16 v[108:111], a[120:123], v[52:55], v[108:111]
 v_cvt_pk_bf16_f32 v27, v90, v91
 v_mfma_f32_16x16x32_bf16 v[116:119], a[192:195], v[52:55], v[116:119]
 buffer_store_dwordx4 v[24:27], v12, s[20:23], s48 offen offset:0 sc1
 v_mfma_f32_16x16x32_bf16 v[124:127], v[232:235], v[52:55], v[124:127]
 s_waitcnt lgkmcnt(2)
 v_mfma_f32_16x16x32_bf16 v[96:99], a[52:55], v[56:59], v[96:99]
 ds_read_b128 v[40:43], v7 offset:28672
 v_mul_f32 v84, s50, v84
 v_mfma_f32_16x16x32_bf16 v[104:107], a[124:127], v[56:59], v[104:107]
 ds_read_b128 v[44:47], v7 offset:30720
 v_mfma_f32_16x16x32_bf16 v[112:115], a[196:199], v[56:59], v[112:115]
 s_add_u32 s43, s43, 36864
 s_cmp_eq_u32 s43, 147456
 v_mfma_f32_16x16x32_bf16 v[120:123], v[236:239], v[56:59], v[120:123]
 s_cselect_b32 s43, 0, s43
 s_add_u32 s44, s44, 36864
 v_mfma_f32_16x16x32_bf16 v[100:103], a[52:55], v[60:63], v[100:103]
 s_cmp_eq_u32 s44, 147456
 s_cselect_b32 s44, 0, s44
 v_mfma_f32_16x16x32_bf16 v[108:111], a[124:127], v[60:63], v[108:111]
 v_mul_f32 v85, s50, v85
 v_mfma_f32_16x16x32_bf16 v[116:119], a[196:199], v[60:63], v[116:119]
 v_mul_f32 v86, s50, v86
 v_mfma_f32_16x16x32_bf16 v[124:127], v[236:239], v[60:63], v[124:127]
 s_waitcnt lgkmcnt(2)
 v_mfma_f32_16x16x32_bf16 v[96:99], a[56:59], v[32:35], v[96:99]
 ds_read_b128 v[48:51], v6 offset:32768
 v_mul_f32 v87, s50, v87
 v_mfma_f32_16x16x32_bf16 v[104:107], a[128:131], v[32:35], v[104:107]
 ds_read_b128 v[52:55], v6 offset:34816
 v_mfma_f32_16x16x32_bf16 v[112:115], a[200:203], v[32:35], v[112:115]
 v_add_u32 v6, s43, v4
 v_mul_f32 v92, s50, v92
 v_mfma_f32_16x16x32_bf16 v[120:123], v[240:243], v[32:35], v[120:123]
 v_mfma_f32_16x16x32_bf16 v[100:103], a[56:59], v[36:39], v[100:103]
 v_mul_f32 v93, s50, v93
 v_mfma_f32_16x16x32_bf16 v[108:111], a[128:131], v[36:39], v[108:111]
 v_mul_f32 v94, s50, v94
 v_mfma_f32_16x16x32_bf16 v[116:119], a[200:203], v[36:39], v[116:119]
 v_mul_f32 v95, s50, v95
 v_mfma_f32_16x16x32_bf16 v[124:127], v[240:243], v[36:39], v[124:127]
 s_waitcnt lgkmcnt(2)
 v_mfma_f32_16x16x32_bf16 v[96:99], a[60:63], v[40:43], v[96:99]
 ds_read_b128 v[56:59], v7 offset:32768
 v_cvt_pk_bf16_f32 v28, v84, v85
 v_mfma_f32_16x16x32_bf16 v[104:107], a[132:135], v[40:43], v[104:107]
 ds_read_b128 v[60:63], v7 offset:34816
 v_mfma_f32_16x16x32_bf16 v[112:115], a[204:207], v[40:43], v[112:115]
 v_add_u32 v7, s43, v5
 v_cvt_pk_bf16_f32 v29, v92, v93
 v_mfma_f32_16x16x32_bf16 v[120:123], v[244:247], v[40:43], v[120:123]
 v_cvt_pk_bf16_f32 v30, v86, v87
 v_mfma_f32_16x16x32_bf16 v[100:103], a[60:63], v[44:47], v[100:103]
 v_mfma_f32_16x16x32_bf16 v[108:111], a[132:135], v[44:47], v[108:111]
 v_cvt_pk_bf16_f32 v31, v94, v95
 v_mfma_f32_16x16x32_bf16 v[116:119], a[204:207], v[44:47], v[116:119]
 buffer_store_dwordx4 v[28:31], v12, s[20:23], s48 offen offset:1024 sc1
 v_mfma_f32_16x16x32_bf16 v[124:127], v[244:247], v[44:47], v[124:127]
 s_waitcnt lgkmcnt(2)
 v_mfma_f32_16x16x32_bf16 v[96:99], a[64:67], v[48:51], v[96:99]
 s_waitcnt vmcnt(13)
 s_barrier
 ds_read_b128 v[32:35], v6 offset:0
 v_mfma_f32_16x16x32_bf16 v[104:107], a[136:139], v[48:51], v[104:107]
 ds_read_b128 v[36:39], v6 offset:2048
 v_mfma_f32_16x16x32_bf16 v[112:115], a[208:211], v[48:51], v[112:115]
 v_mfma_f32_16x16x32_bf16 v[120:123], v[248:251], v[48:51], v[120:123]
 v_mfma_f32_16x16x32_bf16 v[100:103], a[64:67], v[52:55], v[100:103]
 v_mfma_f32_16x16x32_bf16 v[108:111], a[136:139], v[52:55], v[108:111]
 v_mfma_f32_16x16x32_bf16 v[116:119], a[208:211], v[52:55], v[116:119]
 v_mfma_f32_16x16x32_bf16 v[124:127], v[248:251], v[52:55], v[124:127]
 s_waitcnt lgkmcnt(2)
 v_mfma_f32_16x16x32_bf16 v[96:99], a[68:71], v[56:59], v[96:99]
 ds_read_b128 v[40:43], v7 offset:0
 v_mfma_f32_16x16x32_bf16 v[104:107], a[140:143], v[56:59], v[104:107]
 ds_read_b128 v[44:47], v7 offset:2048
 v_mfma_f32_16x16x32_bf16 v[112:115], a[212:215], v[56:59], v[112:115]
 s_mul_i32 s45, s39, 262144
 s_add_u32 s47, s34, s45
 v_mfma_f32_16x16x32_bf16 v[120:123], v[252:255], v[56:59], v[120:123]
 s_add_u32 s48, s35, s45
 v_mov_b32 v14, s42
 v_mfma_f32_16x16x32_bf16 v[100:103], a[68:71], v[60:63], v[100:103]
 s_mov_b32 s39, s40
 s_mov_b32 s40, s41
 v_mfma_f32_16x16x32_bf16 v[108:111], a[140:143], v[60:63], v[108:111]
 s_add_u32 s42, s42, 1
 s_cmp_lt_u32 s42, s36
 v_mfma_f32_16x16x32_bf16 v[116:119], a[212:215], v[60:63], v[116:119]
 v_mfma_f32_16x16x32_bf16 v[124:127], v[252:255], v[60:63], v[124:127]
 s_waitcnt lgkmcnt(2)
 s_cbranch_scc1 Lps_loop_33
 s_nop 7
 v_mul_f32 v96, s50, v96
 v_mul_f32 v97, s50, v97
 v_mul_f32 v98, s50, v98
 v_mul_f32 v99, s50, v99
 v_mul_f32 v104, s50, v104
 v_mul_f32 v105, s50, v105
 v_mul_f32 v106, s50, v106
 v_mul_f32 v107, s50, v107
 v_cvt_pk_bf16_f32 v16, v96, v97
 v_cvt_pk_bf16_f32 v17, v104, v105
 v_cvt_pk_bf16_f32 v18, v98, v99
 v_cvt_pk_bf16_f32 v19, v106, v107
 buffer_store_dwordx4 v[16:19], v12, s[20:23], s47 offen offset:0 sc1
 v_mul_f32 v100, s50, v100
 v_mul_f32 v101, s50, v101
 v_mul_f32 v102, s50, v102
 v_mul_f32 v103, s50, v103
 v_mul_f32 v108, s50, v108
 v_mul_f32 v109, s50, v109
 v_mul_f32 v110, s50, v110
 v_mul_f32 v111, s50, v111
 v_cvt_pk_bf16_f32 v20, v100, v101
 v_cvt_pk_bf16_f32 v21, v108, v109
 v_cvt_pk_bf16_f32 v22, v102, v103
 v_cvt_pk_bf16_f32 v23, v110, v111
 buffer_store_dwordx4 v[20:23], v12, s[20:23], s47 offen offset:1024 sc1
 v_mul_f32 v112, s50, v112
 v_mul_f32 v113, s50, v113
 v_mul_f32 v114, s50, v114
 v_mul_f32 v115, s50, v115
 v_mul_f32 v120, s50, v120
 v_mul_f32 v121, s50, v121
 v_mul_f32 v122, s50, v122
 v_mul_f32 v123, s50, v123
 v_cvt_pk_bf16_f32 v24, v112, v113
 v_cvt_pk_bf16_f32 v25, v120, v121
 v_cvt_pk_bf16_f32 v26, v114, v115
 v_cvt_pk_bf16_f32 v27, v122, v123
 buffer_store_dwordx4 v[24:27], v12, s[20:23], s48 offen offset:0 sc1
 v_mul_f32 v116, s50, v116
 v_mul_f32 v117, s50, v117
 v_mul_f32 v118, s50, v118
 v_mul_f32 v119, s50, v119
 v_mul_f32 v124, s50, v124
 v_mul_f32 v125, s50, v125
 v_mul_f32 v126, s50, v126
 v_mul_f32 v127, s50, v127
 v_cvt_pk_bf16_f32 v28, v116, v117
 v_cvt_pk_bf16_f32 v29, v124, v125
 v_cvt_pk_bf16_f32 v30, v118, v119
 v_cvt_pk_bf16_f32 v31, v126, v127
 buffer_store_dwordx4 v[28:31], v12, s[20:23], s48 offen offset:1024 sc1
 s_waitcnt vmcnt(0) lgkmcnt(0)
 s_barrier
 v_mov_b32 v14, s36
 buffer_store_dword v14, v13, s[20:23], 0 offen sc1
 s_sub_u32 s3, s5, 2
 s_add_u32 s7, s6, s3
 s_cmp_ge_u32 s7, 30
 s_cbranch_scc1 Lfin
 s_cmp_ge_u32 s6, 16
 s_cbranch_scc1 Lob
 s_load_dwordx2 s[8:9], s[0:1], 48
 s_mov_b32 s10, 0x240000
 s_mov_b32 s11, 0x20000
 s_load_dwordx2 s[12:13], s[0:1], 64
 s_mov_b32 s14, 0x480000
 s_mov_b32 s15, 0x20000
 s_load_dwordx2 s[16:17], s[0:1], 64
 s_mov_b32 s18, 0x480000
 s_mov_b32 s19, 0x20000
 s_lshl_b32 s32, s6, 9
 s_add_u32 s33, s32, 256
 s_mov_b32 s36, 32
 s_mov_b32 s37, s3
 s_lshl_b32 s52, s6, 1
 s_lshl_b32 s7, s3, 4
 s_add_u32 s7, s7, s6
 s_and_b32 s94, s7, 3
 s_lshr_b32 s7, s7, 2
 s_lshl_b32 s7, s7, 5
 s_add_u32 s7, s7, s94
 s_lshl_b32 s7, s7, 2
 s_add_u32 s59, s7, 0x3800
 s_waitcnt lgkmcnt(0)
 v_and_b32 v1, 63, v0
 v_lshrrev_b32 v2, 3, v0
 v_mul_u32_u24 v10, 1152, v2
 v_lshrrev_b32 v2, 4, v0
 v_xor_b32 v2, v2, v0
 v_and_b32 v2, 7, v2
 v_lshl_add_u32 v10, v2, 4, v10
 v_lshrrev_b32 v2, 4, v1
 v_bfe_u32 v3, v1, 1, 3
 v_xor_b32 v2, v2, v3
 v_and_b32 v3, 15, v1
 v_lshlrev_b32 v3, 7, v3
 v_lshl_add_u32 v4, v2, 4, v3
 v_xor_b32 v5, 64, v4
 v_lshrrev_b32 v2, 4, v0
 v_lshlrev_b32 v11, 13, v2
 v_lshrrev_b32 v2, 7, v0
 v_lshrrev_b32 v3, 4, v1
 v_lshl_add_u32 v3, v2, 2, v3
 v_bfe_u32 v2, v1, 1, 3
 v_xor_b32 v2, v2, v3
 v_lshl_add_u32 v11, v2, 5, v11
 v_and_b32 v2, 1, v1
 v_lshl_add_u32 v11, v2, 4, v11
 v_bfe_u32 v2, v1, 2, 3
 v_xor_b32 v3, s4, v2
 v_lshlrev_b32 v3, 5, v3
 v_and_b32 v2, 3, v2
 v_lshl_add_u32 v3, v2, 8, v3
 v_lshrrev_b32 v2, 4, v1
 v_lshl_add_u32 v3, v2, 11, v3
 v_and_b32 v2, 3, v1
 v_lshl_add_u32 v3, v2, 3, v3
 v_add_u32 v8, 73728, v3
 v_xor_b32 v3, 0x80, v3
 v_add_u32 v9, 73728, v3
 s_lshl_b32 s45, s4, 11
 v_lshl_add_u32 v12, v1, 4, s45
 s_mov_b32 s39, s37
 s_add_u32 s40, s39, 2
 s_lshl_b32 s49, s4, 10
 s_mul_i32 s46, s39, 36864
 s_add_u32 m0, s49, 0
 s_nop 0
 buffer_load_dwordx4 v10, s[8:11], s46 offen offset:0  lds
 s_add_u32 m0, s49, 3968
 s_nop 0
 buffer_load_dwordx4 v10, s[8:11], s46 offen offset:128  lds
 s_add_u32 m0, s49, 7936
 s_nop 0
 buffer_load_dwordx4 v10, s[8:11], s46 offen offset:256  lds
 s_add_u32 m0, s49, 11904
 s_nop 0
 buffer_load_dwordx4 v10, s[8:11], s46 offen offset:384  lds
 s_add_u32 m0, s49, 15872
 s_nop 0
 buffer_load_dwordx4 v10, s[8:11], s46 offen offset:512  lds
 s_add_u32 m0, s49, 19840
 s_nop 0
 buffer_load_dwordx4 v10, s[8:11], s46 offen offset:640  lds
 s_add_u32 m0, s49, 23808
 s_nop 0
 buffer_load_dwordx4 v10, s[8:11], s46 offen offset:768  lds
 s_add_u32 m0, s49, 27776
 s_nop 0
 buffer_load_dwordx4 v10, s[8:11], s46 offen offset:896  lds
 s_add_u32 m0, s49, 31744
 s_nop 0
 buffer_load_dwordx4 v10, s[8:11], s46 offen offset:1024  lds
 s_lshl_b32 s49, s4, 10
 s_add_u32 s49, s49, 36864
 s_mul_i32 s46, s40, 36864
 s_add_u32 m0, s49, 0
 s_nop 0
 buffer_load_dwordx4 v10, s[8:11], s46 offen offset:0  lds
 s_add_u32 m0, s49, 3968
 s_nop 0
 buffer_load_dwordx4 v10, s[8:11], s46 offen offset:128  lds
 s_add_u32 m0, s49, 7936
 s_nop 0
 buffer_load_dwordx4 v10, s[8:11], s46 offen offset:256  lds
 s_add_u32 m0, s49, 11904
 s_nop 0
 buffer_load_dwordx4 v10, s[8:11], s46 offen offset:384  lds
 s_add_u32 m0, s49, 15872
 s_nop 0
 buffer_load_dwordx4 v10, s[8:11], s46 offen offset:512  lds
 s_add_u32 m0, s49, 19840
 s_nop 0
 buffer_load_dwordx4 v10, s[8:11], s46 offen offset:640  lds
 s_add_u32 m0, s49, 23808
 s_nop 0
 buffer_load_dwordx4 v10, s[8:11], s46 offen offset:768  lds
 s_add_u32 m0, s49, 27776
 s_nop 0
 buffer_load_dwordx4 v10, s[8:11], s46 offen offset:896  lds
 s_add_u32 m0, s49, 31744
 s_nop 0
 buffer_load_dwordx4 v10, s[8:11], s46 offen offset:1024  lds
 s_lshl_b32 s49, s4, 10
 s_add_u32 m0, s49, 73728
 s_add_u32 s45, s32, 0
 buffer_load_dwordx4 v11, s[12:15], s45 offen  lds
 s_add_u32 m0, s49, 77824
 s_add_u32 s45, s32, 131072
 buffer_load_dwordx4 v11, s[12:15], s45 offen  lds
 s_add_u32 m0, s49, 81920
 s_add_u32 s45, s33, 0
 buffer_load_dwordx4 v11, s[16:19], s45 offen  lds
 s_add_u32 m0, s49, 86016
 s_add_u32 s45, s33, 131072
 buffer_load_dwordx4 v11, s[16:19], s45 offen  lds
 s_add_u32 m0, s49, 90112
 s_add_u32 s45, s32, 262144
 buffer_load_dwordx4 v11, s[12:15], s45 offen  lds
 s_add_u32 m0, s49, 94208
 s_add_u32 s45, s32, 393216
 buffer_load_dwordx4 v11, s[12:15], s45 offen  lds
 s_add_u32 m0, s49, 98304
 s_add_u32 s45, s33, 262144
 buffer_load_dwordx4 v11, s[16:19], s45 offen  lds
 s_add_u32 m0, s49, 102400
 s_add_u32 s45, s33, 393216
 buffer_load_dwordx4 v11, s[16:19], s45 offen  lds
 s_add_u32 m0, s49, 106496
 s_add_u32 s45, s32, 524288
 buffer_load_dwordx4 v11, s[12:15], s45 offen  lds
 s_add_u32 m0, s49, 110592
 s_add_u32 s45, s32, 655360
 buffer_load_dwordx4 v11, s[12:15], s45 offen  lds
 s_add_u32 m0, s49, 114688
 s_add_u32 s45, s33, 524288
 buffer_load_dwordx4 v11, s[16:19], s45 offen  lds
 s_add_u32 m0, s49, 118784
 s_add_u32 s45, s33, 655360
 buffer_load_dwordx4 v11, s[16:19], s45 offen  lds
 s_waitcnt vmcnt(8) lgkmcnt(0)
 s_barrier
 s_add_u32 m0, s49, 122880
 s_add_u32 s45, s32, 786432
 buffer_load_dwordx4 v11, s[12:15], s45 offen  lds
 s_add_u32 m0, s49, 126976
 s_add_u32 s45, s32, 917504
 buffer_load_dwordx4 v11, s[12:15], s45 offen  lds
 s_add_u32 m0, s49, 131072
 s_add_u32 s45, s33, 786432
 buffer_load_dwordx4 v11, s[16:19], s45 offen  lds
 s_add_u32 m0, s49, 135168
 s_add_u32 s45, s33, 917504
 buffer_load_dwordx4 v11, s[16:19], s45 offen  lds
 ds_read_b64_tr_b16 a[0:1], v8 offset:0
 ds_read_b64_tr_b16 a[2:3], v8 offset:1024
 ds_read_b64_tr_b16 a[72:73], v9 offset:0
 ds_read_b64_tr_b16 a[74:75], v9 offset:1024
 ds_read_b64_tr_b16 a[144:145], v8 offset:8192
 ds_read_b64_tr_b16 a[146:147], v8 offset:9216
 ds_read_b64_tr_b16 a[216:217], v9 offset:8192
 ds_read_b64_tr_b16 a[218:219], v9 offset:9216
 s_waitcnt vmcnt(8) lgkmcnt(0)
 s_barrier
 s_add_u32 m0, s49, 73728
 s_add_u32 s45, s32, 1048576
 buffer_load_dwordx4 v11, s[12:15], s45 offen  lds
 s_add_u32 m0, s49, 77824
 s_add_u32 s45, s32, 1179648
 buffer_load_dwordx4 v11, s[12:15], s45 offen  lds
 s_add_u32 m0, s49, 81920
 s_add_u32 s45, s33, 1048576
 buffer_load_dwordx4 v11, s[16:19], s45 offen  lds
 s_add_u32 m0, s49, 86016
 s_add_u32 s45, s33, 1179648
 buffer_load_dwordx4 v11, s[16:19], s45 offen  lds
 ds_read_b64_tr_b16 a[4:5], v8 offset:16384
 ds_read_b64_tr_b16 a[6:7], v8 offset:17408
 ds_read_b64_tr_b16 a[76:77], v9 offset:16384
 ds_read_b64_tr_b16 a[78:79], v9 offset:17408
 ds_read_b64_tr_b16 a[148:149], v8 offset:24576
 ds_read_b64_tr_b16 a[150:151], v8 offset:25600
 ds_read_b64_tr_b16 a[220:221], v9 offset:24576
 ds_read_b64_tr_b16 a[222:223], v9 offset:25600
 s_waitcnt vmcnt(8) lgkmcnt(0)
 s_barrier
 s_add_u32 m0, s49, 90112
 s_add_u32 s45, s32, 1310720
 buffer_load_dwordx4 v11, s[12:15], s45 offen  lds
 s_add_u32 m0, s49, 94208
 s_add_u32 s45, s32, 1441792
 buffer_load_dwordx4 v11, s[12:15], s45 offen  lds
 s_add_u32 m0, s49, 98304
 s_add_u32 s45, s33, 1310720
 buffer_load_dwordx4 v11, s[16:19], s45 offen  lds
 s_add_u32 m0, s49, 102400
 s_add_u32 s45, s33, 1441792
 buffer_load_dwordx4 v11, s[16:19], s45 offen  lds
 ds_read_b64_tr_b16 a[8:9], v8 offset:32768
 ds_read_b64_tr_b16 a[10:11], v8 offset:33792
 ds_read_b64_tr_b16 a[80:81], v9 offset:32768
 ds_read_b64_tr_b16 a[82:83], v9 offset:33792
 ds_read_b64_tr_b16 a[152:153], v8 offset:40960
 ds_read_b64_tr_b16 a[154:155], v8 offset:41984
 ds_read_b64_tr_b16 a[224:225], v9 offset:40960
 ds_read_b64_tr_b16 a[226:227], v9 offset:41984
 s_waitcnt vmcnt(8) lgkmcnt(0)
 s_barrier
 s_add_u32 m0, s49, 106496
 s_add_u32 s45, s32, 1572864
 buffer_load_dwordx4 v11, s[12:15], s45 offen  lds
 s_add_u32 m0, s49, 110592
 s_add_u32 s45, s32, 1703936
 buffer_load_dwordx4 v11, s[12:15], s45 offen  lds
 s_add_u32 m0, s49, 114688
 s_add_u32 s45, s33, 1572864
 buffer_load_dwordx4 v11, s[16:19], s45 offen  lds
 s_add_u32 m0, s49, 118784
 s_add_u32 s45, s33, 1703936
 buffer_load_dwordx4 v11, s[16:19], s45 offen  lds
 ds_read_b64_tr_b16 a[12:13], v8 offset:49152
 ds_read_b64_tr_b16 a[14:15], v8 offset:50176
 ds_read_b64_tr_b16 a[84:85], v9 offset:49152
 ds_read_b64_tr_b16 a[86:87], v9 offset:50176
 ds_read_b64_tr_b16 a[156:157], v8 offset:57344
 ds_read_b64_tr_b16 a[158:159], v8 offset:58368
 ds_read_b64_tr_b16 a[228:229], v9 offset:57344
 ds_read_b64_tr_b16 a[230:231], v9 offset:58368
 s_waitcnt vmcnt(8) lgkmcnt(0)
 s_barrier
 s_add_u32 m0, s49, 122880
 s_add_u32 s45, s32, 1835008
 buffer_load_dwordx4 v11, s[12:15], s45 offen  lds
 s_add_u32 m0, s49, 126976
 s_add_u32 s45, s32, 1966080
 buffer_load_dwordx4 v11, s[12:15], s45 offen  lds
 s_add_u32 m0, s49, 131072
 s_add_u32 s45, s33, 1835008
 buffer_load_dwordx4 v11, s[16:19], s45 offen  lds
 s_add_u32 m0, s49, 135168
 s_add_u32 s45, s33, 1966080
 buffer_load_dwordx4 v11, s[16:19], s45 offen  lds
 ds_read_b64_tr_b16 a[16:17], v8 offset:0
 ds_read_b64_tr_b16 a[18:19], v8 offset:1024
 ds_read_b64_tr_b16 a[88:89], v9 offset:0
 ds_read_b64_tr_b16 a[90:91], v9 offset:1024
 ds_read_b64_tr_b16 a[160:161], v8 offset:8192
 ds_read_b64_tr_b16 a[162:163], v8 offset:9216
 ds_read_b64_tr_b16 a[232:233], v9 offset:8192
 ds_read_b64_tr_b16 a[234:235], v9 offset:9216
 s_waitcnt vmcnt(8) lgkmcnt(0)
 s_barrier
 s_add_u32 m0, s49, 73728
 s_add_u32 s45, s32, 2097152
 buffer_load_dwordx4 v11, s[12:15], s45 offen  lds
 s_add_u32 m0, s49, 77824
 s_add_u32 s45, s32, 2228224
 buffer_load_dwordx4 v11, s[12:15], s45 offen  lds
 s_add_u32 m0, s49, 81920
 s_add_u32 s45, s33, 2097152
 buffer_load_dwordx4 v11, s[16:19], s45 offen  lds
 s_add_u32 m0, s49, 86016
 s_add_u32 s45, s33, 2228224
 buffer_load_dwordx4 v11, s[16:19], s45 offen  lds
 ds_read_b64_tr_b16 a[20:21], v8 offset:16384
 ds_read_b64_tr_b16 a[22:23], v8 offset:17408
 ds_read_b64_tr_b16 a[92:93], v9 offset:16384
 ds_read_b64_tr_b16 a[94:95], v9 offset:17408
 ds_read_b64_tr_b16 a[164:165], v8 offset:24576
 ds_read_b64_tr_b16 a[166:167], v8 offset:25600
 ds_read_b64_tr_b16 a[236:237], v9 offset:24576
 ds_read_b64_tr_b16 a[238:239], v9 offset:25600
 s_waitcnt vmcnt(8) lgkmcnt(0)
 s_barrier
 s_add_u32 m0, s49, 90112
 s_add_u32 s45, s32, 2359296
 buffer_load_dwordx4 v11, s[12:15], s45 offen  lds
 s_add_u32 m0, s49, 94208
 s_add_u32 s45, s32, 2490368
 buffer_load_dwordx4 v11, s[12:15], s45 offen  lds
 s_add_u32 m0, s49, 98304
 s_add_u32 s45, s33, 2359296
 buffer_load_dwordx4 v11, s[16:19], s45 offen  lds
 s_add_u32 m0, s49, 102400
 s_add_u32 s45, s33, 2490368
 buffer_load_dwordx4 v11, s[16:19], s45 offen  lds
 ds_read_b64_tr_b16 a[24:25], v8 offset:32768
 ds_read_b64_tr_b16 a[26:27], v8 offset:33792
 ds_read_b64_tr_b16 a[96:97], v9 offset:32768
 ds_read_b64_tr_b16 a[98:99], v9 offset:33792
 ds_read_b64_tr_b16 a[168:169], v8 offset:40960
 ds_read_b64_tr_b16 a[170:171], v8 offset:41984
 ds_read_b64_tr_b16 a[240:241], v9 offset:40960
 ds_read_b64_tr_b16 a[242:243], v9 offset:41984
 s_waitcnt vmcnt(8) lgkmcnt(0)
 s_barrier
 s_add_u32 m0, s49, 106496
 s_add_u32 s45, s32, 2621440
 buffer_load_dwordx4 v11, s[12:15], s45 offen  lds
 s_add_u32 m0, s49, 110592
 s_add_u32 s45, s32, 2752512
 buffer_load_dwordx4 v11, s[12:15], s45 offen  lds
 s_add_u32 m0, s49, 114688
 s_add_u32 s45, s33, 2621440
 buffer_load_dwordx4 v11, s[16:19], s45 offen  lds
 s_add_u32 m0, s49, 118784
 s_add_u32 s45, s33, 2752512
 buffer_load_dwordx4 v11, s[16:19], s45 offen  lds
 ds_read_b64_tr_b16 a[28:29], v8 offset:49152
 ds_read_b64_tr_b16 a[30:31], v8 offset:50176
 ds_read_b64_tr_b16 a[100:101], v9 offset:49152
 ds_read_b64_tr_b16 a[102:103], v9 offset:50176
 ds_read_b64_tr_b16 a[172:173], v8 offset:57344
 ds_read_b64_tr_b16 a[174:175], v8 offset:58368
 ds_read_b64_tr_b16 a[244:245], v9 offset:57344
 ds_read_b64_tr_b16 a[246:247], v9 offset:58368
 s_waitcnt vmcnt(8) lgkmcnt(0)
 s_barrier
 s_add_u32 m0, s49, 122880
 s_add_u32 s45, s32, 2883584
 buffer_load_dwordx4 v11, s[12:15], s45 offen  lds
 s_add_u32 m0, s49, 126976
 s_add_u32 s45, s32, 3014656
 buffer_load_dwordx4 v11, s[12:15], s45 offen  lds
 s_add_u32 m0, s49, 131072
 s_add_u32 s45, s33, 2883584
 buffer_load_dwordx4 v11, s[16:19], s45 offen  lds
 s_add_u32 m0, s49, 135168
 s_add_u32 s45, s33, 3014656
 buffer_load_dwordx4 v11, s[16:19], s45 offen  lds
 ds_read_b64_tr_b16 a[32:33], v8 offset:0
 ds_read_b64_tr_b16 a[34:35], v8 offset:1024
 ds_read_b64_tr_b16 a[104:105], v9 offset:0
 ds_read_b64_tr_b16 a[106:107], v9 offset:1024
 ds_read_b64_tr_b16 a[176:177], v8 offset:8192
 ds_read_b64_tr_b16 a[178:179], v8 offset:9216
 ds_read_b64_tr_b16 a[248:249], v9 offset:8192
 ds_read_b64_tr_b16 a[250:251], v9 offset:9216
 s_waitcnt vmcnt(8) lgkmcnt(0)
 s_barrier
 s_add_u32 m0, s49, 73728
 s_add_u32 s45, s32, 3145728
 buffer_load_dwordx4 v11, s[12:15], s45 offen  lds
 s_add_u32 m0, s49, 77824
 s_add_u32 s45, s32, 3276800
 buffer_load_dwordx4 v11, s[12:15], s45 offen  lds
 s_add_u32 m0, s49, 81920
 s_add_u32 s45, s33, 3145728
 buffer_load_dwordx4 v11, s[16:19], s45 offen  lds
 s_add_u32 m0, s49, 86016
 s_add_u32 s45, s33, 3276800
 buffer_load_dwordx4 v11, s[16:19], s45 offen  lds
 ds_read_b64_tr_b16 a[36:37], v8 offset:16384
 ds_read_b64_tr_b16 a[38:39], v8 offset:17408
 ds_read_b64_tr_b16 a[108:109], v9 offset:16384
 ds_read_b64_tr_b16 a[110:111], v9 offset:17408
 ds_read_b64_tr_b16 a[180:181], v8 offset:24576
 ds_read_b64_tr_b16 a[182:183], v8 offset:25600
 ds_read_b64_tr_b16 a[252:253], v9 offset:24576
 ds_read_b64_tr_b16 a[254:255], v9 offset:25600
 s_waitcnt vmcnt(8) lgkmcnt(0)
 s_barrier
 s_add_u32 m0, s49, 90112
 s_add_u32 s45, s32, 3407872
 buffer_load_dwordx4 v11, s[12:15], s45 offen  lds
 s_add_u32 m0, s49, 94208
 s_add_u32 s45, s32, 3538944
 buffer_load_dwordx4 v11, s[12:15], s45 offen  lds
 s_add_u32 m0, s49, 98304
 s_add_u32 s45, s33, 3407872
 buffer_load_dwordx4 v11, s[16:19], s45 offen  lds
 s_add_u32 m0, s49, 102400
 s_add_u32 s45, s33, 3538944
 buffer_load_dwordx4 v11, s[16:19], s45 offen  lds
 ds_read_b64_tr_b16 a[40:41], v8 offset:32768
 ds_read_b64_tr_b16 a[42:43], v8 offset:33792
 ds_read_b64_tr_b16 a[112:113], v9 offset:32768
 ds_read_b64_tr_b16 a[114:115], v9 offset:33792
 ds_read_b64_tr_b16 a[184:185], v8 offset:40960
 ds_read_b64_tr_b16 a[186:187], v8 offset:41984
 ds_read_b64_tr_b16 v[224:225], v9 offset:40960
 ds_read_b64_tr_b16 v[226:227], v9 offset:41984
 s_waitcnt vmcnt(8) lgkmcnt(0)
 s_barrier
 s_add_u32 m0, s49, 106496
 s_add_u32 s45, s32, 3670016
 buffer_load_dwordx4 v11, s[12:15], s45 offen  lds
 s_add_u32 m0, s49, 110592
 s_add_u32 s45, s32, 3801088
 buffer_load_dwordx4 v11, s[12:15], s45 offen  lds
 s_add_u32 m0, s49, 114688
 s_add_u32 s45, s33, 3670016
 buffer_load_dwordx4 v11, s[16:19], s45 offen  lds
 s_add_u32 m0, s49, 118784
 s_add_u32 s45, s33, 3801088
 buffer_load_dwordx4 v11, s[16:19], s45 offen  lds
 ds_read_b64_tr_b16 a[44:45], v8 offset:49152
 ds_read_b64_tr_b16 a[46:47], v8 offset:50176
 ds_read_b64_tr_b16 a[116:117], v9 offset:49152
 ds_read_b64_tr_b16 a[118:119], v9 offset:50176
 ds_read_b64_tr_b16 a[188:189], v8 offset:57344
 ds_read_b64_tr_b16 a[190:191], v8 offset:58368
 ds_read_b64_tr_b16 v[228:229], v9 offset:57344
 ds_read_b64_tr_b16 v[230:231], v9 offset:58368
 s_waitcnt vmcnt(8) lgkmcnt(0)
 s_barrier
 s_add_u32 m0, s49, 122880
 s_add_u32 s45, s32, 3932160
 buffer_load_dwordx4 v11, s[12:15], s45 offen  lds
 s_add_u32 m0, s49, 126976
 s_add_u32 s45, s32, 4063232
 buffer_load_dwordx4 v11, s[12:15], s45 offen  lds
 s_add_u32 m0, s49, 131072
 s_add_u32 s45, s33, 3932160
 buffer_load_dwordx4 v11, s[16:19], s45 offen  lds
 s_add_u32 m0, s49, 135168
 s_add_u32 s45, s33, 4063232
 buffer_load_dwordx4 v11, s[16:19], s45 offen  lds
 ds_read_b64_tr_b16 a[48:49], v8 offset:0
 ds_read_b64_tr_b16 a[50:51], v8 offset:1024
 ds_read_b64_tr_b16 a[120:121], v9 offset:0
 ds_read_b64_tr_b16 a[122:123], v9 offset:1024
 ds_read_b64_tr_b16 a[192:193], v8 offset:8192
 ds_read_b64_tr_b16 a[194:195], v8 offset:9216
 ds_read_b64_tr_b16 v[232:233], v9 offset:8192
 ds_read_b64_tr_b16 v[234:235], v9 offset:9216
 s_waitcnt vmcnt(8) lgkmcnt(0)
 s_barrier
 s_add_u32 m0, s49, 73728
 s_add_u32 s45, s32, 4194304
 buffer_load_dwordx4 v11, s[12:15], s45 offen  lds
 s_add_u32 m0, s49, 77824
 s_add_u32 s45, s32, 4325376
 buffer_load_dwordx4 v11, s[12:15], s45 offen  lds
 s_add_u32 m0, s49, 81920
 s_add_u32 s45, s33, 4194304
 buffer_load_dwordx4 v11, s[16:19], s45 offen  lds
 s_add_u32 m0, s49, 86016
 s_add_u32 s45, s33, 4325376
 buffer_load_dwordx4 v11, s[16:19], s45 offen  lds
 ds_read_b64_tr_b16 a[52:53], v8 offset:16384
 ds_read_b64_tr_b16 a[54:55], v8 offset:17408
 ds_read_b64_tr_b16 a[124:125], v9 offset:16384
 ds_read_b64_tr_b16 a[126:127], v9 offset:17408
 ds_read_b64_tr_b16 a[196:197], v8 offset:24576
 ds_read_b64_tr_b16 a[198:199], v8 offset:25600
 ds_read_b64_tr_b16 v[236:237], v9 offset:24576
 ds_read_b64_tr_b16 v[238:239], v9 offset:25600
 s_waitcnt vmcnt(8) lgkmcnt(0)
 s_barrier
 s_add_u32 m0, s49, 90112
 s_add_u32 s45, s32, 4456448
 buffer_load_dwordx4 v11, s[12:15], s45 offen  lds
 s_add_u32 m0, s49, 94208
 s_add_u32 s45, s32, 4587520
 buffer_load_dwordx4 v11, s[12:15], s45 offen  lds
 s_add_u32 m0, s49, 98304
 s_add_u32 s45, s33, 4456448
 buffer_load_dwordx4 v11, s[16:19], s45 offen  lds
 s_add_u32 m0, s49, 102400
 s_add_u32 s45, s33, 4587520
 buffer_load_dwordx4 v11, s[16:19], s45 offen  lds
 ds_read_b64_tr_b16 a[56:57], v8 offset:32768
 ds_read_b64_tr_b16 a[58:59], v8 offset:33792
 ds_read_b64_tr_b16 a[128:129], v9 offset:32768
 ds_read_b64_tr_b16 a[130:131], v9 offset:33792
 ds_read_b64_tr_b16 a[200:201], v8 offset:40960
 ds_read_b64_tr_b16 a[202:203], v8 offset:41984
 ds_read_b64_tr_b16 v[240:241], v9 offset:40960
 ds_read_b64_tr_b16 v[242:243], v9 offset:41984
 s_waitcnt vmcnt(8) lgkmcnt(0)
 s_barrier
 ds_read_b64_tr_b16 a[60:61], v8 offset:49152
 ds_read_b64_tr_b16 a[62:63], v8 offset:50176
 ds_read_b64_tr_b16 a[132:133], v9 offset:49152
 ds_read_b64_tr_b16 a[134:135], v9 offset:50176
 ds_read_b64_tr_b16 a[204:205], v8 offset:57344
 ds_read_b64_tr_b16 a[206:207], v8 offset:58368
 ds_read_b64_tr_b16 v[244:245], v9 offset:57344
 ds_read_b64_tr_b16 v[246:247], v9 offset:58368
 s_waitcnt vmcnt(4) lgkmcnt(0)
 s_barrier
 ds_read_b64_tr_b16 a[64:65], v8 offset:0
 ds_read_b64_tr_b16 a[66:67], v8 offset:1024
 ds_read_b64_tr_b16 a[136:137], v9 offset:0
 ds_read_b64_tr_b16 a[138:139], v9 offset:1024
 ds_read_b64_tr_b16 a[208:209], v8 offset:8192
 ds_read_b64_tr_b16 a[210:211], v8 offset:9216
 ds_read_b64_tr_b16 v[248:249], v9 offset:8192
 ds_read_b64_tr_b16 v[250:251], v9 offset:9216
 s_waitcnt vmcnt(0) lgkmcnt(0)
 s_barrier
 ds_read_b64_tr_b16 a[68:69], v8 offset:16384
 ds_read_b64_tr_b16 a[70:71], v8 offset:17408
 ds_read_b64_tr_b16 a[140:141], v9 offset:16384
 ds_read_b64_tr_b16 a[142:143], v9 offset:17408
 ds_read_b64_tr_b16 a[212:213], v8 offset:24576
 ds_read_b64_tr_b16 a[214:215], v8 offset:25600
 ds_read_b64_tr_b16 v[252:253], v9 offset:24576
 ds_read_b64_tr_b16 v[254:255], v9 offset:25600
 s_mov_b32 s50, 0x3e0293ee
 s_mov_b32 s42, 0
 s_mov_b32 s43, 0
 s_mov_b32 s44, 73728
 v_mov_b32 v6, v4
 v_mov_b32 v7, v5
 v_and_b32 v17, 63, v0
 v_lshlrev_b32 v1, 4, v17
 s_lshl_b32 s45, s4, 11
 s_add_u32 s45, s45, 147456
 v_add_u32 v2, s45, v1
 s_lshr_b32 s53, s4, 1
 s_and_b32 s54, s4, 1
 s_add_u32 s52, s52, s53
 s_lshl_b32 s53, s53, 13
 s_lshl_b32 s54, s54, 10
 s_add_u32 s45, s53, s54
 s_add_u32 s45, s45, 147456
 v_add_u32 v3, s45, v1
 s_lshl_b32 s63, s52, 13
 s_add_u32 s63, s63, s54
 s_add_u32 s63, s63, 0x7000000
 s_lshl_b32 s61, s52, 14
 s_add_u32 s61, s61, 0x3000000
 s_lshl_b32 s62, s52, 12
 s_add_u32 s62, s62, 0x400000
 s_lshl_b32 s57, s52, 7
 s_add_u32 s57, s57, 0x1000
 s_waitcnt lgkmcnt(0)
 v_min_u32 v8, 1, v0
 v_lshlrev_b32 v8, 28, v8
 s_mov_b32 s58, 0x40000
 v_mov_b32 v13, 0
 v_mov_b32 v14, 0
 v_min_u32 v15, 1, v17
 v_lshlrev_b32 v15, 28, v15
 v_bfe_u32 v18, v17, 3, 2
 v_and_b32 v19, 7, v17
 v_lshlrev_b32 v19, 7, v19
 v_lshl_add_u32 v18, v18, 11, v19
 v_lshrrev_b32 v19, 5, v17
 v_lshl_or_b32 v11, v19, 28, v18
 s_mov_b32 s56, s61
 v_mov_b32 v18, 0x44444444
 v_mov_b32 v19, 0xeeeeeeee
 v_and_b32 v20, 2, v17
 v_cmp_eq_u32 vcc, 0, v20
 s_nop 1
 v_cndmask_b32 v12, v19, v18, vcc
 v_mov_b32 v217, 0
 v_mov_b32 v218, 0
 v_mov_b32 v220, 0x3f803f80
 v_mov_b32 v221, 0x3f803f80
 v_mov_b32 v222, 0x3f803f80
 v_mov_b32 v223, 0x3f803f80
 v_and_b32 v18, 15, v17
 v_lshrrev_b32 v19, 4, v17
 v_lshlrev_b32 v19, 2, v19
 v_sub_u32 v18, v18, v19
 s_lshr_b32 s45, s54, 6
 v_add_u32 v18, s45, v18
 v_mov_b32 v19, 0xff800000
 v_cmp_le_i32 vcc, 0, v18
 s_nop 1
 v_cndmask_b32 v208, v19, v13, vcc
 v_cmp_le_i32 vcc, 1, v18
 s_nop 1
 v_cndmask_b32 v209, v19, v13, vcc
 v_cmp_le_i32 vcc, 2, v18
 s_nop 1
 v_cndmask_b32 v210, v19, v13, vcc
 v_cmp_le_i32 vcc, 3, v18
 s_nop 1
 v_cndmask_b32 v211, v19, v13, vcc
 v_cmp_le_i32 vcc, 16, v18
 s_nop 1
 v_cndmask_b32 v212, v19, v13, vcc
 v_cmp_le_i32 vcc, 17, v18
 s_nop 1
 v_cndmask_b32 v213, v19, v13, vcc
 v_cmp_le_i32 vcc, 18, v18
 s_nop 1
 v_cndmask_b32 v214, v19, v13, vcc
 v_cmp_le_i32 vcc, 19, v18
 s_nop 1
 v_cndmask_b32 v215, v19, v13, vcc
Lqs_34:
 buffer_load_dword v16, v15, s[20:23], s57 offen sc1
 s_waitcnt vmcnt(0)
 v_cmp_le_u32 vcc, 1, v16
 s_cbranch_vccnz Lqsk_35
 s_sleep 2
 s_sub_u32 s58, s58, 1
 s_cbranch_scc0 Lqs_34
 s_endpgm
Lqsk_35:
 s_waitcnt vmcnt(0) lgkmcnt(0)
 s_barrier
 ds_read_b128 v[32:35], v6 offset:0
 ds_read_b128 v[36:39], v6 offset:2048
 ds_read_b128 v[40:43], v7 offset:0
 ds_read_b128 v[44:47], v7 offset:2048
 s_waitcnt lgkmcnt(2)
Lqb_loop_36:
 v_mfma_f32_16x16x32_bf16 v[64:67], a[0:3], v[32:35], 0
 ds_read_b128 v[48:51], v6 offset:4096
 v_mfma_f32_16x16x32_bf16 v[72:75], a[72:75], v[32:35], 0
 ds_read_b128 v[52:55], v6 offset:6144
 v_mfma_f32_16x16x32_bf16 v[80:83], a[144:147], v[32:35], 0
 s_add_u32 s41, s40, 2
 v_mfma_f32_16x16x32_bf16 v[88:91], a[216:219], v[32:35], 0
 s_add_u32 s45, s42, 2
 s_mul_i32 s46, s41, 36864
 v_mfma_f32_16x16x32_bf16 v[68:71], a[0:3], v[36:39], 0
 s_cmp_lt_u32 s45, s36
 s_cselect_b32 s46, s46, 0
 v_mfma_f32_16x16x32_bf16 v[76:79], a[72:75], v[36:39], 0
 s_lshl_b32 s49, s4, 10
 s_add_u32 s49, s49, s44
 v_mfma_f32_16x16x32_bf16 v[84:87], a[144:147], v[36:39], 0
 s_lshl_b32 s53, s39, 19
 s_add_u32 s53, s53, s61
 v_mfma_f32_16x16x32_bf16 v[92:95], a[216:219], v[36:39], 0
 s_waitcnt lgkmcnt(2)
 v_mfma_f32_16x16x32_bf16 v[64:67], a[4:7], v[40:43], v[64:67]
 ds_read_b128 v[56:59], v7 offset:4096
 v_mfma_f32_16x16x32_bf16 v[72:75], a[76:79], v[40:43], v[72:75]
 ds_read_b128 v[60:63], v7 offset:6144
 v_mfma_f32_16x16x32_bf16 v[80:83], a[148:151], v[40:43], v[80:83]
 s_add_u32 m0, s49, 0
 v_mfma_f32_16x16x32_bf16 v[88:91], a[220:223], v[40:43], v[88:91]
 buffer_load_dwordx4 v10, s[8:11], s46 offen offset:0  lds
 v_mfma_f32_16x16x32_bf16 v[68:71], a[4:7], v[44:47], v[68:71]
 s_add_u32 m0, s49, 3968
 v_mfma_f32_16x16x32_bf16 v[76:79], a[76:79], v[44:47], v[76:79]
 buffer_load_dwordx4 v10, s[8:11], s46 offen offset:128  lds
 v_mfma_f32_16x16x32_bf16 v[84:87], a[148:151], v[44:47], v[84:87]
 s_lshl_b32 s55, s39, 17
 s_add_u32 s55, s55, s62
 v_mfma_f32_16x16x32_bf16 v[92:95], a[220:223], v[44:47], v[92:95]
 s_waitcnt lgkmcnt(2)
 v_mfma_f32_16x16x32_bf16 v[64:67], a[8:11], v[48:51], v[64:67]
 ds_read_b128 v[32:35], v6 offset:8192
 v_mfma_f32_16x16x32_bf16 v[72:75], a[80:83], v[48:51], v[72:75]
 ds_read_b128 v[36:39], v6 offset:10240
 v_mfma_f32_16x16x32_bf16 v[80:83], a[152:155], v[48:51], v[80:83]
 s_add_u32 m0, s49, 7936
 v_mfma_f32_16x16x32_bf16 v[88:91], a[224:227], v[48:51], v[88:91]
 buffer_load_dwordx4 v10, s[8:11], s46 offen offset:256  lds
 v_mfma_f32_16x16x32_bf16 v[68:71], a[8:11], v[52:55], v[68:71]
 s_add_u32 m0, s49, 11904
 v_mfma_f32_16x16x32_bf16 v[76:79], a[80:83], v[52:55], v[76:79]
 buffer_load_dwordx4 v10, s[8:11], s46 offen offset:384  lds
 v_mfma_f32_16x16x32_bf16 v[84:87], a[152:155], v[52:55], v[84:87]
 v_mfma_f32_16x16x32_bf16 v[92:95], a[224:227], v[52:55], v[92:95]
 s_waitcnt lgkmcnt(2)
 v_mfma_f32_16x16x32_bf16 v[64:67], a[12:15], v[56:59], v[64:67]
 ds_read_b128 v[40:43], v7 offset:8192
 v_mfma_f32_16x16x32_bf16 v[72:75], a[84:87], v[56:59], v[72:75]
 ds_read_b128 v[44:47], v7 offset:10240
 v_mfma_f32_16x16x32_bf16 v[80:83], a[156:159], v[56:59], v[80:83]
 s_add_u32 m0, s49, 15872
 v_mfma_f32_16x16x32_bf16 v[88:91], a[228:231], v[56:59], v[88:91]
 buffer_load_dwordx4 v10, s[8:11], s46 offen offset:512  lds
 v_mfma_f32_16x16x32_bf16 v[68:71], a[12:15], v[60:63], v[68:71]
 s_add_u32 m0, s49, 19840
 v_mfma_f32_16x16x32_bf16 v[76:79], a[84:87], v[60:63], v[76:79]
 buffer_load_dwordx4 v10, s[8:11], s46 offen offset:640  lds
 v_mfma_f32_16x16x32_bf16 v[84:87], a[156:159], v[60:63], v[84:87]
 s_add_u32 s60, s39, 1
 v_mfma_f32_16x16x32_bf16 v[92:95], a[228:231], v[60:63], v[92:95]
 s_waitcnt lgkmcnt(2)
 v_mfma_f32_16x16x32_bf16 v[64:67], a[16:19], v[32:35], v[64:67]
 ds_read_b128 v[48:51], v6 offset:12288
 v_mfma_f32_16x16x32_bf16 v[72:75], a[88:91], v[32:35], v[72:75]
 ds_read_b128 v[52:55], v6 offset:14336
 v_mfma_f32_16x16x32_bf16 v[80:83], a[160:163], v[32:35], v[80:83]
 s_add_u32 m0, s49, 23808
 v_mfma_f32_16x16x32_bf16 v[88:91], a[232:235], v[32:35], v[88:91]
 buffer_load_dwordx4 v10, s[8:11], s46 offen offset:768  lds
 v_mfma_f32_16x16x32_bf16 v[68:71], a[16:19], v[36:39], v[68:71]
 s_add_u32 m0, s49, 27776
 v_mfma_f32_16x16x32_bf16 v[76:79], a[88:91], v[36:39], v[76:79]
 buffer_load_dwordx4 v10, s[8:11], s46 offen offset:896  lds
 v_mfma_f32_16x16x32_bf16 v[84:87], a[160:163], v[36:39], v[84:87]
 v_mfma_f32_16x16x32_bf16 v[92:95], a[232:235], v[36:39], v[92:95]
 s_waitcnt lgkmcnt(2)
 v_mfma_f32_16x16x32_bf16 v[64:67], a[20:23], v[40:43], v[64:67]
 ds_read_b128 v[56:59], v7 offset:12288
 v_mfma_f32_16x16x32_bf16 v[72:75], a[92:95], v[40:43], v[72:75]
 ds_read_b128 v[60:63], v7 offset:14336
 v_mfma_f32_16x16x32_bf16 v[80:83], a[164:167], v[40:43], v[80:83]
 s_add_u32 m0, s49, 31744
 v_mfma_f32_16x16x32_bf16 v[88:91], a[236:239], v[40:43], v[88:91]
 buffer_load_dwordx4 v10, s[8:11], s46 offen offset:1024  lds
 v_mfma_f32_16x16x32_bf16 v[68:71], a[20:23], v[44:47], v[68:71]
 v_mfma_f32_16x16x32_bf16 v[76:79], a[92:95], v[44:47], v[76:79]
 v_mfma_f32_16x16x32_bf16 v[84:87], a[164:167], v[44:47], v[84:87]
 v_mfma_f32_16x16x32_bf16 v[92:95], a[236:239], v[44:47], v[92:95]
 s_waitcnt lgkmcnt(2)
 v_mfma_f32_16x16x32_bf16 v[64:67], a[24:27], v[48:51], v[64:67]
 ds_read_b128 v[32:35], v6 offset:16384
 v_mfma_f32_16x16x32_bf16 v[72:75], a[96:99], v[48:51], v[72:75]
 ds_read_b128 v[36:39], v6 offset:18432
 v_mfma_f32_16x16x32_bf16 v[80:83], a[168:171], v[48:51], v[80:83]
 s_waitcnt vmcnt(9)
 buffer_load_dword v17, v11, s[20:23], s56 offen sc1
 v_mfma_f32_16x16x32_bf16 v[88:91], a[240:243], v[48:51], v[88:91]
 s_barrier
 buffer_store_dword v14, v8, s[20:23], s59 offen sc1
 v_mfma_f32_16x16x32_bf16 v[68:71], a[24:27], v[52:55], v[68:71]
 buffer_load_dword v16, v15, s[20:23], s57 offen sc1
 v_mfma_f32_16x16x32_bf16 v[76:79], a[96:99], v[52:55], v[76:79]
 v_mfma_f32_16x16x32_bf16 v[84:87], a[168:171], v[52:55], v[84:87]
 s_lshl_b32 s56, s39, 18
 s_add_u32 s56, s56, s63
 v_mfma_f32_16x16x32_bf16 v[92:95], a[240:243], v[52:55], v[92:95]
 s_waitcnt lgkmcnt(2)
 v_mfma_f32_16x16x32_bf16 v[64:67], a[28:31], v[56:59], v[64:67]
 ds_read_b128 v[40:43], v7 offset:16384
 v_mfma_f32_16x16x32_bf16 v[72:75], a[100:103], v[56:59], v[72:75]
 ds_read_b128 v[44:47], v7 offset:18432
 v_mfma_f32_16x16x32_bf16 v[80:83], a[172:175], v[56:59], v[80:83]
 buffer_load_dwordx4 v[128:131], v1, s[20:23], s53 offen offset:0 sc1
 v_mfma_f32_16x16x32_bf16 v[88:91], a[244:247], v[56:59], v[88:91]
 v_mfma_f32_16x16x32_bf16 v[68:71], a[28:31], v[60:63], v[68:71]
 buffer_load_dwordx4 v[132:135], v1, s[20:23], s53 offen offset:1024 sc1
 v_mfma_f32_16x16x32_bf16 v[76:79], a[100:103], v[60:63], v[76:79]
 v_mfma_f32_16x16x32_bf16 v[84:87], a[172:175], v[60:63], v[84:87]
 v_mfma_f32_16x16x32_bf16 v[92:95], a[244:247], v[60:63], v[92:95]
 s_waitcnt lgkmcnt(2)
 v_mfma_f32_16x16x32_bf16 v[64:67], a[32:35], v[32:35], v[64:67]
 ds_read_b128 v[48:51], v6 offset:20480
 v_mfma_f32_16x16x32_bf16 v[72:75], a[104:107], v[32:35], v[72:75]
 ds_read_b128 v[52:55], v6 offset:22528
 v_mfma_f32_16x16x32_bf16 v[80:83], a[176:179], v[32:35], v[80:83]
 buffer_load_dwordx4 v[136:139], v1, s[20:23], s53 offen offset:2048 sc1
 v_mfma_f32_16x16x32_bf16 v[88:91], a[248:251], v[32:35], v[88:91]
 v_mfma_f32_16x16x32_bf16 v[68:71], a[32:35], v[36:39], v[68:71]
 buffer_load_dwordx4 v[140:143], v1, s[20:23], s53 offen offset:3072 sc1
 v_mfma_f32_16x16x32_bf16 v[76:79], a[104:107], v[36:39], v[76:79]
 v_mfma_f32_16x16x32_bf16 v[84:87], a[176:179], v[36:39], v[84:87]
 s_add_u32 s53, s53, 4096
 v_mfma_f32_16x16x32_bf16 v[92:95], a[248:251], v[36:39], v[92:95]
 s_waitcnt lgkmcnt(2)
 v_mfma_f32_16x16x32_bf16 v[64:67], a[36:39], v[40:43], v[64:67]
 ds_read_b128 v[56:59], v7 offset:20480
 v_mfma_f32_16x16x32_bf16 v[72:75], a[108:111], v[40:43], v[72:75]
 ds_read_b128 v[60:63], v7 offset:22528
 v_mfma_f32_16x16x32_bf16 v[80:83], a[180:183], v[40:43], v[80:83]
 buffer_load_dwordx4 v[144:147], v1, s[20:23], s53 offen offset:0 sc1
 v_mfma_f32_16x16x32_bf16 v[88:91], a[252:255], v[40:43], v[88:91]
 v_mfma_f32_16x16x32_bf16 v[68:71], a[36:39], v[44:47], v[68:71]
 buffer_load_dwordx4 v[148:151], v1, s[20:23], s53 offen offset:1024 sc1
 v_mfma_f32_16x16x32_bf16 v[76:79], a[108:111], v[44:47], v[76:79]
 v_mfma_f32_16x16x32_bf16 v[84:87], a[180:183], v[44:47], v[84:87]
 v_mfma_f32_16x16x32_bf16 v[92:95], a[252:255], v[44:47], v[92:95]
 s_waitcnt lgkmcnt(2)
 v_mfma_f32_16x16x32_bf16 v[64:67], a[40:43], v[48:51], v[64:67]
 ds_read_b128 v[32:35], v6 offset:24576
 v_mfma_f32_16x16x32_bf16 v[72:75], a[112:115], v[48:51], v[72:75]
 ds_read_b128 v[36:39], v6 offset:26624
 v_mfma_f32_16x16x32_bf16 v[80:83], a[184:187], v[48:51], v[80:83]
 buffer_load_dwordx4 v[152:155], v1, s[20:23], s53 offen offset:2048 sc1
 v_mfma_f32_16x16x32_bf16 v[88:91], v[224:227], v[48:51], v[88:91]
 v_mfma_f32_16x16x32_bf16 v[68:71], a[40:43], v[52:55], v[68:71]
 buffer_load_dwordx4 v[156:159], v1, s[20:23], s53 offen offset:3072 sc1
 v_mfma_f32_16x16x32_bf16 v[76:79], a[112:115], v[52:55], v[76:79]
 v_mfma_f32_16x16x32_bf16 v[84:87], a[184:187], v[52:55], v[84:87]
 s_add_u32 s53, s53, 4096
 v_mfma_f32_16x16x32_bf16 v[92:95], v[224:227], v[52:55], v[92:95]
 s_waitcnt lgkmcnt(2)
 v_mfma_f32_16x16x32_bf16 v[64:67], a[44:47], v[56:59], v[64:67]
 ds_read_b128 v[40:43], v7 offset:24576
 v_mfma_f32_16x16x32_bf16 v[72:75], a[116:119], v[56:59], v[72:75]
 ds_read_b128 v[44:47], v7 offset:26624
 v_mfma_f32_16x16x32_bf16 v[80:83], a[188:191], v[56:59], v[80:83]
 buffer_load_dwordx4 v[160:163], v1, s[20:23], s53 offen offset:0 sc1
 v_mfma_f32_16x16x32_bf16 v[88:91], v[228:231], v[56:59], v[88:91]
 v_mfma_f32_16x16x32_bf16 v[68:71], a[44:47], v[60:63], v[68:71]
 buffer_load_dwordx4 v[164:167], v1, s[20:23], s53 offen offset:1024 sc1
 v_mfma_f32_16x16x32_bf16 v[76:79], a[116:119], v[60:63], v[76:79]
 v_mfma_f32_16x16x32_bf16 v[84:87], a[188:191], v[60:63], v[84:87]
 v_mfma_f32_16x16x32_bf16 v[92:95], v[228:231], v[60:63], v[92:95]
 s_waitcnt lgkmcnt(2)
 v_mfma_f32_16x16x32_bf16 v[64:67], a[48:51], v[32:35], v[64:67]
 ds_read_b128 v[48:51], v6 offset:28672
 v_mfma_f32_16x16x32_bf16 v[72:75], a[120:123], v[32:35], v[72:75]
 ds_read_b128 v[52:55], v6 offset:30720
 v_mfma_f32_16x16x32_bf16 v[80:83], a[192:195], v[32:35], v[80:83]
 buffer_load_dwordx4 v[168:171], v1, s[20:23], s53 offen offset:2048 sc1
 v_mfma_f32_16x16x32_bf16 v[88:91], v[232:235], v[32:35], v[88:91]
 v_mfma_f32_16x16x32_bf16 v[68:71], a[48:51], v[36:39], v[68:71]
 buffer_load_dwordx4 v[172:175], v1, s[20:23], s53 offen offset:3072 sc1
 v_mfma_f32_16x16x32_bf16 v[76:79], a[120:123], v[36:39], v[76:79]
 v_mfma_f32_16x16x32_bf16 v[84:87], a[192:195], v[36:39], v[84:87]
 s_add_u32 s53, s53, 4096
 v_mfma_f32_16x16x32_bf16 v[92:95], v[232:235], v[36:39], v[92:95]
 s_waitcnt lgkmcnt(2)
 v_mfma_f32_16x16x32_bf16 v[64:67], a[52:55], v[40:43], v[64:67]
 ds_read_b128 v[56:59], v7 offset:28672
 v_mfma_f32_16x16x32_bf16 v[72:75], a[124:127], v[40:43], v[72:75]
 ds_read_b128 v[60:63], v7 offset:30720
 v_mfma_f32_16x16x32_bf16 v[80:83], a[196:199], v[40:43], v[80:83]
 s_add_u32 s43, s43, 36864
 s_cmp_eq_u32 s43, 147456
 buffer_load_dwordx4 v[176:179], v1, s[20:23], s53 offen offset:0 sc1
 v_mfma_f32_16x16x32_bf16 v[88:91], v[236:239], v[40:43], v[88:91]
 s_cselect_b32 s43, 0, s43
 s_add_u32 s44, s44, 36864
 v_mfma_f32_16x16x32_bf16 v[68:71], a[52:55], v[44:47], v[68:71]
 s_cmp_eq_u32 s44, 147456
 s_cselect_b32 s44, 0, s44
 buffer_load_dwordx4 v[180:183], v1, s[20:23], s53 offen offset:1024 sc1
 v_mfma_f32_16x16x32_bf16 v[76:79], a[124:127], v[44:47], v[76:79]
 v_mfma_f32_16x16x32_bf16 v[84:87], a[196:199], v[44:47], v[84:87]
 v_mfma_f32_16x16x32_bf16 v[92:95], v[236:239], v[44:47], v[92:95]
 s_waitcnt lgkmcnt(2)
 v_mfma_f32_16x16x32_bf16 v[64:67], a[56:59], v[48:51], v[64:67]
 ds_read_b128 v[32:35], v6 offset:32768
 v_mfma_f32_16x16x32_bf16 v[72:75], a[128:131], v[48:51], v[72:75]
 ds_read_b128 v[36:39], v6 offset:34816
 v_mfma_f32_16x16x32_bf16 v[80:83], a[200:203], v[48:51], v[80:83]
 v_add_u32 v6, s43, v4
 buffer_load_dwordx4 v[184:187], v1, s[20:23], s53 offen offset:2048 sc1
 v_mfma_f32_16x16x32_bf16 v[88:91], v[240:243], v[48:51], v[88:91]
 v_mfma_f32_16x16x32_bf16 v[68:71], a[56:59], v[52:55], v[68:71]
 buffer_load_dwordx4 v[188:191], v1, s[20:23], s53 offen offset:3072 sc1
 v_mfma_f32_16x16x32_bf16 v[76:79], a[128:131], v[52:55], v[76:79]
 v_mfma_f32_16x16x32_bf16 v[84:87], a[200:203], v[52:55], v[84:87]
 v_mfma_f32_16x16x32_bf16 v[92:95], v[240:243], v[52:55], v[92:95]
 s_waitcnt lgkmcnt(2)
 v_mfma_f32_16x16x32_bf16 v[64:67], a[60:63], v[56:59], v[64:67]
 ds_read_b128 v[40:43], v7 offset:32768
 v_mfma_f32_16x16x32_bf16 v[72:75], a[132:135], v[56:59], v[72:75]
 ds_read_b128 v[44:47], v7 offset:34816
 v_mfma_f32_16x16x32_bf16 v[80:83], a[204:207], v[56:59], v[80:83]
 v_add_u32 v7, s43, v5
 v_mfma_f32_16x16x32_bf16 v[88:91], v[244:247], v[56:59], v[88:91]
 v_mfma_f32_16x16x32_bf16 v[68:71], a[60:63], v[60:63], v[68:71]
 v_mfma_f32_16x16x32_bf16 v[76:79], a[132:135], v[60:63], v[76:79]
 v_mfma_f32_16x16x32_bf16 v[84:87], a[204:207], v[60:63], v[84:87]
 v_mfma_f32_16x16x32_bf16 v[92:95], v[244:247], v[60:63], v[92:95]
 s_waitcnt lgkmcnt(2)
 v_mfma_f32_16x16x32_bf16 v[64:67], a[64:67], v[32:35], v[64:67]
 s_waitcnt vmcnt(28)
 s_barrier
 ds_read_b128 v[48:51], v6 offset:0
 v_mfma_f32_16x16x32_bf16 v[72:75], a[136:139], v[32:35], v[72:75]
 ds_read_b128 v[52:55], v6 offset:2048
 v_mfma_f32_16x16x32_bf16 v[80:83], a[208:211], v[32:35], v[80:83]
 v_mfma_f32_16x16x32_bf16 v[88:91], v[248:251], v[32:35], v[88:91]
 s_waitcnt vmcnt(16)
 v_cmp_le_u32 vcc, s60, v16
 v_mfma_f32_16x16x32_bf16 v[68:71], a[64:67], v[36:39], v[68:71]
 v_mfma_f32_16x16x32_bf16 v[76:79], a[136:139], v[36:39], v[76:79]
 s_and_b32 s64, vcc_lo, 1
 s_cbranch_scc0 Lqsk_37
 buffer_load_dwordx4 v[192:195], v1, s[20:23], s55 offen offset:0 sc1
 buffer_load_dwordx4 v[196:199], v1, s[20:23], s55 offen offset:1024 sc1
 buffer_load_dwordx4 v[200:203], v1, s[20:23], s55 offen offset:2048 sc1
 buffer_load_dwordx4 v[204:207], v1, s[20:23], s55 offen offset:3072 sc1
Lqsk_37:
 v_mfma_f32_16x16x32_bf16 v[84:87], a[208:211], v[36:39], v[84:87]
 v_mfma_f32_16x16x32_bf16 v[92:95], v[248:251], v[36:39], v[92:95]
 s_waitcnt lgkmcnt(2)
 v_mfma_f32_16x16x32_bf16 v[64:67], a[68:71], v[40:43], v[64:67]
 ds_read_b128 v[56:59], v7 offset:0
 v_mfma_f32_16x16x32_bf16 v[72:75], a[140:143], v[40:43], v[72:75]
 ds_read_b128 v[60:63], v7 offset:2048
 v_mfma_f32_16x16x32_bf16 v[80:83], a[212:215], v[40:43], v[80:83]
 v_mfma_f32_16x16x32_bf16 v[88:91], v[252:255], v[40:43], v[88:91]
 s_mov_b32 s39, s40
 s_mov_b32 s40, s41
 v_mfma_f32_16x16x32_bf16 v[68:71], a[68:71], v[44:47], v[68:71]
 s_add_u32 s42, s42, 1
 v_mov_b32 v14, s42
 v_mfma_f32_16x16x32_bf16 v[76:79], a[140:143], v[44:47], v[76:79]
 v_mfma_f32_16x16x32_bf16 v[84:87], a[212:215], v[44:47], v[84:87]
 v_mfma_f32_16x16x32_bf16 v[92:95], v[252:255], v[44:47], v[92:95]
 s_waitcnt lgkmcnt(2)
 s_nop 7
 v_cvt_pk_bf16_f32 v16, v64, v72
 v_cvt_pk_bf16_f32 v17, v65, v73
 v_cvt_pk_bf16_f32 v18, v66, v74
 v_cvt_pk_bf16_f32 v19, v67, v75
 ds_write_b128 v2, v[16:19] offset:0
 v_cvt_pk_bf16_f32 v20, v68, v76
 v_cvt_pk_bf16_f32 v21, v69, v77
 v_cvt_pk_bf16_f32 v22, v70, v78
 v_cvt_pk_bf16_f32 v23, v71, v79
 ds_write_b128 v2, v[20:23] offset:1024
 v_cvt_pk_bf16_f32 v24, v80, v88
 v_cvt_pk_bf16_f32 v25, v81, v89
 v_cvt_pk_bf16_f32 v26, v82, v90
 v_cvt_pk_bf16_f32 v27, v83, v91
 ds_write_b128 v2, v[24:27] offset:8192
 v_cvt_pk_bf16_f32 v28, v84, v92
 v_cvt_pk_bf16_f32 v29, v85, v93
 v_cvt_pk_bf16_f32 v30, v86, v94
 v_cvt_pk_bf16_f32 v31, v87, v95
 ds_write_b128 v2, v[28:31] offset:9216
 v_mov_b64 v[120:121], 0
 v_mov_b64 v[122:123], 0
 s_waitcnt lgkmcnt(0)
 s_barrier
 ds_read_b128 v[96:99], v3 offset:0
 ds_read_b128 v[100:103], v3 offset:2048
 ds_read_b128 v[104:107], v3 offset:4096
 ds_read_b128 v[108:111], v3 offset:6144
 s_cmp_lg_u32 s64, 0
 s_cbranch_scc1 Lqpre_38
Lqs_39:
 buffer_load_dword v16, v15, s[20:23], s57 offen sc1
 s_waitcnt vmcnt(0)
 v_cmp_le_u32 vcc, s60, v16
 s_cbranch_vccnz Lqsk_40
 s_sleep 2
 s_sub_u32 s58, s58, 1
 s_cbranch_scc0 Lqs_39
 s_endpgm
Lqsk_40:
 buffer_load_dwordx4 v[192:195], v1, s[20:23], s55 offen offset:0 sc1
 buffer_load_dwordx4 v[196:199], v1, s[20:23], s55 offen offset:1024 sc1
 buffer_load_dwordx4 v[200:203], v1, s[20:23], s55 offen offset:2048 sc1
 buffer_load_dwordx4 v[204:207], v1, s[20:23], s55 offen offset:3072 sc1
Lqpre_38:
 s_waitcnt vmcnt(4) lgkmcnt(0)
 v_mfma_f32_16x16x32_bf16 v[112:115], v[128:131], v[96:99], v[208:211]
 v_mfma_f32_16x16x32_bf16 v[116:119], v[132:135], v[96:99], v[212:215]
 v_mfma_f32_16x16x32_bf16 v[112:115], v[136:139], v[100:103], v[112:115]
 v_mfma_f32_16x16x32_bf16 v[116:119], v[140:143], v[100:103], v[116:119]
 v_mfma_f32_16x16x32_bf16 v[112:115], v[144:147], v[104:107], v[112:115]
 v_mfma_f32_16x16x32_bf16 v[116:119], v[148:151], v[104:107], v[116:119]
 v_mfma_f32_16x16x32_bf16 v[112:115], v[152:155], v[108:111], v[112:115]
 v_mfma_f32_16x16x32_bf16 v[116:119], v[156:159], v[108:111], v[116:119]
 s_nop 7
 v_max3_f32 v24, v112, v113, v114
 v_max3_f32 v24, v24, v115, v116
 v_max3_f32 v24, v24, v117, v118
 v_max_f32 v24, v24, v119
 s_waitcnt vmcnt(2)
 v_mov_b64 v[16:17], v[192:193]
 v_mov_b64 v[18:19], v[196:197]
 s_nop 1
 v_smfmac_f32_16x16x64_bf16 v[120:123], v[16:19], v[96:103], v12
 s_waitcnt vmcnt(0)
 v_mov_b64 v[20:21], v[200:201]
 v_mov_b64 v[22:23], v[204:205]
 s_nop 1
 v_smfmac_f32_16x16x64_bf16 v[120:123], v[20:23], v[104:111], v12
 s_nop 7
 v_add_f32 v120, v120, v122
 v_add_f32 v121, v121, v123
 v_mul_f32 v120, s50, v120
 v_mul_f32 v121, s50, v121
 v_max3_f32 v24, v24, v120, v121
 v_mov_b32 v25, v24
 s_nop 1
 v_permlane16_swap_b32 v24, v25
 v_max_f32 v24, v24, v25
 v_mov_b32 v25, v24
 s_nop 1
 v_permlane32_swap_b32 v24, v25
 v_max_f32 v24, v24, v25
 v_sub_f32 v112, v112, v24
 v_sub_f32 v113, v113, v24
 v_sub_f32 v114, v114, v24
 v_sub_f32 v115, v115, v24
 v_sub_f32 v116, v116, v24
 v_sub_f32 v117, v117, v24
 v_sub_f32 v118, v118, v24
 v_sub_f32 v119, v119, v24
 v_sub_f32 v120, v120, v24
 v_sub_f32 v121, v121, v24
 v_exp_f32 v120, v120
 v_exp_f32 v121, v121
 v_exp_f32 v112, v112
 v_exp_f32 v113, v113
 v_exp_f32 v114, v114
 v_exp_f32 v115, v115
 v_exp_f32 v116, v116
 v_exp_f32 v117, v117
 v_exp_f32 v118, v118
 v_exp_f32 v119, v119
 v_cvt_pk_bf16_f32 v216, v120, v121
 v_cvt_pk_bf16_f32 v219, v120, v121
 v_cvt_pk_bf16_f32 v28, v112, v113
 v_cvt_pk_bf16_f32 v29, v116, v117
 v_cvt_pk_bf16_f32 v30, v114, v115
 v_cvt_pk_bf16_f32 v31, v118, v119
 v_mfma_f32_16x16x16_bf16 v[124:127], v[220:221], v[216:217], 0
 v_mfma_f32_16x16x16_bf16 v[64:67], v[194:195], v[216:217], 0
 v_mfma_f32_16x16x16_bf16 v[68:71], v[194:195], v[218:219], 0
 v_mfma_f32_16x16x16_bf16 v[72:75], v[198:199], v[216:217], 0
 v_mfma_f32_16x16x16_bf16 v[76:79], v[198:199], v[218:219], 0
 v_mfma_f32_16x16x16_bf16 v[80:83], v[202:203], v[216:217], 0
 v_mfma_f32_16x16x16_bf16 v[84:87], v[202:203], v[218:219], 0
 v_mfma_f32_16x16x16_bf16 v[88:91], v[206:207], v[216:217], 0
 v_mfma_f32_16x16x16_bf16 v[92:95], v[206:207], v[218:219], 0
 v_mfma_f32_16x16x32_bf16 v[124:127], v[220:223], v[28:31], v[124:127]
 v_mfma_f32_16x16x32_bf16 v[64:67], v[160:163], v[28:31], v[64:67]
 v_mfma_f32_16x16x32_bf16 v[68:71], v[164:167], v[28:31], v[68:71]
 v_mfma_f32_16x16x32_bf16 v[72:75], v[168:171], v[28:31], v[72:75]
 v_mfma_f32_16x16x32_bf16 v[76:79], v[172:175], v[28:31], v[76:79]
 v_mfma_f32_16x16x32_bf16 v[80:83], v[176:179], v[28:31], v[80:83]
 v_mfma_f32_16x16x32_bf16 v[84:87], v[180:183], v[28:31], v[84:87]
 v_mfma_f32_16x16x32_bf16 v[88:91], v[184:187], v[28:31], v[88:91]
 v_mfma_f32_16x16x32_bf16 v[92:95], v[188:191], v[28:31], v[92:95]
 v_rcp_f32 v124, v124
 s_add_u32 s45, s56, 4096
 v_mul_f32 v64, v64, v124
 v_mul_f32 v65, v65, v124
 v_mul_f32 v66, v66, v124
 v_mul_f32 v67, v67, v124
 v_mul_f32 v68, v68, v124
 v_mul_f32 v69, v69, v124
 v_mul_f32 v70, v70, v124
 v_mul_f32 v71, v71, v124
 v_cvt_pk_bf16_f32 v96, v64, v65
 v_cvt_pk_bf16_f32 v97, v68, v69
 v_cvt_pk_bf16_f32 v98, v66, v67
 v_cvt_pk_bf16_f32 v99, v70, v71
 buffer_store_dwordx4 v[96:99], v1, s[20:23], s56 offen offset:0 sc1
 v_mul_f32 v72, v72, v124
 v_mul_f32 v73, v73, v124
 v_mul_f32 v74, v74, v124
 v_mul_f32 v75, v75, v124
 v_mul_f32 v76, v76, v124
 v_mul_f32 v77, v77, v124
 v_mul_f32 v78, v78, v124
 v_mul_f32 v79, v79, v124
 v_cvt_pk_bf16_f32 v100, v72, v73
 v_cvt_pk_bf16_f32 v101, v76, v77
 v_cvt_pk_bf16_f32 v102, v74, v75
 v_cvt_pk_bf16_f32 v103, v78, v79
 buffer_store_dwordx4 v[100:103], v1, s[20:23], s56 offen offset:2048 sc1
 v_mul_f32 v80, v80, v124
 v_mul_f32 v81, v81, v124
 v_mul_f32 v82, v82, v124
 v_mul_f32 v83, v83, v124
 v_mul_f32 v84, v84, v124
 v_mul_f32 v85, v85, v124
 v_mul_f32 v86, v86, v124
 v_mul_f32 v87, v87, v124
 v_cvt_pk_bf16_f32 v104, v80, v81
 v_cvt_pk_bf16_f32 v105, v84, v85
 v_cvt_pk_bf16_f32 v106, v82, v83
 v_cvt_pk_bf16_f32 v107, v86, v87
 buffer_store_dwordx4 v[104:107], v1, s[20:23], s45 offen offset:0 sc1
 v_mul_f32 v88, v88, v124
 v_mul_f32 v89, v89, v124
 v_mul_f32 v90, v90, v124
 v_mul_f32 v91, v91, v124
 v_mul_f32 v92, v92, v124
 v_mul_f32 v93, v93, v124
 v_mul_f32 v94, v94, v124
 v_mul_f32 v95, v95, v124
 v_cvt_pk_bf16_f32 v108, v88, v89
 v_cvt_pk_bf16_f32 v109, v92, v93
 v_cvt_pk_bf16_f32 v110, v90, v91
 v_cvt_pk_bf16_f32 v111, v94, v95
 buffer_store_dwordx4 v[108:111], v1, s[20:23], s45 offen offset:2048 sc1
 v_mfma_f32_16x16x32_bf16 v[64:67], a[0:3], v[48:51], 0
 ds_read_b128 v[32:35], v6 offset:4096
 v_mfma_f32_16x16x32_bf16 v[72:75], a[72:75], v[48:51], 0
 ds_read_b128 v[36:39], v6 offset:6144
 v_mfma_f32_16x16x32_bf16 v[80:83], a[144:147], v[48:51], 0
 s_add_u32 s41, s40, 2
 v_mfma_f32_16x16x32_bf16 v[88:91], a[216:219], v[48:51], 0
 s_add_u32 s45, s42, 2
 s_mul_i32 s46, s41, 36864
 v_mfma_f32_16x16x32_bf16 v[68:71], a[0:3], v[52:55], 0
 s_cmp_lt_u32 s45, s36
 s_cselect_b32 s46, s46, 0
 v_mfma_f32_16x16x32_bf16 v[76:79], a[72:75], v[52:55], 0
 s_lshl_b32 s49, s4, 10
 s_add_u32 s49, s49, s44
 v_mfma_f32_16x16x32_bf16 v[84:87], a[144:147], v[52:55], 0
 s_lshl_b32 s53, s39, 19
 s_add_u32 s53, s53, s61
 v_mfma_f32_16x16x32_bf16 v[92:95], a[216:219], v[52:55], 0
 s_waitcnt lgkmcnt(2)
 v_mfma_f32_16x16x32_bf16 v[64:67], a[4:7], v[56:59], v[64:67]
 ds_read_b128 v[40:43], v7 offset:4096
 v_mfma_f32_16x16x32_bf16 v[72:75], a[76:79], v[56:59], v[72:75]
 ds_read_b128 v[44:47], v7 offset:6144
 v_mfma_f32_16x16x32_bf16 v[80:83], a[148:151], v[56:59], v[80:83]
 s_add_u32 m0, s49, 0
 v_mfma_f32_16x16x32_bf16 v[88:91], a[220:223], v[56:59], v[88:91]
 buffer_load_dwordx4 v10, s[8:11], s46 offen offset:0  lds
 v_mfma_f32_16x16x32_bf16 v[68:71], a[4:7], v[60:63], v[68:71]
 s_add_u32 m0, s49, 3968
 v_mfma_f32_16x16x32_bf16 v[76:79], a[76:79], v[60:63], v[76:79]
 buffer_load_dwordx4 v10, s[8:11], s46 offen offset:128  lds
 v_mfma_f32_16x16x32_bf16 v[84:87], a[148:151], v[60:63], v[84:87]
 s_lshl_b32 s55, s39, 17
 s_add_u32 s55, s55, s62
 v_mfma_f32_16x16x32_bf16 v[92:95], a[220:223], v[60:63], v[92:95]
 s_waitcnt lgkmcnt(2)
 v_mfma_f32_16x16x32_bf16 v[64:67], a[8:11], v[32:35], v[64:67]
 ds_read_b128 v[48:51], v6 offset:8192
 v_mfma_f32_16x16x32_bf16 v[72:75], a[80:83], v[32:35], v[72:75]
 ds_read_b128 v[52:55], v6 offset:10240
 v_mfma_f32_16x16x32_bf16 v[80:83], a[152:155], v[32:35], v[80:83]
 s_add_u32 m0, s49, 7936
 v_mfma_f32_16x16x32_bf16 v[88:91], a[224:227], v[32:35], v[88:91]
 buffer_load_dwordx4 v10, s[8:11], s46 offen offset:256  lds
 v_mfma_f32_16x16x32_bf16 v[68:71], a[8:11], v[36:39], v[68:71]
 s_add_u32 m0, s49, 11904
 v_mfma_f32_16x16x32_bf16 v[76:79], a[80:83], v[36:39], v[76:79]
 buffer_load_dwordx4 v10, s[8:11], s46 offen offset:384  lds
 v_mfma_f32_16x16x32_bf16 v[84:87], a[152:155], v[36:39], v[84:87]
 v_mfma_f32_16x16x32_bf16 v[92:95], a[224:227], v[36:39], v[92:95]
 s_waitcnt lgkmcnt(2)
 v_mfma_f32_16x16x32_bf16 v[64:67], a[12:15], v[40:43], v[64:67]
 ds_read_b128 v[56:59], v7 offset:8192
 v_mfma_f32_16x16x32_bf16 v[72:75], a[84:87], v[40:43], v[72:75]
 ds_read_b128 v[60:63], v7 offset:10240
 v_mfma_f32_16x16x32_bf16 v[80:83], a[156:159], v[40:43], v[80:83]
 s_add_u32 m0, s49, 15872
 v_mfma_f32_16x16x32_bf16 v[88:91], a[228:231], v[40:43], v[88:91]
 buffer_load_dwordx4 v10, s[8:11], s46 offen offset:512  lds
 v_mfma_f32_16x16x32_bf16 v[68:71], a[12:15], v[44:47], v[68:71]
 s_add_u32 m0, s49, 19840
 v_mfma_f32_16x16x32_bf16 v[76:79], a[84:87], v[44:47], v[76:79]
 buffer_load_dwordx4 v10, s[8:11], s46 offen offset:640  lds
 v_mfma_f32_16x16x32_bf16 v[84:87], a[156:159], v[44:47], v[84:87]
 s_add_u32 s60, s39, 1
 v_mfma_f32_16x16x32_bf16 v[92:95], a[228:231], v[44:47], v[92:95]
 s_waitcnt lgkmcnt(2)
 v_mfma_f32_16x16x32_bf16 v[64:67], a[16:19], v[48:51], v[64:67]
 ds_read_b128 v[32:35], v6 offset:12288
 v_mfma_f32_16x16x32_bf16 v[72:75], a[88:91], v[48:51], v[72:75]
 ds_read_b128 v[36:39], v6 offset:14336
 v_mfma_f32_16x16x32_bf16 v[80:83], a[160:163], v[48:51], v[80:83]
 s_add_u32 m0, s49, 23808
 v_mfma_f32_16x16x32_bf16 v[88:91], a[232:235], v[48:51], v[88:91]
 buffer_load_dwordx4 v10, s[8:11], s46 offen offset:768  lds
 v_mfma_f32_16x16x32_bf16 v[68:71], a[16:19], v[52:55], v[68:71]
 s_add_u32 m0, s49, 27776
 v_mfma_f32_16x16x32_bf16 v[76:79], a[88:91], v[52:55], v[76:79]
 buffer_load_dwordx4 v10, s[8:11], s46 offen offset:896  lds
 v_mfma_f32_16x16x32_bf16 v[84:87], a[160:163], v[52:55], v[84:87]
 v_mfma_f32_16x16x32_bf16 v[92:95], a[232:235], v[52:55], v[92:95]
 s_waitcnt lgkmcnt(2)
 v_mfma_f32_16x16x32_bf16 v[64:67], a[20:23], v[56:59], v[64:67]
 ds_read_b128 v[40:43], v7 offset:12288
 v_mfma_f32_16x16x32_bf16 v[72:75], a[92:95], v[56:59], v[72:75]
 ds_read_b128 v[44:47], v7 offset:14336
 v_mfma_f32_16x16x32_bf16 v[80:83], a[164:167], v[56:59], v[80:83]
 s_add_u32 m0, s49, 31744
 v_mfma_f32_16x16x32_bf16 v[88:91], a[236:239], v[56:59], v[88:91]
 buffer_load_dwordx4 v10, s[8:11], s46 offen offset:1024  lds
 v_mfma_f32_16x16x32_bf16 v[68:71], a[20:23], v[60:63], v[68:71]
 v_mfma_f32_16x16x32_bf16 v[76:79], a[92:95], v[60:63], v[76:79]
 v_mfma_f32_16x16x32_bf16 v[84:87], a[164:167], v[60:63], v[84:87]
 v_mfma_f32_16x16x32_bf16 v[92:95], a[236:239], v[60:63], v[92:95]
 s_waitcnt lgkmcnt(2)
 v_mfma_f32_16x16x32_bf16 v[64:67], a[24:27], v[32:35], v[64:67]
 ds_read_b128 v[48:51], v6 offset:16384
 v_mfma_f32_16x16x32_bf16 v[72:75], a[96:99], v[32:35], v[72:75]
 ds_read_b128 v[52:55], v6 offset:18432
 v_mfma_f32_16x16x32_bf16 v[80:83], a[168:171], v[32:35], v[80:83]
 s_waitcnt vmcnt(9)
 buffer_load_dword v17, v11, s[20:23], s56 offen sc1
 v_mfma_f32_16x16x32_bf16 v[88:91], a[240:243], v[32:35], v[88:91]
 s_barrier
 buffer_store_dword v14, v8, s[20:23], s59 offen sc1
 v_mfma_f32_16x16x32_bf16 v[68:71], a[24:27], v[36:39], v[68:71]
 buffer_load_dword v16, v15, s[20:23], s57 offen sc1
 v_mfma_f32_16x16x32_bf16 v[76:79], a[96:99], v[36:39], v[76:79]
 v_mfma_f32_16x16x32_bf16 v[84:87], a[168:171], v[36:39], v[84:87]
 s_lshl_b32 s56, s39, 18
 s_add_u32 s56, s56, s63
 v_mfma_f32_16x16x32_bf16 v[92:95], a[240:243], v[36:39], v[92:95]
 s_waitcnt lgkmcnt(2)
 v_mfma_f32_16x16x32_bf16 v[64:67], a[28:31], v[40:43], v[64:67]
 ds_read_b128 v[56:59], v7 offset:16384
 v_mfma_f32_16x16x32_bf16 v[72:75], a[100:103], v[40:43], v[72:75]
 ds_read_b128 v[60:63], v7 offset:18432
 v_mfma_f32_16x16x32_bf16 v[80:83], a[172:175], v[40:43], v[80:83]
 buffer_load_dwordx4 v[128:131], v1, s[20:23], s53 offen offset:0 sc1
 v_mfma_f32_16x16x32_bf16 v[88:91], a[244:247], v[40:43], v[88:91]
 v_mfma_f32_16x16x32_bf16 v[68:71], a[28:31], v[44:47], v[68:71]
 buffer_load_dwordx4 v[132:135], v1, s[20:23], s53 offen offset:1024 sc1
 v_mfma_f32_16x16x32_bf16 v[76:79], a[100:103], v[44:47], v[76:79]
 v_mfma_f32_16x16x32_bf16 v[84:87], a[172:175], v[44:47], v[84:87]
 v_mfma_f32_16x16x32_bf16 v[92:95], a[244:247], v[44:47], v[92:95]
 s_waitcnt lgkmcnt(2)
 v_mfma_f32_16x16x32_bf16 v[64:67], a[32:35], v[48:51], v[64:67]
 ds_read_b128 v[32:35], v6 offset:20480
 v_mfma_f32_16x16x32_bf16 v[72:75], a[104:107], v[48:51], v[72:75]
 ds_read_b128 v[36:39], v6 offset:22528
 v_mfma_f32_16x16x32_bf16 v[80:83], a[176:179], v[48:51], v[80:83]
 buffer_load_dwordx4 v[136:139], v1, s[20:23], s53 offen offset:2048 sc1
 v_mfma_f32_16x16x32_bf16 v[88:91], a[248:251], v[48:51], v[88:91]
 v_mfma_f32_16x16x32_bf16 v[68:71], a[32:35], v[52:55], v[68:71]
 buffer_load_dwordx4 v[140:143], v1, s[20:23], s53 offen offset:3072 sc1
 v_mfma_f32_16x16x32_bf16 v[76:79], a[104:107], v[52:55], v[76:79]
 v_mfma_f32_16x16x32_bf16 v[84:87], a[176:179], v[52:55], v[84:87]
 s_add_u32 s53, s53, 4096
 v_mfma_f32_16x16x32_bf16 v[92:95], a[248:251], v[52:55], v[92:95]
 s_waitcnt lgkmcnt(2)
 v_mfma_f32_16x16x32_bf16 v[64:67], a[36:39], v[56:59], v[64:67]
 ds_read_b128 v[40:43], v7 offset:20480
 v_mfma_f32_16x16x32_bf16 v[72:75], a[108:111], v[56:59], v[72:75]
 ds_read_b128 v[44:47], v7 offset:22528
 v_mfma_f32_16x16x32_bf16 v[80:83], a[180:183], v[56:59], v[80:83]
 buffer_load_dwordx4 v[144:147], v1, s[20:23], s53 offen offset:0 sc1
 v_mfma_f32_16x16x32_bf16 v[88:91], a[252:255], v[56:59], v[88:91]
 v_mfma_f32_16x16x32_bf16 v[68:71], a[36:39], v[60:63], v[68:71]
 buffer_load_dwordx4 v[148:151], v1, s[20:23], s53 offen offset:1024 sc1
 v_mfma_f32_16x16x32_bf16 v[76:79], a[108:111], v[60:63], v[76:79]
 v_mfma_f32_16x16x32_bf16 v[84:87], a[180:183], v[60:63], v[84:87]
 v_mfma_f32_16x16x32_bf16 v[92:95], a[252:255], v[60:63], v[92:95]
 s_waitcnt lgkmcnt(2)
 v_mfma_f32_16x16x32_bf16 v[64:67], a[40:43], v[32:35], v[64:67]
 ds_read_b128 v[48:51], v6 offset:24576
 v_mfma_f32_16x16x32_bf16 v[72:75], a[112:115], v[32:35], v[72:75]
 ds_read_b128 v[52:55], v6 offset:26624
 v_mfma_f32_16x16x32_bf16 v[80:83], a[184:187], v[32:35], v[80:83]
 buffer_load_dwordx4 v[152:155], v1, s[20:23], s53 offen offset:2048 sc1
 v_mfma_f32_16x16x32_bf16 v[88:91], v[224:227], v[32:35], v[88:91]
 v_mfma_f32_16x16x32_bf16 v[68:71], a[40:43], v[36:39], v[68:71]
 buffer_load_dwordx4 v[156:159], v1, s[20:23], s53 offen offset:3072 sc1
 v_mfma_f32_16x16x32_bf16 v[76:79], a[112:115], v[36:39], v[76:79]
 v_mfma_f32_16x16x32_bf16 v[84:87], a[184:187], v[36:39], v[84:87]
 s_add_u32 s53, s53, 4096
 v_mfma_f32_16x16x32_bf16 v[92:95], v[224:227], v[36:39], v[92:95]
 s_waitcnt lgkmcnt(2)
 v_mfma_f32_16x16x32_bf16 v[64:67], a[44:47], v[40:43], v[64:67]
 ds_read_b128 v[56:59], v7 offset:24576
 v_mfma_f32_16x16x32_bf16 v[72:75], a[116:119], v[40:43], v[72:75]
 ds_read_b128 v[60:63], v7 offset:26624
 v_mfma_f32_16x16x32_bf16 v[80:83], a[188:191], v[40:43], v[80:83]
 buffer_load_dwordx4 v[160:163], v1, s[20:23], s53 offen offset:0 sc1
 v_mfma_f32_16x16x32_bf16 v[88:91], v[228:231], v[40:43], v[88:91]
 v_mfma_f32_16x16x32_bf16 v[68:71], a[44:47], v[44:47], v[68:71]
 buffer_load_dwordx4 v[164:167], v1, s[20:23], s53 offen offset:1024 sc1
 v_mfma_f32_16x16x32_bf16 v[76:79], a[116:119], v[44:47], v[76:79]
 v_mfma_f32_16x16x32_bf16 v[84:87], a[188:191], v[44:47], v[84:87]
 v_mfma_f32_16x16x32_bf16 v[92:95], v[228:231], v[44:47], v[92:95]
 s_waitcnt lgkmcnt(2)
 v_mfma_f32_16x16x32_bf16 v[64:67], a[48:51], v[48:51], v[64:67]
 ds_read_b128 v[32:35], v6 offset:28672
 v_mfma_f32_16x16x32_bf16 v[72:75], a[120:123], v[48:51], v[72:75]
 ds_read_b128 v[36:39], v6 offset:30720
 v_mfma_f32_16x16x32_bf16 v[80:83], a[192:195], v[48:51], v[80:83]
 buffer_load_dwordx4 v[168:171], v1, s[20:23], s53 offen offset:2048 sc1
 v_mfma_f32_16x16x32_bf16 v[88:91], v[232:235], v[48:51], v[88:91]
 v_mfma_f32_16x16x32_bf16 v[68:71], a[48:51], v[52:55], v[68:71]
 buffer_load_dwordx4 v[172:175], v1, s[20:23], s53 offen offset:3072 sc1
 v_mfma_f32_16x16x32_bf16 v[76:79], a[120:123], v[52:55], v[76:79]
 v_mfma_f32_16x16x32_bf16 v[84:87], a[192:195], v[52:55], v[84:87]
 s_add_u32 s53, s53, 4096
 v_mfma_f32_16x16x32_bf16 v[92:95], v[232:235], v[52:55], v[92:95]
 s_waitcnt lgkmcnt(2)
 v_mfma_f32_16x16x32_bf16 v[64:67], a[52:55], v[56:59], v[64:67]
 ds_read_b128 v[40:43], v7 offset:28672
 v_mfma_f32_16x16x32_bf16 v[72:75], a[124:127], v[56:59], v[72:75]
 ds_read_b128 v[44:47], v7 offset:30720
 v_mfma_f32_16x16x32_bf16 v[80:83], a[196:199], v[56:59], v[80:83]
 s_add_u32 s43, s43, 36864
 s_cmp_eq_u32 s43, 147456
 buffer_load_dwordx4 v[176:179], v1, s[20:23], s53 offen offset:0 sc1
 v_mfma_f32_16x16x32_bf16 v[88:91], v[236:239], v[56:59], v[88:91]
 s_cselect_b32 s43, 0, s43
 s_add_u32 s44, s44, 36864
 v_mfma_f32_16x16x32_bf16 v[68:71], a[52:55], v[60:63], v[68:71]
 s_cmp_eq_u32 s44, 147456
 s_cselect_b32 s44, 0, s44
 buffer_load_dwordx4 v[180:183], v1, s[20:23], s53 offen offset:1024 sc1
 v_mfma_f32_16x16x32_bf16 v[76:79], a[124:127], v[60:63], v[76:79]
 v_mfma_f32_16x16x32_bf16 v[84:87], a[196:199], v[60:63], v[84:87]
 v_mfma_f32_16x16x32_bf16 v[92:95], v[236:239], v[60:63], v[92:95]
 s_waitcnt lgkmcnt(2)
 v_mfma_f32_16x16x32_bf16 v[64:67], a[56:59], v[32:35], v[64:67]
 ds_read_b128 v[48:51], v6 offset:32768
 v_mfma_f32_16x16x32_bf16 v[72:75], a[128:131], v[32:35], v[72:75]
 ds_read_b128 v[52:55], v6 offset:34816
 v_mfma_f32_16x16x32_bf16 v[80:83], a[200:203], v[32:35], v[80:83]
 v_add_u32 v6, s43, v4
 buffer_load_dwordx4 v[184:187], v1, s[20:23], s53 offen offset:2048 sc1
 v_mfma_f32_16x16x32_bf16 v[88:91], v[240:243], v[32:35], v[88:91]
 v_mfma_f32_16x16x32_bf16 v[68:71], a[56:59], v[36:39], v[68:71]
 buffer_load_dwordx4 v[188:191], v1, s[20:23], s53 offen offset:3072 sc1
 v_mfma_f32_16x16x32_bf16 v[76:79], a[128:131], v[36:39], v[76:79]
 v_mfma_f32_16x16x32_bf16 v[84:87], a[200:203], v[36:39], v[84:87]
 v_mfma_f32_16x16x32_bf16 v[92:95], v[240:243], v[36:39], v[92:95]
 s_waitcnt lgkmcnt(2)
 v_mfma_f32_16x16x32_bf16 v[64:67], a[60:63], v[40:43], v[64:67]
 ds_read_b128 v[56:59], v7 offset:32768
 v_mfma_f32_16x16x32_bf16 v[72:75], a[132:135], v[40:43], v[72:75]
 ds_read_b128 v[60:63], v7 offset:34816
 v_mfma_f32_16x16x32_bf16 v[80:83], a[204:207], v[40:43], v[80:83]
 v_add_u32 v7, s43, v5
 v_mfma_f32_16x16x32_bf16 v[88:91], v[244:247], v[40:43], v[88:91]
 v_mfma_f32_16x16x32_bf16 v[68:71], a[60:63], v[44:47], v[68:71]
 v_mfma_f32_16x16x32_bf16 v[76:79], a[132:135], v[44:47], v[76:79]
 v_mfma_f32_16x16x32_bf16 v[84:87], a[204:207], v[44:47], v[84:87]
 v_mfma_f32_16x16x32_bf16 v[92:95], v[244:247], v[44:47], v[92:95]
 s_waitcnt lgkmcnt(2)
 v_mfma_f32_16x16x32_bf16 v[64:67], a[64:67], v[48:51], v[64:67]
 s_waitcnt vmcnt(28)
 s_barrier
 ds_read_b128 v[32:35], v6 offset:0
 v_mfma_f32_16x16x32_bf16 v[72:75], a[136:139], v[48:51], v[72:75]
 ds_read_b128 v[36:39], v6 offset:2048
 v_mfma_f32_16x16x32_bf16 v[80:83], a[208:211], v[48:51], v[80:83]
 v_mfma_f32_16x16x32_bf16 v[88:91], v[248:251], v[48:51], v[88:91]
 s_waitcnt vmcnt(16)
 v_cmp_le_u32 vcc, s60, v16
 v_mfma_f32_16x16x32_bf16 v[68:71], a[64:67], v[52:55], v[68:71]
 v_mfma_f32_16x16x32_bf16 v[76:79], a[136:139], v[52:55], v[76:79]
 s_and_b32 s64, vcc_lo, 1
 s_cbranch_scc0 Lqsk_41
 buffer_load_dwordx4 v[192:195], v1, s[20:23], s55 offen offset:0 sc1
 buffer_load_dwordx4 v[196:199], v1, s[20:23], s55 offen offset:1024 sc1
 buffer_load_dwordx4 v[200:203], v1, s[20:23], s55 offen offset:2048 sc1
 buffer_load_dwordx4 v[204:207], v1, s[20:23], s55 offen offset:3072 sc1
Lqsk_41:
 v_mfma_f32_16x16x32_bf16 v[84:87], a[208:211], v[52:55], v[84:87]
 v_mfma_f32_16x16x32_bf16 v[92:95], v[248:251], v[52:55], v[92:95]
 s_waitcnt lgkmcnt(2)
 v_mfma_f32_16x16x32_bf16 v[64:67], a[68:71], v[56:59], v[64:67]
 ds_read_b128 v[40:43], v7 offset:0
 v_mfma_f32_16x16x32_bf16 v[72:75], a[140:143], v[56:59], v[72:75]
 ds_read_b128 v[44:47], v7 offset:2048
 v_mfma_f32_16x16x32_bf16 v[80:83], a[212:215], v[56:59], v[80:83]
 v_mfma_f32_16x16x32_bf16 v[88:91], v[252:255], v[56:59], v[88:91]
 s_mov_b32 s39, s40
 s_mov_b32 s40, s41
 v_mfma_f32_16x16x32_bf16 v[68:71], a[68:71], v[60:63], v[68:71]
 s_add_u32 s42, s42, 1
 v_mov_b32 v14, s42
 v_mfma_f32_16x16x32_bf16 v[76:79], a[140:143], v[60:63], v[76:79]
 v_mfma_f32_16x16x32_bf16 v[84:87], a[212:215], v[60:63], v[84:87]
 v_mfma_f32_16x16x32_bf16 v[92:95], v[252:255], v[60:63], v[92:95]
 s_waitcnt lgkmcnt(2)
 s_nop 7
 v_cvt_pk_bf16_f32 v16, v64, v72
 v_cvt_pk_bf16_f32 v17, v65, v73
 v_cvt_pk_bf16_f32 v18, v66, v74
 v_cvt_pk_bf16_f32 v19, v67, v75
 ds_write_b128 v2, v[16:19] offset:0
 v_cvt_pk_bf16_f32 v20, v68, v76
 v_cvt_pk_bf16_f32 v21, v69, v77
 v_cvt_pk_bf16_f32 v22, v70, v78
 v_cvt_pk_bf16_f32 v23, v71, v79
 ds_write_b128 v2, v[20:23] offset:1024
 v_cvt_pk_bf16_f32 v24, v80, v88
 v_cvt_pk_bf16_f32 v25, v81, v89
 v_cvt_pk_bf16_f32 v26, v82, v90
 v_cvt_pk_bf16_f32 v27, v83, v91
 ds_write_b128 v2, v[24:27] offset:8192
 v_cvt_pk_bf16_f32 v28, v84, v92
 v_cvt_pk_bf16_f32 v29, v85, v93
 v_cvt_pk_bf16_f32 v30, v86, v94
 v_cvt_pk_bf16_f32 v31, v87, v95
 ds_write_b128 v2, v[28:31] offset:9216
 v_mov_b64 v[120:121], 0
 v_mov_b64 v[122:123], 0
 s_waitcnt lgkmcnt(0)
 s_barrier
 ds_read_b128 v[96:99], v3 offset:0
 ds_read_b128 v[100:103], v3 offset:2048
 ds_read_b128 v[104:107], v3 offset:4096
 ds_read_b128 v[108:111], v3 offset:6144
 s_cmp_lg_u32 s64, 0
 s_cbranch_scc1 Lqpre_42
Lqs_43:
 buffer_load_dword v16, v15, s[20:23], s57 offen sc1
 s_waitcnt vmcnt(0)
 v_cmp_le_u32 vcc, s60, v16
 s_cbranch_vccnz Lqsk_44
 s_sleep 2
 s_sub_u32 s58, s58, 1
 s_cbranch_scc0 Lqs_43
 s_endpgm
Lqsk_44:
 buffer_load_dwordx4 v[192:195], v1, s[20:23], s55 offen offset:0 sc1
 buffer_load_dwordx4 v[196:199], v1, s[20:23], s55 offen offset:1024 sc1
 buffer_load_dwordx4 v[200:203], v1, s[20:23], s55 offen offset:2048 sc1
 buffer_load_dwordx4 v[204:207], v1, s[20:23], s55 offen offset:3072 sc1
Lqpre_42:
 s_waitcnt vmcnt(4) lgkmcnt(0)
 v_mfma_f32_16x16x32_bf16 v[112:115], v[128:131], v[96:99], v[208:211]
 v_mfma_f32_16x16x32_bf16 v[116:119], v[132:135], v[96:99], v[212:215]
 v_mfma_f32_16x16x32_bf16 v[112:115], v[136:139], v[100:103], v[112:115]
 v_mfma_f32_16x16x32_bf16 v[116:119], v[140:143], v[100:103], v[116:119]
 v_mfma_f32_16x16x32_bf16 v[112:115], v[144:147], v[104:107], v[112:115]
 v_mfma_f32_16x16x32_bf16 v[116:119], v[148:151], v[104:107], v[116:119]
 v_mfma_f32_16x16x32_bf16 v[112:115], v[152:155], v[108:111], v[112:115]
 v_mfma_f32_16x16x32_bf16 v[116:119], v[156:159], v[108:111], v[116:119]
 s_nop 7
 v_max3_f32 v24, v112, v113, v114
 v_max3_f32 v24, v24, v115, v116
 v_max3_f32 v24, v24, v117, v118
 v_max_f32 v24, v24, v119
 s_waitcnt vmcnt(2)
 v_mov_b64 v[16:17], v[192:193]
 v_mov_b64 v[18:19], v[196:197]
 s_nop 1
 v_smfmac_f32_16x16x64_bf16 v[120:123], v[16:19], v[96:103], v12
 s_waitcnt vmcnt(0)
 v_mov_b64 v[20:21], v[200:201]
 v_mov_b64 v[22:23], v[204:205]
 s_nop 1
 v_smfmac_f32_16x16x64_bf16 v[120:123], v[20:23], v[104:111], v12
 s_nop 7
 v_add_f32 v120, v120, v122
 v_add_f32 v121, v121, v123
 v_mul_f32 v120, s50, v120
 v_mul_f32 v121, s50, v121
 v_max3_f32 v24, v24, v120, v121
 v_mov_b32 v25, v24
 s_nop 1
 v_permlane16_swap_b32 v24, v25
 v_max_f32 v24, v24, v25
 v_mov_b32 v25, v24
 s_nop 1
 v_permlane32_swap_b32 v24, v25
 v_max_f32 v24, v24, v25
 v_sub_f32 v112, v112, v24
 v_sub_f32 v113, v113, v24
 v_sub_f32 v114, v114, v24
 v_sub_f32 v115, v115, v24
 v_sub_f32 v116, v116, v24
 v_sub_f32 v117, v117, v24
 v_sub_f32 v118, v118, v24
 v_sub_f32 v119, v119, v24
 v_sub_f32 v120, v120, v24
 v_sub_f32 v121, v121, v24
 v_exp_f32 v120, v120
 v_exp_f32 v121, v121
 v_exp_f32 v112, v112
 v_exp_f32 v113, v113
 v_exp_f32 v114, v114
 v_exp_f32 v115, v115
 v_exp_f32 v116, v116
 v_exp_f32 v117, v117
 v_exp_f32 v118, v118
 v_exp_f32 v119, v119
 v_cvt_pk_bf16_f32 v216, v120, v121
 v_cvt_pk_bf16_f32 v219, v120, v121
 v_cvt_pk_bf16_f32 v28, v112, v113
 v_cvt_pk_bf16_f32 v29, v116, v117
 v_cvt_pk_bf16_f32 v30, v114, v115
 v_cvt_pk_bf16_f32 v31, v118, v119
 v_mfma_f32_16x16x16_bf16 v[124:127], v[220:221], v[216:217], 0
 v_mfma_f32_16x16x16_bf16 v[64:67], v[194:195], v[216:217], 0
 v_mfma_f32_16x16x16_bf16 v[68:71], v[194:195], v[218:219], 0
 v_mfma_f32_16x16x16_bf16 v[72:75], v[198:199], v[216:217], 0
 v_mfma_f32_16x16x16_bf16 v[76:79], v[198:199], v[218:219], 0
 v_mfma_f32_16x16x16_bf16 v[80:83], v[202:203], v[216:217], 0
 v_mfma_f32_16x16x16_bf16 v[84:87], v[202:203], v[218:219], 0
 v_mfma_f32_16x16x16_bf16 v[88:91], v[206:207], v[216:217], 0
 v_mfma_f32_16x16x16_bf16 v[92:95], v[206:207], v[218:219], 0
 v_mfma_f32_16x16x32_bf16 v[124:127], v[220:223], v[28:31], v[124:127]
 v_mfma_f32_16x16x32_bf16 v[64:67], v[160:163], v[28:31], v[64:67]
 v_mfma_f32_16x16x32_bf16 v[68:71], v[164:167], v[28:31], v[68:71]
 v_mfma_f32_16x16x32_bf16 v[72:75], v[168:171], v[28:31], v[72:75]
 v_mfma_f32_16x16x32_bf16 v[76:79], v[172:175], v[28:31], v[76:79]
 v_mfma_f32_16x16x32_bf16 v[80:83], v[176:179], v[28:31], v[80:83]
 v_mfma_f32_16x16x32_bf16 v[84:87], v[180:183], v[28:31], v[84:87]
 v_mfma_f32_16x16x32_bf16 v[88:91], v[184:187], v[28:31], v[88:91]
 v_mfma_f32_16x16x32_bf16 v[92:95], v[188:191], v[28:31], v[92:95]
 v_rcp_f32 v124, v124
 s_add_u32 s45, s56, 4096
 v_mul_f32 v64, v64, v124
 v_mul_f32 v65, v65, v124
 v_mul_f32 v66, v66, v124
 v_mul_f32 v67, v67, v124
 v_mul_f32 v68, v68, v124
 v_mul_f32 v69, v69, v124
 v_mul_f32 v70, v70, v124
 v_mul_f32 v71, v71, v124
 v_cvt_pk_bf16_f32 v96, v64, v65
 v_cvt_pk_bf16_f32 v97, v68, v69
 v_cvt_pk_bf16_f32 v98, v66, v67
 v_cvt_pk_bf16_f32 v99, v70, v71
 buffer_store_dwordx4 v[96:99], v1, s[20:23], s56 offen offset:0 sc1
 v_mul_f32 v72, v72, v124
 v_mul_f32 v73, v73, v124
 v_mul_f32 v74, v74, v124
 v_mul_f32 v75, v75, v124
 v_mul_f32 v76, v76, v124
 v_mul_f32 v77, v77, v124
 v_mul_f32 v78, v78, v124
 v_mul_f32 v79, v79, v124
 v_cvt_pk_bf16_f32 v100, v72, v73
 v_cvt_pk_bf16_f32 v101, v76, v77
 v_cvt_pk_bf16_f32 v102, v74, v75
 v_cvt_pk_bf16_f32 v103, v78, v79
 buffer_store_dwordx4 v[100:103], v1, s[20:23], s56 offen offset:2048 sc1
 v_mul_f32 v80, v80, v124
 v_mul_f32 v81, v81, v124
 v_mul_f32 v82, v82, v124
 v_mul_f32 v83, v83, v124
 v_mul_f32 v84, v84, v124
 v_mul_f32 v85, v85, v124
 v_mul_f32 v86, v86, v124
 v_mul_f32 v87, v87, v124
 v_cvt_pk_bf16_f32 v104, v80, v81
 v_cvt_pk_bf16_f32 v105, v84, v85
 v_cvt_pk_bf16_f32 v106, v82, v83
 v_cvt_pk_bf16_f32 v107, v86, v87
 buffer_store_dwordx4 v[104:107], v1, s[20:23], s45 offen offset:0 sc1
 v_mul_f32 v88, v88, v124
 v_mul_f32 v89, v89, v124
 v_mul_f32 v90, v90, v124
 v_mul_f32 v91, v91, v124
 v_mul_f32 v92, v92, v124
 v_mul_f32 v93, v93, v124
 v_mul_f32 v94, v94, v124
 v_mul_f32 v95, v95, v124
 v_cvt_pk_bf16_f32 v108, v88, v89
 v_cvt_pk_bf16_f32 v109, v92, v93
 v_cvt_pk_bf16_f32 v110, v90, v91
 v_cvt_pk_bf16_f32 v111, v94, v95
 buffer_store_dwordx4 v[108:111], v1, s[20:23], s45 offen offset:2048 sc1
 s_cmp_lt_u32 s42, s36
 s_cbranch_scc1 Lqb_loop_36
 s_waitcnt vmcnt(0)
 buffer_load_dword v17, v11, s[20:23], s56 offen sc1
 s_barrier
 buffer_store_dword v14, v8, s[20:23], s59 offen sc1
 s_branch Lfin
Lob:
 s_load_dwordx2 s[8:9], s[0:1], 88
 s_mov_b32 s10, 0x480000
 s_mov_b32 s11, 0x20000
 s_sub_u32 s32, s6, 16
 s_mul_i32 s7, s3, 5
 s_add_u32 s7, s7, s6
 s_sub_u32 s7, s7, 25
 s_cmp_lt_u32 s6, 25
 s_cselect_b32 s32, s32, s7
 s_cselect_b32 s33, s3, 4
 s_cselect_b32 s34, 2, 1
 s_cselect_b32 s39, 6, 4
 s_cselect_b32 s35, 22, 20
 s_cselect_b32 s40, 0, 4
 s_mov_b32 s36, 0x7000000
 s_mov_b32 s37, 1152
 s_lshl_b32 s7, s4, 7
 s_add_u32 s38, s7, 0x3800
 s_mov_b32 s93, 1
 s_mov_b32 s92, 3
 s_mov_b32 s91, 9
 s_mov_b32 s90, 1
Los:
 s_load_dwordx2 s[24:25], s[0:1], 104
 s_mov_b32 s26, 0x480000
 s_mov_b32 s27, 0x20000
 s_waitcnt lgkmcnt(0)
 v_and_b32 v15, 63, v0
 v_lshlrev_b32 v1, 4, v15
 v_and_b32 v3, s92, v15
 v_lshlrev_b32 v3, 2, v3
 v_lshrrev_b32 v14, 4, v15
 v_min_u32 v14, 1, v14
 v_lshl_or_b32 v3, v14, 28, v3
 s_add_u32 s44, s32, s40
 s_and_b32 s44, s44, 7
 s_mov_b32 s50, 0x40000
 s_mul_i32 s49, s4, 40960
 v_add_u32 v5, s49, v1
 v_bfe_u32 v14, v15, 5, 1
 v_bfe_u32 v16, v15, 3, 1
 v_lshl_add_u32 v14, v14, 1, v16
 v_bfe_u32 v16, v15, 4, 1
 v_lshl_add_u32 v14, v16, 6, v14
 v_mul_u32_u24 v14, 1152, v14
 v_bfe_u32 v17, v15, 1, 2
 v_xor_b32 v17, v17, v16
 v_lshlrev_b32 v17, 5, v17
 v_and_b32 v16, 1, v15
 v_lshl_add_u32 v17, v16, 4, v17
 v_add_u32 v8, v14, v17
 v_xor_b32 v17, 64, v17
 v_add_u32 v9, v14, v17
 v_lshrrev_b32 v14, 4, v15
 v_bfe_u32 v16, v15, 2, 2
 v_lshl_add_u32 v14, v14, 3, v16
 v_lshlrev_b32 v14, 7, v14
 v_bfe_u32 v16, v15, 3, 2
 v_lshl_add_u32 v14, v16, 5, v14
 v_and_b32 v16, 3, v15
 v_lshl_add_u32 v14, v16, 3, v14
 v_xor_b32 v16, 0, v14
 v_add_u32 v10, s49, v16
 v_xor_b32 v16, 32, v14
 v_add_u32 v11, s49, v16
 v_xor_b32 v16, 64, v14
 v_add_u32 v12, s49, v16
 v_xor_b32 v16, 96, v14
 v_add_u32 v13, s49, v16
 s_lshl_b32 s47, s32, 7
 s_add_u32 s46, s44, 0
 s_and_b32 s46, s46, 7
 s_lshl_b32 s45, s4, 3
 s_add_u32 s46, s46, s45
 s_mul_i32 s46, s46, 147456
 s_add_u32 s46, s46, s47
 s_add_u32 m0, s49, 8192
 s_add_u32 s45, s46, 0
 buffer_load_dwordx4 v8, s[8:11], s45 offen  lds
 s_add_u32 m0, s49, 9216
 s_add_u32 s45, s46, 4608
 buffer_load_dwordx4 v9, s[8:11], s45 offen  lds
 s_add_u32 m0, s49, 10240
 s_add_u32 s45, s46, 9216
 buffer_load_dwordx4 v8, s[8:11], s45 offen  lds
 s_add_u32 m0, s49, 11264
 s_add_u32 s45, s46, 13824
 buffer_load_dwordx4 v9, s[8:11], s45 offen  lds
 s_add_u32 m0, s49, 12288
 s_add_u32 s45, s46, 18432
 buffer_load_dwordx4 v8, s[8:11], s45 offen  lds
 s_add_u32 m0, s49, 13312
 s_add_u32 s45, s46, 23040
 buffer_load_dwordx4 v9, s[8:11], s45 offen  lds
 s_add_u32 m0, s49, 14336
 s_add_u32 s45, s46, 27648
 buffer_load_dwordx4 v8, s[8:11], s45 offen  lds
 s_add_u32 m0, s49, 15360
 s_add_u32 s45, s46, 32256
 buffer_load_dwordx4 v9, s[8:11], s45 offen  lds
 s_add_u32 m0, s49, 16384
 s_add_u32 s45, s46, 36864
 buffer_load_dwordx4 v8, s[8:11], s45 offen  lds
 s_add_u32 m0, s49, 17408
 s_add_u32 s45, s46, 41472
 buffer_load_dwordx4 v9, s[8:11], s45 offen  lds
 s_add_u32 m0, s49, 18432
 s_add_u32 s45, s46, 46080
 buffer_load_dwordx4 v8, s[8:11], s45 offen  lds
 s_add_u32 m0, s49, 19456
 s_add_u32 s45, s46, 50688
 buffer_load_dwordx4 v9, s[8:11], s45 offen  lds
 s_add_u32 m0, s49, 20480
 s_add_u32 s45, s46, 55296
 buffer_load_dwordx4 v8, s[8:11], s45 offen  lds
 s_add_u32 m0, s49, 21504
 s_add_u32 s45, s46, 59904
 buffer_load_dwordx4 v9, s[8:11], s45 offen  lds
 s_add_u32 m0, s49, 22528
 s_add_u32 s45, s46, 64512
 buffer_load_dwordx4 v8, s[8:11], s45 offen  lds
 s_add_u32 m0, s49, 23552
 s_add_u32 s45, s46, 69120
 buffer_load_dwordx4 v9, s[8:11], s45 offen  lds
 s_add_u32 s46, s44, 1
 s_and_b32 s46, s46, 7
 s_lshl_b32 s45, s4, 3
 s_add_u32 s46, s46, s45
 s_mul_i32 s46, s46, 147456
 s_add_u32 s46, s46, s47
 s_add_u32 m0, s49, 24576
 s_add_u32 s45, s46, 0
 buffer_load_dwordx4 v8, s[8:11], s45 offen  lds
 s_add_u32 m0, s49, 25600
 s_add_u32 s45, s46, 4608
 buffer_load_dwordx4 v9, s[8:11], s45 offen  lds
 s_add_u32 m0, s49, 26624
 s_add_u32 s45, s46, 9216
 buffer_load_dwordx4 v8, s[8:11], s45 offen  lds
 s_add_u32 m0, s49, 27648
 s_add_u32 s45, s46, 13824
 buffer_load_dwordx4 v9, s[8:11], s45 offen  lds
 s_add_u32 m0, s49, 28672
 s_add_u32 s45, s46, 18432
 buffer_load_dwordx4 v8, s[8:11], s45 offen  lds
 s_add_u32 m0, s49, 29696
 s_add_u32 s45, s46, 23040
 buffer_load_dwordx4 v9, s[8:11], s45 offen  lds
 s_add_u32 m0, s49, 30720
 s_add_u32 s45, s46, 27648
 buffer_load_dwordx4 v8, s[8:11], s45 offen  lds
 s_add_u32 m0, s49, 31744
 s_add_u32 s45, s46, 32256
 buffer_load_dwordx4 v9, s[8:11], s45 offen  lds
 s_waitcnt vmcnt(20) lgkmcnt(0)
 s_add_u32 m0, s49, 32768
 s_add_u32 s45, s46, 36864
 buffer_load_dwordx4 v8, s[8:11], s45 offen  lds
 s_add_u32 m0, s49, 33792
 s_add_u32 s45, s46, 41472
 buffer_load_dwordx4 v9, s[8:11], s45 offen  lds
 s_add_u32 m0, s49, 34816
 s_add_u32 s45, s46, 46080
 buffer_load_dwordx4 v8, s[8:11], s45 offen  lds
 s_add_u32 m0, s49, 35840
 s_add_u32 s45, s46, 50688
 buffer_load_dwordx4 v9, s[8:11], s45 offen  lds
 ds_read_b64_tr_b16 a[0:1], v10 offset:8192
 ds_read_b64_tr_b16 a[2:3], v10 offset:8704
 ds_read_b64_tr_b16 a[4:5], v11 offset:8192
 ds_read_b64_tr_b16 a[6:7], v11 offset:8704
 ds_read_b64_tr_b16 a[8:9], v12 offset:8192
 ds_read_b64_tr_b16 a[10:11], v12 offset:8704
 ds_read_b64_tr_b16 v[16:17], v13 offset:8192
 ds_read_b64_tr_b16 v[18:19], v13 offset:8704
 s_waitcnt vmcnt(20) lgkmcnt(0)
 s_add_u32 m0, s49, 36864
 s_add_u32 s45, s46, 55296
 buffer_load_dwordx4 v8, s[8:11], s45 offen  lds
 s_add_u32 m0, s49, 37888
 s_add_u32 s45, s46, 59904
 buffer_load_dwordx4 v9, s[8:11], s45 offen  lds
 s_add_u32 m0, s49, 38912
 s_add_u32 s45, s46, 64512
 buffer_load_dwordx4 v8, s[8:11], s45 offen  lds
 s_add_u32 m0, s49, 39936
 s_add_u32 s45, s46, 69120
 buffer_load_dwordx4 v9, s[8:11], s45 offen  lds
 ds_write_b128 v5, v[16:19] offset:0
 ds_read_b64_tr_b16 a[12:13], v10 offset:12288
 ds_read_b64_tr_b16 a[14:15], v10 offset:12800
 ds_read_b64_tr_b16 a[16:17], v11 offset:12288
 ds_read_b64_tr_b16 a[18:19], v11 offset:12800
 ds_read_b64_tr_b16 a[20:21], v12 offset:12288
 ds_read_b64_tr_b16 a[22:23], v12 offset:12800
 ds_read_b64_tr_b16 v[20:21], v13 offset:12288
 ds_read_b64_tr_b16 v[22:23], v13 offset:12800
 s_waitcnt vmcnt(20) lgkmcnt(0)
 s_add_u32 s46, s44, 2
 s_and_b32 s46, s46, 7
 s_lshl_b32 s45, s4, 3
 s_add_u32 s46, s46, s45
 s_mul_i32 s46, s46, 147456
 s_add_u32 s46, s46, s47
 s_add_u32 m0, s49, 8192
 s_add_u32 s45, s46, 0
 buffer_load_dwordx4 v8, s[8:11], s45 offen  lds
 s_add_u32 m0, s49, 9216
 s_add_u32 s45, s46, 4608
 buffer_load_dwordx4 v9, s[8:11], s45 offen  lds
 s_add_u32 m0, s49, 10240
 s_add_u32 s45, s46, 9216
 buffer_load_dwordx4 v8, s[8:11], s45 offen  lds
 s_add_u32 m0, s49, 11264
 s_add_u32 s45, s46, 13824
 buffer_load_dwordx4 v9, s[8:11], s45 offen  lds
 ds_write_b128 v5, v[20:23] offset:1024
 ds_read_b64_tr_b16 a[24:25], v10 offset:16384
 ds_read_b64_tr_b16 a[26:27], v10 offset:16896
 ds_read_b64_tr_b16 a[28:29], v11 offset:16384
 ds_read_b64_tr_b16 a[30:31], v11 offset:16896
 ds_read_b64_tr_b16 a[32:33], v12 offset:16384
 ds_read_b64_tr_b16 a[34:35], v12 offset:16896
 ds_read_b64_tr_b16 v[16:17], v13 offset:16384
 ds_read_b64_tr_b16 v[18:19], v13 offset:16896
 s_waitcnt vmcnt(20) lgkmcnt(0)
 s_add_u32 m0, s49, 12288
 s_add_u32 s45, s46, 18432
 buffer_load_dwordx4 v8, s[8:11], s45 offen  lds
 s_add_u32 m0, s49, 13312
 s_add_u32 s45, s46, 23040
 buffer_load_dwordx4 v9, s[8:11], s45 offen  lds
 s_add_u32 m0, s49, 14336
 s_add_u32 s45, s46, 27648
 buffer_load_dwordx4 v8, s[8:11], s45 offen  lds
 s_add_u32 m0, s49, 15360
 s_add_u32 s45, s46, 32256
 buffer_load_dwordx4 v9, s[8:11], s45 offen  lds
 ds_write_b128 v5, v[16:19] offset:2048
 ds_read_b64_tr_b16 a[36:37], v10 offset:20480
 ds_read_b64_tr_b16 a[38:39], v10 offset:20992
 ds_read_b64_tr_b16 a[40:41], v11 offset:20480
 ds_read_b64_tr_b16 a[42:43], v11 offset:20992
 ds_read_b64_tr_b16 a[44:45], v12 offset:20480
 ds_read_b64_tr_b16 a[46:47], v12 offset:20992
 ds_read_b64_tr_b16 v[20:21], v13 offset:20480
 ds_read_b64_tr_b16 v[22:23], v13 offset:20992
 s_waitcnt vmcnt(20) lgkmcnt(0)
 s_add_u32 m0, s49, 16384
 s_add_u32 s45, s46, 36864
 buffer_load_dwordx4 v8, s[8:11], s45 offen  lds
 s_add_u32 m0, s49, 17408
 s_add_u32 s45, s46, 41472
 buffer_load_dwordx4 v9, s[8:11], s45 offen  lds
 s_add_u32 m0, s49, 18432
 s_add_u32 s45, s46, 46080
 buffer_load_dwordx4 v8, s[8:11], s45 offen  lds
 s_add_u32 m0, s49, 19456
 s_add_u32 s45, s46, 50688
 buffer_load_dwordx4 v9, s[8:11], s45 offen  lds
 ds_write_b128 v5, v[20:23] offset:3072
 ds_read_b64_tr_b16 a[48:49], v10 offset:24576
 ds_read_b64_tr_b16 a[50:51], v10 offset:25088
 ds_read_b64_tr_b16 a[52:53], v11 offset:24576
 ds_read_b64_tr_b16 a[54:55], v11 offset:25088
 ds_read_b64_tr_b16 a[56:57], v12 offset:24576
 ds_read_b64_tr_b16 a[58:59], v12 offset:25088
 ds_read_b64_tr_b16 v[16:17], v13 offset:24576
 ds_read_b64_tr_b16 v[18:19], v13 offset:25088
 s_waitcnt vmcnt(20) lgkmcnt(0)
 s_add_u32 m0, s49, 20480
 s_add_u32 s45, s46, 55296
 buffer_load_dwordx4 v8, s[8:11], s45 offen  lds
 s_add_u32 m0, s49, 21504
 s_add_u32 s45, s46, 59904
 buffer_load_dwordx4 v9, s[8:11], s45 offen  lds
 s_add_u32 m0, s49, 22528
 s_add_u32 s45, s46, 64512
 buffer_load_dwordx4 v8, s[8:11], s45 offen  lds
 s_add_u32 m0, s49, 23552
 s_add_u32 s45, s46, 69120
 buffer_load_dwordx4 v9, s[8:11], s45 offen  lds
 ds_write_b128 v5, v[16:19] offset:4096
 ds_read_b64_tr_b16 a[60:61], v10 offset:28672
 ds_read_b64_tr_b16 a[62:63], v10 offset:29184
 ds_read_b64_tr_b16 a[64:65], v11 offset:28672
 ds_read_b64_tr_b16 a[66:67], v11 offset:29184
 ds_read_b64_tr_b16 a[68:69], v12 offset:28672
 ds_read_b64_tr_b16 a[70:71], v12 offset:29184
 ds_read_b64_tr_b16 v[20:21], v13 offset:28672
 ds_read_b64_tr_b16 v[22:23], v13 offset:29184
 s_waitcnt vmcnt(20) lgkmcnt(0)
 s_add_u32 s46, s44, 3
 s_and_b32 s46, s46, 7
 s_lshl_b32 s45, s4, 3
 s_add_u32 s46, s46, s45
 s_mul_i32 s46, s46, 147456
 s_add_u32 s46, s46, s47
 s_add_u32 m0, s49, 24576
 s_add_u32 s45, s46, 0
 buffer_load_dwordx4 v8, s[8:11], s45 offen  lds
 s_add_u32 m0, s49, 25600
 s_add_u32 s45, s46, 4608
 buffer_load_dwordx4 v9, s[8:11], s45 offen  lds
 s_add_u32 m0, s49, 26624
 s_add_u32 s45, s46, 9216
 buffer_load_dwordx4 v8, s[8:11], s45 offen  lds
 s_add_u32 m0, s49, 27648
 s_add_u32 s45, s46, 13824
 buffer_load_dwordx4 v9, s[8:11], s45 offen  lds
 ds_write_b128 v5, v[20:23] offset:5120
 ds_read_b64_tr_b16 a[72:73], v10 offset:32768
 ds_read_b64_tr_b16 a[74:75], v10 offset:33280
 ds_read_b64_tr_b16 a[76:77], v11 offset:32768
 ds_read_b64_tr_b16 a[78:79], v11 offset:33280
 ds_read_b64_tr_b16 a[80:81], v12 offset:32768
 ds_read_b64_tr_b16 a[82:83], v12 offset:33280
 ds_read_b64_tr_b16 v[16:17], v13 offset:32768
 ds_read_b64_tr_b16 v[18:19], v13 offset:33280
 s_waitcnt vmcnt(20) lgkmcnt(0)
 s_add_u32 m0, s49, 28672
 s_add_u32 s45, s46, 18432
 buffer_load_dwordx4 v8, s[8:11], s45 offen  lds
 s_add_u32 m0, s49, 29696
 s_add_u32 s45, s46, 23040
 buffer_load_dwordx4 v9, s[8:11], s45 offen  lds
 s_add_u32 m0, s49, 30720
 s_add_u32 s45, s46, 27648
 buffer_load_dwordx4 v8, s[8:11], s45 offen  lds
 s_add_u32 m0, s49, 31744
 s_add_u32 s45, s46, 32256
 buffer_load_dwordx4 v9, s[8:11], s45 offen  lds
 ds_write_b128 v5, v[16:19] offset:6144
 ds_read_b64_tr_b16 a[84:85], v10 offset:36864
 ds_read_b64_tr_b16 a[86:87], v10 offset:37376
 ds_read_b64_tr_b16 a[88:89], v11 offset:36864
 ds_read_b64_tr_b16 a[90:91], v11 offset:37376
 ds_read_b64_tr_b16 a[92:93], v12 offset:36864
 ds_read_b64_tr_b16 a[94:95], v12 offset:37376
 ds_read_b64_tr_b16 v[20:21], v13 offset:36864
 ds_read_b64_tr_b16 v[22:23], v13 offset:37376
 s_waitcnt vmcnt(20) lgkmcnt(0)
 s_add_u32 m0, s49, 32768
 s_add_u32 s45, s46, 36864
 buffer_load_dwordx4 v8, s[8:11], s45 offen  lds
 s_add_u32 m0, s49, 33792
 s_add_u32 s45, s46, 41472
 buffer_load_dwordx4 v9, s[8:11], s45 offen  lds
 s_add_u32 m0, s49, 34816
 s_add_u32 s45, s46, 46080
 buffer_load_dwordx4 v8, s[8:11], s45 offen  lds
 s_add_u32 m0, s49, 35840
 s_add_u32 s45, s46, 50688
 buffer_load_dwordx4 v9, s[8:11], s45 offen  lds
 ds_write_b128 v5, v[20:23] offset:7168
 ds_read_b64_tr_b16 a[96:97], v10 offset:8192
 ds_read_b64_tr_b16 a[98:99], v10 offset:8704
 ds_read_b64_tr_b16 a[100:101], v11 offset:8192
 ds_read_b64_tr_b16 a[102:103], v11 offset:8704
 ds_read_b64_tr_b16 a[104:105], v12 offset:8192
 ds_read_b64_tr_b16 a[106:107], v12 offset:8704
 ds_read_b64_tr_b16 v[32:33], v13 offset:8192
 ds_read_b64_tr_b16 v[34:35], v13 offset:8704
 s_waitcnt vmcnt(20) lgkmcnt(0)
 s_add_u32 m0, s49, 36864
 s_add_u32 s45, s46, 55296
 buffer_load_dwordx4 v8, s[8:11], s45 offen  lds
 s_add_u32 m0, s49, 37888
 s_add_u32 s45, s46, 59904
 buffer_load_dwordx4 v9, s[8:11], s45 offen  lds
 s_add_u32 m0, s49, 38912
 s_add_u32 s45, s46, 64512
 buffer_load_dwordx4 v8, s[8:11], s45 offen  lds
 s_add_u32 m0, s49, 39936
 s_add_u32 s45, s46, 69120
 buffer_load_dwordx4 v9, s[8:11], s45 offen  lds
 ds_read_b64_tr_b16 a[108:109], v10 offset:12288
 ds_read_b64_tr_b16 a[110:111], v10 offset:12800
 ds_read_b64_tr_b16 a[112:113], v11 offset:12288
 ds_read_b64_tr_b16 a[114:115], v11 offset:12800
 ds_read_b64_tr_b16 a[116:117], v12 offset:12288
 ds_read_b64_tr_b16 a[118:119], v12 offset:12800
 ds_read_b64_tr_b16 v[36:37], v13 offset:12288
 ds_read_b64_tr_b16 v[38:39], v13 offset:12800
 s_waitcnt vmcnt(20) lgkmcnt(0)
 s_add_u32 s46, s44, 4
 s_and_b32 s46, s46, 7
 s_lshl_b32 s45, s4, 3
 s_add_u32 s46, s46, s45
 s_mul_i32 s46, s46, 147456
 s_add_u32 s46, s46, s47
 s_add_u32 m0, s49, 8192
 s_add_u32 s45, s46, 0
 buffer_load_dwordx4 v8, s[8:11], s45 offen  lds
 s_add_u32 m0, s49, 9216
 s_add_u32 s45, s46, 4608
 buffer_load_dwordx4 v9, s[8:11], s45 offen  lds
 s_add_u32 m0, s49, 10240
 s_add_u32 s45, s46, 9216
 buffer_load_dwordx4 v8, s[8:11], s45 offen  lds
 s_add_u32 m0, s49, 11264
 s_add_u32 s45, s46, 13824
 buffer_load_dwordx4 v9, s[8:11], s45 offen  lds
 ds_read_b64_tr_b16 a[120:121], v10 offset:16384
 ds_read_b64_tr_b16 a[122:123], v10 offset:16896
 ds_read_b64_tr_b16 a[124:125], v11 offset:16384
 ds_read_b64_tr_b16 a[126:127], v11 offset:16896
 ds_read_b64_tr_b16 a[128:129], v12 offset:16384
 ds_read_b64_tr_b16 a[130:131], v12 offset:16896
 ds_read_b64_tr_b16 v[40:41], v13 offset:16384
 ds_read_b64_tr_b16 v[42:43], v13 offset:16896
 s_waitcnt vmcnt(20) lgkmcnt(0)
 s_add_u32 m0, s49, 12288
 s_add_u32 s45, s46, 18432
 buffer_load_dwordx4 v8, s[8:11], s45 offen  lds
 s_add_u32 m0, s49, 13312
 s_add_u32 s45, s46, 23040
 buffer_load_dwordx4 v9, s[8:11], s45 offen  lds
 s_add_u32 m0, s49, 14336
 s_add_u32 s45, s46, 27648
 buffer_load_dwordx4 v8, s[8:11], s45 offen  lds
 s_add_u32 m0, s49, 15360
 s_add_u32 s45, s46, 32256
 buffer_load_dwordx4 v9, s[8:11], s45 offen  lds
 ds_read_b64_tr_b16 a[132:133], v10 offset:20480
 ds_read_b64_tr_b16 a[134:135], v10 offset:20992
 ds_read_b64_tr_b16 a[136:137], v11 offset:20480
 ds_read_b64_tr_b16 a[138:139], v11 offset:20992
 ds_read_b64_tr_b16 a[140:141], v12 offset:20480
 ds_read_b64_tr_b16 a[142:143], v12 offset:20992
 ds_read_b64_tr_b16 v[44:45], v13 offset:20480
 ds_read_b64_tr_b16 v[46:47], v13 offset:20992
 s_waitcnt vmcnt(20) lgkmcnt(0)
 s_add_u32 m0, s49, 16384
 s_add_u32 s45, s46, 36864
 buffer_load_dwordx4 v8, s[8:11], s45 offen  lds
 s_add_u32 m0, s49, 17408
 s_add_u32 s45, s46, 41472
 buffer_load_dwordx4 v9, s[8:11], s45 offen  lds
 s_add_u32 m0, s49, 18432
 s_add_u32 s45, s46, 46080
 buffer_load_dwordx4 v8, s[8:11], s45 offen  lds
 s_add_u32 m0, s49, 19456
 s_add_u32 s45, s46, 50688
 buffer_load_dwordx4 v9, s[8:11], s45 offen  lds
 ds_read_b64_tr_b16 a[144:145], v10 offset:24576
 ds_read_b64_tr_b16 a[146:147], v10 offset:25088
 ds_read_b64_tr_b16 a[148:149], v11 offset:24576
 ds_read_b64_tr_b16 a[150:151], v11 offset:25088
 ds_read_b64_tr_b16 a[152:153], v12 offset:24576
 ds_read_b64_tr_b16 a[154:155], v12 offset:25088
 ds_read_b64_tr_b16 v[48:49], v13 offset:24576
 ds_read_b64_tr_b16 v[50:51], v13 offset:25088
 s_waitcnt vmcnt(20) lgkmcnt(0)
 s_add_u32 m0, s49, 20480
 s_add_u32 s45, s46, 55296
 buffer_load_dwordx4 v8, s[8:11], s45 offen  lds
 s_add_u32 m0, s49, 21504
 s_add_u32 s45, s46, 59904
 buffer_load_dwordx4 v9, s[8:11], s45 offen  lds
 s_add_u32 m0, s49, 22528
 s_add_u32 s45, s46, 64512
 buffer_load_dwordx4 v8, s[8:11], s45 offen  lds
 s_add_u32 m0, s49, 23552
 s_add_u32 s45, s46, 69120
 buffer_load_dwordx4 v9, s[8:11], s45 offen  lds
 ds_read_b64_tr_b16 a[156:157], v10 offset:28672
 ds_read_b64_tr_b16 a[158:159], v10 offset:29184
 ds_read_b64_tr_b16 a[160:161], v11 offset:28672
 ds_read_b64_tr_b16 a[162:163], v11 offset:29184
 ds_read_b64_tr_b16 a[164:165], v12 offset:28672
 ds_read_b64_tr_b16 a[166:167], v12 offset:29184
 ds_read_b64_tr_b16 v[52:53], v13 offset:28672
 ds_read_b64_tr_b16 v[54:55], v13 offset:29184
 s_waitcnt vmcnt(20) lgkmcnt(0)
 s_add_u32 s46, s44, 5
 s_and_b32 s46, s46, 7
 s_lshl_b32 s45, s4, 3
 s_add_u32 s46, s46, s45
 s_mul_i32 s46, s46, 147456
 s_add_u32 s46, s46, s47
 s_add_u32 m0, s49, 24576
 s_add_u32 s45, s46, 0
 buffer_load_dwordx4 v8, s[8:11], s45 offen  lds
 s_add_u32 m0, s49, 25600
 s_add_u32 s45, s46, 4608
 buffer_load_dwordx4 v9, s[8:11], s45 offen  lds
 s_add_u32 m0, s49, 26624
 s_add_u32 s45, s46, 9216
 buffer_load_dwordx4 v8, s[8:11], s45 offen  lds
 s_add_u32 m0, s49, 27648
 s_add_u32 s45, s46, 13824
 buffer_load_dwordx4 v9, s[8:11], s45 offen  lds
 ds_read_b64_tr_b16 a[168:169], v10 offset:32768
 ds_read_b64_tr_b16 a[170:171], v10 offset:33280
 ds_read_b64_tr_b16 a[172:173], v11 offset:32768
 ds_read_b64_tr_b16 a[174:175], v11 offset:33280
 ds_read_b64_tr_b16 a[176:177], v12 offset:32768
 ds_read_b64_tr_b16 a[178:179], v12 offset:33280
 ds_read_b64_tr_b16 v[56:57], v13 offset:32768
 ds_read_b64_tr_b16 v[58:59], v13 offset:33280
 s_waitcnt vmcnt(20) lgkmcnt(0)
 s_add_u32 m0, s49, 28672
 s_add_u32 s45, s46, 18432
 buffer_load_dwordx4 v8, s[8:11], s45 offen  lds
 s_add_u32 m0, s49, 29696
 s_add_u32 s45, s46, 23040
 buffer_load_dwordx4 v9, s[8:11], s45 offen  lds
 s_add_u32 m0, s49, 30720
 s_add_u32 s45, s46, 27648
 buffer_load_dwordx4 v8, s[8:11], s45 offen  lds
 s_add_u32 m0, s49, 31744
 s_add_u32 s45, s46, 32256
 buffer_load_dwordx4 v9, s[8:11], s45 offen  lds
 ds_read_b64_tr_b16 a[180:181], v10 offset:36864
 ds_read_b64_tr_b16 a[182:183], v10 offset:37376
 ds_read_b64_tr_b16 a[184:185], v11 offset:36864
 ds_read_b64_tr_b16 a[186:187], v11 offset:37376
 ds_read_b64_tr_b16 a[188:189], v12 offset:36864
 ds_read_b64_tr_b16 a[190:191], v12 offset:37376
 ds_read_b64_tr_b16 v[60:61], v13 offset:36864
 ds_read_b64_tr_b16 v[62:63], v13 offset:37376
 s_waitcnt vmcnt(20) lgkmcnt(0)
 s_add_u32 m0, s49, 32768
 s_add_u32 s45, s46, 36864
 buffer_load_dwordx4 v8, s[8:11], s45 offen  lds
 s_add_u32 m0, s49, 33792
 s_add_u32 s45, s46, 41472
 buffer_load_dwordx4 v9, s[8:11], s45 offen  lds
 s_add_u32 m0, s49, 34816
 s_add_u32 s45, s46, 46080
 buffer_load_dwordx4 v8, s[8:11], s45 offen  lds
 s_add_u32 m0, s49, 35840
 s_add_u32 s45, s46, 50688
 buffer_load_dwordx4 v9, s[8:11], s45 offen  lds
 ds_read_b64_tr_b16 a[192:193], v10 offset:8192
 ds_read_b64_tr_b16 a[194:195], v10 offset:8704
 ds_read_b64_tr_b16 a[196:197], v11 offset:8192
 ds_read_b64_tr_b16 a[198:199], v11 offset:8704
 ds_read_b64_tr_b16 a[200:201], v12 offset:8192
 ds_read_b64_tr_b16 a[202:203], v12 offset:8704
 ds_read_b64_tr_b16 v[64:65], v13 offset:8192
 ds_read_b64_tr_b16 v[66:67], v13 offset:8704
 s_waitcnt vmcnt(20) lgkmcnt(0)
 s_add_u32 m0, s49, 36864
 s_add_u32 s45, s46, 55296
 buffer_load_dwordx4 v8, s[8:11], s45 offen  lds
 s_add_u32 m0, s49, 37888
 s_add_u32 s45, s46, 59904
 buffer_load_dwordx4 v9, s[8:11], s45 offen  lds
 s_add_u32 m0, s49, 38912
 s_add_u32 s45, s46, 64512
 buffer_load_dwordx4 v8, s[8:11], s45 offen  lds
 s_add_u32 m0, s49, 39936
 s_add_u32 s45, s46, 69120
 buffer_load_dwordx4 v9, s[8:11], s45 offen  lds
 ds_read_b64_tr_b16 a[204:205], v10 offset:12288
 ds_read_b64_tr_b16 a[206:207], v10 offset:12800
 ds_read_b64_tr_b16 a[208:209], v11 offset:12288
 ds_read_b64_tr_b16 a[210:211], v11 offset:12800
 ds_read_b64_tr_b16 a[212:213], v12 offset:12288
 ds_read_b64_tr_b16 a[214:215], v12 offset:12800
 ds_read_b64_tr_b16 v[68:69], v13 offset:12288
 ds_read_b64_tr_b16 v[70:71], v13 offset:12800
 s_waitcnt vmcnt(20) lgkmcnt(0)
 s_add_u32 s46, s44, 6
 s_and_b32 s46, s46, 7
 s_lshl_b32 s45, s4, 3
 s_add_u32 s46, s46, s45
 s_mul_i32 s46, s46, 147456
 s_add_u32 s46, s46, s47
 s_add_u32 m0, s49, 8192
 s_add_u32 s45, s46, 0
 buffer_load_dwordx4 v8, s[8:11], s45 offen  lds
 s_add_u32 m0, s49, 9216
 s_add_u32 s45, s46, 4608
 buffer_load_dwordx4 v9, s[8:11], s45 offen  lds
 s_add_u32 m0, s49, 10240
 s_add_u32 s45, s46, 9216
 buffer_load_dwordx4 v8, s[8:11], s45 offen  lds
 s_add_u32 m0, s49, 11264
 s_add_u32 s45, s46, 13824
 buffer_load_dwordx4 v9, s[8:11], s45 offen  lds
 ds_read_b64_tr_b16 a[216:217], v10 offset:16384
 ds_read_b64_tr_b16 a[218:219], v10 offset:16896
 ds_read_b64_tr_b16 a[220:221], v11 offset:16384
 ds_read_b64_tr_b16 a[222:223], v11 offset:16896
 ds_read_b64_tr_b16 a[224:225], v12 offset:16384
 ds_read_b64_tr_b16 a[226:227], v12 offset:16896
 ds_read_b64_tr_b16 v[72:73], v13 offset:16384
 ds_read_b64_tr_b16 v[74:75], v13 offset:16896
 s_waitcnt vmcnt(20) lgkmcnt(0)
 s_add_u32 m0, s49, 12288
 s_add_u32 s45, s46, 18432
 buffer_load_dwordx4 v8, s[8:11], s45 offen  lds
 s_add_u32 m0, s49, 13312
 s_add_u32 s45, s46, 23040
 buffer_load_dwordx4 v9, s[8:11], s45 offen  lds
 s_add_u32 m0, s49, 14336
 s_add_u32 s45, s46, 27648
 buffer_load_dwordx4 v8, s[8:11], s45 offen  lds
 s_add_u32 m0, s49, 15360
 s_add_u32 s45, s46, 32256
 buffer_load_dwordx4 v9, s[8:11], s45 offen  lds
 ds_read_b64_tr_b16 a[228:229], v10 offset:20480
 ds_read_b64_tr_b16 a[230:231], v10 offset:20992
 ds_read_b64_tr_b16 a[232:233], v11 offset:20480
 ds_read_b64_tr_b16 a[234:235], v11 offset:20992
 ds_read_b64_tr_b16 a[236:237], v12 offset:20480
 ds_read_b64_tr_b16 a[238:239], v12 offset:20992
 ds_read_b64_tr_b16 v[76:77], v13 offset:20480
 ds_read_b64_tr_b16 v[78:79], v13 offset:20992
 s_waitcnt vmcnt(20) lgkmcnt(0)
 s_add_u32 m0, s49, 16384
 s_add_u32 s45, s46, 36864
 buffer_load_dwordx4 v8, s[8:11], s45 offen  lds
 s_add_u32 m0, s49, 17408
 s_add_u32 s45, s46, 41472
 buffer_load_dwordx4 v9, s[8:11], s45 offen  lds
 s_add_u32 m0, s49, 18432
 s_add_u32 s45, s46, 46080
 buffer_load_dwordx4 v8, s[8:11], s45 offen  lds
 s_add_u32 m0, s49, 19456
 s_add_u32 s45, s46, 50688
 buffer_load_dwordx4 v9, s[8:11], s45 offen  lds
 ds_read_b64_tr_b16 a[240:241], v10 offset:24576
 ds_read_b64_tr_b16 a[242:243], v10 offset:25088
 ds_read_b64_tr_b16 a[244:245], v11 offset:24576
 ds_read_b64_tr_b16 a[246:247], v11 offset:25088
 ds_read_b64_tr_b16 a[248:249], v12 offset:24576
 ds_read_b64_tr_b16 a[250:251], v12 offset:25088
 ds_read_b64_tr_b16 v[80:81], v13 offset:24576
 ds_read_b64_tr_b16 v[82:83], v13 offset:25088
 s_waitcnt vmcnt(20) lgkmcnt(0)
 s_add_u32 m0, s49, 20480
 s_add_u32 s45, s46, 55296
 buffer_load_dwordx4 v8, s[8:11], s45 offen  lds
 s_add_u32 m0, s49, 21504
 s_add_u32 s45, s46, 59904
 buffer_load_dwordx4 v9, s[8:11], s45 offen  lds
 s_add_u32 m0, s49, 22528
 s_add_u32 s45, s46, 64512
 buffer_load_dwordx4 v8, s[8:11], s45 offen  lds
 s_add_u32 m0, s49, 23552
 s_add_u32 s45, s46, 69120
 buffer_load_dwordx4 v9, s[8:11], s45 offen  lds
 ds_read_b64_tr_b16 a[252:253], v10 offset:28672
 ds_read_b64_tr_b16 a[254:255], v10 offset:29184
 ds_read_b64_tr_b16 v[128:129], v11 offset:28672
 ds_read_b64_tr_b16 v[130:131], v11 offset:29184
 ds_read_b64_tr_b16 v[132:133], v12 offset:28672
 ds_read_b64_tr_b16 v[134:135], v12 offset:29184
 ds_read_b64_tr_b16 v[84:85], v13 offset:28672
 ds_read_b64_tr_b16 v[86:87], v13 offset:29184
 s_waitcnt vmcnt(20) lgkmcnt(0)
 s_add_u32 s46, s44, 7
 s_and_b32 s46, s46, 7
 s_lshl_b32 s45, s4, 3
 s_add_u32 s46, s46, s45
 s_mul_i32 s46, s46, 147456
 s_add_u32 s46, s46, s47
 s_add_u32 m0, s49, 24576
 s_add_u32 s45, s46, 0
 buffer_load_dwordx4 v8, s[8:11], s45 offen  lds
 s_add_u32 m0, s49, 25600
 s_add_u32 s45, s46, 4608
 buffer_load_dwordx4 v9, s[8:11], s45 offen  lds
 s_add_u32 m0, s49, 26624
 s_add_u32 s45, s46, 9216
 buffer_load_dwordx4 v8, s[8:11], s45 offen  lds
 s_add_u32 m0, s49, 27648
 s_add_u32 s45, s46, 13824
 buffer_load_dwordx4 v9, s[8:11], s45 offen  lds
 ds_read_b64_tr_b16 v[136:137], v10 offset:32768
 ds_read_b64_tr_b16 v[138:139], v10 offset:33280
 ds_read_b64_tr_b16 v[140:141], v11 offset:32768
 ds_read_b64_tr_b16 v[142:143], v11 offset:33280
 ds_read_b64_tr_b16 v[144:145], v12 offset:32768
 ds_read_b64_tr_b16 v[146:147], v12 offset:33280
 ds_read_b64_tr_b16 v[88:89], v13 offset:32768
 ds_read_b64_tr_b16 v[90:91], v13 offset:33280
 s_waitcnt vmcnt(20) lgkmcnt(0)
 s_add_u32 m0, s49, 28672
 s_add_u32 s45, s46, 18432
 buffer_load_dwordx4 v8, s[8:11], s45 offen  lds
 s_add_u32 m0, s49, 29696
 s_add_u32 s45, s46, 23040
 buffer_load_dwordx4 v9, s[8:11], s45 offen  lds
 s_add_u32 m0, s49, 30720
 s_add_u32 s45, s46, 27648
 buffer_load_dwordx4 v8, s[8:11], s45 offen  lds
 s_add_u32 m0, s49, 31744
 s_add_u32 s45, s46, 32256
 buffer_load_dwordx4 v9, s[8:11], s45 offen  lds
 ds_read_b64_tr_b16 v[148:149], v10 offset:36864
 ds_read_b64_tr_b16 v[150:151], v10 offset:37376
 ds_read_b64_tr_b16 v[152:153], v11 offset:36864
 ds_read_b64_tr_b16 v[154:155], v11 offset:37376
 ds_read_b64_tr_b16 v[156:157], v12 offset:36864
 ds_read_b64_tr_b16 v[158:159], v12 offset:37376
 ds_read_b64_tr_b16 v[92:93], v13 offset:36864
 ds_read_b64_tr_b16 v[94:95], v13 offset:37376
 s_waitcnt vmcnt(20) lgkmcnt(0)
 s_add_u32 m0, s49, 32768
 s_add_u32 s45, s46, 36864
 buffer_load_dwordx4 v8, s[8:11], s45 offen  lds
 s_add_u32 m0, s49, 33792
 s_add_u32 s45, s46, 41472
 buffer_load_dwordx4 v9, s[8:11], s45 offen  lds
 s_add_u32 m0, s49, 34816
 s_add_u32 s45, s46, 46080
 buffer_load_dwordx4 v8, s[8:11], s45 offen  lds
 s_add_u32 m0, s49, 35840
 s_add_u32 s45, s46, 50688
 buffer_load_dwordx4 v9, s[8:11], s45 offen  lds
 ds_read_b64_tr_b16 v[160:161], v10 offset:8192
 ds_read_b64_tr_b16 v[162:163], v10 offset:8704
 ds_read_b64_tr_b16 v[164:165], v11 offset:8192
 ds_read_b64_tr_b16 v[166:167], v11 offset:8704
 ds_read_b64_tr_b16 v[168:169], v12 offset:8192
 ds_read_b64_tr_b16 v[170:171], v12 offset:8704
 ds_read_b64_tr_b16 v[96:97], v13 offset:8192
 ds_read_b64_tr_b16 v[98:99], v13 offset:8704
 s_waitcnt vmcnt(20) lgkmcnt(0)
 s_add_u32 m0, s49, 36864
 s_add_u32 s45, s46, 55296
 buffer_load_dwordx4 v8, s[8:11], s45 offen  lds
 s_add_u32 m0, s49, 37888
 s_add_u32 s45, s46, 59904
 buffer_load_dwordx4 v9, s[8:11], s45 offen  lds
 s_add_u32 m0, s49, 38912
 s_add_u32 s45, s46, 64512
 buffer_load_dwordx4 v8, s[8:11], s45 offen  lds
 s_add_u32 m0, s49, 39936
 s_add_u32 s45, s46, 69120
 buffer_load_dwordx4 v9, s[8:11], s45 offen  lds
 ds_read_b64_tr_b16 v[172:173], v10 offset:12288
 ds_read_b64_tr_b16 v[174:175], v10 offset:12800
 ds_read_b64_tr_b16 v[176:177], v11 offset:12288
 ds_read_b64_tr_b16 v[178:179], v11 offset:12800
 ds_read_b64_tr_b16 v[180:181], v12 offset:12288
 ds_read_b64_tr_b16 v[182:183], v12 offset:12800
 ds_read_b64_tr_b16 v[100:101], v13 offset:12288
 ds_read_b64_tr_b16 v[102:103], v13 offset:12800
 s_waitcnt vmcnt(20) lgkmcnt(0)
 ds_read_b64_tr_b16 v[184:185], v10 offset:16384
 ds_read_b64_tr_b16 v[186:187], v10 offset:16896
 ds_read_b64_tr_b16 v[188:189], v11 offset:16384
 ds_read_b64_tr_b16 v[190:191], v11 offset:16896
 ds_read_b64_tr_b16 v[192:193], v12 offset:16384
 ds_read_b64_tr_b16 v[194:195], v12 offset:16896
 ds_read_b64_tr_b16 v[104:105], v13 offset:16384
 ds_read_b64_tr_b16 v[106:107], v13 offset:16896
 s_waitcnt vmcnt(16) lgkmcnt(0)
 ds_read_b64_tr_b16 v[196:197], v10 offset:20480
 ds_read_b64_tr_b16 v[198:199], v10 offset:20992
 ds_read_b64_tr_b16 v[200:201], v11 offset:20480
 ds_read_b64_tr_b16 v[202:203], v11 offset:20992
 ds_read_b64_tr_b16 v[204:205], v12 offset:20480
 ds_read_b64_tr_b16 v[206:207], v12 offset:20992
 ds_read_b64_tr_b16 v[108:109], v13 offset:20480
 ds_read_b64_tr_b16 v[110:111], v13 offset:20992
 s_waitcnt vmcnt(12) lgkmcnt(0)
 ds_read_b64_tr_b16 v[208:209], v10 offset:24576
 ds_read_b64_tr_b16 v[210:211], v10 offset:25088
 ds_read_b64_tr_b16 v[212:213], v11 offset:24576
 ds_read_b64_tr_b16 v[214:215], v11 offset:25088
 ds_read_b64_tr_b16 v[216:217], v12 offset:24576
 ds_read_b64_tr_b16 v[218:219], v12 offset:25088
 ds_read_b64_tr_b16 v[112:113], v13 offset:24576
 ds_read_b64_tr_b16 v[114:115], v13 offset:25088
 s_waitcnt vmcnt(8) lgkmcnt(0)
 ds_read_b64_tr_b16 v[220:221], v10 offset:28672
 ds_read_b64_tr_b16 v[222:223], v10 offset:29184
 ds_read_b64_tr_b16 v[224:225], v11 offset:28672
 ds_read_b64_tr_b16 v[226:227], v11 offset:29184
 ds_read_b64_tr_b16 v[228:229], v12 offset:28672
 ds_read_b64_tr_b16 v[230:231], v12 offset:29184
 ds_read_b64_tr_b16 v[116:117], v13 offset:28672
 ds_read_b64_tr_b16 v[118:119], v13 offset:29184
 s_waitcnt vmcnt(4) lgkmcnt(0)
 ds_read_b64_tr_b16 v[232:233], v10 offset:32768
 ds_read_b64_tr_b16 v[234:235], v10 offset:33280
 ds_read_b64_tr_b16 v[236:237], v11 offset:32768
 ds_read_b64_tr_b16 v[238:239], v11 offset:33280
 ds_read_b64_tr_b16 v[240:241], v12 offset:32768
 ds_read_b64_tr_b16 v[242:243], v12 offset:33280
 ds_read_b64_tr_b16 v[120:121], v13 offset:32768
 ds_read_b64_tr_b16 v[122:123], v13 offset:33280
 s_waitcnt vmcnt(0) lgkmcnt(0)
 ds_read_b64_tr_b16 v[244:245], v10 offset:36864
 ds_read_b64_tr_b16 v[246:247], v10 offset:37376
 ds_read_b64_tr_b16 v[248:249], v11 offset:36864
 ds_read_b64_tr_b16 v[250:251], v11 offset:37376
 ds_read_b64_tr_b16 v[252:253], v12 offset:36864
 ds_read_b64_tr_b16 v[254:255], v12 offset:37376
 ds_read_b64_tr_b16 v[124:125], v13 offset:36864
 ds_read_b64_tr_b16 v[126:127], v13 offset:37376
 s_waitcnt lgkmcnt(0)
 ds_write_b128 v5, v[32:35] offset:8192
 ds_write_b128 v5, v[36:39] offset:9216
 ds_write_b128 v5, v[40:43] offset:10240
 ds_write_b128 v5, v[44:47] offset:11264
 ds_write_b128 v5, v[48:51] offset:12288
 ds_write_b128 v5, v[52:55] offset:13312
 ds_write_b128 v5, v[56:59] offset:14336
 ds_write_b128 v5, v[60:63] offset:15360
 ds_write_b128 v5, v[64:67] offset:16384
 ds_write_b128 v5, v[68:71] offset:17408
 ds_write_b128 v5, v[72:75] offset:18432
 ds_write_b128 v5, v[76:79] offset:19456
 ds_write_b128 v5, v[80:83] offset:20480
 ds_write_b128 v5, v[84:87] offset:21504
 ds_write_b128 v5, v[88:91] offset:22528
 ds_write_b128 v5, v[92:95] offset:23552
 ds_write_b128 v5, v[96:99] offset:24576
 ds_write_b128 v5, v[100:103] offset:25600
 ds_write_b128 v5, v[104:107] offset:26624
 ds_write_b128 v5, v[108:111] offset:27648
 ds_write_b128 v5, v[112:115] offset:28672
 ds_write_b128 v5, v[116:119] offset:29696
 ds_write_b128 v5, v[120:123] offset:30720
 ds_write_b128 v5, v[124:127] offset:31744
 s_waitcnt lgkmcnt(0)
 v_lshrrev_b32 v13, 2, v15
 v_and_b32 v14, 3, v15
 s_lshr_b32 s45, s4, 1
 s_mul_i32 s45, s45, 36864
 s_and_b32 s46, s4, 1
 s_lshl_b32 s46, s46, 6
 s_add_u32 s45, s45, s46
 s_add_u32 s37, s37, s45
 v_mul_u32_u24 v6, 2304, v13
 v_lshl_add_u32 v6, v14, 4, v6
 v_lshl_add_u32 v13, v14, 2, v13
 v_and_b32 v13, 15, v13
 v_lshlrev_b32 v13, 4, v13
 s_lshl_b32 s45, s4, 11
 v_lshl_add_u32 v12, v14, 9, v13
 v_add_u32 v12, s45, v12
 v_lshrrev_b32 v13, 5, v15
 v_lshl_add_u32 v13, v13, 2, v15
 v_and_b32 v13, 15, v13
 v_and_or_b32 v13, v15, 48, v13
 v_lshlrev_b32 v13, 4, v13
 v_xor_b32 v14, 0x80, v13
 v_add_u32 v15, s49, v14
 v_add_u32 v14, s49, v13
 v_add_u32 v4, 32768, v12
 v_add_u32 v7, 114688, v12
 s_lshl_b32 s45, s32, 7
 s_add_u32 s37, s37, s45
 s_lshl_b32 s45, s4, 16
 s_add_u32 s36, s36, s45
 s_mov_b32 s42, s33
 s_mov_b32 s43, 0
 s_and_b32 s53, s42, s93
 s_lshl_b32 s53, s53, s91
 s_add_u32 s53, s53, s38
 s_lshr_b32 s51, s42, s90
 s_add_u32 s51, s51, 1
 ds_read_b128 v[16:19], v5 offset:0
 ds_read_b128 v[20:23], v5 offset:1024
Los0_45:
 buffer_load_dword v2, v3, s[20:23], s53 offen sc1
 s_waitcnt vmcnt(0)
 v_cmp_gt_u32 vcc, s51, v2
 s_and_b32 s52, vcc_lo, 0xffff
 s_cbranch_scc0 Los0k_46
 s_sleep 4
 s_sub_u32 s50, s50, 1
 s_cbranch_scc0 Los0_45
 s_endpgm
Los0k_46:
 s_lshl_b32 s48, s42, 18
 s_add_u32 s48, s48, s36
 s_add_u32 s52, s44, 0
 s_and_b32 s52, s52, 7
 s_lshl_b32 s52, s52, 13
 s_add_u32 s46, s48, s52
 s_add_u32 s47, s46, 4096
 buffer_load_dwordx4 v[32:35], v1, s[20:23], s46 offen offset:0 sc1
 buffer_load_dwordx4 v[36:39], v1, s[20:23], s46 offen offset:1024 sc1
 buffer_load_dwordx4 v[40:43], v1, s[20:23], s46 offen offset:2048 sc1
 buffer_load_dwordx4 v[44:47], v1, s[20:23], s46 offen offset:3072 sc1
 buffer_load_dwordx4 v[48:51], v1, s[20:23], s47 offen offset:0 sc1
 buffer_load_dwordx4 v[52:55], v1, s[20:23], s47 offen offset:1024 sc1
 buffer_load_dwordx4 v[56:59], v1, s[20:23], s47 offen offset:2048 sc1
 buffer_load_dwordx4 v[60:63], v1, s[20:23], s47 offen offset:3072 sc1
 s_add_u32 s52, s44, 1
 s_and_b32 s52, s52, 7
 s_lshl_b32 s52, s52, 13
 s_add_u32 s46, s48, s52
 s_add_u32 s47, s46, 4096
 buffer_load_dwordx4 v[64:67], v1, s[20:23], s46 offen offset:0 sc1
 buffer_load_dwordx4 v[68:71], v1, s[20:23], s46 offen offset:1024 sc1
 buffer_load_dwordx4 v[72:75], v1, s[20:23], s46 offen offset:2048 sc1
 buffer_load_dwordx4 v[76:79], v1, s[20:23], s46 offen offset:3072 sc1
 buffer_load_dwordx4 v[80:83], v1, s[20:23], s47 offen offset:0 sc1
 buffer_load_dwordx4 v[84:87], v1, s[20:23], s47 offen offset:1024 sc1
 buffer_load_dwordx4 v[88:91], v1, s[20:23], s47 offen offset:2048 sc1
 buffer_load_dwordx4 v[92:95], v1, s[20:23], s47 offen offset:3072 sc1
 .p2align 3
Losl_47:
 s_waitcnt vmcnt(14) lgkmcnt(1)
 v_mfma_f32_16x16x32_bf16 v[96:99], a[0:3], v[32:35], 0
 s_add_u32 s52, s44, 2
 s_and_b32 s52, s52, 7
 v_mfma_f32_16x16x32_bf16 v[100:103], a[4:7], v[32:35], 0
 s_lshl_b32 s52, s52, 13
 s_add_u32 s46, s48, s52
 v_mfma_f32_16x16x32_bf16 v[104:107], a[8:11], v[32:35], 0
 s_add_u32 s47, s46, 4096
 v_mfma_f32_16x16x32_bf16 v[108:111], v[16:19], v[32:35], 0
 buffer_load_dwordx4 v[32:35], v1, s[20:23], s46 offen offset:0 sc1
 v_mfma_f32_16x16x32_bf16 v[112:115], a[0:3], v[36:39], 0
 ds_read_b128 v[24:27], v5 offset:2048
 v_mfma_f32_16x16x32_bf16 v[116:119], a[4:7], v[36:39], 0
 v_mfma_f32_16x16x32_bf16 v[120:123], a[8:11], v[36:39], 0
 v_mfma_f32_16x16x32_bf16 v[124:127], v[16:19], v[36:39], 0
 buffer_load_dwordx4 v[36:39], v1, s[20:23], s46 offen offset:1024 sc1
 s_waitcnt vmcnt(14) lgkmcnt(1)
 v_mfma_f32_16x16x32_bf16 v[96:99], a[12:15], v[40:43], v[96:99]
 s_mov_b32 s41, s42
 s_add_u32 s43, s43, 1
 v_mfma_f32_16x16x32_bf16 v[100:103], a[16:19], v[40:43], v[100:103]
 s_cmp_lt_u32 s43, s35
 s_cselect_b32 s45, s34, 0
 v_mfma_f32_16x16x32_bf16 v[104:107], a[20:23], v[40:43], v[104:107]
 s_xor_b32 s34, s34, s39
 s_add_u32 s42, s42, s45
 v_mfma_f32_16x16x32_bf16 v[108:111], v[20:23], v[40:43], v[108:111]
 buffer_load_dwordx4 v[40:43], v1, s[20:23], s46 offen offset:2048 sc1
 v_mfma_f32_16x16x32_bf16 v[112:115], a[12:15], v[44:47], v[112:115]
 ds_read_b128 v[28:31], v5 offset:3072
 v_mfma_f32_16x16x32_bf16 v[116:119], a[16:19], v[44:47], v[116:119]
 v_mfma_f32_16x16x32_bf16 v[120:123], a[20:23], v[44:47], v[120:123]
 v_mfma_f32_16x16x32_bf16 v[124:127], v[20:23], v[44:47], v[124:127]
 buffer_load_dwordx4 v[44:47], v1, s[20:23], s46 offen offset:3072 sc1
 s_waitcnt vmcnt(14) lgkmcnt(1)
 v_mfma_f32_16x16x32_bf16 v[96:99], a[24:27], v[48:51], v[96:99]
 s_and_b32 s53, s42, s93
 s_lshl_b32 s53, s53, s91
 v_mfma_f32_16x16x32_bf16 v[100:103], a[28:31], v[48:51], v[100:103]
 s_add_u32 s53, s53, s38
 s_lshr_b32 s51, s42, s90
 v_mfma_f32_16x16x32_bf16 v[104:107], a[32:35], v[48:51], v[104:107]
 s_add_u32 s51, s51, 1
 v_mfma_f32_16x16x32_bf16 v[108:111], v[24:27], v[48:51], v[108:111]
 buffer_load_dwordx4 v[48:51], v1, s[20:23], s47 offen offset:0 sc1
 v_mfma_f32_16x16x32_bf16 v[112:115], a[24:27], v[52:55], v[112:115]
 ds_read_b128 v[16:19], v5 offset:4096
 v_mfma_f32_16x16x32_bf16 v[116:119], a[28:31], v[52:55], v[116:119]
 v_mfma_f32_16x16x32_bf16 v[120:123], a[32:35], v[52:55], v[120:123]
 v_mfma_f32_16x16x32_bf16 v[124:127], v[24:27], v[52:55], v[124:127]
 buffer_load_dwordx4 v[52:55], v1, s[20:23], s47 offen offset:1024 sc1
 s_waitcnt vmcnt(14) lgkmcnt(1)
 v_mfma_f32_16x16x32_bf16 v[96:99], a[36:39], v[56:59], v[96:99]
 s_mul_i32 s54, s41, 73728
 s_add_u32 s54, s54, s37
 v_mfma_f32_16x16x32_bf16 v[100:103], a[40:43], v[56:59], v[100:103]
 v_mfma_f32_16x16x32_bf16 v[104:107], a[44:47], v[56:59], v[104:107]
 v_mfma_f32_16x16x32_bf16 v[108:111], v[28:31], v[56:59], v[108:111]
 buffer_load_dwordx4 v[56:59], v1, s[20:23], s47 offen offset:2048 sc1
 v_mfma_f32_16x16x32_bf16 v[112:115], a[36:39], v[60:63], v[112:115]
 ds_read_b128 v[20:23], v5 offset:5120
 v_mfma_f32_16x16x32_bf16 v[116:119], a[40:43], v[60:63], v[116:119]
 v_mfma_f32_16x16x32_bf16 v[120:123], a[44:47], v[60:63], v[120:123]
 v_mfma_f32_16x16x32_bf16 v[124:127], v[28:31], v[60:63], v[124:127]
 buffer_load_dwordx4 v[60:63], v1, s[20:23], s47 offen offset:3072 sc1
 s_waitcnt vmcnt(14) lgkmcnt(1)
 v_mfma_f32_16x16x32_bf16 v[96:99], a[48:51], v[64:67], v[96:99]
 s_add_u32 s52, s44, 3
 s_and_b32 s52, s52, 7
 v_mfma_f32_16x16x32_bf16 v[100:103], a[52:55], v[64:67], v[100:103]
 s_lshl_b32 s52, s52, 13
 s_add_u32 s46, s48, s52
 v_mfma_f32_16x16x32_bf16 v[104:107], a[56:59], v[64:67], v[104:107]
 s_add_u32 s47, s46, 4096
 v_mfma_f32_16x16x32_bf16 v[108:111], v[16:19], v[64:67], v[108:111]
 buffer_load_dwordx4 v[64:67], v1, s[20:23], s46 offen offset:0 sc1
 v_mfma_f32_16x16x32_bf16 v[112:115], a[48:51], v[68:71], v[112:115]
 ds_read_b128 v[24:27], v5 offset:6144
 v_mfma_f32_16x16x32_bf16 v[116:119], a[52:55], v[68:71], v[116:119]
 v_mfma_f32_16x16x32_bf16 v[120:123], a[56:59], v[68:71], v[120:123]
 v_mfma_f32_16x16x32_bf16 v[124:127], v[16:19], v[68:71], v[124:127]
 buffer_load_dwordx4 v[68:71], v1, s[20:23], s46 offen offset:1024 sc1
 s_waitcnt vmcnt(14) lgkmcnt(1)
 v_mfma_f32_16x16x32_bf16 v[96:99], a[60:63], v[72:75], v[96:99]
 v_mfma_f32_16x16x32_bf16 v[100:103], a[64:67], v[72:75], v[100:103]
 v_mfma_f32_16x16x32_bf16 v[104:107], a[68:71], v[72:75], v[104:107]
 v_mfma_f32_16x16x32_bf16 v[108:111], v[20:23], v[72:75], v[108:111]
 buffer_load_dwordx4 v[72:75], v1, s[20:23], s46 offen offset:2048 sc1
 v_mfma_f32_16x16x32_bf16 v[112:115], a[60:63], v[76:79], v[112:115]
 ds_read_b128 v[28:31], v5 offset:7168
 v_mfma_f32_16x16x32_bf16 v[116:119], a[64:67], v[76:79], v[116:119]
 v_mfma_f32_16x16x32_bf16 v[120:123], a[68:71], v[76:79], v[120:123]
 v_mfma_f32_16x16x32_bf16 v[124:127], v[20:23], v[76:79], v[124:127]
 buffer_load_dwordx4 v[76:79], v1, s[20:23], s46 offen offset:3072 sc1
 s_waitcnt vmcnt(14) lgkmcnt(1)
 v_mfma_f32_16x16x32_bf16 v[96:99], a[72:75], v[80:83], v[96:99]
 v_mfma_f32_16x16x32_bf16 v[100:103], a[76:79], v[80:83], v[100:103]
 v_mfma_f32_16x16x32_bf16 v[104:107], a[80:83], v[80:83], v[104:107]
 v_mfma_f32_16x16x32_bf16 v[108:111], v[24:27], v[80:83], v[108:111]
 buffer_load_dwordx4 v[80:83], v1, s[20:23], s47 offen offset:0 sc1
 v_mfma_f32_16x16x32_bf16 v[112:115], a[72:75], v[84:87], v[112:115]
 ds_read_b128 v[16:19], v5 offset:8192
 v_mfma_f32_16x16x32_bf16 v[116:119], a[76:79], v[84:87], v[116:119]
 v_mfma_f32_16x16x32_bf16 v[120:123], a[80:83], v[84:87], v[120:123]
 v_mfma_f32_16x16x32_bf16 v[124:127], v[24:27], v[84:87], v[124:127]
 buffer_load_dwordx4 v[84:87], v1, s[20:23], s47 offen offset:1024 sc1
 s_waitcnt vmcnt(14) lgkmcnt(1)
 v_mfma_f32_16x16x32_bf16 v[96:99], a[84:87], v[88:91], v[96:99]
 v_mfma_f32_16x16x32_bf16 v[100:103], a[88:91], v[88:91], v[100:103]
 v_mfma_f32_16x16x32_bf16 v[104:107], a[92:95], v[88:91], v[104:107]
 v_mfma_f32_16x16x32_bf16 v[108:111], v[28:31], v[88:91], v[108:111]
 buffer_load_dwordx4 v[88:91], v1, s[20:23], s47 offen offset:2048 sc1
 v_mfma_f32_16x16x32_bf16 v[112:115], a[84:87], v[92:95], v[112:115]
 ds_read_b128 v[20:23], v5 offset:9216
 v_mfma_f32_16x16x32_bf16 v[116:119], a[88:91], v[92:95], v[116:119]
 v_mfma_f32_16x16x32_bf16 v[120:123], a[92:95], v[92:95], v[120:123]
 v_mfma_f32_16x16x32_bf16 v[124:127], v[28:31], v[92:95], v[124:127]
 buffer_load_dwordx4 v[92:95], v1, s[20:23], s47 offen offset:3072 sc1
 s_waitcnt vmcnt(14) lgkmcnt(1)
 v_mfma_f32_16x16x32_bf16 v[96:99], a[96:99], v[32:35], v[96:99]
 s_add_u32 s52, s44, 4
 s_and_b32 s52, s52, 7
 v_mfma_f32_16x16x32_bf16 v[100:103], a[100:103], v[32:35], v[100:103]
 s_lshl_b32 s52, s52, 13
 s_add_u32 s46, s48, s52
 v_mfma_f32_16x16x32_bf16 v[104:107], a[104:107], v[32:35], v[104:107]
 s_add_u32 s47, s46, 4096
 v_mfma_f32_16x16x32_bf16 v[108:111], v[16:19], v[32:35], v[108:111]
 buffer_load_dwordx4 v[32:35], v1, s[20:23], s46 offen offset:0 sc1
 v_mfma_f32_16x16x32_bf16 v[112:115], a[96:99], v[36:39], v[112:115]
 ds_read_b128 v[24:27], v5 offset:10240
 v_mfma_f32_16x16x32_bf16 v[116:119], a[100:103], v[36:39], v[116:119]
 v_mfma_f32_16x16x32_bf16 v[120:123], a[104:107], v[36:39], v[120:123]
 v_mfma_f32_16x16x32_bf16 v[124:127], v[16:19], v[36:39], v[124:127]
 buffer_load_dwordx4 v[36:39], v1, s[20:23], s46 offen offset:1024 sc1
 s_waitcnt vmcnt(14) lgkmcnt(1)
 v_mfma_f32_16x16x32_bf16 v[96:99], a[108:111], v[40:43], v[96:99]
 v_mfma_f32_16x16x32_bf16 v[100:103], a[112:115], v[40:43], v[100:103]
 v_mfma_f32_16x16x32_bf16 v[104:107], a[116:119], v[40:43], v[104:107]
 v_mfma_f32_16x16x32_bf16 v[108:111], v[20:23], v[40:43], v[108:111]
 buffer_load_dwordx4 v[40:43], v1, s[20:23], s46 offen offset:2048 sc1
 v_mfma_f32_16x16x32_bf16 v[112:115], a[108:111], v[44:47], v[112:115]
 ds_read_b128 v[28:31], v5 offset:11264
 v_mfma_f32_16x16x32_bf16 v[116:119], a[112:115], v[44:47], v[116:119]
 v_mfma_f32_16x16x32_bf16 v[120:123], a[116:119], v[44:47], v[120:123]
 v_mfma_f32_16x16x32_bf16 v[124:127], v[20:23], v[44:47], v[124:127]
 buffer_load_dwordx4 v[44:47], v1, s[20:23], s46 offen offset:3072 sc1
 s_waitcnt vmcnt(14) lgkmcnt(1)
 v_mfma_f32_16x16x32_bf16 v[96:99], a[120:123], v[48:51], v[96:99]
 s_barrier
 v_mfma_f32_16x16x32_bf16 v[100:103], a[124:127], v[48:51], v[100:103]
 v_mfma_f32_16x16x32_bf16 v[104:107], a[128:131], v[48:51], v[104:107]
 v_mfma_f32_16x16x32_bf16 v[108:111], v[24:27], v[48:51], v[108:111]
 buffer_load_dwordx4 v[48:51], v1, s[20:23], s47 offen offset:0 sc1
 v_mfma_f32_16x16x32_bf16 v[112:115], a[120:123], v[52:55], v[112:115]
 ds_read_b128 v[16:19], v5 offset:12288
 v_mfma_f32_16x16x32_bf16 v[116:119], a[124:127], v[52:55], v[116:119]
 v_mfma_f32_16x16x32_bf16 v[120:123], a[128:131], v[52:55], v[120:123]
 v_mfma_f32_16x16x32_bf16 v[124:127], v[24:27], v[52:55], v[124:127]
 buffer_load_dwordx4 v[52:55], v1, s[20:23], s47 offen offset:1024 sc1
 s_waitcnt vmcnt(14) lgkmcnt(1)
 v_mfma_f32_16x16x32_bf16 v[96:99], a[132:135], v[56:59], v[96:99]
 v_mfma_f32_16x16x32_bf16 v[100:103], a[136:139], v[56:59], v[100:103]
 v_mfma_f32_16x16x32_bf16 v[104:107], a[140:143], v[56:59], v[104:107]
 v_mfma_f32_16x16x32_bf16 v[108:111], v[28:31], v[56:59], v[108:111]
 buffer_load_dwordx4 v[56:59], v1, s[20:23], s47 offen offset:2048 sc1
 v_mfma_f32_16x16x32_bf16 v[112:115], a[132:135], v[60:63], v[112:115]
 ds_read_b128 v[20:23], v5 offset:13312
 v_mfma_f32_16x16x32_bf16 v[116:119], a[136:139], v[60:63], v[116:119]
 v_mfma_f32_16x16x32_bf16 v[120:123], a[140:143], v[60:63], v[120:123]
 v_mfma_f32_16x16x32_bf16 v[124:127], v[28:31], v[60:63], v[124:127]
 buffer_load_dwordx4 v[60:63], v1, s[20:23], s47 offen offset:3072 sc1
 s_waitcnt vmcnt(14) lgkmcnt(1)
 v_mfma_f32_16x16x32_bf16 v[96:99], a[144:147], v[64:67], v[96:99]
 s_add_u32 s52, s44, 5
 s_and_b32 s52, s52, 7
 v_mfma_f32_16x16x32_bf16 v[100:103], a[148:151], v[64:67], v[100:103]
 s_lshl_b32 s52, s52, 13
 s_add_u32 s46, s48, s52
 v_mfma_f32_16x16x32_bf16 v[104:107], a[152:155], v[64:67], v[104:107]
 s_add_u32 s47, s46, 4096
 v_mfma_f32_16x16x32_bf16 v[108:111], v[16:19], v[64:67], v[108:111]
 buffer_load_dwordx4 v[64:67], v1, s[20:23], s46 offen offset:0 sc1
 v_mfma_f32_16x16x32_bf16 v[112:115], a[144:147], v[68:71], v[112:115]
 ds_read_b128 v[24:27], v5 offset:14336
 v_mfma_f32_16x16x32_bf16 v[116:119], a[148:151], v[68:71], v[116:119]
 v_mfma_f32_16x16x32_bf16 v[120:123], a[152:155], v[68:71], v[120:123]
 v_mfma_f32_16x16x32_bf16 v[124:127], v[16:19], v[68:71], v[124:127]
 buffer_load_dwordx4 v[68:71], v1, s[20:23], s46 offen offset:1024 sc1
 s_waitcnt vmcnt(14) lgkmcnt(1)
 v_mfma_f32_16x16x32_bf16 v[96:99], a[156:159], v[72:75], v[96:99]
 buffer_load_dword v2, v3, s[20:23], s53 offen sc1
 v_mfma_f32_16x16x32_bf16 v[100:103], a[160:163], v[72:75], v[100:103]
 v_mfma_f32_16x16x32_bf16 v[104:107], a[164:167], v[72:75], v[104:107]
 v_mfma_f32_16x16x32_bf16 v[108:111], v[20:23], v[72:75], v[108:111]
 buffer_load_dwordx4 v[72:75], v1, s[20:23], s46 offen offset:2048 sc1
 v_mfma_f32_16x16x32_bf16 v[112:115], a[156:159], v[76:79], v[112:115]
 ds_read_b128 v[28:31], v5 offset:15360
 v_mfma_f32_16x16x32_bf16 v[116:119], a[160:163], v[76:79], v[116:119]
 v_mfma_f32_16x16x32_bf16 v[120:123], a[164:167], v[76:79], v[120:123]
 v_mfma_f32_16x16x32_bf16 v[124:127], v[20:23], v[76:79], v[124:127]
 buffer_load_dwordx4 v[76:79], v1, s[20:23], s46 offen offset:3072 sc1
 s_waitcnt vmcnt(14) lgkmcnt(1)
 v_mfma_f32_16x16x32_bf16 v[96:99], a[168:171], v[80:83], v[96:99]
 v_mfma_f32_16x16x32_bf16 v[100:103], a[172:175], v[80:83], v[100:103]
 v_mfma_f32_16x16x32_bf16 v[104:107], a[176:179], v[80:83], v[104:107]
 v_mfma_f32_16x16x32_bf16 v[108:111], v[24:27], v[80:83], v[108:111]
 buffer_load_dwordx4 v[80:83], v1, s[20:23], s47 offen offset:0 sc1
 v_mfma_f32_16x16x32_bf16 v[112:115], a[168:171], v[84:87], v[112:115]
 ds_read_b128 v[16:19], v5 offset:16384
 v_mfma_f32_16x16x32_bf16 v[116:119], a[172:175], v[84:87], v[116:119]
 v_mfma_f32_16x16x32_bf16 v[120:123], a[176:179], v[84:87], v[120:123]
 v_mfma_f32_16x16x32_bf16 v[124:127], v[24:27], v[84:87], v[124:127]
 buffer_load_dwordx4 v[84:87], v1, s[20:23], s47 offen offset:1024 sc1
 s_waitcnt vmcnt(14) lgkmcnt(1)
 v_mfma_f32_16x16x32_bf16 v[96:99], a[180:183], v[88:91], v[96:99]
 v_mfma_f32_16x16x32_bf16 v[100:103], a[184:187], v[88:91], v[100:103]
 v_mfma_f32_16x16x32_bf16 v[104:107], a[188:191], v[88:91], v[104:107]
 v_mfma_f32_16x16x32_bf16 v[108:111], v[28:31], v[88:91], v[108:111]
 buffer_load_dwordx4 v[88:91], v1, s[20:23], s47 offen offset:2048 sc1
 v_mfma_f32_16x16x32_bf16 v[112:115], a[180:183], v[92:95], v[112:115]
 ds_read_b128 v[20:23], v5 offset:17408
 v_mfma_f32_16x16x32_bf16 v[116:119], a[184:187], v[92:95], v[116:119]
 v_mfma_f32_16x16x32_bf16 v[120:123], a[188:191], v[92:95], v[120:123]
 v_mfma_f32_16x16x32_bf16 v[124:127], v[28:31], v[92:95], v[124:127]
 buffer_load_dwordx4 v[92:95], v1, s[20:23], s47 offen offset:3072 sc1
 s_waitcnt vmcnt(14) lgkmcnt(1)
 v_mfma_f32_16x16x32_bf16 v[96:99], a[192:195], v[32:35], v[96:99]
 s_add_u32 s52, s44, 6
 s_and_b32 s52, s52, 7
 v_mfma_f32_16x16x32_bf16 v[100:103], a[196:199], v[32:35], v[100:103]
 s_lshl_b32 s52, s52, 13
 s_add_u32 s46, s48, s52
 v_mfma_f32_16x16x32_bf16 v[104:107], a[200:203], v[32:35], v[104:107]
 s_add_u32 s47, s46, 4096
 v_mfma_f32_16x16x32_bf16 v[108:111], v[16:19], v[32:35], v[108:111]
 buffer_load_dwordx4 v[32:35], v1, s[20:23], s46 offen offset:0 sc1
 v_mfma_f32_16x16x32_bf16 v[112:115], a[192:195], v[36:39], v[112:115]
 ds_read_b128 v[24:27], v5 offset:18432
 v_mfma_f32_16x16x32_bf16 v[116:119], a[196:199], v[36:39], v[116:119]
 v_mfma_f32_16x16x32_bf16 v[120:123], a[200:203], v[36:39], v[120:123]
 v_mfma_f32_16x16x32_bf16 v[124:127], v[16:19], v[36:39], v[124:127]
 buffer_load_dwordx4 v[36:39], v1, s[20:23], s46 offen offset:1024 sc1
 s_waitcnt vmcnt(14) lgkmcnt(1)
 v_mfma_f32_16x16x32_bf16 v[96:99], a[204:207], v[40:43], v[96:99]
 v_mfma_f32_16x16x32_bf16 v[100:103], a[208:211], v[40:43], v[100:103]
 v_mfma_f32_16x16x32_bf16 v[104:107], a[212:215], v[40:43], v[104:107]
 v_mfma_f32_16x16x32_bf16 v[108:111], v[20:23], v[40:43], v[108:111]
 buffer_load_dwordx4 v[40:43], v1, s[20:23], s46 offen offset:2048 sc1
 v_mfma_f32_16x16x32_bf16 v[112:115], a[204:207], v[44:47], v[112:115]
 ds_read_b128 v[28:31], v5 offset:19456
 v_mfma_f32_16x16x32_bf16 v[116:119], a[208:211], v[44:47], v[116:119]
 v_mfma_f32_16x16x32_bf16 v[120:123], a[212:215], v[44:47], v[120:123]
 v_mfma_f32_16x16x32_bf16 v[124:127], v[20:23], v[44:47], v[124:127]
 buffer_load_dwordx4 v[44:47], v1, s[20:23], s46 offen offset:3072 sc1
 s_waitcnt vmcnt(14) lgkmcnt(1)
 v_mfma_f32_16x16x32_bf16 v[96:99], a[216:219], v[48:51], v[96:99]
 v_mfma_f32_16x16x32_bf16 v[100:103], a[220:223], v[48:51], v[100:103]
 v_mfma_f32_16x16x32_bf16 v[104:107], a[224:227], v[48:51], v[104:107]
 v_mfma_f32_16x16x32_bf16 v[108:111], v[24:27], v[48:51], v[108:111]
 buffer_load_dwordx4 v[48:51], v1, s[20:23], s47 offen offset:0 sc1
 v_mfma_f32_16x16x32_bf16 v[112:115], a[216:219], v[52:55], v[112:115]
 ds_read_b128 v[16:19], v5 offset:20480
 v_mfma_f32_16x16x32_bf16 v[116:119], a[220:223], v[52:55], v[116:119]
 v_mfma_f32_16x16x32_bf16 v[120:123], a[224:227], v[52:55], v[120:123]
 v_mfma_f32_16x16x32_bf16 v[124:127], v[24:27], v[52:55], v[124:127]
 buffer_load_dwordx4 v[52:55], v1, s[20:23], s47 offen offset:1024 sc1
 s_waitcnt vmcnt(14) lgkmcnt(1)
 v_mfma_f32_16x16x32_bf16 v[96:99], a[228:231], v[56:59], v[96:99]
 v_mfma_f32_16x16x32_bf16 v[100:103], a[232:235], v[56:59], v[100:103]
 v_mfma_f32_16x16x32_bf16 v[104:107], a[236:239], v[56:59], v[104:107]
 v_mfma_f32_16x16x32_bf16 v[108:111], v[28:31], v[56:59], v[108:111]
 buffer_load_dwordx4 v[56:59], v1, s[20:23], s47 offen offset:2048 sc1
 v_mfma_f32_16x16x32_bf16 v[112:115], a[228:231], v[60:63], v[112:115]
 ds_read_b128 v[20:23], v5 offset:21504
 v_mfma_f32_16x16x32_bf16 v[116:119], a[232:235], v[60:63], v[116:119]
 v_mfma_f32_16x16x32_bf16 v[120:123], a[236:239], v[60:63], v[120:123]
 v_mfma_f32_16x16x32_bf16 v[124:127], v[28:31], v[60:63], v[124:127]
 buffer_load_dwordx4 v[60:63], v1, s[20:23], s47 offen offset:3072 sc1
 s_waitcnt vmcnt(14) lgkmcnt(1)
 v_mfma_f32_16x16x32_bf16 v[96:99], a[240:243], v[64:67], v[96:99]
 s_add_u32 s52, s44, 7
 s_and_b32 s52, s52, 7
 v_mfma_f32_16x16x32_bf16 v[100:103], a[244:247], v[64:67], v[100:103]
 s_lshl_b32 s52, s52, 13
 s_add_u32 s46, s48, s52
 v_mfma_f32_16x16x32_bf16 v[104:107], a[248:251], v[64:67], v[104:107]
 s_add_u32 s47, s46, 4096
 v_mfma_f32_16x16x32_bf16 v[108:111], v[16:19], v[64:67], v[108:111]
 buffer_load_dwordx4 v[64:67], v1, s[20:23], s46 offen offset:0 sc1
 v_mfma_f32_16x16x32_bf16 v[112:115], a[240:243], v[68:71], v[112:115]
 ds_read_b128 v[24:27], v5 offset:22528
 v_mfma_f32_16x16x32_bf16 v[116:119], a[244:247], v[68:71], v[116:119]
 v_mfma_f32_16x16x32_bf16 v[120:123], a[248:251], v[68:71], v[120:123]
 v_mfma_f32_16x16x32_bf16 v[124:127], v[16:19], v[68:71], v[124:127]
 buffer_load_dwordx4 v[68:71], v1, s[20:23], s46 offen offset:1024 sc1
 s_waitcnt vmcnt(14) lgkmcnt(1)
 v_mfma_f32_16x16x32_bf16 v[96:99], a[252:255], v[72:75], v[96:99]
 v_mfma_f32_16x16x32_bf16 v[100:103], v[128:131], v[72:75], v[100:103]
 v_mfma_f32_16x16x32_bf16 v[104:107], v[132:135], v[72:75], v[104:107]
 v_mfma_f32_16x16x32_bf16 v[108:111], v[20:23], v[72:75], v[108:111]
 buffer_load_dwordx4 v[72:75], v1, s[20:23], s46 offen offset:2048 sc1
 v_mfma_f32_16x16x32_bf16 v[112:115], a[252:255], v[76:79], v[112:115]
 ds_read_b128 v[28:31], v5 offset:23552
 v_mfma_f32_16x16x32_bf16 v[116:119], v[128:131], v[76:79], v[116:119]
 v_mfma_f32_16x16x32_bf16 v[120:123], v[132:135], v[76:79], v[120:123]
 v_mfma_f32_16x16x32_bf16 v[124:127], v[20:23], v[76:79], v[124:127]
 buffer_load_dwordx4 v[76:79], v1, s[20:23], s46 offen offset:3072 sc1
 s_waitcnt vmcnt(14) lgkmcnt(1)
 v_mfma_f32_16x16x32_bf16 v[96:99], v[136:139], v[80:83], v[96:99]
 v_cmp_gt_u32 vcc, s51, v2
 v_mfma_f32_16x16x32_bf16 v[100:103], v[140:143], v[80:83], v[100:103]
 v_mfma_f32_16x16x32_bf16 v[104:107], v[144:147], v[80:83], v[104:107]
 v_mfma_f32_16x16x32_bf16 v[108:111], v[24:27], v[80:83], v[108:111]
 buffer_load_dwordx4 v[80:83], v1, s[20:23], s47 offen offset:0 sc1
 v_mfma_f32_16x16x32_bf16 v[112:115], v[136:139], v[84:87], v[112:115]
 ds_read_b128 v[16:19], v5 offset:24576
 v_mfma_f32_16x16x32_bf16 v[116:119], v[140:143], v[84:87], v[116:119]
 v_mfma_f32_16x16x32_bf16 v[120:123], v[144:147], v[84:87], v[120:123]
 v_mfma_f32_16x16x32_bf16 v[124:127], v[24:27], v[84:87], v[124:127]
 buffer_load_dwordx4 v[84:87], v1, s[20:23], s47 offen offset:1024 sc1
 s_waitcnt vmcnt(14) lgkmcnt(1)
 v_mfma_f32_16x16x32_bf16 v[96:99], v[148:151], v[88:91], v[96:99]
 s_and_b32 s52, vcc_lo, 0xffff
 s_cbranch_scc1 Losw_48
Loswk_49:
 v_mfma_f32_16x16x32_bf16 v[100:103], v[152:155], v[88:91], v[100:103]
 s_lshl_b32 s48, s42, 18
 s_add_u32 s48, s48, s36
 v_mfma_f32_16x16x32_bf16 v[104:107], v[156:159], v[88:91], v[104:107]
 v_mfma_f32_16x16x32_bf16 v[108:111], v[28:31], v[88:91], v[108:111]
 buffer_load_dwordx4 v[88:91], v1, s[20:23], s47 offen offset:2048 sc1
 v_mfma_f32_16x16x32_bf16 v[112:115], v[148:151], v[92:95], v[112:115]
 ds_read_b128 v[20:23], v5 offset:25600
 v_mfma_f32_16x16x32_bf16 v[116:119], v[152:155], v[92:95], v[116:119]
 v_mfma_f32_16x16x32_bf16 v[120:123], v[156:159], v[92:95], v[120:123]
 v_mfma_f32_16x16x32_bf16 v[124:127], v[28:31], v[92:95], v[124:127]
 buffer_load_dwordx4 v[92:95], v1, s[20:23], s47 offen offset:3072 sc1
 s_waitcnt vmcnt(14) lgkmcnt(1)
 v_mfma_f32_16x16x32_bf16 v[96:99], v[160:163], v[32:35], v[96:99]
 s_add_u32 s52, s44, 0
 s_and_b32 s52, s52, 7
 v_mfma_f32_16x16x32_bf16 v[100:103], v[164:167], v[32:35], v[100:103]
 s_lshl_b32 s52, s52, 13
 s_add_u32 s46, s48, s52
 v_mfma_f32_16x16x32_bf16 v[104:107], v[168:171], v[32:35], v[104:107]
 s_add_u32 s47, s46, 4096
 v_mfma_f32_16x16x32_bf16 v[108:111], v[16:19], v[32:35], v[108:111]
 buffer_load_dwordx4 v[32:35], v1, s[20:23], s46 offen offset:0 sc1
 v_mfma_f32_16x16x32_bf16 v[112:115], v[160:163], v[36:39], v[112:115]
 ds_read_b128 v[24:27], v5 offset:26624
 v_mfma_f32_16x16x32_bf16 v[116:119], v[164:167], v[36:39], v[116:119]
 v_mfma_f32_16x16x32_bf16 v[120:123], v[168:171], v[36:39], v[120:123]
 v_mfma_f32_16x16x32_bf16 v[124:127], v[16:19], v[36:39], v[124:127]
 buffer_load_dwordx4 v[36:39], v1, s[20:23], s46 offen offset:1024 sc1
 s_waitcnt vmcnt(14) lgkmcnt(1)
 v_mfma_f32_16x16x32_bf16 v[96:99], v[172:175], v[40:43], v[96:99]
 v_mfma_f32_16x16x32_bf16 v[100:103], v[176:179], v[40:43], v[100:103]
 v_mfma_f32_16x16x32_bf16 v[104:107], v[180:183], v[40:43], v[104:107]
 v_mfma_f32_16x16x32_bf16 v[108:111], v[20:23], v[40:43], v[108:111]
 buffer_load_dwordx4 v[40:43], v1, s[20:23], s46 offen offset:2048 sc1
 v_mfma_f32_16x16x32_bf16 v[112:115], v[172:175], v[44:47], v[112:115]
 ds_read_b128 v[28:31], v5 offset:27648
 v_mfma_f32_16x16x32_bf16 v[116:119], v[176:179], v[44:47], v[116:119]
 v_mfma_f32_16x16x32_bf16 v[120:123], v[180:183], v[44:47], v[120:123]
 v_mfma_f32_16x16x32_bf16 v[124:127], v[20:23], v[44:47], v[124:127]
 buffer_load_dwordx4 v[44:47], v1, s[20:23], s46 offen offset:3072 sc1
 s_waitcnt vmcnt(14) lgkmcnt(1)
 v_mfma_f32_16x16x32_bf16 v[96:99], v[184:187], v[48:51], v[96:99]
 v_mfma_f32_16x16x32_bf16 v[100:103], v[188:191], v[48:51], v[100:103]
 v_mfma_f32_16x16x32_bf16 v[104:107], v[192:195], v[48:51], v[104:107]
 v_mfma_f32_16x16x32_bf16 v[108:111], v[24:27], v[48:51], v[108:111]
 buffer_load_dwordx4 v[48:51], v1, s[20:23], s47 offen offset:0 sc1
 v_mfma_f32_16x16x32_bf16 v[112:115], v[184:187], v[52:55], v[112:115]
 ds_read_b128 v[16:19], v5 offset:28672
 v_mfma_f32_16x16x32_bf16 v[116:119], v[188:191], v[52:55], v[116:119]
 v_mfma_f32_16x16x32_bf16 v[120:123], v[192:195], v[52:55], v[120:123]
 v_mfma_f32_16x16x32_bf16 v[124:127], v[24:27], v[52:55], v[124:127]
 buffer_load_dwordx4 v[52:55], v1, s[20:23], s47 offen offset:1024 sc1
 s_waitcnt vmcnt(14) lgkmcnt(1)
 v_mfma_f32_16x16x32_bf16 v[96:99], v[196:199], v[56:59], v[96:99]
 v_mfma_f32_16x16x32_bf16 v[100:103], v[200:203], v[56:59], v[100:103]
 v_mfma_f32_16x16x32_bf16 v[104:107], v[204:207], v[56:59], v[104:107]
 v_mfma_f32_16x16x32_bf16 v[108:111], v[28:31], v[56:59], v[108:111]
 buffer_load_dwordx4 v[56:59], v1, s[20:23], s47 offen offset:2048 sc1
 v_mfma_f32_16x16x32_bf16 v[112:115], v[196:199], v[60:63], v[112:115]
 ds_read_b128 v[20:23], v5 offset:29696
 v_mfma_f32_16x16x32_bf16 v[116:119], v[200:203], v[60:63], v[116:119]
 v_mfma_f32_16x16x32_bf16 v[120:123], v[204:207], v[60:63], v[120:123]
 v_mfma_f32_16x16x32_bf16 v[124:127], v[28:31], v[60:63], v[124:127]
 buffer_load_dwordx4 v[60:63], v1, s[20:23], s47 offen offset:3072 sc1
 s_waitcnt vmcnt(14) lgkmcnt(1)
 v_mfma_f32_16x16x32_bf16 v[96:99], v[208:211], v[64:67], v[96:99]
 s_add_u32 s52, s44, 1
 s_and_b32 s52, s52, 7
 v_mfma_f32_16x16x32_bf16 v[100:103], v[212:215], v[64:67], v[100:103]
 s_lshl_b32 s52, s52, 13
 s_add_u32 s46, s48, s52
 v_mfma_f32_16x16x32_bf16 v[104:107], v[216:219], v[64:67], v[104:107]
 s_add_u32 s47, s46, 4096
 v_mfma_f32_16x16x32_bf16 v[108:111], v[16:19], v[64:67], v[108:111]
 buffer_load_dwordx4 v[64:67], v1, s[20:23], s46 offen offset:0 sc1
 v_mfma_f32_16x16x32_bf16 v[112:115], v[208:211], v[68:71], v[112:115]
 ds_read_b128 v[24:27], v5 offset:30720
 v_mfma_f32_16x16x32_bf16 v[116:119], v[212:215], v[68:71], v[116:119]
 v_mfma_f32_16x16x32_bf16 v[120:123], v[216:219], v[68:71], v[120:123]
 v_mfma_f32_16x16x32_bf16 v[124:127], v[16:19], v[68:71], v[124:127]
 buffer_load_dwordx4 v[68:71], v1, s[20:23], s46 offen offset:1024 sc1
 s_waitcnt vmcnt(14) lgkmcnt(1)
 v_mfma_f32_16x16x32_bf16 v[96:99], v[220:223], v[72:75], v[96:99]
 v_mfma_f32_16x16x32_bf16 v[100:103], v[224:227], v[72:75], v[100:103]
 v_mfma_f32_16x16x32_bf16 v[104:107], v[228:231], v[72:75], v[104:107]
 v_mfma_f32_16x16x32_bf16 v[108:111], v[20:23], v[72:75], v[108:111]
 buffer_load_dwordx4 v[72:75], v1, s[20:23], s46 offen offset:2048 sc1
 v_mfma_f32_16x16x32_bf16 v[112:115], v[220:223], v[76:79], v[112:115]
 ds_read_b128 v[28:31], v5 offset:31744
 v_mfma_f32_16x16x32_bf16 v[116:119], v[224:227], v[76:79], v[116:119]
 v_mfma_f32_16x16x32_bf16 v[120:123], v[228:231], v[76:79], v[120:123]
 v_mfma_f32_16x16x32_bf16 v[124:127], v[20:23], v[76:79], v[124:127]
 buffer_load_dwordx4 v[76:79], v1, s[20:23], s46 offen offset:3072 sc1
 s_waitcnt vmcnt(14) lgkmcnt(1)
 v_mfma_f32_16x16x32_bf16 v[96:99], v[232:235], v[80:83], v[96:99]
 v_mfma_f32_16x16x32_bf16 v[100:103], v[236:239], v[80:83], v[100:103]
 v_mfma_f32_16x16x32_bf16 v[104:107], v[240:243], v[80:83], v[104:107]
 v_mfma_f32_16x16x32_bf16 v[108:111], v[24:27], v[80:83], v[108:111]
 buffer_load_dwordx4 v[80:83], v1, s[20:23], s47 offen offset:0 sc1
 v_mfma_f32_16x16x32_bf16 v[112:115], v[232:235], v[84:87], v[112:115]
 ds_read_b128 v[16:19], v5 offset:0
 v_mfma_f32_16x16x32_bf16 v[116:119], v[236:239], v[84:87], v[116:119]
 v_mfma_f32_16x16x32_bf16 v[120:123], v[240:243], v[84:87], v[120:123]
 v_mfma_f32_16x16x32_bf16 v[124:127], v[24:27], v[84:87], v[124:127]
 buffer_load_dwordx4 v[84:87], v1, s[20:23], s47 offen offset:1024 sc1
 s_waitcnt vmcnt(14) lgkmcnt(1)
 v_mfma_f32_16x16x32_bf16 v[96:99], v[244:247], v[88:91], v[96:99]
 v_mfma_f32_16x16x32_bf16 v[100:103], v[248:251], v[88:91], v[100:103]
 v_mfma_f32_16x16x32_bf16 v[104:107], v[252:255], v[88:91], v[104:107]
 v_mfma_f32_16x16x32_bf16 v[108:111], v[28:31], v[88:91], v[108:111]
 buffer_load_dwordx4 v[88:91], v1, s[20:23], s47 offen offset:2048 sc1
 v_mfma_f32_16x16x32_bf16 v[112:115], v[244:247], v[92:95], v[112:115]
 ds_read_b128 v[20:23], v5 offset:1024
 v_mfma_f32_16x16x32_bf16 v[116:119], v[248:251], v[92:95], v[116:119]
 v_mfma_f32_16x16x32_bf16 v[120:123], v[252:255], v[92:95], v[120:123]
 v_mfma_f32_16x16x32_bf16 v[124:127], v[28:31], v[92:95], v[124:127]
 buffer_load_dwordx4 v[92:95], v1, s[20:23], s47 offen offset:3072 sc1
 s_cmp_lt_u32 s43, s35
 ds_write_b128 v14, v[96:99] offset:32768
 ds_write_b128 v15, v[100:103] offset:33792
 ds_write_b128 v14, v[104:107] offset:34816
 ds_write_b128 v15, v[108:111] offset:35840
 ds_write_b128 v14, v[112:115] offset:36864
 ds_write_b128 v15, v[116:119] offset:37888
 ds_write_b128 v14, v[120:123] offset:38912
 ds_write_b128 v15, v[124:127] offset:39936
 s_waitcnt lgkmcnt(0)
 s_barrier
 ds_read_b128 v[96:99], v4 offset:0
 ds_read_b128 v[100:103], v4 offset:256
 ds_read_b128 v[104:107], v4 offset:40960
 ds_read_b128 v[108:111], v4 offset:41216
 ds_read_b128 v[112:115], v7 offset:0
 ds_read_b128 v[116:119], v7 offset:256
 ds_read_b128 v[120:123], v7 offset:40960
 ds_read_b128 v[124:127], v7 offset:41216
 s_waitcnt lgkmcnt(4)
 v_pk_add_f32 v[96:97], v[96:97], v[104:105]
 v_pk_add_f32 v[98:99], v[98:99], v[106:107]
 v_pk_add_f32 v[100:101], v[100:101], v[108:109]
 v_pk_add_f32 v[102:103], v[102:103], v[110:111]
 s_waitcnt lgkmcnt(2)
 v_pk_add_f32 v[96:97], v[96:97], v[112:113]
 v_pk_add_f32 v[98:99], v[98:99], v[114:115]
 v_pk_add_f32 v[100:101], v[100:101], v[116:117]
 v_pk_add_f32 v[102:103], v[102:103], v[118:119]
 s_waitcnt lgkmcnt(0)
 v_pk_add_f32 v[96:97], v[96:97], v[120:121]
 v_pk_add_f32 v[98:99], v[98:99], v[122:123]
 v_pk_add_f32 v[100:101], v[100:101], v[124:125]
 v_pk_add_f32 v[102:103], v[102:103], v[126:127]
 v_cvt_pk_bf16_f32 v8, v96, v97
 v_cvt_pk_bf16_f32 v9, v98, v99
 v_cvt_pk_bf16_f32 v10, v100, v101
 v_cvt_pk_bf16_f32 v11, v102, v103
 buffer_store_dwordx4 v[8:11], v6, s[24:27], s54 offen
 s_cbranch_scc1 Losl_47
 s_branch Lose_50
Losw_48:
 buffer_load_dword v2, v3, s[20:23], s53 offen sc1
 s_waitcnt vmcnt(0)
 v_cmp_gt_u32 vcc, s51, v2
 s_and_b32 s52, vcc_lo, 0xffff
 s_cbranch_scc0 Loswk_49
 s_sleep 4
 s_sub_u32 s50, s50, 1
 s_cbranch_scc0 Losw_48
 s_endpgm
Lose_50:
 s_waitcnt vmcnt(0)
 s_branch Lfin
Lchain:
 s_load_dwordx2 s[8:9], s[0:1], 64
 s_mov_b32 s10, 0x480000
 s_mov_b32 s11, 0x20000
 s_load_dwordx2 s[12:13], s[0:1], 72
 s_mov_b32 s14, 0x480000
 s_mov_b32 s15, 0x20000
 s_load_dwordx2 s[16:17], s[0:1], 80
 s_mov_b32 s18, 0x480000
 s_mov_b32 s19, 0x20000
 s_load_dwordx2 s[24:25], s[0:1], 88
 s_mov_b32 s26, 0x480000
 s_mov_b32 s27, 0x20000
 s_load_dwordx2 s[28:29], s[0:1], 112
 s_mov_b32 s30, 0x100
 s_mov_b32 s31, 0x20000
 s_load_dwordx2 s[32:33], s[0:1], 56
 s_mov_b32 s34, 0x2400
 s_mov_b32 s35, 0x20000
 v_and_b32 v20, 63, v0
 v_lshlrev_b32 v3, 4, v20
 v_mov_b32 v7, 0
 s_mov_b32 s48, 0xcccccccc
 s_mov_b32 s49, 0xcccccccc
 v_mov_b32 v21, 0x44444444
 v_mov_b32 v22, 0xeeeeeeee
 v_cndmask_b32 v5, v21, v22, s[48:49]
 s_lshl_b32 s47, s4, 10
 s_add_u32 s47, s47, 19456
 v_and_b32 v21, 48, v20
 v_lshl_add_u32 v21, v21, 3, s47
 v_and_b32 v22, 8, v20
 v_lshl_add_u32 v21, v22, 2, v21
 v_and_b32 v22, 1, v20
 v_lshl_add_u32 v21, v22, 4, v21
 v_and_b32 v22, 6, v20
 v_lshl_add_u32 v8, v22, 1, v21
 v_and_b32 v21, 32, v20
 v_lshlrev_b32 v21, 5, v21
 v_and_b32 v22, 12, v20
 v_lshl_add_u32 v21, v22, 5, v21
 v_and_b32 v22, 1, v20
 v_lshl_add_u32 v21, v22, 6, v21
 v_and_b32 v22, 16, v20
 v_lshl_add_u32 v21, v22, 1, v21
 v_and_b32 v22, 2, v20
 v_lshl_add_u32 v9, v22, 3, v21
 v_lshrrev_b32 v21, 4, v0
 v_lshlrev_b32 v21, 7, v21
 v_and_b32 v22, 15, v20
 v_lshl_add_u32 v21, v22, 2, v21
 v_add_u32 v10, 17408, v21
 v_and_b32 v22, 1, v20
 v_and_b32 v21, 12, v20
 v_lshlrev_b32 v21, 5, v21
 v_lshl_add_u32 v21, v22, 6, v21
 v_and_b32 v22, 48, v20
 v_add_u32 v11, v21, v22
 s_mov_b32 s55, 0x3e0293ee
 s_mov_b32 s54, 0x40000
 s_lshl_b32 s47, s6, 6
 s_add_u32 s60, s47, 0x100000
 s_add_u32 s61, s47, 0x101000
 s_add_u32 s62, s47, 0x102000
 s_lshl_b32 s47, s6, 7
 s_add_u32 s56, s47, 0x0
 s_add_u32 s57, s47, 0x1000
 s_mul_i32 s47, s6, 10496
 s_add_u32 s40, s47, 0x102000
 s_lshl_b32 s58, s4, 11
 s_add_u32 s47, s47, s58
 s_add_u32 s39, s47, 0x100000
 s_lshl_b32 s42, s4, 11
 s_add_u32 s41, s42, 0x1e0000
 s_mov_b32 s43, 0x1e2000
 s_lshr_b32 s69, s4, 1
 s_lshl_b32 s69, s69, 11
 s_and_b32 s47, s4, 1
 s_lshl_b32 s47, s47, 3
 s_add_u32 s69, s69, s47
 s_lshl_b32 s47, s6, 5
 s_add_u32 s65, s47, 0x1e2000
 s_add_u32 s66, s47, 0x162000
 s_lshr_b32 s47, s6, 3
 s_lshl_b32 s47, s47, 9
 s_and_b32 s58, s6, 1
 s_lshl_b32 s58, s58, 8
 s_add_u32 s47, s47, s58
 s_and_b32 s58, s6, 6
 s_lshl_b32 s58, s58, 5
 s_add_u32 s47, s47, s58
 s_lshl_b32 s58, s4, 11
 s_add_u32 s47, s47, s58
 s_add_u32 s44, s47, 0x1e0000
 s_add_u32 s45, s47, 0x160000
 s_lshl_b32 s47, s6, 14
 s_add_u32 s37, s47, 0x3000000
 s_add_u32 s67, s37, s58
 s_add_u32 s59, s67, 8192
 s_lshl_b32 s47, s6, 12
 s_add_u32 s38, s47, 0x3e0000
 s_mov_b32 s36, 0
 s_mov_b32 s46, 0
 s_waitcnt lgkmcnt(0)
 v_and_b32 v30, 63, v0
 v_bfe_u32 v31, v30, 1, 2
 v_lshrrev_b32 v32, 5, v30
 v_xor_b32 v31, v31, v32
 v_lshlrev_b32 v31, 5, v31
 v_and_b32 v32, 1, v30
 v_lshl_add_u32 v31, v32, 4, v31
 v_xor_b32 v33, 64, v31
 v_lshrrev_b32 v32, 3, v30
 s_lshl_b32 s47, s4, 4
 v_and_b32 v34, 3, v32
 v_lshrrev_b32 v35, 2, v32
 v_lshl_add_u32 v34, v34, 1, v35
 v_add_u32 v34, s47, v34
 v_lshl_add_u32 v12, v34, 13, v31
 v_add_u32 v34, 8, v34
 v_lshl_add_u32 v13, v34, 13, v33
 v_and_b32 v34, 1, v32
 v_lshlrev_b32 v34, 6, v34
 v_and_b32 v35, 6, v32
 s_lshl_b32 s47, s4, 3
 v_add3_u32 v34, v34, v35, s47
 v_lshl_add_u32 v56, v34, 13, v31
 v_mul_u32_u24 v35, 1152, v34
 v_add_u32 v14, v35, v31
 v_add_u32 v34, 1, v34
 v_lshl_add_u32 v57, v34, 13, v33
 v_mul_u32_u24 v35, 1152, v34
 v_add_u32 v15, v35, v33
 v_bfe_u32 v31, v30, 4, 1
 v_bfe_u32 v32, v30, 3, 1
 v_lshl_add_u32 v33, v32, 1, v31
 v_xor_b32 v33, s4, v33
 v_lshlrev_b32 v33, 5, v33
 v_lshl_add_u32 v33, v31, 9, v33
 v_lshl_add_u32 v33, v32, 10, v33
 v_bfe_u32 v31, v30, 2, 1
 v_lshl_add_u32 v33, v31, 7, v33
 v_lshrrev_b32 v31, 5, v30
 v_lshl_add_u32 v33, v31, 11, v33
 v_and_b32 v31, 3, v30
 v_lshl_add_u32 v16, v31, 3, v33
 v_add_u32 v17, 0x10000, v16
 v_add_u32 v18, 0x20000, v16
 v_lshlrev_b32 v60, 4, v0
 v_add_u32 v61, 0x10000, v60
 v_add_u32 v62, 0x20000, v60
 s_lshl_b32 s70, s6, 8
 s_mul_i32 s71, s6, 147456
 s_lshl_b32 s72, s4, 11
 s_lshl_b32 s47, s4, 4
 v_add_u32 v31, s47, v30
 s_lshr_b32 s47, s4, 1
 s_lshl_b32 s47, s47, 5
 v_add_u32 v32, s47, v31
 v_lshrrev_b32 v33, 4, v30
 v_lshlrev_b32 v33, 28, v33
 v_lshl_or_b32 v58, v31, 13, v33
 v_lshl_or_b32 v19, v32, 13, v33
 v_mul_u32_u24 v32, 1152, v32
 v_or_b32 v59, v32, v33
 s_add_u32 m0, s72, 24576
 s_add_u32 s47, s70, 0
 buffer_load_dwordx4 v56, s[8:11], s47 offen  lds
 s_add_u32 m0, s72, 25600
 s_nop 0
 buffer_load_dwordx4 v57, s[8:11], s47 offen  lds
 s_add_u32 m0, s72, 32768
 s_add_u32 s47, s70, 128
 buffer_load_dwordx4 v56, s[8:11], s47 offen  lds
 s_add_u32 m0, s72, 33792
 s_nop 0
 buffer_load_dwordx4 v57, s[8:11], s47 offen  lds
 s_add_u32 m0, s72, 40960
 s_add_u32 s47, s70, 0
 buffer_load_dwordx4 v56, s[12:15], s47 offen  lds
 s_add_u32 m0, s72, 41984
 s_nop 0
 buffer_load_dwordx4 v57, s[12:15], s47 offen  lds
 s_add_u32 m0, s72, 49152
 s_add_u32 s47, s70, 0
 buffer_load_dwordx4 v56, s[16:19], s47 offen  lds
 s_add_u32 m0, s72, 50176
 s_nop 0
 buffer_load_dwordx4 v57, s[16:19], s47 offen  lds
 s_add_u32 m0, s72, 57344
 s_add_u32 s47, s70, 128
 buffer_load_dwordx4 v56, s[16:19], s47 offen  lds
 s_add_u32 m0, s72, 58368
 s_nop 0
 buffer_load_dwordx4 v57, s[16:19], s47 offen  lds
 s_add_u32 m0, s72, 65536
 s_add_u32 s47, s70, 262144
 buffer_load_dwordx4 v56, s[8:11], s47 offen  lds
 s_add_u32 m0, s72, 66560
 s_nop 0
 buffer_load_dwordx4 v57, s[8:11], s47 offen  lds
 s_add_u32 m0, s72, 73728
 s_add_u32 s47, s70, 262272
 buffer_load_dwordx4 v56, s[8:11], s47 offen  lds
 s_add_u32 m0, s72, 74752
 s_nop 0
 buffer_load_dwordx4 v57, s[8:11], s47 offen  lds
 s_add_u32 m0, s72, 81920
 s_add_u32 s47, s70, 262144
 buffer_load_dwordx4 v56, s[12:15], s47 offen  lds
 s_add_u32 m0, s72, 82944
 s_nop 0
 buffer_load_dwordx4 v57, s[12:15], s47 offen  lds
 s_waitcnt vmcnt(14)
 s_waitcnt lgkmcnt(0)
 s_barrier
 s_add_u32 m0, s72, 90112
 s_add_u32 s47, s70, 262144
 buffer_load_dwordx4 v56, s[16:19], s47 offen  lds
 s_add_u32 m0, s72, 91136
 s_nop 0
 buffer_load_dwordx4 v57, s[16:19], s47 offen  lds
 v_mbcnt_lo_u32_b32 v69, -1, 0
 v_min_u32 v69, 1, v69
 v_lshlrev_b32 v69, 28, v69
 buffer_load_dword v68, v69, s[28:31], 0 offen offset:4 sc1
 ds_read_b64_tr_b16 v[72:73], v16 offset:24576
 ds_read_b64_tr_b16 v[74:75], v16 offset:24832
 ds_read_b64_tr_b16 v[76:77], v16 offset:28672
 ds_read_b64_tr_b16 v[78:79], v16 offset:28928
 s_waitcnt vmcnt(15)
 s_waitcnt lgkmcnt(0)
 s_barrier
 s_add_u32 m0, s72, 98304
 s_add_u32 s47, s70, 262272
 buffer_load_dwordx4 v56, s[16:19], s47 offen  lds
 s_add_u32 m0, s72, 99328
 s_nop 0
 buffer_load_dwordx4 v57, s[16:19], s47 offen  lds
 ds_read_b64_tr_b16 v[80:81], v16 offset:32768
 ds_read_b64_tr_b16 v[82:83], v16 offset:33024
 ds_read_b64_tr_b16 v[84:85], v16 offset:36864
 ds_read_b64_tr_b16 v[86:87], v16 offset:37120
 s_waitcnt vmcnt(15)
 s_waitcnt lgkmcnt(0)
 s_barrier
 s_add_u32 m0, s72, 106496
 s_add_u32 s47, s70, 1048576
 buffer_load_dwordx4 v56, s[8:11], s47 offen  lds
 s_add_u32 m0, s72, 107520
 s_nop 0
 buffer_load_dwordx4 v57, s[8:11], s47 offen  lds
 ds_read_b64_tr_b16 v[88:89], v16 offset:40960
 ds_read_b64_tr_b16 v[90:91], v16 offset:41216
 ds_read_b64_tr_b16 v[92:93], v16 offset:45056
 ds_read_b64_tr_b16 v[94:95], v16 offset:45312
 s_waitcnt vmcnt(15)
 s_waitcnt lgkmcnt(0)
 s_barrier
 s_add_u32 m0, s72, 114688
 s_add_u32 s47, s70, 1048704
 buffer_load_dwordx4 v56, s[8:11], s47 offen  lds
 s_add_u32 m0, s72, 115712
 s_nop 0
 buffer_load_dwordx4 v57, s[8:11], s47 offen  lds
 ds_read_b64_tr_b16 v[96:97], v16 offset:49152
 ds_read_b64_tr_b16 v[98:99], v16 offset:49408
 ds_read_b64_tr_b16 v[100:101], v16 offset:53248
 ds_read_b64_tr_b16 v[102:103], v16 offset:53504
 s_waitcnt vmcnt(15)
 s_waitcnt lgkmcnt(0)
 s_barrier
 s_add_u32 m0, s72, 122880
 s_add_u32 s47, s70, 1048576
 buffer_load_dwordx4 v56, s[12:15], s47 offen  lds
 s_add_u32 m0, s72, 123904
 s_nop 0
 buffer_load_dwordx4 v57, s[12:15], s47 offen  lds
 ds_read_b64_tr_b16 v[104:105], v16 offset:57344
 ds_read_b64_tr_b16 v[106:107], v16 offset:57600
 ds_read_b64_tr_b16 v[108:109], v16 offset:61440
 ds_read_b64_tr_b16 v[110:111], v16 offset:61696
 s_waitcnt vmcnt(15)
 s_waitcnt lgkmcnt(0)
 s_barrier
 s_add_u32 m0, s72, 131072
 s_add_u32 s47, s70, 1048576
 buffer_load_dwordx4 v56, s[16:19], s47 offen  lds
 s_add_u32 m0, s72, 132096
 s_nop 0
 buffer_load_dwordx4 v57, s[16:19], s47 offen  lds
 ds_read_b64_tr_b16 v[112:113], v17 offset:0
 ds_read_b64_tr_b16 v[114:115], v17 offset:256
 ds_read_b64_tr_b16 v[116:117], v17 offset:4096
 ds_read_b64_tr_b16 v[118:119], v17 offset:4352
 s_waitcnt vmcnt(15)
 s_waitcnt lgkmcnt(0)
 s_barrier
 s_add_u32 m0, s72, 139264
 s_add_u32 s47, s70, 1048704
 buffer_load_dwordx4 v56, s[16:19], s47 offen  lds
 s_add_u32 m0, s72, 140288
 s_nop 0
 buffer_load_dwordx4 v57, s[16:19], s47 offen  lds
 ds_read_b64_tr_b16 v[120:121], v17 offset:8192
 ds_read_b64_tr_b16 v[122:123], v17 offset:8448
 ds_read_b64_tr_b16 v[124:125], v17 offset:12288
 ds_read_b64_tr_b16 v[126:127], v17 offset:12544
 s_waitcnt vmcnt(15)
 s_waitcnt lgkmcnt(0)
 s_barrier
 s_add_u32 m0, s72, 147456
 s_add_u32 s47, s70, 1310720
 buffer_load_dwordx4 v56, s[8:11], s47 offen  lds
 s_add_u32 m0, s72, 148480
 s_nop 0
 buffer_load_dwordx4 v57, s[8:11], s47 offen  lds
 ds_read_b64_tr_b16 v[128:129], v17 offset:16384
 ds_read_b64_tr_b16 v[130:131], v17 offset:16640
 ds_read_b64_tr_b16 v[132:133], v17 offset:20480
 ds_read_b64_tr_b16 v[134:135], v17 offset:20736
 s_waitcnt vmcnt(15)
 s_waitcnt lgkmcnt(0)
 s_barrier
 s_add_u32 m0, s72, 155648
 s_add_u32 s47, s70, 1310848
 buffer_load_dwordx4 v56, s[8:11], s47 offen  lds
 s_add_u32 m0, s72, 156672
 s_nop 0
 buffer_load_dwordx4 v57, s[8:11], s47 offen  lds
 ds_read_b64_tr_b16 v[136:137], v17 offset:24576
 ds_read_b64_tr_b16 v[138:139], v17 offset:24832
 ds_read_b64_tr_b16 v[140:141], v17 offset:28672
 ds_read_b64_tr_b16 v[142:143], v17 offset:28928
 s_waitcnt vmcnt(14)
 s_waitcnt lgkmcnt(0)
 s_barrier
 s_add_u32 m0, s72, 24576
 s_add_u32 s47, s70, 1310720
 buffer_load_dwordx4 v56, s[12:15], s47 offen  lds
 s_add_u32 m0, s72, 25600
 s_nop 0
 buffer_load_dwordx4 v57, s[12:15], s47 offen  lds
 s_branch Lrhc_52
Lrh_51:
 v_mbcnt_lo_u32_b32 v69, -1, 0
 v_min_u32 v69, 1, v69
 v_lshlrev_b32 v69, 28, v69
 buffer_load_dword v68, v69, s[28:31], 0 offen offset:4 sc1
 s_waitcnt vmcnt(0)
Lrhc_52:
 v_readfirstlane_b32 s89, v68
 s_cmp_eq_u32 s89, s88
 s_cbranch_scc1 Lrhk_53
 s_cmp_lg_u32 s89, 0
 s_cbranch_scc1 Lredo
 s_sub_u32 s95, s95, 1
 s_cbranch_scc0 Lrh_51
 s_endpgm
Lrhk_53:
 v_mov_b32 v20, 0
 v_mov_b32 v21, 0
 v_mov_b32 v22, 0
 v_mov_b32 v23, 0
 v_mov_b32 v27, -1
 v_bfe_u32 v24, v3, 8, 1
 v_bfe_u32 v25, v3, 9, 1
 v_lshl_or_b32 v24, v24, 1, v25
 v_bfe_u32 v25, v3, 5, 1
 v_lshl_or_b32 v24, v24, 1, v25
 v_and_b32 v25, 0xd0, v3
 v_lshlrev_b32 v25, 24, v25
 v_lshl_or_b32 v24, v24, 2, v25
 v_bfe_u32 v26, v3, 8, 2
 v_bfe_u32 v25, v3, 2, 4
 v_lshl_or_b32 v26, v26, 4, v25
 v_and_b32 v25, 0xc0, v3
 v_lshl_or_b32 v26, v25, 24, v26
 buffer_store_dwordx4 v[20:23], v3, s[20:23], s39 offen offset:0 sc1
 buffer_store_dwordx4 v[20:23], v3, s[20:23], s39 offen offset:1024 sc1
 buffer_store_dwordx4 v[20:23], v3, s[20:23], s40 offen offset:0 sc1
 buffer_store_dwordx4 v[20:23], v3, s[20:23], s40 offen offset:1024 sc1
 buffer_store_dword v27, v26, s[20:23], s44 offen sc1
 buffer_store_dword v27, v26, s[20:23], s45 offen sc1
 buffer_store_dword v27, v24, s[20:23], s65 offen sc1
 buffer_store_dword v27, v24, s[20:23], s66 offen sc1
 ds_read_b64_tr_b16 v[144:145], v17 offset:32768
 ds_read_b64_tr_b16 v[146:147], v17 offset:33024
 ds_read_b64_tr_b16 v[148:149], v17 offset:36864
 ds_read_b64_tr_b16 v[150:151], v17 offset:37120
 s_waitcnt vmcnt(22)
 s_waitcnt lgkmcnt(0)
 s_barrier
 s_add_u32 m0, s72, 32768
 s_add_u32 s47, s70, 1310720
 buffer_load_dwordx4 v56, s[16:19], s47 offen  lds
 s_add_u32 m0, s72, 33792
 s_nop 0
 buffer_load_dwordx4 v57, s[16:19], s47 offen  lds
 ds_read_b64_tr_b16 v[152:153], v17 offset:40960
 ds_read_b64_tr_b16 v[154:155], v17 offset:41216
 ds_read_b64_tr_b16 v[156:157], v17 offset:45056
 ds_read_b64_tr_b16 v[158:159], v17 offset:45312
 s_waitcnt vmcnt(22)
 s_waitcnt lgkmcnt(0)
 s_barrier
 s_add_u32 m0, s72, 40960
 s_add_u32 s47, s70, 1310848
 buffer_load_dwordx4 v56, s[16:19], s47 offen  lds
 s_add_u32 m0, s72, 41984
 s_nop 0
 buffer_load_dwordx4 v57, s[16:19], s47 offen  lds
 v_lshrrev_b32 v68, 4, v3
 v_bfe_u32 v69, v68, 2, 2
 v_and_b32 v70, 1, v68
 v_lshl_add_u32 v69, v69, 1, v70
 v_mul_u32_u24 v69, 1152, v69
 v_and_b32 v70, 48, v68
 v_and_b32 v71, 2, v68
 v_lshl_add_u32 v71, v71, 2, v70
 v_lshl_add_u32 v71, v71, 1, v69
 v_add_u32 v69, v70, v69
 s_lshr_b32 s47, s4, 1
 s_lshl_b32 s47, s47, 8
 s_and_b32 s58, s4, 1
 s_lshl_b32 s58, s58, 6
 s_add_u32 s47, s47, s58
 buffer_load_dwordx4 v[20:23], v69, s[32:35], s47 offen offset:0
 buffer_load_dwordx4 v[24:27], v69, s[32:35], s47 offen offset:128
 buffer_load_dwordx4 v[28:31], v69, s[32:35], s47 offen offset:512
 buffer_load_dwordx4 v[32:35], v69, s[32:35], s47 offen offset:640
 buffer_load_dwordx4 v[36:39], v71, s[32:35], 0 offen offset:1024
 ds_read_b64_tr_b16 v[160:161], v17 offset:49152
 ds_read_b64_tr_b16 v[162:163], v17 offset:49408
 ds_read_b64_tr_b16 v[164:165], v17 offset:53248
 ds_read_b64_tr_b16 v[166:167], v17 offset:53504
 s_waitcnt vmcnt(27)
 s_waitcnt lgkmcnt(0)
 s_barrier
 s_add_u32 m0, s72, 49152
 s_add_u32 s47, s70, 2097152
 buffer_load_dwordx4 v56, s[8:11], s47 offen  lds
 s_add_u32 m0, s72, 50176
 s_nop 0
 buffer_load_dwordx4 v57, s[8:11], s47 offen  lds
 ds_read_b64_tr_b16 v[168:169], v17 offset:57344
 ds_read_b64_tr_b16 v[170:171], v17 offset:57600
 ds_read_b64_tr_b16 v[172:173], v17 offset:61440
 ds_read_b64_tr_b16 v[174:175], v17 offset:61696
 s_waitcnt vmcnt(27)
 s_waitcnt lgkmcnt(0)
 s_barrier
 s_add_u32 m0, s72, 57344
 s_add_u32 s47, s70, 2097280
 buffer_load_dwordx4 v56, s[8:11], s47 offen  lds
 s_add_u32 m0, s72, 58368
 s_nop 0
 buffer_load_dwordx4 v57, s[8:11], s47 offen  lds
 ds_read_b64_tr_b16 v[176:177], v18 offset:0
 ds_read_b64_tr_b16 v[178:179], v18 offset:256
 ds_read_b64_tr_b16 v[180:181], v18 offset:4096
 ds_read_b64_tr_b16 v[182:183], v18 offset:4352
 s_waitcnt vmcnt(27)
 s_waitcnt lgkmcnt(0)
 s_barrier
 s_add_u32 m0, s72, 65536
 s_add_u32 s47, s70, 2097152
 buffer_load_dwordx4 v56, s[12:15], s47 offen  lds
 s_add_u32 m0, s72, 66560
 s_nop 0
 buffer_load_dwordx4 v57, s[12:15], s47 offen  lds
 ds_read_b64_tr_b16 v[184:185], v18 offset:8192
 ds_read_b64_tr_b16 v[186:187], v18 offset:8448
 ds_read_b64_tr_b16 v[188:189], v18 offset:12288
 ds_read_b64_tr_b16 v[190:191], v18 offset:12544
 s_waitcnt vmcnt(27)
 s_waitcnt lgkmcnt(0)
 s_barrier
 s_add_u32 m0, s72, 73728
 s_add_u32 s47, s70, 2097152
 buffer_load_dwordx4 v56, s[16:19], s47 offen  lds
 s_add_u32 m0, s72, 74752
 s_nop 0
 buffer_load_dwordx4 v57, s[16:19], s47 offen  lds
 ds_read_b64_tr_b16 v[192:193], v18 offset:16384
 ds_read_b64_tr_b16 v[194:195], v18 offset:16640
 ds_read_b64_tr_b16 v[196:197], v18 offset:20480
 ds_read_b64_tr_b16 v[198:199], v18 offset:20736
 s_waitcnt vmcnt(27)
 s_waitcnt lgkmcnt(0)
 s_barrier
 s_add_u32 m0, s72, 81920
 s_add_u32 s47, s70, 2097280
 buffer_load_dwordx4 v56, s[16:19], s47 offen  lds
 s_add_u32 m0, s72, 82944
 s_nop 0
 buffer_load_dwordx4 v57, s[16:19], s47 offen  lds
 ds_read_b64_tr_b16 v[200:201], v18 offset:24576
 ds_read_b64_tr_b16 v[202:203], v18 offset:24832
 ds_read_b64_tr_b16 v[204:205], v18 offset:28672
 ds_read_b64_tr_b16 v[206:207], v18 offset:28928
 s_waitcnt vmcnt(27)
 s_waitcnt lgkmcnt(0)
 s_barrier
 s_add_u32 m0, s72, 90112
 s_add_u32 s47, s70, 2359296
 buffer_load_dwordx4 v56, s[8:11], s47 offen  lds
 s_add_u32 m0, s72, 91136
 s_nop 0
 buffer_load_dwordx4 v57, s[8:11], s47 offen  lds
 ds_read_b64_tr_b16 v[208:209], v16 offset:24576
 ds_read_b64_tr_b16 v[210:211], v16 offset:24832
 ds_read_b64_tr_b16 v[212:213], v16 offset:28672
 ds_read_b64_tr_b16 v[214:215], v16 offset:28928
 s_waitcnt vmcnt(19)
 s_waitcnt lgkmcnt(0)
 s_barrier
 s_add_u32 m0, s72, 98304
 s_add_u32 s47, s70, 2359424
 buffer_load_dwordx4 v56, s[8:11], s47 offen  lds
 s_add_u32 m0, s72, 99328
 s_nop 0
 buffer_load_dwordx4 v57, s[8:11], s47 offen  lds
 ds_read_b64_tr_b16 v[216:217], v16 offset:32768
 ds_read_b64_tr_b16 v[218:219], v16 offset:33024
 ds_read_b64_tr_b16 v[220:221], v16 offset:36864
 ds_read_b64_tr_b16 v[222:223], v16 offset:37120
 s_waitcnt vmcnt(19)
 s_waitcnt lgkmcnt(0)
 s_barrier
 s_add_u32 m0, s72, 106496
 s_add_u32 s47, s70, 2359296
 buffer_load_dwordx4 v56, s[12:15], s47 offen  lds
 s_add_u32 m0, s72, 107520
 s_nop 0
 buffer_load_dwordx4 v57, s[12:15], s47 offen  lds
 ds_read_b64_tr_b16 v[224:225], v16 offset:40960
 ds_read_b64_tr_b16 v[226:227], v16 offset:41216
 ds_read_b64_tr_b16 v[228:229], v16 offset:45056
 ds_read_b64_tr_b16 v[230:231], v16 offset:45312
 s_waitcnt vmcnt(14)
 s_waitcnt lgkmcnt(0)
 s_barrier
 s_add_u32 m0, s72, 114688
 s_add_u32 s47, s70, 2359296
 buffer_load_dwordx4 v56, s[16:19], s47 offen  lds
 s_add_u32 m0, s72, 115712
 s_nop 0
 buffer_load_dwordx4 v57, s[16:19], s47 offen  lds
 s_getreg_b32 s73, hwreg(HW_REG_XCC_ID, 0, 3)
 s_lshl_b32 s73, s73, 3
 s_lshl_b64 s[74:75], 1, s73
 v_mov_b32 v64, s74
 v_mov_b32 v65, s75
 v_mov_b32 v66, 0x7ff00000
 v_cmp_eq_u32 vcc, 0, v0
 s_nop 1
 v_cndmask_b32 v66, v66, v7, vcc
 buffer_atomic_add_x2 v[64:65], v66, s[28:31], 0 offen offset:8
 ds_read_b64_tr_b16 v[232:233], v16 offset:49152
 ds_read_b64_tr_b16 v[234:235], v16 offset:49408
 ds_read_b64_tr_b16 v[236:237], v16 offset:53248
 ds_read_b64_tr_b16 v[238:239], v16 offset:53504
 s_waitcnt vmcnt(15)
 s_waitcnt lgkmcnt(0)
 s_barrier
 s_add_u32 m0, s72, 122880
 s_add_u32 s47, s70, 2359424
 buffer_load_dwordx4 v56, s[16:19], s47 offen  lds
 s_add_u32 m0, s72, 123904
 s_nop 0
 buffer_load_dwordx4 v57, s[16:19], s47 offen  lds
 v_mov_b32 v68, 0x05040100
 v_mov_b32 v69, 0x07060302
 v_cndmask_b32 v70, v68, v69, s[48:49]
 v_perm_b32 v20, v24, v20, v70
 v_perm_b32 v21, v25, v21, v70
 v_perm_b32 v22, v26, v22, v70
 v_perm_b32 v23, v27, v23, v70
 v_perm_b32 v28, v32, v28, v70
 v_perm_b32 v29, v33, v29, v70
 v_perm_b32 v30, v34, v30, v70
 v_perm_b32 v31, v35, v31, v70
 v_perm_b32 v24, v37, v36, v68
 v_perm_b32 v25, v39, v38, v68
 v_perm_b32 v26, v37, v36, v69
 v_perm_b32 v27, v39, v38, v69
 ds_write_b128 v60, v[20:23]
 ds_write_b128 v60, v[28:31] offset:4096
 ds_write_b128 v3, v[24:27] offset:8192
 ds_read_b64_tr_b16 v[240:241], v16 offset:57344
 ds_read_b64_tr_b16 v[242:243], v16 offset:57600
 ds_read_b64_tr_b16 v[244:245], v16 offset:61440
 ds_read_b64_tr_b16 v[246:247], v16 offset:61696
 s_waitcnt vmcnt(15)
 s_waitcnt lgkmcnt(0)
 s_barrier
 s_add_u32 m0, s72, 131072
 s_add_u32 s47, s70, 3145728
 buffer_load_dwordx4 v56, s[8:11], s47 offen  lds
 s_add_u32 m0, s72, 132096
 s_nop 0
 buffer_load_dwordx4 v57, s[8:11], s47 offen  lds
 ds_read_b64_tr_b16 v[248:249], v17 offset:0
 ds_read_b64_tr_b16 v[250:251], v17 offset:256
 ds_read_b64_tr_b16 v[252:253], v17 offset:4096
 ds_read_b64_tr_b16 v[254:255], v17 offset:4352
 s_waitcnt vmcnt(15)
 s_waitcnt lgkmcnt(0)
 s_barrier
 s_add_u32 m0, s72, 139264
 s_add_u32 s47, s70, 3145856
 buffer_load_dwordx4 v56, s[8:11], s47 offen  lds
 s_add_u32 m0, s72, 140288
 s_nop 0
 buffer_load_dwordx4 v57, s[8:11], s47 offen  lds
 ds_read_b64_tr_b16 a[0:1], v17 offset:8192
 ds_read_b64_tr_b16 a[2:3], v17 offset:8448
 ds_read_b64_tr_b16 a[4:5], v17 offset:12288
 ds_read_b64_tr_b16 a[6:7], v17 offset:12544
 s_waitcnt vmcnt(15)
 s_waitcnt lgkmcnt(0)
 s_barrier
 s_add_u32 m0, s72, 147456
 s_add_u32 s47, s70, 3145728
 buffer_load_dwordx4 v56, s[12:15], s47 offen  lds
 s_add_u32 m0, s72, 148480
 s_nop 0
 buffer_load_dwordx4 v57, s[12:15], s47 offen  lds
 ds_read_b64_tr_b16 a[8:9], v17 offset:16384
 ds_read_b64_tr_b16 a[10:11], v17 offset:16640
 ds_read_b64_tr_b16 a[12:13], v17 offset:20480
 ds_read_b64_tr_b16 a[14:15], v17 offset:20736
 s_waitcnt vmcnt(15)
 s_waitcnt lgkmcnt(0)
 s_barrier
 s_add_u32 m0, s72, 155648
 s_add_u32 s47, s70, 3145728
 buffer_load_dwordx4 v56, s[16:19], s47 offen  lds
 s_add_u32 m0, s72, 156672
 s_nop 0
 buffer_load_dwordx4 v57, s[16:19], s47 offen  lds
 ds_read_b64_tr_b16 a[16:17], v17 offset:24576
 ds_read_b64_tr_b16 a[18:19], v17 offset:24832
 ds_read_b64_tr_b16 a[20:21], v17 offset:28672
 ds_read_b64_tr_b16 a[22:23], v17 offset:28928
 s_waitcnt vmcnt(15)
 s_waitcnt lgkmcnt(0)
 s_barrier
 s_add_u32 m0, s72, 24576
 s_add_u32 s47, s70, 3145856
 buffer_load_dwordx4 v56, s[16:19], s47 offen  lds
 s_add_u32 m0, s72, 25600
 s_nop 0
 buffer_load_dwordx4 v57, s[16:19], s47 offen  lds
 ds_read_b64_tr_b16 a[24:25], v17 offset:32768
 ds_read_b64_tr_b16 a[26:27], v17 offset:33024
 ds_read_b64_tr_b16 a[28:29], v17 offset:36864
 ds_read_b64_tr_b16 a[30:31], v17 offset:37120
 s_waitcnt vmcnt(15)
 s_waitcnt lgkmcnt(0)
 s_barrier
 s_add_u32 m0, s72, 32768
 s_add_u32 s47, s70, 3407872
 buffer_load_dwordx4 v56, s[8:11], s47 offen  lds
 s_add_u32 m0, s72, 33792
 s_nop 0
 buffer_load_dwordx4 v57, s[8:11], s47 offen  lds
 ds_read_b64_tr_b16 a[32:33], v17 offset:40960
 ds_read_b64_tr_b16 a[34:35], v17 offset:41216
 ds_read_b64_tr_b16 a[36:37], v17 offset:45056
 ds_read_b64_tr_b16 a[38:39], v17 offset:45312
 s_waitcnt vmcnt(15)
 s_waitcnt lgkmcnt(0)
 s_barrier
 s_add_u32 m0, s72, 40960
 s_add_u32 s47, s70, 3408000
 buffer_load_dwordx4 v56, s[8:11], s47 offen  lds
 s_add_u32 m0, s72, 41984
 s_nop 0
 buffer_load_dwordx4 v57, s[8:11], s47 offen  lds
 ds_read_b64_tr_b16 a[40:41], v17 offset:49152
 ds_read_b64_tr_b16 a[42:43], v17 offset:49408
 ds_read_b64_tr_b16 a[44:45], v17 offset:53248
 ds_read_b64_tr_b16 a[46:47], v17 offset:53504
 s_waitcnt vmcnt(14)
 s_waitcnt lgkmcnt(0)
 s_barrier
 s_add_u32 m0, s72, 49152
 s_add_u32 s47, s70, 3407872
 buffer_load_dwordx4 v56, s[12:15], s47 offen  lds
 s_add_u32 m0, s72, 50176
 s_nop 0
 buffer_load_dwordx4 v57, s[12:15], s47 offen  lds
 ds_read_b64_tr_b16 a[48:49], v17 offset:57344
 ds_read_b64_tr_b16 a[50:51], v17 offset:57600
 ds_read_b64_tr_b16 a[52:53], v17 offset:61440
 ds_read_b64_tr_b16 a[54:55], v17 offset:61696
 s_waitcnt vmcnt(14)
 s_waitcnt lgkmcnt(0)
 s_barrier
 s_add_u32 m0, s72, 57344
 s_add_u32 s47, s70, 3407872
 buffer_load_dwordx4 v56, s[16:19], s47 offen  lds
 s_add_u32 m0, s72, 58368
 s_nop 0
 buffer_load_dwordx4 v57, s[16:19], s47 offen  lds
 ds_read_b64_tr_b16 a[56:57], v18 offset:0
 ds_read_b64_tr_b16 a[58:59], v18 offset:256
 ds_read_b64_tr_b16 a[60:61], v18 offset:4096
 ds_read_b64_tr_b16 a[62:63], v18 offset:4352
 s_waitcnt vmcnt(14)
 s_waitcnt lgkmcnt(0)
 s_barrier
 s_add_u32 m0, s72, 65536
 s_add_u32 s47, s70, 3408000
 buffer_load_dwordx4 v56, s[16:19], s47 offen  lds
 s_add_u32 m0, s72, 66560
 s_nop 0
 buffer_load_dwordx4 v57, s[16:19], s47 offen  lds
 ds_read_b64_tr_b16 a[64:65], v18 offset:8192
 ds_read_b64_tr_b16 a[66:67], v18 offset:8448
 ds_read_b64_tr_b16 a[68:69], v18 offset:12288
 ds_read_b64_tr_b16 a[70:71], v18 offset:12544
 s_waitcnt vmcnt(14)
 s_waitcnt lgkmcnt(0)
 s_barrier
 s_add_u32 m0, s72, 73728
 s_add_u32 s47, s70, 4194304
 buffer_load_dwordx4 v12, s[8:11], s47 offen  lds
 s_add_u32 m0, s72, 74752
 s_nop 0
 buffer_load_dwordx4 v13, s[8:11], s47 offen  lds
 ds_read_b64_tr_b16 a[72:73], v18 offset:16384
 ds_read_b64_tr_b16 a[74:75], v18 offset:16640
 ds_read_b64_tr_b16 a[76:77], v18 offset:20480
 ds_read_b64_tr_b16 a[78:79], v18 offset:20736
 s_waitcnt vmcnt(14)
 s_waitcnt lgkmcnt(0)
 s_barrier
 s_add_u32 m0, s72, 81920
 s_add_u32 s47, s70, 4194432
 buffer_load_dwordx4 v12, s[8:11], s47 offen  lds
 s_add_u32 m0, s72, 82944
 s_nop 0
 buffer_load_dwordx4 v13, s[8:11], s47 offen  lds
 ds_read_b64_tr_b16 a[80:81], v18 offset:24576
 ds_read_b64_tr_b16 a[82:83], v18 offset:24832
 ds_read_b64_tr_b16 a[84:85], v18 offset:28672
 ds_read_b64_tr_b16 a[86:87], v18 offset:28928
 s_waitcnt vmcnt(14)
 s_waitcnt lgkmcnt(0)
 s_barrier
 s_add_u32 m0, s72, 90112
 s_add_u32 s47, s70, 4194304
 buffer_load_dwordx4 v12, s[12:15], s47 offen  lds
 s_add_u32 m0, s72, 91136
 s_nop 0
 buffer_load_dwordx4 v13, s[12:15], s47 offen  lds
 v_min_u32 v65, 16, v3
 v_lshlrev_b32 v65, 24, v65
 buffer_load_dwordx4 v[68:71], v65, s[28:31], 0 offen sc1
 ds_read_b64_tr_b16 a[88:89], v16 offset:24576
 ds_read_b64_tr_b16 a[90:91], v16 offset:24832
 ds_read_b64_tr_b16 a[92:93], v16 offset:28672
 ds_read_b64_tr_b16 a[94:95], v16 offset:28928
 s_waitcnt vmcnt(15)
 s_waitcnt lgkmcnt(0)
 s_barrier
 s_add_u32 m0, s72, 98304
 s_add_u32 s47, s70, 4194304
 buffer_load_dwordx4 v12, s[16:19], s47 offen  lds
 s_add_u32 m0, s72, 99328
 s_nop 0
 buffer_load_dwordx4 v13, s[16:19], s47 offen  lds
 ds_read_b64_tr_b16 a[96:97], v16 offset:32768
 ds_read_b64_tr_b16 a[98:99], v16 offset:33024
 ds_read_b64_tr_b16 a[100:101], v16 offset:36864
 ds_read_b64_tr_b16 a[102:103], v16 offset:37120
 s_waitcnt vmcnt(15)
 s_waitcnt lgkmcnt(0)
 s_barrier
 s_add_u32 m0, s72, 106496
 s_add_u32 s47, s70, 4194432
 buffer_load_dwordx4 v12, s[16:19], s47 offen  lds
 s_add_u32 m0, s72, 107520
 s_nop 0
 buffer_load_dwordx4 v13, s[16:19], s47 offen  lds
 ds_read_b64_tr_b16 a[104:105], v16 offset:40960
 ds_read_b64_tr_b16 a[106:107], v16 offset:41216
 ds_read_b64_tr_b16 a[108:109], v16 offset:45056
 ds_read_b64_tr_b16 a[110:111], v16 offset:45312
 s_waitcnt vmcnt(15)
 s_waitcnt lgkmcnt(0)
 s_barrier
 s_add_u32 m0, s72, 114688
 s_add_u32 s47, s71, 0
 buffer_load_dwordx4 v14, s[24:27], s47 offen  lds
 s_add_u32 m0, s72, 115712
 s_nop 0
 buffer_load_dwordx4 v15, s[24:27], s47 offen  lds
 ds_read_b64_tr_b16 a[112:113], v16 offset:49152
 ds_read_b64_tr_b16 a[114:115], v16 offset:49408
 ds_read_b64_tr_b16 a[116:117], v16 offset:53248
 ds_read_b64_tr_b16 a[118:119], v16 offset:53504
 s_waitcnt vmcnt(15)
 s_waitcnt lgkmcnt(0)
 s_barrier
 s_add_u32 m0, s72, 122880
 s_add_u32 s47, s71, 128
 buffer_load_dwordx4 v14, s[24:27], s47 offen  lds
 s_add_u32 m0, s72, 123904
 s_nop 0
 buffer_load_dwordx4 v15, s[24:27], s47 offen  lds
 ds_read_b64_tr_b16 a[120:121], v16 offset:57344
 ds_read_b64_tr_b16 a[122:123], v16 offset:57600
 ds_read_b64_tr_b16 a[124:125], v16 offset:61440
 ds_read_b64_tr_b16 a[126:127], v16 offset:61696
 s_waitcnt vmcnt(15)
 s_waitcnt lgkmcnt(0)
 s_barrier
 s_add_u32 m0, s72, 131072
 s_add_u32 s47, s71, 256
 buffer_load_dwordx4 v14, s[24:27], s47 offen  lds
 s_add_u32 m0, s72, 132096
 s_nop 0
 buffer_load_dwordx4 v15, s[24:27], s47 offen  lds
 ds_read_b64_tr_b16 a[128:129], v17 offset:0
 ds_read_b64_tr_b16 a[130:131], v17 offset:256
 ds_read_b64_tr_b16 a[132:133], v17 offset:4096
 ds_read_b64_tr_b16 a[134:135], v17 offset:4352
 s_waitcnt vmcnt(15)
 s_waitcnt lgkmcnt(0)
 s_barrier
 s_add_u32 m0, s72, 139264
 s_add_u32 s47, s71, 384
 buffer_load_dwordx4 v14, s[24:27], s47 offen  lds
 s_add_u32 m0, s72, 140288
 s_nop 0
 buffer_load_dwordx4 v15, s[24:27], s47 offen  lds
 ds_read_b64_tr_b16 a[136:137], v17 offset:8192
 ds_read_b64_tr_b16 a[138:139], v17 offset:8448
 ds_read_b64_tr_b16 a[140:141], v17 offset:12288
 ds_read_b64_tr_b16 a[142:143], v17 offset:12544
 s_waitcnt vmcnt(15)
 s_waitcnt lgkmcnt(0)
 s_barrier
 s_add_u32 m0, s72, 147456
 s_add_u32 s47, s71, 512
 buffer_load_dwordx4 v14, s[24:27], s47 offen  lds
 s_add_u32 m0, s72, 148480
 s_nop 0
 buffer_load_dwordx4 v15, s[24:27], s47 offen  lds
 ds_read_b64_tr_b16 a[144:145], v17 offset:16384
 ds_read_b64_tr_b16 a[146:147], v17 offset:16640
 ds_read_b64_tr_b16 a[148:149], v17 offset:20480
 ds_read_b64_tr_b16 a[150:151], v17 offset:20736
 s_waitcnt vmcnt(15)
 s_waitcnt lgkmcnt(0)
 s_barrier
 s_add_u32 m0, s72, 155648
 s_add_u32 s47, s71, 640
 buffer_load_dwordx4 v14, s[24:27], s47 offen  lds
 s_add_u32 m0, s72, 156672
 s_nop 0
 buffer_load_dwordx4 v15, s[24:27], s47 offen  lds
 ds_read_b64_tr_b16 a[152:153], v17 offset:24576
 ds_read_b64_tr_b16 a[154:155], v17 offset:24832
 ds_read_b64_tr_b16 a[156:157], v17 offset:28672
 ds_read_b64_tr_b16 a[158:159], v17 offset:28928
 s_waitcnt vmcnt(14)
 s_waitcnt lgkmcnt(0)
 s_barrier
 s_add_u32 m0, s72, 24576
 s_add_u32 s47, s71, 768
 buffer_load_dwordx4 v14, s[24:27], s47 offen  lds
 s_add_u32 m0, s72, 25600
 s_nop 0
 buffer_load_dwordx4 v15, s[24:27], s47 offen  lds
 ds_read_b64_tr_b16 a[160:161], v17 offset:32768
 ds_read_b64_tr_b16 a[162:163], v17 offset:33024
 ds_read_b64_tr_b16 a[164:165], v17 offset:36864
 ds_read_b64_tr_b16 a[166:167], v17 offset:37120
 s_waitcnt vmcnt(14)
 s_waitcnt lgkmcnt(0)
 s_barrier
 s_add_u32 m0, s72, 32768
 s_add_u32 s47, s71, 896
 buffer_load_dwordx4 v14, s[24:27], s47 offen  lds
 s_add_u32 m0, s72, 33792
 s_nop 0
 buffer_load_dwordx4 v15, s[24:27], s47 offen  lds
 s_branch Lhsc_56
Lhs_55:
 buffer_load_dwordx4 v[68:71], v65, s[28:31], 0 offen sc1
 s_waitcnt vmcnt(0)
Lhsc_56:
 v_sad_u8 v69, v70, 0, 0
 v_sad_u8 v69, v71, 0, v69
 v_lshrrev_b32 v69, 5, v69
 v_min_u32 v68, v68, v69
 v_cmp_ne_u32 vcc, 0, v68
 s_cbranch_vccnz Lhsok_57
 s_sub_u32 s54, s54, 1
 s_cbranch_scc0 Lhs_55
 s_endpgm
Lhsok_57:
 v_readfirstlane_b32 s74, v70
 v_readfirstlane_b32 s75, v71
 buffer_load_dwordx4 v[20:23], v3, s[20:23], s39 offen offset:0 sc1
 buffer_load_dwordx4 v[20:23], v3, s[20:23], s39 offen offset:1024 sc1
 buffer_load_dwordx4 v[20:23], v3, s[20:23], s40 offen offset:0 sc1
 buffer_load_dwordx4 v[20:23], v3, s[20:23], s40 offen offset:1024 sc1
 v_lshlrev_b32 v67, 6, v0
 ds_read_b64_tr_b16 a[168:169], v17 offset:40960
 ds_read_b64_tr_b16 a[170:171], v17 offset:41216
 ds_read_b64_tr_b16 a[172:173], v17 offset:45056
 ds_read_b64_tr_b16 a[174:175], v17 offset:45312
 s_waitcnt vmcnt(18)
 s_waitcnt lgkmcnt(0)
 s_barrier
 s_add_u32 m0, s72, 40960
 s_add_u32 s47, s71, 37760
 buffer_load_dwordx4 v14, s[24:27], s47 offen  lds
 s_add_u32 m0, s72, 41984
 s_nop 0
 buffer_load_dwordx4 v15, s[24:27], s47 offen  lds
 ds_read_b64_tr_b16 a[176:177], v17 offset:49152
 ds_read_b64_tr_b16 a[178:179], v17 offset:49408
 ds_read_b64_tr_b16 a[180:181], v17 offset:53248
 ds_read_b64_tr_b16 a[182:183], v17 offset:53504
 s_waitcnt vmcnt(18)
 s_waitcnt lgkmcnt(0)
 s_barrier
 s_add_u32 m0, s72, 49152
 s_add_u32 s47, s71, 1024
 buffer_load_dwordx4 v14, s[24:27], s47 offen  lds
 s_add_u32 m0, s72, 50176
 s_nop 0
 buffer_load_dwordx4 v15, s[24:27], s47 offen  lds
 ds_read_b64_tr_b16 a[184:185], v17 offset:57344
 ds_read_b64_tr_b16 a[186:187], v17 offset:57600
 ds_read_b64_tr_b16 a[188:189], v17 offset:61440
 ds_read_b64_tr_b16 a[190:191], v17 offset:61696
 s_waitcnt vmcnt(18)
 s_waitcnt lgkmcnt(0)
 s_barrier
 s_add_u32 m0, s72, 57344
 s_add_u32 s47, s70, 1310848
 buffer_load_dwordx4 v56, s[12:15], s47 offen  lds
 s_add_u32 m0, s72, 58368
 s_nop 0
 buffer_load_dwordx4 v57, s[12:15], s47 offen  lds
 ds_read_b64_tr_b16 a[192:193], v18 offset:0
 ds_read_b64_tr_b16 a[194:195], v18 offset:256
 ds_read_b64_tr_b16 a[196:197], v18 offset:4096
 ds_read_b64_tr_b16 a[198:199], v18 offset:4352
 s_waitcnt vmcnt(18)
 s_waitcnt lgkmcnt(0)
 s_barrier
 s_add_u32 m0, s72, 65536
 s_add_u32 s47, s70, 2097280
 buffer_load_dwordx4 v56, s[12:15], s47 offen  lds
 s_add_u32 m0, s72, 66560
 s_nop 0
 buffer_load_dwordx4 v57, s[12:15], s47 offen  lds
 s_lshl_b32 s47, s6, 2
 s_add_u32 s47, s47, 0x4000
 v_mov_b32 v64, 1
 buffer_store_dword v64, v66, s[20:23], s47 offen
 ds_read_b64_tr_b16 a[200:201], v18 offset:8192
 ds_read_b64_tr_b16 a[202:203], v18 offset:8448
 ds_read_b64_tr_b16 a[204:205], v18 offset:12288
 ds_read_b64_tr_b16 a[206:207], v18 offset:12544
 s_waitcnt vmcnt(19)
 s_waitcnt lgkmcnt(0)
 s_barrier
 s_add_u32 m0, s72, 73728
 s_add_u32 s47, s70, 2359424
 buffer_load_dwordx4 v56, s[12:15], s47 offen  lds
 s_add_u32 m0, s72, 74752
 s_nop 0
 buffer_load_dwordx4 v57, s[12:15], s47 offen  lds
 ds_read_b64_tr_b16 a[208:209], v18 offset:16384
 ds_read_b64_tr_b16 a[210:211], v18 offset:16640
 ds_read_b64_tr_b16 a[212:213], v18 offset:20480
 ds_read_b64_tr_b16 a[214:215], v18 offset:20736
 s_waitcnt vmcnt(19)
 s_waitcnt lgkmcnt(0)
 s_barrier
 s_add_u32 m0, s72, 81920
 s_add_u32 s47, s70, 3145856
 buffer_load_dwordx4 v56, s[12:15], s47 offen  lds
 s_add_u32 m0, s72, 82944
 s_nop 0
 buffer_load_dwordx4 v57, s[12:15], s47 offen  lds
 ds_read_b64_tr_b16 a[216:217], v18 offset:24576
 ds_read_b64_tr_b16 a[218:219], v18 offset:24832
 ds_read_b64_tr_b16 a[220:221], v18 offset:28672
 ds_read_b64_tr_b16 a[222:223], v18 offset:28928
 s_waitcnt vmcnt(19)
 s_waitcnt lgkmcnt(0)
 s_barrier
 s_add_u32 m0, s72, 90112
 s_add_u32 s47, s70, 3408000
 buffer_load_dwordx4 v56, s[12:15], s47 offen  lds
 s_add_u32 m0, s72, 91136
 s_nop 0
 buffer_load_dwordx4 v57, s[12:15], s47 offen  lds
 ds_read_b64_tr_b16 a[224:225], v16 offset:24576
 ds_read_b64_tr_b16 a[226:227], v16 offset:24832
 ds_read_b64_tr_b16 a[228:229], v16 offset:28672
 ds_read_b64_tr_b16 a[230:231], v16 offset:28928
 s_waitcnt vmcnt(19)
 s_waitcnt lgkmcnt(0)
 s_barrier
 s_add_u32 m0, s72, 98304
 s_add_u32 s47, s71, 37888
 buffer_load_dwordx4 v14, s[24:27], s47 offen  lds
 s_add_u32 m0, s72, 99328
 s_nop 0
 buffer_load_dwordx4 v15, s[24:27], s47 offen  lds
 s_and_b32 s47, s6, 29
 s_cbranch_scc1 Lgt_58
 buffer_store_dword v64, v66, s[28:31], 0 offen offset:128 sc1
Lgt_58:
 ds_read_b64_tr_b16 a[232:233], v16 offset:32768
 ds_read_b64_tr_b16 a[234:235], v16 offset:33024
 ds_read_b64_tr_b16 a[236:237], v16 offset:36864
 ds_read_b64_tr_b16 a[238:239], v16 offset:37120
 s_waitcnt vmcnt(15)
 s_waitcnt lgkmcnt(0)
 s_barrier
 s_add_u32 m0, s72, 106496
 s_add_u32 s47, s71, 36864
 buffer_load_dwordx4 v14, s[24:27], s47 offen  lds
 s_add_u32 m0, s72, 107520
 s_nop 0
 buffer_load_dwordx4 v15, s[24:27], s47 offen  lds
 ds_read_b64_tr_b16 a[240:241], v16 offset:40960
 ds_read_b64_tr_b16 a[242:243], v16 offset:41216
 ds_read_b64_tr_b16 a[244:245], v16 offset:45056
 ds_read_b64_tr_b16 a[246:247], v16 offset:45312
 s_waitcnt vmcnt(15)
 s_waitcnt lgkmcnt(0)
 s_barrier
 s_add_u32 m0, s72, 114688
 s_add_u32 s47, s71, 36992
 buffer_load_dwordx4 v14, s[24:27], s47 offen  lds
 s_add_u32 m0, s72, 115712
 s_nop 0
 buffer_load_dwordx4 v15, s[24:27], s47 offen  lds
 ds_read_b64_tr_b16 a[248:249], v16 offset:49152
 ds_read_b64_tr_b16 a[250:251], v16 offset:49408
 ds_read_b64_tr_b16 a[252:253], v16 offset:53248
 ds_read_b64_tr_b16 a[254:255], v16 offset:53504
 s_waitcnt vmcnt(15)
 s_waitcnt lgkmcnt(0)
 s_barrier
 s_add_u32 m0, s72, 122880
 s_add_u32 s47, s71, 37120
 buffer_load_dwordx4 v14, s[24:27], s47 offen  lds
 s_add_u32 m0, s72, 123904
 s_nop 0
 buffer_load_dwordx4 v15, s[24:27], s47 offen  lds
 v_lshrrev_b32 v68, 2, v3
 s_mov_b32 s47, 0x4000
 buffer_load_dword v68, v68, s[20:23], s47 offen sc1
 ds_read_b64_tr_b16 v[48:49], v16 offset:57344
 ds_read_b64_tr_b16 v[50:51], v16 offset:57600
 ds_read_b64_tr_b16 v[52:53], v16 offset:61440
 ds_read_b64_tr_b16 v[54:55], v16 offset:61696
 s_waitcnt vmcnt(16)
 s_waitcnt lgkmcnt(0)
 s_barrier
 s_add_u32 m0, s72, 131072
 s_add_u32 s47, s71, 37248
 buffer_load_dwordx4 v14, s[24:27], s47 offen  lds
 s_add_u32 m0, s72, 132096
 s_nop 0
 buffer_load_dwordx4 v15, s[24:27], s47 offen  lds
 ds_write_b128 v60, v[48:51] offset:57344
 ds_write_b128 v60, v[52:55] offset:61440
 ds_read_b64_tr_b16 v[40:41], v17 offset:0
 ds_read_b64_tr_b16 v[42:43], v17 offset:256
 ds_read_b64_tr_b16 v[44:45], v17 offset:4096
 ds_read_b64_tr_b16 v[46:47], v17 offset:4352
 s_waitcnt vmcnt(15)
 s_waitcnt lgkmcnt(0)
 s_barrier
 s_add_u32 m0, s72, 139264
 s_add_u32 s47, s71, 37376
 buffer_load_dwordx4 v14, s[24:27], s47 offen  lds
 s_add_u32 m0, s72, 140288
 s_nop 0
 buffer_load_dwordx4 v15, s[24:27], s47 offen  lds
 ds_write_b128 v61, v[40:43] offset:0
 ds_write_b128 v61, v[44:47] offset:4096
 ds_read_b64_tr_b16 v[48:49], v17 offset:8192
 ds_read_b64_tr_b16 v[50:51], v17 offset:8448
 ds_read_b64_tr_b16 v[52:53], v17 offset:12288
 ds_read_b64_tr_b16 v[54:55], v17 offset:12544
 s_waitcnt vmcnt(15)
 s_waitcnt lgkmcnt(0)
 s_barrier
 s_add_u32 m0, s72, 147456
 s_add_u32 s47, s71, 37504
 buffer_load_dwordx4 v14, s[24:27], s47 offen  lds
 s_add_u32 m0, s72, 148480
 s_nop 0
 buffer_load_dwordx4 v15, s[24:27], s47 offen  lds
 ds_write_b128 v61, v[48:51] offset:8192
 ds_write_b128 v61, v[52:55] offset:12288
 ds_read_b64_tr_b16 v[40:41], v17 offset:16384
 ds_read_b64_tr_b16 v[42:43], v17 offset:16640
 ds_read_b64_tr_b16 v[44:45], v17 offset:20480
 ds_read_b64_tr_b16 v[46:47], v17 offset:20736
 s_waitcnt vmcnt(15)
 s_waitcnt lgkmcnt(0)
 s_barrier
 s_add_u32 m0, s72, 155648
 s_add_u32 s47, s71, 37632
 buffer_load_dwordx4 v14, s[24:27], s47 offen  lds
 s_add_u32 m0, s72, 156672
 s_nop 0
 buffer_load_dwordx4 v15, s[24:27], s47 offen  lds
 ds_write_b128 v61, v[40:43] offset:16384
 ds_write_b128 v61, v[44:47] offset:20480
 ds_read_b64_tr_b16 v[48:49], v17 offset:24576
 ds_read_b64_tr_b16 v[50:51], v17 offset:24832
 ds_read_b64_tr_b16 v[52:53], v17 offset:28672
 ds_read_b64_tr_b16 v[54:55], v17 offset:28928
 s_waitcnt vmcnt(15)
 s_waitcnt lgkmcnt(0)
 s_barrier
 s_add_u32 m0, s72, 24576
 s_add_u32 s47, s70, 4194432
 buffer_load_dwordx4 v12, s[12:15], s47 offen  lds
 s_add_u32 m0, s72, 25600
 s_nop 0
 buffer_load_dwordx4 v13, s[12:15], s47 offen  lds
 ds_write_b128 v61, v[48:51] offset:24576
 ds_write_b128 v61, v[52:55] offset:28672
 ds_read_b64_tr_b16 v[40:41], v17 offset:32768
 ds_read_b64_tr_b16 v[42:43], v17 offset:33024
 ds_read_b64_tr_b16 v[44:45], v17 offset:36864
 ds_read_b64_tr_b16 v[46:47], v17 offset:37120
 s_waitcnt vmcnt(15)
 s_waitcnt lgkmcnt(0)
 s_barrier
 s_add_u32 m0, s72, 32768
 s_add_u32 s47, s70, 128
 buffer_load_dwordx4 v56, s[12:15], s47 offen  lds
 s_add_u32 m0, s72, 33792
 s_nop 0
 buffer_load_dwordx4 v57, s[12:15], s47 offen  lds
 ds_write_b128 v61, v[40:43] offset:32768
 ds_write_b128 v61, v[44:47] offset:36864
 ds_read_b64_tr_b16 v[48:49], v17 offset:40960
 ds_read_b64_tr_b16 v[50:51], v17 offset:41216
 ds_read_b64_tr_b16 v[52:53], v17 offset:45056
 ds_read_b64_tr_b16 v[54:55], v17 offset:45312
 s_waitcnt vmcnt(15)
 s_waitcnt lgkmcnt(0)
 s_barrier
 s_add_u32 m0, s72, 40960
 s_add_u32 s47, s70, 262272
 buffer_load_dwordx4 v56, s[12:15], s47 offen  lds
 s_add_u32 m0, s72, 41984
 s_nop 0
 buffer_load_dwordx4 v57, s[12:15], s47 offen  lds
 ds_write_b128 v61, v[48:51] offset:40960
 ds_write_b128 v61, v[52:55] offset:45056
 ds_read_b64_tr_b16 v[40:41], v17 offset:49152
 ds_read_b64_tr_b16 v[42:43], v17 offset:49408
 ds_read_b64_tr_b16 v[44:45], v17 offset:53248
 ds_read_b64_tr_b16 v[46:47], v17 offset:53504
 s_waitcnt vmcnt(15)
 s_waitcnt lgkmcnt(0)
 s_barrier
 s_add_u32 m0, s72, 49152
 s_add_u32 s47, s70, 1048704
 buffer_load_dwordx4 v56, s[12:15], s47 offen  lds
 s_add_u32 m0, s72, 50176
 s_nop 0
 buffer_load_dwordx4 v57, s[12:15], s47 offen  lds
 buffer_load_dword v1, v65, s[20:23], s56 offen sc1
 ds_write_b128 v61, v[40:43] offset:49152
 ds_write_b128 v61, v[44:47] offset:53248
 ds_read_b64_tr_b16 v[48:49], v17 offset:57344
 ds_read_b64_tr_b16 v[50:51], v17 offset:57600
 ds_read_b64_tr_b16 v[52:53], v17 offset:61440
 ds_read_b64_tr_b16 v[54:55], v17 offset:61696
 s_waitcnt vmcnt(15)
 s_waitcnt lgkmcnt(0)
 s_barrier
 v_cmp_ne_u32 vcc, 0, v68
 s_mov_b32 s77, vcc_lo
 s_add_u32 s58, s6, 1
 s_and_b32 s58, s58, 31
 s_bitcmp1_b32 s77, s58
 s_cbranch_scc1 Lhlp_59
 s_lshl_b32 s76, s58, 8
 s_mul_i32 s80, s58, 147456
 s_add_u32 s47, s76, 2359424
 buffer_load_dword v63, v19, s[12:15], s47 offen
 s_add_u32 s47, s80, 37888
 buffer_load_dword v63, v59, s[24:27], s47 offen
 s_add_u32 s47, s80, 37120
 buffer_load_dword v63, v59, s[24:27], s47 offen
 s_add_u32 s47, s80, 37504
 buffer_load_dword v63, v59, s[24:27], s47 offen
 s_add_u32 s47, s76, 128
 buffer_load_dword v63, v19, s[12:15], s47 offen
Lhlp_59:
 s_add_u32 s58, s6, 2
 s_and_b32 s58, s58, 31
 s_bitcmp1_b32 s77, s58
 s_cbranch_scc1 Lhlp_60
 s_lshl_b32 s76, s58, 8
 s_mul_i32 s80, s58, 147456
 s_add_u32 s47, s76, 3145856
 buffer_load_dword v63, v19, s[12:15], s47 offen
 s_add_u32 s47, s80, 36864
 buffer_load_dword v63, v59, s[24:27], s47 offen
 s_add_u32 s47, s80, 37248
 buffer_load_dword v63, v59, s[24:27], s47 offen
 s_add_u32 s47, s80, 37632
 buffer_load_dword v63, v59, s[24:27], s47 offen
 s_add_u32 s47, s76, 262272
 buffer_load_dword v63, v19, s[12:15], s47 offen
Lhlp_60:
 s_add_u32 s58, s6, 3
 s_and_b32 s58, s58, 31
 s_bitcmp1_b32 s77, s58
 s_cbranch_scc1 Lhlp_61
 s_lshl_b32 s76, s58, 8
 s_mul_i32 s80, s58, 147456
 s_add_u32 s47, s76, 3408000
 buffer_load_dword v63, v19, s[12:15], s47 offen
 s_add_u32 s47, s80, 36992
 buffer_load_dword v63, v59, s[24:27], s47 offen
 s_add_u32 s47, s80, 37376
 buffer_load_dword v63, v59, s[24:27], s47 offen
 s_add_u32 s47, s76, 4194432
 buffer_load_dword v63, v58, s[12:15], s47 offen
 s_add_u32 s47, s76, 1048704
 buffer_load_dword v63, v19, s[12:15], s47 offen
Lhlp_61:
 ds_write_b128 v61, v[48:51] offset:57344
 ds_write_b128 v61, v[52:55] offset:61440
 ds_read_b64_tr_b16 v[40:41], v18 offset:0
 ds_read_b64_tr_b16 v[42:43], v18 offset:256
 ds_read_b64_tr_b16 v[44:45], v18 offset:4096
 ds_read_b64_tr_b16 v[46:47], v18 offset:4352
 s_waitcnt vmcnt(13)
 s_waitcnt lgkmcnt(0)
 s_barrier
 ds_write_b128 v62, v[40:43] offset:0
 ds_write_b128 v62, v[44:47] offset:4096
 ds_read_b64_tr_b16 v[48:49], v18 offset:8192
 ds_read_b64_tr_b16 v[50:51], v18 offset:8448
 ds_read_b64_tr_b16 v[52:53], v18 offset:12288
 ds_read_b64_tr_b16 v[54:55], v18 offset:12544
 s_waitcnt vmcnt(11)
 s_waitcnt lgkmcnt(0)
 s_barrier
 ds_write_b128 v62, v[48:51] offset:8192
 ds_write_b128 v62, v[52:55] offset:12288
 ds_read_b64_tr_b16 v[40:41], v18 offset:16384
 ds_read_b64_tr_b16 v[42:43], v18 offset:16640
 ds_read_b64_tr_b16 v[44:45], v18 offset:20480
 ds_read_b64_tr_b16 v[46:47], v18 offset:20736
 s_waitcnt vmcnt(9)
 s_waitcnt lgkmcnt(0)
 s_barrier
 ds_write_b128 v62, v[40:43] offset:16384
 ds_write_b128 v62, v[44:47] offset:20480
 ds_read_b64_tr_b16 v[48:49], v18 offset:24576
 ds_read_b64_tr_b16 v[50:51], v18 offset:24832
 ds_read_b64_tr_b16 v[52:53], v18 offset:28672
 ds_read_b64_tr_b16 v[54:55], v18 offset:28928
 s_waitcnt vmcnt(7)
 s_waitcnt lgkmcnt(0)
 s_barrier
 ds_write_b128 v62, v[48:51] offset:24576
 ds_write_b128 v62, v[52:55] offset:28672
 ds_read_b64_tr_b16 v[40:41], v16 offset:24576
 ds_read_b64_tr_b16 v[42:43], v16 offset:24832
 ds_read_b64_tr_b16 v[44:45], v16 offset:28672
 ds_read_b64_tr_b16 v[46:47], v16 offset:28928
 s_waitcnt vmcnt(5)
 s_waitcnt lgkmcnt(0)
 s_barrier
 ds_write_b128 v60, v[40:43] offset:24576
 ds_write_b128 v60, v[44:47] offset:28672
 ds_read_b64_tr_b16 v[48:49], v16 offset:32768
 ds_read_b64_tr_b16 v[50:51], v16 offset:33024
 ds_read_b64_tr_b16 v[52:53], v16 offset:36864
 ds_read_b64_tr_b16 v[54:55], v16 offset:37120
 s_waitcnt vmcnt(3)
 s_waitcnt lgkmcnt(0)
 s_barrier
 ds_write_b128 v60, v[48:51] offset:32768
 ds_write_b128 v60, v[52:55] offset:36864
 ds_read_b64_tr_b16 v[40:41], v16 offset:40960
 ds_read_b64_tr_b16 v[42:43], v16 offset:41216
 ds_read_b64_tr_b16 v[44:45], v16 offset:45056
 ds_read_b64_tr_b16 v[46:47], v16 offset:45312
 s_waitcnt vmcnt(1)
 s_waitcnt lgkmcnt(0)
 s_barrier
 ds_write_b128 v60, v[40:43] offset:40960
 ds_write_b128 v60, v[44:47] offset:45056
 ds_read_b64_tr_b16 v[48:49], v16 offset:49152
 ds_read_b64_tr_b16 v[50:51], v16 offset:49408
 ds_read_b64_tr_b16 v[52:53], v16 offset:53248
 ds_read_b64_tr_b16 v[54:55], v16 offset:53504
 s_waitcnt lgkmcnt(0)
 s_barrier
 ds_write_b128 v60, v[48:51] offset:49152
 ds_write_b128 v60, v[52:55] offset:53248
 v_lshlrev_b32 v0, 4, v0
 s_waitcnt vmcnt(0)
 v_cmp_le_u32 vcc, 2, v1
 s_cbranch_vccnz Lpbk_62
Lpb0_63:
 buffer_load_dword v1, v7, s[20:23], s56 offen sc1
 s_waitcnt vmcnt(0)
 v_cmp_le_u32 vcc, 2, v1
 s_cbranch_vccnz Lpb0ok_64
 s_sub_u32 s54, s54, 1
 s_cbranch_scc0 Lpb0_63
 s_endpgm
Lpb0ok_64:
Lpbk_62:
 s_lshl_b32 s47, s4, 11
 s_add_u32 m0, s47, 9216
 s_add_u32 s68, s37, 0x80000
 buffer_load_dwordx4 v3, s[20:23], s67 offen offset:0 sc1 lds
 buffer_load_dwordx4 v3, s[20:23], s67 offen offset:1024 sc1 lds
 buffer_load_dword v12, v67, s[20:23], s37 offen sc1
 buffer_load_dword v12, v67, s[20:23], s68 offen sc1
 v_mov_b64 v[68:69], 0
 v_mov_b64 v[70:71], 0
 s_add_u32 s68, s68, 0x80000
 s_mov_b32 s24, 0xf000f
 s_mov_b32 s25, 0xf000f
 s_mov_b32 s26, 0xf000f0
 s_mov_b32 s27, 0xf000f0
 s_mov_b32 s28, 0xf000f00
 s_mov_b32 s29, 0xf000f00
 s_mov_b32 s30, 0xf000f000
 s_mov_b32 s31, 0xf000f000
 s_mov_b32 s32, 0xaaaaaaaa
 s_mov_b32 s33, 0xaaaaaaaa
 s_mov_b32 s34, 0x3f803f80
 s_mov_b32 s35, 0x3f803f80
 s_mov_b32 s70, -1
 s_mov_b32 s71, 0
 s_lshl_b32 s47, s4, 12
 s_add_u32 s68, s68, s47
 v_mov_b32 v2, 0
 v_mov_b32 v4, 0
 s_waitcnt lgkmcnt(0)
 ds_read_b128 v[20:23], v0 offset:24576
 ds_read_b128 v[24:27], v0 offset:28672
 ds_read_b128 v[28:31], v0 offset:32768
 ds_read_b128 v[32:35], v0 offset:36864
 v_mov_b64 v[36:37], 0
 v_mov_b64 v[38:39], 0
 v_mov_b64 v[40:41], 0
 v_mov_b64 v[42:43], 0
 v_mov_b64 v[44:45], 0
 v_mov_b64 v[46:47], 0
 v_mov_b64 v[48:49], 0
 v_mov_b64 v[50:51], 0
 v_lshl_add_u32 v1, v3, 3, s68
 v_mov_b32 v6, s56
 v_cndmask_b32 v1, v6, v1, s[70:71]
 v_min_u32 v6, 16, v0
 v_lshlrev_b32 v6, 24, v6
 s_max_u32 s47, s36, 1
 v_add_u32 v2, -1, s47
 s_xor_b32 s44, s44, 0x80000
 s_xor_b32 s45, s45, 0x80000
 s_xor_b32 s65, s65, 0x80000
 s_xor_b32 s66, s66, 0x80000
 s_xor_b32 s41, s41, 0x80000
 s_xor_b32 s43, s43, 0x80000
 s_lshr_b64 s[74:75], s[74:75], s73
 s_and_b32 s74, s74, 0xff
 s_cmp_eq_u32 s74, 32
 s_waitcnt vmcnt(2)
 s_cbranch_scc0 Lslow_65
 .p2align 3
Lstep_67:
 s_mov_b64 exec, -1
 s_waitcnt lgkmcnt(0)
 s_barrier
 ds_read_b128 v[52:55], v3 offset:8192
 ds_read_b128 v[56:59], v3 offset:0
 ds_read_b128 v[60:63], v3 offset:1024
 buffer_store_dwordx4 v[64:67], v0, s[20:23], s38 offen sc1
 s_waitcnt lgkmcnt(2)
 v_smfmac_f32_16x16x64_bf16 v[36:39], v[52:55], a[136:143], v5
 v_smfmac_f32_16x16x64_bf16 v[40:43], v[52:55], a[144:151], v5
 buffer_store_dword v2, v6, s[20:23], s57 offen sc1
 v_smfmac_f32_16x16x64_bf16 v[44:47], v[52:55], a[152:159], v5
 s_waitcnt lgkmcnt(1)
 v_smfmac_f32_16x16x64_bf16 v[48:51], v[52:55], v[20:27], v5
 v_smfmac_f32_16x16x64_bf16 v[36:39], v[56:59], v[72:79], v5
 ds_read_b128 v[20:23], v0 offset:40960
 v_mov_b64 v[64:65], 0
 v_smfmac_f32_16x16x64_bf16 v[40:43], v[56:59], v[80:87], v5
 ds_read_b128 v[24:27], v0 offset:45056
 v_mov_b64 v[66:67], 0
 v_smfmac_f32_16x16x64_bf16 v[44:47], v[56:59], v[88:95], v5
 ds_read_b128 v[52:55], v3 offset:2048
 s_waitcnt lgkmcnt(3)
 v_smfmac_f32_16x16x64_bf16 v[48:51], v[56:59], v[28:35], v5
 v_smfmac_f32_16x16x64_bf16 v[36:39], v[60:63], v[112:119], v5
 ds_read_b128 v[28:31], v0 offset:49152
 v_smfmac_f32_16x16x64_bf16 v[40:43], v[60:63], v[120:127], v5
 ds_read_b128 v[32:35], v0 offset:53248
 v_smfmac_f32_16x16x64_bf16 v[44:47], v[60:63], v[128:135], v5
 ds_read_b128 v[56:59], v3 offset:3072
 v_smfmac_f32_16x16x64_bf16 v[64:67], v[60:63], v[136:143], v5
 v_smfmac_f32_16x16x64_bf16 v[68:71], v[60:63], v[144:151], v5
 s_waitcnt lgkmcnt(3)
 v_smfmac_f32_16x16x64_bf16 v[48:51], v[60:63], v[20:27], v5
 v_smfmac_f32_16x16x64_bf16 v[36:39], v[52:55], v[152:159], v5
 ds_read_b128 v[20:23], v0 offset:57344
 v_smfmac_f32_16x16x64_bf16 v[40:43], v[52:55], v[160:167], v5
 ds_read_b128 v[24:27], v0 offset:61440
 v_smfmac_f32_16x16x64_bf16 v[44:47], v[52:55], v[168:175], v5
 v_smfmac_f32_16x16x64_bf16 v[64:67], v[52:55], v[176:183], v5
 v_smfmac_f32_16x16x64_bf16 v[68:71], v[52:55], v[184:191], v5
 s_waitcnt lgkmcnt(2)
 v_add_u32 v0, 0x10000, v0
 v_smfmac_f32_16x16x64_bf16 v[48:51], v[52:55], v[28:35], v5
 s_branch Ljoin_70
 .p2align 3
LstepB_69:
 s_mov_b64 exec, -1
 buffer_load_dwordx4 v[12:15], v3, s[20:23], s41 offen offset:0 sc1
 buffer_load_dwordx4 v[16:19], v3, s[20:23], s41 offen offset:1024 sc1
 s_waitcnt lgkmcnt(0)
 s_barrier
 ds_read_b128 v[52:55], v3 offset:8192
 ds_read_b128 v[56:59], v3 offset:0
 ds_read_b128 v[60:63], v3 offset:1024
 buffer_store_dwordx4 v[64:67], v0, s[20:23], s38 offen sc1
 s_waitcnt lgkmcnt(2)
 v_smfmac_f32_16x16x64_bf16 v[36:39], v[52:55], a[136:143], v5
 v_smfmac_f32_16x16x64_bf16 v[40:43], v[52:55], a[144:151], v5
 v_smfmac_f32_16x16x64_bf16 v[44:47], v[52:55], a[152:159], v5
 s_waitcnt lgkmcnt(1)
 v_smfmac_f32_16x16x64_bf16 v[48:51], v[52:55], v[20:27], v5
 s_waitcnt vmcnt(3)
 v_smfmac_f32_16x16x64_bf16 v[36:39], v[56:59], v[72:79], v5
 ds_read_b128 v[20:23], v0 offset:40960
 v_mov_b64 v[64:65], 0
 v_smfmac_f32_16x16x64_bf16 v[40:43], v[56:59], v[80:87], v5
 ds_read_b128 v[24:27], v0 offset:45056
 v_mov_b64 v[66:67], 0
 v_smfmac_f32_16x16x64_bf16 v[44:47], v[56:59], v[88:95], v5
 ds_read_b128 v[52:55], v3 offset:2048
 s_waitcnt lgkmcnt(3)
 v_smfmac_f32_16x16x64_bf16 v[48:51], v[56:59], v[28:35], v5
 v_mov_b64 v[68:69], 0
 v_smfmac_f32_16x16x64_bf16 v[36:39], v[60:63], v[112:119], v5
 ds_read_b128 v[28:31], v0 offset:49152
 v_mov_b64 v[70:71], 0
 v_smfmac_f32_16x16x64_bf16 v[40:43], v[60:63], v[120:127], v5
 ds_read_b128 v[32:35], v0 offset:53248
 v_smfmac_f32_16x16x64_bf16 v[44:47], v[60:63], v[128:135], v5
 ds_read_b128 v[56:59], v3 offset:3072
 v_smfmac_f32_16x16x64_bf16 v[64:67], v[60:63], v[136:143], v5
 s_waitcnt vmcnt(1)
 ds_write_b128 v4, v[12:15] offset:0
 v_smfmac_f32_16x16x64_bf16 v[68:71], v[60:63], v[144:151], v5
 s_waitcnt lgkmcnt(4)
 v_smfmac_f32_16x16x64_bf16 v[48:51], v[60:63], v[20:27], v5
 ds_write_b128 v4, v[16:19] offset:1024
 v_max3_u32 v2, v12, v13, v14
 v_smfmac_f32_16x16x64_bf16 v[36:39], v[52:55], v[152:159], v5
 ds_read_b128 v[20:23], v0 offset:57344
 v_max3_u32 v2, v2, v15, v16
 v_smfmac_f32_16x16x64_bf16 v[40:43], v[52:55], v[160:167], v5
 ds_read_b128 v[24:27], v0 offset:61440
 v_max3_u32 v2, v2, v17, v18
 v_smfmac_f32_16x16x64_bf16 v[44:47], v[52:55], v[168:175], v5
 v_max_u32 v2, v2, v19
 v_smfmac_f32_16x16x64_bf16 v[64:67], v[52:55], v[176:183], v5
 v_cmp_eq_u32 vcc, -1, v2
 v_smfmac_f32_16x16x64_bf16 v[68:71], v[52:55], v[184:191], v5
 s_waitcnt lgkmcnt(4)
 v_add_u32 v0, 0x10000, v0
 v_smfmac_f32_16x16x64_bf16 v[48:51], v[52:55], v[28:35], v5
 s_cbranch_vccnz Lyr_71
Lyb_72:
 s_waitcnt lgkmcnt(2)
Ljoin_70:
 v_smfmac_f32_16x16x64_bf16 v[36:39], v[56:59], v[192:199], v5
 ds_read_b128 v[28:31], v0 offset:0
 buffer_load_dwordx4 v[12:15], v3, s[20:23], s59 offen offset:0 sc1
 v_smfmac_f32_16x16x64_bf16 v[40:43], v[56:59], v[200:207], v5
 ds_read_b128 v[32:35], v0 offset:4096
 buffer_load_dwordx4 v[16:19], v3, s[20:23], s59 offen offset:1024 sc1
 v_smfmac_f32_16x16x64_bf16 v[44:47], v[56:59], v[208:215], v5
 s_barrier
 ds_read_b128 v[60:63], v3 offset:4096
 v_smfmac_f32_16x16x64_bf16 v[64:67], v[56:59], v[216:223], v5
 ds_read_b128 v[52:55], v3 offset:5120
 v_smfmac_f32_16x16x64_bf16 v[68:71], v[56:59], v[224:231], v5
 s_waitcnt lgkmcnt(4)
 v_smfmac_f32_16x16x64_bf16 v[48:51], v[56:59], v[20:27], v5
 buffer_load_dword v1, v1, s[20:23], 0 offen sc1
 s_waitcnt lgkmcnt(1)
 v_smfmac_f32_16x16x64_bf16 v[36:39], v[60:63], v[232:239], v5
 ds_read_b128 v[20:23], v0 offset:8192
 v_smfmac_f32_16x16x64_bf16 v[40:43], v[60:63], v[240:247], v5
 ds_read_b128 v[24:27], v0 offset:12288
 v_smfmac_f32_16x16x64_bf16 v[44:47], v[60:63], v[248:255], v5
 ds_read_b128 v[56:59], v3 offset:6144
 s_waitcnt lgkmcnt(3)
 v_smfmac_f32_16x16x64_bf16 v[48:51], v[60:63], v[28:35], v5
 v_smfmac_f32_16x16x64_bf16 v[36:39], v[52:55], a[16:23], v5
 ds_read_b128 v[28:31], v0 offset:16384
 v_smfmac_f32_16x16x64_bf16 v[40:43], v[52:55], a[24:31], v5
 ds_read_b128 v[32:35], v0 offset:20480
 v_smfmac_f32_16x16x64_bf16 v[44:47], v[52:55], a[32:39], v5
 ds_read_b128 v[60:63], v3 offset:7168
 s_waitcnt lgkmcnt(3)
 v_smfmac_f32_16x16x64_bf16 v[48:51], v[52:55], v[20:27], v5
 v_smfmac_f32_16x16x64_bf16 v[36:39], v[56:59], a[56:63], v5
 ds_read_b128 v[20:23], v0 offset:24576
 v_smfmac_f32_16x16x64_bf16 v[40:43], v[56:59], a[64:71], v5
 ds_read_b128 v[24:27], v0 offset:28672
 s_waitcnt lgkmcnt(2)
 v_smfmac_f32_16x16x64_bf16 v[36:39], v[60:63], a[96:103], v5
 v_smfmac_f32_16x16x64_bf16 v[40:43], v[60:63], a[104:111], v5
 v_smfmac_f32_16x16x64_bf16 v[64:67], v[52:55], a[40:47], v5
 s_nop 0
 v_add_f32 v36, v36, v38
 v_smfmac_f32_16x16x64_bf16 v[68:71], v[52:55], a[48:55], v5
 ds_read_b128 v[52:55], v3 offset:8192
 v_add_f32 v37, v37, v39
 v_smfmac_f32_16x16x64_bf16 v[44:47], v[56:59], a[72:79], v5
 v_add_f32 v40, v40, v42
 v_add_f32 v41, v41, v43
 v_smfmac_f32_16x16x64_bf16 v[48:51], v[56:59], v[28:35], v5
 s_waitcnt lgkmcnt(1)
 v_cvt_pk_bf16_f32 v36, v36, v40
 v_smfmac_f32_16x16x64_bf16 v[44:47], v[60:63], a[112:119], v5
 ds_read_b128 v[32:35], v3 offset:11264
 v_cvt_pk_bf16_f32 v37, v37, v41
 v_smfmac_f32_16x16x64_bf16 v[48:51], v[60:63], v[20:27], v5
 ds_write2_b32 v10, v36, v37 offset0:0 offset1:16
 v_smfmac_f32_16x16x64_bf16 v[64:67], v[56:59], a[80:87], v5
 ds_read_b128 v[20:23], v3 offset:9216
 v_add_f32 v44, v44, v46
 v_add_f32 v45, v45, v47
 v_smfmac_f32_16x16x64_bf16 v[68:71], v[56:59], a[88:95], v5
 s_waitcnt lgkmcnt(3)
 v_add_f32 v48, v48, v50
 v_add_f32 v49, v49, v51
 v_cvt_pk_bf16_f32 v44, v44, v48
 v_cvt_pk_bf16_f32 v45, v45, v49
 ds_write2_b32 v8, v44, v45 offset0:0 offset1:16
 v_smfmac_f32_16x16x64_bf16 v[64:67], v[52:55], a[160:167], v5
 ds_read_b128 v[56:59], v3 offset:0
 v_mov_b64 v[28:29], 0
 v_smfmac_f32_16x16x64_bf16 v[68:71], v[52:55], a[168:175], v5
 ds_read_b128 v[52:55], v3 offset:4096
 v_mov_b64 v[30:31], 0
 v_smfmac_f32_16x16x64_bf16 v[64:67], v[60:63], a[120:127], v5
 ds_read_b128 v[24:27], v3 offset:10240
 v_smfmac_f32_16x16x64_bf16 v[68:71], v[60:63], a[128:135], v5
 s_waitcnt lgkmcnt(3)
 s_barrier
 ds_read_b128 v[36:39], v11 offset:17408
 s_waitcnt lgkmcnt(3)
 v_smfmac_f32_16x16x64_bf16 v[64:67], v[56:59], v[96:103], v5
 ds_read_b128 v[40:43], v11 offset:17920
 s_waitcnt lgkmcnt(3)
 v_smfmac_f32_16x16x64_bf16 v[68:71], v[56:59], v[104:111], v5
 ds_read_b128 v[60:63], v9 offset:19456
 ds_read_b128 v[44:47], v11 offset:18432
 v_smfmac_f32_16x16x64_bf16 v[64:67], v[52:55], a[0:7], v5
 ds_read_b128 v[48:51], v11 offset:18944
 v_smfmac_f32_16x16x64_bf16 v[68:71], v[52:55], a[8:15], v5
 ds_read_b128 v[52:55], v3 offset:12288
 s_waitcnt lgkmcnt(5)
 v_mfma_f32_16x16x32_bf16 v[20:23], v[20:23], v[36:39], 0
 ds_read_b128 v[56:59], v9 offset:21504
 v_mfma_f32_16x16x32_bf16 v[24:27], v[24:27], v[36:39], 0
 v_add_f32 v64, v64, v66
 v_add_f32 v65, v65, v67
 s_waitcnt lgkmcnt(5)
 v_mfma_f32_16x16x32_bf16 v[20:23], v[32:35], v[40:43], v[20:23]
 ds_read_b128 v[32:35], v3 offset:13312
 v_cvt_pk_bf16_f32 v2, v64, v65
 v_add_f32 v68, v68, v70
 s_waitcnt lgkmcnt(5)
 v_smfmac_f32_16x16x64_bf16 v[28:31], v[60:63], v[36:43], v5
 ds_read_b128 v[60:63], v3 offset:14336
 ds_read_b128 v[36:39], v3 offset:15360
 v_add_f32 v69, v69, v71
 s_waitcnt lgkmcnt(4)
 v_mfma_f32_16x16x32_bf16 v[24:27], v[52:55], v[40:43], v[24:27]
 ds_read_b128 v[52:55], v3 offset:16384
 v_cvt_pk_bf16_f32 v4, v68, v69
 s_waitcnt lgkmcnt(4)
 v_smfmac_f32_16x16x64_bf16 v[28:31], v[56:59], v[44:51], v5
 ds_read_b128 v[40:43], v0 offset:36864
 s_waitcnt lgkmcnt(4)
 v_mfma_f32_16x16x32_bf16 v[20:23], v[32:35], v[44:47], v[20:23]
 v_mov_b64 v[32:33], s[34:35]
 v_mov_b64 v[34:35], s[34:35]
 s_waitcnt lgkmcnt(3)
 v_mfma_f32_16x16x32_bf16 v[24:27], v[60:63], v[44:47], v[24:27]
 ds_read_b128 v[44:47], v0 offset:40960
 v_add_f32 v28, v28, v30
 v_add_f32 v29, v29, v31
 s_waitcnt lgkmcnt(3)
 v_mfma_f32_16x16x32_bf16 v[20:23], v[36:39], v[48:51], v[20:23]
 ds_read_b128 v[36:39], v0 offset:32768
 v_cndmask_b32 v28, v28, v29, s[48:49]
 v_mul_f32 v28, s55, v28
 s_waitcnt lgkmcnt(3)
 v_mfma_f32_16x16x32_bf16 v[24:27], v[52:55], v[48:51], v[24:27]
 ds_read_b128 v[48:51], v0 offset:45056
 v_exp_f32 v28, v28
 v_mov_b64 v[64:65], 0
 v_cndmask_b32 v29, 0, v28, s[48:49]
 v_cndmask_b32 v28, v28, 0, s[48:49]
 v_cvt_pk_bf16_f32 v6, v28, v29
 v_mov_b64 v[66:67], 0
 v_mov_b64 v[68:69], 0
 v_cndmask_b32 v20, v20, v24, s[48:49]
 v_cndmask_b32 v21, v21, v25, s[48:49]
 v_cndmask_b32 v22, v22, v26, s[48:49]
 v_cndmask_b32 v23, v23, v27, s[48:49]
 v_mfma_f32_16x16x16_bf16 v[60:63], v[6:7], v[32:33], 0
 s_waitcnt vmcnt(1)
 v_exp_f32 v20, v20
 v_mfma_f32_16x16x16_bf16 v[52:55], v[6:7], v[2:3], 0
 s_cmp_eq_u32 s36, 63
 v_exp_f32 v21, v21
 v_mfma_f32_16x16x16_bf16 v[56:59], v[6:7], v[4:5], 0
 v_exp_f32 v22, v22
 v_exp_f32 v23, v23
 v_cvt_pk_bf16_f32 v30, v20, v21
 v_cvt_pk_bf16_f32 v31, v22, v23
 v_mov_b64 v[70:71], 0
 v_mov_b64 v[20:21], 0
 v_smfmac_f32_16x16x32_bf16 v[60:63], v[30:31], v[32:35], v5
 v_mov_b64 v[22:23], 0
 v_mov_b64 v[24:25], 0
 v_smfmac_f32_16x16x32_bf16 v[52:55], v[30:31], v[12:15], v5
 v_mov_b64 v[26:27], 0
 v_smfmac_f32_16x16x32_bf16 v[56:59], v[30:31], v[16:19], v5
 s_nop 0
 v_add_f32 v60, v60, v62
 v_add_f32 v61, v61, v63
 v_rcp_f32 v60, v60
 v_rcp_f32 v61, v61
 v_add_f32 v52, v52, v54
 v_add_f32 v53, v53, v55
 v_mul_f32 v52, v52, v60
 v_mul_f32 v53, v53, v61
 v_add_f32 v56, v56, v58
 v_add_f32 v57, v57, v59
 v_mul_f32 v56, v56, v60
 v_mul_f32 v57, v57, v61
 v_cvt_pk_bf16_f32 v52, v52, v56
 v_cvt_pk_bf16_f32 v53, v53, v57
 ds_write2_b32 v8, v52, v53 offset0:128 offset1:144
 v_subrev_u32 v60, 0x21800000, v60
 v_subrev_u32 v61, 0x21800000, v61
 v_max_u32 v60, v60, v61
 v_cmp_lt_u32 vcc, 0x3c000000, v60
 s_cbranch_scc1 Lchexit_66
 v_mov_b64 v[28:29], 0
 v_mov_b64 v[30:31], 0
 v_mov_b64 v[32:33], 0
 v_mov_b64 v[34:35], 0
 s_cbranch_vccnz Lmx_73
Lmxb_74:
 s_waitcnt lgkmcnt(0)
 v_bfe_u32 v6, v0, 7, 5
 s_barrier
 ds_read_b128 v[52:55], v9 offset:19968
 v_mul_u32_u24 v6, 10496, v6
 ds_read_b128 v[56:59], v9 offset:22016
 ds_read_b128 v[12:15], v0 offset:49152
 v_bfe_u32 v60, v3, 4, 3
 ds_read_b128 v[16:19], v0 offset:53248
 s_add_u32 s67, s67, 0x80000
 v_lshl_add_u32 v6, v60, 3, v6
 s_xor_b32 s46, s46, 0x1
 s_add_u32 s59, s59, 0x80000
 v_mov_b64 v[60:61], 0
 s_add_u32 s38, s38, 0x20000
 v_mov_b64 v[62:63], 0
 s_waitcnt lgkmcnt(3)
 v_smfmac_f32_16x16x64_bf16 v[64:67], v[52:55], a[248:255], v5
 buffer_load_dwordx4 v3, s[20:23], s67 offen offset:0 sc1 lds
 v_smfmac_f32_16x16x64_bf16 v[68:71], v[52:55], a[176:183], v5
 s_waitcnt lgkmcnt(2)
 s_cmp_lt_u32 s36, 61
 v_smfmac_f32_16x16x64_bf16 v[64:67], v[56:59], v[36:43], v5
 ds_read_b128 v[36:39], v0 offset:57344
 buffer_load_dwordx4 v3, s[20:23], s67 offen offset:1024 sc1 lds
 v_smfmac_f32_16x16x64_bf16 v[20:23], v[52:55], a[184:191], v5
 ds_read_b128 v[40:43], v0 offset:61440
 s_cselect_b32 s47, 0x80000, 0
 v_add_u32 v0, 0x10000, v0
 v_smfmac_f32_16x16x64_bf16 v[68:71], v[56:59], v[44:51], v5
 ds_read_b128 v[44:47], v0 offset:0
 s_add_u32 s68, s68, s47
 v_add_f32 v64, v64, v66
 v_add_f32 v65, v65, v67
 v_cvt_pk_bf16_f32 v65, v65, v65
 v_smfmac_f32_16x16x64_bf16 v[24:27], v[52:55], a[192:199], v5
 ds_read_b128 v[48:51], v0 offset:4096
 s_waitcnt lgkmcnt(4)
 v_cvt_pk_bf16_f32 v64, v64, v64
 v_and_or_b32 v65, v65, -2, s46
 v_smfmac_f32_16x16x64_bf16 v[20:23], v[56:59], v[12:19], v5
 ds_read_b128 v[12:15], v0 offset:8192
 buffer_store_dwordx2 v[64:65], v6, s[20:23], s62 offen
 v_add_f32 v68, v68, v70
 v_add_f32 v69, v69, v71
 v_smfmac_f32_16x16x64_bf16 v[28:31], v[52:55], a[200:207], v5
 ds_read_b128 v[16:19], v0 offset:12288
 s_waitcnt lgkmcnt(4)
 v_mov_b64 v[64:65], 0
 v_mov_b64 v[66:67], 0
 v_smfmac_f32_16x16x64_bf16 v[24:27], v[56:59], v[36:43], v5
 ds_read_b128 v[36:39], v0 offset:16384
 s_add_u32 s36, s36, 1
 v_add_f32 v20, v20, v22
 v_add_f32 v21, v21, v23
 v_cvt_pk_bf16_f32 v69, v69, v21
 v_smfmac_f32_16x16x64_bf16 v[32:35], v[52:55], a[208:215], v5
 ds_read_b128 v[40:43], v0 offset:20480
 s_waitcnt lgkmcnt(4)
 v_cvt_pk_bf16_f32 v68, v68, v20
 v_and_or_b32 v69, v69, -2, s46
 v_smfmac_f32_16x16x64_bf16 v[28:31], v[56:59], v[44:51], v5
 ds_read_b128 v[44:47], v0 offset:24576
 buffer_store_dwordx2 v[68:69], v6, s[20:23], s60 offen offset:0
 v_add_f32 v24, v24, v26
 v_add_f32 v25, v25, v27
 v_smfmac_f32_16x16x64_bf16 v[60:63], v[52:55], a[216:223], v5
 ds_read_b128 v[48:51], v0 offset:28672
 s_waitcnt lgkmcnt(4)
 v_mov_b64 v[20:21], 0
 v_mov_b64 v[22:23], 0
 v_smfmac_f32_16x16x64_bf16 v[32:35], v[56:59], v[12:19], v5
 s_add_u32 s58, s36, 2
 s_min_u32 s58, s58, 64
 v_add_f32 v28, v28, v30
 v_add_f32 v29, v29, v31
 v_cvt_pk_bf16_f32 v25, v25, v29
 v_smfmac_f32_16x16x64_bf16 v[64:67], v[52:55], a[224:231], v5
 s_waitcnt lgkmcnt(2)
 s_xor_b32 s44, s44, 0x80000
 v_cvt_pk_bf16_f32 v24, v24, v28
 v_and_or_b32 v25, v25, -2, s46
 v_smfmac_f32_16x16x64_bf16 v[60:63], v[56:59], v[36:43], v5
 buffer_store_dwordx2 v[24:25], v6, s[20:23], s60 offen offset:2048
 v_add_f32 v32, v32, v34
 v_smfmac_f32_16x16x64_bf16 v[20:23], v[52:55], a[232:239], v5
 s_waitcnt lgkmcnt(0)
 s_xor_b32 s45, s45, 0x80000
 v_add_f32 v33, v33, v35
 v_smfmac_f32_16x16x64_bf16 v[64:67], v[56:59], v[44:51], v5
 s_xor_b32 s65, s65, 0x80000
 s_xor_b32 s66, s66, 0x80000
 v_add_f32 v60, v60, v62
 v_add_f32 v61, v61, v63
 v_smfmac_f32_16x16x64_bf16 v[20:23], v[56:59], a[240:247], v5
 s_cmp_eq_u32 s4, 0
 v_cvt_pk_bf16_f32 v33, v33, v61
 v_cvt_pk_bf16_f32 v32, v32, v60
 v_and_or_b32 v33, v33, -2, s46
 buffer_store_dwordx2 v[32:33], v6, s[20:23], s61 offen offset:0
 v_add_f32 v64, v64, v66
 v_add_f32 v65, v65, v67
 s_nop 0
 v_add_f32 v20, v20, v22
 v_add_f32 v21, v21, v23
 v_cvt_pk_bf16_f32 v65, v65, v21
 v_cvt_pk_bf16_f32 v64, v64, v20
 v_and_or_b32 v65, v65, -2, s46
 buffer_store_dwordx2 v[64:65], v6, s[20:23], s61 offen offset:2048
 s_cbranch_scc1 LwH_75
 s_cmp_eq_u32 s4, 1
 s_cbranch_scc1 Lw_76
 s_cmp_eq_u32 s4, 2
 s_cbranch_scc1 Lw_77
 s_xor_b32 s41, s41, 0x80000
 s_xor_b32 s43, s43, 0x80000
 v_mov_b32 v47, 0x3f80
 v_cndmask_b32 v47, v47, 1.0, s[32:33]
 v_cndmask_b32 v44, 0, v47, s[24:25]
 v_cndmask_b32 v45, 0, v47, s[26:27]
 v_cndmask_b32 v46, 0, v47, s[28:29]
 v_cndmask_b32 v47, 0, v47, s[30:31]
 v_bfe_u32 v52, v3, 8, 2
 v_bfe_u32 v58, v3, 2, 4
 v_lshl_or_b32 v52, v52, 4, v58
 v_and_b32 v58, 0xc0, v3
 v_lshl_or_b32 v52, v58, 24, v52
 v_subrev_u32 v0, 0x20000, v0
 v_mov_b32 v59, -1
 v_add_u32 v54, s42, v3
 v_add_u32 v58, s69, v9
 ds_read_b64 v[64:65], v58 offset:19456
 v_mov_b32 v66, v2
 v_mov_b32 v67, v4
 v_mov_b64 v[68:69], 0
 v_mov_b64 v[70:71], 0
 ds_read_b128 v[20:23], v0 offset:24576
 ds_read_b128 v[24:27], v0 offset:28672
 ds_read_b128 v[28:31], v0 offset:32768
 ds_read_b128 v[32:35], v0 offset:36864
 s_waitcnt vmcnt(0)
 buffer_load_dwordx4 v[36:39], v3, s[20:23], s39 offen offset:0 sc1
 buffer_load_dwordx4 v[40:43], v3, s[20:23], s39 offen offset:1024 sc1
 s_nop 15
 s_nop 10
 buffer_load_dwordx4 v[12:15], v3, s[20:23], s39 offen offset:0 sc1
 buffer_load_dwordx4 v[16:19], v3, s[20:23], s39 offen offset:1024 sc1
 s_waitcnt vmcnt(3)
 v_mfma_f32_16x16x32_bf16 v[48:51], v[44:47], v[36:39], 0
 s_waitcnt vmcnt(2)
 v_mfma_f32_16x16x32_bf16 v[48:51], v[44:47], v[40:43], v[48:51]
 v_bitop3_b32 v55, v37, v39, s46 bitop3:0x7e
 v_bitop3_b32 v56, v41, v43, s46 bitop3:0x7e
 v_bitop3_b32 v55, v55, 1, v56 bitop3:0xc8
 v_cmp_ne_u32 vcc, 0, v55
 s_nop 3
 v_add_f32_dpp v48, v48, v48 row_ror:4 row_mask:0xf bank_mask:0xf
 v_add_f32_dpp v49, v49, v49 row_ror:4 row_mask:0xf bank_mask:0xf
 s_cbranch_vccnz Lr2_79
 v_add_f32_dpp v48, v48, v48 row_ror:8 row_mask:0xf bank_mask:0xf
 v_add_f32_dpp v49, v49, v49 row_ror:8 row_mask:0xf bank_mask:0xf
 v_cvt_pk_bf16_f32 v48, v48, v49
 buffer_store_dword v48, v52, s[20:23], s44 offen
Lb1_80:
 buffer_store_dword v59, v52, s[20:23], s45 offen
 v_cmp_gt_u32 vcc, s58, v1
 v_mov_b64 v[36:37], 0
 v_mov_b64 v[38:39], 0
 v_mov_b64 v[40:41], 0
 v_mov_b64 v[42:43], 0
 v_mov_b64 v[44:45], 0
 v_mov_b64 v[46:47], 0
 v_mov_b64 v[48:49], 0
 v_mov_b64 v[50:51], 0
 s_cmp_lg_u32 vcc_hi, 0
 s_cbranch_scc1 Lfw_82
Lfok_81:
 v_lshl_add_u32 v1, v3, 3, s68
 v_mov_b32 v6, s56
 v_cndmask_b32 v1, v6, v1, s[70:71]
 v_mov_b32 v4, v54
 s_waitcnt vmcnt(0)
 s_nop 15
 s_nop 15
 s_nop 11
 s_branch LstepB_69
Lw_77:
 s_xor_b32 s41, s41, 0x80000
 s_xor_b32 s43, s43, 0x80000
 v_mov_b32 v47, 0x3f80
 v_cndmask_b32 v47, v47, 1.0, s[32:33]
 v_cndmask_b32 v44, 0, v47, s[24:25]
 v_cndmask_b32 v45, 0, v47, s[26:27]
 v_cndmask_b32 v46, 0, v47, s[28:29]
 v_cndmask_b32 v47, 0, v47, s[30:31]
 v_bfe_u32 v52, v3, 8, 2
 v_bfe_u32 v58, v3, 2, 4
 v_lshl_or_b32 v52, v52, 4, v58
 v_and_b32 v58, 0xc0, v3
 v_lshl_or_b32 v52, v58, 24, v52
 v_subrev_u32 v0, 0x20000, v0
 v_mov_b32 v59, -1
 v_add_u32 v54, s42, v3
 v_add_u32 v58, s69, v9
 ds_read_b64 v[64:65], v58 offset:19456
 v_mov_b32 v66, v2
 v_mov_b32 v67, v4
 v_mov_b64 v[68:69], 0
 v_mov_b64 v[70:71], 0
 ds_read_b128 v[20:23], v0 offset:24576
 ds_read_b128 v[24:27], v0 offset:28672
 ds_read_b128 v[28:31], v0 offset:32768
 ds_read_b128 v[32:35], v0 offset:36864
 s_waitcnt vmcnt(1)
 buffer_load_dwordx4 v[36:39], v3, s[20:23], s39 offen offset:0 sc1
 buffer_load_dwordx4 v[40:43], v3, s[20:23], s39 offen offset:1024 sc1
 s_nop 15
 s_nop 10
 buffer_load_dwordx4 v[12:15], v3, s[20:23], s39 offen offset:0 sc1
 buffer_load_dwordx4 v[16:19], v3, s[20:23], s39 offen offset:1024 sc1
 s_waitcnt vmcnt(3)
 v_mfma_f32_16x16x32_bf16 v[48:51], v[44:47], v[36:39], 0
 s_waitcnt vmcnt(2)
 v_mfma_f32_16x16x32_bf16 v[48:51], v[44:47], v[40:43], v[48:51]
 v_bitop3_b32 v55, v37, v39, s46 bitop3:0x7e
 v_bitop3_b32 v56, v41, v43, s46 bitop3:0x7e
 v_bitop3_b32 v55, v55, 1, v56 bitop3:0xc8
 v_cmp_ne_u32 vcc, 0, v55
 s_nop 3
 v_add_f32_dpp v48, v48, v48 row_ror:4 row_mask:0xf bank_mask:0xf
 v_add_f32_dpp v49, v49, v49 row_ror:4 row_mask:0xf bank_mask:0xf
 s_cbranch_vccnz Lr2_85
 v_add_f32_dpp v48, v48, v48 row_ror:8 row_mask:0xf bank_mask:0xf
 v_add_f32_dpp v49, v49, v49 row_ror:8 row_mask:0xf bank_mask:0xf
 v_cvt_pk_bf16_f32 v48, v48, v49
 buffer_store_dword v48, v52, s[20:23], s44 offen
Lb1_86:
 buffer_store_dword v59, v52, s[20:23], s45 offen
 v_cmp_gt_u32 vcc, s58, v1
 v_mov_b64 v[36:37], 0
 v_mov_b64 v[38:39], 0
 v_mov_b64 v[40:41], 0
 v_mov_b64 v[42:43], 0
 v_mov_b64 v[44:45], 0
 v_mov_b64 v[46:47], 0
 v_mov_b64 v[48:49], 0
 v_mov_b64 v[50:51], 0
 s_cmp_lg_u32 vcc_hi, 0
 s_cbranch_scc1 Lfw_88
Lfok_87:
 v_lshl_add_u32 v1, v3, 3, s68
 v_mov_b32 v6, s56
 v_cndmask_b32 v1, v6, v1, s[70:71]
 v_mov_b32 v4, v54
 s_nop 7
 buffer_load_dwordx4 v[68:71], v3, s[20:23], s43 offen offset:0 sc1
 s_nop 15
 s_nop 7
Lp2_89:
 buffer_load_dwordx4 v[68:71], v3, s[20:23], s43 offen offset:0 sc1
 s_waitcnt vmcnt(1)
 v_max3_u32 v55, v68, v69, v70
 v_max_u32 v55, v55, v71
 ds_write_b128 v3, v[68:71] offset:8192
 v_cmpx_eq_u32 vcc, -1, v55
 s_cbranch_execz LstepB_69
 buffer_load_dwordx4 v[68:71], v3, s[20:23], s43 offen offset:0 sc1
 s_waitcnt vmcnt(1)
 v_max3_u32 v55, v68, v69, v70
 v_max_u32 v55, v55, v71
 ds_write_b128 v3, v[68:71] offset:8192
 v_cmpx_eq_u32 vcc, -1, v55
 s_cbranch_execz LstepB_69
 buffer_load_dwordx4 v[68:71], v3, s[20:23], s43 offen offset:0 sc1
 s_waitcnt vmcnt(1)
 v_max3_u32 v55, v68, v69, v70
 v_max_u32 v55, v55, v71
 ds_write_b128 v3, v[68:71] offset:8192
 v_cmpx_eq_u32 vcc, -1, v55
 s_cbranch_execz LstepB_69
 s_sub_u32 s54, s54, 1
 s_cbranch_scc0 Lp2_89
 s_endpgm
Lw_76:
 s_waitcnt vmcnt(2)
 buffer_load_dwordx4 v[36:39], v3, s[20:23], s39 offen offset:0 sc1
 buffer_load_dwordx4 v[40:43], v3, s[20:23], s39 offen offset:1024 sc1
 s_xor_b32 s41, s41, 0x80000
 s_xor_b32 s43, s43, 0x80000
 v_mov_b32 v47, 0x3f80
 v_cndmask_b32 v47, v47, 1.0, s[32:33]
 v_cndmask_b32 v44, 0, v47, s[24:25]
 v_cndmask_b32 v45, 0, v47, s[26:27]
 v_cndmask_b32 v46, 0, v47, s[28:29]
 v_cndmask_b32 v47, 0, v47, s[30:31]
 v_bfe_u32 v52, v3, 8, 2
 v_bfe_u32 v58, v3, 2, 4
 v_lshl_or_b32 v52, v52, 4, v58
 v_and_b32 v58, 0xc0, v3
 v_lshl_or_b32 v52, v58, 24, v52
 v_subrev_u32 v0, 0x20000, v0
 v_mov_b32 v59, -1
 v_add_u32 v54, s42, v3
 v_add_u32 v58, s69, v9
 ds_read_b64 v[64:65], v58 offset:19456
 v_mov_b32 v66, v2
 v_mov_b32 v67, v4
 v_mov_b64 v[68:69], 0
 v_mov_b64 v[70:71], 0
 ds_read_b128 v[20:23], v0 offset:24576
 ds_read_b128 v[24:27], v0 offset:28672
 ds_read_b128 v[28:31], v0 offset:32768
 ds_read_b128 v[32:35], v0 offset:36864
 s_nop 3
 buffer_load_dwordx4 v[12:15], v3, s[20:23], s39 offen offset:0 sc1
 buffer_load_dwordx4 v[16:19], v3, s[20:23], s39 offen offset:1024 sc1
 s_waitcnt vmcnt(3)
 v_mfma_f32_16x16x32_bf16 v[48:51], v[44:47], v[36:39], 0
 s_waitcnt vmcnt(2)
 v_mfma_f32_16x16x32_bf16 v[48:51], v[44:47], v[40:43], v[48:51]
 v_bitop3_b32 v55, v37, v39, s46 bitop3:0x7e
 v_bitop3_b32 v56, v41, v43, s46 bitop3:0x7e
 v_bitop3_b32 v55, v55, 1, v56 bitop3:0xc8
 v_cmp_ne_u32 vcc, 0, v55
 s_nop 3
 v_add_f32_dpp v48, v48, v48 row_ror:4 row_mask:0xf bank_mask:0xf
 v_add_f32_dpp v49, v49, v49 row_ror:4 row_mask:0xf bank_mask:0xf
 s_cbranch_vccnz Lr2_91
 v_add_f32_dpp v48, v48, v48 row_ror:8 row_mask:0xf bank_mask:0xf
 v_add_f32_dpp v49, v49, v49 row_ror:8 row_mask:0xf bank_mask:0xf
 v_cvt_pk_bf16_f32 v48, v48, v49
 buffer_store_dword v48, v52, s[20:23], s44 offen
Lb1_92:
 buffer_store_dword v59, v52, s[20:23], s45 offen
 v_cmp_gt_u32 vcc, s58, v1
 v_mov_b64 v[36:37], 0
 v_mov_b64 v[38:39], 0
 v_mov_b64 v[40:41], 0
 v_mov_b64 v[42:43], 0
 v_mov_b64 v[44:45], 0
 v_mov_b64 v[46:47], 0
 v_mov_b64 v[48:49], 0
 v_mov_b64 v[50:51], 0
 s_cmp_lg_u32 vcc_hi, 0
 s_cbranch_scc1 Lfw_94
Lfok_93:
 v_lshl_add_u32 v1, v3, 3, s68
 v_mov_b32 v6, s56
 v_cndmask_b32 v1, v6, v1, s[70:71]
 v_min_u32 v6, 16, v0
 v_lshlrev_b32 v6, 24, v6
 s_max_u32 s47, s36, 1
 v_add_u32 v2, -1, s47
 s_nop 15
 s_nop 0
 buffer_load_dwordx4 v[12:15], v3, s[20:23], s41 offen offset:0 sc1
 buffer_load_dwordx4 v[16:19], v3, s[20:23], s41 offen offset:1024 sc1
 s_nop 15
 s_nop 7
Lp2_95:
 buffer_load_dwordx4 v[12:15], v3, s[20:23], s41 offen offset:0 sc1
 buffer_load_dwordx4 v[16:19], v3, s[20:23], s41 offen offset:1024 sc1
 s_waitcnt vmcnt(2)
 v_max3_u32 v55, v12, v13, v14
 v_max3_u32 v55, v55, v15, v16
 v_max3_u32 v55, v55, v17, v18
 v_max_u32 v55, v55, v19
 ds_write_b128 v54, v[12:15] offset:0
 ds_write_b128 v54, v[16:19] offset:1024
 v_cmpx_eq_u32 vcc, -1, v55
 s_cbranch_execz Lstep_67
 buffer_load_dwordx4 v[12:15], v3, s[20:23], s41 offen offset:0 sc1
 buffer_load_dwordx4 v[16:19], v3, s[20:23], s41 offen offset:1024 sc1
 s_waitcnt vmcnt(2)
 v_max3_u32 v55, v12, v13, v14
 v_max3_u32 v55, v55, v15, v16
 v_max3_u32 v55, v55, v17, v18
 v_max_u32 v55, v55, v19
 ds_write_b128 v54, v[12:15] offset:0
 ds_write_b128 v54, v[16:19] offset:1024
 v_cmpx_eq_u32 vcc, -1, v55
 s_cbranch_execz Lstep_67
 buffer_load_dwordx4 v[12:15], v3, s[20:23], s41 offen offset:0 sc1
 buffer_load_dwordx4 v[16:19], v3, s[20:23], s41 offen offset:1024 sc1
 s_waitcnt vmcnt(2)
 v_max3_u32 v55, v12, v13, v14
 v_max3_u32 v55, v55, v15, v16
 v_max3_u32 v55, v55, v17, v18
 v_max_u32 v55, v55, v19
 ds_write_b128 v54, v[12:15] offset:0
 ds_write_b128 v54, v[16:19] offset:1024
 v_cmpx_eq_u32 vcc, -1, v55
 s_cbranch_execz Lstep_67
 s_sub_u32 s54, s54, 1
 s_cbranch_scc0 Lp2_95
 s_endpgm
LwH_75:
 v_bfe_u32 v53, v3, 8, 1
 v_bfe_u32 v58, v3, 9, 1
 v_lshl_or_b32 v53, v53, 1, v58
 v_bfe_u32 v58, v3, 5, 1
 v_lshl_or_b32 v53, v53, 1, v58
 v_and_b32 v58, 0xd0, v3
 v_lshlrev_b32 v58, 24, v58
 v_lshl_or_b32 v53, v53, 2, v58
 s_waitcnt vmcnt(3)
 s_nop 7
 buffer_load_dwordx4 v[20:23], v3, s[20:23], s40 offen offset:0 sc1
 buffer_load_dwordx4 v[24:27], v3, s[20:23], s40 offen offset:1024 sc1
 buffer_load_dwordx4 v[36:39], v3, s[20:23], s39 offen offset:0 sc1
 buffer_load_dwordx4 v[40:43], v3, s[20:23], s39 offen offset:1024 sc1
 s_xor_b32 s41, s41, 0x80000
 s_xor_b32 s43, s43, 0x80000
 v_mov_b32 v47, 0x3f80
 v_cndmask_b32 v47, v47, 1.0, s[32:33]
 v_cndmask_b32 v44, 0, v47, s[24:25]
 v_cndmask_b32 v45, 0, v47, s[26:27]
 v_cndmask_b32 v46, 0, v47, s[28:29]
 v_cndmask_b32 v47, 0, v47, s[30:31]
 v_bfe_u32 v52, v3, 8, 2
 v_bfe_u32 v58, v3, 2, 4
 v_lshl_or_b32 v52, v52, 4, v58
 v_and_b32 v58, 0xc0, v3
 v_lshl_or_b32 v52, v58, 24, v52
 v_subrev_u32 v0, 0x20000, v0
 v_mov_b32 v59, -1
 v_add_u32 v54, s42, v3
 v_add_u32 v58, s69, v9
 ds_read_b64 v[64:65], v58 offset:19456
 v_mov_b32 v66, v2
 v_mov_b32 v67, v4
 v_mov_b64 v[68:69], 0
 v_mov_b64 v[70:71], 0
 s_waitcnt vmcnt(2)
 v_mfma_f32_16x16x32_bf16 v[28:31], v[44:47], v[20:23], 0
 v_mfma_f32_16x16x32_bf16 v[28:31], v[44:47], v[24:27], v[28:31]
 s_waitcnt vmcnt(1)
 v_mfma_f32_16x16x32_bf16 v[48:51], v[44:47], v[36:39], 0
 s_waitcnt vmcnt(0)
 v_mfma_f32_16x16x32_bf16 v[48:51], v[44:47], v[40:43], v[48:51]
 v_bitop3_b32 v55, v37, v39, s46 bitop3:0x7e
 v_bitop3_b32 v56, v41, v43, s46 bitop3:0x7e
 v_bitop3_b32 v57, v21, v23, s46 bitop3:0x7e
 v_or3_b32 v55, v55, v56, v57
 v_bitop3_b32 v56, v25, v27, s46 bitop3:0x7e
 v_bitop3_b32 v55, v55, 1, v56 bitop3:0xc8
 v_cmp_ne_u32 vcc, 0, v55
 v_add_f32_dpp v29, v29, v29 row_ror:4 row_mask:0xf bank_mask:0xf
 v_add_f32_dpp v48, v48, v48 row_ror:4 row_mask:0xf bank_mask:0xf
 v_add_f32_dpp v49, v49, v49 row_ror:4 row_mask:0xf bank_mask:0xf
 v_add_f32_dpp v29, v29, v29 row_ror:8 row_mask:0xf bank_mask:0xf
 v_add_f32_dpp v48, v48, v48 row_ror:8 row_mask:0xf bank_mask:0xf
 v_add_f32_dpp v49, v49, v49 row_ror:8 row_mask:0xf bank_mask:0xf
 s_cbranch_vccnz Lr1_96
 v_cvt_pk_bf16_f32 v48, v48, v49
 buffer_store_dword v48, v52, s[20:23], s44 offen
 v_mov_b32_dpp v30, v29 quad_perm:[1,0,3,2] row_mask:0xf bank_mask:0xf
 v_cvt_pk_bf16_f32 v29, v29, v30
 buffer_store_dword v29, v53, s[20:23], s65 offen
Lb1_97:
 buffer_store_dword v59, v52, s[20:23], s45 offen
 buffer_store_dword v59, v53, s[20:23], s66 offen
 v_cmp_gt_u32 vcc, s58, v1
 ds_read_b128 v[20:23], v0 offset:24576
 ds_read_b128 v[24:27], v0 offset:28672
 ds_read_b128 v[28:31], v0 offset:32768
 ds_read_b128 v[32:35], v0 offset:36864
 v_mov_b64 v[36:37], 0
 v_mov_b64 v[38:39], 0
 v_mov_b64 v[40:41], 0
 v_mov_b64 v[42:43], 0
 v_mov_b64 v[44:45], 0
 v_mov_b64 v[46:47], 0
 v_mov_b64 v[48:49], 0
 v_mov_b64 v[50:51], 0
 s_cmp_lg_u32 vcc_hi, 0
 s_cbranch_scc1 Lfw_99
Lfok_98:
 v_lshl_add_u32 v1, v3, 3, s68
 v_mov_b32 v6, s56
 v_cndmask_b32 v1, v6, v1, s[70:71]
 v_min_u32 v6, 16, v0
 v_lshlrev_b32 v6, 24, v6
 s_max_u32 s47, s36, 1
 v_add_u32 v2, -1, s47
 s_nop 10
 buffer_load_dwordx4 v[12:15], v3, s[20:23], s41 offen offset:0 sc1
 buffer_load_dwordx4 v[16:19], v3, s[20:23], s41 offen offset:1024 sc1
 s_nop 15
 s_nop 7
Lp2_100:
 buffer_load_dwordx4 v[12:15], v3, s[20:23], s41 offen offset:0 sc1
 buffer_load_dwordx4 v[16:19], v3, s[20:23], s41 offen offset:1024 sc1
 s_waitcnt vmcnt(2)
 v_max3_u32 v55, v12, v13, v14
 v_max3_u32 v55, v55, v15, v16
 v_max3_u32 v55, v55, v17, v18
 v_max_u32 v55, v55, v19
 ds_write_b128 v54, v[12:15] offset:0
 ds_write_b128 v54, v[16:19] offset:1024
 v_cmpx_eq_u32 vcc, -1, v55
 s_cbranch_execz Lstep_67
 buffer_load_dwordx4 v[12:15], v3, s[20:23], s41 offen offset:0 sc1
 buffer_load_dwordx4 v[16:19], v3, s[20:23], s41 offen offset:1024 sc1
 s_waitcnt vmcnt(2)
 v_max3_u32 v55, v12, v13, v14
 v_max3_u32 v55, v55, v15, v16
 v_max3_u32 v55, v55, v17, v18
 v_max_u32 v55, v55, v19
 ds_write_b128 v54, v[12:15] offset:0
 ds_write_b128 v54, v[16:19] offset:1024
 v_cmpx_eq_u32 vcc, -1, v55
 s_cbranch_execz Lstep_67
 buffer_load_dwordx4 v[12:15], v3, s[20:23], s41 offen offset:0 sc1
 buffer_load_dwordx4 v[16:19], v3, s[20:23], s41 offen offset:1024 sc1
 s_waitcnt vmcnt(2)
 v_max3_u32 v55, v12, v13, v14
 v_max3_u32 v55, v55, v15, v16
 v_max3_u32 v55, v55, v17, v18
 v_max_u32 v55, v55, v19
 ds_write_b128 v54, v[12:15] offset:0
 ds_write_b128 v54, v[16:19] offset:1024
 v_cmpx_eq_u32 vcc, -1, v55
 s_cbranch_execz Lstep_67
 s_sub_u32 s54, s54, 1
 s_cbranch_scc0 Lp2_100
 s_endpgm
Lr1_96:
 s_mov_b64 exec, vcc
Lrt_101:
 buffer_load_dwordx4 v[20:23], v3, s[20:23], s40 offen offset:0 sc1
 buffer_load_dwordx4 v[24:27], v3, s[20:23], s40 offen offset:1024 sc1
 buffer_load_dwordx4 v[36:39], v3, s[20:23], s39 offen offset:0 sc1
 buffer_load_dwordx4 v[40:43], v3, s[20:23], s39 offen offset:1024 sc1
 s_waitcnt vmcnt(4)
 v_bitop3_b32 v55, v37, v39, s46 bitop3:0x7e
 v_bitop3_b32 v56, v41, v43, s46 bitop3:0x7e
 v_bitop3_b32 v57, v21, v23, s46 bitop3:0x7e
 v_or3_b32 v55, v55, v56, v57
 v_bitop3_b32 v56, v25, v27, s46 bitop3:0x7e
 v_bitop3_b32 v55, v55, 1, v56 bitop3:0xc8
 v_cmpx_ne_u32 vcc, 0, v55
 s_cbranch_execz Lrte_102
 buffer_load_dwordx4 v[20:23], v3, s[20:23], s40 offen offset:0 sc1
 buffer_load_dwordx4 v[24:27], v3, s[20:23], s40 offen offset:1024 sc1
 buffer_load_dwordx4 v[36:39], v3, s[20:23], s39 offen offset:0 sc1
 buffer_load_dwordx4 v[40:43], v3, s[20:23], s39 offen offset:1024 sc1
 s_waitcnt vmcnt(4)
 v_bitop3_b32 v55, v37, v39, s46 bitop3:0x7e
 v_bitop3_b32 v56, v41, v43, s46 bitop3:0x7e
 v_bitop3_b32 v57, v21, v23, s46 bitop3:0x7e
 v_or3_b32 v55, v55, v56, v57
 v_bitop3_b32 v56, v25, v27, s46 bitop3:0x7e
 v_bitop3_b32 v55, v55, 1, v56 bitop3:0xc8
 v_cmpx_ne_u32 vcc, 0, v55
 s_cbranch_execz Lrte_102
 buffer_load_dwordx4 v[20:23], v3, s[20:23], s40 offen offset:0 sc1
 buffer_load_dwordx4 v[24:27], v3, s[20:23], s40 offen offset:1024 sc1
 buffer_load_dwordx4 v[36:39], v3, s[20:23], s39 offen offset:0 sc1
 buffer_load_dwordx4 v[40:43], v3, s[20:23], s39 offen offset:1024 sc1
 s_waitcnt vmcnt(4)
 v_bitop3_b32 v55, v37, v39, s46 bitop3:0x7e
 v_bitop3_b32 v56, v41, v43, s46 bitop3:0x7e
 v_bitop3_b32 v57, v21, v23, s46 bitop3:0x7e
 v_or3_b32 v55, v55, v56, v57
 v_bitop3_b32 v56, v25, v27, s46 bitop3:0x7e
 v_bitop3_b32 v55, v55, 1, v56 bitop3:0xc8
 v_cmpx_ne_u32 vcc, 0, v55
 s_cbranch_execz Lrte_102
 s_sub_u32 s54, s54, 1
 s_cbranch_scc0 Lrt_101
 s_endpgm
Lrte_102:
 s_mov_b64 exec, -1
 s_nop 2
 v_mfma_f32_16x16x32_bf16 v[28:31], v[44:47], v[20:23], 0
 v_mfma_f32_16x16x32_bf16 v[28:31], v[44:47], v[24:27], v[28:31]
 v_mfma_f32_16x16x32_bf16 v[48:51], v[44:47], v[36:39], 0
 v_mfma_f32_16x16x32_bf16 v[48:51], v[44:47], v[40:43], v[48:51]
 s_nop 6
 v_add_f32_dpp v29, v29, v29 row_ror:4 row_mask:0xf bank_mask:0xf
 v_add_f32_dpp v48, v48, v48 row_ror:4 row_mask:0xf bank_mask:0xf
 v_add_f32_dpp v49, v49, v49 row_ror:4 row_mask:0xf bank_mask:0xf
 v_add_f32_dpp v29, v29, v29 row_ror:8 row_mask:0xf bank_mask:0xf
 v_add_f32_dpp v48, v48, v48 row_ror:8 row_mask:0xf bank_mask:0xf
 v_add_f32_dpp v49, v49, v49 row_ror:8 row_mask:0xf bank_mask:0xf
 v_cvt_pk_bf16_f32 v48, v48, v49
 buffer_store_dword v48, v52, s[20:23], s44 offen
 v_mov_b32_dpp v30, v29 quad_perm:[1,0,3,2] row_mask:0xf bank_mask:0xf
 v_cvt_pk_bf16_f32 v29, v29, v30
 buffer_store_dword v29, v53, s[20:23], s65 offen
 s_waitcnt vmcnt(2)
 s_branch Lb1_97
Lyr_71:
 s_mov_b64 exec, vcc
Lrt_103:
 buffer_load_dwordx4 v[12:15], v3, s[20:23], s41 offen offset:0 sc1
 buffer_load_dwordx4 v[16:19], v3, s[20:23], s41 offen offset:1024 sc1
 s_waitcnt vmcnt(2)
 v_max3_u32 v2, v12, v13, v14
 v_max3_u32 v2, v2, v15, v16
 v_max3_u32 v2, v2, v17, v18
 v_max_u32 v2, v2, v19
 v_cmpx_eq_u32 vcc, -1, v2
 s_cbranch_execz Lrte_104
 buffer_load_dwordx4 v[12:15], v3, s[20:23], s41 offen offset:0 sc1
 buffer_load_dwordx4 v[16:19], v3, s[20:23], s41 offen offset:1024 sc1
 s_waitcnt vmcnt(2)
 v_max3_u32 v2, v12, v13, v14
 v_max3_u32 v2, v2, v15, v16
 v_max3_u32 v2, v2, v17, v18
 v_max_u32 v2, v2, v19
 v_cmpx_eq_u32 vcc, -1, v2
 s_cbranch_execz Lrte_104
 buffer_load_dwordx4 v[12:15], v3, s[20:23], s41 offen offset:0 sc1
 buffer_load_dwordx4 v[16:19], v3, s[20:23], s41 offen offset:1024 sc1
 s_waitcnt vmcnt(2)
 v_max3_u32 v2, v12, v13, v14
 v_max3_u32 v2, v2, v15, v16
 v_max3_u32 v2, v2, v17, v18
 v_max_u32 v2, v2, v19
 v_cmpx_eq_u32 vcc, -1, v2
 s_cbranch_execz Lrte_104
 s_sub_u32 s54, s54, 1
 s_cbranch_scc0 Lrt_103
 s_endpgm
Lrte_104:
 s_mov_b64 exec, -1
 ds_write_b128 v4, v[12:15] offset:0
 ds_write_b128 v4, v[16:19] offset:1024
 s_waitcnt lgkmcnt(0)
 s_branch Lyb_72
Lmx_73:
 s_waitcnt lgkmcnt(0)
 ds_read_b128 v[36:39], v11 offset:17408
 ds_read_b128 v[40:43], v11 offset:17920
 ds_read_b128 v[44:47], v11 offset:18432
 ds_read_b128 v[48:51], v11 offset:18944
 v_mov_b64 v[28:29], 0
 v_mov_b64 v[30:31], 0
 ds_read_b128 v[52:55], v3 offset:9216
 ds_read_b128 v[56:59], v3 offset:10240
 s_waitcnt lgkmcnt(0)
 v_mfma_f32_16x16x32_bf16 v[20:23], v[52:55], v[36:39], 0
 v_mfma_f32_16x16x32_bf16 v[24:27], v[56:59], v[36:39], 0
 ds_read_b128 v[52:55], v3 offset:11264
 ds_read_b128 v[56:59], v3 offset:12288
 s_waitcnt lgkmcnt(0)
 v_mfma_f32_16x16x32_bf16 v[20:23], v[52:55], v[40:43], v[20:23]
 v_mfma_f32_16x16x32_bf16 v[24:27], v[56:59], v[40:43], v[24:27]
 ds_read_b128 v[52:55], v3 offset:13312
 ds_read_b128 v[56:59], v3 offset:14336
 s_waitcnt lgkmcnt(0)
 v_mfma_f32_16x16x32_bf16 v[20:23], v[52:55], v[44:47], v[20:23]
 v_mfma_f32_16x16x32_bf16 v[24:27], v[56:59], v[44:47], v[24:27]
 ds_read_b128 v[52:55], v3 offset:15360
 ds_read_b128 v[56:59], v3 offset:16384
 s_waitcnt lgkmcnt(0)
 v_mfma_f32_16x16x32_bf16 v[20:23], v[52:55], v[48:51], v[20:23]
 v_mfma_f32_16x16x32_bf16 v[24:27], v[56:59], v[48:51], v[24:27]
 ds_read_b128 v[52:55], v9 offset:19456
 ds_read_b128 v[56:59], v9 offset:21504
 s_waitcnt lgkmcnt(0)
 v_smfmac_f32_16x16x64_bf16 v[28:31], v[52:55], v[36:43], v5
 v_smfmac_f32_16x16x64_bf16 v[28:31], v[56:59], v[44:51], v5
 ds_read_b128 v[36:39], v0 offset:32768
 ds_read_b128 v[40:43], v0 offset:36864
 ds_read_b128 v[44:47], v0 offset:40960
 ds_read_b128 v[48:51], v0 offset:45056
 v_mov_b64 v[32:33], s[34:35]
 v_mov_b64 v[34:35], s[34:35]
 s_nop 1
 v_add_f32 v28, v28, v30
 v_add_f32 v29, v29, v31
 v_mul_f32 v28, s55, v28
 v_mul_f32 v29, s55, v29
 v_max_f32 v30, v28, v29
 v_cndmask_b32 v28, v28, v29, s[48:49]
 v_max3_f32 v30, v30, v20, v21
 v_max3_f32 v30, v30, v22, v23
 v_max3_f32 v30, v30, v24, v25
 v_max3_f32 v31, v30, v26, v27
 v_max3_f32 v29, v30, v26, v27
 v_cndmask_b32 v20, v20, v24, s[48:49]
 v_cndmask_b32 v21, v21, v25, s[48:49]
 v_permlane16_swap_b32 v31, v29
 v_max_f32 v30, v31, v29
 v_max_f32 v6, v31, v29
 v_cndmask_b32 v22, v22, v26, s[48:49]
 v_cndmask_b32 v23, v23, v27, s[48:49]
 v_permlane32_swap_b32 v30, v6
 v_max_f32 v30, v30, v6
 v_sub_f32 v28, v28, v30
 v_sub_f32 v20, v20, v30
 v_sub_f32 v21, v21, v30
 v_sub_f32 v22, v22, v30
 v_sub_f32 v23, v23, v30
 v_exp_f32 v28, v28
 v_exp_f32 v20, v20
 v_exp_f32 v21, v21
 v_exp_f32 v22, v22
 v_exp_f32 v23, v23
 v_cndmask_b32 v29, 0, v28, s[48:49]
 v_cndmask_b32 v28, v28, 0, s[48:49]
 v_cvt_pk_bf16_f32 v6, v28, v29
 v_cvt_pk_bf16_f32 v30, v20, v21
 v_cvt_pk_bf16_f32 v31, v22, v23
 v_mfma_f32_16x16x16_bf16 v[60:63], v[6:7], v[32:33], 0
 v_mfma_f32_16x16x16_bf16 v[52:55], v[6:7], v[2:3], 0
 v_mfma_f32_16x16x16_bf16 v[56:59], v[6:7], v[4:5], 0
 v_smfmac_f32_16x16x32_bf16 v[60:63], v[30:31], v[32:35], v5
 v_smfmac_f32_16x16x32_bf16 v[52:55], v[30:31], v[12:15], v5
 v_smfmac_f32_16x16x32_bf16 v[56:59], v[30:31], v[16:19], v5
 s_nop 0
 v_add_f32 v60, v60, v62
 v_add_f32 v61, v61, v63
 v_rcp_f32 v60, v60
 v_rcp_f32 v61, v61
 v_add_f32 v52, v52, v54
 v_add_f32 v53, v53, v55
 v_mul_f32 v52, v52, v60
 v_mul_f32 v53, v53, v61
 v_add_f32 v56, v56, v58
 v_add_f32 v57, v57, v59
 v_mul_f32 v56, v56, v60
 v_mul_f32 v57, v57, v61
 v_cvt_pk_bf16_f32 v52, v52, v56
 v_cvt_pk_bf16_f32 v53, v53, v57
 ds_write2_b32 v8, v52, v53 offset0:128 offset1:144
 v_mov_b64 v[20:21], 0
 v_mov_b64 v[22:23], 0
 v_mov_b64 v[24:25], 0
 v_mov_b64 v[26:27], 0
 v_mov_b64 v[28:29], 0
 v_mov_b64 v[30:31], 0
 v_mov_b64 v[32:33], 0
 v_mov_b64 v[34:35], 0
 s_waitcnt lgkmcnt(0)
 s_branch Lmxb_74
Lr2_79:
 s_waitcnt vmcnt(1)
 v_mfma_f32_16x16x32_bf16 v[48:51], v[44:47], v[12:15], 0
 s_waitcnt vmcnt(0)
 v_mfma_f32_16x16x32_bf16 v[48:51], v[44:47], v[16:19], v[48:51]
 v_bitop3_b32 v55, v13, v15, s46 bitop3:0x7e
 v_bitop3_b32 v56, v17, v19, s46 bitop3:0x7e
 v_bitop3_b32 v55, v55, 1, v56 bitop3:0xc8
 v_cmp_ne_u32 vcc, 0, v55
 s_nop 3
 v_add_f32_dpp v48, v48, v48 row_ror:4 row_mask:0xf bank_mask:0xf
 v_add_f32_dpp v49, v49, v49 row_ror:4 row_mask:0xf bank_mask:0xf
 s_cbranch_vccnz Lr1_78
 v_add_f32_dpp v48, v48, v48 row_ror:8 row_mask:0xf bank_mask:0xf
 v_add_f32_dpp v49, v49, v49 row_ror:8 row_mask:0xf bank_mask:0xf
 v_cvt_pk_bf16_f32 v48, v48, v49
 buffer_store_dword v48, v52, s[20:23], s44 offen
 s_branch Lb1_80
Lr1_78:
 s_mov_b64 exec, vcc
Lrt_105:
 buffer_load_dwordx4 v[12:15], v3, s[20:23], s39 offen offset:0 sc1
 buffer_load_dwordx4 v[16:19], v3, s[20:23], s39 offen offset:1024 sc1
 s_waitcnt vmcnt(2)
 v_bitop3_b32 v55, v13, v15, s46 bitop3:0x7e
 v_bitop3_b32 v56, v17, v19, s46 bitop3:0x7e
 v_bitop3_b32 v55, v55, 1, v56 bitop3:0xc8
 v_cmpx_ne_u32 vcc, 0, v55
 s_cbranch_execz Lrte_106
 buffer_load_dwordx4 v[12:15], v3, s[20:23], s39 offen offset:0 sc1
 buffer_load_dwordx4 v[16:19], v3, s[20:23], s39 offen offset:1024 sc1
 s_waitcnt vmcnt(2)
 v_bitop3_b32 v55, v13, v15, s46 bitop3:0x7e
 v_bitop3_b32 v56, v17, v19, s46 bitop3:0x7e
 v_bitop3_b32 v55, v55, 1, v56 bitop3:0xc8
 v_cmpx_ne_u32 vcc, 0, v55
 s_cbranch_execz Lrte_106
 buffer_load_dwordx4 v[12:15], v3, s[20:23], s39 offen offset:0 sc1
 buffer_load_dwordx4 v[16:19], v3, s[20:23], s39 offen offset:1024 sc1
 s_waitcnt vmcnt(2)
 v_bitop3_b32 v55, v13, v15, s46 bitop3:0x7e
 v_bitop3_b32 v56, v17, v19, s46 bitop3:0x7e
 v_bitop3_b32 v55, v55, 1, v56 bitop3:0xc8
 v_cmpx_ne_u32 vcc, 0, v55
 s_cbranch_execz Lrte_106
 s_sub_u32 s54, s54, 1
 s_cbranch_scc0 Lrt_105
 s_endpgm
Lrte_106:
 s_mov_b64 exec, -1
 s_nop 2
 v_mfma_f32_16x16x32_bf16 v[48:51], v[44:47], v[12:15], 0
 v_mfma_f32_16x16x32_bf16 v[48:51], v[44:47], v[16:19], v[48:51]
 s_nop 7
 v_add_f32_dpp v48, v48, v48 row_ror:4 row_mask:0xf bank_mask:0xf
 v_add_f32_dpp v49, v49, v49 row_ror:4 row_mask:0xf bank_mask:0xf
 s_nop 0
 v_add_f32_dpp v48, v48, v48 row_ror:8 row_mask:0xf bank_mask:0xf
 v_add_f32_dpp v49, v49, v49 row_ror:8 row_mask:0xf bank_mask:0xf
 v_cvt_pk_bf16_f32 v48, v48, v49
 buffer_store_dword v48, v52, s[20:23], s44 offen
 s_branch Lb1_80
Lr2_85:
 s_waitcnt vmcnt(1)
 v_mfma_f32_16x16x32_bf16 v[48:51], v[44:47], v[12:15], 0
 s_waitcnt vmcnt(0)
 v_mfma_f32_16x16x32_bf16 v[48:51], v[44:47], v[16:19], v[48:51]
 v_bitop3_b32 v55, v13, v15, s46 bitop3:0x7e
 v_bitop3_b32 v56, v17, v19, s46 bitop3:0x7e
 v_bitop3_b32 v55, v55, 1, v56 bitop3:0xc8
 v_cmp_ne_u32 vcc, 0, v55
 s_nop 3
 v_add_f32_dpp v48, v48, v48 row_ror:4 row_mask:0xf bank_mask:0xf
 v_add_f32_dpp v49, v49, v49 row_ror:4 row_mask:0xf bank_mask:0xf
 s_cbranch_vccnz Lr1_84
 v_add_f32_dpp v48, v48, v48 row_ror:8 row_mask:0xf bank_mask:0xf
 v_add_f32_dpp v49, v49, v49 row_ror:8 row_mask:0xf bank_mask:0xf
 v_cvt_pk_bf16_f32 v48, v48, v49
 buffer_store_dword v48, v52, s[20:23], s44 offen
 s_branch Lb1_86
Lr1_84:
 s_mov_b64 exec, vcc
Lrt_107:
 buffer_load_dwordx4 v[12:15], v3, s[20:23], s39 offen offset:0 sc1
 buffer_load_dwordx4 v[16:19], v3, s[20:23], s39 offen offset:1024 sc1
 s_waitcnt vmcnt(2)
 v_bitop3_b32 v55, v13, v15, s46 bitop3:0x7e
 v_bitop3_b32 v56, v17, v19, s46 bitop3:0x7e
 v_bitop3_b32 v55, v55, 1, v56 bitop3:0xc8
 v_cmpx_ne_u32 vcc, 0, v55
 s_cbranch_execz Lrte_108
 buffer_load_dwordx4 v[12:15], v3, s[20:23], s39 offen offset:0 sc1
 buffer_load_dwordx4 v[16:19], v3, s[20:23], s39 offen offset:1024 sc1
 s_waitcnt vmcnt(2)
 v_bitop3_b32 v55, v13, v15, s46 bitop3:0x7e
 v_bitop3_b32 v56, v17, v19, s46 bitop3:0x7e
 v_bitop3_b32 v55, v55, 1, v56 bitop3:0xc8
 v_cmpx_ne_u32 vcc, 0, v55
 s_cbranch_execz Lrte_108
 buffer_load_dwordx4 v[12:15], v3, s[20:23], s39 offen offset:0 sc1
 buffer_load_dwordx4 v[16:19], v3, s[20:23], s39 offen offset:1024 sc1
 s_waitcnt vmcnt(2)
 v_bitop3_b32 v55, v13, v15, s46 bitop3:0x7e
 v_bitop3_b32 v56, v17, v19, s46 bitop3:0x7e
 v_bitop3_b32 v55, v55, 1, v56 bitop3:0xc8
 v_cmpx_ne_u32 vcc, 0, v55
 s_cbranch_execz Lrte_108
 s_sub_u32 s54, s54, 1
 s_cbranch_scc0 Lrt_107
 s_endpgm
Lrte_108:
 s_mov_b64 exec, -1
 s_nop 2
 v_mfma_f32_16x16x32_bf16 v[48:51], v[44:47], v[12:15], 0
 v_mfma_f32_16x16x32_bf16 v[48:51], v[44:47], v[16:19], v[48:51]
 s_nop 7
 v_add_f32_dpp v48, v48, v48 row_ror:4 row_mask:0xf bank_mask:0xf
 v_add_f32_dpp v49, v49, v49 row_ror:4 row_mask:0xf bank_mask:0xf
 s_nop 0
 v_add_f32_dpp v48, v48, v48 row_ror:8 row_mask:0xf bank_mask:0xf
 v_add_f32_dpp v49, v49, v49 row_ror:8 row_mask:0xf bank_mask:0xf
 v_cvt_pk_bf16_f32 v48, v48, v49
 buffer_store_dword v48, v52, s[20:23], s44 offen
 s_branch Lb1_86
Lr2_91:
 s_waitcnt vmcnt(1)
 v_mfma_f32_16x16x32_bf16 v[48:51], v[44:47], v[12:15], 0
 s_waitcnt vmcnt(0)
 v_mfma_f32_16x16x32_bf16 v[48:51], v[44:47], v[16:19], v[48:51]
 v_bitop3_b32 v55, v13, v15, s46 bitop3:0x7e
 v_bitop3_b32 v56, v17, v19, s46 bitop3:0x7e
 v_bitop3_b32 v55, v55, 1, v56 bitop3:0xc8
 v_cmp_ne_u32 vcc, 0, v55
 s_nop 3
 v_add_f32_dpp v48, v48, v48 row_ror:4 row_mask:0xf bank_mask:0xf
 v_add_f32_dpp v49, v49, v49 row_ror:4 row_mask:0xf bank_mask:0xf
 s_cbranch_vccnz Lr1_90
 v_add_f32_dpp v48, v48, v48 row_ror:8 row_mask:0xf bank_mask:0xf
 v_add_f32_dpp v49, v49, v49 row_ror:8 row_mask:0xf bank_mask:0xf
 v_cvt_pk_bf16_f32 v48, v48, v49
 buffer_store_dword v48, v52, s[20:23], s44 offen
 s_branch Lb1_92
Lr1_90:
 s_mov_b64 exec, vcc
Lrt_109:
 buffer_load_dwordx4 v[12:15], v3, s[20:23], s39 offen offset:0 sc1
 buffer_load_dwordx4 v[16:19], v3, s[20:23], s39 offen offset:1024 sc1
 s_waitcnt vmcnt(2)
 v_bitop3_b32 v55, v13, v15, s46 bitop3:0x7e
 v_bitop3_b32 v56, v17, v19, s46 bitop3:0x7e
 v_bitop3_b32 v55, v55, 1, v56 bitop3:0xc8
 v_cmpx_ne_u32 vcc, 0, v55
 s_cbranch_execz Lrte_110
 buffer_load_dwordx4 v[12:15], v3, s[20:23], s39 offen offset:0 sc1
 buffer_load_dwordx4 v[16:19], v3, s[20:23], s39 offen offset:1024 sc1
 s_waitcnt vmcnt(2)
 v_bitop3_b32 v55, v13, v15, s46 bitop3:0x7e
 v_bitop3_b32 v56, v17, v19, s46 bitop3:0x7e
 v_bitop3_b32 v55, v55, 1, v56 bitop3:0xc8
 v_cmpx_ne_u32 vcc, 0, v55
 s_cbranch_execz Lrte_110
 buffer_load_dwordx4 v[12:15], v3, s[20:23], s39 offen offset:0 sc1
 buffer_load_dwordx4 v[16:19], v3, s[20:23], s39 offen offset:1024 sc1
 s_waitcnt vmcnt(2)
 v_bitop3_b32 v55, v13, v15, s46 bitop3:0x7e
 v_bitop3_b32 v56, v17, v19, s46 bitop3:0x7e
 v_bitop3_b32 v55, v55, 1, v56 bitop3:0xc8
 v_cmpx_ne_u32 vcc, 0, v55
 s_cbranch_execz Lrte_110
 s_sub_u32 s54, s54, 1
 s_cbranch_scc0 Lrt_109
 s_endpgm
Lrte_110:
 s_mov_b64 exec, -1
 s_nop 2
 v_mfma_f32_16x16x32_bf16 v[48:51], v[44:47], v[12:15], 0
 v_mfma_f32_16x16x32_bf16 v[48:51], v[44:47], v[16:19], v[48:51]
 s_nop 7
 v_add_f32_dpp v48, v48, v48 row_ror:4 row_mask:0xf bank_mask:0xf
 v_add_f32_dpp v49, v49, v49 row_ror:4 row_mask:0xf bank_mask:0xf
 s_nop 0
 v_add_f32_dpp v48, v48, v48 row_ror:8 row_mask:0xf bank_mask:0xf
 v_add_f32_dpp v49, v49, v49 row_ror:8 row_mask:0xf bank_mask:0xf
 v_cvt_pk_bf16_f32 v48, v48, v49
 buffer_store_dword v48, v52, s[20:23], s44 offen
 s_branch Lb1_92
Lfw_82:
Lpb_111:
 buffer_load_dword v1, v7, s[20:23], s56 offen sc1
 s_waitcnt vmcnt(0)
 v_cmp_le_u32 vcc, s58, v1
 s_cbranch_vccnz Lpbok_112
 s_sub_u32 s54, s54, 1
 s_cbranch_scc0 Lpb_111
 s_endpgm
Lpbok_112:
 s_branch Lfok_81
Lfw_88:
Lpb_113:
 buffer_load_dword v1, v7, s[20:23], s56 offen sc1
 s_waitcnt vmcnt(0)
 v_cmp_le_u32 vcc, s58, v1
 s_cbranch_vccnz Lpbok_114
 s_sub_u32 s54, s54, 1
 s_cbranch_scc0 Lpb_113
 s_endpgm
Lpbok_114:
 s_branch Lfok_87
Lfw_94:
Lpb_115:
 buffer_load_dword v1, v7, s[20:23], s56 offen sc1
 s_waitcnt vmcnt(0)
 v_cmp_le_u32 vcc, s58, v1
 s_cbranch_vccnz Lpbok_116
 s_sub_u32 s54, s54, 1
 s_cbranch_scc0 Lpb_115
 s_endpgm
Lpbok_116:
 s_branch Lfok_93
Lfw_99:
Lpb_117:
 buffer_load_dword v1, v7, s[20:23], s56 offen sc1
 s_waitcnt vmcnt(0)
 v_cmp_le_u32 vcc, s58, v1
 s_cbranch_vccnz Lpbok_118
 s_sub_u32 s54, s54, 1
 s_cbranch_scc0 Lpb_117
 s_endpgm
Lpbok_118:
 s_branch Lfok_98
Lfail_68:
 s_endpgm
Lslow_65:
 .p2align 3
Lstep_119:
 s_mov_b64 exec, -1
 s_waitcnt lgkmcnt(0)
 s_barrier
 ds_read_b128 v[52:55], v3 offset:8192
 ds_read_b128 v[56:59], v3 offset:0
 ds_read_b128 v[60:63], v3 offset:1024
 buffer_store_dwordx4 v[64:67], v0, s[20:23], s38 offen sc1
 s_waitcnt lgkmcnt(2)
 v_smfmac_f32_16x16x64_bf16 v[36:39], v[52:55], a[136:143], v5
 v_smfmac_f32_16x16x64_bf16 v[40:43], v[52:55], a[144:151], v5
 buffer_store_dword v2, v6, s[20:23], s57 offen sc1
 v_smfmac_f32_16x16x64_bf16 v[44:47], v[52:55], a[152:159], v5
 s_waitcnt lgkmcnt(1)
 v_smfmac_f32_16x16x64_bf16 v[48:51], v[52:55], v[20:27], v5
 v_smfmac_f32_16x16x64_bf16 v[36:39], v[56:59], v[72:79], v5
 ds_read_b128 v[20:23], v0 offset:40960
 v_mov_b64 v[64:65], 0
 v_smfmac_f32_16x16x64_bf16 v[40:43], v[56:59], v[80:87], v5
 ds_read_b128 v[24:27], v0 offset:45056
 v_mov_b64 v[66:67], 0
 v_smfmac_f32_16x16x64_bf16 v[44:47], v[56:59], v[88:95], v5
 ds_read_b128 v[52:55], v3 offset:2048
 s_waitcnt lgkmcnt(3)
 v_smfmac_f32_16x16x64_bf16 v[48:51], v[56:59], v[28:35], v5
 v_smfmac_f32_16x16x64_bf16 v[36:39], v[60:63], v[112:119], v5
 ds_read_b128 v[28:31], v0 offset:49152
 v_smfmac_f32_16x16x64_bf16 v[40:43], v[60:63], v[120:127], v5
 ds_read_b128 v[32:35], v0 offset:53248
 v_smfmac_f32_16x16x64_bf16 v[44:47], v[60:63], v[128:135], v5
 ds_read_b128 v[56:59], v3 offset:3072
 v_smfmac_f32_16x16x64_bf16 v[64:67], v[60:63], v[136:143], v5
 v_smfmac_f32_16x16x64_bf16 v[68:71], v[60:63], v[144:151], v5
 s_waitcnt lgkmcnt(3)
 v_smfmac_f32_16x16x64_bf16 v[48:51], v[60:63], v[20:27], v5
 v_smfmac_f32_16x16x64_bf16 v[36:39], v[52:55], v[152:159], v5
 ds_read_b128 v[20:23], v0 offset:57344
 v_smfmac_f32_16x16x64_bf16 v[40:43], v[52:55], v[160:167], v5
 ds_read_b128 v[24:27], v0 offset:61440
 v_smfmac_f32_16x16x64_bf16 v[44:47], v[52:55], v[168:175], v5
 v_smfmac_f32_16x16x64_bf16 v[64:67], v[52:55], v[176:183], v5
 v_smfmac_f32_16x16x64_bf16 v[68:71], v[52:55], v[184:191], v5
 s_waitcnt lgkmcnt(2)
 v_add_u32 v0, 0x10000, v0
 v_smfmac_f32_16x16x64_bf16 v[48:51], v[52:55], v[28:35], v5
 s_branch Ljoin_122
 .p2align 3
LstepB_121:
 s_mov_b64 exec, -1
 buffer_load_dwordx4 v[12:15], v3, s[20:23], s41 offen offset:0 sc1
 buffer_load_dwordx4 v[16:19], v3, s[20:23], s41 offen offset:1024 sc1
 s_waitcnt lgkmcnt(0)
 s_barrier
 ds_read_b128 v[52:55], v3 offset:8192
 ds_read_b128 v[56:59], v3 offset:0
 ds_read_b128 v[60:63], v3 offset:1024
 buffer_store_dwordx4 v[64:67], v0, s[20:23], s38 offen sc1
 s_waitcnt lgkmcnt(2)
 v_smfmac_f32_16x16x64_bf16 v[36:39], v[52:55], a[136:143], v5
 v_smfmac_f32_16x16x64_bf16 v[40:43], v[52:55], a[144:151], v5
 v_smfmac_f32_16x16x64_bf16 v[44:47], v[52:55], a[152:159], v5
 s_waitcnt lgkmcnt(1)
 v_smfmac_f32_16x16x64_bf16 v[48:51], v[52:55], v[20:27], v5
 s_waitcnt vmcnt(3)
 v_smfmac_f32_16x16x64_bf16 v[36:39], v[56:59], v[72:79], v5
 ds_read_b128 v[20:23], v0 offset:40960
 v_mov_b64 v[64:65], 0
 v_smfmac_f32_16x16x64_bf16 v[40:43], v[56:59], v[80:87], v5
 ds_read_b128 v[24:27], v0 offset:45056
 v_mov_b64 v[66:67], 0
 v_smfmac_f32_16x16x64_bf16 v[44:47], v[56:59], v[88:95], v5
 ds_read_b128 v[52:55], v3 offset:2048
 s_waitcnt lgkmcnt(3)
 v_smfmac_f32_16x16x64_bf16 v[48:51], v[56:59], v[28:35], v5
 v_mov_b64 v[68:69], 0
 v_smfmac_f32_16x16x64_bf16 v[36:39], v[60:63], v[112:119], v5
 ds_read_b128 v[28:31], v0 offset:49152
 v_mov_b64 v[70:71], 0
 v_smfmac_f32_16x16x64_bf16 v[40:43], v[60:63], v[120:127], v5
 ds_read_b128 v[32:35], v0 offset:53248
 v_smfmac_f32_16x16x64_bf16 v[44:47], v[60:63], v[128:135], v5
 ds_read_b128 v[56:59], v3 offset:3072
 v_smfmac_f32_16x16x64_bf16 v[64:67], v[60:63], v[136:143], v5
 s_waitcnt vmcnt(1)
 ds_write_b128 v4, v[12:15] offset:0
 v_smfmac_f32_16x16x64_bf16 v[68:71], v[60:63], v[144:151], v5
 s_waitcnt lgkmcnt(4)
 v_smfmac_f32_16x16x64_bf16 v[48:51], v[60:63], v[20:27], v5
 ds_write_b128 v4, v[16:19] offset:1024
 v_max3_u32 v2, v12, v13, v14
 v_smfmac_f32_16x16x64_bf16 v[36:39], v[52:55], v[152:159], v5
 ds_read_b128 v[20:23], v0 offset:57344
 v_max3_u32 v2, v2, v15, v16
 v_smfmac_f32_16x16x64_bf16 v[40:43], v[52:55], v[160:167], v5
 ds_read_b128 v[24:27], v0 offset:61440
 v_max3_u32 v2, v2, v17, v18
 v_smfmac_f32_16x16x64_bf16 v[44:47], v[52:55], v[168:175], v5
 v_max_u32 v2, v2, v19
 v_smfmac_f32_16x16x64_bf16 v[64:67], v[52:55], v[176:183], v5
 v_cmp_eq_u32 vcc, -1, v2
 v_smfmac_f32_16x16x64_bf16 v[68:71], v[52:55], v[184:191], v5
 s_waitcnt lgkmcnt(4)
 v_add_u32 v0, 0x10000, v0
 v_smfmac_f32_16x16x64_bf16 v[48:51], v[52:55], v[28:35], v5
 s_cbranch_vccnz Lyr_123
Lyb_124:
 s_waitcnt lgkmcnt(2)
Ljoin_122:
 v_smfmac_f32_16x16x64_bf16 v[36:39], v[56:59], v[192:199], v5
 ds_read_b128 v[28:31], v0 offset:0
 buffer_load_dwordx4 v[12:15], v3, s[20:23], s59 offen offset:0 sc1
 v_smfmac_f32_16x16x64_bf16 v[40:43], v[56:59], v[200:207], v5
 ds_read_b128 v[32:35], v0 offset:4096
 buffer_load_dwordx4 v[16:19], v3, s[20:23], s59 offen offset:1024 sc1
 v_smfmac_f32_16x16x64_bf16 v[44:47], v[56:59], v[208:215], v5
 s_barrier
 ds_read_b128 v[60:63], v3 offset:4096
 v_smfmac_f32_16x16x64_bf16 v[64:67], v[56:59], v[216:223], v5
 ds_read_b128 v[52:55], v3 offset:5120
 v_smfmac_f32_16x16x64_bf16 v[68:71], v[56:59], v[224:231], v5
 s_waitcnt lgkmcnt(4)
 v_smfmac_f32_16x16x64_bf16 v[48:51], v[56:59], v[20:27], v5
 buffer_load_dword v1, v1, s[20:23], 0 offen sc1
 s_waitcnt lgkmcnt(1)
 v_smfmac_f32_16x16x64_bf16 v[36:39], v[60:63], v[232:239], v5
 ds_read_b128 v[20:23], v0 offset:8192
 v_smfmac_f32_16x16x64_bf16 v[40:43], v[60:63], v[240:247], v5
 ds_read_b128 v[24:27], v0 offset:12288
 v_smfmac_f32_16x16x64_bf16 v[44:47], v[60:63], v[248:255], v5
 ds_read_b128 v[56:59], v3 offset:6144
 s_waitcnt lgkmcnt(3)
 v_smfmac_f32_16x16x64_bf16 v[48:51], v[60:63], v[28:35], v5
 v_smfmac_f32_16x16x64_bf16 v[36:39], v[52:55], a[16:23], v5
 ds_read_b128 v[28:31], v0 offset:16384
 v_smfmac_f32_16x16x64_bf16 v[40:43], v[52:55], a[24:31], v5
 ds_read_b128 v[32:35], v0 offset:20480
 v_smfmac_f32_16x16x64_bf16 v[44:47], v[52:55], a[32:39], v5
 ds_read_b128 v[60:63], v3 offset:7168
 s_waitcnt lgkmcnt(3)
 v_smfmac_f32_16x16x64_bf16 v[48:51], v[52:55], v[20:27], v5
 v_smfmac_f32_16x16x64_bf16 v[36:39], v[56:59], a[56:63], v5
 ds_read_b128 v[20:23], v0 offset:24576
 v_smfmac_f32_16x16x64_bf16 v[40:43], v[56:59], a[64:71], v5
 ds_read_b128 v[24:27], v0 offset:28672
 s_waitcnt lgkmcnt(2)
 v_smfmac_f32_16x16x64_bf16 v[36:39], v[60:63], a[96:103], v5
 v_smfmac_f32_16x16x64_bf16 v[40:43], v[60:63], a[104:111], v5
 v_smfmac_f32_16x16x64_bf16 v[64:67], v[52:55], a[40:47], v5
 s_nop 0
 v_add_f32 v36, v36, v38
 v_smfmac_f32_16x16x64_bf16 v[68:71], v[52:55], a[48:55], v5
 ds_read_b128 v[52:55], v3 offset:8192
 v_add_f32 v37, v37, v39
 v_smfmac_f32_16x16x64_bf16 v[44:47], v[56:59], a[72:79], v5
 v_add_f32 v40, v40, v42
 v_add_f32 v41, v41, v43
 v_smfmac_f32_16x16x64_bf16 v[48:51], v[56:59], v[28:35], v5
 s_waitcnt lgkmcnt(1)
 v_cvt_pk_bf16_f32 v36, v36, v40
 v_smfmac_f32_16x16x64_bf16 v[44:47], v[60:63], a[112:119], v5
 ds_read_b128 v[32:35], v3 offset:11264
 v_cvt_pk_bf16_f32 v37, v37, v41
 v_smfmac_f32_16x16x64_bf16 v[48:51], v[60:63], v[20:27], v5
 ds_write2_b32 v10, v36, v37 offset0:0 offset1:16
 v_smfmac_f32_16x16x64_bf16 v[64:67], v[56:59], a[80:87], v5
 ds_read_b128 v[20:23], v3 offset:9216
 v_add_f32 v44, v44, v46
 v_add_f32 v45, v45, v47
 v_smfmac_f32_16x16x64_bf16 v[68:71], v[56:59], a[88:95], v5
 s_waitcnt lgkmcnt(3)
 v_add_f32 v48, v48, v50
 v_add_f32 v49, v49, v51
 v_cvt_pk_bf16_f32 v44, v44, v48
 v_cvt_pk_bf16_f32 v45, v45, v49
 ds_write2_b32 v8, v44, v45 offset0:0 offset1:16
 v_smfmac_f32_16x16x64_bf16 v[64:67], v[52:55], a[160:167], v5
 ds_read_b128 v[56:59], v3 offset:0
 v_mov_b64 v[28:29], 0
 v_smfmac_f32_16x16x64_bf16 v[68:71], v[52:55], a[168:175], v5
 ds_read_b128 v[52:55], v3 offset:4096
 v_mov_b64 v[30:31], 0
 v_smfmac_f32_16x16x64_bf16 v[64:67], v[60:63], a[120:127], v5
 ds_read_b128 v[24:27], v3 offset:10240
 v_smfmac_f32_16x16x64_bf16 v[68:71], v[60:63], a[128:135], v5
 s_waitcnt lgkmcnt(3)
 s_barrier
 ds_read_b128 v[36:39], v11 offset:17408
 s_waitcnt lgkmcnt(3)
 v_smfmac_f32_16x16x64_bf16 v[64:67], v[56:59], v[96:103], v5
 ds_read_b128 v[40:43], v11 offset:17920
 s_waitcnt lgkmcnt(3)
 v_smfmac_f32_16x16x64_bf16 v[68:71], v[56:59], v[104:111], v5
 ds_read_b128 v[60:63], v9 offset:19456
 ds_read_b128 v[44:47], v11 offset:18432
 v_smfmac_f32_16x16x64_bf16 v[64:67], v[52:55], a[0:7], v5
 ds_read_b128 v[48:51], v11 offset:18944
 v_smfmac_f32_16x16x64_bf16 v[68:71], v[52:55], a[8:15], v5
 ds_read_b128 v[52:55], v3 offset:12288
 s_waitcnt lgkmcnt(5)
 v_mfma_f32_16x16x32_bf16 v[20:23], v[20:23], v[36:39], 0
 ds_read_b128 v[56:59], v9 offset:21504
 v_mfma_f32_16x16x32_bf16 v[24:27], v[24:27], v[36:39], 0
 v_add_f32 v64, v64, v66
 v_add_f32 v65, v65, v67
 s_waitcnt lgkmcnt(5)
 v_mfma_f32_16x16x32_bf16 v[20:23], v[32:35], v[40:43], v[20:23]
 ds_read_b128 v[32:35], v3 offset:13312
 v_cvt_pk_bf16_f32 v2, v64, v65
 v_add_f32 v68, v68, v70
 s_waitcnt lgkmcnt(5)
 v_smfmac_f32_16x16x64_bf16 v[28:31], v[60:63], v[36:43], v5
 ds_read_b128 v[60:63], v3 offset:14336
 ds_read_b128 v[36:39], v3 offset:15360
 v_add_f32 v69, v69, v71
 s_waitcnt lgkmcnt(4)
 v_mfma_f32_16x16x32_bf16 v[24:27], v[52:55], v[40:43], v[24:27]
 ds_read_b128 v[52:55], v3 offset:16384
 v_cvt_pk_bf16_f32 v4, v68, v69
 s_waitcnt lgkmcnt(4)
 v_smfmac_f32_16x16x64_bf16 v[28:31], v[56:59], v[44:51], v5
 ds_read_b128 v[40:43], v0 offset:36864
 s_waitcnt lgkmcnt(4)
 v_mfma_f32_16x16x32_bf16 v[20:23], v[32:35], v[44:47], v[20:23]
 v_mov_b64 v[32:33], s[34:35]
 v_mov_b64 v[34:35], s[34:35]
 s_waitcnt lgkmcnt(3)
 v_mfma_f32_16x16x32_bf16 v[24:27], v[60:63], v[44:47], v[24:27]
 ds_read_b128 v[44:47], v0 offset:40960
 v_add_f32 v28, v28, v30
 v_add_f32 v29, v29, v31
 s_waitcnt lgkmcnt(3)
 v_mfma_f32_16x16x32_bf16 v[20:23], v[36:39], v[48:51], v[20:23]
 ds_read_b128 v[36:39], v0 offset:32768
 v_cndmask_b32 v28, v28, v29, s[48:49]
 v_mul_f32 v28, s55, v28
 s_waitcnt lgkmcnt(3)
 v_mfma_f32_16x16x32_bf16 v[24:27], v[52:55], v[48:51], v[24:27]
 ds_read_b128 v[48:51], v0 offset:45056
 v_exp_f32 v28, v28
 v_mov_b64 v[64:65], 0
 v_cndmask_b32 v29, 0, v28, s[48:49]
 v_cndmask_b32 v28, v28, 0, s[48:49]
 v_cvt_pk_bf16_f32 v6, v28, v29
 v_mov_b64 v[66:67], 0
 v_mov_b64 v[68:69], 0
 v_cndmask_b32 v20, v20, v24, s[48:49]
 v_cndmask_b32 v21, v21, v25, s[48:49]
 v_cndmask_b32 v22, v22, v26, s[48:49]
 v_cndmask_b32 v23, v23, v27, s[48:49]
 v_mfma_f32_16x16x16_bf16 v[60:63], v[6:7], v[32:33], 0
 s_waitcnt vmcnt(1)
 v_exp_f32 v20, v20
 v_mfma_f32_16x16x16_bf16 v[52:55], v[6:7], v[2:3], 0
 s_cmp_eq_u32 s36, 63
 v_exp_f32 v21, v21
 v_mfma_f32_16x16x16_bf16 v[56:59], v[6:7], v[4:5], 0
 v_exp_f32 v22, v22
 v_exp_f32 v23, v23
 v_cvt_pk_bf16_f32 v30, v20, v21
 v_cvt_pk_bf16_f32 v31, v22, v23
 v_mov_b64 v[70:71], 0
 v_mov_b64 v[20:21], 0
 v_smfmac_f32_16x16x32_bf16 v[60:63], v[30:31], v[32:35], v5
 v_mov_b64 v[22:23], 0
 v_mov_b64 v[24:25], 0
 v_smfmac_f32_16x16x32_bf16 v[52:55], v[30:31], v[12:15], v5
 v_mov_b64 v[26:27], 0
 v_smfmac_f32_16x16x32_bf16 v[56:59], v[30:31], v[16:19], v5
 s_nop 0
 v_add_f32 v60, v60, v62
 v_add_f32 v61, v61, v63
 v_rcp_f32 v60, v60
 v_rcp_f32 v61, v61
 v_add_f32 v52, v52, v54
 v_add_f32 v53, v53, v55
 v_mul_f32 v52, v52, v60
 v_mul_f32 v53, v53, v61
 v_add_f32 v56, v56, v58
 v_add_f32 v57, v57, v59
 v_mul_f32 v56, v56, v60
 v_mul_f32 v57, v57, v61
 v_cvt_pk_bf16_f32 v52, v52, v56
 v_cvt_pk_bf16_f32 v53, v53, v57
 ds_write2_b32 v8, v52, v53 offset0:128 offset1:144
 v_subrev_u32 v60, 0x21800000, v60
 v_subrev_u32 v61, 0x21800000, v61
 v_max_u32 v60, v60, v61
 v_cmp_lt_u32 vcc, 0x3c000000, v60
 s_cbranch_scc1 Lchexit_66
 v_mov_b64 v[28:29], 0
 v_mov_b64 v[30:31], 0
 v_mov_b64 v[32:33], 0
 v_mov_b64 v[34:35], 0
 s_cbranch_vccnz Lmx_125
Lmxb_126:
 s_waitcnt lgkmcnt(0)
 v_bfe_u32 v6, v0, 7, 5
 s_barrier
 ds_read_b128 v[52:55], v9 offset:19968
 v_mul_u32_u24 v6, 10496, v6
 ds_read_b128 v[56:59], v9 offset:22016
 ds_read_b128 v[12:15], v0 offset:49152
 v_bfe_u32 v60, v3, 4, 3
 ds_read_b128 v[16:19], v0 offset:53248
 s_add_u32 s67, s67, 0x80000
 v_lshl_add_u32 v6, v60, 3, v6
 s_xor_b32 s46, s46, 0x1
 s_add_u32 s59, s59, 0x80000
 v_mov_b64 v[60:61], 0
 s_add_u32 s38, s38, 0x20000
 v_mov_b64 v[62:63], 0
 s_waitcnt lgkmcnt(3)
 v_smfmac_f32_16x16x64_bf16 v[64:67], v[52:55], a[248:255], v5
 buffer_load_dwordx4 v3, s[20:23], s67 offen offset:0 sc1 lds
 v_smfmac_f32_16x16x64_bf16 v[68:71], v[52:55], a[176:183], v5
 s_waitcnt lgkmcnt(2)
 s_cmp_lt_u32 s36, 61
 v_smfmac_f32_16x16x64_bf16 v[64:67], v[56:59], v[36:43], v5
 ds_read_b128 v[36:39], v0 offset:57344
 buffer_load_dwordx4 v3, s[20:23], s67 offen offset:1024 sc1 lds
 v_smfmac_f32_16x16x64_bf16 v[20:23], v[52:55], a[184:191], v5
 ds_read_b128 v[40:43], v0 offset:61440
 s_cselect_b32 s47, 0x80000, 0
 v_add_u32 v0, 0x10000, v0
 v_smfmac_f32_16x16x64_bf16 v[68:71], v[56:59], v[44:51], v5
 ds_read_b128 v[44:47], v0 offset:0
 s_add_u32 s68, s68, s47
 v_add_f32 v64, v64, v66
 v_add_f32 v65, v65, v67
 v_cvt_pk_bf16_f32 v65, v65, v65
 v_smfmac_f32_16x16x64_bf16 v[24:27], v[52:55], a[192:199], v5
 ds_read_b128 v[48:51], v0 offset:4096
 s_waitcnt lgkmcnt(4)
 v_cvt_pk_bf16_f32 v64, v64, v64
 v_and_or_b32 v65, v65, -2, s46
 v_smfmac_f32_16x16x64_bf16 v[20:23], v[56:59], v[12:19], v5
 ds_read_b128 v[12:15], v0 offset:8192
 buffer_store_dwordx2 v[64:65], v6, s[20:23], s62 offen sc1
 v_add_f32 v68, v68, v70
 v_add_f32 v69, v69, v71
 v_smfmac_f32_16x16x64_bf16 v[28:31], v[52:55], a[200:207], v5
 ds_read_b128 v[16:19], v0 offset:12288
 s_waitcnt lgkmcnt(4)
 v_mov_b64 v[64:65], 0
 v_mov_b64 v[66:67], 0
 v_smfmac_f32_16x16x64_bf16 v[24:27], v[56:59], v[36:43], v5
 ds_read_b128 v[36:39], v0 offset:16384
 s_add_u32 s36, s36, 1
 v_add_f32 v20, v20, v22
 v_add_f32 v21, v21, v23
 v_cvt_pk_bf16_f32 v69, v69, v21
 v_smfmac_f32_16x16x64_bf16 v[32:35], v[52:55], a[208:215], v5
 ds_read_b128 v[40:43], v0 offset:20480
 s_waitcnt lgkmcnt(4)
 v_cvt_pk_bf16_f32 v68, v68, v20
 v_and_or_b32 v69, v69, -2, s46
 v_smfmac_f32_16x16x64_bf16 v[28:31], v[56:59], v[44:51], v5
 ds_read_b128 v[44:47], v0 offset:24576
 buffer_store_dwordx2 v[68:69], v6, s[20:23], s60 offen offset:0 sc1
 v_add_f32 v24, v24, v26
 v_add_f32 v25, v25, v27
 v_smfmac_f32_16x16x64_bf16 v[60:63], v[52:55], a[216:223], v5
 ds_read_b128 v[48:51], v0 offset:28672
 s_waitcnt lgkmcnt(4)
 v_mov_b64 v[20:21], 0
 v_mov_b64 v[22:23], 0
 v_smfmac_f32_16x16x64_bf16 v[32:35], v[56:59], v[12:19], v5
 s_add_u32 s58, s36, 2
 s_min_u32 s58, s58, 64
 v_add_f32 v28, v28, v30
 v_add_f32 v29, v29, v31
 v_cvt_pk_bf16_f32 v25, v25, v29
 v_smfmac_f32_16x16x64_bf16 v[64:67], v[52:55], a[224:231], v5
 s_waitcnt lgkmcnt(2)
 s_xor_b32 s44, s44, 0x80000
 v_cvt_pk_bf16_f32 v24, v24, v28
 v_and_or_b32 v25, v25, -2, s46
 v_smfmac_f32_16x16x64_bf16 v[60:63], v[56:59], v[36:43], v5
 buffer_store_dwordx2 v[24:25], v6, s[20:23], s60 offen offset:2048 sc1
 v_add_f32 v32, v32, v34
 v_smfmac_f32_16x16x64_bf16 v[20:23], v[52:55], a[232:239], v5
 s_waitcnt lgkmcnt(0)
 s_xor_b32 s45, s45, 0x80000
 v_add_f32 v33, v33, v35
 v_smfmac_f32_16x16x64_bf16 v[64:67], v[56:59], v[44:51], v5
 s_xor_b32 s65, s65, 0x80000
 s_xor_b32 s66, s66, 0x80000
 v_add_f32 v60, v60, v62
 v_add_f32 v61, v61, v63
 v_smfmac_f32_16x16x64_bf16 v[20:23], v[56:59], a[240:247], v5
 s_cmp_eq_u32 s4, 0
 v_cvt_pk_bf16_f32 v33, v33, v61
 v_cvt_pk_bf16_f32 v32, v32, v60
 v_and_or_b32 v33, v33, -2, s46
 buffer_store_dwordx2 v[32:33], v6, s[20:23], s61 offen offset:0 sc1
 v_add_f32 v64, v64, v66
 v_add_f32 v65, v65, v67
 s_nop 0
 v_add_f32 v20, v20, v22
 v_add_f32 v21, v21, v23
 v_cvt_pk_bf16_f32 v65, v65, v21
 v_cvt_pk_bf16_f32 v64, v64, v20
 v_and_or_b32 v65, v65, -2, s46
 buffer_store_dwordx2 v[64:65], v6, s[20:23], s61 offen offset:2048 sc1
 s_cbranch_scc1 LwH_127
 s_cmp_eq_u32 s4, 1
 s_cbranch_scc1 Lw_128
 s_cmp_eq_u32 s4, 2
 s_cbranch_scc1 Lw_129
 s_xor_b32 s41, s41, 0x80000
 s_xor_b32 s43, s43, 0x80000
 v_mov_b32 v47, 0x3f80
 v_cndmask_b32 v47, v47, 1.0, s[32:33]
 v_cndmask_b32 v44, 0, v47, s[24:25]
 v_cndmask_b32 v45, 0, v47, s[26:27]
 v_cndmask_b32 v46, 0, v47, s[28:29]
 v_cndmask_b32 v47, 0, v47, s[30:31]
 v_bfe_u32 v52, v3, 8, 2
 v_bfe_u32 v58, v3, 2, 4
 v_lshl_or_b32 v52, v52, 4, v58
 v_and_b32 v58, 0xc0, v3
 v_lshl_or_b32 v52, v58, 24, v52
 v_subrev_u32 v0, 0x20000, v0
 v_mov_b32 v59, -1
 v_add_u32 v54, s42, v3
 v_add_u32 v58, s69, v9
 ds_read_b64 v[64:65], v58 offset:19456
 v_mov_b32 v66, v2
 v_mov_b32 v67, v4
 v_mov_b64 v[68:69], 0
 v_mov_b64 v[70:71], 0
 ds_read_b128 v[20:23], v0 offset:24576
 ds_read_b128 v[24:27], v0 offset:28672
 ds_read_b128 v[28:31], v0 offset:32768
 ds_read_b128 v[32:35], v0 offset:36864
 s_waitcnt vmcnt(0)
 buffer_load_dwordx4 v[36:39], v3, s[20:23], s39 offen offset:0 sc1
 buffer_load_dwordx4 v[40:43], v3, s[20:23], s39 offen offset:1024 sc1
 s_nop 15
 s_nop 10
 buffer_load_dwordx4 v[12:15], v3, s[20:23], s39 offen offset:0 sc1
 buffer_load_dwordx4 v[16:19], v3, s[20:23], s39 offen offset:1024 sc1
 s_waitcnt vmcnt(3)
 v_mfma_f32_16x16x32_bf16 v[48:51], v[44:47], v[36:39], 0
 s_waitcnt vmcnt(2)
 v_mfma_f32_16x16x32_bf16 v[48:51], v[44:47], v[40:43], v[48:51]
 v_bitop3_b32 v55, v37, v39, s46 bitop3:0x7e
 v_bitop3_b32 v56, v41, v43, s46 bitop3:0x7e
 v_bitop3_b32 v55, v55, 1, v56 bitop3:0xc8
 v_cmp_ne_u32 vcc, 0, v55
 s_nop 3
 v_add_f32_dpp v48, v48, v48 row_ror:4 row_mask:0xf bank_mask:0xf
 v_add_f32_dpp v49, v49, v49 row_ror:4 row_mask:0xf bank_mask:0xf
 s_cbranch_vccnz Lr2_131
 v_add_f32_dpp v48, v48, v48 row_ror:8 row_mask:0xf bank_mask:0xf
 v_add_f32_dpp v49, v49, v49 row_ror:8 row_mask:0xf bank_mask:0xf
 v_cvt_pk_bf16_f32 v48, v48, v49
 buffer_store_dword v48, v52, s[20:23], s44 offen sc1
Lb1_132:
 buffer_store_dword v59, v52, s[20:23], s45 offen sc1
 v_cmp_gt_u32 vcc, s58, v1
 v_mov_b64 v[36:37], 0
 v_mov_b64 v[38:39], 0
 v_mov_b64 v[40:41], 0
 v_mov_b64 v[42:43], 0
 v_mov_b64 v[44:45], 0
 v_mov_b64 v[46:47], 0
 v_mov_b64 v[48:49], 0
 v_mov_b64 v[50:51], 0
 s_cmp_lg_u32 vcc_hi, 0
 s_cbranch_scc1 Lfw_134
Lfok_133:
 v_lshl_add_u32 v1, v3, 3, s68
 v_mov_b32 v6, s56
 v_cndmask_b32 v1, v6, v1, s[70:71]
 v_mov_b32 v4, v54
 s_waitcnt vmcnt(0)
 s_nop 15
 s_nop 15
 s_nop 11
 s_branch LstepB_121
Lw_129:
 s_xor_b32 s41, s41, 0x80000
 s_xor_b32 s43, s43, 0x80000
 v_mov_b32 v47, 0x3f80
 v_cndmask_b32 v47, v47, 1.0, s[32:33]
 v_cndmask_b32 v44, 0, v47, s[24:25]
 v_cndmask_b32 v45, 0, v47, s[26:27]
 v_cndmask_b32 v46, 0, v47, s[28:29]
 v_cndmask_b32 v47, 0, v47, s[30:31]
 v_bfe_u32 v52, v3, 8, 2
 v_bfe_u32 v58, v3, 2, 4
 v_lshl_or_b32 v52, v52, 4, v58
 v_and_b32 v58, 0xc0, v3
 v_lshl_or_b32 v52, v58, 24, v52
 v_subrev_u32 v0, 0x20000, v0
 v_mov_b32 v59, -1
 v_add_u32 v54, s42, v3
 v_add_u32 v58, s69, v9
 ds_read_b64 v[64:65], v58 offset:19456
 v_mov_b32 v66, v2
 v_mov_b32 v67, v4
 v_mov_b64 v[68:69], 0
 v_mov_b64 v[70:71], 0
 ds_read_b128 v[20:23], v0 offset:24576
 ds_read_b128 v[24:27], v0 offset:28672
 ds_read_b128 v[28:31], v0 offset:32768
 ds_read_b128 v[32:35], v0 offset:36864
 s_waitcnt vmcnt(1)
 buffer_load_dwordx4 v[36:39], v3, s[20:23], s39 offen offset:0 sc1
 buffer_load_dwordx4 v[40:43], v3, s[20:23], s39 offen offset:1024 sc1
 s_nop 15
 s_nop 10
 buffer_load_dwordx4 v[12:15], v3, s[20:23], s39 offen offset:0 sc1
 buffer_load_dwordx4 v[16:19], v3, s[20:23], s39 offen offset:1024 sc1
 s_waitcnt vmcnt(3)
 v_mfma_f32_16x16x32_bf16 v[48:51], v[44:47], v[36:39], 0
 s_waitcnt vmcnt(2)
 v_mfma_f32_16x16x32_bf16 v[48:51], v[44:47], v[40:43], v[48:51]
 v_bitop3_b32 v55, v37, v39, s46 bitop3:0x7e
 v_bitop3_b32 v56, v41, v43, s46 bitop3:0x7e
 v_bitop3_b32 v55, v55, 1, v56 bitop3:0xc8
 v_cmp_ne_u32 vcc, 0, v55
 s_nop 3
 v_add_f32_dpp v48, v48, v48 row_ror:4 row_mask:0xf bank_mask:0xf
 v_add_f32_dpp v49, v49, v49 row_ror:4 row_mask:0xf bank_mask:0xf
 s_cbranch_vccnz Lr2_137
 v_add_f32_dpp v48, v48, v48 row_ror:8 row_mask:0xf bank_mask:0xf
 v_add_f32_dpp v49, v49, v49 row_ror:8 row_mask:0xf bank_mask:0xf
 v_cvt_pk_bf16_f32 v48, v48, v49
 buffer_store_dword v48, v52, s[20:23], s44 offen sc1
Lb1_138:
 buffer_store_dword v59, v52, s[20:23], s45 offen sc1
 v_cmp_gt_u32 vcc, s58, v1
 v_mov_b64 v[36:37], 0
 v_mov_b64 v[38:39], 0
 v_mov_b64 v[40:41], 0
 v_mov_b64 v[42:43], 0
 v_mov_b64 v[44:45], 0
 v_mov_b64 v[46:47], 0
 v_mov_b64 v[48:49], 0
 v_mov_b64 v[50:51], 0
 s_cmp_lg_u32 vcc_hi, 0
 s_cbranch_scc1 Lfw_140
Lfok_139:
 v_lshl_add_u32 v1, v3, 3, s68
 v_mov_b32 v6, s56
 v_cndmask_b32 v1, v6, v1, s[70:71]
 v_mov_b32 v4, v54
 s_nop 7
 buffer_load_dwordx4 v[68:71], v3, s[20:23], s43 offen offset:0 sc1
 s_nop 15
 s_nop 7
Lp2_141:
 buffer_load_dwordx4 v[68:71], v3, s[20:23], s43 offen offset:0 sc1
 s_waitcnt vmcnt(1)
 v_max3_u32 v55, v68, v69, v70
 v_max_u32 v55, v55, v71
 ds_write_b128 v3, v[68:71] offset:8192
 v_cmpx_eq_u32 vcc, -1, v55
 s_cbranch_execz LstepB_121
 buffer_load_dwordx4 v[68:71], v3, s[20:23], s43 offen offset:0 sc1
 s_waitcnt vmcnt(1)
 v_max3_u32 v55, v68, v69, v70
 v_max_u32 v55, v55, v71
 ds_write_b128 v3, v[68:71] offset:8192
 v_cmpx_eq_u32 vcc, -1, v55
 s_cbranch_execz LstepB_121
 buffer_load_dwordx4 v[68:71], v3, s[20:23], s43 offen offset:0 sc1
 s_waitcnt vmcnt(1)
 v_max3_u32 v55, v68, v69, v70
 v_max_u32 v55, v55, v71
 ds_write_b128 v3, v[68:71] offset:8192
 v_cmpx_eq_u32 vcc, -1, v55
 s_cbranch_execz LstepB_121
 s_sub_u32 s54, s54, 1
 s_cbranch_scc0 Lp2_141
 s_endpgm
Lw_128:
 s_waitcnt vmcnt(2)
 buffer_load_dwordx4 v[36:39], v3, s[20:23], s39 offen offset:0 sc1
 buffer_load_dwordx4 v[40:43], v3, s[20:23], s39 offen offset:1024 sc1
 s_xor_b32 s41, s41, 0x80000
 s_xor_b32 s43, s43, 0x80000
 v_mov_b32 v47, 0x3f80
 v_cndmask_b32 v47, v47, 1.0, s[32:33]
 v_cndmask_b32 v44, 0, v47, s[24:25]
 v_cndmask_b32 v45, 0, v47, s[26:27]
 v_cndmask_b32 v46, 0, v47, s[28:29]
 v_cndmask_b32 v47, 0, v47, s[30:31]
 v_bfe_u32 v52, v3, 8, 2
 v_bfe_u32 v58, v3, 2, 4
 v_lshl_or_b32 v52, v52, 4, v58
 v_and_b32 v58, 0xc0, v3
 v_lshl_or_b32 v52, v58, 24, v52
 v_subrev_u32 v0, 0x20000, v0
 v_mov_b32 v59, -1
 v_add_u32 v54, s42, v3
 v_add_u32 v58, s69, v9
 ds_read_b64 v[64:65], v58 offset:19456
 v_mov_b32 v66, v2
 v_mov_b32 v67, v4
 v_mov_b64 v[68:69], 0
 v_mov_b64 v[70:71], 0
 ds_read_b128 v[20:23], v0 offset:24576
 ds_read_b128 v[24:27], v0 offset:28672
 ds_read_b128 v[28:31], v0 offset:32768
 ds_read_b128 v[32:35], v0 offset:36864
 s_nop 3
 buffer_load_dwordx4 v[12:15], v3, s[20:23], s39 offen offset:0 sc1
 buffer_load_dwordx4 v[16:19], v3, s[20:23], s39 offen offset:1024 sc1
 s_waitcnt vmcnt(3)
 v_mfma_f32_16x16x32_bf16 v[48:51], v[44:47], v[36:39], 0
 s_waitcnt vmcnt(2)
 v_mfma_f32_16x16x32_bf16 v[48:51], v[44:47], v[40:43], v[48:51]
 v_bitop3_b32 v55, v37, v39, s46 bitop3:0x7e
 v_bitop3_b32 v56, v41, v43, s46 bitop3:0x7e
 v_bitop3_b32 v55, v55, 1, v56 bitop3:0xc8
 v_cmp_ne_u32 vcc, 0, v55
 s_nop 3
 v_add_f32_dpp v48, v48, v48 row_ror:4 row_mask:0xf bank_mask:0xf
 v_add_f32_dpp v49, v49, v49 row_ror:4 row_mask:0xf bank_mask:0xf
 s_cbranch_vccnz Lr2_143
 v_add_f32_dpp v48, v48, v48 row_ror:8 row_mask:0xf bank_mask:0xf
 v_add_f32_dpp v49, v49, v49 row_ror:8 row_mask:0xf bank_mask:0xf
 v_cvt_pk_bf16_f32 v48, v48, v49
 buffer_store_dword v48, v52, s[20:23], s44 offen sc1
Lb1_144:
 buffer_store_dword v59, v52, s[20:23], s45 offen sc1
 v_cmp_gt_u32 vcc, s58, v1
 v_mov_b64 v[36:37], 0
 v_mov_b64 v[38:39], 0
 v_mov_b64 v[40:41], 0
 v_mov_b64 v[42:43], 0
 v_mov_b64 v[44:45], 0
 v_mov_b64 v[46:47], 0
 v_mov_b64 v[48:49], 0
 v_mov_b64 v[50:51], 0
 s_cmp_lg_u32 vcc_hi, 0
 s_cbranch_scc1 Lfw_146
Lfok_145:
 v_lshl_add_u32 v1, v3, 3, s68
 v_mov_b32 v6, s56
 v_cndmask_b32 v1, v6, v1, s[70:71]
 v_min_u32 v6, 16, v0
 v_lshlrev_b32 v6, 24, v6
 s_max_u32 s47, s36, 1
 v_add_u32 v2, -1, s47
 s_nop 15
 s_nop 0
 buffer_load_dwordx4 v[12:15], v3, s[20:23], s41 offen offset:0 sc1
 buffer_load_dwordx4 v[16:19], v3, s[20:23], s41 offen offset:1024 sc1
 s_nop 15
 s_nop 7
Lp2_147:
 buffer_load_dwordx4 v[12:15], v3, s[20:23], s41 offen offset:0 sc1
 buffer_load_dwordx4 v[16:19], v3, s[20:23], s41 offen offset:1024 sc1
 s_waitcnt vmcnt(2)
 v_max3_u32 v55, v12, v13, v14
 v_max3_u32 v55, v55, v15, v16
 v_max3_u32 v55, v55, v17, v18
 v_max_u32 v55, v55, v19
 ds_write_b128 v54, v[12:15] offset:0
 ds_write_b128 v54, v[16:19] offset:1024
 v_cmpx_eq_u32 vcc, -1, v55
 s_cbranch_execz Lstep_119
 buffer_load_dwordx4 v[12:15], v3, s[20:23], s41 offen offset:0 sc1
 buffer_load_dwordx4 v[16:19], v3, s[20:23], s41 offen offset:1024 sc1
 s_waitcnt vmcnt(2)
 v_max3_u32 v55, v12, v13, v14
 v_max3_u32 v55, v55, v15, v16
 v_max3_u32 v55, v55, v17, v18
 v_max_u32 v55, v55, v19
 ds_write_b128 v54, v[12:15] offset:0
 ds_write_b128 v54, v[16:19] offset:1024
 v_cmpx_eq_u32 vcc, -1, v55
 s_cbranch_execz Lstep_119
 buffer_load_dwordx4 v[12:15], v3, s[20:23], s41 offen offset:0 sc1
 buffer_load_dwordx4 v[16:19], v3, s[20:23], s41 offen offset:1024 sc1
 s_waitcnt vmcnt(2)
 v_max3_u32 v55, v12, v13, v14
 v_max3_u32 v55, v55, v15, v16
 v_max3_u32 v55, v55, v17, v18
 v_max_u32 v55, v55, v19
 ds_write_b128 v54, v[12:15] offset:0
 ds_write_b128 v54, v[16:19] offset:1024
 v_cmpx_eq_u32 vcc, -1, v55
 s_cbranch_execz Lstep_119
 s_sub_u32 s54, s54, 1
 s_cbranch_scc0 Lp2_147
 s_endpgm
LwH_127:
 v_bfe_u32 v53, v3, 8, 1
 v_bfe_u32 v58, v3, 9, 1
 v_lshl_or_b32 v53, v53, 1, v58
 v_bfe_u32 v58, v3, 5, 1
 v_lshl_or_b32 v53, v53, 1, v58
 v_and_b32 v58, 0xd0, v3
 v_lshlrev_b32 v58, 24, v58
 v_lshl_or_b32 v53, v53, 2, v58
 s_waitcnt vmcnt(3)
 s_nop 7
 buffer_load_dwordx4 v[20:23], v3, s[20:23], s40 offen offset:0 sc1
 buffer_load_dwordx4 v[24:27], v3, s[20:23], s40 offen offset:1024 sc1
 buffer_load_dwordx4 v[36:39], v3, s[20:23], s39 offen offset:0 sc1
 buffer_load_dwordx4 v[40:43], v3, s[20:23], s39 offen offset:1024 sc1
 s_xor_b32 s41, s41, 0x80000
 s_xor_b32 s43, s43, 0x80000
 v_mov_b32 v47, 0x3f80
 v_cndmask_b32 v47, v47, 1.0, s[32:33]
 v_cndmask_b32 v44, 0, v47, s[24:25]
 v_cndmask_b32 v45, 0, v47, s[26:27]
 v_cndmask_b32 v46, 0, v47, s[28:29]
 v_cndmask_b32 v47, 0, v47, s[30:31]
 v_bfe_u32 v52, v3, 8, 2
 v_bfe_u32 v58, v3, 2, 4
 v_lshl_or_b32 v52, v52, 4, v58
 v_and_b32 v58, 0xc0, v3
 v_lshl_or_b32 v52, v58, 24, v52
 v_subrev_u32 v0, 0x20000, v0
 v_mov_b32 v59, -1
 v_add_u32 v54, s42, v3
 v_add_u32 v58, s69, v9
 ds_read_b64 v[64:65], v58 offset:19456
 v_mov_b32 v66, v2
 v_mov_b32 v67, v4
 v_mov_b64 v[68:69], 0
 v_mov_b64 v[70:71], 0
 s_waitcnt vmcnt(2)
 v_mfma_f32_16x16x32_bf16 v[28:31], v[44:47], v[20:23], 0
 v_mfma_f32_16x16x32_bf16 v[28:31], v[44:47], v[24:27], v[28:31]
 s_waitcnt vmcnt(1)
 v_mfma_f32_16x16x32_bf16 v[48:51], v[44:47], v[36:39], 0
 s_waitcnt vmcnt(0)
 v_mfma_f32_16x16x32_bf16 v[48:51], v[44:47], v[40:43], v[48:51]
 v_bitop3_b32 v55, v37, v39, s46 bitop3:0x7e
 v_bitop3_b32 v56, v41, v43, s46 bitop3:0x7e
 v_bitop3_b32 v57, v21, v23, s46 bitop3:0x7e
 v_or3_b32 v55, v55, v56, v57
 v_bitop3_b32 v56, v25, v27, s46 bitop3:0x7e
 v_bitop3_b32 v55, v55, 1, v56 bitop3:0xc8
 v_cmp_ne_u32 vcc, 0, v55
 v_add_f32_dpp v29, v29, v29 row_ror:4 row_mask:0xf bank_mask:0xf
 v_add_f32_dpp v48, v48, v48 row_ror:4 row_mask:0xf bank_mask:0xf
 v_add_f32_dpp v49, v49, v49 row_ror:4 row_mask:0xf bank_mask:0xf
 v_add_f32_dpp v29, v29, v29 row_ror:8 row_mask:0xf bank_mask:0xf
 v_add_f32_dpp v48, v48, v48 row_ror:8 row_mask:0xf bank_mask:0xf
 v_add_f32_dpp v49, v49, v49 row_ror:8 row_mask:0xf bank_mask:0xf
 s_cbranch_vccnz Lr1_148
 v_cvt_pk_bf16_f32 v48, v48, v49
 buffer_store_dword v48, v52, s[20:23], s44 offen sc1
 v_mov_b32_dpp v30, v29 quad_perm:[1,0,3,2] row_mask:0xf bank_mask:0xf
 v_cvt_pk_bf16_f32 v29, v29, v30
 buffer_store_dword v29, v53, s[20:23], s65 offen sc1
Lb1_149:
 buffer_store_dword v59, v52, s[20:23], s45 offen sc1
 buffer_store_dword v59, v53, s[20:23], s66 offen sc1
 v_cmp_gt_u32 vcc, s58, v1
 ds_read_b128 v[20:23], v0 offset:24576
 ds_read_b128 v[24:27], v0 offset:28672
 ds_read_b128 v[28:31], v0 offset:32768
 ds_read_b128 v[32:35], v0 offset:36864
 v_mov_b64 v[36:37], 0
 v_mov_b64 v[38:39], 0
 v_mov_b64 v[40:41], 0
 v_mov_b64 v[42:43], 0
 v_mov_b64 v[44:45], 0
 v_mov_b64 v[46:47], 0
 v_mov_b64 v[48:49], 0
 v_mov_b64 v[50:51], 0
 s_cmp_lg_u32 vcc_hi, 0
 s_cbranch_scc1 Lfw_151
Lfok_150:
 v_lshl_add_u32 v1, v3, 3, s68
 v_mov_b32 v6, s56
 v_cndmask_b32 v1, v6, v1, s[70:71]
 v_min_u32 v6, 16, v0
 v_lshlrev_b32 v6, 24, v6
 s_max_u32 s47, s36, 1
 v_add_u32 v2, -1, s47
 s_nop 10
 buffer_load_dwordx4 v[12:15], v3, s[20:23], s41 offen offset:0 sc1
 buffer_load_dwordx4 v[16:19], v3, s[20:23], s41 offen offset:1024 sc1
 s_nop 15
 s_nop 7
Lp2_152:
 buffer_load_dwordx4 v[12:15], v3, s[20:23], s41 offen offset:0 sc1
 buffer_load_dwordx4 v[16:19], v3, s[20:23], s41 offen offset:1024 sc1
 s_waitcnt vmcnt(2)
 v_max3_u32 v55, v12, v13, v14
 v_max3_u32 v55, v55, v15, v16
 v_max3_u32 v55, v55, v17, v18
 v_max_u32 v55, v55, v19
 ds_write_b128 v54, v[12:15] offset:0
 ds_write_b128 v54, v[16:19] offset:1024
 v_cmpx_eq_u32 vcc, -1, v55
 s_cbranch_execz Lstep_119
 buffer_load_dwordx4 v[12:15], v3, s[20:23], s41 offen offset:0 sc1
 buffer_load_dwordx4 v[16:19], v3, s[20:23], s41 offen offset:1024 sc1
 s_waitcnt vmcnt(2)
 v_max3_u32 v55, v12, v13, v14
 v_max3_u32 v55, v55, v15, v16
 v_max3_u32 v55, v55, v17, v18
 v_max_u32 v55, v55, v19
 ds_write_b128 v54, v[12:15] offset:0
 ds_write_b128 v54, v[16:19] offset:1024
 v_cmpx_eq_u32 vcc, -1, v55
 s_cbranch_execz Lstep_119
 buffer_load_dwordx4 v[12:15], v3, s[20:23], s41 offen offset:0 sc1
 buffer_load_dwordx4 v[16:19], v3, s[20:23], s41 offen offset:1024 sc1
 s_waitcnt vmcnt(2)
 v_max3_u32 v55, v12, v13, v14
 v_max3_u32 v55, v55, v15, v16
 v_max3_u32 v55, v55, v17, v18
 v_max_u32 v55, v55, v19
 ds_write_b128 v54, v[12:15] offset:0
 ds_write_b128 v54, v[16:19] offset:1024
 v_cmpx_eq_u32 vcc, -1, v55
 s_cbranch_execz Lstep_119
 s_sub_u32 s54, s54, 1
 s_cbranch_scc0 Lp2_152
 s_endpgm
Lr1_148:
 s_mov_b64 exec, vcc
Lrt_153:
 buffer_load_dwordx4 v[20:23], v3, s[20:23], s40 offen offset:0 sc1
 buffer_load_dwordx4 v[24:27], v3, s[20:23], s40 offen offset:1024 sc1
 buffer_load_dwordx4 v[36:39], v3, s[20:23], s39 offen offset:0 sc1
 buffer_load_dwordx4 v[40:43], v3, s[20:23], s39 offen offset:1024 sc1
 s_waitcnt vmcnt(4)
 v_bitop3_b32 v55, v37, v39, s46 bitop3:0x7e
 v_bitop3_b32 v56, v41, v43, s46 bitop3:0x7e
 v_bitop3_b32 v57, v21, v23, s46 bitop3:0x7e
 v_or3_b32 v55, v55, v56, v57
 v_bitop3_b32 v56, v25, v27, s46 bitop3:0x7e
 v_bitop3_b32 v55, v55, 1, v56 bitop3:0xc8
 v_cmpx_ne_u32 vcc, 0, v55
 s_cbranch_execz Lrte_154
 buffer_load_dwordx4 v[20:23], v3, s[20:23], s40 offen offset:0 sc1
 buffer_load_dwordx4 v[24:27], v3, s[20:23], s40 offen offset:1024 sc1
 buffer_load_dwordx4 v[36:39], v3, s[20:23], s39 offen offset:0 sc1
 buffer_load_dwordx4 v[40:43], v3, s[20:23], s39 offen offset:1024 sc1
 s_waitcnt vmcnt(4)
 v_bitop3_b32 v55, v37, v39, s46 bitop3:0x7e
 v_bitop3_b32 v56, v41, v43, s46 bitop3:0x7e
 v_bitop3_b32 v57, v21, v23, s46 bitop3:0x7e
 v_or3_b32 v55, v55, v56, v57
 v_bitop3_b32 v56, v25, v27, s46 bitop3:0x7e
 v_bitop3_b32 v55, v55, 1, v56 bitop3:0xc8
 v_cmpx_ne_u32 vcc, 0, v55
 s_cbranch_execz Lrte_154
 buffer_load_dwordx4 v[20:23], v3, s[20:23], s40 offen offset:0 sc1
 buffer_load_dwordx4 v[24:27], v3, s[20:23], s40 offen offset:1024 sc1
 buffer_load_dwordx4 v[36:39], v3, s[20:23], s39 offen offset:0 sc1
 buffer_load_dwordx4 v[40:43], v3, s[20:23], s39 offen offset:1024 sc1
 s_waitcnt vmcnt(4)
 v_bitop3_b32 v55, v37, v39, s46 bitop3:0x7e
 v_bitop3_b32 v56, v41, v43, s46 bitop3:0x7e
 v_bitop3_b32 v57, v21, v23, s46 bitop3:0x7e
 v_or3_b32 v55, v55, v56, v57
 v_bitop3_b32 v56, v25, v27, s46 bitop3:0x7e
 v_bitop3_b32 v55, v55, 1, v56 bitop3:0xc8
 v_cmpx_ne_u32 vcc, 0, v55
 s_cbranch_execz Lrte_154
 s_sub_u32 s54, s54, 1
 s_cbranch_scc0 Lrt_153
 s_endpgm
Lrte_154:
 s_mov_b64 exec, -1
 s_nop 2
 v_mfma_f32_16x16x32_bf16 v[28:31], v[44:47], v[20:23], 0
 v_mfma_f32_16x16x32_bf16 v[28:31], v[44:47], v[24:27], v[28:31]
 v_mfma_f32_16x16x32_bf16 v[48:51], v[44:47], v[36:39], 0
 v_mfma_f32_16x16x32_bf16 v[48:51], v[44:47], v[40:43], v[48:51]
 s_nop 6
 v_add_f32_dpp v29, v29, v29 row_ror:4 row_mask:0xf bank_mask:0xf
 v_add_f32_dpp v48, v48, v48 row_ror:4 row_mask:0xf bank_mask:0xf
 v_add_f32_dpp v49, v49, v49 row_ror:4 row_mask:0xf bank_mask:0xf
 v_add_f32_dpp v29, v29, v29 row_ror:8 row_mask:0xf bank_mask:0xf
 v_add_f32_dpp v48, v48, v48 row_ror:8 row_mask:0xf bank_mask:0xf
 v_add_f32_dpp v49, v49, v49 row_ror:8 row_mask:0xf bank_mask:0xf
 v_cvt_pk_bf16_f32 v48, v48, v49
 buffer_store_dword v48, v52, s[20:23], s44 offen sc1
 v_mov_b32_dpp v30, v29 quad_perm:[1,0,3,2] row_mask:0xf bank_mask:0xf
 v_cvt_pk_bf16_f32 v29, v29, v30
 buffer_store_dword v29, v53, s[20:23], s65 offen sc1
 s_waitcnt vmcnt(2)
 s_branch Lb1_149
Lyr_123:
 s_mov_b64 exec, vcc
Lrt_155:
 buffer_load_dwordx4 v[12:15], v3, s[20:23], s41 offen offset:0 sc1
 buffer_load_dwordx4 v[16:19], v3, s[20:23], s41 offen offset:1024 sc1
 s_waitcnt vmcnt(2)
 v_max3_u32 v2, v12, v13, v14
 v_max3_u32 v2, v2, v15, v16
 v_max3_u32 v2, v2, v17, v18
 v_max_u32 v2, v2, v19
 v_cmpx_eq_u32 vcc, -1, v2
 s_cbranch_execz Lrte_156
 buffer_load_dwordx4 v[12:15], v3, s[20:23], s41 offen offset:0 sc1
 buffer_load_dwordx4 v[16:19], v3, s[20:23], s41 offen offset:1024 sc1
 s_waitcnt vmcnt(2)
 v_max3_u32 v2, v12, v13, v14
 v_max3_u32 v2, v2, v15, v16
 v_max3_u32 v2, v2, v17, v18
 v_max_u32 v2, v2, v19
 v_cmpx_eq_u32 vcc, -1, v2
 s_cbranch_execz Lrte_156
 buffer_load_dwordx4 v[12:15], v3, s[20:23], s41 offen offset:0 sc1
 buffer_load_dwordx4 v[16:19], v3, s[20:23], s41 offen offset:1024 sc1
 s_waitcnt vmcnt(2)
 v_max3_u32 v2, v12, v13, v14
 v_max3_u32 v2, v2, v15, v16
 v_max3_u32 v2, v2, v17, v18
 v_max_u32 v2, v2, v19
 v_cmpx_eq_u32 vcc, -1, v2
 s_cbranch_execz Lrte_156
 s_sub_u32 s54, s54, 1
 s_cbranch_scc0 Lrt_155
 s_endpgm
Lrte_156:
 s_mov_b64 exec, -1
 ds_write_b128 v4, v[12:15] offset:0
 ds_write_b128 v4, v[16:19] offset:1024
 s_waitcnt lgkmcnt(0)
 s_branch Lyb_124
Lmx_125:
 s_waitcnt lgkmcnt(0)
 ds_read_b128 v[36:39], v11 offset:17408
 ds_read_b128 v[40:43], v11 offset:17920
 ds_read_b128 v[44:47], v11 offset:18432
 ds_read_b128 v[48:51], v11 offset:18944
 v_mov_b64 v[28:29], 0
 v_mov_b64 v[30:31], 0
 ds_read_b128 v[52:55], v3 offset:9216
 ds_read_b128 v[56:59], v3 offset:10240
 s_waitcnt lgkmcnt(0)
 v_mfma_f32_16x16x32_bf16 v[20:23], v[52:55], v[36:39], 0
 v_mfma_f32_16x16x32_bf16 v[24:27], v[56:59], v[36:39], 0
 ds_read_b128 v[52:55], v3 offset:11264
 ds_read_b128 v[56:59], v3 offset:12288
 s_waitcnt lgkmcnt(0)
 v_mfma_f32_16x16x32_bf16 v[20:23], v[52:55], v[40:43], v[20:23]
 v_mfma_f32_16x16x32_bf16 v[24:27], v[56:59], v[40:43], v[24:27]
 ds_read_b128 v[52:55], v3 offset:13312
 ds_read_b128 v[56:59], v3 offset:14336
 s_waitcnt lgkmcnt(0)
 v_mfma_f32_16x16x32_bf16 v[20:23], v[52:55], v[44:47], v[20:23]
 v_mfma_f32_16x16x32_bf16 v[24:27], v[56:59], v[44:47], v[24:27]
 ds_read_b128 v[52:55], v3 offset:15360
 ds_read_b128 v[56:59], v3 offset:16384
 s_waitcnt lgkmcnt(0)
 v_mfma_f32_16x16x32_bf16 v[20:23], v[52:55], v[48:51], v[20:23]
 v_mfma_f32_16x16x32_bf16 v[24:27], v[56:59], v[48:51], v[24:27]
 ds_read_b128 v[52:55], v9 offset:19456
 ds_read_b128 v[56:59], v9 offset:21504
 s_waitcnt lgkmcnt(0)
 v_smfmac_f32_16x16x64_bf16 v[28:31], v[52:55], v[36:43], v5
 v_smfmac_f32_16x16x64_bf16 v[28:31], v[56:59], v[44:51], v5
 ds_read_b128 v[36:39], v0 offset:32768
 ds_read_b128 v[40:43], v0 offset:36864
 ds_read_b128 v[44:47], v0 offset:40960
 ds_read_b128 v[48:51], v0 offset:45056
 v_mov_b64 v[32:33], s[34:35]
 v_mov_b64 v[34:35], s[34:35]
 s_nop 1
 v_add_f32 v28, v28, v30
 v_add_f32 v29, v29, v31
 v_mul_f32 v28, s55, v28
 v_mul_f32 v29, s55, v29
 v_max_f32 v30, v28, v29
 v_cndmask_b32 v28, v28, v29, s[48:49]
 v_max3_f32 v30, v30, v20, v21
 v_max3_f32 v30, v30, v22, v23
 v_max3_f32 v30, v30, v24, v25
 v_max3_f32 v31, v30, v26, v27
 v_max3_f32 v29, v30, v26, v27
 v_cndmask_b32 v20, v20, v24, s[48:49]
 v_cndmask_b32 v21, v21, v25, s[48:49]
 v_permlane16_swap_b32 v31, v29
 v_max_f32 v30, v31, v29
 v_max_f32 v6, v31, v29
 v_cndmask_b32 v22, v22, v26, s[48:49]
 v_cndmask_b32 v23, v23, v27, s[48:49]
 v_permlane32_swap_b32 v30, v6
 v_max_f32 v30, v30, v6
 v_sub_f32 v28, v28, v30
 v_sub_f32 v20, v20, v30
 v_sub_f32 v21, v21, v30
 v_sub_f32 v22, v22, v30
 v_sub_f32 v23, v23, v30
 v_exp_f32 v28, v28
 v_exp_f32 v20, v20
 v_exp_f32 v21, v21
 v_exp_f32 v22, v22
 v_exp_f32 v23, v23
 v_cndmask_b32 v29, 0, v28, s[48:49]
 v_cndmask_b32 v28, v28, 0, s[48:49]
 v_cvt_pk_bf16_f32 v6, v28, v29
 v_cvt_pk_bf16_f32 v30, v20, v21
 v_cvt_pk_bf16_f32 v31, v22, v23
 v_mfma_f32_16x16x16_bf16 v[60:63], v[6:7], v[32:33], 0
 v_mfma_f32_16x16x16_bf16 v[52:55], v[6:7], v[2:3], 0
 v_mfma_f32_16x16x16_bf16 v[56:59], v[6:7], v[4:5], 0
 v_smfmac_f32_16x16x32_bf16 v[60:63], v[30:31], v[32:35], v5
 v_smfmac_f32_16x16x32_bf16 v[52:55], v[30:31], v[12:15], v5
 v_smfmac_f32_16x16x32_bf16 v[56:59], v[30:31], v[16:19], v5
 s_nop 0
 v_add_f32 v60, v60, v62
 v_add_f32 v61, v61, v63
 v_rcp_f32 v60, v60
 v_rcp_f32 v61, v61
 v_add_f32 v52, v52, v54
 v_add_f32 v53, v53, v55
 v_mul_f32 v52, v52, v60
 v_mul_f32 v53, v53, v61
 v_add_f32 v56, v56, v58
 v_add_f32 v57, v57, v59
 v_mul_f32 v56, v56, v60
 v_mul_f32 v57, v57, v61
 v_cvt_pk_bf16_f32 v52, v52, v56
 v_cvt_pk_bf16_f32 v53, v53, v57
 ds_write2_b32 v8, v52, v53 offset0:128 offset1:144
 v_mov_b64 v[20:21], 0
 v_mov_b64 v[22:23], 0
 v_mov_b64 v[24:25], 0
 v_mov_b64 v[26:27], 0
 v_mov_b64 v[28:29], 0
 v_mov_b64 v[30:31], 0
 v_mov_b64 v[32:33], 0
 v_mov_b64 v[34:35], 0
 s_waitcnt lgkmcnt(0)
 s_branch Lmxb_126
Lr2_131:
 s_waitcnt vmcnt(1)
 v_mfma_f32_16x16x32_bf16 v[48:51], v[44:47], v[12:15], 0
 s_waitcnt vmcnt(0)
 v_mfma_f32_16x16x32_bf16 v[48:51], v[44:47], v[16:19], v[48:51]
 v_bitop3_b32 v55, v13, v15, s46 bitop3:0x7e
 v_bitop3_b32 v56, v17, v19, s46 bitop3:0x7e
 v_bitop3_b32 v55, v55, 1, v56 bitop3:0xc8
 v_cmp_ne_u32 vcc, 0, v55
 s_nop 3
 v_add_f32_dpp v48, v48, v48 row_ror:4 row_mask:0xf bank_mask:0xf
 v_add_f32_dpp v49, v49, v49 row_ror:4 row_mask:0xf bank_mask:0xf
 s_cbranch_vccnz Lr1_130
 v_add_f32_dpp v48, v48, v48 row_ror:8 row_mask:0xf bank_mask:0xf
 v_add_f32_dpp v49, v49, v49 row_ror:8 row_mask:0xf bank_mask:0xf
 v_cvt_pk_bf16_f32 v48, v48, v49
 buffer_store_dword v48, v52, s[20:23], s44 offen sc1
 s_branch Lb1_132
Lr1_130:
 s_mov_b64 exec, vcc
Lrt_157:
 buffer_load_dwordx4 v[12:15], v3, s[20:23], s39 offen offset:0 sc1
 buffer_load_dwordx4 v[16:19], v3, s[20:23], s39 offen offset:1024 sc1
 s_waitcnt vmcnt(2)
 v_bitop3_b32 v55, v13, v15, s46 bitop3:0x7e
 v_bitop3_b32 v56, v17, v19, s46 bitop3:0x7e
 v_bitop3_b32 v55, v55, 1, v56 bitop3:0xc8
 v_cmpx_ne_u32 vcc, 0, v55
 s_cbranch_execz Lrte_158
 buffer_load_dwordx4 v[12:15], v3, s[20:23], s39 offen offset:0 sc1
 buffer_load_dwordx4 v[16:19], v3, s[20:23], s39 offen offset:1024 sc1
 s_waitcnt vmcnt(2)
 v_bitop3_b32 v55, v13, v15, s46 bitop3:0x7e
 v_bitop3_b32 v56, v17, v19, s46 bitop3:0x7e
 v_bitop3_b32 v55, v55, 1, v56 bitop3:0xc8
 v_cmpx_ne_u32 vcc, 0, v55
 s_cbranch_execz Lrte_158
 buffer_load_dwordx4 v[12:15], v3, s[20:23], s39 offen offset:0 sc1
 buffer_load_dwordx4 v[16:19], v3, s[20:23], s39 offen offset:1024 sc1
 s_waitcnt vmcnt(2)
 v_bitop3_b32 v55, v13, v15, s46 bitop3:0x7e
 v_bitop3_b32 v56, v17, v19, s46 bitop3:0x7e
 v_bitop3_b32 v55, v55, 1, v56 bitop3:0xc8
 v_cmpx_ne_u32 vcc, 0, v55
 s_cbranch_execz Lrte_158
 s_sub_u32 s54, s54, 1
 s_cbranch_scc0 Lrt_157
 s_endpgm
Lrte_158:
 s_mov_b64 exec, -1
 s_nop 2
 v_mfma_f32_16x16x32_bf16 v[48:51], v[44:47], v[12:15], 0
 v_mfma_f32_16x16x32_bf16 v[48:51], v[44:47], v[16:19], v[48:51]
 s_nop 7
 v_add_f32_dpp v48, v48, v48 row_ror:4 row_mask:0xf bank_mask:0xf
 v_add_f32_dpp v49, v49, v49 row_ror:4 row_mask:0xf bank_mask:0xf
 s_nop 0
 v_add_f32_dpp v48, v48, v48 row_ror:8 row_mask:0xf bank_mask:0xf
 v_add_f32_dpp v49, v49, v49 row_ror:8 row_mask:0xf bank_mask:0xf
 v_cvt_pk_bf16_f32 v48, v48, v49
 buffer_store_dword v48, v52, s[20:23], s44 offen sc1
 s_branch Lb1_132
Lr2_137:
 s_waitcnt vmcnt(1)
 v_mfma_f32_16x16x32_bf16 v[48:51], v[44:47], v[12:15], 0
 s_waitcnt vmcnt(0)
 v_mfma_f32_16x16x32_bf16 v[48:51], v[44:47], v[16:19], v[48:51]
 v_bitop3_b32 v55, v13, v15, s46 bitop3:0x7e
 v_bitop3_b32 v56, v17, v19, s46 bitop3:0x7e
 v_bitop3_b32 v55, v55, 1, v56 bitop3:0xc8
 v_cmp_ne_u32 vcc, 0, v55
 s_nop 3
 v_add_f32_dpp v48, v48, v48 row_ror:4 row_mask:0xf bank_mask:0xf
 v_add_f32_dpp v49, v49, v49 row_ror:4 row_mask:0xf bank_mask:0xf
 s_cbranch_vccnz Lr1_136
 v_add_f32_dpp v48, v48, v48 row_ror:8 row_mask:0xf bank_mask:0xf
 v_add_f32_dpp v49, v49, v49 row_ror:8 row_mask:0xf bank_mask:0xf
 v_cvt_pk_bf16_f32 v48, v48, v49
 buffer_store_dword v48, v52, s[20:23], s44 offen sc1
 s_branch Lb1_138
Lr1_136:
 s_mov_b64 exec, vcc
Lrt_159:
 buffer_load_dwordx4 v[12:15], v3, s[20:23], s39 offen offset:0 sc1
 buffer_load_dwordx4 v[16:19], v3, s[20:23], s39 offen offset:1024 sc1
 s_waitcnt vmcnt(2)
 v_bitop3_b32 v55, v13, v15, s46 bitop3:0x7e
 v_bitop3_b32 v56, v17, v19, s46 bitop3:0x7e
 v_bitop3_b32 v55, v55, 1, v56 bitop3:0xc8
 v_cmpx_ne_u32 vcc, 0, v55
 s_cbranch_execz Lrte_160
 buffer_load_dwordx4 v[12:15], v3, s[20:23], s39 offen offset:0 sc1
 buffer_load_dwordx4 v[16:19], v3, s[20:23], s39 offen offset:1024 sc1
 s_waitcnt vmcnt(2)
 v_bitop3_b32 v55, v13, v15, s46 bitop3:0x7e
 v_bitop3_b32 v56, v17, v19, s46 bitop3:0x7e
 v_bitop3_b32 v55, v55, 1, v56 bitop3:0xc8
 v_cmpx_ne_u32 vcc, 0, v55
 s_cbranch_execz Lrte_160
 buffer_load_dwordx4 v[12:15], v3, s[20:23], s39 offen offset:0 sc1
 buffer_load_dwordx4 v[16:19], v3, s[20:23], s39 offen offset:1024 sc1
 s_waitcnt vmcnt(2)
 v_bitop3_b32 v55, v13, v15, s46 bitop3:0x7e
 v_bitop3_b32 v56, v17, v19, s46 bitop3:0x7e
 v_bitop3_b32 v55, v55, 1, v56 bitop3:0xc8
 v_cmpx_ne_u32 vcc, 0, v55
 s_cbranch_execz Lrte_160
 s_sub_u32 s54, s54, 1
 s_cbranch_scc0 Lrt_159
 s_endpgm
Lrte_160:
 s_mov_b64 exec, -1
 s_nop 2
 v_mfma_f32_16x16x32_bf16 v[48:51], v[44:47], v[12:15], 0
 v_mfma_f32_16x16x32_bf16 v[48:51], v[44:47], v[16:19], v[48:51]
 s_nop 7
 v_add_f32_dpp v48, v48, v48 row_ror:4 row_mask:0xf bank_mask:0xf
 v_add_f32_dpp v49, v49, v49 row_ror:4 row_mask:0xf bank_mask:0xf
 s_nop 0
 v_add_f32_dpp v48, v48, v48 row_ror:8 row_mask:0xf bank_mask:0xf
 v_add_f32_dpp v49, v49, v49 row_ror:8 row_mask:0xf bank_mask:0xf
 v_cvt_pk_bf16_f32 v48, v48, v49
 buffer_store_dword v48, v52, s[20:23], s44 offen sc1
 s_branch Lb1_138
Lr2_143:
 s_waitcnt vmcnt(1)
 v_mfma_f32_16x16x32_bf16 v[48:51], v[44:47], v[12:15], 0
 s_waitcnt vmcnt(0)
 v_mfma_f32_16x16x32_bf16 v[48:51], v[44:47], v[16:19], v[48:51]
 v_bitop3_b32 v55, v13, v15, s46 bitop3:0x7e
 v_bitop3_b32 v56, v17, v19, s46 bitop3:0x7e
 v_bitop3_b32 v55, v55, 1, v56 bitop3:0xc8
 v_cmp_ne_u32 vcc, 0, v55
 s_nop 3
 v_add_f32_dpp v48, v48, v48 row_ror:4 row_mask:0xf bank_mask:0xf
 v_add_f32_dpp v49, v49, v49 row_ror:4 row_mask:0xf bank_mask:0xf
 s_cbranch_vccnz Lr1_142
 v_add_f32_dpp v48, v48, v48 row_ror:8 row_mask:0xf bank_mask:0xf
 v_add_f32_dpp v49, v49, v49 row_ror:8 row_mask:0xf bank_mask:0xf
 v_cvt_pk_bf16_f32 v48, v48, v49
 buffer_store_dword v48, v52, s[20:23], s44 offen sc1
 s_branch Lb1_144
Lr1_142:
 s_mov_b64 exec, vcc
Lrt_161:
 buffer_load_dwordx4 v[12:15], v3, s[20:23], s39 offen offset:0 sc1
 buffer_load_dwordx4 v[16:19], v3, s[20:23], s39 offen offset:1024 sc1
 s_waitcnt vmcnt(2)
 v_bitop3_b32 v55, v13, v15, s46 bitop3:0x7e
 v_bitop3_b32 v56, v17, v19, s46 bitop3:0x7e
 v_bitop3_b32 v55, v55, 1, v56 bitop3:0xc8
 v_cmpx_ne_u32 vcc, 0, v55
 s_cbranch_execz Lrte_162
 buffer_load_dwordx4 v[12:15], v3, s[20:23], s39 offen offset:0 sc1
 buffer_load_dwordx4 v[16:19], v3, s[20:23], s39 offen offset:1024 sc1
 s_waitcnt vmcnt(2)
 v_bitop3_b32 v55, v13, v15, s46 bitop3:0x7e
 v_bitop3_b32 v56, v17, v19, s46 bitop3:0x7e
 v_bitop3_b32 v55, v55, 1, v56 bitop3:0xc8
 v_cmpx_ne_u32 vcc, 0, v55
 s_cbranch_execz Lrte_162
 buffer_load_dwordx4 v[12:15], v3, s[20:23], s39 offen offset:0 sc1
 buffer_load_dwordx4 v[16:19], v3, s[20:23], s39 offen offset:1024 sc1
 s_waitcnt vmcnt(2)
 v_bitop3_b32 v55, v13, v15, s46 bitop3:0x7e
 v_bitop3_b32 v56, v17, v19, s46 bitop3:0x7e
 v_bitop3_b32 v55, v55, 1, v56 bitop3:0xc8
 v_cmpx_ne_u32 vcc, 0, v55
 s_cbranch_execz Lrte_162
 s_sub_u32 s54, s54, 1
 s_cbranch_scc0 Lrt_161
 s_endpgm
Lrte_162:
 s_mov_b64 exec, -1
 s_nop 2
 v_mfma_f32_16x16x32_bf16 v[48:51], v[44:47], v[12:15], 0
 v_mfma_f32_16x16x32_bf16 v[48:51], v[44:47], v[16:19], v[48:51]
 s_nop 7
 v_add_f32_dpp v48, v48, v48 row_ror:4 row_mask:0xf bank_mask:0xf
 v_add_f32_dpp v49, v49, v49 row_ror:4 row_mask:0xf bank_mask:0xf
 s_nop 0
 v_add_f32_dpp v48, v48, v48 row_ror:8 row_mask:0xf bank_mask:0xf
 v_add_f32_dpp v49, v49, v49 row_ror:8 row_mask:0xf bank_mask:0xf
 v_cvt_pk_bf16_f32 v48, v48, v49
 buffer_store_dword v48, v52, s[20:23], s44 offen sc1
 s_branch Lb1_144
Lfw_134:
Lpb_163:
 buffer_load_dword v1, v7, s[20:23], s56 offen sc1
 s_waitcnt vmcnt(0)
 v_cmp_le_u32 vcc, s58, v1
 s_cbranch_vccnz Lpbok_164
 s_sub_u32 s54, s54, 1
 s_cbranch_scc0 Lpb_163
 s_endpgm
Lpbok_164:
 s_branch Lfok_133
Lfw_140:
Lpb_165:
 buffer_load_dword v1, v7, s[20:23], s56 offen sc1
 s_waitcnt vmcnt(0)
 v_cmp_le_u32 vcc, s58, v1
 s_cbranch_vccnz Lpbok_166
 s_sub_u32 s54, s54, 1
 s_cbranch_scc0 Lpb_165
 s_endpgm
Lpbok_166:
 s_branch Lfok_139
Lfw_146:
Lpb_167:
 buffer_load_dword v1, v7, s[20:23], s56 offen sc1
 s_waitcnt vmcnt(0)
 v_cmp_le_u32 vcc, s58, v1
 s_cbranch_vccnz Lpbok_168
 s_sub_u32 s54, s54, 1
 s_cbranch_scc0 Lpb_167
 s_endpgm
Lpbok_168:
 s_branch Lfok_145
Lfw_151:
Lpb_169:
 buffer_load_dword v1, v7, s[20:23], s56 offen sc1
 s_waitcnt vmcnt(0)
 v_cmp_le_u32 vcc, s58, v1
 s_cbranch_vccnz Lpbok_170
 s_sub_u32 s54, s54, 1
 s_cbranch_scc0 Lpb_169
 s_endpgm
Lpbok_170:
 s_branch Lfok_150
Lfail_120:
 s_endpgm
Lchexit_66:
 s_add_u32 s38, s38, 0x10000
 v_add_u32 v6, s69, v9
 ds_read_b64 v[64:65], v6 offset:19456
 v_mov_b32 v66, v2
 v_mov_b32 v67, v4
 s_waitcnt lgkmcnt(0)
 buffer_store_dwordx4 v[64:67], v0, s[20:23], s38 offen sc1
 s_waitcnt vmcnt(0) lgkmcnt(0)
 s_barrier
 v_subrev_u32 v0, 0x10000, v0
 v_min_u32 v0, 16, v0
 v_lshlrev_b32 v0, 24, v0
 v_mov_b32 v6, 64
 buffer_store_dword v6, v0, s[20:23], s57 offen sc1
Lfin:
Lend:
 s_endpgm
Lredo:
 s_mov_b32 s88, s89
 s_waitcnt vmcnt(0) lgkmcnt(0)
 s_barrier
 s_branch Lrole
.section .rodata,"a"
.p2align 6
.amdhsa_kernel concat_heads__compressed_kv_cla__memory_aug_recurrent_mem_tr__prompt_kernel
  .amdhsa_next_free_vgpr 512
  .amdhsa_next_free_sgpr 102
  .amdhsa_accum_offset 256
  .amdhsa_group_segment_fixed_size 0
  .amdhsa_kernarg_size 128
  .amdhsa_user_sgpr_count 2
  .amdhsa_user_sgpr_kernarg_segment_ptr 1
  .amdhsa_system_sgpr_workgroup_id_x 1
  .amdhsa_float_denorm_mode_32 3
.end_amdhsa_kernel
```

```asm
; @launch grid=(256,1,1) block=(256,1,1) lds=163840
.amdgcn_target "amdgcn-amd-amdhsa--gfx950"
.text
.globl concat_heads__compressed_kv_cla__memory_aug_recurrent_mem_tr__prompt_kernel
.p2align 8
.type concat_heads__compressed_kv_cla__memory_aug_recurrent_mem_tr__prompt_kernel,@function
concat_heads__compressed_kv_cla__memory_aug_recurrent_mem_tr__prompt_kernel:
 s_cmp_ge_u32 s2, 256
 s_cbranch_scc1 Lend
 s_load_dwordx2 s[20:21], s[0:1], 120
 s_mov_b32 s22, 0x10000000
 s_mov_b32 s23, 0x20000
 s_load_dwordx2 s[28:29], s[0:1], 112
 s_mov_b32 s30, 0x100
 s_mov_b32 s31, 0x20000
 v_lshrrev_b32 v1, 6, v0
 s_lshr_b32 s6, s2, 3
 v_readfirstlane_b32 s4, v1
 s_getreg_b32 s73, hwreg(HW_REG_XCC_ID, 0, 3)
 s_sub_u32 s88, s73, s2
 s_and_b32 s88, s88, 7
 s_add_u32 s88, s88, 1
 s_mov_b32 s95, 0x40000
 s_waitcnt lgkmcnt(0)
 s_cmp_eq_u32 s2, 0
 s_cbranch_scc0 Lrole
 v_min_u32 v1, 1, v0
 v_lshlrev_b32 v1, 28, v1
 v_mov_b32 v2, s88
 buffer_store_dword v2, v1, s[28:31], 0 offen offset:4 sc1
Lrole:
 s_add_u32 s5, s2, s88
 s_sub_u32 s5, s5, 1
 s_and_b32 s5, s5, 7
 s_lshl_b32 s5, s5, 2
 s_lshr_b32 s5, 0x76532041, s5
 s_and_b32 s5, s5, 7
 s_getpc_b64 s[8:9]
Lpc:
 s_lshl_b32 s7, s6, 13
 s_cmp_le_u32 s7, Lend - Lpc
 s_cselect_b32 s3, s4, 1
 s_cmp_eq_u32 s3, 0
 s_cbranch_scc0 Lcpf
 v_lshl_add_u32 v1, v0, 7, s7
 v_min_u32 v1, Lend - Lpc, v1
 global_load_dword v255, v1, s[8:9]
Lcpf:
 s_cmp_eq_u32 s5, 0
 s_cbranch_scc1 Lchain
 s_cmp_eq_u32 s5, 1
 s_cbranch_scc1 Lpb
 s_cmp_lt_u32 s5, 4
 s_cbranch_scc1 Lqa
 s_load_dwordx2 s[8:9], s[0:1], 8
 s_mov_b32 s10, 0x200000
 s_mov_b32 s11, 0x20000
 s_load_dwordx2 s[12:13], s[0:1], 24
 s_mov_b32 s14, 0x400000
 s_mov_b32 s15, 0x20000
 s_load_dwordx2 s[16:17], s[0:1], 32
 s_mov_b32 s18, 0x400000
 s_mov_b32 s19, 0x20000
 s_sub_u32 s3, s5, 4
 s_lshl_b32 s3, s3, 3
 s_lshr_b32 s7, s6, 2
 s_add_u32 s3, s3, s7
 s_lshl_b32 s32, s3, 8
 s_mov_b32 s33, s32
 s_lshl_b32 s34, s3, 14
 s_add_u32 s34, s34, 0x1000000
 s_add_u32 s35, s34, 8192
 s_mov_b32 s36, 16
 s_and_b32 s37, s6, 3
 s_lshl_b32 s7, s3, 5
 s_add_u32 s7, s7, s37
 s_lshl_b32 s7, s7, 2
 s_add_u32 s7, s7, 0x2000
 v_min_u32 v1, 1, v0
 v_lshlrev_b32 v1, 28, v1
 v_add_u32 v13, s7, v1
 s_waitcnt lgkmcnt(0)
 v_and_b32 v1, 63, v0
 v_lshrrev_b32 v2, 3, v0
 v_mul_u32_u24 v10, 1024, v2
 v_lshrrev_b32 v2, 4, v0
 v_xor_b32 v2, v2, v0
 v_and_b32 v2, 7, v2
 v_lshl_add_u32 v10, v2, 4, v10
 v_lshrrev_b32 v2, 4, v1
 v_bfe_u32 v3, v1, 1, 3
 v_xor_b32 v2, v2, v3
 v_and_b32 v3, 15, v1
 v_lshlrev_b32 v3, 7, v3
 v_lshl_add_u32 v4, v2, 4, v3
 v_xor_b32 v5, 64, v4
 v_lshrrev_b32 v2, 4, v0
 v_lshlrev_b32 v11, 13, v2
 v_lshrrev_b32 v2, 7, v0
 v_lshrrev_b32 v3, 4, v1
 v_lshl_add_u32 v3, v2, 2, v3
 v_bfe_u32 v2, v1, 1, 3
 v_xor_b32 v2, v2, v3
 v_lshl_add_u32 v11, v2, 5, v11
 v_and_b32 v2, 1, v1
 v_lshl_add_u32 v11, v2, 4, v11
 v_bfe_u32 v2, v1, 2, 3
 v_xor_b32 v3, s4, v2
 v_lshlrev_b32 v3, 5, v3
 v_and_b32 v2, 3, v2
 v_lshl_add_u32 v3, v2, 8, v3
 v_lshrrev_b32 v2, 4, v1
 v_lshl_add_u32 v3, v2, 11, v3
 v_and_b32 v2, 3, v1
 v_lshl_add_u32 v3, v2, 3, v3
 v_add_u32 v8, 65536, v3
 v_xor_b32 v3, 0x80, v3
 v_add_u32 v9, 65536, v3
 s_lshl_b32 s45, s4, 11
 v_lshl_add_u32 v12, v1, 4, s45
 s_mov_b32 s39, s37
 s_add_u32 s40, s39, 4
 s_lshl_b32 s49, s4, 10
 s_mul_i32 s46, s39, 32768
 s_add_u32 m0, s49, 0
 s_nop 0
 buffer_load_dwordx4 v10, s[8:11], s46 offen offset:0  lds
 s_add_u32 m0, s49, 3968
 s_nop 0
 buffer_load_dwordx4 v10, s[8:11], s46 offen offset:128  lds
 s_add_u32 m0, s49, 7936
 s_nop 0
 buffer_load_dwordx4 v10, s[8:11], s46 offen offset:256  lds
 s_add_u32 m0, s49, 11904
 s_nop 0
 buffer_load_dwordx4 v10, s[8:11], s46 offen offset:384  lds
 s_add_u32 m0, s49, 15872
 s_nop 0
 buffer_load_dwordx4 v10, s[8:11], s46 offen offset:512  lds
 s_add_u32 m0, s49, 19840
 s_nop 0
 buffer_load_dwordx4 v10, s[8:11], s46 offen offset:640  lds
 s_add_u32 m0, s49, 23808
 s_nop 0
 buffer_load_dwordx4 v10, s[8:11], s46 offen offset:768  lds
 s_add_u32 m0, s49, 27776
 s_nop 0
 buffer_load_dwordx4 v10, s[8:11], s46 offen offset:896  lds
 s_lshl_b32 s49, s4, 10
 s_add_u32 s49, s49, 32768
 s_mul_i32 s46, s40, 32768
 s_add_u32 m0, s49, 0
 s_nop 0
 buffer_load_dwordx4 v10, s[8:11], s46 offen offset:0  lds
 s_add_u32 m0, s49, 3968
 s_nop 0
 buffer_load_dwordx4 v10, s[8:11], s46 offen offset:128  lds
 s_add_u32 m0, s49, 7936
 s_nop 0
 buffer_load_dwordx4 v10, s[8:11], s46 offen offset:256  lds
 s_add_u32 m0, s49, 11904
 s_nop 0
 buffer_load_dwordx4 v10, s[8:11], s46 offen offset:384  lds
 s_add_u32 m0, s49, 15872
 s_nop 0
 buffer_load_dwordx4 v10, s[8:11], s46 offen offset:512  lds
 s_add_u32 m0, s49, 19840
 s_nop 0
 buffer_load_dwordx4 v10, s[8:11], s46 offen offset:640  lds
 s_add_u32 m0, s49, 23808
 s_nop 0
 buffer_load_dwordx4 v10, s[8:11], s46 offen offset:768  lds
 s_add_u32 m0, s49, 27776
 s_nop 0
 buffer_load_dwordx4 v10, s[8:11], s46 offen offset:896  lds
 s_lshl_b32 s49, s4, 10
 s_add_u32 m0, s49, 65536
 s_add_u32 s45, s32, 0
 buffer_load_dwordx4 v11, s[12:15], s45 offen  lds
 s_add_u32 m0, s49, 69632
 s_add_u32 s45, s32, 131072
 buffer_load_dwordx4 v11, s[12:15], s45 offen  lds
 s_add_u32 m0, s49, 73728
 s_add_u32 s45, s33, 0
 buffer_load_dwordx4 v11, s[16:19], s45 offen  lds
 s_add_u32 m0, s49, 77824
 s_add_u32 s45, s33, 131072
 buffer_load_dwordx4 v11, s[16:19], s45 offen  lds
 s_add_u32 m0, s49, 81920
 s_add_u32 s45, s32, 262144
 buffer_load_dwordx4 v11, s[12:15], s45 offen  lds
 s_add_u32 m0, s49, 86016
 s_add_u32 s45, s32, 393216
 buffer_load_dwordx4 v11, s[12:15], s45 offen  lds
 s_add_u32 m0, s49, 90112
 s_add_u32 s45, s33, 262144
 buffer_load_dwordx4 v11, s[16:19], s45 offen  lds
 s_add_u32 m0, s49, 94208
 s_add_u32 s45, s33, 393216
 buffer_load_dwordx4 v11, s[16:19], s45 offen  lds
 s_add_u32 m0, s49, 98304
 s_add_u32 s45, s32, 524288
 buffer_load_dwordx4 v11, s[12:15], s45 offen  lds
 s_add_u32 m0, s49, 102400
 s_add_u32 s45, s32, 655360
 buffer_load_dwordx4 v11, s[12:15], s45 offen  lds
 s_add_u32 m0, s49, 106496
 s_add_u32 s45, s33, 524288
 buffer_load_dwordx4 v11, s[16:19], s45 offen  lds
 s_add_u32 m0, s49, 110592
 s_add_u32 s45, s33, 655360
 buffer_load_dwordx4 v11, s[16:19], s45 offen  lds
 s_waitcnt vmcnt(8) lgkmcnt(0)
 s_barrier
 s_add_u32 m0, s49, 114688
 s_add_u32 s45, s32, 786432
 buffer_load_dwordx4 v11, s[12:15], s45 offen  lds
 s_add_u32 m0, s49, 118784
 s_add_u32 s45, s32, 917504
 buffer_load_dwordx4 v11, s[12:15], s45 offen  lds
 s_add_u32 m0, s49, 122880
 s_add_u32 s45, s33, 786432
 buffer_load_dwordx4 v11, s[16:19], s45 offen  lds
 s_add_u32 m0, s49, 126976
 s_add_u32 s45, s33, 917504
 buffer_load_dwordx4 v11, s[16:19], s45 offen  lds
 ds_read_b64_tr_b16 a[0:1], v8 offset:0
 ds_read_b64_tr_b16 a[2:3], v8 offset:1024
 ds_read_b64_tr_b16 a[64:65], v9 offset:0
 ds_read_b64_tr_b16 a[66:67], v9 offset:1024
 ds_read_b64_tr_b16 a[128:129], v8 offset:8192
 ds_read_b64_tr_b16 a[130:131], v8 offset:9216
 ds_read_b64_tr_b16 a[192:193], v9 offset:8192
 ds_read_b64_tr_b16 a[194:195], v9 offset:9216
 s_waitcnt vmcnt(8) lgkmcnt(0)
 s_barrier
 s_add_u32 m0, s49, 65536
 s_add_u32 s45, s32, 1048576
 buffer_load_dwordx4 v11, s[12:15], s45 offen  lds
 s_add_u32 m0, s49, 69632
 s_add_u32 s45, s32, 1179648
 buffer_load_dwordx4 v11, s[12:15], s45 offen  lds
 s_add_u32 m0, s49, 73728
 s_add_u32 s45, s33, 1048576
 buffer_load_dwordx4 v11, s[16:19], s45 offen  lds
 s_add_u32 m0, s49, 77824
 s_add_u32 s45, s33, 1179648
 buffer_load_dwordx4 v11, s[16:19], s45 offen  lds
 ds_read_b64_tr_b16 a[4:5], v8 offset:16384
 ds_read_b64_tr_b16 a[6:7], v8 offset:17408
 ds_read_b64_tr_b16 a[68:69], v9 offset:16384
 ds_read_b64_tr_b16 a[70:71], v9 offset:17408
 ds_read_b64_tr_b16 a[132:133], v8 offset:24576
 ds_read_b64_tr_b16 a[134:135], v8 offset:25600
 ds_read_b64_tr_b16 a[196:197], v9 offset:24576
 ds_read_b64_tr_b16 a[198:199], v9 offset:25600
 s_waitcnt vmcnt(8) lgkmcnt(0)
 s_barrier
 s_add_u32 m0, s49, 81920
 s_add_u32 s45, s32, 1310720
 buffer_load_dwordx4 v11, s[12:15], s45 offen  lds
 s_add_u32 m0, s49, 86016
 s_add_u32 s45, s32, 1441792
 buffer_load_dwordx4 v11, s[12:15], s45 offen  lds
 s_add_u32 m0, s49, 90112
 s_add_u32 s45, s33, 1310720
 buffer_load_dwordx4 v11, s[16:19], s45 offen  lds
 s_add_u32 m0, s49, 94208
 s_add_u32 s45, s33, 1441792
 buffer_load_dwordx4 v11, s[16:19], s45 offen  lds
 ds_read_b64_tr_b16 a[8:9], v8 offset:32768
 ds_read_b64_tr_b16 a[10:11], v8 offset:33792
 ds_read_b64_tr_b16 a[72:73], v9 offset:32768
 ds_read_b64_tr_b16 a[74:75], v9 offset:33792
 ds_read_b64_tr_b16 a[136:137], v8 offset:40960
 ds_read_b64_tr_b16 a[138:139], v8 offset:41984
 ds_read_b64_tr_b16 a[200:201], v9 offset:40960
 ds_read_b64_tr_b16 a[202:203], v9 offset:41984
 s_waitcnt vmcnt(8) lgkmcnt(0)
 s_barrier
 s_add_u32 m0, s49, 98304
 s_add_u32 s45, s32, 1572864
 buffer_load_dwordx4 v11, s[12:15], s45 offen  lds
 s_add_u32 m0, s49, 102400
 s_add_u32 s45, s32, 1703936
 buffer_load_dwordx4 v11, s[12:15], s45 offen  lds
 s_add_u32 m0, s49, 106496
 s_add_u32 s45, s33, 1572864
 buffer_load_dwordx4 v11, s[16:19], s45 offen  lds
 s_add_u32 m0, s49, 110592
 s_add_u32 s45, s33, 1703936
 buffer_load_dwordx4 v11, s[16:19], s45 offen  lds
 ds_read_b64_tr_b16 a[12:13], v8 offset:49152
 ds_read_b64_tr_b16 a[14:15], v8 offset:50176
 ds_read_b64_tr_b16 a[76:77], v9 offset:49152
 ds_read_b64_tr_b16 a[78:79], v9 offset:50176
 ds_read_b64_tr_b16 a[140:141], v8 offset:57344
 ds_read_b64_tr_b16 a[142:143], v8 offset:58368
 ds_read_b64_tr_b16 a[204:205], v9 offset:57344
 ds_read_b64_tr_b16 a[206:207], v9 offset:58368
 s_waitcnt vmcnt(8) lgkmcnt(0)
 s_barrier
 s_add_u32 m0, s49, 114688
 s_add_u32 s45, s32, 1835008
 buffer_load_dwordx4 v11, s[12:15], s45 offen  lds
 s_add_u32 m0, s49, 118784
 s_add_u32 s45, s32, 1966080
 buffer_load_dwordx4 v11, s[12:15], s45 offen  lds
 s_add_u32 m0, s49, 122880
 s_add_u32 s45, s33, 1835008
 buffer_load_dwordx4 v11, s[16:19], s45 offen  lds
 s_add_u32 m0, s49, 126976
 s_add_u32 s45, s33, 1966080
 buffer_load_dwordx4 v11, s[16:19], s45 offen  lds
 ds_read_b64_tr_b16 a[16:17], v8 offset:0
 ds_read_b64_tr_b16 a[18:19], v8 offset:1024
 ds_read_b64_tr_b16 a[80:81], v9 offset:0
 ds_read_b64_tr_b16 a[82:83], v9 offset:1024
 ds_read_b64_tr_b16 a[144:145], v8 offset:8192
 ds_read_b64_tr_b16 a[146:147], v8 offset:9216
 ds_read_b64_tr_b16 a[208:209], v9 offset:8192
 ds_read_b64_tr_b16 a[210:211], v9 offset:9216
 s_waitcnt vmcnt(8) lgkmcnt(0)
 s_barrier
 s_add_u32 m0, s49, 65536
 s_add_u32 s45, s32, 2097152
 buffer_load_dwordx4 v11, s[12:15], s45 offen  lds
 s_add_u32 m0, s49, 69632
 s_add_u32 s45, s32, 2228224
 buffer_load_dwordx4 v11, s[12:15], s45 offen  lds
 s_add_u32 m0, s49, 73728
 s_add_u32 s45, s33, 2097152
 buffer_load_dwordx4 v11, s[16:19], s45 offen  lds
 s_add_u32 m0, s49, 77824
 s_add_u32 s45, s33, 2228224
 buffer_load_dwordx4 v11, s[16:19], s45 offen  lds
 ds_read_b64_tr_b16 a[20:21], v8 offset:16384
 ds_read_b64_tr_b16 a[22:23], v8 offset:17408
 ds_read_b64_tr_b16 a[84:85], v9 offset:16384
 ds_read_b64_tr_b16 a[86:87], v9 offset:17408
 ds_read_b64_tr_b16 a[148:149], v8 offset:24576
 ds_read_b64_tr_b16 a[150:151], v8 offset:25600
 ds_read_b64_tr_b16 a[212:213], v9 offset:24576
 ds_read_b64_tr_b16 a[214:215], v9 offset:25600
 s_waitcnt vmcnt(8) lgkmcnt(0)
 s_barrier
 s_add_u32 m0, s49, 81920
 s_add_u32 s45, s32, 2359296
 buffer_load_dwordx4 v11, s[12:15], s45 offen  lds
 s_add_u32 m0, s49, 86016
 s_add_u32 s45, s32, 2490368
 buffer_load_dwordx4 v11, s[12:15], s45 offen  lds
 s_add_u32 m0, s49, 90112
 s_add_u32 s45, s33, 2359296
 buffer_load_dwordx4 v11, s[16:19], s45 offen  lds
 s_add_u32 m0, s49, 94208
 s_add_u32 s45, s33, 2490368
 buffer_load_dwordx4 v11, s[16:19], s45 offen  lds
 ds_read_b64_tr_b16 a[24:25], v8 offset:32768
 ds_read_b64_tr_b16 a[26:27], v8 offset:33792
 ds_read_b64_tr_b16 a[88:89], v9 offset:32768
 ds_read_b64_tr_b16 a[90:91], v9 offset:33792
 ds_read_b64_tr_b16 a[152:153], v8 offset:40960
 ds_read_b64_tr_b16 a[154:155], v8 offset:41984
 ds_read_b64_tr_b16 a[216:217], v9 offset:40960
 ds_read_b64_tr_b16 a[218:219], v9 offset:41984
 s_waitcnt vmcnt(8) lgkmcnt(0)
 s_barrier
 s_add_u32 m0, s49, 98304
 s_add_u32 s45, s32, 2621440
 buffer_load_dwordx4 v11, s[12:15], s45 offen  lds
 s_add_u32 m0, s49, 102400
 s_add_u32 s45, s32, 2752512
 buffer_load_dwordx4 v11, s[12:15], s45 offen  lds
 s_add_u32 m0, s49, 106496
 s_add_u32 s45, s33, 2621440
 buffer_load_dwordx4 v11, s[16:19], s45 offen  lds
 s_add_u32 m0, s49, 110592
 s_add_u32 s45, s33, 2752512
 buffer_load_dwordx4 v11, s[16:19], s45 offen  lds
 ds_read_b64_tr_b16 a[28:29], v8 offset:49152
 ds_read_b64_tr_b16 a[30:31], v8 offset:50176
 ds_read_b64_tr_b16 a[92:93], v9 offset:49152
 ds_read_b64_tr_b16 a[94:95], v9 offset:50176
 ds_read_b64_tr_b16 a[156:157], v8 offset:57344
 ds_read_b64_tr_b16 a[158:159], v8 offset:58368
 ds_read_b64_tr_b16 a[220:221], v9 offset:57344
 ds_read_b64_tr_b16 a[222:223], v9 offset:58368
 s_waitcnt vmcnt(8) lgkmcnt(0)
 s_barrier
 s_add_u32 m0, s49, 114688
 s_add_u32 s45, s32, 2883584
 buffer_load_dwordx4 v11, s[12:15], s45 offen  lds
 s_add_u32 m0, s49, 118784
 s_add_u32 s45, s32, 3014656
 buffer_load_dwordx4 v11, s[12:15], s45 offen  lds
 s_add_u32 m0, s49, 122880
 s_add_u32 s45, s33, 2883584
 buffer_load_dwordx4 v11, s[16:19], s45 offen  lds
 s_add_u32 m0, s49, 126976
 s_add_u32 s45, s33, 3014656
 buffer_load_dwordx4 v11, s[16:19], s45 offen  lds
 ds_read_b64_tr_b16 a[32:33], v8 offset:0
 ds_read_b64_tr_b16 a[34:35], v8 offset:1024
 ds_read_b64_tr_b16 a[96:97], v9 offset:0
 ds_read_b64_tr_b16 a[98:99], v9 offset:1024
 ds_read_b64_tr_b16 a[160:161], v8 offset:8192
 ds_read_b64_tr_b16 a[162:163], v8 offset:9216
 ds_read_b64_tr_b16 a[224:225], v9 offset:8192
 ds_read_b64_tr_b16 a[226:227], v9 offset:9216
 s_waitcnt vmcnt(8) lgkmcnt(0)
 s_barrier
 s_add_u32 m0, s49, 65536
 s_add_u32 s45, s32, 3145728
 buffer_load_dwordx4 v11, s[12:15], s45 offen  lds
 s_add_u32 m0, s49, 69632
 s_add_u32 s45, s32, 3276800
 buffer_load_dwordx4 v11, s[12:15], s45 offen  lds
 s_add_u32 m0, s49, 73728
 s_add_u32 s45, s33, 3145728
 buffer_load_dwordx4 v11, s[16:19], s45 offen  lds
 s_add_u32 m0, s49, 77824
 s_add_u32 s45, s33, 3276800
 buffer_load_dwordx4 v11, s[16:19], s45 offen  lds
 ds_read_b64_tr_b16 a[36:37], v8 offset:16384
 ds_read_b64_tr_b16 a[38:39], v8 offset:17408
 ds_read_b64_tr_b16 a[100:101], v9 offset:16384
 ds_read_b64_tr_b16 a[102:103], v9 offset:17408
 ds_read_b64_tr_b16 a[164:165], v8 offset:24576
 ds_read_b64_tr_b16 a[166:167], v8 offset:25600
 ds_read_b64_tr_b16 a[228:229], v9 offset:24576
 ds_read_b64_tr_b16 a[230:231], v9 offset:25600
 s_waitcnt vmcnt(8) lgkmcnt(0)
 s_barrier
 s_add_u32 m0, s49, 81920
 s_add_u32 s45, s32, 3407872
 buffer_load_dwordx4 v11, s[12:15], s45 offen  lds
 s_add_u32 m0, s49, 86016
 s_add_u32 s45, s32, 3538944
 buffer_load_dwordx4 v11, s[12:15], s45 offen  lds
 s_add_u32 m0, s49, 90112
 s_add_u32 s45, s33, 3407872
 buffer_load_dwordx4 v11, s[16:19], s45 offen  lds
 s_add_u32 m0, s49, 94208
 s_add_u32 s45, s33, 3538944
 buffer_load_dwordx4 v11, s[16:19], s45 offen  lds
 ds_read_b64_tr_b16 a[40:41], v8 offset:32768
 ds_read_b64_tr_b16 a[42:43], v8 offset:33792
 ds_read_b64_tr_b16 a[104:105], v9 offset:32768
 ds_read_b64_tr_b16 a[106:107], v9 offset:33792
 ds_read_b64_tr_b16 a[168:169], v8 offset:40960
 ds_read_b64_tr_b16 a[170:171], v8 offset:41984
 ds_read_b64_tr_b16 a[232:233], v9 offset:40960
 ds_read_b64_tr_b16 a[234:235], v9 offset:41984
 s_waitcnt vmcnt(8) lgkmcnt(0)
 s_barrier
 s_add_u32 m0, s49, 98304
 s_add_u32 s45, s32, 3670016
 buffer_load_dwordx4 v11, s[12:15], s45 offen  lds
 s_add_u32 m0, s49, 102400
 s_add_u32 s45, s32, 3801088
 buffer_load_dwordx4 v11, s[12:15], s45 offen  lds
 s_add_u32 m0, s49, 106496
 s_add_u32 s45, s33, 3670016
 buffer_load_dwordx4 v11, s[16:19], s45 offen  lds
 s_add_u32 m0, s49, 110592
 s_add_u32 s45, s33, 3801088
 buffer_load_dwordx4 v11, s[16:19], s45 offen  lds
 ds_read_b64_tr_b16 a[44:45], v8 offset:49152
 ds_read_b64_tr_b16 a[46:47], v8 offset:50176
 ds_read_b64_tr_b16 a[108:109], v9 offset:49152
 ds_read_b64_tr_b16 a[110:111], v9 offset:50176
 ds_read_b64_tr_b16 a[172:173], v8 offset:57344
 ds_read_b64_tr_b16 a[174:175], v8 offset:58368
 ds_read_b64_tr_b16 a[236:237], v9 offset:57344
 ds_read_b64_tr_b16 a[238:239], v9 offset:58368
 s_waitcnt vmcnt(8) lgkmcnt(0)
 s_barrier
 s_add_u32 m0, s49, 114688
 s_add_u32 s45, s32, 3932160
 buffer_load_dwordx4 v11, s[12:15], s45 offen  lds
 s_add_u32 m0, s49, 118784
 s_add_u32 s45, s32, 4063232
 buffer_load_dwordx4 v11, s[12:15], s45 offen  lds
 s_add_u32 m0, s49, 122880
 s_add_u32 s45, s33, 3932160
 buffer_load_dwordx4 v11, s[16:19], s45 offen  lds
 s_add_u32 m0, s49, 126976
 s_add_u32 s45, s33, 4063232
 buffer_load_dwordx4 v11, s[16:19], s45 offen  lds
 ds_read_b64_tr_b16 a[48:49], v8 offset:0
 ds_read_b64_tr_b16 a[50:51], v8 offset:1024
 ds_read_b64_tr_b16 a[112:113], v9 offset:0
 ds_read_b64_tr_b16 a[114:115], v9 offset:1024
 ds_read_b64_tr_b16 a[176:177], v8 offset:8192
 ds_read_b64_tr_b16 a[178:179], v8 offset:9216
 ds_read_b64_tr_b16 a[240:241], v9 offset:8192
 ds_read_b64_tr_b16 a[242:243], v9 offset:9216
 s_waitcnt vmcnt(8) lgkmcnt(0)
 s_barrier
 ds_read_b64_tr_b16 a[52:53], v8 offset:16384
 ds_read_b64_tr_b16 a[54:55], v8 offset:17408
 ds_read_b64_tr_b16 a[116:117], v9 offset:16384
 ds_read_b64_tr_b16 a[118:119], v9 offset:17408
 ds_read_b64_tr_b16 a[180:181], v8 offset:24576
 ds_read_b64_tr_b16 a[182:183], v8 offset:25600
 ds_read_b64_tr_b16 a[244:245], v9 offset:24576
 ds_read_b64_tr_b16 a[246:247], v9 offset:25600
 s_waitcnt vmcnt(4) lgkmcnt(0)
 s_barrier
 ds_read_b64_tr_b16 a[56:57], v8 offset:32768
 ds_read_b64_tr_b16 a[58:59], v8 offset:33792
 ds_read_b64_tr_b16 a[120:121], v9 offset:32768
 ds_read_b64_tr_b16 a[122:123], v9 offset:33792
 ds_read_b64_tr_b16 a[184:185], v8 offset:40960
 ds_read_b64_tr_b16 a[186:187], v8 offset:41984
 ds_read_b64_tr_b16 a[248:249], v9 offset:40960
 ds_read_b64_tr_b16 a[250:251], v9 offset:41984
 s_waitcnt vmcnt(0) lgkmcnt(0)
 s_barrier
 ds_read_b64_tr_b16 a[60:61], v8 offset:49152
 ds_read_b64_tr_b16 a[62:63], v8 offset:50176
 ds_read_b64_tr_b16 a[124:125], v9 offset:49152
 ds_read_b64_tr_b16 a[126:127], v9 offset:50176
 ds_read_b64_tr_b16 a[188:189], v8 offset:57344
 ds_read_b64_tr_b16 a[190:191], v8 offset:58368
 ds_read_b64_tr_b16 a[252:253], v9 offset:57344
 ds_read_b64_tr_b16 a[254:255], v9 offset:58368
 s_mov_b32 s50, 0x3e0293ee
 s_mov_b32 s42, 0
 s_mov_b32 s43, 0
 s_mov_b32 s44, 65536
 v_mov_b32 v6, v4
 v_mov_b32 v7, v5
Lrh_3:
 v_mbcnt_lo_u32_b32 v21, -1, 0
 v_min_u32 v21, 1, v21
 v_lshlrev_b32 v21, 28, v21
 buffer_load_dword v20, v21, s[28:31], 0 offen offset:4 sc1
 s_waitcnt vmcnt(0)
Lrhc_4:
 v_readfirstlane_b32 s89, v20
 s_cmp_eq_u32 s89, s88
 s_cbranch_scc1 Lrhk_5
 s_cmp_lg_u32 s89, 0
 s_cbranch_scc1 Lredo
 s_sub_u32 s95, s95, 1
 s_cbranch_scc0 Lrh_3
 s_endpgm
Lrhk_5:
 s_cmp_lg_u32 s4, 0
 s_cbranch_scc1 Lfrk_2
 v_min_u32 v21, 1, v0
 v_lshlrev_b32 v21, 28, v21
Lfr_1:
 buffer_load_dword v20, v21, s[28:31], 0 offen offset:128 sc1
 s_waitcnt vmcnt(0)
 v_cmp_eq_u32 vcc, 1, v20
 s_cbranch_vccnz Lfrk_2
 s_sleep 12
 s_sub_u32 s95, s95, 1
 s_cbranch_scc0 Lfr_1
 s_endpgm
Lfrk_2:
 s_lshl_b32 s47, s2, 13
 s_add_u32 s47, s47, 0x8000000
 s_mov_b32 s48, s47
 v_mov_b32 v14, 0
 s_waitcnt vmcnt(0) lgkmcnt(0)
 s_barrier
 ds_read_b128 v[32:35], v6 offset:0
 ds_read_b128 v[36:39], v6 offset:2048
 ds_read_b128 v[40:43], v7 offset:0
 ds_read_b128 v[44:47], v7 offset:2048
 v_lshlrev_b32 v1, 12, v0
 s_lshl_b32 s45, s6, 7
 buffer_load_dword v15, v1, s[8:11], s45 offen
 v_add_u32 v1, 0x100000, v1
 buffer_load_dword v15, v1, s[8:11], s45 offen
 v_add_u32 v1, 0x100000, v1
 s_waitcnt lgkmcnt(2)
Lps_loop_6:
 v_mfma_f32_16x16x32_bf16 v[64:67], a[0:3], v[32:35], 0
 ds_read_b128 v[48:51], v6 offset:4096
 v_mfma_f32_16x16x32_bf16 v[72:75], a[64:67], v[32:35], 0
 ds_read_b128 v[52:55], v6 offset:6144
 v_mfma_f32_16x16x32_bf16 v[80:83], v[32:35], a[128:131], 0
 s_add_u32 s41, s40, 4
 v_mfma_f32_16x16x32_bf16 v[88:91], v[32:35], a[192:195], 0
 s_add_u32 s45, s42, 2
 s_mul_i32 s46, s41, 32768
 v_mfma_f32_16x16x32_bf16 v[68:71], a[0:3], v[36:39], 0
 s_cmp_lt_u32 s45, s36
 s_cselect_b32 s46, s46, 0
 v_mfma_f32_16x16x32_bf16 v[76:79], a[64:67], v[36:39], 0
 s_lshl_b32 s49, s4, 10
 s_add_u32 s49, s49, s44
 v_mfma_f32_16x16x32_bf16 v[84:87], v[36:39], a[128:131], 0
 v_mfma_f32_16x16x32_bf16 v[92:95], v[36:39], a[192:195], 0
 s_waitcnt lgkmcnt(2)
 v_mfma_f32_16x16x32_bf16 v[64:67], a[4:7], v[40:43], v[64:67]
 ds_read_b128 v[56:59], v7 offset:4096
 v_mfma_f32_16x16x32_bf16 v[72:75], a[68:71], v[40:43], v[72:75]
 ds_read_b128 v[60:63], v7 offset:6144
 v_mfma_f32_16x16x32_bf16 v[80:83], v[40:43], a[132:135], v[80:83]
 s_add_u32 m0, s49, 0
 v_mfma_f32_16x16x32_bf16 v[88:91], v[40:43], a[196:199], v[88:91]
 buffer_load_dwordx4 v10, s[8:11], s46 offen offset:0  lds
 v_mfma_f32_16x16x32_bf16 v[68:71], a[4:7], v[44:47], v[68:71]
 s_add_u32 m0, s49, 3968
 v_mfma_f32_16x16x32_bf16 v[76:79], a[68:71], v[44:47], v[76:79]
 buffer_load_dwordx4 v10, s[8:11], s46 offen offset:128  lds
 v_mfma_f32_16x16x32_bf16 v[84:87], v[44:47], a[132:135], v[84:87]
 v_mfma_f32_16x16x32_bf16 v[92:95], v[44:47], a[196:199], v[92:95]
 s_waitcnt lgkmcnt(2)
 v_mfma_f32_16x16x32_bf16 v[64:67], a[8:11], v[48:51], v[64:67]
 ds_read_b128 v[32:35], v6 offset:8192
 v_mfma_f32_16x16x32_bf16 v[72:75], a[72:75], v[48:51], v[72:75]
 ds_read_b128 v[36:39], v6 offset:10240
 v_mfma_f32_16x16x32_bf16 v[80:83], v[48:51], a[136:139], v[80:83]
 s_add_u32 m0, s49, 7936
 v_mfma_f32_16x16x32_bf16 v[88:91], v[48:51], a[200:203], v[88:91]
 buffer_load_dwordx4 v10, s[8:11], s46 offen offset:256  lds
 v_mfma_f32_16x16x32_bf16 v[68:71], a[8:11], v[52:55], v[68:71]
 s_add_u32 m0, s49, 11904
 v_mfma_f32_16x16x32_bf16 v[76:79], a[72:75], v[52:55], v[76:79]
 buffer_load_dwordx4 v10, s[8:11], s46 offen offset:384  lds
 v_mfma_f32_16x16x32_bf16 v[84:87], v[52:55], a[136:139], v[84:87]
 v_mfma_f32_16x16x32_bf16 v[92:95], v[52:55], a[200:203], v[92:95]
 s_waitcnt lgkmcnt(2)
 v_mfma_f32_16x16x32_bf16 v[64:67], a[12:15], v[56:59], v[64:67]
 ds_read_b128 v[40:43], v7 offset:8192
 v_mfma_f32_16x16x32_bf16 v[72:75], a[76:79], v[56:59], v[72:75]
 ds_read_b128 v[44:47], v7 offset:10240
 v_mfma_f32_16x16x32_bf16 v[80:83], v[56:59], a[140:143], v[80:83]
 s_add_u32 m0, s49, 15872
 v_mfma_f32_16x16x32_bf16 v[88:91], v[56:59], a[204:207], v[88:91]
 buffer_load_dwordx4 v10, s[8:11], s46 offen offset:512  lds
 v_mfma_f32_16x16x32_bf16 v[68:71], a[12:15], v[60:63], v[68:71]
 s_add_u32 m0, s49, 19840
 v_mfma_f32_16x16x32_bf16 v[76:79], a[76:79], v[60:63], v[76:79]
 buffer_load_dwordx4 v10, s[8:11], s46 offen offset:640  lds
 v_mfma_f32_16x16x32_bf16 v[84:87], v[60:63], a[140:143], v[84:87]
 v_mfma_f32_16x16x32_bf16 v[92:95], v[60:63], a[204:207], v[92:95]
 s_waitcnt lgkmcnt(2)
 v_mfma_f32_16x16x32_bf16 v[64:67], a[16:19], v[32:35], v[64:67]
 ds_read_b128 v[48:51], v6 offset:12288
 v_mfma_f32_16x16x32_bf16 v[72:75], a[80:83], v[32:35], v[72:75]
 ds_read_b128 v[52:55], v6 offset:14336
 v_mfma_f32_16x16x32_bf16 v[80:83], v[32:35], a[144:147], v[80:83]
 s_add_u32 m0, s49, 23808
 v_mfma_f32_16x16x32_bf16 v[88:91], v[32:35], a[208:211], v[88:91]
 buffer_load_dwordx4 v10, s[8:11], s46 offen offset:768  lds
 v_mfma_f32_16x16x32_bf16 v[68:71], a[16:19], v[36:39], v[68:71]
 s_add_u32 m0, s49, 27776
 v_mfma_f32_16x16x32_bf16 v[76:79], a[80:83], v[36:39], v[76:79]
 buffer_load_dwordx4 v10, s[8:11], s46 offen offset:896  lds
 v_mfma_f32_16x16x32_bf16 v[84:87], v[36:39], a[144:147], v[84:87]
 v_mfma_f32_16x16x32_bf16 v[92:95], v[36:39], a[208:211], v[92:95]
 s_waitcnt lgkmcnt(2)
 v_mfma_f32_16x16x32_bf16 v[64:67], a[20:23], v[40:43], v[64:67]
 ds_read_b128 v[56:59], v7 offset:12288
 v_mfma_f32_16x16x32_bf16 v[72:75], a[84:87], v[40:43], v[72:75]
 ds_read_b128 v[60:63], v7 offset:14336
 v_mfma_f32_16x16x32_bf16 v[80:83], v[40:43], a[148:151], v[80:83]
 v_mfma_f32_16x16x32_bf16 v[88:91], v[40:43], a[212:215], v[88:91]
 v_mfma_f32_16x16x32_bf16 v[68:71], a[20:23], v[44:47], v[68:71]
 v_mfma_f32_16x16x32_bf16 v[76:79], a[84:87], v[44:47], v[76:79]
 v_mfma_f32_16x16x32_bf16 v[84:87], v[44:47], a[148:151], v[84:87]
 v_mfma_f32_16x16x32_bf16 v[92:95], v[44:47], a[212:215], v[92:95]
 s_waitcnt lgkmcnt(2)
 v_mfma_f32_16x16x32_bf16 v[64:67], a[24:27], v[48:51], v[64:67]
 ds_read_b128 v[32:35], v6 offset:16384
 v_mfma_f32_16x16x32_bf16 v[72:75], a[88:91], v[48:51], v[72:75]
 ds_read_b128 v[36:39], v6 offset:18432
 v_mfma_f32_16x16x32_bf16 v[80:83], v[48:51], a[152:155], v[80:83]
 v_cvt_pk_bf16_f32 v16, v96, v97
 v_mfma_f32_16x16x32_bf16 v[88:91], v[48:51], a[216:219], v[88:91]
 v_cvt_pk_bf16_f32 v17, v104, v105
 v_mfma_f32_16x16x32_bf16 v[68:71], a[24:27], v[52:55], v[68:71]
 v_mfma_f32_16x16x32_bf16 v[76:79], a[88:91], v[52:55], v[76:79]
 v_cvt_pk_bf16_f32 v18, v98, v99
 v_mfma_f32_16x16x32_bf16 v[84:87], v[52:55], a[152:155], v[84:87]
 v_mfma_f32_16x16x32_bf16 v[92:95], v[52:55], a[216:219], v[92:95]
 s_waitcnt lgkmcnt(2)
 v_mfma_f32_16x16x32_bf16 v[64:67], a[28:31], v[56:59], v[64:67]
 ds_read_b128 v[40:43], v7 offset:16384
 v_mfma_f32_16x16x32_bf16 v[72:75], a[92:95], v[56:59], v[72:75]
 ds_read_b128 v[44:47], v7 offset:18432
 v_mfma_f32_16x16x32_bf16 v[80:83], v[56:59], a[156:159], v[80:83]
 v_cvt_pk_bf16_f32 v19, v106, v107
 v_mfma_f32_16x16x32_bf16 v[88:91], v[56:59], a[220:223], v[88:91]
 v_mfma_f32_16x16x32_bf16 v[68:71], a[28:31], v[60:63], v[68:71]
 buffer_store_dwordx4 v[16:19], v12, s[20:23], s47 offen offset:0 sc1
 v_mfma_f32_16x16x32_bf16 v[76:79], a[92:95], v[60:63], v[76:79]
 v_cvt_pk_bf16_f32 v20, v100, v101
 v_mfma_f32_16x16x32_bf16 v[84:87], v[60:63], a[156:159], v[84:87]
 v_mfma_f32_16x16x32_bf16 v[92:95], v[60:63], a[220:223], v[92:95]
 s_waitcnt lgkmcnt(2)
 v_mfma_f32_16x16x32_bf16 v[64:67], a[32:35], v[32:35], v[64:67]
 ds_read_b128 v[48:51], v6 offset:20480
 v_mfma_f32_16x16x32_bf16 v[72:75], a[96:99], v[32:35], v[72:75]
 ds_read_b128 v[52:55], v6 offset:22528
 v_mfma_f32_16x16x32_bf16 v[80:83], v[32:35], a[160:163], v[80:83]
 v_cvt_pk_bf16_f32 v21, v108, v109
 v_mfma_f32_16x16x32_bf16 v[88:91], v[32:35], a[224:227], v[88:91]
 v_mfma_f32_16x16x32_bf16 v[68:71], a[32:35], v[36:39], v[68:71]
 v_cvt_pk_bf16_f32 v22, v102, v103
 v_mfma_f32_16x16x32_bf16 v[76:79], a[96:99], v[36:39], v[76:79]
 v_mfma_f32_16x16x32_bf16 v[84:87], v[36:39], a[160:163], v[84:87]
 v_cvt_pk_bf16_f32 v23, v110, v111
 v_mfma_f32_16x16x32_bf16 v[92:95], v[36:39], a[224:227], v[92:95]
 s_waitcnt lgkmcnt(2)
 v_mfma_f32_16x16x32_bf16 v[64:67], a[36:39], v[40:43], v[64:67]
 ds_read_b128 v[56:59], v7 offset:20480
 v_mfma_f32_16x16x32_bf16 v[72:75], a[100:103], v[40:43], v[72:75]
 ds_read_b128 v[60:63], v7 offset:22528
 v_mfma_f32_16x16x32_bf16 v[80:83], v[40:43], a[164:167], v[80:83]
 buffer_store_dwordx4 v[20:23], v12, s[20:23], s47 offen offset:1024 sc1
 v_mfma_f32_16x16x32_bf16 v[88:91], v[40:43], a[228:231], v[88:91]
 v_mfma_f32_16x16x32_bf16 v[68:71], a[36:39], v[44:47], v[68:71]
 v_cvt_pk_bf16_f32 v24, v112, v113
 v_mfma_f32_16x16x32_bf16 v[76:79], a[100:103], v[44:47], v[76:79]
 v_mfma_f32_16x16x32_bf16 v[84:87], v[44:47], a[164:167], v[84:87]
 v_cvt_pk_bf16_f32 v25, v116, v117
 v_mfma_f32_16x16x32_bf16 v[92:95], v[44:47], a[228:231], v[92:95]
 s_waitcnt lgkmcnt(2)
 v_mfma_f32_16x16x32_bf16 v[64:67], a[40:43], v[48:51], v[64:67]
 ds_read_b128 v[32:35], v6 offset:24576
 v_mfma_f32_16x16x32_bf16 v[72:75], a[104:107], v[48:51], v[72:75]
 ds_read_b128 v[36:39], v6 offset:26624
 v_mfma_f32_16x16x32_bf16 v[80:83], v[48:51], a[168:171], v[80:83]
 v_mfma_f32_16x16x32_bf16 v[88:91], v[48:51], a[232:235], v[88:91]
 v_cvt_pk_bf16_f32 v26, v114, v115
 v_mfma_f32_16x16x32_bf16 v[68:71], a[40:43], v[52:55], v[68:71]
 v_cvt_pk_bf16_f32 v27, v118, v119
 v_mfma_f32_16x16x32_bf16 v[76:79], a[104:107], v[52:55], v[76:79]
 v_mfma_f32_16x16x32_bf16 v[84:87], v[52:55], a[168:171], v[84:87]
 buffer_store_dwordx4 v[24:27], v12, s[20:23], s48 offen offset:0 sc1
 v_mfma_f32_16x16x32_bf16 v[92:95], v[52:55], a[232:235], v[92:95]
 s_waitcnt lgkmcnt(2)
 v_mfma_f32_16x16x32_bf16 v[64:67], a[44:47], v[56:59], v[64:67]
 ds_read_b128 v[40:43], v7 offset:24576
 v_mfma_f32_16x16x32_bf16 v[72:75], a[108:111], v[56:59], v[72:75]
 ds_read_b128 v[44:47], v7 offset:26624
 v_mfma_f32_16x16x32_bf16 v[80:83], v[56:59], a[172:175], v[80:83]
 s_add_u32 s43, s43, 32768
 s_cmp_eq_u32 s43, 131072
 v_mfma_f32_16x16x32_bf16 v[88:91], v[56:59], a[236:239], v[88:91]
 s_cselect_b32 s43, 0, s43
 s_add_u32 s44, s44, 32768
 v_mfma_f32_16x16x32_bf16 v[68:71], a[44:47], v[60:63], v[68:71]
 s_cmp_eq_u32 s44, 131072
 s_cselect_b32 s44, 0, s44
 v_mfma_f32_16x16x32_bf16 v[76:79], a[108:111], v[60:63], v[76:79]
 v_mfma_f32_16x16x32_bf16 v[84:87], v[60:63], a[172:175], v[84:87]
 v_cvt_pk_bf16_f32 v28, v120, v121
 v_mfma_f32_16x16x32_bf16 v[92:95], v[60:63], a[236:239], v[92:95]
 s_waitcnt lgkmcnt(2)
 v_mfma_f32_16x16x32_bf16 v[64:67], a[48:51], v[32:35], v[64:67]
 ds_read_b128 v[48:51], v6 offset:28672
 v_mfma_f32_16x16x32_bf16 v[72:75], a[112:115], v[32:35], v[72:75]
 ds_read_b128 v[52:55], v6 offset:30720
 v_mfma_f32_16x16x32_bf16 v[80:83], v[32:35], a[176:179], v[80:83]
 v_add_u32 v6, s43, v4
 v_mfma_f32_16x16x32_bf16 v[88:91], v[32:35], a[240:243], v[88:91]
 v_mfma_f32_16x16x32_bf16 v[68:71], a[48:51], v[36:39], v[68:71]
 v_cvt_pk_bf16_f32 v29, v124, v125
 v_mfma_f32_16x16x32_bf16 v[76:79], a[112:115], v[36:39], v[76:79]
 v_cvt_pk_bf16_f32 v30, v122, v123
 v_mfma_f32_16x16x32_bf16 v[84:87], v[36:39], a[176:179], v[84:87]
 v_mfma_f32_16x16x32_bf16 v[92:95], v[36:39], a[240:243], v[92:95]
 s_waitcnt lgkmcnt(2)
 v_mfma_f32_16x16x32_bf16 v[64:67], a[52:55], v[40:43], v[64:67]
 ds_read_b128 v[56:59], v7 offset:28672
 v_mfma_f32_16x16x32_bf16 v[72:75], a[116:119], v[40:43], v[72:75]
 ds_read_b128 v[60:63], v7 offset:30720
 v_mfma_f32_16x16x32_bf16 v[80:83], v[40:43], a[180:183], v[80:83]
 v_add_u32 v7, s43, v5
 v_mfma_f32_16x16x32_bf16 v[88:91], v[40:43], a[244:247], v[88:91]
 v_cvt_pk_bf16_f32 v31, v126, v127
 v_mfma_f32_16x16x32_bf16 v[68:71], a[52:55], v[44:47], v[68:71]
 v_mfma_f32_16x16x32_bf16 v[76:79], a[116:119], v[44:47], v[76:79]
 buffer_store_dwordx4 v[28:31], v12, s[20:23], s48 offen offset:1024 sc1
 v_mfma_f32_16x16x32_bf16 v[84:87], v[44:47], a[180:183], v[84:87]
 v_mfma_f32_16x16x32_bf16 v[92:95], v[44:47], a[244:247], v[92:95]
 s_waitcnt lgkmcnt(2)
 v_mfma_f32_16x16x32_bf16 v[64:67], a[56:59], v[48:51], v[64:67]
 s_waitcnt vmcnt(12)
 s_barrier
 ds_read_b128 v[32:35], v6 offset:0
 v_mfma_f32_16x16x32_bf16 v[72:75], a[120:123], v[48:51], v[72:75]
 ds_read_b128 v[36:39], v6 offset:2048
 v_mfma_f32_16x16x32_bf16 v[80:83], v[48:51], a[184:187], v[80:83]
 v_mfma_f32_16x16x32_bf16 v[88:91], v[48:51], a[248:251], v[88:91]
 v_mfma_f32_16x16x32_bf16 v[68:71], a[56:59], v[52:55], v[68:71]
 v_mfma_f32_16x16x32_bf16 v[76:79], a[120:123], v[52:55], v[76:79]
 v_mfma_f32_16x16x32_bf16 v[84:87], v[52:55], a[184:187], v[84:87]
 v_mfma_f32_16x16x32_bf16 v[92:95], v[52:55], a[248:251], v[92:95]
 s_waitcnt lgkmcnt(2)
 v_mfma_f32_16x16x32_bf16 v[64:67], a[60:63], v[56:59], v[64:67]
 ds_read_b128 v[40:43], v7 offset:0
 v_mfma_f32_16x16x32_bf16 v[72:75], a[124:127], v[56:59], v[72:75]
 ds_read_b128 v[44:47], v7 offset:2048
 v_mfma_f32_16x16x32_bf16 v[80:83], v[56:59], a[188:191], v[80:83]
 s_mul_i32 s45, s39, 524288
 s_add_u32 s47, s34, s45
 v_mfma_f32_16x16x32_bf16 v[88:91], v[56:59], a[252:255], v[88:91]
 s_add_u32 s48, s35, s45
 v_mov_b32 v14, s42
 v_mfma_f32_16x16x32_bf16 v[68:71], a[60:63], v[60:63], v[68:71]
 s_mov_b32 s39, s40
 s_mov_b32 s40, s41
 v_mfma_f32_16x16x32_bf16 v[76:79], a[124:127], v[60:63], v[76:79]
 s_add_u32 s42, s42, 1
 v_mfma_f32_16x16x32_bf16 v[84:87], v[60:63], a[188:191], v[84:87]
 v_mfma_f32_16x16x32_bf16 v[92:95], v[60:63], a[252:255], v[92:95]
 s_waitcnt lgkmcnt(2)
 v_mfma_f32_16x16x32_bf16 v[96:99], a[0:3], v[32:35], 0
 ds_read_b128 v[48:51], v6 offset:4096
 v_mfma_f32_16x16x32_bf16 v[104:107], a[64:67], v[32:35], 0
 ds_read_b128 v[52:55], v6 offset:6144
 v_mfma_f32_16x16x32_bf16 v[112:115], v[32:35], a[128:131], 0
 s_add_u32 s41, s40, 4
 v_mfma_f32_16x16x32_bf16 v[120:123], v[32:35], a[192:195], 0
 s_add_u32 s45, s42, 2
 s_mul_i32 s46, s41, 32768
 v_mfma_f32_16x16x32_bf16 v[100:103], a[0:3], v[36:39], 0
 s_cmp_lt_u32 s45, s36
 s_cselect_b32 s46, s46, 0
 v_mfma_f32_16x16x32_bf16 v[108:111], a[64:67], v[36:39], 0
 s_lshl_b32 s49, s4, 10
 s_add_u32 s49, s49, s44
 v_mfma_f32_16x16x32_bf16 v[116:119], v[36:39], a[128:131], 0
 v_mfma_f32_16x16x32_bf16 v[124:127], v[36:39], a[192:195], 0
 s_waitcnt lgkmcnt(2)
 v_mfma_f32_16x16x32_bf16 v[96:99], a[4:7], v[40:43], v[96:99]
 ds_read_b128 v[56:59], v7 offset:4096
 v_mfma_f32_16x16x32_bf16 v[104:107], a[68:71], v[40:43], v[104:107]
 ds_read_b128 v[60:63], v7 offset:6144
 v_mfma_f32_16x16x32_bf16 v[112:115], v[40:43], a[132:135], v[112:115]
 s_add_u32 m0, s49, 0
 v_mfma_f32_16x16x32_bf16 v[120:123], v[40:43], a[196:199], v[120:123]
 buffer_load_dwordx4 v10, s[8:11], s46 offen offset:0  lds
 v_mfma_f32_16x16x32_bf16 v[100:103], a[4:7], v[44:47], v[100:103]
 s_add_u32 m0, s49, 3968
 v_mfma_f32_16x16x32_bf16 v[108:111], a[68:71], v[44:47], v[108:111]
 buffer_load_dwordx4 v10, s[8:11], s46 offen offset:128  lds
 v_mfma_f32_16x16x32_bf16 v[116:119], v[44:47], a[132:135], v[116:119]
 v_mfma_f32_16x16x32_bf16 v[124:127], v[44:47], a[196:199], v[124:127]
 s_waitcnt lgkmcnt(2)
 v_mfma_f32_16x16x32_bf16 v[96:99], a[8:11], v[48:51], v[96:99]
 ds_read_b128 v[32:35], v6 offset:8192
 v_mfma_f32_16x16x32_bf16 v[104:107], a[72:75], v[48:51], v[104:107]
 ds_read_b128 v[36:39], v6 offset:10240
 v_mfma_f32_16x16x32_bf16 v[112:115], v[48:51], a[136:139], v[112:115]
 s_add_u32 m0, s49, 7936
 v_mfma_f32_16x16x32_bf16 v[120:123], v[48:51], a[200:203], v[120:123]
 buffer_load_dwordx4 v10, s[8:11], s46 offen offset:256  lds
 v_mfma_f32_16x16x32_bf16 v[100:103], a[8:11], v[52:55], v[100:103]
 s_add_u32 m0, s49, 11904
 v_mfma_f32_16x16x32_bf16 v[108:111], a[72:75], v[52:55], v[108:111]
 buffer_load_dwordx4 v10, s[8:11], s46 offen offset:384  lds
 v_mfma_f32_16x16x32_bf16 v[116:119], v[52:55], a[136:139], v[116:119]
 v_mfma_f32_16x16x32_bf16 v[124:127], v[52:55], a[200:203], v[124:127]
 s_waitcnt lgkmcnt(2)
 v_mfma_f32_16x16x32_bf16 v[96:99], a[12:15], v[56:59], v[96:99]
 ds_read_b128 v[40:43], v7 offset:8192
 v_mfma_f32_16x16x32_bf16 v[104:107], a[76:79], v[56:59], v[104:107]
 ds_read_b128 v[44:47], v7 offset:10240
 v_mfma_f32_16x16x32_bf16 v[112:115], v[56:59], a[140:143], v[112:115]
 s_add_u32 m0, s49, 15872
 v_mfma_f32_16x16x32_bf16 v[120:123], v[56:59], a[204:207], v[120:123]
 buffer_load_dwordx4 v10, s[8:11], s46 offen offset:512  lds
 v_mfma_f32_16x16x32_bf16 v[100:103], a[12:15], v[60:63], v[100:103]
 s_add_u32 m0, s49, 19840
 v_mfma_f32_16x16x32_bf16 v[108:111], a[76:79], v[60:63], v[108:111]
 buffer_load_dwordx4 v10, s[8:11], s46 offen offset:640  lds
 v_mfma_f32_16x16x32_bf16 v[116:119], v[60:63], a[140:143], v[116:119]
 v_mfma_f32_16x16x32_bf16 v[124:127], v[60:63], a[204:207], v[124:127]
 s_waitcnt lgkmcnt(2)
 v_mfma_f32_16x16x32_bf16 v[96:99], a[16:19], v[32:35], v[96:99]
 ds_read_b128 v[48:51], v6 offset:12288
 v_mfma_f32_16x16x32_bf16 v[104:107], a[80:83], v[32:35], v[104:107]
 ds_read_b128 v[52:55], v6 offset:14336
 v_mfma_f32_16x16x32_bf16 v[112:115], v[32:35], a[144:147], v[112:115]
 s_add_u32 m0, s49, 23808
 v_mfma_f32_16x16x32_bf16 v[120:123], v[32:35], a[208:211], v[120:123]
 buffer_load_dwordx4 v10, s[8:11], s46 offen offset:768  lds
 v_mfma_f32_16x16x32_bf16 v[100:103], a[16:19], v[36:39], v[100:103]
 s_add_u32 m0, s49, 27776
 v_mfma_f32_16x16x32_bf16 v[108:111], a[80:83], v[36:39], v[108:111]
 buffer_load_dwordx4 v10, s[8:11], s46 offen offset:896  lds
 v_mfma_f32_16x16x32_bf16 v[116:119], v[36:39], a[144:147], v[116:119]
 v_mfma_f32_16x16x32_bf16 v[124:127], v[36:39], a[208:211], v[124:127]
 s_waitcnt lgkmcnt(2)
 v_mfma_f32_16x16x32_bf16 v[96:99], a[20:23], v[40:43], v[96:99]
 ds_read_b128 v[56:59], v7 offset:12288
 v_mfma_f32_16x16x32_bf16 v[104:107], a[84:87], v[40:43], v[104:107]
 ds_read_b128 v[60:63], v7 offset:14336
 v_mfma_f32_16x16x32_bf16 v[112:115], v[40:43], a[148:151], v[112:115]
 v_mfma_f32_16x16x32_bf16 v[120:123], v[40:43], a[212:215], v[120:123]
 v_mfma_f32_16x16x32_bf16 v[100:103], a[20:23], v[44:47], v[100:103]
 v_mfma_f32_16x16x32_bf16 v[108:111], a[84:87], v[44:47], v[108:111]
 v_mfma_f32_16x16x32_bf16 v[116:119], v[44:47], a[148:151], v[116:119]
 v_mfma_f32_16x16x32_bf16 v[124:127], v[44:47], a[212:215], v[124:127]
 s_waitcnt lgkmcnt(2)
 v_mfma_f32_16x16x32_bf16 v[96:99], a[24:27], v[48:51], v[96:99]
 ds_read_b128 v[32:35], v6 offset:16384
 v_mfma_f32_16x16x32_bf16 v[104:107], a[88:91], v[48:51], v[104:107]
 ds_read_b128 v[36:39], v6 offset:18432
 v_mfma_f32_16x16x32_bf16 v[112:115], v[48:51], a[152:155], v[112:115]
 v_cvt_pk_bf16_f32 v16, v64, v65
 v_mfma_f32_16x16x32_bf16 v[120:123], v[48:51], a[216:219], v[120:123]
 v_cvt_pk_bf16_f32 v17, v72, v73
 v_mfma_f32_16x16x32_bf16 v[100:103], a[24:27], v[52:55], v[100:103]
 v_mfma_f32_16x16x32_bf16 v[108:111], a[88:91], v[52:55], v[108:111]
 v_cvt_pk_bf16_f32 v18, v66, v67
 v_mfma_f32_16x16x32_bf16 v[116:119], v[52:55], a[152:155], v[116:119]
 v_mfma_f32_16x16x32_bf16 v[124:127], v[52:55], a[216:219], v[124:127]
 s_waitcnt lgkmcnt(2)
 v_mfma_f32_16x16x32_bf16 v[96:99], a[28:31], v[56:59], v[96:99]
 ds_read_b128 v[40:43], v7 offset:16384
 v_mfma_f32_16x16x32_bf16 v[104:107], a[92:95], v[56:59], v[104:107]
 ds_read_b128 v[44:47], v7 offset:18432
 v_mfma_f32_16x16x32_bf16 v[112:115], v[56:59], a[156:159], v[112:115]
 v_cvt_pk_bf16_f32 v19, v74, v75
 v_mfma_f32_16x16x32_bf16 v[120:123], v[56:59], a[220:223], v[120:123]
 v_mfma_f32_16x16x32_bf16 v[100:103], a[28:31], v[60:63], v[100:103]
 buffer_store_dwordx4 v[16:19], v12, s[20:23], s47 offen offset:0 sc1
 v_mfma_f32_16x16x32_bf16 v[108:111], a[92:95], v[60:63], v[108:111]
 v_cvt_pk_bf16_f32 v20, v68, v69
 v_mfma_f32_16x16x32_bf16 v[116:119], v[60:63], a[156:159], v[116:119]
 v_mfma_f32_16x16x32_bf16 v[124:127], v[60:63], a[220:223], v[124:127]
 s_waitcnt lgkmcnt(2)
 v_mfma_f32_16x16x32_bf16 v[96:99], a[32:35], v[32:35], v[96:99]
 ds_read_b128 v[48:51], v6 offset:20480
 v_mfma_f32_16x16x32_bf16 v[104:107], a[96:99], v[32:35], v[104:107]
 ds_read_b128 v[52:55], v6 offset:22528
 v_mfma_f32_16x16x32_bf16 v[112:115], v[32:35], a[160:163], v[112:115]
 v_cvt_pk_bf16_f32 v21, v76, v77
 v_mfma_f32_16x16x32_bf16 v[120:123], v[32:35], a[224:227], v[120:123]
 v_mfma_f32_16x16x32_bf16 v[100:103], a[32:35], v[36:39], v[100:103]
 v_cvt_pk_bf16_f32 v22, v70, v71
 v_mfma_f32_16x16x32_bf16 v[108:111], a[96:99], v[36:39], v[108:111]
 v_mfma_f32_16x16x32_bf16 v[116:119], v[36:39], a[160:163], v[116:119]
 v_cvt_pk_bf16_f32 v23, v78, v79
 v_mfma_f32_16x16x32_bf16 v[124:127], v[36:39], a[224:227], v[124:127]
 s_waitcnt lgkmcnt(2)
 v_mfma_f32_16x16x32_bf16 v[96:99], a[36:39], v[40:43], v[96:99]
 ds_read_b128 v[56:59], v7 offset:20480
 v_mfma_f32_16x16x32_bf16 v[104:107], a[100:103], v[40:43], v[104:107]
 ds_read_b128 v[60:63], v7 offset:22528
 v_mfma_f32_16x16x32_bf16 v[112:115], v[40:43], a[164:167], v[112:115]
 buffer_store_dwordx4 v[20:23], v12, s[20:23], s47 offen offset:1024 sc1
 v_mfma_f32_16x16x32_bf16 v[120:123], v[40:43], a[228:231], v[120:123]
 v_mfma_f32_16x16x32_bf16 v[100:103], a[36:39], v[44:47], v[100:103]
 v_cvt_pk_bf16_f32 v24, v80, v81
 v_mfma_f32_16x16x32_bf16 v[108:111], a[100:103], v[44:47], v[108:111]
 v_mfma_f32_16x16x32_bf16 v[116:119], v[44:47], a[164:167], v[116:119]
 v_cvt_pk_bf16_f32 v25, v84, v85
 v_mfma_f32_16x16x32_bf16 v[124:127], v[44:47], a[228:231], v[124:127]
 s_waitcnt lgkmcnt(2)
 v_mfma_f32_16x16x32_bf16 v[96:99], a[40:43], v[48:51], v[96:99]
 ds_read_b128 v[32:35], v6 offset:24576
 v_mfma_f32_16x16x32_bf16 v[104:107], a[104:107], v[48:51], v[104:107]
 ds_read_b128 v[36:39], v6 offset:26624
 v_mfma_f32_16x16x32_bf16 v[112:115], v[48:51], a[168:171], v[112:115]
 v_mfma_f32_16x16x32_bf16 v[120:123], v[48:51], a[232:235], v[120:123]
 v_cvt_pk_bf16_f32 v26, v82, v83
 v_mfma_f32_16x16x32_bf16 v[100:103], a[40:43], v[52:55], v[100:103]
 v_cvt_pk_bf16_f32 v27, v86, v87
 v_mfma_f32_16x16x32_bf16 v[108:111], a[104:107], v[52:55], v[108:111]
 v_mfma_f32_16x16x32_bf16 v[116:119], v[52:55], a[168:171], v[116:119]
 buffer_store_dwordx4 v[24:27], v12, s[20:23], s48 offen offset:0 sc1
 v_mfma_f32_16x16x32_bf16 v[124:127], v[52:55], a[232:235], v[124:127]
 s_waitcnt lgkmcnt(2)
 v_mfma_f32_16x16x32_bf16 v[96:99], a[44:47], v[56:59], v[96:99]
 ds_read_b128 v[40:43], v7 offset:24576
 v_mfma_f32_16x16x32_bf16 v[104:107], a[108:111], v[56:59], v[104:107]
 ds_read_b128 v[44:47], v7 offset:26624
 v_mfma_f32_16x16x32_bf16 v[112:115], v[56:59], a[172:175], v[112:115]
 s_add_u32 s43, s43, 32768
 s_cmp_eq_u32 s43, 131072
 v_mfma_f32_16x16x32_bf16 v[120:123], v[56:59], a[236:239], v[120:123]
 s_cselect_b32 s43, 0, s43
 s_add_u32 s44, s44, 32768
 v_mfma_f32_16x16x32_bf16 v[100:103], a[44:47], v[60:63], v[100:103]
 s_cmp_eq_u32 s44, 131072
 s_cselect_b32 s44, 0, s44
 v_mfma_f32_16x16x32_bf16 v[108:111], a[108:111], v[60:63], v[108:111]
 v_mfma_f32_16x16x32_bf16 v[116:119], v[60:63], a[172:175], v[116:119]
 v_cvt_pk_bf16_f32 v28, v88, v89
 v_mfma_f32_16x16x32_bf16 v[124:127], v[60:63], a[236:239], v[124:127]
 s_waitcnt lgkmcnt(2)
 v_mfma_f32_16x16x32_bf16 v[96:99], a[48:51], v[32:35], v[96:99]
 ds_read_b128 v[48:51], v6 offset:28672
 v_mfma_f32_16x16x32_bf16 v[104:107], a[112:115], v[32:35], v[104:107]
 ds_read_b128 v[52:55], v6 offset:30720
 v_mfma_f32_16x16x32_bf16 v[112:115], v[32:35], a[176:179], v[112:115]
 v_add_u32 v6, s43, v4
 v_mfma_f32_16x16x32_bf16 v[120:123], v[32:35], a[240:243], v[120:123]
 v_mfma_f32_16x16x32_bf16 v[100:103], a[48:51], v[36:39], v[100:103]
 v_cvt_pk_bf16_f32 v29, v92, v93
 v_mfma_f32_16x16x32_bf16 v[108:111], a[112:115], v[36:39], v[108:111]
 v_cvt_pk_bf16_f32 v30, v90, v91
 v_mfma_f32_16x16x32_bf16 v[116:119], v[36:39], a[176:179], v[116:119]
 v_mfma_f32_16x16x32_bf16 v[124:127], v[36:39], a[240:243], v[124:127]
 s_waitcnt lgkmcnt(2)
 v_mfma_f32_16x16x32_bf16 v[96:99], a[52:55], v[40:43], v[96:99]
 ds_read_b128 v[56:59], v7 offset:28672
 v_mfma_f32_16x16x32_bf16 v[104:107], a[116:119], v[40:43], v[104:107]
 ds_read_b128 v[60:63], v7 offset:30720
 v_mfma_f32_16x16x32_bf16 v[112:115], v[40:43], a[180:183], v[112:115]
 v_add_u32 v7, s43, v5
 v_mfma_f32_16x16x32_bf16 v[120:123], v[40:43], a[244:247], v[120:123]
 v_cvt_pk_bf16_f32 v31, v94, v95
 v_mfma_f32_16x16x32_bf16 v[100:103], a[52:55], v[44:47], v[100:103]
 v_mfma_f32_16x16x32_bf16 v[108:111], a[116:119], v[44:47], v[108:111]
 buffer_store_dwordx4 v[28:31], v12, s[20:23], s48 offen offset:1024 sc1
 v_mfma_f32_16x16x32_bf16 v[116:119], v[44:47], a[180:183], v[116:119]
 v_mfma_f32_16x16x32_bf16 v[124:127], v[44:47], a[244:247], v[124:127]
 s_waitcnt lgkmcnt(2)
 v_mfma_f32_16x16x32_bf16 v[96:99], a[56:59], v[48:51], v[96:99]
 s_waitcnt vmcnt(12)
 s_barrier
 ds_read_b128 v[32:35], v6 offset:0
 v_mfma_f32_16x16x32_bf16 v[104:107], a[120:123], v[48:51], v[104:107]
 ds_read_b128 v[36:39], v6 offset:2048
 v_mfma_f32_16x16x32_bf16 v[112:115], v[48:51], a[184:187], v[112:115]
 v_mfma_f32_16x16x32_bf16 v[120:123], v[48:51], a[248:251], v[120:123]
 v_mfma_f32_16x16x32_bf16 v[100:103], a[56:59], v[52:55], v[100:103]
 v_mfma_f32_16x16x32_bf16 v[108:111], a[120:123], v[52:55], v[108:111]
 v_mfma_f32_16x16x32_bf16 v[116:119], v[52:55], a[184:187], v[116:119]
 v_mfma_f32_16x16x32_bf16 v[124:127], v[52:55], a[248:251], v[124:127]
 s_waitcnt lgkmcnt(2)
 v_mfma_f32_16x16x32_bf16 v[96:99], a[60:63], v[56:59], v[96:99]
 ds_read_b128 v[40:43], v7 offset:0
 v_mfma_f32_16x16x32_bf16 v[104:107], a[124:127], v[56:59], v[104:107]
 ds_read_b128 v[44:47], v7 offset:2048
 v_mfma_f32_16x16x32_bf16 v[112:115], v[56:59], a[188:191], v[112:115]
 s_mul_i32 s45, s39, 524288
 s_add_u32 s47, s34, s45
 v_mfma_f32_16x16x32_bf16 v[120:123], v[56:59], a[252:255], v[120:123]
 s_add_u32 s48, s35, s45
 v_mov_b32 v14, s42
 v_mfma_f32_16x16x32_bf16 v[100:103], a[60:63], v[60:63], v[100:103]
 s_mov_b32 s39, s40
 s_mov_b32 s40, s41
 v_mfma_f32_16x16x32_bf16 v[108:111], a[124:127], v[60:63], v[108:111]
 s_add_u32 s42, s42, 1
 s_cmp_lt_u32 s42, s36
 v_mfma_f32_16x16x32_bf16 v[116:119], v[60:63], a[188:191], v[116:119]
 v_mfma_f32_16x16x32_bf16 v[124:127], v[60:63], a[252:255], v[124:127]
 s_waitcnt lgkmcnt(2)
 s_cbranch_scc1 Lps_loop_6
 s_nop 7
 v_cvt_pk_bf16_f32 v16, v96, v97
 v_cvt_pk_bf16_f32 v17, v104, v105
 v_cvt_pk_bf16_f32 v18, v98, v99
 v_cvt_pk_bf16_f32 v19, v106, v107
 buffer_store_dwordx4 v[16:19], v12, s[20:23], s47 offen offset:0 sc1
 v_cvt_pk_bf16_f32 v20, v100, v101
 v_cvt_pk_bf16_f32 v21, v108, v109
 v_cvt_pk_bf16_f32 v22, v102, v103
 v_cvt_pk_bf16_f32 v23, v110, v111
 buffer_store_dwordx4 v[20:23], v12, s[20:23], s47 offen offset:1024 sc1
 v_cvt_pk_bf16_f32 v24, v112, v113
 v_cvt_pk_bf16_f32 v25, v116, v117
 v_cvt_pk_bf16_f32 v26, v114, v115
 v_cvt_pk_bf16_f32 v27, v118, v119
 buffer_store_dwordx4 v[24:27], v12, s[20:23], s48 offen offset:0 sc1
 v_cvt_pk_bf16_f32 v28, v120, v121
 v_cvt_pk_bf16_f32 v29, v124, v125
 v_cvt_pk_bf16_f32 v30, v122, v123
 v_cvt_pk_bf16_f32 v31, v126, v127
 buffer_store_dwordx4 v[28:31], v12, s[20:23], s48 offen offset:1024 sc1
 s_waitcnt vmcnt(0) lgkmcnt(0)
 s_barrier
 v_mov_b32 v14, s36
 buffer_store_dword v14, v13, s[20:23], 0 offen sc1
 s_mov_b32 s32, s3
 s_and_b32 s33, s6, 3
 s_sub_u32 s34, 7, s33
 v_and_b32 v1, 63, v0
 v_lshlrev_b32 v1, 4, v1
 v_mov_b32 v4, 0xff800000
 v_min_u32 v5, 1, v0
 v_lshlrev_b32 v5, 28, v5
 v_mov_b32 v6, 0x3f803f80
 v_accvgpr_write_b32 a192, v6
 v_accvgpr_write_b32 a193, v6
 v_accvgpr_write_b32 a194, v6
 v_accvgpr_write_b32 a195, v6
 s_mov_b32 s52, 0xfff0ffff
 s_mov_b32 s53, 0xf000ff00
 s_mov_b32 s54, 0xffe0fffe
 s_mov_b32 s55, 0xe000fe00
 s_mov_b32 s56, 0xffc0fffc
 s_mov_b32 s57, 0xc000fc00
 s_mov_b32 s58, 0xff80fff8
 s_mov_b32 s59, 0x8000f800
 s_mov_b32 s73, 0x53800000
 s_mov_b32 s74, 0x21800000
 s_lshl_b32 s50, s4, 12
 s_lshl_b32 s45, s32, 14
 s_add_u32 s45, s45, s50
 s_add_u32 s45, s45, 0x1000000
 s_lshl_b32 s36, s33, 3
 s_add_u32 s36, s36, 8
 s_lshl_b32 s47, s34, 3
 s_add_u32 s47, s47, 8
 s_mov_b32 s35, 0
 s_mov_b32 s38, 0
 s_mov_b32 s46, 0
 s_lshl_b32 s7, s3, 7
 s_add_u32 s7, s7, 0x2000
 s_lshr_b32 s94, s3, 1
 s_lshl_b32 s94, s94, 7
 s_add_u32 s94, s94, 0x3000
 v_min_u32 v10, 16, v1
 v_lshlrev_b32 v10, 24, v10
Law_7:
 buffer_load_dwordx4 v[240:243], v10, s[20:23], s94 offen sc1
 buffer_load_dwordx4 v[244:247], v10, s[20:23], s7 offen sc1
 s_waitcnt vmcnt(0)
 v_min3_u32 v240, v240, v241, v242
 v_min_u32 v240, v240, v243
 v_lshlrev_b32 v240, 1, v240
 v_min3_u32 v240, v240, v244, v245
 v_min3_u32 v240, v240, v246, v247
 v_cmp_le_u32 vcc, 16, v240
 s_cbranch_vccnz Lawk_8
 s_sleep 2
 s_sub_u32 s95, s95, 1
 s_cbranch_scc0 Law_7
 s_endpgm
Lawk_8:
 s_lshl_b32 s37, s35, 19
 s_add_u32 m0, s38, s50
 s_add_u32 s37, s37, s45
 buffer_load_dwordx4 v1, s[20:23], s37 offen offset:0 sc1 lds
 buffer_load_dwordx4 v1, s[20:23], s37 offen offset:1024 sc1 lds
 buffer_load_dwordx4 v1, s[20:23], s37 offen offset:2048 sc1 lds
 buffer_load_dwordx4 v1, s[20:23], s37 offen offset:3072 sc1 lds
 s_add_u32 s38, s38, 0x4000
 s_and_b32 s38, s38, 0x1ffff
 s_add_u32 s35, s35, 1
 s_cmp_eq_u32 s35, s36
 s_cselect_b32 s36, s47, s36
 s_cselect_b32 s35, 0, s35
 s_lshl_b32 s44, s33, 3
 s_add_u32 s44, s44, s4
 s_lshl_b32 s44, s44, 5
 s_add_u32 s44, s44, s32
 s_lshl_b32 s44, s44, 13
 s_add_u32 s44, s44, 0x5000000
 buffer_load_dwordx4 a[0:3], v1, s[20:23], s44 offen offset:0 sc1
 buffer_load_dwordx4 a[16:19], v1, s[20:23], s44 offen offset:1024 sc1
 buffer_load_dwordx4 a[4:7], v1, s[20:23], s44 offen offset:2048 sc1
 buffer_load_dwordx4 a[20:23], v1, s[20:23], s44 offen offset:3072 sc1
 s_add_u32 s44, s44, 4096
 buffer_load_dwordx4 a[8:11], v1, s[20:23], s44 offen offset:0 sc1
 buffer_load_dwordx4 a[24:27], v1, s[20:23], s44 offen offset:1024 sc1
 buffer_load_dwordx4 a[12:15], v1, s[20:23], s44 offen offset:2048 sc1
 buffer_load_dwordx4 a[28:31], v1, s[20:23], s44 offen offset:3072 sc1
 s_lshl_b32 s44, s33, 3
 s_add_u32 s44, s44, 7
 s_sub_u32 s44, s44, s4
 s_lshl_b32 s44, s44, 5
 s_add_u32 s44, s44, s32
 s_lshl_b32 s44, s44, 13
 s_add_u32 s44, s44, 0x5000000
 buffer_load_dwordx4 a[32:35], v1, s[20:23], s44 offen offset:0 sc1
 buffer_load_dwordx4 a[48:51], v1, s[20:23], s44 offen offset:1024 sc1
 buffer_load_dwordx4 a[36:39], v1, s[20:23], s44 offen offset:2048 sc1
 buffer_load_dwordx4 a[52:55], v1, s[20:23], s44 offen offset:3072 sc1
 s_add_u32 s44, s44, 4096
 buffer_load_dwordx4 a[40:43], v1, s[20:23], s44 offen offset:0 sc1
 buffer_load_dwordx4 a[56:59], v1, s[20:23], s44 offen offset:1024 sc1
 buffer_load_dwordx4 a[44:47], v1, s[20:23], s44 offen offset:2048 sc1
 buffer_load_dwordx4 a[60:63], v1, s[20:23], s44 offen offset:3072 sc1
 s_lshl_b32 s37, s35, 19
 s_add_u32 m0, s38, s50
 s_add_u32 s37, s37, s45
 buffer_load_dwordx4 v1, s[20:23], s37 offen offset:0 sc1 lds
 buffer_load_dwordx4 v1, s[20:23], s37 offen offset:1024 sc1 lds
 buffer_load_dwordx4 v1, s[20:23], s37 offen offset:2048 sc1 lds
 buffer_load_dwordx4 v1, s[20:23], s37 offen offset:3072 sc1 lds
 s_add_u32 s38, s38, 0x4000
 s_and_b32 s38, s38, 0x1ffff
 s_add_u32 s35, s35, 1
 s_cmp_eq_u32 s35, s36
 s_cselect_b32 s36, s47, s36
 s_cselect_b32 s35, 0, s35
 s_lshl_b32 s37, s35, 19
 s_add_u32 m0, s38, s50
 s_add_u32 s37, s37, s45
 buffer_load_dwordx4 v1, s[20:23], s37 offen offset:0 sc1 lds
 buffer_load_dwordx4 v1, s[20:23], s37 offen offset:1024 sc1 lds
 buffer_load_dwordx4 v1, s[20:23], s37 offen offset:2048 sc1 lds
 buffer_load_dwordx4 v1, s[20:23], s37 offen offset:3072 sc1 lds
 s_add_u32 s38, s38, 0x4000
 s_and_b32 s38, s38, 0x1ffff
 s_add_u32 s35, s35, 1
 s_cmp_eq_u32 s35, s36
 s_cselect_b32 s36, s47, s36
 s_cselect_b32 s35, 0, s35
 s_waitcnt vmcnt(8)
 s_barrier
 v_mov_b32 v2, v1
 ds_read_b128 a[128:131], v2 offset:0
 ds_read_b128 a[132:135], v2 offset:1024
 ds_read_b128 a[136:139], v2 offset:2048
 ds_read_b128 a[140:143], v2 offset:3072
 ds_read_b128 a[144:147], v2 offset:4096
 ds_read_b128 a[148:151], v2 offset:5120
 ds_read_b128 a[152:155], v2 offset:6144
 ds_read_b128 a[156:159], v2 offset:7168
 s_mov_b32 s39, 0
 s_add_u32 s39, s39, 0x4000
 s_and_b32 s39, s39, 0x1ffff
 v_mov_b32 v3, v2
 v_add_u32 v2, s39, v1
Lablk_9:
 s_lshl_b32 s43, s33, 3
 s_add_u32 s41, s43, s4
 s_add_u32 s42, s43, 7
 s_sub_u32 s42, s42, s4
 s_mov_b32 s49, 0
 s_waitcnt lgkmcnt(0)
 v_mfma_f32_16x16x32_bf16 v[48:51], a[128:131], a[0:3], 0
 s_cmp_lt_u32 s49, s41
 v_mov_b64 v[176:177], 0
 v_mov_b64 v[178:179], 0
 v_mfma_f32_16x16x32_bf16 v[56:59], a[128:131], a[16:19], 0
 s_cselect_b64 s[68:69], -1, 0
 v_mov_b64 v[180:181], 0
 v_mov_b64 v[182:183], 0
 v_mfma_f32_16x16x32_bf16 v[64:67], a[128:131], a[32:35], 0
 v_mfma_f32_16x16x32_bf16 v[72:75], a[128:131], a[48:51], 0
 s_cmp_le_u32 s49, s41
 v_mov_b64 v[184:185], 0
 v_mov_b64 v[186:187], 0
 v_mfma_f32_16x16x32_bf16 v[48:51], a[136:139], a[4:7], v[48:51]
 v_mfma_f32_16x16x32_bf16 v[56:59], a[136:139], a[20:23], v[56:59]
 s_cselect_b64 s[70:71], -1, 0
 v_mov_b64 v[188:189], 0
 v_mov_b64 v[190:191], 0
 v_mfma_f32_16x16x32_bf16 v[64:67], a[136:139], a[36:39], v[64:67]
 v_mfma_f32_16x16x32_bf16 v[72:75], a[136:139], a[52:55], v[72:75]
 s_cmp_eq_u32 s49, s41
 v_mov_b64 v[192:193], 0
 v_mov_b64 v[194:195], 0
 v_mfma_f32_16x16x32_bf16 v[48:51], a[144:147], a[8:11], v[48:51]
 s_cselect_b64 s[60:61], s[52:53], s[68:69]
 v_mfma_f32_16x16x32_bf16 v[56:59], a[144:147], a[24:27], v[56:59]
 v_mov_b64 v[196:197], 0
 v_mov_b64 v[198:199], 0
 v_mfma_f32_16x16x32_bf16 v[64:67], a[144:147], a[40:43], v[64:67]
 s_cselect_b64 s[62:63], s[54:55], s[68:69]
 v_mfma_f32_16x16x32_bf16 v[72:75], a[144:147], a[56:59], v[72:75]
 v_mov_b64 v[200:201], 0
 v_mov_b64 v[202:203], 0
 v_mfma_f32_16x16x32_bf16 v[48:51], a[152:155], a[12:15], v[48:51]
 s_cselect_b64 s[64:65], s[56:57], s[68:69]
 v_mfma_f32_16x16x32_bf16 v[56:59], a[152:155], a[28:31], v[56:59]
 v_mov_b64 v[204:205], 0
 v_mov_b64 v[206:207], 0
 v_mfma_f32_16x16x32_bf16 v[64:67], a[152:155], a[44:47], v[64:67]
 s_cselect_b64 s[66:67], s[58:59], s[68:69]
 v_mfma_f32_16x16x32_bf16 v[72:75], a[152:155], a[60:63], v[72:75]
 s_nop 4
 v_max3_f32 v12, v48, v49, v50
 v_max3_f32 v13, v56, v57, v58
 v_max3_f32 v14, v64, v65, v66
 v_max3_f32 v15, v72, v73, v74
 v_max_f32 v12, v12, v51
 v_max_f32 v13, v13, v59
 v_max_f32 v14, v14, v67
 v_max_f32 v15, v15, v75
 v_mov_b32 v6, v12
 v_mov_b32 v7, v13
 v_mov_b32 v8, v14
 v_mov_b32 v9, v15
 v_permlane16_swap_b32 v12, v6
 v_permlane16_swap_b32 v13, v7
 v_permlane16_swap_b32 v14, v8
 v_permlane16_swap_b32 v15, v9
 v_max_f32 v12, v12, v6
 v_max_f32 v13, v13, v7
 v_max_f32 v14, v14, v8
 v_max_f32 v15, v15, v9
 v_mov_b32 v6, v12
 v_mov_b32 v7, v13
 v_mov_b32 v8, v14
 v_mov_b32 v9, v15
 v_permlane32_swap_b32 v12, v6
 v_permlane32_swap_b32 v13, v7
 v_permlane32_swap_b32 v14, v8
 v_permlane32_swap_b32 v15, v9
 v_max_f32 v12, v12, v6
 v_max_f32 v13, v13, v7
 v_max_f32 v14, v14, v8
 v_max_f32 v15, v15, v9
 v_sub_f32 v12, 0, v12
 v_sub_f32 v13, 0, v13
 v_sub_f32 v14, 0, v14
 v_sub_f32 v15, 0, v15
 v_cndmask_b32 v80, v4, v12, s[60:61]
 v_cndmask_b32 v81, v4, v12, s[62:63]
 v_cndmask_b32 v82, v4, v12, s[64:65]
 v_cndmask_b32 v83, v4, v12, s[66:67]
 v_cndmask_b32 v84, v4, v12, s[68:69]
 v_cndmask_b32 v85, v4, v12, s[68:69]
 v_cndmask_b32 v86, v4, v12, s[68:69]
 v_cndmask_b32 v87, v4, v12, s[68:69]
 v_cndmask_b32 v88, v4, v13, s[70:71]
 v_cndmask_b32 v89, v4, v13, s[70:71]
 v_cndmask_b32 v90, v4, v13, s[70:71]
 v_cndmask_b32 v91, v4, v13, s[70:71]
 v_cndmask_b32 v92, v4, v13, s[60:61]
 v_cndmask_b32 v93, v4, v13, s[62:63]
 v_cndmask_b32 v94, v4, v13, s[64:65]
 v_cndmask_b32 v95, v4, v13, s[66:67]
 v_mov_b32 v96, v14
 v_mov_b32 v97, v14
 v_mov_b32 v98, v14
 v_mov_b32 v99, v14
 v_mov_b32 v100, v14
 v_mov_b32 v101, v14
 v_mov_b32 v102, v14
 v_mov_b32 v103, v14
 v_mov_b32 v104, v15
 v_mov_b32 v105, v15
 v_mov_b32 v106, v15
 v_mov_b32 v107, v15
 v_mov_b32 v108, v15
 v_mov_b32 v109, v15
 v_mov_b32 v110, v15
 v_mov_b32 v111, v15
 s_waitcnt lgkmcnt(0)
 v_mfma_f32_16x16x32_bf16 v[48:51], a[128:131], a[0:3], v[80:83]
 ds_read_b128 a[160:163], v3 offset:8192
 v_mov_b64 v[208:209], 0
 v_mov_b64 v[210:211], 0
 v_mfma_f32_16x16x32_bf16 v[56:59], a[128:131], a[16:19], v[88:91]
 v_mov_b64 v[212:213], 0
 v_mov_b64 v[214:215], 0
 v_mfma_f32_16x16x32_bf16 v[52:55], a[132:135], a[0:3], v[84:87]
 ds_read_b128 a[164:167], v3 offset:9216
 v_mfma_f32_16x16x32_bf16 v[60:63], a[132:135], a[16:19], v[92:95]
 v_mov_b64 v[216:217], 0
 v_mov_b64 v[218:219], 0
 v_mfma_f32_16x16x32_bf16 v[48:51], a[136:139], a[4:7], v[48:51]
 ds_read_b128 a[168:171], v3 offset:10240
 v_mov_b64 v[220:221], 0
 v_mov_b64 v[222:223], 0
 v_mfma_f32_16x16x32_bf16 v[56:59], a[136:139], a[20:23], v[56:59]
 v_mfma_f32_16x16x32_bf16 v[52:55], a[140:143], a[4:7], v[52:55]
 ds_read_b128 a[172:175], v3 offset:11264
 v_mov_b64 v[224:225], 0
 v_mov_b64 v[226:227], 0
 v_mfma_f32_16x16x32_bf16 v[60:63], a[140:143], a[20:23], v[60:63]
 v_mov_b64 v[228:229], 0
 v_mov_b64 v[230:231], 0
 v_mfma_f32_16x16x32_bf16 v[48:51], a[144:147], a[8:11], v[48:51]
 ds_read_b128 a[176:179], v3 offset:12288
 v_mfma_f32_16x16x32_bf16 v[56:59], a[144:147], a[24:27], v[56:59]
 v_mov_b64 v[232:233], 0
 v_mov_b64 v[234:235], 0
 v_mfma_f32_16x16x32_bf16 v[52:55], a[148:151], a[8:11], v[52:55]
 ds_read_b128 a[180:183], v3 offset:13312
 v_mov_b64 v[236:237], 0
 v_mov_b64 v[238:239], 0
 v_mfma_f32_16x16x32_bf16 v[60:63], a[148:151], a[24:27], v[60:63]
 v_mfma_f32_16x16x32_bf16 v[48:51], a[152:155], a[12:15], v[48:51]
 ds_read_b128 a[184:187], v3 offset:14336
 v_mov_b64 v[40:41], 0
 v_mov_b64 v[42:43], 0
 v_mfma_f32_16x16x32_bf16 v[56:59], a[152:155], a[28:31], v[56:59]
 v_mov_b64 v[44:45], 0
 v_mov_b64 v[46:47], 0
 v_mfma_f32_16x16x32_bf16 v[52:55], a[156:159], a[12:15], v[52:55]
 ds_read_b128 a[188:191], v3 offset:15360
 v_mfma_f32_16x16x32_bf16 v[60:63], a[156:159], a[28:31], v[60:63]
 v_mfma_f32_16x16x32_bf16 v[64:67], a[128:131], a[32:35], v[96:99]
 s_waitcnt vmcnt(4)
 s_barrier
 v_mfma_f32_16x16x32_bf16 v[72:75], a[128:131], a[48:51], v[104:107]
 ds_read_b128 a[128:131], v2 offset:0
 v_mfma_f32_16x16x32_bf16 v[68:71], a[132:135], a[32:35], v[100:103]
 s_add_u32 s49, s49, 1
 v_mfma_f32_16x16x32_bf16 v[76:79], a[132:135], a[48:51], v[108:111]
 ds_read_b128 a[132:135], v2 offset:1024
 v_exp_f32 v48, v48
 v_exp_f32 v49, v49
 v_mfma_f32_16x16x32_bf16 v[64:67], a[136:139], a[36:39], v[64:67]
 s_cmp_lt_u32 s49, s41
 v_exp_f32 v52, v52
 v_exp_f32 v53, v53
 v_mfma_f32_16x16x32_bf16 v[72:75], a[136:139], a[52:55], v[72:75]
 ds_read_b128 a[136:139], v2 offset:2048
 v_exp_f32 v50, v50
 v_mfma_f32_16x16x32_bf16 v[68:71], a[140:143], a[36:39], v[68:71]
 s_cselect_b64 s[68:69], -1, 0
 v_cvt_pk_bf16_f32 v16, v48, v49
 v_cvt_pk_bf16_f32 v17, v52, v53
 v_exp_f32 v51, v51
 v_mfma_f32_16x16x32_bf16 v[76:79], a[140:143], a[52:55], v[76:79]
 ds_read_b128 a[140:143], v2 offset:3072
 v_exp_f32 v54, v54
 v_exp_f32 v55, v55
 v_mfma_f32_16x16x32_bf16 v[64:67], a[144:147], a[40:43], v[64:67]
 v_cvt_pk_bf16_f32 v18, v50, v51
 v_cvt_pk_bf16_f32 v19, v54, v55
 v_mfma_f32_16x16x32_bf16 v[72:75], a[144:147], a[56:59], v[72:75]
 ds_read_b128 a[144:147], v2 offset:4096
 v_exp_f32 v56, v56
 v_exp_f32 v57, v57
 v_mfma_f32_16x16x32_bf16 v[68:71], a[148:151], a[40:43], v[68:71]
 s_cmp_le_u32 s49, s41
 v_exp_f32 v60, v60
 v_exp_f32 v61, v61
 v_mfma_f32_16x16x32_bf16 v[76:79], a[148:151], a[56:59], v[76:79]
 ds_read_b128 a[148:151], v2 offset:5120
 v_exp_f32 v58, v58
 v_mfma_f32_16x16x32_bf16 v[64:67], a[152:155], a[44:47], v[64:67]
 s_cselect_b64 s[70:71], -1, 0
 v_cvt_pk_bf16_f32 v20, v56, v57
 v_cvt_pk_bf16_f32 v21, v60, v61
 v_exp_f32 v59, v59
 v_mfma_f32_16x16x32_bf16 v[72:75], a[152:155], a[60:63], v[72:75]
 ds_read_b128 a[152:155], v2 offset:6144
 v_exp_f32 v62, v62
 v_exp_f32 v63, v63
 v_mfma_f32_16x16x32_bf16 v[68:71], a[156:159], a[44:47], v[68:71]
 v_cvt_pk_bf16_f32 v22, v58, v59
 v_cvt_pk_bf16_f32 v23, v62, v63
 v_mfma_f32_16x16x32_bf16 v[76:79], a[156:159], a[60:63], v[76:79]
 ds_read_b128 a[156:159], v2 offset:7168
 s_waitcnt lgkmcnt(8)
 v_mfma_f32_16x16x32_bf16 v[112:115], a[160:163], v[16:19], 0
 s_add_u32 s39, s39, 0x4000
 s_and_b32 s39, s39, 0x1ffff
 v_mfma_f32_16x16x32_bf16 v[144:147], a[160:163], v[20:23], 0
 s_cmp_eq_u32 s49, s41
 v_mfma_f32_16x16x32_bf16 v[116:119], a[164:167], v[16:19], 0
 s_cselect_b64 s[60:61], s[52:53], s[68:69]
 v_mfma_f32_16x16x32_bf16 v[148:151], a[164:167], v[20:23], 0
 s_cselect_b64 s[62:63], s[54:55], s[68:69]
 v_mov_b32 v3, v2
 v_add_u32 v2, s39, v1
 v_exp_f32 v64, v64
 v_mfma_f32_16x16x32_bf16 v[120:123], a[168:171], v[16:19], 0
 s_cselect_b64 s[64:65], s[56:57], s[68:69]
 v_exp_f32 v65, v65
 v_mfma_f32_16x16x32_bf16 v[152:155], a[168:171], v[20:23], 0
 s_cselect_b64 s[66:67], s[58:59], s[68:69]
 v_exp_f32 v68, v68
 v_mfma_f32_16x16x32_bf16 v[124:127], a[172:175], v[16:19], 0
 s_lshl_b32 s37, s35, 19
 v_exp_f32 v69, v69
 v_exp_f32 v66, v66
 v_mfma_f32_16x16x32_bf16 v[156:159], a[172:175], v[20:23], 0
 s_add_u32 m0, s38, s50
 v_cvt_pk_bf16_f32 v24, v64, v65
 v_cvt_pk_bf16_f32 v25, v68, v69
 v_mfma_f32_16x16x32_bf16 v[128:131], a[176:179], v[16:19], 0
 s_add_u32 s37, s37, s45
 v_exp_f32 v67, v67
 v_mfma_f32_16x16x32_bf16 v[160:163], a[176:179], v[20:23], 0
 buffer_load_dwordx4 v1, s[20:23], s37 offen offset:0 sc1 lds
 buffer_load_dwordx4 v1, s[20:23], s37 offen offset:1024 sc1 lds
 v_exp_f32 v70, v70
 v_mfma_f32_16x16x32_bf16 v[132:135], a[180:183], v[16:19], 0
 buffer_load_dwordx4 v1, s[20:23], s37 offen offset:2048 sc1 lds
 v_exp_f32 v71, v71
 v_cvt_pk_bf16_f32 v26, v66, v67
 v_cvt_pk_bf16_f32 v27, v70, v71
 v_mfma_f32_16x16x32_bf16 v[164:167], a[180:183], v[20:23], 0
 buffer_load_dwordx4 v1, s[20:23], s37 offen offset:3072 sc1 lds
 v_cndmask_b32 v80, v4, v12, s[60:61]
 v_cndmask_b32 v81, v4, v12, s[62:63]
 v_mfma_f32_16x16x32_bf16 v[136:139], a[184:187], v[16:19], 0
 s_add_u32 s38, s38, 0x4000
 v_cndmask_b32 v82, v4, v12, s[64:65]
 v_cndmask_b32 v83, v4, v12, s[66:67]
 v_mfma_f32_16x16x32_bf16 v[168:171], a[184:187], v[20:23], 0
 s_and_b32 s38, s38, 0x1ffff
 v_cndmask_b32 v84, v4, v12, s[68:69]
 v_cndmask_b32 v85, v4, v12, s[68:69]
 v_mfma_f32_16x16x32_bf16 v[140:143], a[188:191], v[16:19], 0
 s_add_u32 s35, s35, 1
 v_cndmask_b32 v86, v4, v12, s[68:69]
 v_cndmask_b32 v87, v4, v12, s[68:69]
 v_cndmask_b32 v88, v4, v13, s[70:71]
 v_cndmask_b32 v89, v4, v13, s[70:71]
 v_mfma_f32_16x16x32_bf16 v[172:175], a[188:191], v[20:23], 0
 s_cmp_eq_u32 s35, s36
 v_cndmask_b32 v90, v4, v13, s[70:71]
 v_cndmask_b32 v91, v4, v13, s[70:71]
 v_mfma_f32_16x16x32_bf16 v[32:35], a[192:195], v[16:19], 0
 s_cselect_b32 s36, s47, s36
 v_cndmask_b32 v92, v4, v13, s[60:61]
 v_cndmask_b32 v93, v4, v13, s[62:63]
 v_mfma_f32_16x16x32_bf16 v[36:39], a[192:195], v[20:23], 0
 s_cselect_b32 s35, 0, s35
 v_cndmask_b32 v94, v4, v13, s[64:65]
 v_cndmask_b32 v95, v4, v13, s[66:67]
 s_cmp_eq_u32 s43, 0
 s_cbranch_scc1 Lamk_14
 s_sub_u32 s40, s43, 1
 .p2align 3
Lapl_13:
 s_waitcnt lgkmcnt(0)
 v_mfma_f32_16x16x32_bf16 v[48:51], a[128:131], a[0:3], v[80:83]
 v_exp_f32 v72, v72
 v_mfma_f32_16x16x32_bf16 v[56:59], a[128:131], a[16:19], v[88:91]
 v_exp_f32 v73, v73
 v_mfma_f32_16x16x32_bf16 v[52:55], a[132:135], a[0:3], v[84:87]
 v_mfma_f32_16x16x32_bf16 v[60:63], a[132:135], a[16:19], v[92:95]
 v_exp_f32 v76, v76
 v_mfma_f32_16x16x32_bf16 v[48:51], a[136:139], a[4:7], v[48:51]
 v_exp_f32 v77, v77
 v_mfma_f32_16x16x32_bf16 v[56:59], a[136:139], a[20:23], v[56:59]
 v_mfma_f32_16x16x32_bf16 v[52:55], a[140:143], a[4:7], v[52:55]
 v_exp_f32 v74, v74
 v_mfma_f32_16x16x32_bf16 v[60:63], a[140:143], a[20:23], v[60:63]
 v_cvt_pk_bf16_f32 v28, v72, v73
 v_cvt_pk_bf16_f32 v29, v76, v77
 v_mfma_f32_16x16x32_bf16 v[48:51], a[144:147], a[8:11], v[48:51]
 v_mfma_f32_16x16x32_bf16 v[56:59], a[144:147], a[24:27], v[56:59]
 v_exp_f32 v75, v75
 v_mfma_f32_16x16x32_bf16 v[52:55], a[148:151], a[8:11], v[52:55]
 v_exp_f32 v78, v78
 v_mfma_f32_16x16x32_bf16 v[60:63], a[148:151], a[24:27], v[60:63]
 v_mfma_f32_16x16x32_bf16 v[48:51], a[152:155], a[12:15], v[48:51]
 v_exp_f32 v79, v79
 v_mfma_f32_16x16x32_bf16 v[56:59], a[152:155], a[28:31], v[56:59]
 v_cvt_pk_bf16_f32 v30, v74, v75
 v_cvt_pk_bf16_f32 v31, v78, v79
 v_mfma_f32_16x16x32_bf16 v[52:55], a[156:159], a[12:15], v[52:55]
 v_mfma_f32_16x16x32_bf16 v[60:63], a[156:159], a[28:31], v[60:63]
 v_mfma_f32_16x16x32_bf16 v[176:179], a[160:163], v[24:27], v[176:179]
 v_mfma_f32_16x16x32_bf16 v[208:211], a[160:163], v[28:31], v[208:211]
 ds_read_b128 a[160:163], v3 offset:8192
 v_mfma_f32_16x16x32_bf16 v[180:183], a[164:167], v[24:27], v[180:183]
 v_mfma_f32_16x16x32_bf16 v[212:215], a[164:167], v[28:31], v[212:215]
 ds_read_b128 a[164:167], v3 offset:9216
 v_exp_f32 v48, v48
 v_mfma_f32_16x16x32_bf16 v[184:187], a[168:171], v[24:27], v[184:187]
 v_exp_f32 v49, v49
 v_mfma_f32_16x16x32_bf16 v[216:219], a[168:171], v[28:31], v[216:219]
 ds_read_b128 a[168:171], v3 offset:10240
 v_exp_f32 v52, v52
 v_mfma_f32_16x16x32_bf16 v[188:191], a[172:175], v[24:27], v[188:191]
 v_mfma_f32_16x16x32_bf16 v[220:223], a[172:175], v[28:31], v[220:223]
 ds_read_b128 a[172:175], v3 offset:11264
 v_exp_f32 v53, v53
 v_mfma_f32_16x16x32_bf16 v[192:195], a[176:179], v[24:27], v[192:195]
 v_exp_f32 v50, v50
 v_mfma_f32_16x16x32_bf16 v[224:227], a[176:179], v[28:31], v[224:227]
 ds_read_b128 a[176:179], v3 offset:12288
 v_mfma_f32_16x16x32_bf16 v[196:199], a[180:183], v[24:27], v[196:199]
 v_cvt_pk_bf16_f32 v16, v48, v49
 v_cvt_pk_bf16_f32 v17, v52, v53
 v_mfma_f32_16x16x32_bf16 v[228:231], a[180:183], v[28:31], v[228:231]
 ds_read_b128 a[180:183], v3 offset:13312
 v_exp_f32 v51, v51
 v_mfma_f32_16x16x32_bf16 v[200:203], a[184:187], v[24:27], v[200:203]
 v_exp_f32 v54, v54
 v_mfma_f32_16x16x32_bf16 v[232:235], a[184:187], v[28:31], v[232:235]
 ds_read_b128 a[184:187], v3 offset:14336
 v_mfma_f32_16x16x32_bf16 v[204:207], a[188:191], v[24:27], v[204:207]
 v_exp_f32 v55, v55
 v_mfma_f32_16x16x32_bf16 v[236:239], a[188:191], v[28:31], v[236:239]
 ds_read_b128 a[188:191], v3 offset:15360
 v_cvt_pk_bf16_f32 v18, v50, v51
 v_cvt_pk_bf16_f32 v19, v54, v55
 v_mfma_f32_16x16x32_bf16 v[40:43], a[192:195], v[24:27], v[40:43]
 v_mfma_f32_16x16x32_bf16 v[44:47], a[192:195], v[28:31], v[44:47]
 v_mfma_f32_16x16x32_bf16 v[64:67], a[128:131], a[32:35], v[96:99]
 s_waitcnt vmcnt(4)
 s_barrier
 v_exp_f32 v56, v56
 v_mfma_f32_16x16x32_bf16 v[72:75], a[128:131], a[48:51], v[104:107]
 ds_read_b128 a[128:131], v2 offset:0
 v_exp_f32 v57, v57
 v_mfma_f32_16x16x32_bf16 v[68:71], a[132:135], a[32:35], v[100:103]
 s_add_u32 s39, s39, 0x4000
 v_mfma_f32_16x16x32_bf16 v[76:79], a[132:135], a[48:51], v[108:111]
 ds_read_b128 a[132:135], v2 offset:1024
 v_exp_f32 v60, v60
 v_mfma_f32_16x16x32_bf16 v[64:67], a[136:139], a[36:39], v[64:67]
 v_exp_f32 v61, v61
 v_mfma_f32_16x16x32_bf16 v[72:75], a[136:139], a[52:55], v[72:75]
 ds_read_b128 a[136:139], v2 offset:2048
 v_mfma_f32_16x16x32_bf16 v[68:71], a[140:143], a[36:39], v[68:71]
 v_exp_f32 v58, v58
 v_mfma_f32_16x16x32_bf16 v[76:79], a[140:143], a[52:55], v[76:79]
 ds_read_b128 a[140:143], v2 offset:3072
 v_cvt_pk_bf16_f32 v20, v56, v57
 v_cvt_pk_bf16_f32 v21, v60, v61
 v_mfma_f32_16x16x32_bf16 v[64:67], a[144:147], a[40:43], v[64:67]
 s_and_b32 s39, s39, 0x1ffff
 v_mfma_f32_16x16x32_bf16 v[72:75], a[144:147], a[56:59], v[72:75]
 ds_read_b128 a[144:147], v2 offset:4096
 v_exp_f32 v59, v59
 v_mfma_f32_16x16x32_bf16 v[68:71], a[148:151], a[40:43], v[68:71]
 v_exp_f32 v62, v62
 v_mfma_f32_16x16x32_bf16 v[76:79], a[148:151], a[56:59], v[76:79]
 ds_read_b128 a[148:151], v2 offset:5120
 v_mfma_f32_16x16x32_bf16 v[64:67], a[152:155], a[44:47], v[64:67]
 v_exp_f32 v63, v63
 v_mfma_f32_16x16x32_bf16 v[72:75], a[152:155], a[60:63], v[72:75]
 ds_read_b128 a[152:155], v2 offset:6144
 v_cvt_pk_bf16_f32 v22, v58, v59
 v_cvt_pk_bf16_f32 v23, v62, v63
 v_mfma_f32_16x16x32_bf16 v[68:71], a[156:159], a[44:47], v[68:71]
 v_mfma_f32_16x16x32_bf16 v[76:79], a[156:159], a[60:63], v[76:79]
 ds_read_b128 a[156:159], v2 offset:7168
 s_waitcnt lgkmcnt(8)
 v_mfma_f32_16x16x32_bf16 v[112:115], a[160:163], v[16:19], v[112:115]
 s_lshl_b32 s37, s35, 19
 v_mov_b32 v3, v2
 v_add_u32 v2, s39, v1
 v_mfma_f32_16x16x32_bf16 v[144:147], a[160:163], v[20:23], v[144:147]
 s_add_u32 m0, s38, s50
 v_mfma_f32_16x16x32_bf16 v[116:119], a[164:167], v[16:19], v[116:119]
 s_add_u32 s37, s37, s45
 v_mfma_f32_16x16x32_bf16 v[148:151], a[164:167], v[20:23], v[148:151]
 buffer_load_dwordx4 v1, s[20:23], s37 offen offset:0 sc1 lds
 v_exp_f32 v64, v64
 v_mfma_f32_16x16x32_bf16 v[120:123], a[168:171], v[16:19], v[120:123]
 buffer_load_dwordx4 v1, s[20:23], s37 offen offset:1024 sc1 lds
 v_mfma_f32_16x16x32_bf16 v[152:155], a[168:171], v[20:23], v[152:155]
 v_exp_f32 v65, v65
 v_mfma_f32_16x16x32_bf16 v[124:127], a[172:175], v[16:19], v[124:127]
 buffer_load_dwordx4 v1, s[20:23], s37 offen offset:2048 sc1 lds
 v_exp_f32 v68, v68
 v_mfma_f32_16x16x32_bf16 v[156:159], a[172:175], v[20:23], v[156:159]
 buffer_load_dwordx4 v1, s[20:23], s37 offen offset:3072 sc1 lds
 v_exp_f32 v69, v69
 v_mfma_f32_16x16x32_bf16 v[128:131], a[176:179], v[16:19], v[128:131]
 s_add_u32 s38, s38, 0x4000
 v_mfma_f32_16x16x32_bf16 v[160:163], a[176:179], v[20:23], v[160:163]
 s_and_b32 s38, s38, 0x1ffff
 v_exp_f32 v66, v66
 v_mfma_f32_16x16x32_bf16 v[132:135], a[180:183], v[16:19], v[132:135]
 s_add_u32 s35, s35, 1
 v_cvt_pk_bf16_f32 v24, v64, v65
 v_cvt_pk_bf16_f32 v25, v68, v69
 v_mfma_f32_16x16x32_bf16 v[164:167], a[180:183], v[20:23], v[164:167]
 v_exp_f32 v67, v67
 v_mfma_f32_16x16x32_bf16 v[136:139], a[184:187], v[16:19], v[136:139]
 s_cmp_eq_u32 s35, s36
 v_mfma_f32_16x16x32_bf16 v[168:171], a[184:187], v[20:23], v[168:171]
 s_cselect_b32 s36, s47, s36
 v_exp_f32 v70, v70
 v_mfma_f32_16x16x32_bf16 v[140:143], a[188:191], v[16:19], v[140:143]
 s_cselect_b32 s35, 0, s35
 v_exp_f32 v71, v71
 v_mfma_f32_16x16x32_bf16 v[172:175], a[188:191], v[20:23], v[172:175]
 s_add_u32 s49, s49, 1
 v_cvt_pk_bf16_f32 v26, v66, v67
 v_cvt_pk_bf16_f32 v27, v70, v71
 v_mfma_f32_16x16x32_bf16 v[32:35], a[192:195], v[16:19], v[32:35]
 s_cmp_lt_u32 s49, s40
 v_mfma_f32_16x16x32_bf16 v[36:39], a[192:195], v[20:23], v[36:39]
 s_cbranch_scc1 Lapl_13
Lamk_14:
 s_add_u32 s40, s43, 4
 .p2align 3
Lamk_16:
 s_waitcnt lgkmcnt(0)
 v_mfma_f32_16x16x32_bf16 v[48:51], a[128:131], a[0:3], v[80:83]
 s_add_u32 s49, s49, 1
 v_exp_f32 v72, v72
 v_mfma_f32_16x16x32_bf16 v[56:59], a[128:131], a[16:19], v[88:91]
 s_cmp_lt_u32 s49, s41
 v_exp_f32 v73, v73
 v_mfma_f32_16x16x32_bf16 v[52:55], a[132:135], a[0:3], v[84:87]
 v_mfma_f32_16x16x32_bf16 v[60:63], a[132:135], a[16:19], v[92:95]
 s_cselect_b64 s[68:69], -1, 0
 v_exp_f32 v76, v76
 v_mfma_f32_16x16x32_bf16 v[48:51], a[136:139], a[4:7], v[48:51]
 s_cmp_le_u32 s49, s41
 v_exp_f32 v77, v77
 v_mfma_f32_16x16x32_bf16 v[56:59], a[136:139], a[20:23], v[56:59]
 v_mfma_f32_16x16x32_bf16 v[52:55], a[140:143], a[4:7], v[52:55]
 s_cselect_b64 s[70:71], -1, 0
 v_exp_f32 v74, v74
 v_mfma_f32_16x16x32_bf16 v[60:63], a[140:143], a[20:23], v[60:63]
 v_cvt_pk_bf16_f32 v28, v72, v73
 v_cvt_pk_bf16_f32 v29, v76, v77
 v_mfma_f32_16x16x32_bf16 v[48:51], a[144:147], a[8:11], v[48:51]
 s_cmp_eq_u32 s49, s41
 v_mfma_f32_16x16x32_bf16 v[56:59], a[144:147], a[24:27], v[56:59]
 s_cselect_b64 s[60:61], s[52:53], s[68:69]
 v_exp_f32 v75, v75
 v_mfma_f32_16x16x32_bf16 v[52:55], a[148:151], a[8:11], v[52:55]
 v_exp_f32 v78, v78
 v_mfma_f32_16x16x32_bf16 v[60:63], a[148:151], a[24:27], v[60:63]
 s_cselect_b64 s[62:63], s[54:55], s[68:69]
 v_mfma_f32_16x16x32_bf16 v[48:51], a[152:155], a[12:15], v[48:51]
 s_cselect_b64 s[64:65], s[56:57], s[68:69]
 v_exp_f32 v79, v79
 v_mfma_f32_16x16x32_bf16 v[56:59], a[152:155], a[28:31], v[56:59]
 v_cvt_pk_bf16_f32 v30, v74, v75
 v_cvt_pk_bf16_f32 v31, v78, v79
 v_mfma_f32_16x16x32_bf16 v[52:55], a[156:159], a[12:15], v[52:55]
 s_cselect_b64 s[66:67], s[58:59], s[68:69]
 v_mfma_f32_16x16x32_bf16 v[60:63], a[156:159], a[28:31], v[60:63]
 v_mfma_f32_16x16x32_bf16 v[176:179], a[160:163], v[24:27], v[176:179]
 v_mfma_f32_16x16x32_bf16 v[208:211], a[160:163], v[28:31], v[208:211]
 ds_read_b128 a[160:163], v3 offset:8192
 v_mfma_f32_16x16x32_bf16 v[180:183], a[164:167], v[24:27], v[180:183]
 v_mfma_f32_16x16x32_bf16 v[212:215], a[164:167], v[28:31], v[212:215]
 ds_read_b128 a[164:167], v3 offset:9216
 v_exp_f32 v48, v48
 v_mfma_f32_16x16x32_bf16 v[184:187], a[168:171], v[24:27], v[184:187]
 v_exp_f32 v49, v49
 v_mfma_f32_16x16x32_bf16 v[216:219], a[168:171], v[28:31], v[216:219]
 ds_read_b128 a[168:171], v3 offset:10240
 v_exp_f32 v52, v52
 v_mfma_f32_16x16x32_bf16 v[188:191], a[172:175], v[24:27], v[188:191]
 v_exp_f32 v53, v53
 v_mfma_f32_16x16x32_bf16 v[220:223], a[172:175], v[28:31], v[220:223]
 ds_read_b128 a[172:175], v3 offset:11264
 v_exp_f32 v50, v50
 v_mfma_f32_16x16x32_bf16 v[192:195], a[176:179], v[24:27], v[192:195]
 v_cvt_pk_bf16_f32 v16, v48, v49
 v_cvt_pk_bf16_f32 v17, v52, v53
 v_mfma_f32_16x16x32_bf16 v[224:227], a[176:179], v[28:31], v[224:227]
 ds_read_b128 a[176:179], v3 offset:12288
 v_exp_f32 v51, v51
 v_mfma_f32_16x16x32_bf16 v[196:199], a[180:183], v[24:27], v[196:199]
 v_exp_f32 v54, v54
 v_mfma_f32_16x16x32_bf16 v[228:231], a[180:183], v[28:31], v[228:231]
 ds_read_b128 a[180:183], v3 offset:13312
 v_exp_f32 v55, v55
 v_mfma_f32_16x16x32_bf16 v[200:203], a[184:187], v[24:27], v[200:203]
 v_cvt_pk_bf16_f32 v18, v50, v51
 v_cvt_pk_bf16_f32 v19, v54, v55
 v_mfma_f32_16x16x32_bf16 v[232:235], a[184:187], v[28:31], v[232:235]
 ds_read_b128 a[184:187], v3 offset:14336
 v_cndmask_b32 v80, v4, v12, s[60:61]
 v_cndmask_b32 v81, v4, v12, s[62:63]
 v_mfma_f32_16x16x32_bf16 v[204:207], a[188:191], v[24:27], v[204:207]
 v_cndmask_b32 v82, v4, v12, s[64:65]
 v_cndmask_b32 v83, v4, v12, s[66:67]
 v_mfma_f32_16x16x32_bf16 v[236:239], a[188:191], v[28:31], v[236:239]
 ds_read_b128 a[188:191], v3 offset:15360
 v_cndmask_b32 v84, v4, v12, s[68:69]
 v_cndmask_b32 v85, v4, v12, s[68:69]
 v_mfma_f32_16x16x32_bf16 v[40:43], a[192:195], v[24:27], v[40:43]
 v_cndmask_b32 v86, v4, v12, s[68:69]
 v_cndmask_b32 v87, v4, v12, s[68:69]
 v_mfma_f32_16x16x32_bf16 v[44:47], a[192:195], v[28:31], v[44:47]
 v_mfma_f32_16x16x32_bf16 v[64:67], a[128:131], a[32:35], v[96:99]
 s_waitcnt vmcnt(4)
 s_barrier
 v_exp_f32 v56, v56
 v_mfma_f32_16x16x32_bf16 v[72:75], a[128:131], a[48:51], v[104:107]
 ds_read_b128 a[128:131], v2 offset:0
 v_exp_f32 v57, v57
 v_mfma_f32_16x16x32_bf16 v[68:71], a[132:135], a[32:35], v[100:103]
 s_add_u32 s39, s39, 0x4000
 v_exp_f32 v60, v60
 v_mfma_f32_16x16x32_bf16 v[76:79], a[132:135], a[48:51], v[108:111]
 ds_read_b128 a[132:135], v2 offset:1024
 v_exp_f32 v61, v61
 v_mfma_f32_16x16x32_bf16 v[64:67], a[136:139], a[36:39], v[64:67]
 v_exp_f32 v58, v58
 v_mfma_f32_16x16x32_bf16 v[72:75], a[136:139], a[52:55], v[72:75]
 ds_read_b128 a[136:139], v2 offset:2048
 v_cvt_pk_bf16_f32 v20, v56, v57
 v_cvt_pk_bf16_f32 v21, v60, v61
 v_mfma_f32_16x16x32_bf16 v[68:71], a[140:143], a[36:39], v[68:71]
 v_exp_f32 v59, v59
 v_mfma_f32_16x16x32_bf16 v[76:79], a[140:143], a[52:55], v[76:79]
 ds_read_b128 a[140:143], v2 offset:3072
 v_exp_f32 v62, v62
 v_mfma_f32_16x16x32_bf16 v[64:67], a[144:147], a[40:43], v[64:67]
 s_and_b32 s39, s39, 0x1ffff
 v_exp_f32 v63, v63
 v_mfma_f32_16x16x32_bf16 v[72:75], a[144:147], a[56:59], v[72:75]
 ds_read_b128 a[144:147], v2 offset:4096
 v_cvt_pk_bf16_f32 v22, v58, v59
 v_cvt_pk_bf16_f32 v23, v62, v63
 v_mfma_f32_16x16x32_bf16 v[68:71], a[148:151], a[40:43], v[68:71]
 v_cndmask_b32 v88, v4, v13, s[70:71]
 v_cndmask_b32 v89, v4, v13, s[70:71]
 v_mfma_f32_16x16x32_bf16 v[76:79], a[148:151], a[56:59], v[76:79]
 ds_read_b128 a[148:151], v2 offset:5120
 v_cndmask_b32 v90, v4, v13, s[70:71]
 v_cndmask_b32 v91, v4, v13, s[70:71]
 v_mfma_f32_16x16x32_bf16 v[64:67], a[152:155], a[44:47], v[64:67]
 v_cndmask_b32 v92, v4, v13, s[60:61]
 v_cndmask_b32 v93, v4, v13, s[62:63]
 v_mfma_f32_16x16x32_bf16 v[72:75], a[152:155], a[60:63], v[72:75]
 ds_read_b128 a[152:155], v2 offset:6144
 v_cndmask_b32 v94, v4, v13, s[64:65]
 v_cndmask_b32 v95, v4, v13, s[66:67]
 v_mfma_f32_16x16x32_bf16 v[68:71], a[156:159], a[44:47], v[68:71]
 v_mfma_f32_16x16x32_bf16 v[76:79], a[156:159], a[60:63], v[76:79]
 ds_read_b128 a[156:159], v2 offset:7168
 s_waitcnt lgkmcnt(8)
 v_mfma_f32_16x16x32_bf16 v[112:115], a[160:163], v[16:19], v[112:115]
 s_lshl_b32 s37, s35, 19
 v_mov_b32 v3, v2
 v_add_u32 v2, s39, v1
 v_mfma_f32_16x16x32_bf16 v[144:147], a[160:163], v[20:23], v[144:147]
 s_add_u32 m0, s38, s50
 v_mfma_f32_16x16x32_bf16 v[116:119], a[164:167], v[16:19], v[116:119]
 s_add_u32 s37, s37, s45
 v_mfma_f32_16x16x32_bf16 v[148:151], a[164:167], v[20:23], v[148:151]
 buffer_load_dwordx4 v1, s[20:23], s37 offen offset:0 sc1 lds
 v_exp_f32 v64, v64
 v_mfma_f32_16x16x32_bf16 v[120:123], a[168:171], v[16:19], v[120:123]
 v_mfma_f32_16x16x32_bf16 v[152:155], a[168:171], v[20:23], v[152:155]
 buffer_load_dwordx4 v1, s[20:23], s37 offen offset:1024 sc1 lds
 v_exp_f32 v65, v65
 v_mfma_f32_16x16x32_bf16 v[124:127], a[172:175], v[16:19], v[124:127]
 buffer_load_dwordx4 v1, s[20:23], s37 offen offset:2048 sc1 lds
 v_exp_f32 v68, v68
 v_mfma_f32_16x16x32_bf16 v[156:159], a[172:175], v[20:23], v[156:159]
 buffer_load_dwordx4 v1, s[20:23], s37 offen offset:3072 sc1 lds
 v_exp_f32 v69, v69
 v_mfma_f32_16x16x32_bf16 v[128:131], a[176:179], v[16:19], v[128:131]
 v_mfma_f32_16x16x32_bf16 v[160:163], a[176:179], v[20:23], v[160:163]
 s_add_u32 s38, s38, 0x4000
 v_exp_f32 v66, v66
 v_mfma_f32_16x16x32_bf16 v[132:135], a[180:183], v[16:19], v[132:135]
 s_and_b32 s38, s38, 0x1ffff
 v_cvt_pk_bf16_f32 v24, v64, v65
 v_cvt_pk_bf16_f32 v25, v68, v69
 v_mfma_f32_16x16x32_bf16 v[164:167], a[180:183], v[20:23], v[164:167]
 s_add_u32 s35, s35, 1
 v_exp_f32 v67, v67
 v_mfma_f32_16x16x32_bf16 v[136:139], a[184:187], v[16:19], v[136:139]
 s_cmp_eq_u32 s35, s36
 v_mfma_f32_16x16x32_bf16 v[168:171], a[184:187], v[20:23], v[168:171]
 v_exp_f32 v70, v70
 v_mfma_f32_16x16x32_bf16 v[140:143], a[188:191], v[16:19], v[140:143]
 s_cselect_b32 s36, s47, s36
 v_exp_f32 v71, v71
 v_mfma_f32_16x16x32_bf16 v[172:175], a[188:191], v[20:23], v[172:175]
 s_cselect_b32 s35, 0, s35
 v_cvt_pk_bf16_f32 v26, v66, v67
 v_cvt_pk_bf16_f32 v27, v70, v71
 v_mfma_f32_16x16x32_bf16 v[32:35], a[192:195], v[16:19], v[32:35]
 s_cmp_lt_u32 s49, s40
 v_mfma_f32_16x16x32_bf16 v[36:39], a[192:195], v[20:23], v[36:39]
 s_cbranch_scc1 Lamk_16
 s_add_u32 s40, s43, 8
 s_cmp_eq_u32 s46, 0
 s_cbranch_scc0 Laq2_17
 v_min_u32 v10, 16, v1
 v_lshlrev_b32 v10, 24, v10
Law_19:
 buffer_load_dwordx4 v[240:243], v10, s[20:23], s94 offen sc1
 s_waitcnt vmcnt(0)
 v_min3_u32 v240, v240, v241, v242
 v_min_u32 v240, v240, v243
 v_cmp_le_u32 vcc, 16, v240
 s_cbranch_vccnz Lawk_20
 s_sleep 2
 s_sub_u32 s95, s95, 1
 s_cbranch_scc0 Law_19
 s_endpgm
Lawk_20:
 s_lshl_b32 s44, s34, 3
 s_add_u32 s44, s44, s4
 s_lshl_b32 s44, s44, 5
 s_add_u32 s44, s44, s32
 s_lshl_b32 s44, s44, 13
 s_add_u32 s44, s44, 0x5000000
 buffer_load_dwordx4 a[64:67], v1, s[20:23], s44 offen offset:0 sc1
 buffer_load_dwordx4 a[80:83], v1, s[20:23], s44 offen offset:1024 sc1
 buffer_load_dwordx4 a[68:71], v1, s[20:23], s44 offen offset:2048 sc1
 buffer_load_dwordx4 a[84:87], v1, s[20:23], s44 offen offset:3072 sc1
 s_add_u32 s44, s44, 4096
 buffer_load_dwordx4 a[72:75], v1, s[20:23], s44 offen offset:0 sc1
 buffer_load_dwordx4 a[88:91], v1, s[20:23], s44 offen offset:1024 sc1
 buffer_load_dwordx4 a[76:79], v1, s[20:23], s44 offen offset:2048 sc1
 buffer_load_dwordx4 a[92:95], v1, s[20:23], s44 offen offset:3072 sc1
 s_lshl_b32 s44, s34, 3
 s_add_u32 s44, s44, 7
 s_sub_u32 s44, s44, s4
 s_lshl_b32 s44, s44, 5
 s_add_u32 s44, s44, s32
 s_lshl_b32 s44, s44, 13
 s_add_u32 s44, s44, 0x5000000
 buffer_load_dwordx4 a[96:99], v1, s[20:23], s44 offen offset:0 sc1
 buffer_load_dwordx4 a[112:115], v1, s[20:23], s44 offen offset:1024 sc1
 buffer_load_dwordx4 a[100:103], v1, s[20:23], s44 offen offset:2048 sc1
 buffer_load_dwordx4 a[116:119], v1, s[20:23], s44 offen offset:3072 sc1
 s_add_u32 s44, s44, 4096
 buffer_load_dwordx4 a[104:107], v1, s[20:23], s44 offen offset:0 sc1
 buffer_load_dwordx4 a[120:123], v1, s[20:23], s44 offen offset:1024 sc1
 buffer_load_dwordx4 a[108:111], v1, s[20:23], s44 offen offset:2048 sc1
 buffer_load_dwordx4 a[124:127], v1, s[20:23], s44 offen offset:3072 sc1
 s_branch Laq2_18
Laq2_17:
 v_mov_b32 v6, 1
 buffer_store_dword v6, v5, s[20:23], s72 offen sc1
Laq2_18:
 s_cmp_lt_u32 s49, s42
 s_cselect_b64 s[68:69], -1, 0
 s_cmp_le_u32 s49, s42
 s_cselect_b64 s[70:71], -1, 0
 s_cmp_eq_u32 s49, s42
 s_cselect_b64 s[60:61], s[52:53], s[68:69]
 s_cselect_b64 s[62:63], s[54:55], s[68:69]
 s_cselect_b64 s[64:65], s[56:57], s[68:69]
 s_cselect_b64 s[66:67], s[58:59], s[68:69]
 v_mfma_f32_16x16x32_bf16 v[176:179], a[160:163], v[24:27], v[176:179]
 v_cndmask_b32 v96, v4, v14, s[60:61]
 v_cndmask_b32 v97, v4, v14, s[62:63]
 v_mfma_f32_16x16x32_bf16 v[180:183], a[164:167], v[24:27], v[180:183]
 v_cndmask_b32 v98, v4, v14, s[64:65]
 v_cndmask_b32 v99, v4, v14, s[66:67]
 v_mfma_f32_16x16x32_bf16 v[184:187], a[168:171], v[24:27], v[184:187]
 v_cndmask_b32 v100, v4, v14, s[68:69]
 v_cndmask_b32 v101, v4, v14, s[68:69]
 v_mfma_f32_16x16x32_bf16 v[188:191], a[172:175], v[24:27], v[188:191]
 v_exp_f32 v72, v72
 v_mfma_f32_16x16x32_bf16 v[192:195], a[176:179], v[24:27], v[192:195]
 v_exp_f32 v73, v73
 v_mfma_f32_16x16x32_bf16 v[196:199], a[180:183], v[24:27], v[196:199]
 v_exp_f32 v76, v76
 v_mfma_f32_16x16x32_bf16 v[200:203], a[184:187], v[24:27], v[200:203]
 v_exp_f32 v77, v77
 v_mfma_f32_16x16x32_bf16 v[204:207], a[188:191], v[24:27], v[204:207]
 v_exp_f32 v74, v74
 v_mfma_f32_16x16x32_bf16 v[40:43], a[192:195], v[24:27], v[40:43]
 v_cndmask_b32 v102, v4, v14, s[68:69]
 v_cndmask_b32 v103, v4, v14, s[68:69]
 s_nop 0
 .p2align 3
Lam1_15:
 s_waitcnt lgkmcnt(0)
 v_mfma_f32_16x16x32_bf16 v[64:67], a[128:131], a[32:35], v[96:99]
 v_cvt_pk_bf16_f32 v28, v72, v73
 v_cvt_pk_bf16_f32 v29, v76, v77
 v_mfma_f32_16x16x32_bf16 v[68:71], a[132:135], a[32:35], v[100:103]
 v_exp_f32 v75, v75
 v_mfma_f32_16x16x32_bf16 v[64:67], a[136:139], a[36:39], v[64:67]
 v_exp_f32 v78, v78
 v_mfma_f32_16x16x32_bf16 v[68:71], a[140:143], a[36:39], v[68:71]
 v_exp_f32 v79, v79
 v_mfma_f32_16x16x32_bf16 v[64:67], a[144:147], a[40:43], v[64:67]
 v_cvt_pk_bf16_f32 v30, v74, v75
 v_cvt_pk_bf16_f32 v31, v78, v79
 v_mfma_f32_16x16x32_bf16 v[68:71], a[148:151], a[40:43], v[68:71]
 v_cndmask_b32 v104, v4, v15, s[70:71]
 v_cndmask_b32 v105, v4, v15, s[70:71]
 v_mfma_f32_16x16x32_bf16 v[64:67], a[152:155], a[44:47], v[64:67]
 v_mfma_f32_16x16x32_bf16 v[68:71], a[156:159], a[44:47], v[68:71]
 v_mfma_f32_16x16x32_bf16 v[208:211], a[160:163], v[28:31], v[208:211]
 ds_read_b128 a[160:163], v3 offset:8192
 v_cndmask_b32 v106, v4, v15, s[70:71]
 v_cndmask_b32 v107, v4, v15, s[70:71]
 v_mfma_f32_16x16x32_bf16 v[212:215], a[164:167], v[28:31], v[212:215]
 ds_read_b128 a[164:167], v3 offset:9216
 v_cndmask_b32 v108, v4, v15, s[60:61]
 v_cndmask_b32 v109, v4, v15, s[62:63]
 v_mfma_f32_16x16x32_bf16 v[216:219], a[168:171], v[28:31], v[216:219]
 ds_read_b128 a[168:171], v3 offset:10240
 v_cndmask_b32 v110, v4, v15, s[64:65]
 v_cndmask_b32 v111, v4, v15, s[66:67]
 v_mfma_f32_16x16x32_bf16 v[220:223], a[172:175], v[28:31], v[220:223]
 ds_read_b128 a[172:175], v3 offset:11264
 v_exp_f32 v64, v64
 v_mfma_f32_16x16x32_bf16 v[224:227], a[176:179], v[28:31], v[224:227]
 ds_read_b128 a[176:179], v3 offset:12288
 v_exp_f32 v65, v65
 v_mfma_f32_16x16x32_bf16 v[228:231], a[180:183], v[28:31], v[228:231]
 ds_read_b128 a[180:183], v3 offset:13312
 v_exp_f32 v68, v68
 v_mfma_f32_16x16x32_bf16 v[232:235], a[184:187], v[28:31], v[232:235]
 ds_read_b128 a[184:187], v3 offset:14336
 v_exp_f32 v69, v69
 v_mfma_f32_16x16x32_bf16 v[236:239], a[188:191], v[28:31], v[236:239]
 ds_read_b128 a[188:191], v3 offset:15360
 v_exp_f32 v66, v66
 v_mfma_f32_16x16x32_bf16 v[44:47], a[192:195], v[28:31], v[44:47]
 v_mfma_f32_16x16x32_bf16 v[72:75], a[128:131], a[48:51], v[104:107]
 s_waitcnt vmcnt(4)
 s_barrier
 ds_read_b128 a[128:131], v2 offset:0
 s_add_u32 s39, s39, 0x4000
 v_cvt_pk_bf16_f32 v24, v64, v65
 v_cvt_pk_bf16_f32 v25, v68, v69
 v_mfma_f32_16x16x32_bf16 v[76:79], a[132:135], a[48:51], v[108:111]
 ds_read_b128 a[132:135], v2 offset:1024
 v_exp_f32 v67, v67
 v_mfma_f32_16x16x32_bf16 v[72:75], a[136:139], a[52:55], v[72:75]
 ds_read_b128 a[136:139], v2 offset:2048
 v_exp_f32 v70, v70
 v_mfma_f32_16x16x32_bf16 v[76:79], a[140:143], a[52:55], v[76:79]
 ds_read_b128 a[140:143], v2 offset:3072
 v_mfma_f32_16x16x32_bf16 v[72:75], a[144:147], a[56:59], v[72:75]
 ds_read_b128 a[144:147], v2 offset:4096
 s_and_b32 s39, s39, 0x1ffff
 v_exp_f32 v71, v71
 v_mfma_f32_16x16x32_bf16 v[76:79], a[148:151], a[56:59], v[76:79]
 ds_read_b128 a[148:151], v2 offset:5120
 v_cvt_pk_bf16_f32 v26, v66, v67
 v_cvt_pk_bf16_f32 v27, v70, v71
 v_mfma_f32_16x16x32_bf16 v[72:75], a[152:155], a[60:63], v[72:75]
 ds_read_b128 a[152:155], v2 offset:6144
 v_mfma_f32_16x16x32_bf16 v[76:79], a[156:159], a[60:63], v[76:79]
 ds_read_b128 a[156:159], v2 offset:7168
 s_waitcnt lgkmcnt(8)
 s_add_u32 s49, s49, 1
 s_cmp_lt_u32 s49, s42
 s_cselect_b64 s[68:69], -1, 0
 s_cmp_le_u32 s49, s42
 s_cselect_b64 s[70:71], -1, 0
 s_cmp_eq_u32 s49, s42
 s_cselect_b64 s[60:61], s[52:53], s[68:69]
 s_cselect_b64 s[62:63], s[54:55], s[68:69]
 s_cselect_b64 s[64:65], s[56:57], s[68:69]
 s_cselect_b64 s[66:67], s[58:59], s[68:69]
 v_mfma_f32_16x16x32_bf16 v[176:179], a[160:163], v[24:27], v[176:179]
 s_lshl_b32 s37, s35, 19
 s_add_u32 m0, s38, s50
 v_mov_b32 v3, v2
 v_add_u32 v2, s39, v1
 v_cndmask_b32 v96, v4, v14, s[60:61]
 v_cndmask_b32 v97, v4, v14, s[62:63]
 v_mfma_f32_16x16x32_bf16 v[180:183], a[164:167], v[24:27], v[180:183]
 s_add_u32 s37, s37, s45
 buffer_load_dwordx4 v1, s[20:23], s37 offen offset:0 sc1 lds
 v_cndmask_b32 v98, v4, v14, s[64:65]
 v_cndmask_b32 v99, v4, v14, s[66:67]
 v_mfma_f32_16x16x32_bf16 v[184:187], a[168:171], v[24:27], v[184:187]
 buffer_load_dwordx4 v1, s[20:23], s37 offen offset:1024 sc1 lds
 v_exp_f32 v72, v72
 v_mfma_f32_16x16x32_bf16 v[188:191], a[172:175], v[24:27], v[188:191]
 buffer_load_dwordx4 v1, s[20:23], s37 offen offset:2048 sc1 lds
 buffer_load_dwordx4 v1, s[20:23], s37 offen offset:3072 sc1 lds
 v_exp_f32 v73, v73
 v_mfma_f32_16x16x32_bf16 v[192:195], a[176:179], v[24:27], v[192:195]
 s_add_u32 s38, s38, 0x4000
 v_exp_f32 v76, v76
 v_mfma_f32_16x16x32_bf16 v[196:199], a[180:183], v[24:27], v[196:199]
 s_and_b32 s38, s38, 0x1ffff
 s_add_u32 s35, s35, 1
 v_exp_f32 v77, v77
 v_mfma_f32_16x16x32_bf16 v[200:203], a[184:187], v[24:27], v[200:203]
 s_cmp_eq_u32 s35, s36
 v_exp_f32 v74, v74
 v_mfma_f32_16x16x32_bf16 v[204:207], a[188:191], v[24:27], v[204:207]
 s_cselect_b32 s36, s47, s36
 s_cselect_b32 s35, 0, s35
 v_cndmask_b32 v100, v4, v14, s[68:69]
 v_cndmask_b32 v101, v4, v14, s[68:69]
 v_mfma_f32_16x16x32_bf16 v[40:43], a[192:195], v[24:27], v[40:43]
 s_cmp_lt_u32 s49, s40
 v_cndmask_b32 v102, v4, v14, s[68:69]
 v_cndmask_b32 v103, v4, v14, s[68:69]
 s_cbranch_scc1 Lam1_15
 v_cvt_pk_bf16_f32 v28, v72, v73
 v_cvt_pk_bf16_f32 v29, v76, v77
 v_exp_f32 v75, v75
 v_exp_f32 v78, v78
 v_exp_f32 v79, v79
 v_cvt_pk_bf16_f32 v30, v74, v75
 v_cvt_pk_bf16_f32 v31, v78, v79
 s_nop 1
 v_mfma_f32_16x16x32_bf16 v[44:47], a[192:195], v[28:31], v[44:47]
 v_mfma_f32_16x16x32_bf16 v[208:211], a[160:163], v[28:31], v[208:211]
 v_mfma_f32_16x16x32_bf16 v[212:215], a[164:167], v[28:31], v[212:215]
 v_mfma_f32_16x16x32_bf16 v[216:219], a[168:171], v[28:31], v[216:219]
 v_mfma_f32_16x16x32_bf16 v[220:223], a[172:175], v[28:31], v[220:223]
 v_mfma_f32_16x16x32_bf16 v[224:227], a[176:179], v[28:31], v[224:227]
 v_mfma_f32_16x16x32_bf16 v[228:231], a[180:183], v[28:31], v[228:231]
 v_mfma_f32_16x16x32_bf16 v[232:235], a[184:187], v[28:31], v[232:235]
 v_mfma_f32_16x16x32_bf16 v[236:239], a[188:191], v[28:31], v[236:239]
 v_cmp_ngt_f32 s[60:61], s73, v32
 v_cmp_nlt_f32 vcc, s74, v32
 s_or_b64 s[60:61], s[60:61], vcc
 v_cmp_ngt_f32 s[62:63], s73, v36
 v_cmp_nlt_f32 vcc, s74, v36
 s_or_b64 s[62:63], s[62:63], vcc
 v_cmp_ngt_f32 s[64:65], s73, v40
 v_cmp_nlt_f32 vcc, s74, v40
 s_or_b64 s[64:65], s[64:65], vcc
 v_cmp_ngt_f32 s[66:67], s73, v44
 v_cmp_nlt_f32 vcc, s74, v44
 s_or_b64 s[66:67], s[66:67], vcc
 s_or_b64 s[60:61], s[60:61], s[62:63]
 s_or_b64 s[64:65], s[64:65], s[66:67]
 s_or_b64 s[60:61], s[60:61], s[64:65]
 s_cbranch_scc1 Laslow_10
Laback_11:
 v_rcp_f32 v32, v32
 v_rcp_f32 v36, v36
 v_rcp_f32 v40, v40
 v_rcp_f32 v44, v44
 s_lshl_b32 s40, s41, 5
 s_add_u32 s40, s40, s32
 s_lshl_b32 s40, s40, 13
 s_add_u32 s40, s40, 0x6000000
 s_add_u32 s44, s40, 4096
 v_pk_mul_f32 v[112:113], v[112:113], v[32:33] op_sel_hi:[1,0]
 v_pk_mul_f32 v[114:115], v[114:115], v[32:33] op_sel_hi:[1,0]
 v_pk_mul_f32 v[116:117], v[116:117], v[32:33] op_sel_hi:[1,0]
 v_pk_mul_f32 v[118:119], v[118:119], v[32:33] op_sel_hi:[1,0]
 v_cvt_pk_bf16_f32 v240, v112, v113
 v_cvt_pk_bf16_f32 v241, v116, v117
 v_cvt_pk_bf16_f32 v242, v114, v115
 v_cvt_pk_bf16_f32 v243, v118, v119
 buffer_store_dwordx4 v[240:243], v1, s[20:23], s40 offen offset:0 sc1
 v_pk_mul_f32 v[120:121], v[120:121], v[32:33] op_sel_hi:[1,0]
 v_pk_mul_f32 v[122:123], v[122:123], v[32:33] op_sel_hi:[1,0]
 v_pk_mul_f32 v[124:125], v[124:125], v[32:33] op_sel_hi:[1,0]
 v_pk_mul_f32 v[126:127], v[126:127], v[32:33] op_sel_hi:[1,0]
 v_cvt_pk_bf16_f32 v244, v120, v121
 v_cvt_pk_bf16_f32 v245, v124, v125
 v_cvt_pk_bf16_f32 v246, v122, v123
 v_cvt_pk_bf16_f32 v247, v126, v127
 buffer_store_dwordx4 v[244:247], v1, s[20:23], s40 offen offset:2048 sc1
 v_pk_mul_f32 v[128:129], v[128:129], v[32:33] op_sel_hi:[1,0]
 v_pk_mul_f32 v[130:131], v[130:131], v[32:33] op_sel_hi:[1,0]
 v_pk_mul_f32 v[132:133], v[132:133], v[32:33] op_sel_hi:[1,0]
 v_pk_mul_f32 v[134:135], v[134:135], v[32:33] op_sel_hi:[1,0]
 v_cvt_pk_bf16_f32 v248, v128, v129
 v_cvt_pk_bf16_f32 v249, v132, v133
 v_cvt_pk_bf16_f32 v250, v130, v131
 v_cvt_pk_bf16_f32 v251, v134, v135
 buffer_store_dwordx4 v[248:251], v1, s[20:23], s44 offen offset:0 sc1
 v_pk_mul_f32 v[136:137], v[136:137], v[32:33] op_sel_hi:[1,0]
 v_pk_mul_f32 v[138:139], v[138:139], v[32:33] op_sel_hi:[1,0]
 v_pk_mul_f32 v[140:141], v[140:141], v[32:33] op_sel_hi:[1,0]
 v_pk_mul_f32 v[142:143], v[142:143], v[32:33] op_sel_hi:[1,0]
 v_cvt_pk_bf16_f32 v252, v136, v137
 v_cvt_pk_bf16_f32 v253, v140, v141
 v_cvt_pk_bf16_f32 v254, v138, v139
 v_cvt_pk_bf16_f32 v255, v142, v143
 buffer_store_dwordx4 v[252:255], v1, s[20:23], s44 offen offset:2048 sc1
 v_pk_mul_f32 v[144:145], v[144:145], v[36:37] op_sel_hi:[1,0]
 v_pk_mul_f32 v[146:147], v[146:147], v[36:37] op_sel_hi:[1,0]
 v_pk_mul_f32 v[148:149], v[148:149], v[36:37] op_sel_hi:[1,0]
 v_pk_mul_f32 v[150:151], v[150:151], v[36:37] op_sel_hi:[1,0]
 v_cvt_pk_bf16_f32 v240, v144, v145
 v_cvt_pk_bf16_f32 v241, v148, v149
 v_cvt_pk_bf16_f32 v242, v146, v147
 v_cvt_pk_bf16_f32 v243, v150, v151
 buffer_store_dwordx4 v[240:243], v1, s[20:23], s40 offen offset:1024 sc1
 v_pk_mul_f32 v[152:153], v[152:153], v[36:37] op_sel_hi:[1,0]
 v_pk_mul_f32 v[154:155], v[154:155], v[36:37] op_sel_hi:[1,0]
 v_pk_mul_f32 v[156:157], v[156:157], v[36:37] op_sel_hi:[1,0]
 v_pk_mul_f32 v[158:159], v[158:159], v[36:37] op_sel_hi:[1,0]
 v_cvt_pk_bf16_f32 v244, v152, v153
 v_cvt_pk_bf16_f32 v245, v156, v157
 v_cvt_pk_bf16_f32 v246, v154, v155
 v_cvt_pk_bf16_f32 v247, v158, v159
 buffer_store_dwordx4 v[244:247], v1, s[20:23], s40 offen offset:3072 sc1
 v_pk_mul_f32 v[160:161], v[160:161], v[36:37] op_sel_hi:[1,0]
 v_pk_mul_f32 v[162:163], v[162:163], v[36:37] op_sel_hi:[1,0]
 v_pk_mul_f32 v[164:165], v[164:165], v[36:37] op_sel_hi:[1,0]
 v_pk_mul_f32 v[166:167], v[166:167], v[36:37] op_sel_hi:[1,0]
 v_cvt_pk_bf16_f32 v248, v160, v161
 v_cvt_pk_bf16_f32 v249, v164, v165
 v_cvt_pk_bf16_f32 v250, v162, v163
 v_cvt_pk_bf16_f32 v251, v166, v167
 buffer_store_dwordx4 v[248:251], v1, s[20:23], s44 offen offset:1024 sc1
 v_pk_mul_f32 v[168:169], v[168:169], v[36:37] op_sel_hi:[1,0]
 v_pk_mul_f32 v[170:171], v[170:171], v[36:37] op_sel_hi:[1,0]
 v_pk_mul_f32 v[172:173], v[172:173], v[36:37] op_sel_hi:[1,0]
 v_pk_mul_f32 v[174:175], v[174:175], v[36:37] op_sel_hi:[1,0]
 v_cvt_pk_bf16_f32 v252, v168, v169
 v_cvt_pk_bf16_f32 v253, v172, v173
 v_cvt_pk_bf16_f32 v254, v170, v171
 v_cvt_pk_bf16_f32 v255, v174, v175
 buffer_store_dwordx4 v[252:255], v1, s[20:23], s44 offen offset:3072 sc1
 s_lshl_b32 s40, s42, 5
 s_add_u32 s40, s40, s32
 s_lshl_b32 s40, s40, 13
 s_add_u32 s40, s40, 0x6000000
 s_add_u32 s44, s40, 4096
 v_pk_mul_f32 v[176:177], v[176:177], v[40:41] op_sel_hi:[1,0]
 v_pk_mul_f32 v[178:179], v[178:179], v[40:41] op_sel_hi:[1,0]
 v_pk_mul_f32 v[180:181], v[180:181], v[40:41] op_sel_hi:[1,0]
 v_pk_mul_f32 v[182:183], v[182:183], v[40:41] op_sel_hi:[1,0]
 v_cvt_pk_bf16_f32 v240, v176, v177
 v_cvt_pk_bf16_f32 v241, v180, v181
 v_cvt_pk_bf16_f32 v242, v178, v179
 v_cvt_pk_bf16_f32 v243, v182, v183
 buffer_store_dwordx4 v[240:243], v1, s[20:23], s40 offen offset:0 sc1
 v_pk_mul_f32 v[184:185], v[184:185], v[40:41] op_sel_hi:[1,0]
 v_pk_mul_f32 v[186:187], v[186:187], v[40:41] op_sel_hi:[1,0]
 v_pk_mul_f32 v[188:189], v[188:189], v[40:41] op_sel_hi:[1,0]
 v_pk_mul_f32 v[190:191], v[190:191], v[40:41] op_sel_hi:[1,0]
 v_cvt_pk_bf16_f32 v244, v184, v185
 v_cvt_pk_bf16_f32 v245, v188, v189
 v_cvt_pk_bf16_f32 v246, v186, v187
 v_cvt_pk_bf16_f32 v247, v190, v191
 buffer_store_dwordx4 v[244:247], v1, s[20:23], s40 offen offset:2048 sc1
 v_pk_mul_f32 v[192:193], v[192:193], v[40:41] op_sel_hi:[1,0]
 v_pk_mul_f32 v[194:195], v[194:195], v[40:41] op_sel_hi:[1,0]
 v_pk_mul_f32 v[196:197], v[196:197], v[40:41] op_sel_hi:[1,0]
 v_pk_mul_f32 v[198:199], v[198:199], v[40:41] op_sel_hi:[1,0]
 v_cvt_pk_bf16_f32 v248, v192, v193
 v_cvt_pk_bf16_f32 v249, v196, v197
 v_cvt_pk_bf16_f32 v250, v194, v195
 v_cvt_pk_bf16_f32 v251, v198, v199
 buffer_store_dwordx4 v[248:251], v1, s[20:23], s44 offen offset:0 sc1
 v_pk_mul_f32 v[200:201], v[200:201], v[40:41] op_sel_hi:[1,0]
 v_pk_mul_f32 v[202:203], v[202:203], v[40:41] op_sel_hi:[1,0]
 v_pk_mul_f32 v[204:205], v[204:205], v[40:41] op_sel_hi:[1,0]
 v_pk_mul_f32 v[206:207], v[206:207], v[40:41] op_sel_hi:[1,0]
 v_cvt_pk_bf16_f32 v252, v200, v201
 v_cvt_pk_bf16_f32 v253, v204, v205
 v_cvt_pk_bf16_f32 v254, v202, v203
 v_cvt_pk_bf16_f32 v255, v206, v207
 buffer_store_dwordx4 v[252:255], v1, s[20:23], s44 offen offset:2048 sc1
 v_pk_mul_f32 v[208:209], v[208:209], v[44:45] op_sel_hi:[1,0]
 v_pk_mul_f32 v[210:211], v[210:211], v[44:45] op_sel_hi:[1,0]
 v_pk_mul_f32 v[212:213], v[212:213], v[44:45] op_sel_hi:[1,0]
 v_pk_mul_f32 v[214:215], v[214:215], v[44:45] op_sel_hi:[1,0]
 v_cvt_pk_bf16_f32 v240, v208, v209
 v_cvt_pk_bf16_f32 v241, v212, v213
 v_cvt_pk_bf16_f32 v242, v210, v211
 v_cvt_pk_bf16_f32 v243, v214, v215
 buffer_store_dwordx4 v[240:243], v1, s[20:23], s40 offen offset:1024 sc1
 v_pk_mul_f32 v[216:217], v[216:217], v[44:45] op_sel_hi:[1,0]
 v_pk_mul_f32 v[218:219], v[218:219], v[44:45] op_sel_hi:[1,0]
 v_pk_mul_f32 v[220:221], v[220:221], v[44:45] op_sel_hi:[1,0]
 v_pk_mul_f32 v[222:223], v[222:223], v[44:45] op_sel_hi:[1,0]
 v_cvt_pk_bf16_f32 v244, v216, v217
 v_cvt_pk_bf16_f32 v245, v220, v221
 v_cvt_pk_bf16_f32 v246, v218, v219
 v_cvt_pk_bf16_f32 v247, v222, v223
 buffer_store_dwordx4 v[244:247], v1, s[20:23], s40 offen offset:3072 sc1
 v_pk_mul_f32 v[224:225], v[224:225], v[44:45] op_sel_hi:[1,0]
 v_pk_mul_f32 v[226:227], v[226:227], v[44:45] op_sel_hi:[1,0]
 v_pk_mul_f32 v[228:229], v[228:229], v[44:45] op_sel_hi:[1,0]
 v_pk_mul_f32 v[230:231], v[230:231], v[44:45] op_sel_hi:[1,0]
 v_cvt_pk_bf16_f32 v248, v224, v225
 v_cvt_pk_bf16_f32 v249, v228, v229
 v_cvt_pk_bf16_f32 v250, v226, v227
 v_cvt_pk_bf16_f32 v251, v230, v231
 buffer_store_dwordx4 v[248:251], v1, s[20:23], s44 offen offset:1024 sc1
 v_pk_mul_f32 v[232:233], v[232:233], v[44:45] op_sel_hi:[1,0]
 v_pk_mul_f32 v[234:235], v[234:235], v[44:45] op_sel_hi:[1,0]
 v_pk_mul_f32 v[236:237], v[236:237], v[44:45] op_sel_hi:[1,0]
 v_pk_mul_f32 v[238:239], v[238:239], v[44:45] op_sel_hi:[1,0]
 v_cvt_pk_bf16_f32 v252, v232, v233
 v_cvt_pk_bf16_f32 v253, v236, v237
 v_cvt_pk_bf16_f32 v254, v234, v235
 v_cvt_pk_bf16_f32 v255, v238, v239
 buffer_store_dwordx4 v[252:255], v1, s[20:23], s44 offen offset:3072 sc1
 s_lshl_b32 s72, s33, 5
 s_add_u32 s72, s72, s32
 s_lshl_b32 s72, s72, 2
 s_add_u32 s72, s72, 0x3c00
 s_cmp_eq_u32 s46, 1
 s_cbranch_scc1 Ladone_12
 s_mov_b32 s46, 1
 s_mov_b32 s33, s34
 s_waitcnt vmcnt(16)
 v_accvgpr_mov_b32 a0, a64
 v_accvgpr_mov_b32 a1, a65
 v_accvgpr_mov_b32 a2, a66
 v_accvgpr_mov_b32 a3, a67
 v_accvgpr_mov_b32 a4, a68
 v_accvgpr_mov_b32 a5, a69
 v_accvgpr_mov_b32 a6, a70
 v_accvgpr_mov_b32 a7, a71
 v_accvgpr_mov_b32 a8, a72
 v_accvgpr_mov_b32 a9, a73
 v_accvgpr_mov_b32 a10, a74
 v_accvgpr_mov_b32 a11, a75
 v_accvgpr_mov_b32 a12, a76
 v_accvgpr_mov_b32 a13, a77
 v_accvgpr_mov_b32 a14, a78
 v_accvgpr_mov_b32 a15, a79
 v_accvgpr_mov_b32 a16, a80
 v_accvgpr_mov_b32 a17, a81
 v_accvgpr_mov_b32 a18, a82
 v_accvgpr_mov_b32 a19, a83
 v_accvgpr_mov_b32 a20, a84
 v_accvgpr_mov_b32 a21, a85
 v_accvgpr_mov_b32 a22, a86
 v_accvgpr_mov_b32 a23, a87
 v_accvgpr_mov_b32 a24, a88
 v_accvgpr_mov_b32 a25, a89
 v_accvgpr_mov_b32 a26, a90
 v_accvgpr_mov_b32 a27, a91
 v_accvgpr_mov_b32 a28, a92
 v_accvgpr_mov_b32 a29, a93
 v_accvgpr_mov_b32 a30, a94
 v_accvgpr_mov_b32 a31, a95
 v_accvgpr_mov_b32 a32, a96
 v_accvgpr_mov_b32 a33, a97
 v_accvgpr_mov_b32 a34, a98
 v_accvgpr_mov_b32 a35, a99
 v_accvgpr_mov_b32 a36, a100
 v_accvgpr_mov_b32 a37, a101
 v_accvgpr_mov_b32 a38, a102
 v_accvgpr_mov_b32 a39, a103
 v_accvgpr_mov_b32 a40, a104
 v_accvgpr_mov_b32 a41, a105
 v_accvgpr_mov_b32 a42, a106
 v_accvgpr_mov_b32 a43, a107
 v_accvgpr_mov_b32 a44, a108
 v_accvgpr_mov_b32 a45, a109
 v_accvgpr_mov_b32 a46, a110
 v_accvgpr_mov_b32 a47, a111
 v_accvgpr_mov_b32 a48, a112
 v_accvgpr_mov_b32 a49, a113
 v_accvgpr_mov_b32 a50, a114
 v_accvgpr_mov_b32 a51, a115
 v_accvgpr_mov_b32 a52, a116
 v_accvgpr_mov_b32 a53, a117
 v_accvgpr_mov_b32 a54, a118
 v_accvgpr_mov_b32 a55, a119
 v_accvgpr_mov_b32 a56, a120
 v_accvgpr_mov_b32 a57, a121
 v_accvgpr_mov_b32 a58, a122
 v_accvgpr_mov_b32 a59, a123
 v_accvgpr_mov_b32 a60, a124
 v_accvgpr_mov_b32 a61, a125
 v_accvgpr_mov_b32 a62, a126
 v_accvgpr_mov_b32 a63, a127
 s_branch Lablk_9
Laslow_10:
 s_waitcnt vmcnt(0) lgkmcnt(0)
 v_mov_b32 v12, 0
 v_mov_b32 v240, v4
 v_mov_b32 v13, 0
 v_mov_b32 v241, v4
 v_mov_b32 v14, 0
 v_mov_b32 v242, v4
 v_mov_b32 v15, 0
 v_mov_b32 v243, v4
 s_mov_b32 s49, 0
Lsl_21:
 s_lshl_b32 s37, s49, 19
 s_add_u32 s37, s37, s45
 s_sub_u32 s37, s37, s50
 s_add_u32 s44, s37, 0
 buffer_load_dwordx4 a[128:131], v1, s[20:23], s44 offen offset:0 sc1
 buffer_load_dwordx4 a[132:135], v1, s[20:23], s44 offen offset:1024 sc1
 buffer_load_dwordx4 a[136:139], v1, s[20:23], s44 offen offset:2048 sc1
 buffer_load_dwordx4 a[140:143], v1, s[20:23], s44 offen offset:3072 sc1
 s_add_u32 s44, s37, 4096
 buffer_load_dwordx4 a[144:147], v1, s[20:23], s44 offen offset:0 sc1
 buffer_load_dwordx4 a[148:151], v1, s[20:23], s44 offen offset:1024 sc1
 buffer_load_dwordx4 a[152:155], v1, s[20:23], s44 offen offset:2048 sc1
 buffer_load_dwordx4 a[156:159], v1, s[20:23], s44 offen offset:3072 sc1
 s_cmp_lt_u32 s49, s41
 s_cselect_b64 s[68:69], -1, 0
 s_cmp_le_u32 s49, s41
 s_cselect_b64 s[70:71], -1, 0
 s_cmp_eq_u32 s49, s41
 s_cselect_b64 s[60:61], s[52:53], s[68:69]
 s_cselect_b64 s[62:63], s[54:55], s[68:69]
 s_cselect_b64 s[64:65], s[56:57], s[68:69]
 s_cselect_b64 s[66:67], s[58:59], s[68:69]
 v_cndmask_b32 v80, v4, v12, s[60:61]
 v_cndmask_b32 v81, v4, v12, s[62:63]
 v_cndmask_b32 v82, v4, v12, s[64:65]
 v_cndmask_b32 v83, v4, v12, s[66:67]
 v_cndmask_b32 v84, v4, v12, s[68:69]
 v_cndmask_b32 v85, v4, v12, s[68:69]
 v_cndmask_b32 v86, v4, v12, s[68:69]
 v_cndmask_b32 v87, v4, v12, s[68:69]
 v_cndmask_b32 v88, v4, v13, s[70:71]
 v_cndmask_b32 v89, v4, v13, s[70:71]
 v_cndmask_b32 v90, v4, v13, s[70:71]
 v_cndmask_b32 v91, v4, v13, s[70:71]
 v_cndmask_b32 v92, v4, v13, s[60:61]
 v_cndmask_b32 v93, v4, v13, s[62:63]
 v_cndmask_b32 v94, v4, v13, s[64:65]
 v_cndmask_b32 v95, v4, v13, s[66:67]
 s_cmp_lt_u32 s49, s42
 s_cselect_b64 s[68:69], -1, 0
 s_cmp_le_u32 s49, s42
 s_cselect_b64 s[70:71], -1, 0
 s_cmp_eq_u32 s49, s42
 s_cselect_b64 s[60:61], s[52:53], s[68:69]
 s_cselect_b64 s[62:63], s[54:55], s[68:69]
 s_cselect_b64 s[64:65], s[56:57], s[68:69]
 s_cselect_b64 s[66:67], s[58:59], s[68:69]
 v_cndmask_b32 v96, v4, v14, s[60:61]
 v_cndmask_b32 v97, v4, v14, s[62:63]
 v_cndmask_b32 v98, v4, v14, s[64:65]
 v_cndmask_b32 v99, v4, v14, s[66:67]
 v_cndmask_b32 v100, v4, v14, s[68:69]
 v_cndmask_b32 v101, v4, v14, s[68:69]
 v_cndmask_b32 v102, v4, v14, s[68:69]
 v_cndmask_b32 v103, v4, v14, s[68:69]
 v_cndmask_b32 v104, v4, v15, s[70:71]
 v_cndmask_b32 v105, v4, v15, s[70:71]
 v_cndmask_b32 v106, v4, v15, s[70:71]
 v_cndmask_b32 v107, v4, v15, s[70:71]
 v_cndmask_b32 v108, v4, v15, s[60:61]
 v_cndmask_b32 v109, v4, v15, s[62:63]
 v_cndmask_b32 v110, v4, v15, s[64:65]
 v_cndmask_b32 v111, v4, v15, s[66:67]
 s_waitcnt vmcnt(0)
 s_nop 0
 v_mfma_f32_16x16x32_bf16 v[48:51], a[128:131], a[0:3], v[80:83]
 v_mfma_f32_16x16x32_bf16 v[56:59], a[128:131], a[16:19], v[88:91]
 v_mfma_f32_16x16x32_bf16 v[64:67], a[128:131], a[32:35], v[96:99]
 v_mfma_f32_16x16x32_bf16 v[72:75], a[128:131], a[48:51], v[104:107]
 v_mfma_f32_16x16x32_bf16 v[52:55], a[132:135], a[0:3], v[84:87]
 v_mfma_f32_16x16x32_bf16 v[60:63], a[132:135], a[16:19], v[92:95]
 v_mfma_f32_16x16x32_bf16 v[68:71], a[132:135], a[32:35], v[100:103]
 v_mfma_f32_16x16x32_bf16 v[76:79], a[132:135], a[48:51], v[108:111]
 v_mfma_f32_16x16x32_bf16 v[48:51], a[136:139], a[4:7], v[48:51]
 v_mfma_f32_16x16x32_bf16 v[56:59], a[136:139], a[20:23], v[56:59]
 v_mfma_f32_16x16x32_bf16 v[64:67], a[136:139], a[36:39], v[64:67]
 v_mfma_f32_16x16x32_bf16 v[72:75], a[136:139], a[52:55], v[72:75]
 v_mfma_f32_16x16x32_bf16 v[52:55], a[140:143], a[4:7], v[52:55]
 v_mfma_f32_16x16x32_bf16 v[60:63], a[140:143], a[20:23], v[60:63]
 v_mfma_f32_16x16x32_bf16 v[68:71], a[140:143], a[36:39], v[68:71]
 v_mfma_f32_16x16x32_bf16 v[76:79], a[140:143], a[52:55], v[76:79]
 v_mfma_f32_16x16x32_bf16 v[48:51], a[144:147], a[8:11], v[48:51]
 v_mfma_f32_16x16x32_bf16 v[56:59], a[144:147], a[24:27], v[56:59]
 v_mfma_f32_16x16x32_bf16 v[64:67], a[144:147], a[40:43], v[64:67]
 v_mfma_f32_16x16x32_bf16 v[72:75], a[144:147], a[56:59], v[72:75]
 v_mfma_f32_16x16x32_bf16 v[52:55], a[148:151], a[8:11], v[52:55]
 v_mfma_f32_16x16x32_bf16 v[60:63], a[148:151], a[24:27], v[60:63]
 v_mfma_f32_16x16x32_bf16 v[68:71], a[148:151], a[40:43], v[68:71]
 v_mfma_f32_16x16x32_bf16 v[76:79], a[148:151], a[56:59], v[76:79]
 v_mfma_f32_16x16x32_bf16 v[48:51], a[152:155], a[12:15], v[48:51]
 v_mfma_f32_16x16x32_bf16 v[56:59], a[152:155], a[28:31], v[56:59]
 v_mfma_f32_16x16x32_bf16 v[64:67], a[152:155], a[44:47], v[64:67]
 v_mfma_f32_16x16x32_bf16 v[72:75], a[152:155], a[60:63], v[72:75]
 v_mfma_f32_16x16x32_bf16 v[52:55], a[156:159], a[12:15], v[52:55]
 v_mfma_f32_16x16x32_bf16 v[60:63], a[156:159], a[28:31], v[60:63]
 v_mfma_f32_16x16x32_bf16 v[68:71], a[156:159], a[44:47], v[68:71]
 v_mfma_f32_16x16x32_bf16 v[76:79], a[156:159], a[60:63], v[76:79]
 s_nop 7
 v_max3_f32 v240, v240, v48, v49
 v_max3_f32 v240, v240, v50, v51
 v_max3_f32 v240, v240, v52, v53
 v_max3_f32 v240, v240, v54, v55
 v_max3_f32 v241, v241, v56, v57
 v_max3_f32 v241, v241, v58, v59
 v_max3_f32 v241, v241, v60, v61
 v_max3_f32 v241, v241, v62, v63
 v_max3_f32 v242, v242, v64, v65
 v_max3_f32 v242, v242, v66, v67
 v_max3_f32 v242, v242, v68, v69
 v_max3_f32 v242, v242, v70, v71
 v_max3_f32 v243, v243, v72, v73
 v_max3_f32 v243, v243, v74, v75
 v_max3_f32 v243, v243, v76, v77
 v_max3_f32 v243, v243, v78, v79
 s_add_u32 s49, s49, 1
 s_cmp_le_u32 s49, s42
 s_cbranch_scc1 Lsl_21
 v_mov_b32 v244, v240
 v_mov_b32 v245, v241
 v_mov_b32 v246, v242
 v_mov_b32 v247, v243
 v_permlane16_swap_b32 v240, v244
 v_permlane16_swap_b32 v241, v245
 v_permlane16_swap_b32 v242, v246
 v_permlane16_swap_b32 v243, v247
 v_max_f32 v240, v240, v244
 v_max_f32 v241, v241, v245
 v_max_f32 v242, v242, v246
 v_max_f32 v243, v243, v247
 v_mov_b32 v244, v240
 v_mov_b32 v245, v241
 v_mov_b32 v246, v242
 v_mov_b32 v247, v243
 v_permlane32_swap_b32 v240, v244
 v_permlane32_swap_b32 v241, v245
 v_permlane32_swap_b32 v242, v246
 v_permlane32_swap_b32 v243, v247
 v_max_f32 v240, v240, v244
 v_max_f32 v241, v241, v245
 v_max_f32 v242, v242, v246
 v_max_f32 v243, v243, v247
 v_sub_f32 v12, 0, v240
 v_sub_f32 v13, 0, v241
 v_sub_f32 v14, 0, v242
 v_sub_f32 v15, 0, v243
 v_mov_b64 v[112:113], 0
 v_mov_b64 v[114:115], 0
 v_mov_b64 v[116:117], 0
 v_mov_b64 v[118:119], 0
 v_mov_b64 v[120:121], 0
 v_mov_b64 v[122:123], 0
 v_mov_b64 v[124:125], 0
 v_mov_b64 v[126:127], 0
 v_mov_b64 v[128:129], 0
 v_mov_b64 v[130:131], 0
 v_mov_b64 v[132:133], 0
 v_mov_b64 v[134:135], 0
 v_mov_b64 v[136:137], 0
 v_mov_b64 v[138:139], 0
 v_mov_b64 v[140:141], 0
 v_mov_b64 v[142:143], 0
 v_mov_b64 v[144:145], 0
 v_mov_b64 v[146:147], 0
 v_mov_b64 v[148:149], 0
 v_mov_b64 v[150:151], 0
 v_mov_b64 v[152:153], 0
 v_mov_b64 v[154:155], 0
 v_mov_b64 v[156:157], 0
 v_mov_b64 v[158:159], 0
 v_mov_b64 v[160:161], 0
 v_mov_b64 v[162:163], 0
 v_mov_b64 v[164:165], 0
 v_mov_b64 v[166:167], 0
 v_mov_b64 v[168:169], 0
 v_mov_b64 v[170:171], 0
 v_mov_b64 v[172:173], 0
 v_mov_b64 v[174:175], 0
 v_mov_b64 v[176:177], 0
 v_mov_b64 v[178:179], 0
 v_mov_b64 v[180:181], 0
 v_mov_b64 v[182:183], 0
 v_mov_b64 v[184:185], 0
 v_mov_b64 v[186:187], 0
 v_mov_b64 v[188:189], 0
 v_mov_b64 v[190:191], 0
 v_mov_b64 v[192:193], 0
 v_mov_b64 v[194:195], 0
 v_mov_b64 v[196:197], 0
 v_mov_b64 v[198:199], 0
 v_mov_b64 v[200:201], 0
 v_mov_b64 v[202:203], 0
 v_mov_b64 v[204:205], 0
 v_mov_b64 v[206:207], 0
 v_mov_b64 v[208:209], 0
 v_mov_b64 v[210:211], 0
 v_mov_b64 v[212:213], 0
 v_mov_b64 v[214:215], 0
 v_mov_b64 v[216:217], 0
 v_mov_b64 v[218:219], 0
 v_mov_b64 v[220:221], 0
 v_mov_b64 v[222:223], 0
 v_mov_b64 v[224:225], 0
 v_mov_b64 v[226:227], 0
 v_mov_b64 v[228:229], 0
 v_mov_b64 v[230:231], 0
 v_mov_b64 v[232:233], 0
 v_mov_b64 v[234:235], 0
 v_mov_b64 v[236:237], 0
 v_mov_b64 v[238:239], 0
 v_mov_b64 v[32:33], 0
 v_mov_b64 v[34:35], 0
 v_mov_b64 v[36:37], 0
 v_mov_b64 v[38:39], 0
 v_mov_b64 v[40:41], 0
 v_mov_b64 v[42:43], 0
 v_mov_b64 v[44:45], 0
 v_mov_b64 v[46:47], 0
 s_mov_b32 s49, 0
Lsl_22:
 s_lshl_b32 s37, s49, 19
 s_add_u32 s37, s37, s45
 s_sub_u32 s37, s37, s50
 s_add_u32 s44, s37, 0
 buffer_load_dwordx4 a[128:131], v1, s[20:23], s44 offen offset:0 sc1
 buffer_load_dwordx4 a[132:135], v1, s[20:23], s44 offen offset:1024 sc1
 buffer_load_dwordx4 a[136:139], v1, s[20:23], s44 offen offset:2048 sc1
 buffer_load_dwordx4 a[140:143], v1, s[20:23], s44 offen offset:3072 sc1
 s_add_u32 s44, s37, 4096
 buffer_load_dwordx4 a[144:147], v1, s[20:23], s44 offen offset:0 sc1
 buffer_load_dwordx4 a[148:151], v1, s[20:23], s44 offen offset:1024 sc1
 buffer_load_dwordx4 a[152:155], v1, s[20:23], s44 offen offset:2048 sc1
 buffer_load_dwordx4 a[156:159], v1, s[20:23], s44 offen offset:3072 sc1
 s_add_u32 s44, s37, 8192
 buffer_load_dwordx4 a[160:163], v1, s[20:23], s44 offen offset:0 sc1
 buffer_load_dwordx4 a[164:167], v1, s[20:23], s44 offen offset:1024 sc1
 buffer_load_dwordx4 a[168:171], v1, s[20:23], s44 offen offset:2048 sc1
 buffer_load_dwordx4 a[172:175], v1, s[20:23], s44 offen offset:3072 sc1
 s_add_u32 s44, s37, 12288
 buffer_load_dwordx4 a[176:179], v1, s[20:23], s44 offen offset:0 sc1
 buffer_load_dwordx4 a[180:183], v1, s[20:23], s44 offen offset:1024 sc1
 buffer_load_dwordx4 a[184:187], v1, s[20:23], s44 offen offset:2048 sc1
 buffer_load_dwordx4 a[188:191], v1, s[20:23], s44 offen offset:3072 sc1
 s_cmp_lt_u32 s49, s41
 s_cselect_b64 s[68:69], -1, 0
 s_cmp_le_u32 s49, s41
 s_cselect_b64 s[70:71], -1, 0
 s_cmp_eq_u32 s49, s41
 s_cselect_b64 s[60:61], s[52:53], s[68:69]
 s_cselect_b64 s[62:63], s[54:55], s[68:69]
 s_cselect_b64 s[64:65], s[56:57], s[68:69]
 s_cselect_b64 s[66:67], s[58:59], s[68:69]
 v_cndmask_b32 v80, v4, v12, s[60:61]
 v_cndmask_b32 v81, v4, v12, s[62:63]
 v_cndmask_b32 v82, v4, v12, s[64:65]
 v_cndmask_b32 v83, v4, v12, s[66:67]
 v_cndmask_b32 v84, v4, v12, s[68:69]
 v_cndmask_b32 v85, v4, v12, s[68:69]
 v_cndmask_b32 v86, v4, v12, s[68:69]
 v_cndmask_b32 v87, v4, v12, s[68:69]
 v_cndmask_b32 v88, v4, v13, s[70:71]
 v_cndmask_b32 v89, v4, v13, s[70:71]
 v_cndmask_b32 v90, v4, v13, s[70:71]
 v_cndmask_b32 v91, v4, v13, s[70:71]
 v_cndmask_b32 v92, v4, v13, s[60:61]
 v_cndmask_b32 v93, v4, v13, s[62:63]
 v_cndmask_b32 v94, v4, v13, s[64:65]
 v_cndmask_b32 v95, v4, v13, s[66:67]
 s_cmp_lt_u32 s49, s42
 s_cselect_b64 s[68:69], -1, 0
 s_cmp_le_u32 s49, s42
 s_cselect_b64 s[70:71], -1, 0
 s_cmp_eq_u32 s49, s42
 s_cselect_b64 s[60:61], s[52:53], s[68:69]
 s_cselect_b64 s[62:63], s[54:55], s[68:69]
 s_cselect_b64 s[64:65], s[56:57], s[68:69]
 s_cselect_b64 s[66:67], s[58:59], s[68:69]
 v_cndmask_b32 v96, v4, v14, s[60:61]
 v_cndmask_b32 v97, v4, v14, s[62:63]
 v_cndmask_b32 v98, v4, v14, s[64:65]
 v_cndmask_b32 v99, v4, v14, s[66:67]
 v_cndmask_b32 v100, v4, v14, s[68:69]
 v_cndmask_b32 v101, v4, v14, s[68:69]
 v_cndmask_b32 v102, v4, v14, s[68:69]
 v_cndmask_b32 v103, v4, v14, s[68:69]
 v_cndmask_b32 v104, v4, v15, s[70:71]
 v_cndmask_b32 v105, v4, v15, s[70:71]
 v_cndmask_b32 v106, v4, v15, s[70:71]
 v_cndmask_b32 v107, v4, v15, s[70:71]
 v_cndmask_b32 v108, v4, v15, s[60:61]
 v_cndmask_b32 v109, v4, v15, s[62:63]
 v_cndmask_b32 v110, v4, v15, s[64:65]
 v_cndmask_b32 v111, v4, v15, s[66:67]
 s_waitcnt vmcnt(0)
 s_nop 0
 v_mfma_f32_16x16x32_bf16 v[48:51], a[128:131], a[0:3], v[80:83]
 v_mfma_f32_16x16x32_bf16 v[56:59], a[128:131], a[16:19], v[88:91]
 v_mfma_f32_16x16x32_bf16 v[64:67], a[128:131], a[32:35], v[96:99]
 v_mfma_f32_16x16x32_bf16 v[72:75], a[128:131], a[48:51], v[104:107]
 v_mfma_f32_16x16x32_bf16 v[52:55], a[132:135], a[0:3], v[84:87]
 v_mfma_f32_16x16x32_bf16 v[60:63], a[132:135], a[16:19], v[92:95]
 v_mfma_f32_16x16x32_bf16 v[68:71], a[132:135], a[32:35], v[100:103]
 v_mfma_f32_16x16x32_bf16 v[76:79], a[132:135], a[48:51], v[108:111]
 v_mfma_f32_16x16x32_bf16 v[48:51], a[136:139], a[4:7], v[48:51]
 v_mfma_f32_16x16x32_bf16 v[56:59], a[136:139], a[20:23], v[56:59]
 v_mfma_f32_16x16x32_bf16 v[64:67], a[136:139], a[36:39], v[64:67]
 v_mfma_f32_16x16x32_bf16 v[72:75], a[136:139], a[52:55], v[72:75]
 v_mfma_f32_16x16x32_bf16 v[52:55], a[140:143], a[4:7], v[52:55]
 v_mfma_f32_16x16x32_bf16 v[60:63], a[140:143], a[20:23], v[60:63]
 v_mfma_f32_16x16x32_bf16 v[68:71], a[140:143], a[36:39], v[68:71]
 v_mfma_f32_16x16x32_bf16 v[76:79], a[140:143], a[52:55], v[76:79]
 v_mfma_f32_16x16x32_bf16 v[48:51], a[144:147], a[8:11], v[48:51]
 v_mfma_f32_16x16x32_bf16 v[56:59], a[144:147], a[24:27], v[56:59]
 v_mfma_f32_16x16x32_bf16 v[64:67], a[144:147], a[40:43], v[64:67]
 v_mfma_f32_16x16x32_bf16 v[72:75], a[144:147], a[56:59], v[72:75]
 v_mfma_f32_16x16x32_bf16 v[52:55], a[148:151], a[8:11], v[52:55]
 v_mfma_f32_16x16x32_bf16 v[60:63], a[148:151], a[24:27], v[60:63]
 v_mfma_f32_16x16x32_bf16 v[68:71], a[148:151], a[40:43], v[68:71]
 v_mfma_f32_16x16x32_bf16 v[76:79], a[148:151], a[56:59], v[76:79]
 v_mfma_f32_16x16x32_bf16 v[48:51], a[152:155], a[12:15], v[48:51]
 v_mfma_f32_16x16x32_bf16 v[56:59], a[152:155], a[28:31], v[56:59]
 v_mfma_f32_16x16x32_bf16 v[64:67], a[152:155], a[44:47], v[64:67]
 v_mfma_f32_16x16x32_bf16 v[72:75], a[152:155], a[60:63], v[72:75]
 v_mfma_f32_16x16x32_bf16 v[52:55], a[156:159], a[12:15], v[52:55]
 v_mfma_f32_16x16x32_bf16 v[60:63], a[156:159], a[28:31], v[60:63]
 v_mfma_f32_16x16x32_bf16 v[68:71], a[156:159], a[44:47], v[68:71]
 v_mfma_f32_16x16x32_bf16 v[76:79], a[156:159], a[60:63], v[76:79]
 s_nop 7
 v_exp_f32 v48, v48
 v_exp_f32 v49, v49
 v_exp_f32 v52, v52
 v_exp_f32 v53, v53
 v_exp_f32 v50, v50
 v_cvt_pk_bf16_f32 v16, v48, v49
 v_cvt_pk_bf16_f32 v17, v52, v53
 v_exp_f32 v51, v51
 v_exp_f32 v54, v54
 v_exp_f32 v55, v55
 v_cvt_pk_bf16_f32 v18, v50, v51
 v_cvt_pk_bf16_f32 v19, v54, v55
 v_exp_f32 v56, v56
 v_exp_f32 v57, v57
 v_exp_f32 v60, v60
 v_exp_f32 v61, v61
 v_exp_f32 v58, v58
 v_cvt_pk_bf16_f32 v20, v56, v57
 v_cvt_pk_bf16_f32 v21, v60, v61
 v_exp_f32 v59, v59
 v_exp_f32 v62, v62
 v_exp_f32 v63, v63
 v_cvt_pk_bf16_f32 v22, v58, v59
 v_cvt_pk_bf16_f32 v23, v62, v63
 v_exp_f32 v64, v64
 v_exp_f32 v65, v65
 v_exp_f32 v68, v68
 v_exp_f32 v69, v69
 v_exp_f32 v66, v66
 v_cvt_pk_bf16_f32 v24, v64, v65
 v_cvt_pk_bf16_f32 v25, v68, v69
 v_exp_f32 v67, v67
 v_exp_f32 v70, v70
 v_exp_f32 v71, v71
 v_cvt_pk_bf16_f32 v26, v66, v67
 v_cvt_pk_bf16_f32 v27, v70, v71
 v_exp_f32 v72, v72
 v_exp_f32 v73, v73
 v_exp_f32 v76, v76
 v_exp_f32 v77, v77
 v_exp_f32 v74, v74
 v_cvt_pk_bf16_f32 v28, v72, v73
 v_cvt_pk_bf16_f32 v29, v76, v77
 v_exp_f32 v75, v75
 v_exp_f32 v78, v78
 v_exp_f32 v79, v79
 v_cvt_pk_bf16_f32 v30, v74, v75
 v_cvt_pk_bf16_f32 v31, v78, v79
 s_nop 1
 v_mfma_f32_16x16x32_bf16 v[112:115], a[160:163], v[16:19], v[112:115]
 v_mfma_f32_16x16x32_bf16 v[144:147], a[160:163], v[20:23], v[144:147]
 v_mfma_f32_16x16x32_bf16 v[176:179], a[160:163], v[24:27], v[176:179]
 v_mfma_f32_16x16x32_bf16 v[208:211], a[160:163], v[28:31], v[208:211]
 v_mfma_f32_16x16x32_bf16 v[116:119], a[164:167], v[16:19], v[116:119]
 v_mfma_f32_16x16x32_bf16 v[148:151], a[164:167], v[20:23], v[148:151]
 v_mfma_f32_16x16x32_bf16 v[180:183], a[164:167], v[24:27], v[180:183]
 v_mfma_f32_16x16x32_bf16 v[212:215], a[164:167], v[28:31], v[212:215]
 v_mfma_f32_16x16x32_bf16 v[120:123], a[168:171], v[16:19], v[120:123]
 v_mfma_f32_16x16x32_bf16 v[152:155], a[168:171], v[20:23], v[152:155]
 v_mfma_f32_16x16x32_bf16 v[184:187], a[168:171], v[24:27], v[184:187]
 v_mfma_f32_16x16x32_bf16 v[216:219], a[168:171], v[28:31], v[216:219]
 v_mfma_f32_16x16x32_bf16 v[124:127], a[172:175], v[16:19], v[124:127]
 v_mfma_f32_16x16x32_bf16 v[156:159], a[172:175], v[20:23], v[156:159]
 v_mfma_f32_16x16x32_bf16 v[188:191], a[172:175], v[24:27], v[188:191]
 v_mfma_f32_16x16x32_bf16 v[220:223], a[172:175], v[28:31], v[220:223]
 v_mfma_f32_16x16x32_bf16 v[128:131], a[176:179], v[16:19], v[128:131]
 v_mfma_f32_16x16x32_bf16 v[160:163], a[176:179], v[20:23], v[160:163]
 v_mfma_f32_16x16x32_bf16 v[192:195], a[176:179], v[24:27], v[192:195]
 v_mfma_f32_16x16x32_bf16 v[224:227], a[176:179], v[28:31], v[224:227]
 v_mfma_f32_16x16x32_bf16 v[132:135], a[180:183], v[16:19], v[132:135]
 v_mfma_f32_16x16x32_bf16 v[164:167], a[180:183], v[20:23], v[164:167]
 v_mfma_f32_16x16x32_bf16 v[196:199], a[180:183], v[24:27], v[196:199]
 v_mfma_f32_16x16x32_bf16 v[228:231], a[180:183], v[28:31], v[228:231]
 v_mfma_f32_16x16x32_bf16 v[136:139], a[184:187], v[16:19], v[136:139]
 v_mfma_f32_16x16x32_bf16 v[168:171], a[184:187], v[20:23], v[168:171]
 v_mfma_f32_16x16x32_bf16 v[200:203], a[184:187], v[24:27], v[200:203]
 v_mfma_f32_16x16x32_bf16 v[232:235], a[184:187], v[28:31], v[232:235]
 v_mfma_f32_16x16x32_bf16 v[140:143], a[188:191], v[16:19], v[140:143]
 v_mfma_f32_16x16x32_bf16 v[172:175], a[188:191], v[20:23], v[172:175]
 v_mfma_f32_16x16x32_bf16 v[204:207], a[188:191], v[24:27], v[204:207]
 v_mfma_f32_16x16x32_bf16 v[236:239], a[188:191], v[28:31], v[236:239]
 v_mfma_f32_16x16x32_bf16 v[32:35], a[192:195], v[16:19], v[32:35]
 v_mfma_f32_16x16x32_bf16 v[36:39], a[192:195], v[20:23], v[36:39]
 v_mfma_f32_16x16x32_bf16 v[40:43], a[192:195], v[24:27], v[40:43]
 v_mfma_f32_16x16x32_bf16 v[44:47], a[192:195], v[28:31], v[44:47]
 s_add_u32 s49, s49, 1
 s_cmp_le_u32 s49, s42
 s_cbranch_scc1 Lsl_22
 ds_read_b128 a[128:131], v3 offset:0
 ds_read_b128 a[132:135], v3 offset:1024
 ds_read_b128 a[136:139], v3 offset:2048
 ds_read_b128 a[140:143], v3 offset:3072
 ds_read_b128 a[144:147], v3 offset:4096
 ds_read_b128 a[148:151], v3 offset:5120
 ds_read_b128 a[152:155], v3 offset:6144
 ds_read_b128 a[156:159], v3 offset:7168
 s_branch Laback_11
Ladone_12:
 s_waitcnt vmcnt(0) lgkmcnt(0)
 s_barrier
 v_mov_b32 v6, 1
 buffer_store_dword v6, v5, s[20:23], s72 offen sc1
 s_cmp_ge_u32 s6, 27
 s_cbranch_scc1 Lfin
 s_load_dwordx2 s[8:9], s[0:1], 40
 s_mov_b32 s10, 0x480000
 s_mov_b32 s11, 0x20000
 s_mul_i32 s7, s6, 29
 s_lshr_b32 s7, s7, 8
 s_mul_i32 s94, s7, 9
 s_sub_u32 s32, s6, s94
 s_mul_i32 s40, s7, 3
 s_lshl_b32 s7, s7, 2
 s_add_u32 s7, s7, s5
 s_sub_u32 s33, s7, 4
 s_mov_b32 s34, 12
 s_cmp_lt_u32 s33, 4
 s_cselect_b32 s35, 6, 5
 s_mov_b32 s36, 0x6000000
 s_mov_b32 s37, 0
 s_lshl_b32 s38, s4, 5
 s_add_u32 s38, s38, 0x3c00
 s_mov_b32 s39, 0
 s_mov_b32 s93, 0x38
 s_mov_b32 s92, 7
 s_mov_b32 s91, 4
 s_mov_b32 s90, 31
 s_branch Los
Lpb:
 s_load_dwordx2 s[8:9], s[0:1], 48
 s_mov_b32 s10, 0x240000
 s_mov_b32 s11, 0x20000
 s_load_dwordx2 s[12:13], s[0:1], 72
 s_mov_b32 s14, 0x480000
 s_mov_b32 s15, 0x20000
 s_load_dwordx2 s[16:17], s[0:1], 80
 s_mov_b32 s18, 0x480000
 s_mov_b32 s19, 0x20000
 s_lshl_b32 s32, s6, 8
 s_mov_b32 s33, s32
 s_lshl_b32 s34, s6, 14
 s_add_u32 s34, s34, 0x3000000
 s_add_u32 s35, s34, 8192
 s_mov_b32 s36, 64
 s_mov_b32 s37, 0
 s_lshl_b32 s7, s6, 7
 s_add_u32 s7, s7, 0x0
 v_min_u32 v1, 1, v0
 v_lshlrev_b32 v1, 28, v1
 v_add_u32 v13, s7, v1
 s_waitcnt lgkmcnt(0)
 v_and_b32 v1, 63, v0
 v_lshrrev_b32 v2, 3, v0
 v_mul_u32_u24 v10, 1152, v2
 v_lshrrev_b32 v2, 4, v0
 v_xor_b32 v2, v2, v0
 v_and_b32 v2, 7, v2
 v_lshl_add_u32 v10, v2, 4, v10
 v_lshrrev_b32 v2, 4, v1
 v_bfe_u32 v3, v1, 1, 3
 v_xor_b32 v2, v2, v3
 v_and_b32 v3, 15, v1
 v_lshlrev_b32 v3, 7, v3
 v_lshl_add_u32 v4, v2, 4, v3
 v_xor_b32 v5, 64, v4
 v_lshrrev_b32 v2, 4, v0
 v_lshlrev_b32 v11, 13, v2
 v_lshrrev_b32 v2, 7, v0
 v_lshrrev_b32 v3, 4, v1
 v_lshl_add_u32 v3, v2, 2, v3
 v_bfe_u32 v2, v1, 1, 3
 v_xor_b32 v2, v2, v3
 v_lshl_add_u32 v11, v2, 5, v11
 v_and_b32 v2, 1, v1
 v_lshl_add_u32 v11, v2, 4, v11
 v_bfe_u32 v2, v1, 2, 3
 v_xor_b32 v3, s4, v2
 v_lshlrev_b32 v3, 5, v3
 v_and_b32 v2, 3, v2
 v_lshl_add_u32 v3, v2, 8, v3
 v_lshrrev_b32 v2, 4, v1
 v_lshl_add_u32 v3, v2, 11, v3
 v_and_b32 v2, 3, v1
 v_lshl_add_u32 v3, v2, 3, v3
 v_add_u32 v8, 73728, v3
 v_xor_b32 v3, 0x80, v3
 v_add_u32 v9, 73728, v3
 s_lshl_b32 s45, s4, 11
 v_lshl_add_u32 v12, v1, 4, s45
 s_mov_b32 s39, s37
 s_add_u32 s40, s39, 1
 s_lshl_b32 s49, s4, 10
 s_mul_i32 s46, s39, 36864
 s_add_u32 m0, s49, 0
 s_nop 0
 buffer_load_dwordx4 v10, s[8:11], s46 offen offset:0  lds
 s_add_u32 m0, s49, 3968
 s_nop 0
 buffer_load_dwordx4 v10, s[8:11], s46 offen offset:128  lds
 s_add_u32 m0, s49, 7936
 s_nop 0
 buffer_load_dwordx4 v10, s[8:11], s46 offen offset:256  lds
 s_add_u32 m0, s49, 11904
 s_nop 0
 buffer_load_dwordx4 v10, s[8:11], s46 offen offset:384  lds
 s_add_u32 m0, s49, 15872
 s_nop 0
 buffer_load_dwordx4 v10, s[8:11], s46 offen offset:512  lds
 s_add_u32 m0, s49, 19840
 s_nop 0
 buffer_load_dwordx4 v10, s[8:11], s46 offen offset:640  lds
 s_add_u32 m0, s49, 23808
 s_nop 0
 buffer_load_dwordx4 v10, s[8:11], s46 offen offset:768  lds
 s_add_u32 m0, s49, 27776
 s_nop 0
 buffer_load_dwordx4 v10, s[8:11], s46 offen offset:896  lds
 s_add_u32 m0, s49, 31744
 s_nop 0
 buffer_load_dwordx4 v10, s[8:11], s46 offen offset:1024  lds
 s_lshl_b32 s49, s4, 10
 s_add_u32 s49, s49, 36864
 s_mul_i32 s46, s40, 36864
 s_add_u32 m0, s49, 0
 s_nop 0
 buffer_load_dwordx4 v10, s[8:11], s46 offen offset:0  lds
 s_add_u32 m0, s49, 3968
 s_nop 0
 buffer_load_dwordx4 v10, s[8:11], s46 offen offset:128  lds
 s_add_u32 m0, s49, 7936
 s_nop 0
 buffer_load_dwordx4 v10, s[8:11], s46 offen offset:256  lds
 s_add_u32 m0, s49, 11904
 s_nop 0
 buffer_load_dwordx4 v10, s[8:11], s46 offen offset:384  lds
 s_add_u32 m0, s49, 15872
 s_nop 0
 buffer_load_dwordx4 v10, s[8:11], s46 offen offset:512  lds
 s_add_u32 m0, s49, 19840
 s_nop 0
 buffer_load_dwordx4 v10, s[8:11], s46 offen offset:640  lds
 s_add_u32 m0, s49, 23808
 s_nop 0
 buffer_load_dwordx4 v10, s[8:11], s46 offen offset:768  lds
 s_add_u32 m0, s49, 27776
 s_nop 0
 buffer_load_dwordx4 v10, s[8:11], s46 offen offset:896  lds
 s_add_u32 m0, s49, 31744
 s_nop 0
 buffer_load_dwordx4 v10, s[8:11], s46 offen offset:1024  lds
 s_lshl_b32 s49, s4, 10
 s_add_u32 m0, s49, 73728
 s_add_u32 s45, s32, 0
 buffer_load_dwordx4 v11, s[12:15], s45 offen  lds
 s_add_u32 m0, s49, 77824
 s_add_u32 s45, s32, 131072
 buffer_load_dwordx4 v11, s[12:15], s45 offen  lds
 s_add_u32 m0, s49, 81920
 s_add_u32 s45, s33, 0
 buffer_load_dwordx4 v11, s[16:19], s45 offen  lds
 s_add_u32 m0, s49, 86016
 s_add_u32 s45, s33, 131072
 buffer_load_dwordx4 v11, s[16:19], s45 offen  lds
 s_add_u32 m0, s49, 90112
 s_add_u32 s45, s32, 262144
 buffer_load_dwordx4 v11, s[12:15], s45 offen  lds
 s_add_u32 m0, s49, 94208
 s_add_u32 s45, s32, 393216
 buffer_load_dwordx4 v11, s[12:15], s45 offen  lds
 s_add_u32 m0, s49, 98304
 s_add_u32 s45, s33, 262144
 buffer_load_dwordx4 v11, s[16:19], s45 offen  lds
 s_add_u32 m0, s49, 102400
 s_add_u32 s45, s33, 393216
 buffer_load_dwordx4 v11, s[16:19], s45 offen  lds
 s_add_u32 m0, s49, 106496
 s_add_u32 s45, s32, 524288
 buffer_load_dwordx4 v11, s[12:15], s45 offen  lds
 s_add_u32 m0, s49, 110592
 s_add_u32 s45, s32, 655360
 buffer_load_dwordx4 v11, s[12:15], s45 offen  lds
 s_add_u32 m0, s49, 114688
 s_add_u32 s45, s33, 524288
 buffer_load_dwordx4 v11, s[16:19], s45 offen  lds
 s_add_u32 m0, s49, 118784
 s_add_u32 s45, s33, 655360
 buffer_load_dwordx4 v11, s[16:19], s45 offen  lds
 s_waitcnt vmcnt(8) lgkmcnt(0)
 s_barrier
 s_add_u32 m0, s49, 122880
 s_add_u32 s45, s32, 786432
 buffer_load_dwordx4 v11, s[12:15], s45 offen  lds
 s_add_u32 m0, s49, 126976
 s_add_u32 s45, s32, 917504
 buffer_load_dwordx4 v11, s[12:15], s45 offen  lds
 s_add_u32 m0, s49, 131072
 s_add_u32 s45, s33, 786432
 buffer_load_dwordx4 v11, s[16:19], s45 offen  lds
 s_add_u32 m0, s49, 135168
 s_add_u32 s45, s33, 917504
 buffer_load_dwordx4 v11, s[16:19], s45 offen  lds
 ds_read_b64_tr_b16 a[0:1], v8 offset:0
 ds_read_b64_tr_b16 a[2:3], v8 offset:1024
 ds_read_b64_tr_b16 a[72:73], v9 offset:0
 ds_read_b64_tr_b16 a[74:75], v9 offset:1024
 ds_read_b64_tr_b16 a[144:145], v8 offset:8192
 ds_read_b64_tr_b16 a[146:147], v8 offset:9216
 ds_read_b64_tr_b16 a[216:217], v9 offset:8192
 ds_read_b64_tr_b16 a[218:219], v9 offset:9216
 s_waitcnt vmcnt(8) lgkmcnt(0)
 s_barrier
 s_add_u32 m0, s49, 73728
 s_add_u32 s45, s32, 1048576
 buffer_load_dwordx4 v11, s[12:15], s45 offen  lds
 s_add_u32 m0, s49, 77824
 s_add_u32 s45, s32, 1179648
 buffer_load_dwordx4 v11, s[12:15], s45 offen  lds
 s_add_u32 m0, s49, 81920
 s_add_u32 s45, s33, 1048576
 buffer_load_dwordx4 v11, s[16:19], s45 offen  lds
 s_add_u32 m0, s49, 86016
 s_add_u32 s45, s33, 1179648
 buffer_load_dwordx4 v11, s[16:19], s45 offen  lds
 ds_read_b64_tr_b16 a[4:5], v8 offset:16384
 ds_read_b64_tr_b16 a[6:7], v8 offset:17408
 ds_read_b64_tr_b16 a[76:77], v9 offset:16384
 ds_read_b64_tr_b16 a[78:79], v9 offset:17408
 ds_read_b64_tr_b16 a[148:149], v8 offset:24576
 ds_read_b64_tr_b16 a[150:151], v8 offset:25600
 ds_read_b64_tr_b16 a[220:221], v9 offset:24576
 ds_read_b64_tr_b16 a[222:223], v9 offset:25600
 s_waitcnt vmcnt(8) lgkmcnt(0)
 s_barrier
 s_add_u32 m0, s49, 90112
 s_add_u32 s45, s32, 1310720
 buffer_load_dwordx4 v11, s[12:15], s45 offen  lds
 s_add_u32 m0, s49, 94208
 s_add_u32 s45, s32, 1441792
 buffer_load_dwordx4 v11, s[12:15], s45 offen  lds
 s_add_u32 m0, s49, 98304
 s_add_u32 s45, s33, 1310720
 buffer_load_dwordx4 v11, s[16:19], s45 offen  lds
 s_add_u32 m0, s49, 102400
 s_add_u32 s45, s33, 1441792
 buffer_load_dwordx4 v11, s[16:19], s45 offen  lds
 ds_read_b64_tr_b16 a[8:9], v8 offset:32768
 ds_read_b64_tr_b16 a[10:11], v8 offset:33792
 ds_read_b64_tr_b16 a[80:81], v9 offset:32768
 ds_read_b64_tr_b16 a[82:83], v9 offset:33792
 ds_read_b64_tr_b16 a[152:153], v8 offset:40960
 ds_read_b64_tr_b16 a[154:155], v8 offset:41984
 ds_read_b64_tr_b16 a[224:225], v9 offset:40960
 ds_read_b64_tr_b16 a[226:227], v9 offset:41984
 s_waitcnt vmcnt(8) lgkmcnt(0)
 s_barrier
 s_add_u32 m0, s49, 106496
 s_add_u32 s45, s32, 1572864
 buffer_load_dwordx4 v11, s[12:15], s45 offen  lds
 s_add_u32 m0, s49, 110592
 s_add_u32 s45, s32, 1703936
 buffer_load_dwordx4 v11, s[12:15], s45 offen  lds
 s_add_u32 m0, s49, 114688
 s_add_u32 s45, s33, 1572864
 buffer_load_dwordx4 v11, s[16:19], s45 offen  lds
 s_add_u32 m0, s49, 118784
 s_add_u32 s45, s33, 1703936
 buffer_load_dwordx4 v11, s[16:19], s45 offen  lds
 ds_read_b64_tr_b16 a[12:13], v8 offset:49152
 ds_read_b64_tr_b16 a[14:15], v8 offset:50176
 ds_read_b64_tr_b16 a[84:85], v9 offset:49152
 ds_read_b64_tr_b16 a[86:87], v9 offset:50176
 ds_read_b64_tr_b16 a[156:157], v8 offset:57344
 ds_read_b64_tr_b16 a[158:159], v8 offset:58368
 ds_read_b64_tr_b16 a[228:229], v9 offset:57344
 ds_read_b64_tr_b16 a[230:231], v9 offset:58368
 s_waitcnt vmcnt(8) lgkmcnt(0)
 s_barrier
 s_add_u32 m0, s49, 122880
 s_add_u32 s45, s32, 1835008
 buffer_load_dwordx4 v11, s[12:15], s45 offen  lds
 s_add_u32 m0, s49, 126976
 s_add_u32 s45, s32, 1966080
 buffer_load_dwordx4 v11, s[12:15], s45 offen  lds
 s_add_u32 m0, s49, 131072
 s_add_u32 s45, s33, 1835008
 buffer_load_dwordx4 v11, s[16:19], s45 offen  lds
 s_add_u32 m0, s49, 135168
 s_add_u32 s45, s33, 1966080
 buffer_load_dwordx4 v11, s[16:19], s45 offen  lds
 ds_read_b64_tr_b16 a[16:17], v8 offset:0
 ds_read_b64_tr_b16 a[18:19], v8 offset:1024
 ds_read_b64_tr_b16 a[88:89], v9 offset:0
 ds_read_b64_tr_b16 a[90:91], v9 offset:1024
 ds_read_b64_tr_b16 a[160:161], v8 offset:8192
 ds_read_b64_tr_b16 a[162:163], v8 offset:9216
 ds_read_b64_tr_b16 a[232:233], v9 offset:8192
 ds_read_b64_tr_b16 a[234:235], v9 offset:9216
 s_waitcnt vmcnt(8) lgkmcnt(0)
 s_barrier
 s_add_u32 m0, s49, 73728
 s_add_u32 s45, s32, 2097152
 buffer_load_dwordx4 v11, s[12:15], s45 offen  lds
 s_add_u32 m0, s49, 77824
 s_add_u32 s45, s32, 2228224
 buffer_load_dwordx4 v11, s[12:15], s45 offen  lds
 s_add_u32 m0, s49, 81920
 s_add_u32 s45, s33, 2097152
 buffer_load_dwordx4 v11, s[16:19], s45 offen  lds
 s_add_u32 m0, s49, 86016
 s_add_u32 s45, s33, 2228224
 buffer_load_dwordx4 v11, s[16:19], s45 offen  lds
 ds_read_b64_tr_b16 a[20:21], v8 offset:16384
 ds_read_b64_tr_b16 a[22:23], v8 offset:17408
 ds_read_b64_tr_b16 a[92:93], v9 offset:16384
 ds_read_b64_tr_b16 a[94:95], v9 offset:17408
 ds_read_b64_tr_b16 a[164:165], v8 offset:24576
 ds_read_b64_tr_b16 a[166:167], v8 offset:25600
 ds_read_b64_tr_b16 a[236:237], v9 offset:24576
 ds_read_b64_tr_b16 a[238:239], v9 offset:25600
 s_waitcnt vmcnt(8) lgkmcnt(0)
 s_barrier
 s_add_u32 m0, s49, 90112
 s_add_u32 s45, s32, 2359296
 buffer_load_dwordx4 v11, s[12:15], s45 offen  lds
 s_add_u32 m0, s49, 94208
 s_add_u32 s45, s32, 2490368
 buffer_load_dwordx4 v11, s[12:15], s45 offen  lds
 s_add_u32 m0, s49, 98304
 s_add_u32 s45, s33, 2359296
 buffer_load_dwordx4 v11, s[16:19], s45 offen  lds
 s_add_u32 m0, s49, 102400
 s_add_u32 s45, s33, 2490368
 buffer_load_dwordx4 v11, s[16:19], s45 offen  lds
 ds_read_b64_tr_b16 a[24:25], v8 offset:32768
 ds_read_b64_tr_b16 a[26:27], v8 offset:33792
 ds_read_b64_tr_b16 a[96:97], v9 offset:32768
 ds_read_b64_tr_b16 a[98:99], v9 offset:33792
 ds_read_b64_tr_b16 a[168:169], v8 offset:40960
 ds_read_b64_tr_b16 a[170:171], v8 offset:41984
 ds_read_b64_tr_b16 a[240:241], v9 offset:40960
 ds_read_b64_tr_b16 a[242:243], v9 offset:41984
 s_waitcnt vmcnt(8) lgkmcnt(0)
 s_barrier
 s_add_u32 m0, s49, 106496
 s_add_u32 s45, s32, 2621440
 buffer_load_dwordx4 v11, s[12:15], s45 offen  lds
 s_add_u32 m0, s49, 110592
 s_add_u32 s45, s32, 2752512
 buffer_load_dwordx4 v11, s[12:15], s45 offen  lds
 s_add_u32 m0, s49, 114688
 s_add_u32 s45, s33, 2621440
 buffer_load_dwordx4 v11, s[16:19], s45 offen  lds
 s_add_u32 m0, s49, 118784
 s_add_u32 s45, s33, 2752512
 buffer_load_dwordx4 v11, s[16:19], s45 offen  lds
 ds_read_b64_tr_b16 a[28:29], v8 offset:49152
 ds_read_b64_tr_b16 a[30:31], v8 offset:50176
 ds_read_b64_tr_b16 a[100:101], v9 offset:49152
 ds_read_b64_tr_b16 a[102:103], v9 offset:50176
 ds_read_b64_tr_b16 a[172:173], v8 offset:57344
 ds_read_b64_tr_b16 a[174:175], v8 offset:58368
 ds_read_b64_tr_b16 a[244:245], v9 offset:57344
 ds_read_b64_tr_b16 a[246:247], v9 offset:58368
 s_waitcnt vmcnt(8) lgkmcnt(0)
 s_barrier
 s_add_u32 m0, s49, 122880
 s_add_u32 s45, s32, 2883584
 buffer_load_dwordx4 v11, s[12:15], s45 offen  lds
 s_add_u32 m0, s49, 126976
 s_add_u32 s45, s32, 3014656
 buffer_load_dwordx4 v11, s[12:15], s45 offen  lds
 s_add_u32 m0, s49, 131072
 s_add_u32 s45, s33, 2883584
 buffer_load_dwordx4 v11, s[16:19], s45 offen  lds
 s_add_u32 m0, s49, 135168
 s_add_u32 s45, s33, 3014656
 buffer_load_dwordx4 v11, s[16:19], s45 offen  lds
 ds_read_b64_tr_b16 a[32:33], v8 offset:0
 ds_read_b64_tr_b16 a[34:35], v8 offset:1024
 ds_read_b64_tr_b16 a[104:105], v9 offset:0
 ds_read_b64_tr_b16 a[106:107], v9 offset:1024
 ds_read_b64_tr_b16 a[176:177], v8 offset:8192
 ds_read_b64_tr_b16 a[178:179], v8 offset:9216
 ds_read_b64_tr_b16 a[248:249], v9 offset:8192
 ds_read_b64_tr_b16 a[250:251], v9 offset:9216
 s_waitcnt vmcnt(8) lgkmcnt(0)
 s_barrier
 s_add_u32 m0, s49, 73728
 s_add_u32 s45, s32, 3145728
 buffer_load_dwordx4 v11, s[12:15], s45 offen  lds
 s_add_u32 m0, s49, 77824
 s_add_u32 s45, s32, 3276800
 buffer_load_dwordx4 v11, s[12:15], s45 offen  lds
 s_add_u32 m0, s49, 81920
 s_add_u32 s45, s33, 3145728
 buffer_load_dwordx4 v11, s[16:19], s45 offen  lds
 s_add_u32 m0, s49, 86016
 s_add_u32 s45, s33, 3276800
 buffer_load_dwordx4 v11, s[16:19], s45 offen  lds
 ds_read_b64_tr_b16 a[36:37], v8 offset:16384
 ds_read_b64_tr_b16 a[38:39], v8 offset:17408
 ds_read_b64_tr_b16 a[108:109], v9 offset:16384
 ds_read_b64_tr_b16 a[110:111], v9 offset:17408
 ds_read_b64_tr_b16 a[180:181], v8 offset:24576
 ds_read_b64_tr_b16 a[182:183], v8 offset:25600
 ds_read_b64_tr_b16 a[252:253], v9 offset:24576
 ds_read_b64_tr_b16 a[254:255], v9 offset:25600
 s_waitcnt vmcnt(8) lgkmcnt(0)
 s_barrier
 s_add_u32 m0, s49, 90112
 s_add_u32 s45, s32, 3407872
 buffer_load_dwordx4 v11, s[12:15], s45 offen  lds
 s_add_u32 m0, s49, 94208
 s_add_u32 s45, s32, 3538944
 buffer_load_dwordx4 v11, s[12:15], s45 offen  lds
 s_add_u32 m0, s49, 98304
 s_add_u32 s45, s33, 3407872
 buffer_load_dwordx4 v11, s[16:19], s45 offen  lds
 s_add_u32 m0, s49, 102400
 s_add_u32 s45, s33, 3538944
 buffer_load_dwordx4 v11, s[16:19], s45 offen  lds
 ds_read_b64_tr_b16 a[40:41], v8 offset:32768
 ds_read_b64_tr_b16 a[42:43], v8 offset:33792
 ds_read_b64_tr_b16 a[112:113], v9 offset:32768
 ds_read_b64_tr_b16 a[114:115], v9 offset:33792
 ds_read_b64_tr_b16 a[184:185], v8 offset:40960
 ds_read_b64_tr_b16 a[186:187], v8 offset:41984
 ds_read_b64_tr_b16 v[224:225], v9 offset:40960
 ds_read_b64_tr_b16 v[226:227], v9 offset:41984
 s_waitcnt vmcnt(8) lgkmcnt(0)
 s_barrier
 s_add_u32 m0, s49, 106496
 s_add_u32 s45, s32, 3670016
 buffer_load_dwordx4 v11, s[12:15], s45 offen  lds
 s_add_u32 m0, s49, 110592
 s_add_u32 s45, s32, 3801088
 buffer_load_dwordx4 v11, s[12:15], s45 offen  lds
 s_add_u32 m0, s49, 114688
 s_add_u32 s45, s33, 3670016
 buffer_load_dwordx4 v11, s[16:19], s45 offen  lds
 s_add_u32 m0, s49, 118784
 s_add_u32 s45, s33, 3801088
 buffer_load_dwordx4 v11, s[16:19], s45 offen  lds
 ds_read_b64_tr_b16 a[44:45], v8 offset:49152
 ds_read_b64_tr_b16 a[46:47], v8 offset:50176
 ds_read_b64_tr_b16 a[116:117], v9 offset:49152
 ds_read_b64_tr_b16 a[118:119], v9 offset:50176
 ds_read_b64_tr_b16 a[188:189], v8 offset:57344
 ds_read_b64_tr_b16 a[190:191], v8 offset:58368
 ds_read_b64_tr_b16 v[228:229], v9 offset:57344
 ds_read_b64_tr_b16 v[230:231], v9 offset:58368
 s_waitcnt vmcnt(8) lgkmcnt(0)
 s_barrier
 s_add_u32 m0, s49, 122880
 s_add_u32 s45, s32, 3932160
 buffer_load_dwordx4 v11, s[12:15], s45 offen  lds
 s_add_u32 m0, s49, 126976
 s_add_u32 s45, s32, 4063232
 buffer_load_dwordx4 v11, s[12:15], s45 offen  lds
 s_add_u32 m0, s49, 131072
 s_add_u32 s45, s33, 3932160
 buffer_load_dwordx4 v11, s[16:19], s45 offen  lds
 s_add_u32 m0, s49, 135168
 s_add_u32 s45, s33, 4063232
 buffer_load_dwordx4 v11, s[16:19], s45 offen  lds
 ds_read_b64_tr_b16 a[48:49], v8 offset:0
 ds_read_b64_tr_b16 a[50:51], v8 offset:1024
 ds_read_b64_tr_b16 a[120:121], v9 offset:0
 ds_read_b64_tr_b16 a[122:123], v9 offset:1024
 ds_read_b64_tr_b16 a[192:193], v8 offset:8192
 ds_read_b64_tr_b16 a[194:195], v8 offset:9216
 ds_read_b64_tr_b16 v[232:233], v9 offset:8192
 ds_read_b64_tr_b16 v[234:235], v9 offset:9216
 s_waitcnt vmcnt(8) lgkmcnt(0)
 s_barrier
 s_add_u32 m0, s49, 73728
 s_add_u32 s45, s32, 4194304
 buffer_load_dwordx4 v11, s[12:15], s45 offen  lds
 s_add_u32 m0, s49, 77824
 s_add_u32 s45, s32, 4325376
 buffer_load_dwordx4 v11, s[12:15], s45 offen  lds
 s_add_u32 m0, s49, 81920
 s_add_u32 s45, s33, 4194304
 buffer_load_dwordx4 v11, s[16:19], s45 offen  lds
 s_add_u32 m0, s49, 86016
 s_add_u32 s45, s33, 4325376
 buffer_load_dwordx4 v11, s[16:19], s45 offen  lds
 ds_read_b64_tr_b16 a[52:53], v8 offset:16384
 ds_read_b64_tr_b16 a[54:55], v8 offset:17408
 ds_read_b64_tr_b16 a[124:125], v9 offset:16384
 ds_read_b64_tr_b16 a[126:127], v9 offset:17408
 ds_read_b64_tr_b16 a[196:197], v8 offset:24576
 ds_read_b64_tr_b16 a[198:199], v8 offset:25600
 ds_read_b64_tr_b16 v[236:237], v9 offset:24576
 ds_read_b64_tr_b16 v[238:239], v9 offset:25600
 s_waitcnt vmcnt(8) lgkmcnt(0)
 s_barrier
 s_add_u32 m0, s49, 90112
 s_add_u32 s45, s32, 4456448
 buffer_load_dwordx4 v11, s[12:15], s45 offen  lds
 s_add_u32 m0, s49, 94208
 s_add_u32 s45, s32, 4587520
 buffer_load_dwordx4 v11, s[12:15], s45 offen  lds
 s_add_u32 m0, s49, 98304
 s_add_u32 s45, s33, 4456448
 buffer_load_dwordx4 v11, s[16:19], s45 offen  lds
 s_add_u32 m0, s49, 102400
 s_add_u32 s45, s33, 4587520
 buffer_load_dwordx4 v11, s[16:19], s45 offen  lds
 ds_read_b64_tr_b16 a[56:57], v8 offset:32768
 ds_read_b64_tr_b16 a[58:59], v8 offset:33792
 ds_read_b64_tr_b16 a[128:129], v9 offset:32768
 ds_read_b64_tr_b16 a[130:131], v9 offset:33792
 ds_read_b64_tr_b16 a[200:201], v8 offset:40960
 ds_read_b64_tr_b16 a[202:203], v8 offset:41984
 ds_read_b64_tr_b16 v[240:241], v9 offset:40960
 ds_read_b64_tr_b16 v[242:243], v9 offset:41984
 s_waitcnt vmcnt(8) lgkmcnt(0)
 s_barrier
 ds_read_b64_tr_b16 a[60:61], v8 offset:49152
 ds_read_b64_tr_b16 a[62:63], v8 offset:50176
 ds_read_b64_tr_b16 a[132:133], v9 offset:49152
 ds_read_b64_tr_b16 a[134:135], v9 offset:50176
 ds_read_b64_tr_b16 a[204:205], v8 offset:57344
 ds_read_b64_tr_b16 a[206:207], v8 offset:58368
 ds_read_b64_tr_b16 v[244:245], v9 offset:57344
 ds_read_b64_tr_b16 v[246:247], v9 offset:58368
 s_waitcnt vmcnt(4) lgkmcnt(0)
 s_barrier
 ds_read_b64_tr_b16 a[64:65], v8 offset:0
 ds_read_b64_tr_b16 a[66:67], v8 offset:1024
 ds_read_b64_tr_b16 a[136:137], v9 offset:0
 ds_read_b64_tr_b16 a[138:139], v9 offset:1024
 ds_read_b64_tr_b16 a[208:209], v8 offset:8192
 ds_read_b64_tr_b16 a[210:211], v8 offset:9216
 ds_read_b64_tr_b16 v[248:249], v9 offset:8192
 ds_read_b64_tr_b16 v[250:251], v9 offset:9216
 s_waitcnt vmcnt(0) lgkmcnt(0)
 s_barrier
 ds_read_b64_tr_b16 a[68:69], v8 offset:16384
 ds_read_b64_tr_b16 a[70:71], v8 offset:17408
 ds_read_b64_tr_b16 a[140:141], v9 offset:16384
 ds_read_b64_tr_b16 a[142:143], v9 offset:17408
 ds_read_b64_tr_b16 a[212:213], v8 offset:24576
 ds_read_b64_tr_b16 a[214:215], v8 offset:25600
 ds_read_b64_tr_b16 v[252:253], v9 offset:24576
 ds_read_b64_tr_b16 v[254:255], v9 offset:25600
 s_mov_b32 s50, 0x3e0293ee
 s_mov_b32 s42, 0
 s_mov_b32 s43, 0
 s_mov_b32 s44, 73728
 v_mov_b32 v6, v4
 v_mov_b32 v7, v5
Lrh_25:
 v_mbcnt_lo_u32_b32 v21, -1, 0
 v_min_u32 v21, 1, v21
 v_lshlrev_b32 v21, 28, v21
 buffer_load_dword v20, v21, s[28:31], 0 offen offset:4 sc1
 s_waitcnt vmcnt(0)
Lrhc_26:
 v_readfirstlane_b32 s89, v20
 s_cmp_eq_u32 s89, s88
 s_cbranch_scc1 Lrhk_27
 s_cmp_lg_u32 s89, 0
 s_cbranch_scc1 Lredo
 s_sub_u32 s95, s95, 1
 s_cbranch_scc0 Lrh_25
 s_endpgm
Lrhk_27:
 s_cmp_lg_u32 s4, 0
 s_cbranch_scc1 Lfrk_24
 v_min_u32 v21, 1, v0
 v_lshlrev_b32 v21, 28, v21
Lfr_23:
 buffer_load_dword v20, v21, s[28:31], 0 offen offset:0 sc1
 s_waitcnt vmcnt(0)
 v_cmp_eq_u32 vcc, 1, v20
 s_cbranch_vccnz Lfrk_24
 s_sub_u32 s95, s95, 1
 s_cbranch_scc0 Lfr_23
 s_endpgm
Lfrk_24:
 s_lshl_b32 s47, s2, 13
 s_add_u32 s47, s47, 0x8000000
 s_mov_b32 s48, s47
 v_mov_b32 v14, 0
 s_waitcnt vmcnt(0) lgkmcnt(0)
 s_barrier
 ds_read_b128 v[32:35], v6 offset:0
 ds_read_b128 v[36:39], v6 offset:2048
 ds_read_b128 v[40:43], v7 offset:0
 ds_read_b128 v[44:47], v7 offset:2048
 v_lshlrev_b32 v1, 12, v0
 s_lshl_b32 s45, s6, 7
 buffer_load_dword v15, v1, s[8:11], s45 offen
 v_add_u32 v1, 0x100000, v1
 buffer_load_dword v15, v1, s[8:11], s45 offen
 v_add_u32 v1, 0x100000, v1
 buffer_load_dword v15, v1, s[8:11], s45 offen
 v_add_u32 v1, 0x100000, v1
 s_waitcnt lgkmcnt(2)
Lps_loop_28:
 v_mfma_f32_16x16x32_bf16 v[64:67], a[0:3], v[32:35], 0
 ds_read_b128 v[48:51], v6 offset:4096
 v_mfma_f32_16x16x32_bf16 v[72:75], a[72:75], v[32:35], 0
 ds_read_b128 v[52:55], v6 offset:6144
 v_mfma_f32_16x16x32_bf16 v[80:83], v[32:35], a[144:147], 0
 s_add_u32 s41, s40, 1
 v_mfma_f32_16x16x32_bf16 v[88:91], v[32:35], a[216:219], 0
 s_add_u32 s45, s42, 2
 s_mul_i32 s46, s41, 36864
 v_mfma_f32_16x16x32_bf16 v[68:71], a[0:3], v[36:39], 0
 s_cmp_lt_u32 s45, s36
 s_cselect_b32 s46, s46, 0
 v_mfma_f32_16x16x32_bf16 v[76:79], a[72:75], v[36:39], 0
 s_lshl_b32 s49, s4, 10
 s_add_u32 s49, s49, s44
 v_mfma_f32_16x16x32_bf16 v[84:87], v[36:39], a[144:147], 0
 v_mul_f32 v96, s50, v96
 v_mul_f32 v97, s50, v97
 v_mfma_f32_16x16x32_bf16 v[92:95], v[36:39], a[216:219], 0
 s_waitcnt lgkmcnt(2)
 v_mfma_f32_16x16x32_bf16 v[64:67], a[4:7], v[40:43], v[64:67]
 ds_read_b128 v[56:59], v7 offset:4096
 v_mul_f32 v98, s50, v98
 v_mfma_f32_16x16x32_bf16 v[72:75], a[76:79], v[40:43], v[72:75]
 ds_read_b128 v[60:63], v7 offset:6144
 v_mul_f32 v99, s50, v99
 v_mfma_f32_16x16x32_bf16 v[80:83], v[40:43], a[148:151], v[80:83]
 v_mul_f32 v104, s50, v104
 v_mfma_f32_16x16x32_bf16 v[88:91], v[40:43], a[220:223], v[88:91]
 v_mul_f32 v105, s50, v105
 v_mfma_f32_16x16x32_bf16 v[68:71], a[4:7], v[44:47], v[68:71]
 v_mul_f32 v106, s50, v106
 v_mul_f32 v107, s50, v107
 v_mfma_f32_16x16x32_bf16 v[76:79], a[76:79], v[44:47], v[76:79]
 v_cvt_pk_bf16_f32 v16, v96, v104
 v_mfma_f32_16x16x32_bf16 v[84:87], v[44:47], a[148:151], v[84:87]
 v_cvt_pk_bf16_f32 v17, v97, v105
 v_mfma_f32_16x16x32_bf16 v[92:95], v[44:47], a[220:223], v[92:95]
 s_waitcnt lgkmcnt(2)
 v_cvt_pk_bf16_f32 v18, v98, v106
 v_mfma_f32_16x16x32_bf16 v[64:67], a[8:11], v[48:51], v[64:67]
 ds_read_b128 v[32:35], v6 offset:8192
 v_cvt_pk_bf16_f32 v19, v99, v107
 v_mfma_f32_16x16x32_bf16 v[72:75], a[80:83], v[48:51], v[72:75]
 ds_read_b128 v[36:39], v6 offset:10240
 v_mfma_f32_16x16x32_bf16 v[80:83], v[48:51], a[152:155], v[80:83]
 buffer_store_dwordx4 v[16:19], v12, s[20:23], s47 offen offset:0 sc1
 v_mul_f32 v100, s50, v100
 v_mfma_f32_16x16x32_bf16 v[88:91], v[48:51], a[224:227], v[88:91]
 v_mul_f32 v101, s50, v101
 v_mfma_f32_16x16x32_bf16 v[68:71], a[8:11], v[52:55], v[68:71]
 v_mul_f32 v102, s50, v102
 v_mfma_f32_16x16x32_bf16 v[76:79], a[80:83], v[52:55], v[76:79]
 v_mul_f32 v103, s50, v103
 v_mul_f32 v108, s50, v108
 v_mfma_f32_16x16x32_bf16 v[84:87], v[52:55], a[152:155], v[84:87]
 v_mul_f32 v109, s50, v109
 v_mfma_f32_16x16x32_bf16 v[92:95], v[52:55], a[224:227], v[92:95]
 s_waitcnt lgkmcnt(2)
 v_mfma_f32_16x16x32_bf16 v[64:67], a[12:15], v[56:59], v[64:67]
 ds_read_b128 v[40:43], v7 offset:8192
 v_mul_f32 v110, s50, v110
 v_mfma_f32_16x16x32_bf16 v[72:75], a[84:87], v[56:59], v[72:75]
 ds_read_b128 v[44:47], v7 offset:10240
 v_mul_f32 v111, s50, v111
 v_mfma_f32_16x16x32_bf16 v[80:83], v[56:59], a[156:159], v[80:83]
 v_cvt_pk_bf16_f32 v20, v100, v108
 v_mfma_f32_16x16x32_bf16 v[88:91], v[56:59], a[228:231], v[88:91]
 v_cvt_pk_bf16_f32 v21, v101, v109
 v_mfma_f32_16x16x32_bf16 v[68:71], a[12:15], v[60:63], v[68:71]
 v_cvt_pk_bf16_f32 v22, v102, v110
 v_cvt_pk_bf16_f32 v23, v103, v111
 v_mfma_f32_16x16x32_bf16 v[76:79], a[84:87], v[60:63], v[76:79]
 buffer_store_dwordx4 v[20:23], v12, s[20:23], s47 offen offset:1024 sc1
 v_mfma_f32_16x16x32_bf16 v[84:87], v[60:63], a[156:159], v[84:87]
 v_cvt_pk_bf16_f32 v24, v112, v113
 v_mfma_f32_16x16x32_bf16 v[92:95], v[60:63], a[228:231], v[92:95]
 s_waitcnt lgkmcnt(2)
 v_cvt_pk_bf16_f32 v25, v116, v117
 v_mfma_f32_16x16x32_bf16 v[64:67], a[16:19], v[32:35], v[64:67]
 ds_read_b128 v[48:51], v6 offset:12288
 v_cvt_pk_bf16_f32 v26, v114, v115
 v_mfma_f32_16x16x32_bf16 v[72:75], a[88:91], v[32:35], v[72:75]
 ds_read_b128 v[52:55], v6 offset:14336
 v_mfma_f32_16x16x32_bf16 v[80:83], v[32:35], a[160:163], v[80:83]
 v_cvt_pk_bf16_f32 v27, v118, v119
 buffer_store_dwordx4 v[24:27], v12, s[20:23], s48 offen offset:0 sc1
 v_mfma_f32_16x16x32_bf16 v[88:91], v[32:35], a[232:235], v[88:91]
 v_cvt_pk_bf16_f32 v28, v120, v121
 v_mfma_f32_16x16x32_bf16 v[68:71], a[16:19], v[36:39], v[68:71]
 v_cvt_pk_bf16_f32 v29, v124, v125
 v_mfma_f32_16x16x32_bf16 v[76:79], a[88:91], v[36:39], v[76:79]
 v_cvt_pk_bf16_f32 v30, v122, v123
 v_cvt_pk_bf16_f32 v31, v126, v127
 v_mfma_f32_16x16x32_bf16 v[84:87], v[36:39], a[160:163], v[84:87]
 buffer_store_dwordx4 v[28:31], v12, s[20:23], s48 offen offset:1024 sc1
 v_mfma_f32_16x16x32_bf16 v[92:95], v[36:39], a[232:235], v[92:95]
 s_waitcnt lgkmcnt(2)
 v_mfma_f32_16x16x32_bf16 v[64:67], a[20:23], v[40:43], v[64:67]
 ds_read_b128 v[56:59], v7 offset:12288
 v_mfma_f32_16x16x32_bf16 v[72:75], a[92:95], v[40:43], v[72:75]
 ds_read_b128 v[60:63], v7 offset:14336
 v_mfma_f32_16x16x32_bf16 v[80:83], v[40:43], a[164:167], v[80:83]
 s_add_u32 m0, s49, 0
 v_mfma_f32_16x16x32_bf16 v[88:91], v[40:43], a[236:239], v[88:91]
 buffer_load_dwordx4 v10, s[8:11], s46 offen offset:0  lds
 v_mfma_f32_16x16x32_bf16 v[68:71], a[20:23], v[44:47], v[68:71]
 s_add_u32 m0, s49, 3968
 v_mfma_f32_16x16x32_bf16 v[76:79], a[92:95], v[44:47], v[76:79]
 buffer_load_dwordx4 v10, s[8:11], s46 offen offset:128  lds
 v_mfma_f32_16x16x32_bf16 v[84:87], v[44:47], a[164:167], v[84:87]
 v_mfma_f32_16x16x32_bf16 v[92:95], v[44:47], a[236:239], v[92:95]
 s_waitcnt lgkmcnt(2)
 v_mfma_f32_16x16x32_bf16 v[64:67], a[24:27], v[48:51], v[64:67]
 ds_read_b128 v[32:35], v6 offset:16384
 v_mfma_f32_16x16x32_bf16 v[72:75], a[96:99], v[48:51], v[72:75]
 ds_read_b128 v[36:39], v6 offset:18432
 v_mfma_f32_16x16x32_bf16 v[80:83], v[48:51], a[168:171], v[80:83]
 s_add_u32 m0, s49, 7936
 v_mfma_f32_16x16x32_bf16 v[88:91], v[48:51], a[240:243], v[88:91]
 buffer_load_dwordx4 v10, s[8:11], s46 offen offset:256  lds
 v_mfma_f32_16x16x32_bf16 v[68:71], a[24:27], v[52:55], v[68:71]
 s_add_u32 m0, s49, 11904
 v_mfma_f32_16x16x32_bf16 v[76:79], a[96:99], v[52:55], v[76:79]
 buffer_load_dwordx4 v10, s[8:11], s46 offen offset:384  lds
 v_mfma_f32_16x16x32_bf16 v[84:87], v[52:55], a[168:171], v[84:87]
 v_mfma_f32_16x16x32_bf16 v[92:95], v[52:55], a[240:243], v[92:95]
 s_waitcnt lgkmcnt(2)
 v_mfma_f32_16x16x32_bf16 v[64:67], a[28:31], v[56:59], v[64:67]
 ds_read_b128 v[40:43], v7 offset:16384
 v_mfma_f32_16x16x32_bf16 v[72:75], a[100:103], v[56:59], v[72:75]
 ds_read_b128 v[44:47], v7 offset:18432
 v_mfma_f32_16x16x32_bf16 v[80:83], v[56:59], a[172:175], v[80:83]
 s_add_u32 m0, s49, 15872
 v_mfma_f32_16x16x32_bf16 v[88:91], v[56:59], a[244:247], v[88:91]
 buffer_load_dwordx4 v10, s[8:11], s46 offen offset:512  lds
 v_mfma_f32_16x16x32_bf16 v[68:71], a[28:31], v[60:63], v[68:71]
 s_add_u32 m0, s49, 19840
 v_mfma_f32_16x16x32_bf16 v[76:79], a[100:103], v[60:63], v[76:79]
 buffer_load_dwordx4 v10, s[8:11], s46 offen offset:640  lds
 v_mfma_f32_16x16x32_bf16 v[84:87], v[60:63], a[172:175], v[84:87]
 v_mfma_f32_16x16x32_bf16 v[92:95], v[60:63], a[244:247], v[92:95]
 s_waitcnt lgkmcnt(2)
 v_mfma_f32_16x16x32_bf16 v[64:67], a[32:35], v[32:35], v[64:67]
 ds_read_b128 v[48:51], v6 offset:20480
 v_mfma_f32_16x16x32_bf16 v[72:75], a[104:107], v[32:35], v[72:75]
 ds_read_b128 v[52:55], v6 offset:22528
 v_mfma_f32_16x16x32_bf16 v[80:83], v[32:35], a[176:179], v[80:83]
 s_add_u32 m0, s49, 23808
 v_mfma_f32_16x16x32_bf16 v[88:91], v[32:35], a[248:251], v[88:91]
 buffer_load_dwordx4 v10, s[8:11], s46 offen offset:768  lds
 v_mfma_f32_16x16x32_bf16 v[68:71], a[32:35], v[36:39], v[68:71]
 s_add_u32 m0, s49, 27776
 v_mfma_f32_16x16x32_bf16 v[76:79], a[104:107], v[36:39], v[76:79]
 buffer_load_dwordx4 v10, s[8:11], s46 offen offset:896  lds
 v_mfma_f32_16x16x32_bf16 v[84:87], v[36:39], a[176:179], v[84:87]
 v_mfma_f32_16x16x32_bf16 v[92:95], v[36:39], a[248:251], v[92:95]
 s_waitcnt lgkmcnt(2)
 v_mfma_f32_16x16x32_bf16 v[64:67], a[36:39], v[40:43], v[64:67]
 ds_read_b128 v[56:59], v7 offset:20480
 v_mfma_f32_16x16x32_bf16 v[72:75], a[108:111], v[40:43], v[72:75]
 ds_read_b128 v[60:63], v7 offset:22528
 v_mfma_f32_16x16x32_bf16 v[80:83], v[40:43], a[180:183], v[80:83]
 s_add_u32 m0, s49, 31744
 v_mfma_f32_16x16x32_bf16 v[88:91], v[40:43], a[252:255], v[88:91]
 buffer_load_dwordx4 v10, s[8:11], s46 offen offset:1024  lds
 v_mfma_f32_16x16x32_bf16 v[68:71], a[36:39], v[44:47], v[68:71]
 v_mfma_f32_16x16x32_bf16 v[76:79], a[108:111], v[44:47], v[76:79]
 v_mfma_f32_16x16x32_bf16 v[84:87], v[44:47], a[180:183], v[84:87]
 v_mfma_f32_16x16x32_bf16 v[92:95], v[44:47], a[252:255], v[92:95]
 s_waitcnt lgkmcnt(2)
 v_mfma_f32_16x16x32_bf16 v[64:67], a[40:43], v[48:51], v[64:67]
 ds_read_b128 v[32:35], v6 offset:24576
 v_mfma_f32_16x16x32_bf16 v[72:75], a[112:115], v[48:51], v[72:75]
 ds_read_b128 v[36:39], v6 offset:26624
 v_mfma_f32_16x16x32_bf16 v[80:83], v[48:51], a[184:187], v[80:83]
 v_mfma_f32_16x16x32_bf16 v[88:91], v[48:51], v[224:227], v[88:91]
 v_mfma_f32_16x16x32_bf16 v[68:71], a[40:43], v[52:55], v[68:71]
 v_mfma_f32_16x16x32_bf16 v[76:79], a[112:115], v[52:55], v[76:79]
 v_mfma_f32_16x16x32_bf16 v[84:87], v[52:55], a[184:187], v[84:87]
 v_mfma_f32_16x16x32_bf16 v[92:95], v[52:55], v[224:227], v[92:95]
 s_waitcnt lgkmcnt(2)
 v_mfma_f32_16x16x32_bf16 v[64:67], a[44:47], v[56:59], v[64:67]
 ds_read_b128 v[40:43], v7 offset:24576
 v_mfma_f32_16x16x32_bf16 v[72:75], a[116:119], v[56:59], v[72:75]
 ds_read_b128 v[44:47], v7 offset:26624
 v_mfma_f32_16x16x32_bf16 v[80:83], v[56:59], a[188:191], v[80:83]
 v_mfma_f32_16x16x32_bf16 v[88:91], v[56:59], v[228:231], v[88:91]
 v_mfma_f32_16x16x32_bf16 v[68:71], a[44:47], v[60:63], v[68:71]
 v_mfma_f32_16x16x32_bf16 v[76:79], a[116:119], v[60:63], v[76:79]
 v_mfma_f32_16x16x32_bf16 v[84:87], v[60:63], a[188:191], v[84:87]
 v_mfma_f32_16x16x32_bf16 v[92:95], v[60:63], v[228:231], v[92:95]
 s_waitcnt lgkmcnt(2)
 v_mfma_f32_16x16x32_bf16 v[64:67], a[48:51], v[32:35], v[64:67]
 ds_read_b128 v[48:51], v6 offset:28672
 v_mfma_f32_16x16x32_bf16 v[72:75], a[120:123], v[32:35], v[72:75]
 ds_read_b128 v[52:55], v6 offset:30720
 v_mfma_f32_16x16x32_bf16 v[80:83], v[32:35], a[192:195], v[80:83]
 v_mfma_f32_16x16x32_bf16 v[88:91], v[32:35], v[232:235], v[88:91]
 v_mfma_f32_16x16x32_bf16 v[68:71], a[48:51], v[36:39], v[68:71]
 v_mfma_f32_16x16x32_bf16 v[76:79], a[120:123], v[36:39], v[76:79]
 v_mfma_f32_16x16x32_bf16 v[84:87], v[36:39], a[192:195], v[84:87]
 v_mfma_f32_16x16x32_bf16 v[92:95], v[36:39], v[232:235], v[92:95]
 s_waitcnt lgkmcnt(2)
 v_mfma_f32_16x16x32_bf16 v[64:67], a[52:55], v[40:43], v[64:67]
 ds_read_b128 v[56:59], v7 offset:28672
 v_mfma_f32_16x16x32_bf16 v[72:75], a[124:127], v[40:43], v[72:75]
 ds_read_b128 v[60:63], v7 offset:30720
 v_mfma_f32_16x16x32_bf16 v[80:83], v[40:43], a[196:199], v[80:83]
 s_add_u32 s43, s43, 36864
 s_cmp_eq_u32 s43, 147456
 v_mfma_f32_16x16x32_bf16 v[88:91], v[40:43], v[236:239], v[88:91]
 s_cselect_b32 s43, 0, s43
 s_add_u32 s44, s44, 36864
 v_mfma_f32_16x16x32_bf16 v[68:71], a[52:55], v[44:47], v[68:71]
 s_cmp_eq_u32 s44, 147456
 s_cselect_b32 s44, 0, s44
 v_mfma_f32_16x16x32_bf16 v[76:79], a[124:127], v[44:47], v[76:79]
 v_mfma_f32_16x16x32_bf16 v[84:87], v[44:47], a[196:199], v[84:87]
 v_mfma_f32_16x16x32_bf16 v[92:95], v[44:47], v[236:239], v[92:95]
 s_waitcnt lgkmcnt(2)
 v_mfma_f32_16x16x32_bf16 v[64:67], a[56:59], v[48:51], v[64:67]
 ds_read_b128 v[32:35], v6 offset:32768
 v_mfma_f32_16x16x32_bf16 v[72:75], a[128:131], v[48:51], v[72:75]
 ds_read_b128 v[36:39], v6 offset:34816
 v_mfma_f32_16x16x32_bf16 v[80:83], v[48:51], a[200:203], v[80:83]
 v_add_u32 v6, s43, v4
 v_mfma_f32_16x16x32_bf16 v[88:91], v[48:51], v[240:243], v[88:91]
 v_mfma_f32_16x16x32_bf16 v[68:71], a[56:59], v[52:55], v[68:71]
 v_mfma_f32_16x16x32_bf16 v[76:79], a[128:131], v[52:55], v[76:79]
 v_mfma_f32_16x16x32_bf16 v[84:87], v[52:55], a[200:203], v[84:87]
 v_mfma_f32_16x16x32_bf16 v[92:95], v[52:55], v[240:243], v[92:95]
 s_waitcnt lgkmcnt(2)
 v_mfma_f32_16x16x32_bf16 v[64:67], a[60:63], v[56:59], v[64:67]
 ds_read_b128 v[40:43], v7 offset:32768
 v_mfma_f32_16x16x32_bf16 v[72:75], a[132:135], v[56:59], v[72:75]
 ds_read_b128 v[44:47], v7 offset:34816
 v_mfma_f32_16x16x32_bf16 v[80:83], v[56:59], a[204:207], v[80:83]
 v_add_u32 v7, s43, v5
 v_mfma_f32_16x16x32_bf16 v[88:91], v[56:59], v[244:247], v[88:91]
 v_mfma_f32_16x16x32_bf16 v[68:71], a[60:63], v[60:63], v[68:71]
 v_mfma_f32_16x16x32_bf16 v[76:79], a[132:135], v[60:63], v[76:79]
 v_mfma_f32_16x16x32_bf16 v[84:87], v[60:63], a[204:207], v[84:87]
 v_mfma_f32_16x16x32_bf16 v[92:95], v[60:63], v[244:247], v[92:95]
 s_waitcnt lgkmcnt(2)
 v_mfma_f32_16x16x32_bf16 v[64:67], a[64:67], v[32:35], v[64:67]
 s_waitcnt vmcnt(9)
 s_barrier
 ds_read_b128 v[48:51], v6 offset:0
 v_mfma_f32_16x16x32_bf16 v[72:75], a[136:139], v[32:35], v[72:75]
 ds_read_b128 v[52:55], v6 offset:2048
 v_mfma_f32_16x16x32_bf16 v[80:83], v[32:35], a[208:211], v[80:83]
 buffer_store_dword v14, v13, s[20:23], 0 offen sc1
 v_mfma_f32_16x16x32_bf16 v[88:91], v[32:35], v[248:251], v[88:91]
 v_mfma_f32_16x16x32_bf16 v[68:71], a[64:67], v[36:39], v[68:71]
 v_mfma_f32_16x16x32_bf16 v[76:79], a[136:139], v[36:39], v[76:79]
 v_mfma_f32_16x16x32_bf16 v[84:87], v[36:39], a[208:211], v[84:87]
 v_mfma_f32_16x16x32_bf16 v[92:95], v[36:39], v[248:251], v[92:95]
 s_waitcnt lgkmcnt(2)
 v_mfma_f32_16x16x32_bf16 v[64:67], a[68:71], v[40:43], v[64:67]
 ds_read_b128 v[56:59], v7 offset:0
 v_mfma_f32_16x16x32_bf16 v[72:75], a[140:143], v[40:43], v[72:75]
 ds_read_b128 v[60:63], v7 offset:2048
 v_mfma_f32_16x16x32_bf16 v[80:83], v[40:43], a[212:215], v[80:83]
 s_mul_i32 s45, s39, 524288
 s_add_u32 s47, s34, s45
 v_mfma_f32_16x16x32_bf16 v[88:91], v[40:43], v[252:255], v[88:91]
 s_add_u32 s48, s35, s45
 v_add_u32 v14, 1, v14
 v_mfma_f32_16x16x32_bf16 v[68:71], a[68:71], v[44:47], v[68:71]
 s_mov_b32 s39, s40
 s_mov_b32 s40, s41
 v_mfma_f32_16x16x32_bf16 v[76:79], a[140:143], v[44:47], v[76:79]
 s_add_u32 s42, s42, 1
 v_mfma_f32_16x16x32_bf16 v[84:87], v[44:47], a[212:215], v[84:87]
 v_mfma_f32_16x16x32_bf16 v[92:95], v[44:47], v[252:255], v[92:95]
 s_waitcnt lgkmcnt(2)
 v_mfma_f32_16x16x32_bf16 v[96:99], a[0:3], v[48:51], 0
 ds_read_b128 v[32:35], v6 offset:4096
 v_mfma_f32_16x16x32_bf16 v[104:107], a[72:75], v[48:51], 0
 ds_read_b128 v[36:39], v6 offset:6144
 v_mfma_f32_16x16x32_bf16 v[112:115], v[48:51], a[144:147], 0
 s_add_u32 s41, s40, 1
 v_mfma_f32_16x16x32_bf16 v[120:123], v[48:51], a[216:219], 0
 s_add_u32 s45, s42, 2
 s_mul_i32 s46, s41, 36864
 v_mfma_f32_16x16x32_bf16 v[100:103], a[0:3], v[52:55], 0
 s_cmp_lt_u32 s45, s36
 s_cselect_b32 s46, s46, 0
 v_mfma_f32_16x16x32_bf16 v[108:111], a[72:75], v[52:55], 0
 s_lshl_b32 s49, s4, 10
 s_add_u32 s49, s49, s44
 v_mfma_f32_16x16x32_bf16 v[116:119], v[52:55], a[144:147], 0
 v_mul_f32 v64, s50, v64
 v_mul_f32 v65, s50, v65
 v_mfma_f32_16x16x32_bf16 v[124:127], v[52:55], a[216:219], 0
 s_waitcnt lgkmcnt(2)
 v_mfma_f32_16x16x32_bf16 v[96:99], a[4:7], v[56:59], v[96:99]
 ds_read_b128 v[40:43], v7 offset:4096
 v_mul_f32 v66, s50, v66
 v_mfma_f32_16x16x32_bf16 v[104:107], a[76:79], v[56:59], v[104:107]
 ds_read_b128 v[44:47], v7 offset:6144
 v_mul_f32 v67, s50, v67
 v_mfma_f32_16x16x32_bf16 v[112:115], v[56:59], a[148:151], v[112:115]
 v_mul_f32 v72, s50, v72
 v_mfma_f32_16x16x32_bf16 v[120:123], v[56:59], a[220:223], v[120:123]
 v_mul_f32 v73, s50, v73
 v_mfma_f32_16x16x32_bf16 v[100:103], a[4:7], v[60:63], v[100:103]
 v_mul_f32 v74, s50, v74
 v_mul_f32 v75, s50, v75
 v_mfma_f32_16x16x32_bf16 v[108:111], a[76:79], v[60:63], v[108:111]
 v_cvt_pk_bf16_f32 v16, v64, v72
 v_mfma_f32_16x16x32_bf16 v[116:119], v[60:63], a[148:151], v[116:119]
 v_cvt_pk_bf16_f32 v17, v65, v73
 v_mfma_f32_16x16x32_bf16 v[124:127], v[60:63], a[220:223], v[124:127]
 s_waitcnt lgkmcnt(2)
 v_cvt_pk_bf16_f32 v18, v66, v74
 v_mfma_f32_16x16x32_bf16 v[96:99], a[8:11], v[32:35], v[96:99]
 ds_read_b128 v[48:51], v6 offset:8192
 v_cvt_pk_bf16_f32 v19, v67, v75
 v_mfma_f32_16x16x32_bf16 v[104:107], a[80:83], v[32:35], v[104:107]
 ds_read_b128 v[52:55], v6 offset:10240
 v_mfma_f32_16x16x32_bf16 v[112:115], v[32:35], a[152:155], v[112:115]
 buffer_store_dwordx4 v[16:19], v12, s[20:23], s47 offen offset:0 sc1
 v_mul_f32 v68, s50, v68
 v_mfma_f32_16x16x32_bf16 v[120:123], v[32:35], a[224:227], v[120:123]
 v_mul_f32 v69, s50, v69
 v_mfma_f32_16x16x32_bf16 v[100:103], a[8:11], v[36:39], v[100:103]
 v_mul_f32 v70, s50, v70
 v_mfma_f32_16x16x32_bf16 v[108:111], a[80:83], v[36:39], v[108:111]
 v_mul_f32 v71, s50, v71
 v_mul_f32 v76, s50, v76
 v_mfma_f32_16x16x32_bf16 v[116:119], v[36:39], a[152:155], v[116:119]
 v_mul_f32 v77, s50, v77
 v_mfma_f32_16x16x32_bf16 v[124:127], v[36:39], a[224:227], v[124:127]
 s_waitcnt lgkmcnt(2)
 v_mfma_f32_16x16x32_bf16 v[96:99], a[12:15], v[40:43], v[96:99]
 ds_read_b128 v[56:59], v7 offset:8192
 v_mul_f32 v78, s50, v78
 v_mfma_f32_16x16x32_bf16 v[104:107], a[84:87], v[40:43], v[104:107]
 ds_read_b128 v[60:63], v7 offset:10240
 v_mul_f32 v79, s50, v79
 v_mfma_f32_16x16x32_bf16 v[112:115], v[40:43], a[156:159], v[112:115]
 v_cvt_pk_bf16_f32 v20, v68, v76
 v_mfma_f32_16x16x32_bf16 v[120:123], v[40:43], a[228:231], v[120:123]
 v_cvt_pk_bf16_f32 v21, v69, v77
 v_mfma_f32_16x16x32_bf16 v[100:103], a[12:15], v[44:47], v[100:103]
 v_cvt_pk_bf16_f32 v22, v70, v78
 v_cvt_pk_bf16_f32 v23, v71, v79
 v_mfma_f32_16x16x32_bf16 v[108:111], a[84:87], v[44:47], v[108:111]
 buffer_store_dwordx4 v[20:23], v12, s[20:23], s47 offen offset:1024 sc1
 v_mfma_f32_16x16x32_bf16 v[116:119], v[44:47], a[156:159], v[116:119]
 v_cvt_pk_bf16_f32 v24, v80, v81
 v_mfma_f32_16x16x32_bf16 v[124:127], v[44:47], a[228:231], v[124:127]
 s_waitcnt lgkmcnt(2)
 v_cvt_pk_bf16_f32 v25, v84, v85
 v_mfma_f32_16x16x32_bf16 v[96:99], a[16:19], v[48:51], v[96:99]
 ds_read_b128 v[32:35], v6 offset:12288
 v_cvt_pk_bf16_f32 v26, v82, v83
 v_mfma_f32_16x16x32_bf16 v[104:107], a[88:91], v[48:51], v[104:107]
 ds_read_b128 v[36:39], v6 offset:14336
 v_mfma_f32_16x16x32_bf16 v[112:115], v[48:51], a[160:163], v[112:115]
 v_cvt_pk_bf16_f32 v27, v86, v87
 buffer_store_dwordx4 v[24:27], v12, s[20:23], s48 offen offset:0 sc1
 v_mfma_f32_16x16x32_bf16 v[120:123], v[48:51], a[232:235], v[120:123]
 v_cvt_pk_bf16_f32 v28, v88, v89
 v_mfma_f32_16x16x32_bf16 v[100:103], a[16:19], v[52:55], v[100:103]
 v_cvt_pk_bf16_f32 v29, v92, v93
 v_mfma_f32_16x16x32_bf16 v[108:111], a[88:91], v[52:55], v[108:111]
 v_cvt_pk_bf16_f32 v30, v90, v91
 v_cvt_pk_bf16_f32 v31, v94, v95
 v_mfma_f32_16x16x32_bf16 v[116:119], v[52:55], a[160:163], v[116:119]
 buffer_store_dwordx4 v[28:31], v12, s[20:23], s48 offen offset:1024 sc1
 v_mfma_f32_16x16x32_bf16 v[124:127], v[52:55], a[232:235], v[124:127]
 s_waitcnt lgkmcnt(2)
 v_mfma_f32_16x16x32_bf16 v[96:99], a[20:23], v[56:59], v[96:99]
 ds_read_b128 v[40:43], v7 offset:12288
 v_mfma_f32_16x16x32_bf16 v[104:107], a[92:95], v[56:59], v[104:107]
 ds_read_b128 v[44:47], v7 offset:14336
 v_mfma_f32_16x16x32_bf16 v[112:115], v[56:59], a[164:167], v[112:115]
 s_add_u32 m0, s49, 0
 v_mfma_f32_16x16x32_bf16 v[120:123], v[56:59], a[236:239], v[120:123]
 buffer_load_dwordx4 v10, s[8:11], s46 offen offset:0  lds
 v_mfma_f32_16x16x32_bf16 v[100:103], a[20:23], v[60:63], v[100:103]
 s_add_u32 m0, s49, 3968
 v_mfma_f32_16x16x32_bf16 v[108:111], a[92:95], v[60:63], v[108:111]
 buffer_load_dwordx4 v10, s[8:11], s46 offen offset:128  lds
 v_mfma_f32_16x16x32_bf16 v[116:119], v[60:63], a[164:167], v[116:119]
 v_mfma_f32_16x16x32_bf16 v[124:127], v[60:63], a[236:239], v[124:127]
 s_waitcnt lgkmcnt(2)
 v_mfma_f32_16x16x32_bf16 v[96:99], a[24:27], v[32:35], v[96:99]
 ds_read_b128 v[48:51], v6 offset:16384
 v_mfma_f32_16x16x32_bf16 v[104:107], a[96:99], v[32:35], v[104:107]
 ds_read_b128 v[52:55], v6 offset:18432
 v_mfma_f32_16x16x32_bf16 v[112:115], v[32:35], a[168:171], v[112:115]
 s_add_u32 m0, s49, 7936
 v_mfma_f32_16x16x32_bf16 v[120:123], v[32:35], a[240:243], v[120:123]
 buffer_load_dwordx4 v10, s[8:11], s46 offen offset:256  lds
 v_mfma_f32_16x16x32_bf16 v[100:103], a[24:27], v[36:39], v[100:103]
 s_add_u32 m0, s49, 11904
 v_mfma_f32_16x16x32_bf16 v[108:111], a[96:99], v[36:39], v[108:111]
 buffer_load_dwordx4 v10, s[8:11], s46 offen offset:384  lds
 v_mfma_f32_16x16x32_bf16 v[116:119], v[36:39], a[168:171], v[116:119]
 v_mfma_f32_16x16x32_bf16 v[124:127], v[36:39], a[240:243], v[124:127]
 s_waitcnt lgkmcnt(2)
 v_mfma_f32_16x16x32_bf16 v[96:99], a[28:31], v[40:43], v[96:99]
 ds_read_b128 v[56:59], v7 offset:16384
 v_mfma_f32_16x16x32_bf16 v[104:107], a[100:103], v[40:43], v[104:107]
 ds_read_b128 v[60:63], v7 offset:18432
 v_mfma_f32_16x16x32_bf16 v[112:115], v[40:43], a[172:175], v[112:115]
 s_add_u32 m0, s49, 15872
 v_mfma_f32_16x16x32_bf16 v[120:123], v[40:43], a[244:247], v[120:123]
 buffer_load_dwordx4 v10, s[8:11], s46 offen offset:512  lds
 v_mfma_f32_16x16x32_bf16 v[100:103], a[28:31], v[44:47], v[100:103]
 s_add_u32 m0, s49, 19840
 v_mfma_f32_16x16x32_bf16 v[108:111], a[100:103], v[44:47], v[108:111]
 buffer_load_dwordx4 v10, s[8:11], s46 offen offset:640  lds
 v_mfma_f32_16x16x32_bf16 v[116:119], v[44:47], a[172:175], v[116:119]
 v_mfma_f32_16x16x32_bf16 v[124:127], v[44:47], a[244:247], v[124:127]
 s_waitcnt lgkmcnt(2)
 v_mfma_f32_16x16x32_bf16 v[96:99], a[32:35], v[48:51], v[96:99]
 ds_read_b128 v[32:35], v6 offset:20480
 v_mfma_f32_16x16x32_bf16 v[104:107], a[104:107], v[48:51], v[104:107]
 ds_read_b128 v[36:39], v6 offset:22528
 v_mfma_f32_16x16x32_bf16 v[112:115], v[48:51], a[176:179], v[112:115]
 s_add_u32 m0, s49, 23808
 v_mfma_f32_16x16x32_bf16 v[120:123], v[48:51], a[248:251], v[120:123]
 buffer_load_dwordx4 v10, s[8:11], s46 offen offset:768  lds
 v_mfma_f32_16x16x32_bf16 v[100:103], a[32:35], v[52:55], v[100:103]
 s_add_u32 m0, s49, 27776
 v_mfma_f32_16x16x32_bf16 v[108:111], a[104:107], v[52:55], v[108:111]
 buffer_load_dwordx4 v10, s[8:11], s46 offen offset:896  lds
 v_mfma_f32_16x16x32_bf16 v[116:119], v[52:55], a[176:179], v[116:119]
 v_mfma_f32_16x16x32_bf16 v[124:127], v[52:55], a[248:251], v[124:127]
 s_waitcnt lgkmcnt(2)
 v_mfma_f32_16x16x32_bf16 v[96:99], a[36:39], v[56:59], v[96:99]
 ds_read_b128 v[40:43], v7 offset:20480
 v_mfma_f32_16x16x32_bf16 v[104:107], a[108:111], v[56:59], v[104:107]
 ds_read_b128 v[44:47], v7 offset:22528
 v_mfma_f32_16x16x32_bf16 v[112:115], v[56:59], a[180:183], v[112:115]
 s_add_u32 m0, s49, 31744
 v_mfma_f32_16x16x32_bf16 v[120:123], v[56:59], a[252:255], v[120:123]
 buffer_load_dwordx4 v10, s[8:11], s46 offen offset:1024  lds
 v_mfma_f32_16x16x32_bf16 v[100:103], a[36:39], v[60:63], v[100:103]
 v_mfma_f32_16x16x32_bf16 v[108:111], a[108:111], v[60:63], v[108:111]
 v_mfma_f32_16x16x32_bf16 v[116:119], v[60:63], a[180:183], v[116:119]
 v_mfma_f32_16x16x32_bf16 v[124:127], v[60:63], a[252:255], v[124:127]
 s_waitcnt lgkmcnt(2)
 v_mfma_f32_16x16x32_bf16 v[96:99], a[40:43], v[32:35], v[96:99]
 ds_read_b128 v[48:51], v6 offset:24576
 v_mfma_f32_16x16x32_bf16 v[104:107], a[112:115], v[32:35], v[104:107]
 ds_read_b128 v[52:55], v6 offset:26624
 v_mfma_f32_16x16x32_bf16 v[112:115], v[32:35], a[184:187], v[112:115]
 v_mfma_f32_16x16x32_bf16 v[120:123], v[32:35], v[224:227], v[120:123]
 v_mfma_f32_16x16x32_bf16 v[100:103], a[40:43], v[36:39], v[100:103]
 v_mfma_f32_16x16x32_bf16 v[108:111], a[112:115], v[36:39], v[108:111]
 v_mfma_f32_16x16x32_bf16 v[116:119], v[36:39], a[184:187], v[116:119]
 v_mfma_f32_16x16x32_bf16 v[124:127], v[36:39], v[224:227], v[124:127]
 s_waitcnt lgkmcnt(2)
 v_mfma_f32_16x16x32_bf16 v[96:99], a[44:47], v[40:43], v[96:99]
 ds_read_b128 v[56:59], v7 offset:24576
 v_mfma_f32_16x16x32_bf16 v[104:107], a[116:119], v[40:43], v[104:107]
 ds_read_b128 v[60:63], v7 offset:26624
 v_mfma_f32_16x16x32_bf16 v[112:115], v[40:43], a[188:191], v[112:115]
 v_mfma_f32_16x16x32_bf16 v[120:123], v[40:43], v[228:231], v[120:123]
 v_mfma_f32_16x16x32_bf16 v[100:103], a[44:47], v[44:47], v[100:103]
 v_mfma_f32_16x16x32_bf16 v[108:111], a[116:119], v[44:47], v[108:111]
 v_mfma_f32_16x16x32_bf16 v[116:119], v[44:47], a[188:191], v[116:119]
 v_mfma_f32_16x16x32_bf16 v[124:127], v[44:47], v[228:231], v[124:127]
 s_waitcnt lgkmcnt(2)
 v_mfma_f32_16x16x32_bf16 v[96:99], a[48:51], v[48:51], v[96:99]
 ds_read_b128 v[32:35], v6 offset:28672
 v_mfma_f32_16x16x32_bf16 v[104:107], a[120:123], v[48:51], v[104:107]
 ds_read_b128 v[36:39], v6 offset:30720
 v_mfma_f32_16x16x32_bf16 v[112:115], v[48:51], a[192:195], v[112:115]
 v_mfma_f32_16x16x32_bf16 v[120:123], v[48:51], v[232:235], v[120:123]
 v_mfma_f32_16x16x32_bf16 v[100:103], a[48:51], v[52:55], v[100:103]
 v_mfma_f32_16x16x32_bf16 v[108:111], a[120:123], v[52:55], v[108:111]
 v_mfma_f32_16x16x32_bf16 v[116:119], v[52:55], a[192:195], v[116:119]
 v_mfma_f32_16x16x32_bf16 v[124:127], v[52:55], v[232:235], v[124:127]
 s_waitcnt lgkmcnt(2)
 v_mfma_f32_16x16x32_bf16 v[96:99], a[52:55], v[56:59], v[96:99]
 ds_read_b128 v[40:43], v7 offset:28672
 v_mfma_f32_16x16x32_bf16 v[104:107], a[124:127], v[56:59], v[104:107]
 ds_read_b128 v[44:47], v7 offset:30720
 v_mfma_f32_16x16x32_bf16 v[112:115], v[56:59], a[196:199], v[112:115]
 s_add_u32 s43, s43, 36864
 s_cmp_eq_u32 s43, 147456
 v_mfma_f32_16x16x32_bf16 v[120:123], v[56:59], v[236:239], v[120:123]
 s_cselect_b32 s43, 0, s43
 s_add_u32 s44, s44, 36864
 v_mfma_f32_16x16x32_bf16 v[100:103], a[52:55], v[60:63], v[100:103]
 s_cmp_eq_u32 s44, 147456
 s_cselect_b32 s44, 0, s44
 v_mfma_f32_16x16x32_bf16 v[108:111], a[124:127], v[60:63], v[108:111]
 v_mfma_f32_16x16x32_bf16 v[116:119], v[60:63], a[196:199], v[116:119]
 v_mfma_f32_16x16x32_bf16 v[124:127], v[60:63], v[236:239], v[124:127]
 s_waitcnt lgkmcnt(2)
 v_mfma_f32_16x16x32_bf16 v[96:99], a[56:59], v[32:35], v[96:99]
 ds_read_b128 v[48:51], v6 offset:32768
 v_mfma_f32_16x16x32_bf16 v[104:107], a[128:131], v[32:35], v[104:107]
 ds_read_b128 v[52:55], v6 offset:34816
 v_mfma_f32_16x16x32_bf16 v[112:115], v[32:35], a[200:203], v[112:115]
 v_add_u32 v6, s43, v4
 v_mfma_f32_16x16x32_bf16 v[120:123], v[32:35], v[240:243], v[120:123]
 v_mfma_f32_16x16x32_bf16 v[100:103], a[56:59], v[36:39], v[100:103]
 v_mfma_f32_16x16x32_bf16 v[108:111], a[128:131], v[36:39], v[108:111]
 v_mfma_f32_16x16x32_bf16 v[116:119], v[36:39], a[200:203], v[116:119]
 v_mfma_f32_16x16x32_bf16 v[124:127], v[36:39], v[240:243], v[124:127]
 s_waitcnt lgkmcnt(2)
 v_mfma_f32_16x16x32_bf16 v[96:99], a[60:63], v[40:43], v[96:99]
 ds_read_b128 v[56:59], v7 offset:32768
 v_mfma_f32_16x16x32_bf16 v[104:107], a[132:135], v[40:43], v[104:107]
 ds_read_b128 v[60:63], v7 offset:34816
 v_mfma_f32_16x16x32_bf16 v[112:115], v[40:43], a[204:207], v[112:115]
 v_add_u32 v7, s43, v5
 v_mfma_f32_16x16x32_bf16 v[120:123], v[40:43], v[244:247], v[120:123]
 v_mfma_f32_16x16x32_bf16 v[100:103], a[60:63], v[44:47], v[100:103]
 v_mfma_f32_16x16x32_bf16 v[108:111], a[132:135], v[44:47], v[108:111]
 v_mfma_f32_16x16x32_bf16 v[116:119], v[44:47], a[204:207], v[116:119]
 v_mfma_f32_16x16x32_bf16 v[124:127], v[44:47], v[244:247], v[124:127]
 s_waitcnt lgkmcnt(2)
 v_mfma_f32_16x16x32_bf16 v[96:99], a[64:67], v[48:51], v[96:99]
 s_waitcnt vmcnt(9)
 s_barrier
 ds_read_b128 v[32:35], v6 offset:0
 v_mfma_f32_16x16x32_bf16 v[104:107], a[136:139], v[48:51], v[104:107]
 ds_read_b128 v[36:39], v6 offset:2048
 v_mfma_f32_16x16x32_bf16 v[112:115], v[48:51], a[208:211], v[112:115]
 buffer_store_dword v14, v13, s[20:23], 0 offen sc1
 v_mfma_f32_16x16x32_bf16 v[120:123], v[48:51], v[248:251], v[120:123]
 v_mfma_f32_16x16x32_bf16 v[100:103], a[64:67], v[52:55], v[100:103]
 v_mfma_f32_16x16x32_bf16 v[108:111], a[136:139], v[52:55], v[108:111]
 v_mfma_f32_16x16x32_bf16 v[116:119], v[52:55], a[208:211], v[116:119]
 v_mfma_f32_16x16x32_bf16 v[124:127], v[52:55], v[248:251], v[124:127]
 s_waitcnt lgkmcnt(2)
 v_mfma_f32_16x16x32_bf16 v[96:99], a[68:71], v[56:59], v[96:99]
 ds_read_b128 v[40:43], v7 offset:0
 v_mfma_f32_16x16x32_bf16 v[104:107], a[140:143], v[56:59], v[104:107]
 ds_read_b128 v[44:47], v7 offset:2048
 v_mfma_f32_16x16x32_bf16 v[112:115], v[56:59], a[212:215], v[112:115]
 s_mul_i32 s45, s39, 524288
 s_add_u32 s47, s34, s45
 v_mfma_f32_16x16x32_bf16 v[120:123], v[56:59], v[252:255], v[120:123]
 s_add_u32 s48, s35, s45
 v_add_u32 v14, 1, v14
 v_mfma_f32_16x16x32_bf16 v[100:103], a[68:71], v[60:63], v[100:103]
 s_mov_b32 s39, s40
 s_mov_b32 s40, s41
 v_mfma_f32_16x16x32_bf16 v[108:111], a[140:143], v[60:63], v[108:111]
 s_add_u32 s42, s42, 1
 s_cmp_lt_u32 s42, s36
 v_mfma_f32_16x16x32_bf16 v[116:119], v[60:63], a[212:215], v[116:119]
 v_mfma_f32_16x16x32_bf16 v[124:127], v[60:63], v[252:255], v[124:127]
 s_waitcnt lgkmcnt(2)
 s_cbranch_scc1 Lps_loop_28
 s_nop 7
 v_mul_f32 v96, s50, v96
 v_mul_f32 v97, s50, v97
 v_mul_f32 v98, s50, v98
 v_mul_f32 v99, s50, v99
 v_mul_f32 v104, s50, v104
 v_mul_f32 v105, s50, v105
 v_mul_f32 v106, s50, v106
 v_mul_f32 v107, s50, v107
 v_cvt_pk_bf16_f32 v16, v96, v104
 v_cvt_pk_bf16_f32 v17, v97, v105
 v_cvt_pk_bf16_f32 v18, v98, v106
 v_cvt_pk_bf16_f32 v19, v99, v107
 buffer_store_dwordx4 v[16:19], v12, s[20:23], s47 offen offset:0 sc1
 v_mul_f32 v100, s50, v100
 v_mul_f32 v101, s50, v101
 v_mul_f32 v102, s50, v102
 v_mul_f32 v103, s50, v103
 v_mul_f32 v108, s50, v108
 v_mul_f32 v109, s50, v109
 v_mul_f32 v110, s50, v110
 v_mul_f32 v111, s50, v111
 v_cvt_pk_bf16_f32 v20, v100, v108
 v_cvt_pk_bf16_f32 v21, v101, v109
 v_cvt_pk_bf16_f32 v22, v102, v110
 v_cvt_pk_bf16_f32 v23, v103, v111
 buffer_store_dwordx4 v[20:23], v12, s[20:23], s47 offen offset:1024 sc1
 v_cvt_pk_bf16_f32 v24, v112, v113
 v_cvt_pk_bf16_f32 v25, v116, v117
 v_cvt_pk_bf16_f32 v26, v114, v115
 v_cvt_pk_bf16_f32 v27, v118, v119
 buffer_store_dwordx4 v[24:27], v12, s[20:23], s48 offen offset:0 sc1
 v_cvt_pk_bf16_f32 v28, v120, v121
 v_cvt_pk_bf16_f32 v29, v124, v125
 v_cvt_pk_bf16_f32 v30, v122, v123
 v_cvt_pk_bf16_f32 v31, v126, v127
 buffer_store_dwordx4 v[28:31], v12, s[20:23], s48 offen offset:1024 sc1
 s_waitcnt vmcnt(0) lgkmcnt(0)
 s_barrier
 v_mov_b32 v14, s36
 buffer_store_dword v14, v13, s[20:23], 0 offen sc1
 s_branch Lfin
Lqa:
 s_load_dwordx2 s[8:9], s[0:1], 0
 s_mov_b32 s10, 0x240000
 s_mov_b32 s11, 0x20000
 s_load_dwordx2 s[12:13], s[0:1], 16
 s_mov_b32 s14, 0x480000
 s_mov_b32 s15, 0x20000
 s_load_dwordx2 s[16:17], s[0:1], 16
 s_mov_b32 s18, 0x480000
 s_mov_b32 s19, 0x20000
 s_lshl_b32 s7, s5, 5
 s_add_u32 s7, s7, s6
 s_cmp_eq_u32 s7, 127
 s_cbranch_scc0 Lqa1
Lrh_29:
 v_mbcnt_lo_u32_b32 v5, -1, 0
 v_min_u32 v5, 1, v5
 v_lshlrev_b32 v5, 28, v5
 buffer_load_dword v4, v5, s[28:31], 0 offen offset:4 sc1
 s_waitcnt vmcnt(0)
Lrhc_30:
 v_readfirstlane_b32 s89, v4
 s_cmp_eq_u32 s89, s88
 s_cbranch_scc1 Lrhk_31
 s_cmp_lg_u32 s89, 0
 s_cbranch_scc1 Lredo
 s_sub_u32 s95, s95, 1
 s_cbranch_scc0 Lrh_29
 s_endpgm
Lrhk_31:
 v_mov_b32 v4, 0
 v_mov_b32 v5, 0
 v_mov_b32 v6, 0
 v_mov_b32 v7, 0
 v_lshlrev_b32 v1, 4, v0
 s_mov_b32 s7, 0
 buffer_store_dwordx4 v[4:7], v1, s[20:23], s7 offen sc1
 s_mov_b32 s7, 4096
 buffer_store_dwordx4 v[4:7], v1, s[20:23], s7 offen sc1
 s_mov_b32 s7, 8192
 buffer_store_dwordx4 v[4:7], v1, s[20:23], s7 offen sc1
 s_mov_b32 s7, 12288
 buffer_store_dwordx4 v[4:7], v1, s[20:23], s7 offen sc1
 s_mov_b32 s7, 16384
 buffer_store_dwordx4 v[4:7], v1, s[20:23], s7 offen sc1
 v_min_u32 v1, 1, v0
 v_lshlrev_b32 v1, 28, v1
 v_mov_b32 v2, 1
 s_waitcnt vmcnt(0)
 s_barrier
 buffer_store_dword v2, v1, s[28:31], 0 offen sc1
Lqa1:
 s_sub_u32 s3, s5, 2
 s_lshl_b32 s3, s3, 3
 s_lshr_b32 s7, s6, 2
 s_add_u32 s3, s3, s7
 s_lshl_b32 s32, s3, 9
 s_add_u32 s33, s32, 256
 s_lshl_b32 s34, s3, 14
 s_add_u32 s34, s34, 0x5000000
 s_add_u32 s35, s34, 8192
 s_mov_b32 s36, 16
 s_and_b32 s37, s6, 3
 s_lshl_b32 s7, s3, 5
 s_add_u32 s7, s7, s37
 s_lshl_b32 s7, s7, 2
 s_add_u32 s7, s7, 0x3000
 v_min_u32 v1, 1, v0
 v_lshlrev_b32 v1, 28, v1
 v_add_u32 v13, s7, v1
 s_waitcnt lgkmcnt(0)
 v_and_b32 v1, 63, v0
 v_lshrrev_b32 v2, 3, v0
 v_mul_u32_u24 v10, 1152, v2
 v_lshrrev_b32 v2, 4, v0
 v_xor_b32 v2, v2, v0
 v_and_b32 v2, 7, v2
 v_lshl_add_u32 v10, v2, 4, v10
 v_lshrrev_b32 v2, 4, v1
 v_bfe_u32 v3, v1, 1, 3
 v_xor_b32 v2, v2, v3
 v_and_b32 v3, 15, v1
 v_lshlrev_b32 v3, 7, v3
 v_lshl_add_u32 v4, v2, 4, v3
 v_xor_b32 v5, 64, v4
 v_lshrrev_b32 v2, 4, v0
 v_lshlrev_b32 v11, 13, v2
 v_lshrrev_b32 v2, 7, v0
 v_lshrrev_b32 v3, 4, v1
 v_lshl_add_u32 v3, v2, 2, v3
 v_bfe_u32 v2, v1, 1, 3
 v_xor_b32 v2, v2, v3
 v_lshl_add_u32 v11, v2, 5, v11
 v_and_b32 v2, 1, v1
 v_lshl_add_u32 v11, v2, 4, v11
 v_bfe_u32 v2, v1, 2, 3
 v_xor_b32 v3, s4, v2
 v_lshlrev_b32 v3, 5, v3
 v_and_b32 v2, 3, v2
 v_lshl_add_u32 v3, v2, 8, v3
 v_lshrrev_b32 v2, 4, v1
 v_lshl_add_u32 v3, v2, 11, v3
 v_and_b32 v2, 3, v1
 v_lshl_add_u32 v3, v2, 3, v3
 v_add_u32 v8, 73728, v3
 v_xor_b32 v3, 0x80, v3
 v_add_u32 v9, 73728, v3
 s_lshl_b32 s45, s4, 11
 v_lshl_add_u32 v12, v1, 4, s45
 s_mov_b32 s39, s37
 s_add_u32 s40, s39, 4
 s_lshl_b32 s49, s4, 10
 s_mul_i32 s46, s39, 36864
 s_add_u32 m0, s49, 0
 s_nop 0
 buffer_load_dwordx4 v10, s[8:11], s46 offen offset:0  lds
 s_add_u32 m0, s49, 3968
 s_nop 0
 buffer_load_dwordx4 v10, s[8:11], s46 offen offset:128  lds
 s_add_u32 m0, s49, 7936
 s_nop 0
 buffer_load_dwordx4 v10, s[8:11], s46 offen offset:256  lds
 s_add_u32 m0, s49, 11904
 s_nop 0
 buffer_load_dwordx4 v10, s[8:11], s46 offen offset:384  lds
 s_add_u32 m0, s49, 15872
 s_nop 0
 buffer_load_dwordx4 v10, s[8:11], s46 offen offset:512  lds
 s_add_u32 m0, s49, 19840
 s_nop 0
 buffer_load_dwordx4 v10, s[8:11], s46 offen offset:640  lds
 s_add_u32 m0, s49, 23808
 s_nop 0
 buffer_load_dwordx4 v10, s[8:11], s46 offen offset:768  lds
 s_add_u32 m0, s49, 27776
 s_nop 0
 buffer_load_dwordx4 v10, s[8:11], s46 offen offset:896  lds
 s_add_u32 m0, s49, 31744
 s_nop 0
 buffer_load_dwordx4 v10, s[8:11], s46 offen offset:1024  lds
 s_lshl_b32 s49, s4, 10
 s_add_u32 s49, s49, 36864
 s_mul_i32 s46, s40, 36864
 s_add_u32 m0, s49, 0
 s_nop 0
 buffer_load_dwordx4 v10, s[8:11], s46 offen offset:0  lds
 s_add_u32 m0, s49, 3968
 s_nop 0
 buffer_load_dwordx4 v10, s[8:11], s46 offen offset:128  lds
 s_add_u32 m0, s49, 7936
 s_nop 0
 buffer_load_dwordx4 v10, s[8:11], s46 offen offset:256  lds
 s_add_u32 m0, s49, 11904
 s_nop 0
 buffer_load_dwordx4 v10, s[8:11], s46 offen offset:384  lds
 s_add_u32 m0, s49, 15872
 s_nop 0
 buffer_load_dwordx4 v10, s[8:11], s46 offen offset:512  lds
 s_add_u32 m0, s49, 19840
 s_nop 0
 buffer_load_dwordx4 v10, s[8:11], s46 offen offset:640  lds
 s_add_u32 m0, s49, 23808
 s_nop 0
 buffer_load_dwordx4 v10, s[8:11], s46 offen offset:768  lds
 s_add_u32 m0, s49, 27776
 s_nop 0
 buffer_load_dwordx4 v10, s[8:11], s46 offen offset:896  lds
 s_add_u32 m0, s49, 31744
 s_nop 0
 buffer_load_dwordx4 v10, s[8:11], s46 offen offset:1024  lds
 s_lshl_b32 s49, s4, 10
 s_add_u32 m0, s49, 73728
 s_add_u32 s45, s32, 0
 buffer_load_dwordx4 v11, s[12:15], s45 offen  lds
 s_add_u32 m0, s49, 77824
 s_add_u32 s45, s32, 131072
 buffer_load_dwordx4 v11, s[12:15], s45 offen  lds
 s_add_u32 m0, s49, 81920
 s_add_u32 s45, s33, 0
 buffer_load_dwordx4 v11, s[16:19], s45 offen  lds
 s_add_u32 m0, s49, 86016
 s_add_u32 s45, s33, 131072
 buffer_load_dwordx4 v11, s[16:19], s45 offen  lds
 s_add_u32 m0, s49, 90112
 s_add_u32 s45, s32, 262144
 buffer_load_dwordx4 v11, s[12:15], s45 offen  lds
 s_add_u32 m0, s49, 94208
 s_add_u32 s45, s32, 393216
 buffer_load_dwordx4 v11, s[12:15], s45 offen  lds
 s_add_u32 m0, s49, 98304
 s_add_u32 s45, s33, 262144
 buffer_load_dwordx4 v11, s[16:19], s45 offen  lds
 s_add_u32 m0, s49, 102400
 s_add_u32 s45, s33, 393216
 buffer_load_dwordx4 v11, s[16:19], s45 offen  lds
 s_add_u32 m0, s49, 106496
 s_add_u32 s45, s32, 524288
 buffer_load_dwordx4 v11, s[12:15], s45 offen  lds
 s_add_u32 m0, s49, 110592
 s_add_u32 s45, s32, 655360
 buffer_load_dwordx4 v11, s[12:15], s45 offen  lds
 s_add_u32 m0, s49, 114688
 s_add_u32 s45, s33, 524288
 buffer_load_dwordx4 v11, s[16:19], s45 offen  lds
 s_add_u32 m0, s49, 118784
 s_add_u32 s45, s33, 655360
 buffer_load_dwordx4 v11, s[16:19], s45 offen  lds
 s_waitcnt vmcnt(8) lgkmcnt(0)
 s_barrier
 s_add_u32 m0, s49, 122880
 s_add_u32 s45, s32, 786432
 buffer_load_dwordx4 v11, s[12:15], s45 offen  lds
 s_add_u32 m0, s49, 126976
 s_add_u32 s45, s32, 917504
 buffer_load_dwordx4 v11, s[12:15], s45 offen  lds
 s_add_u32 m0, s49, 131072
 s_add_u32 s45, s33, 786432
 buffer_load_dwordx4 v11, s[16:19], s45 offen  lds
 s_add_u32 m0, s49, 135168
 s_add_u32 s45, s33, 917504
 buffer_load_dwordx4 v11, s[16:19], s45 offen  lds
 ds_read_b64_tr_b16 a[0:1], v8 offset:0
 ds_read_b64_tr_b16 a[2:3], v8 offset:1024
 ds_read_b64_tr_b16 a[72:73], v9 offset:0
 ds_read_b64_tr_b16 a[74:75], v9 offset:1024
 ds_read_b64_tr_b16 a[144:145], v8 offset:8192
 ds_read_b64_tr_b16 a[146:147], v8 offset:9216
 ds_read_b64_tr_b16 a[216:217], v9 offset:8192
 ds_read_b64_tr_b16 a[218:219], v9 offset:9216
 s_waitcnt vmcnt(8) lgkmcnt(0)
 s_barrier
 s_add_u32 m0, s49, 73728
 s_add_u32 s45, s32, 1048576
 buffer_load_dwordx4 v11, s[12:15], s45 offen  lds
 s_add_u32 m0, s49, 77824
 s_add_u32 s45, s32, 1179648
 buffer_load_dwordx4 v11, s[12:15], s45 offen  lds
 s_add_u32 m0, s49, 81920
 s_add_u32 s45, s33, 1048576
 buffer_load_dwordx4 v11, s[16:19], s45 offen  lds
 s_add_u32 m0, s49, 86016
 s_add_u32 s45, s33, 1179648
 buffer_load_dwordx4 v11, s[16:19], s45 offen  lds
 ds_read_b64_tr_b16 a[4:5], v8 offset:16384
 ds_read_b64_tr_b16 a[6:7], v8 offset:17408
 ds_read_b64_tr_b16 a[76:77], v9 offset:16384
 ds_read_b64_tr_b16 a[78:79], v9 offset:17408
 ds_read_b64_tr_b16 a[148:149], v8 offset:24576
 ds_read_b64_tr_b16 a[150:151], v8 offset:25600
 ds_read_b64_tr_b16 a[220:221], v9 offset:24576
 ds_read_b64_tr_b16 a[222:223], v9 offset:25600
 s_waitcnt vmcnt(8) lgkmcnt(0)
 s_barrier
 s_add_u32 m0, s49, 90112
 s_add_u32 s45, s32, 1310720
 buffer_load_dwordx4 v11, s[12:15], s45 offen  lds
 s_add_u32 m0, s49, 94208
 s_add_u32 s45, s32, 1441792
 buffer_load_dwordx4 v11, s[12:15], s45 offen  lds
 s_add_u32 m0, s49, 98304
 s_add_u32 s45, s33, 1310720
 buffer_load_dwordx4 v11, s[16:19], s45 offen  lds
 s_add_u32 m0, s49, 102400
 s_add_u32 s45, s33, 1441792
 buffer_load_dwordx4 v11, s[16:19], s45 offen  lds
 ds_read_b64_tr_b16 a[8:9], v8 offset:32768
 ds_read_b64_tr_b16 a[10:11], v8 offset:33792
 ds_read_b64_tr_b16 a[80:81], v9 offset:32768
 ds_read_b64_tr_b16 a[82:83], v9 offset:33792
 ds_read_b64_tr_b16 a[152:153], v8 offset:40960
 ds_read_b64_tr_b16 a[154:155], v8 offset:41984
 ds_read_b64_tr_b16 a[224:225], v9 offset:40960
 ds_read_b64_tr_b16 a[226:227], v9 offset:41984
 s_waitcnt vmcnt(8) lgkmcnt(0)
 s_barrier
 s_add_u32 m0, s49, 106496
 s_add_u32 s45, s32, 1572864
 buffer_load_dwordx4 v11, s[12:15], s45 offen  lds
 s_add_u32 m0, s49, 110592
 s_add_u32 s45, s32, 1703936
 buffer_load_dwordx4 v11, s[12:15], s45 offen  lds
 s_add_u32 m0, s49, 114688
 s_add_u32 s45, s33, 1572864
 buffer_load_dwordx4 v11, s[16:19], s45 offen  lds
 s_add_u32 m0, s49, 118784
 s_add_u32 s45, s33, 1703936
 buffer_load_dwordx4 v11, s[16:19], s45 offen  lds
 ds_read_b64_tr_b16 a[12:13], v8 offset:49152
 ds_read_b64_tr_b16 a[14:15], v8 offset:50176
 ds_read_b64_tr_b16 a[84:85], v9 offset:49152
 ds_read_b64_tr_b16 a[86:87], v9 offset:50176
 ds_read_b64_tr_b16 a[156:157], v8 offset:57344
 ds_read_b64_tr_b16 a[158:159], v8 offset:58368
 ds_read_b64_tr_b16 a[228:229], v9 offset:57344
 ds_read_b64_tr_b16 a[230:231], v9 offset:58368
 s_waitcnt vmcnt(8) lgkmcnt(0)
 s_barrier
 s_add_u32 m0, s49, 122880
 s_add_u32 s45, s32, 1835008
 buffer_load_dwordx4 v11, s[12:15], s45 offen  lds
 s_add_u32 m0, s49, 126976
 s_add_u32 s45, s32, 1966080
 buffer_load_dwordx4 v11, s[12:15], s45 offen  lds
 s_add_u32 m0, s49, 131072
 s_add_u32 s45, s33, 1835008
 buffer_load_dwordx4 v11, s[16:19], s45 offen  lds
 s_add_u32 m0, s49, 135168
 s_add_u32 s45, s33, 1966080
 buffer_load_dwordx4 v11, s[16:19], s45 offen  lds
 ds_read_b64_tr_b16 a[16:17], v8 offset:0
 ds_read_b64_tr_b16 a[18:19], v8 offset:1024
 ds_read_b64_tr_b16 a[88:89], v9 offset:0
 ds_read_b64_tr_b16 a[90:91], v9 offset:1024
 ds_read_b64_tr_b16 a[160:161], v8 offset:8192
 ds_read_b64_tr_b16 a[162:163], v8 offset:9216
 ds_read_b64_tr_b16 a[232:233], v9 offset:8192
 ds_read_b64_tr_b16 a[234:235], v9 offset:9216
 s_waitcnt vmcnt(8) lgkmcnt(0)
 s_barrier
 s_add_u32 m0, s49, 73728
 s_add_u32 s45, s32, 2097152
 buffer_load_dwordx4 v11, s[12:15], s45 offen  lds
 s_add_u32 m0, s49, 77824
 s_add_u32 s45, s32, 2228224
 buffer_load_dwordx4 v11, s[12:15], s45 offen  lds
 s_add_u32 m0, s49, 81920
 s_add_u32 s45, s33, 2097152
 buffer_load_dwordx4 v11, s[16:19], s45 offen  lds
 s_add_u32 m0, s49, 86016
 s_add_u32 s45, s33, 2228224
 buffer_load_dwordx4 v11, s[16:19], s45 offen  lds
 ds_read_b64_tr_b16 a[20:21], v8 offset:16384
 ds_read_b64_tr_b16 a[22:23], v8 offset:17408
 ds_read_b64_tr_b16 a[92:93], v9 offset:16384
 ds_read_b64_tr_b16 a[94:95], v9 offset:17408
 ds_read_b64_tr_b16 a[164:165], v8 offset:24576
 ds_read_b64_tr_b16 a[166:167], v8 offset:25600
 ds_read_b64_tr_b16 a[236:237], v9 offset:24576
 ds_read_b64_tr_b16 a[238:239], v9 offset:25600
 s_waitcnt vmcnt(8) lgkmcnt(0)
 s_barrier
 s_add_u32 m0, s49, 90112
 s_add_u32 s45, s32, 2359296
 buffer_load_dwordx4 v11, s[12:15], s45 offen  lds
 s_add_u32 m0, s49, 94208
 s_add_u32 s45, s32, 2490368
 buffer_load_dwordx4 v11, s[12:15], s45 offen  lds
 s_add_u32 m0, s49, 98304
 s_add_u32 s45, s33, 2359296
 buffer_load_dwordx4 v11, s[16:19], s45 offen  lds
 s_add_u32 m0, s49, 102400
 s_add_u32 s45, s33, 2490368
 buffer_load_dwordx4 v11, s[16:19], s45 offen  lds
 ds_read_b64_tr_b16 a[24:25], v8 offset:32768
 ds_read_b64_tr_b16 a[26:27], v8 offset:33792
 ds_read_b64_tr_b16 a[96:97], v9 offset:32768
 ds_read_b64_tr_b16 a[98:99], v9 offset:33792
 ds_read_b64_tr_b16 a[168:169], v8 offset:40960
 ds_read_b64_tr_b16 a[170:171], v8 offset:41984
 ds_read_b64_tr_b16 a[240:241], v9 offset:40960
 ds_read_b64_tr_b16 a[242:243], v9 offset:41984
 s_waitcnt vmcnt(8) lgkmcnt(0)
 s_barrier
 s_add_u32 m0, s49, 106496
 s_add_u32 s45, s32, 2621440
 buffer_load_dwordx4 v11, s[12:15], s45 offen  lds
 s_add_u32 m0, s49, 110592
 s_add_u32 s45, s32, 2752512
 buffer_load_dwordx4 v11, s[12:15], s45 offen  lds
 s_add_u32 m0, s49, 114688
 s_add_u32 s45, s33, 2621440
 buffer_load_dwordx4 v11, s[16:19], s45 offen  lds
 s_add_u32 m0, s49, 118784
 s_add_u32 s45, s33, 2752512
 buffer_load_dwordx4 v11, s[16:19], s45 offen  lds
 ds_read_b64_tr_b16 a[28:29], v8 offset:49152
 ds_read_b64_tr_b16 a[30:31], v8 offset:50176
 ds_read_b64_tr_b16 a[100:101], v9 offset:49152
 ds_read_b64_tr_b16 a[102:103], v9 offset:50176
 ds_read_b64_tr_b16 a[172:173], v8 offset:57344
 ds_read_b64_tr_b16 a[174:175], v8 offset:58368
 ds_read_b64_tr_b16 a[244:245], v9 offset:57344
 ds_read_b64_tr_b16 a[246:247], v9 offset:58368
 s_waitcnt vmcnt(8) lgkmcnt(0)
 s_barrier
 s_add_u32 m0, s49, 122880
 s_add_u32 s45, s32, 2883584
 buffer_load_dwordx4 v11, s[12:15], s45 offen  lds
 s_add_u32 m0, s49, 126976
 s_add_u32 s45, s32, 3014656
 buffer_load_dwordx4 v11, s[12:15], s45 offen  lds
 s_add_u32 m0, s49, 131072
 s_add_u32 s45, s33, 2883584
 buffer_load_dwordx4 v11, s[16:19], s45 offen  lds
 s_add_u32 m0, s49, 135168
 s_add_u32 s45, s33, 3014656
 buffer_load_dwordx4 v11, s[16:19], s45 offen  lds
 ds_read_b64_tr_b16 a[32:33], v8 offset:0
 ds_read_b64_tr_b16 a[34:35], v8 offset:1024
 ds_read_b64_tr_b16 a[104:105], v9 offset:0
 ds_read_b64_tr_b16 a[106:107], v9 offset:1024
 ds_read_b64_tr_b16 a[176:177], v8 offset:8192
 ds_read_b64_tr_b16 a[178:179], v8 offset:9216
 ds_read_b64_tr_b16 a[248:249], v9 offset:8192
 ds_read_b64_tr_b16 a[250:251], v9 offset:9216
 s_waitcnt vmcnt(8) lgkmcnt(0)
 s_barrier
 s_add_u32 m0, s49, 73728
 s_add_u32 s45, s32, 3145728
 buffer_load_dwordx4 v11, s[12:15], s45 offen  lds
 s_add_u32 m0, s49, 77824
 s_add_u32 s45, s32, 3276800
 buffer_load_dwordx4 v11, s[12:15], s45 offen  lds
 s_add_u32 m0, s49, 81920
 s_add_u32 s45, s33, 3145728
 buffer_load_dwordx4 v11, s[16:19], s45 offen  lds
 s_add_u32 m0, s49, 86016
 s_add_u32 s45, s33, 3276800
 buffer_load_dwordx4 v11, s[16:19], s45 offen  lds
 ds_read_b64_tr_b16 a[36:37], v8 offset:16384
 ds_read_b64_tr_b16 a[38:39], v8 offset:17408
 ds_read_b64_tr_b16 a[108:109], v9 offset:16384
 ds_read_b64_tr_b16 a[110:111], v9 offset:17408
 ds_read_b64_tr_b16 a[180:181], v8 offset:24576
 ds_read_b64_tr_b16 a[182:183], v8 offset:25600
 ds_read_b64_tr_b16 a[252:253], v9 offset:24576
 ds_read_b64_tr_b16 a[254:255], v9 offset:25600
 s_waitcnt vmcnt(8) lgkmcnt(0)
 s_barrier
 s_add_u32 m0, s49, 90112
 s_add_u32 s45, s32, 3407872
 buffer_load_dwordx4 v11, s[12:15], s45 offen  lds
 s_add_u32 m0, s49, 94208
 s_add_u32 s45, s32, 3538944
 buffer_load_dwordx4 v11, s[12:15], s45 offen  lds
 s_add_u32 m0, s49, 98304
 s_add_u32 s45, s33, 3407872
 buffer_load_dwordx4 v11, s[16:19], s45 offen  lds
 s_add_u32 m0, s49, 102400
 s_add_u32 s45, s33, 3538944
 buffer_load_dwordx4 v11, s[16:19], s45 offen  lds
 ds_read_b64_tr_b16 a[40:41], v8 offset:32768
 ds_read_b64_tr_b16 a[42:43], v8 offset:33792
 ds_read_b64_tr_b16 a[112:113], v9 offset:32768
 ds_read_b64_tr_b16 a[114:115], v9 offset:33792
 ds_read_b64_tr_b16 a[184:185], v8 offset:40960
 ds_read_b64_tr_b16 a[186:187], v8 offset:41984
 ds_read_b64_tr_b16 v[224:225], v9 offset:40960
 ds_read_b64_tr_b16 v[226:227], v9 offset:41984
 s_waitcnt vmcnt(8) lgkmcnt(0)
 s_barrier
 s_add_u32 m0, s49, 106496
 s_add_u32 s45, s32, 3670016
 buffer_load_dwordx4 v11, s[12:15], s45 offen  lds
 s_add_u32 m0, s49, 110592
 s_add_u32 s45, s32, 3801088
 buffer_load_dwordx4 v11, s[12:15], s45 offen  lds
 s_add_u32 m0, s49, 114688
 s_add_u32 s45, s33, 3670016
 buffer_load_dwordx4 v11, s[16:19], s45 offen  lds
 s_add_u32 m0, s49, 118784
 s_add_u32 s45, s33, 3801088
 buffer_load_dwordx4 v11, s[16:19], s45 offen  lds
 ds_read_b64_tr_b16 a[44:45], v8 offset:49152
 ds_read_b64_tr_b16 a[46:47], v8 offset:50176
 ds_read_b64_tr_b16 a[116:117], v9 offset:49152
 ds_read_b64_tr_b16 a[118:119], v9 offset:50176
 ds_read_b64_tr_b16 a[188:189], v8 offset:57344
 ds_read_b64_tr_b16 a[190:191], v8 offset:58368
 ds_read_b64_tr_b16 v[228:229], v9 offset:57344
 ds_read_b64_tr_b16 v[230:231], v9 offset:58368
 s_waitcnt vmcnt(8) lgkmcnt(0)
 s_barrier
 s_add_u32 m0, s49, 122880
 s_add_u32 s45, s32, 3932160
 buffer_load_dwordx4 v11, s[12:15], s45 offen  lds
 s_add_u32 m0, s49, 126976
 s_add_u32 s45, s32, 4063232
 buffer_load_dwordx4 v11, s[12:15], s45 offen  lds
 s_add_u32 m0, s49, 131072
 s_add_u32 s45, s33, 3932160
 buffer_load_dwordx4 v11, s[16:19], s45 offen  lds
 s_add_u32 m0, s49, 135168
 s_add_u32 s45, s33, 4063232
 buffer_load_dwordx4 v11, s[16:19], s45 offen  lds
 ds_read_b64_tr_b16 a[48:49], v8 offset:0
 ds_read_b64_tr_b16 a[50:51], v8 offset:1024
 ds_read_b64_tr_b16 a[120:121], v9 offset:0
 ds_read_b64_tr_b16 a[122:123], v9 offset:1024
 ds_read_b64_tr_b16 a[192:193], v8 offset:8192
 ds_read_b64_tr_b16 a[194:195], v8 offset:9216
 ds_read_b64_tr_b16 v[232:233], v9 offset:8192
 ds_read_b64_tr_b16 v[234:235], v9 offset:9216
 s_waitcnt vmcnt(8) lgkmcnt(0)
 s_barrier
 s_add_u32 m0, s49, 73728
 s_add_u32 s45, s32, 4194304
 buffer_load_dwordx4 v11, s[12:15], s45 offen  lds
 s_add_u32 m0, s49, 77824
 s_add_u32 s45, s32, 4325376
 buffer_load_dwordx4 v11, s[12:15], s45 offen  lds
 s_add_u32 m0, s49, 81920
 s_add_u32 s45, s33, 4194304
 buffer_load_dwordx4 v11, s[16:19], s45 offen  lds
 s_add_u32 m0, s49, 86016
 s_add_u32 s45, s33, 4325376
 buffer_load_dwordx4 v11, s[16:19], s45 offen  lds
 ds_read_b64_tr_b16 a[52:53], v8 offset:16384
 ds_read_b64_tr_b16 a[54:55], v8 offset:17408
 ds_read_b64_tr_b16 a[124:125], v9 offset:16384
 ds_read_b64_tr_b16 a[126:127], v9 offset:17408
 ds_read_b64_tr_b16 a[196:197], v8 offset:24576
 ds_read_b64_tr_b16 a[198:199], v8 offset:25600
 ds_read_b64_tr_b16 v[236:237], v9 offset:24576
 ds_read_b64_tr_b16 v[238:239], v9 offset:25600
 s_waitcnt vmcnt(8) lgkmcnt(0)
 s_barrier
 s_add_u32 m0, s49, 90112
 s_add_u32 s45, s32, 4456448
 buffer_load_dwordx4 v11, s[12:15], s45 offen  lds
 s_add_u32 m0, s49, 94208
 s_add_u32 s45, s32, 4587520
 buffer_load_dwordx4 v11, s[12:15], s45 offen  lds
 s_add_u32 m0, s49, 98304
 s_add_u32 s45, s33, 4456448
 buffer_load_dwordx4 v11, s[16:19], s45 offen  lds
 s_add_u32 m0, s49, 102400
 s_add_u32 s45, s33, 4587520
 buffer_load_dwordx4 v11, s[16:19], s45 offen  lds
 ds_read_b64_tr_b16 a[56:57], v8 offset:32768
 ds_read_b64_tr_b16 a[58:59], v8 offset:33792
 ds_read_b64_tr_b16 a[128:129], v9 offset:32768
 ds_read_b64_tr_b16 a[130:131], v9 offset:33792
 ds_read_b64_tr_b16 a[200:201], v8 offset:40960
 ds_read_b64_tr_b16 a[202:203], v8 offset:41984
 ds_read_b64_tr_b16 v[240:241], v9 offset:40960
 ds_read_b64_tr_b16 v[242:243], v9 offset:41984
 s_waitcnt vmcnt(8) lgkmcnt(0)
 s_barrier
 ds_read_b64_tr_b16 a[60:61], v8 offset:49152
 ds_read_b64_tr_b16 a[62:63], v8 offset:50176
 ds_read_b64_tr_b16 a[132:133], v9 offset:49152
 ds_read_b64_tr_b16 a[134:135], v9 offset:50176
 ds_read_b64_tr_b16 a[204:205], v8 offset:57344
 ds_read_b64_tr_b16 a[206:207], v8 offset:58368
 ds_read_b64_tr_b16 v[244:245], v9 offset:57344
 ds_read_b64_tr_b16 v[246:247], v9 offset:58368
 s_waitcnt vmcnt(4) lgkmcnt(0)
 s_barrier
 ds_read_b64_tr_b16 a[64:65], v8 offset:0
 ds_read_b64_tr_b16 a[66:67], v8 offset:1024
 ds_read_b64_tr_b16 a[136:137], v9 offset:0
 ds_read_b64_tr_b16 a[138:139], v9 offset:1024
 ds_read_b64_tr_b16 a[208:209], v8 offset:8192
 ds_read_b64_tr_b16 a[210:211], v8 offset:9216
 ds_read_b64_tr_b16 v[248:249], v9 offset:8192
 ds_read_b64_tr_b16 v[250:251], v9 offset:9216
 s_waitcnt vmcnt(0) lgkmcnt(0)
 s_barrier
 ds_read_b64_tr_b16 a[68:69], v8 offset:16384
 ds_read_b64_tr_b16 a[70:71], v8 offset:17408
 ds_read_b64_tr_b16 a[140:141], v9 offset:16384
 ds_read_b64_tr_b16 a[142:143], v9 offset:17408
 ds_read_b64_tr_b16 a[212:213], v8 offset:24576
 ds_read_b64_tr_b16 a[214:215], v8 offset:25600
 ds_read_b64_tr_b16 v[252:253], v9 offset:24576
 ds_read_b64_tr_b16 v[254:255], v9 offset:25600
 s_mov_b32 s50, 0x3e0293ee
 s_mov_b32 s42, 0
 s_mov_b32 s43, 0
 s_mov_b32 s44, 73728
 v_mov_b32 v6, v4
 v_mov_b32 v7, v5
Lrh_34:
 v_mbcnt_lo_u32_b32 v21, -1, 0
 v_min_u32 v21, 1, v21
 v_lshlrev_b32 v21, 28, v21
 buffer_load_dword v20, v21, s[28:31], 0 offen offset:4 sc1
 s_waitcnt vmcnt(0)
Lrhc_35:
 v_readfirstlane_b32 s89, v20
 s_cmp_eq_u32 s89, s88
 s_cbranch_scc1 Lrhk_36
 s_cmp_lg_u32 s89, 0
 s_cbranch_scc1 Lredo
 s_sub_u32 s95, s95, 1
 s_cbranch_scc0 Lrh_34
 s_endpgm
Lrhk_36:
 s_cmp_lg_u32 s4, 0
 s_cbranch_scc1 Lfrk_33
 v_min_u32 v21, 1, v0
 v_lshlrev_b32 v21, 28, v21
Lfr_32:
 buffer_load_dword v20, v21, s[28:31], 0 offen offset:0 sc1
 s_waitcnt vmcnt(0)
 v_cmp_eq_u32 vcc, 1, v20
 s_cbranch_vccnz Lfrk_33
 s_sub_u32 s95, s95, 1
 s_cbranch_scc0 Lfr_32
 s_endpgm
Lfrk_33:
 s_lshl_b32 s47, s2, 13
 s_add_u32 s47, s47, 0x8000000
 s_mov_b32 s48, s47
 v_mov_b32 v14, 0
 s_waitcnt vmcnt(0) lgkmcnt(0)
 s_barrier
 ds_read_b128 v[32:35], v6 offset:0
 ds_read_b128 v[36:39], v6 offset:2048
 ds_read_b128 v[40:43], v7 offset:0
 ds_read_b128 v[44:47], v7 offset:2048
 v_lshlrev_b32 v1, 12, v0
 s_lshl_b32 s45, s6, 7
 buffer_load_dword v15, v1, s[8:11], s45 offen
 v_add_u32 v1, 0x100000, v1
 buffer_load_dword v15, v1, s[8:11], s45 offen
 v_add_u32 v1, 0x100000, v1
 buffer_load_dword v15, v1, s[8:11], s45 offen
 v_add_u32 v1, 0x100000, v1
 s_waitcnt lgkmcnt(2)
Lps_loop_37:
 v_mfma_f32_16x16x32_bf16 v[64:67], a[0:3], v[32:35], 0
 ds_read_b128 v[48:51], v6 offset:4096
 v_mfma_f32_16x16x32_bf16 v[72:75], a[72:75], v[32:35], 0
 ds_read_b128 v[52:55], v6 offset:6144
 v_mfma_f32_16x16x32_bf16 v[80:83], a[144:147], v[32:35], 0
 s_add_u32 s41, s40, 4
 v_mfma_f32_16x16x32_bf16 v[88:91], a[216:219], v[32:35], 0
 s_add_u32 s45, s42, 2
 s_mul_i32 s46, s41, 36864
 v_mfma_f32_16x16x32_bf16 v[68:71], a[0:3], v[36:39], 0
 s_cmp_lt_u32 s45, s36
 s_cselect_b32 s46, s46, 0
 v_mfma_f32_16x16x32_bf16 v[76:79], a[72:75], v[36:39], 0
 s_lshl_b32 s49, s4, 10
 s_add_u32 s49, s49, s44
 v_mfma_f32_16x16x32_bf16 v[84:87], a[144:147], v[36:39], 0
 v_mfma_f32_16x16x32_bf16 v[92:95], a[216:219], v[36:39], 0
 s_waitcnt lgkmcnt(2)
 v_mfma_f32_16x16x32_bf16 v[64:67], a[4:7], v[40:43], v[64:67]
 ds_read_b128 v[56:59], v7 offset:4096
 v_mfma_f32_16x16x32_bf16 v[72:75], a[76:79], v[40:43], v[72:75]
 ds_read_b128 v[60:63], v7 offset:6144
 v_mfma_f32_16x16x32_bf16 v[80:83], a[148:151], v[40:43], v[80:83]
 s_add_u32 m0, s49, 0
 v_mfma_f32_16x16x32_bf16 v[88:91], a[220:223], v[40:43], v[88:91]
 buffer_load_dwordx4 v10, s[8:11], s46 offen offset:0  lds
 v_mfma_f32_16x16x32_bf16 v[68:71], a[4:7], v[44:47], v[68:71]
 s_add_u32 m0, s49, 3968
 v_mfma_f32_16x16x32_bf16 v[76:79], a[76:79], v[44:47], v[76:79]
 buffer_load_dwordx4 v10, s[8:11], s46 offen offset:128  lds
 v_mfma_f32_16x16x32_bf16 v[84:87], a[148:151], v[44:47], v[84:87]
 v_mfma_f32_16x16x32_bf16 v[92:95], a[220:223], v[44:47], v[92:95]
 s_waitcnt lgkmcnt(2)
 v_mfma_f32_16x16x32_bf16 v[64:67], a[8:11], v[48:51], v[64:67]
 ds_read_b128 v[32:35], v6 offset:8192
 v_mfma_f32_16x16x32_bf16 v[72:75], a[80:83], v[48:51], v[72:75]
 ds_read_b128 v[36:39], v6 offset:10240
 v_mfma_f32_16x16x32_bf16 v[80:83], a[152:155], v[48:51], v[80:83]
 s_add_u32 m0, s49, 7936
 v_mfma_f32_16x16x32_bf16 v[88:91], a[224:227], v[48:51], v[88:91]
 buffer_load_dwordx4 v10, s[8:11], s46 offen offset:256  lds
 v_mfma_f32_16x16x32_bf16 v[68:71], a[8:11], v[52:55], v[68:71]
 s_add_u32 m0, s49, 11904
 v_mfma_f32_16x16x32_bf16 v[76:79], a[80:83], v[52:55], v[76:79]
 buffer_load_dwordx4 v10, s[8:11], s46 offen offset:384  lds
 v_mfma_f32_16x16x32_bf16 v[84:87], a[152:155], v[52:55], v[84:87]
 v_mfma_f32_16x16x32_bf16 v[92:95], a[224:227], v[52:55], v[92:95]
 s_waitcnt lgkmcnt(2)
 v_mfma_f32_16x16x32_bf16 v[64:67], a[12:15], v[56:59], v[64:67]
 ds_read_b128 v[40:43], v7 offset:8192
 v_mfma_f32_16x16x32_bf16 v[72:75], a[84:87], v[56:59], v[72:75]
 ds_read_b128 v[44:47], v7 offset:10240
 v_mfma_f32_16x16x32_bf16 v[80:83], a[156:159], v[56:59], v[80:83]
 s_add_u32 m0, s49, 15872
 v_mfma_f32_16x16x32_bf16 v[88:91], a[228:231], v[56:59], v[88:91]
 buffer_load_dwordx4 v10, s[8:11], s46 offen offset:512  lds
 v_mfma_f32_16x16x32_bf16 v[68:71], a[12:15], v[60:63], v[68:71]
 s_add_u32 m0, s49, 19840
 v_mfma_f32_16x16x32_bf16 v[76:79], a[84:87], v[60:63], v[76:79]
 buffer_load_dwordx4 v10, s[8:11], s46 offen offset:640  lds
 v_mfma_f32_16x16x32_bf16 v[84:87], a[156:159], v[60:63], v[84:87]
 v_mfma_f32_16x16x32_bf16 v[92:95], a[228:231], v[60:63], v[92:95]
 s_waitcnt lgkmcnt(2)
 v_mfma_f32_16x16x32_bf16 v[64:67], a[16:19], v[32:35], v[64:67]
 ds_read_b128 v[48:51], v6 offset:12288
 v_mfma_f32_16x16x32_bf16 v[72:75], a[88:91], v[32:35], v[72:75]
 ds_read_b128 v[52:55], v6 offset:14336
 v_mfma_f32_16x16x32_bf16 v[80:83], a[160:163], v[32:35], v[80:83]
 s_add_u32 m0, s49, 23808
 v_mfma_f32_16x16x32_bf16 v[88:91], a[232:235], v[32:35], v[88:91]
 buffer_load_dwordx4 v10, s[8:11], s46 offen offset:768  lds
 v_mfma_f32_16x16x32_bf16 v[68:71], a[16:19], v[36:39], v[68:71]
 s_add_u32 m0, s49, 27776
 v_mfma_f32_16x16x32_bf16 v[76:79], a[88:91], v[36:39], v[76:79]
 buffer_load_dwordx4 v10, s[8:11], s46 offen offset:896  lds
 v_mfma_f32_16x16x32_bf16 v[84:87], a[160:163], v[36:39], v[84:87]
 v_mfma_f32_16x16x32_bf16 v[92:95], a[232:235], v[36:39], v[92:95]
 s_waitcnt lgkmcnt(2)
 v_mfma_f32_16x16x32_bf16 v[64:67], a[20:23], v[40:43], v[64:67]
 ds_read_b128 v[56:59], v7 offset:12288
 v_mfma_f32_16x16x32_bf16 v[72:75], a[92:95], v[40:43], v[72:75]
 ds_read_b128 v[60:63], v7 offset:14336
 v_mfma_f32_16x16x32_bf16 v[80:83], a[164:167], v[40:43], v[80:83]
 s_add_u32 m0, s49, 31744
 v_mfma_f32_16x16x32_bf16 v[88:91], a[236:239], v[40:43], v[88:91]
 buffer_load_dwordx4 v10, s[8:11], s46 offen offset:1024  lds
 v_mfma_f32_16x16x32_bf16 v[68:71], a[20:23], v[44:47], v[68:71]
 v_mfma_f32_16x16x32_bf16 v[76:79], a[92:95], v[44:47], v[76:79]
 v_mfma_f32_16x16x32_bf16 v[84:87], a[164:167], v[44:47], v[84:87]
 v_mfma_f32_16x16x32_bf16 v[92:95], a[236:239], v[44:47], v[92:95]
 s_waitcnt lgkmcnt(2)
 v_mfma_f32_16x16x32_bf16 v[64:67], a[24:27], v[48:51], v[64:67]
 ds_read_b128 v[32:35], v6 offset:16384
 v_mul_f32 v96, s50, v96
 v_mfma_f32_16x16x32_bf16 v[72:75], a[96:99], v[48:51], v[72:75]
 ds_read_b128 v[36:39], v6 offset:18432
 v_mfma_f32_16x16x32_bf16 v[80:83], a[168:171], v[48:51], v[80:83]
 v_mul_f32 v97, s50, v97
 v_mfma_f32_16x16x32_bf16 v[88:91], a[240:243], v[48:51], v[88:91]
 v_mul_f32 v98, s50, v98
 v_mfma_f32_16x16x32_bf16 v[68:71], a[24:27], v[52:55], v[68:71]
 v_mul_f32 v99, s50, v99
 v_mfma_f32_16x16x32_bf16 v[76:79], a[96:99], v[52:55], v[76:79]
 v_mul_f32 v104, s50, v104
 v_mfma_f32_16x16x32_bf16 v[84:87], a[168:171], v[52:55], v[84:87]
 v_mul_f32 v105, s50, v105
 v_mfma_f32_16x16x32_bf16 v[92:95], a[240:243], v[52:55], v[92:95]
 s_waitcnt lgkmcnt(2)
 v_mfma_f32_16x16x32_bf16 v[64:67], a[28:31], v[56:59], v[64:67]
 ds_read_b128 v[40:43], v7 offset:16384
 v_mfma_f32_16x16x32_bf16 v[72:75], a[100:103], v[56:59], v[72:75]
 ds_read_b128 v[44:47], v7 offset:18432
 v_mul_f32 v106, s50, v106
 v_mfma_f32_16x16x32_bf16 v[80:83], a[172:175], v[56:59], v[80:83]
 v_mul_f32 v107, s50, v107
 v_mfma_f32_16x16x32_bf16 v[88:91], a[244:247], v[56:59], v[88:91]
 v_cvt_pk_bf16_f32 v16, v96, v97
 v_mfma_f32_16x16x32_bf16 v[68:71], a[28:31], v[60:63], v[68:71]
 v_mfma_f32_16x16x32_bf16 v[76:79], a[100:103], v[60:63], v[76:79]
 v_cvt_pk_bf16_f32 v17, v104, v105
 v_mfma_f32_16x16x32_bf16 v[84:87], a[172:175], v[60:63], v[84:87]
 v_cvt_pk_bf16_f32 v18, v98, v99
 v_mfma_f32_16x16x32_bf16 v[92:95], a[244:247], v[60:63], v[92:95]
 s_waitcnt lgkmcnt(2)
 v_cvt_pk_bf16_f32 v19, v106, v107
 v_mfma_f32_16x16x32_bf16 v[64:67], a[32:35], v[32:35], v[64:67]
 ds_read_b128 v[48:51], v6 offset:20480
 v_mfma_f32_16x16x32_bf16 v[72:75], a[104:107], v[32:35], v[72:75]
 ds_read_b128 v[52:55], v6 offset:22528
 v_mfma_f32_16x16x32_bf16 v[80:83], a[176:179], v[32:35], v[80:83]
 buffer_store_dwordx4 v[16:19], v12, s[20:23], s47 offen offset:0 sc1
 v_mfma_f32_16x16x32_bf16 v[88:91], a[248:251], v[32:35], v[88:91]
 v_mul_f32 v100, s50, v100
 v_mfma_f32_16x16x32_bf16 v[68:71], a[32:35], v[36:39], v[68:71]
 v_mul_f32 v101, s50, v101
 v_mfma_f32_16x16x32_bf16 v[76:79], a[104:107], v[36:39], v[76:79]
 v_mul_f32 v102, s50, v102
 v_mfma_f32_16x16x32_bf16 v[84:87], a[176:179], v[36:39], v[84:87]
 v_mul_f32 v103, s50, v103
 v_mfma_f32_16x16x32_bf16 v[92:95], a[248:251], v[36:39], v[92:95]
 s_waitcnt lgkmcnt(2)
 v_mfma_f32_16x16x32_bf16 v[64:67], a[36:39], v[40:43], v[64:67]
 ds_read_b128 v[56:59], v7 offset:20480
 v_mul_f32 v108, s50, v108
 v_mfma_f32_16x16x32_bf16 v[72:75], a[108:111], v[40:43], v[72:75]
 ds_read_b128 v[60:63], v7 offset:22528
 v_mfma_f32_16x16x32_bf16 v[80:83], a[180:183], v[40:43], v[80:83]
 v_mul_f32 v109, s50, v109
 v_mfma_f32_16x16x32_bf16 v[88:91], a[252:255], v[40:43], v[88:91]
 v_mul_f32 v110, s50, v110
 v_mfma_f32_16x16x32_bf16 v[68:71], a[36:39], v[44:47], v[68:71]
 v_mul_f32 v111, s50, v111
 v_mfma_f32_16x16x32_bf16 v[76:79], a[108:111], v[44:47], v[76:79]
 v_mfma_f32_16x16x32_bf16 v[84:87], a[180:183], v[44:47], v[84:87]
 v_cvt_pk_bf16_f32 v20, v100, v101
 v_mfma_f32_16x16x32_bf16 v[92:95], a[252:255], v[44:47], v[92:95]
 s_waitcnt lgkmcnt(2)
 v_cvt_pk_bf16_f32 v21, v108, v109
 v_mfma_f32_16x16x32_bf16 v[64:67], a[40:43], v[48:51], v[64:67]
 ds_read_b128 v[32:35], v6 offset:24576
 v_mfma_f32_16x16x32_bf16 v[72:75], a[112:115], v[48:51], v[72:75]
 ds_read_b128 v[36:39], v6 offset:26624
 v_cvt_pk_bf16_f32 v22, v102, v103
 v_mfma_f32_16x16x32_bf16 v[80:83], a[184:187], v[48:51], v[80:83]
 v_mfma_f32_16x16x32_bf16 v[88:91], v[224:227], v[48:51], v[88:91]
 v_cvt_pk_bf16_f32 v23, v110, v111
 v_mfma_f32_16x16x32_bf16 v[68:71], a[40:43], v[52:55], v[68:71]
 buffer_store_dwordx4 v[20:23], v12, s[20:23], s47 offen offset:1024 sc1
 v_mfma_f32_16x16x32_bf16 v[76:79], a[112:115], v[52:55], v[76:79]
 v_mul_f32 v112, s50, v112
 v_mfma_f32_16x16x32_bf16 v[84:87], a[184:187], v[52:55], v[84:87]
 v_mul_f32 v113, s50, v113
 v_mfma_f32_16x16x32_bf16 v[92:95], v[224:227], v[52:55], v[92:95]
 s_waitcnt lgkmcnt(2)
 v_mfma_f32_16x16x32_bf16 v[64:67], a[44:47], v[56:59], v[64:67]
 ds_read_b128 v[40:43], v7 offset:24576
 v_mul_f32 v114, s50, v114
 v_mfma_f32_16x16x32_bf16 v[72:75], a[116:119], v[56:59], v[72:75]
 ds_read_b128 v[44:47], v7 offset:26624
 v_mfma_f32_16x16x32_bf16 v[80:83], a[188:191], v[56:59], v[80:83]
 v_mul_f32 v115, s50, v115
 v_mfma_f32_16x16x32_bf16 v[88:91], v[228:231], v[56:59], v[88:91]
 v_mul_f32 v120, s50, v120
 v_mfma_f32_16x16x32_bf16 v[68:71], a[44:47], v[60:63], v[68:71]
 v_mul_f32 v121, s50, v121
 v_mfma_f32_16x16x32_bf16 v[76:79], a[116:119], v[60:63], v[76:79]
 v_mfma_f32_16x16x32_bf16 v[84:87], a[188:191], v[60:63], v[84:87]
 v_mul_f32 v122, s50, v122
 v_mfma_f32_16x16x32_bf16 v[92:95], v[228:231], v[60:63], v[92:95]
 s_waitcnt lgkmcnt(2)
 v_mul_f32 v123, s50, v123
 v_mfma_f32_16x16x32_bf16 v[64:67], a[48:51], v[32:35], v[64:67]
 ds_read_b128 v[48:51], v6 offset:28672
 v_mfma_f32_16x16x32_bf16 v[72:75], a[120:123], v[32:35], v[72:75]
 ds_read_b128 v[52:55], v6 offset:30720
 v_cvt_pk_bf16_f32 v24, v112, v113
 v_mfma_f32_16x16x32_bf16 v[80:83], a[192:195], v[32:35], v[80:83]
 v_mfma_f32_16x16x32_bf16 v[88:91], v[232:235], v[32:35], v[88:91]
 v_cvt_pk_bf16_f32 v25, v120, v121
 v_mfma_f32_16x16x32_bf16 v[68:71], a[48:51], v[36:39], v[68:71]
 v_cvt_pk_bf16_f32 v26, v114, v115
 v_mfma_f32_16x16x32_bf16 v[76:79], a[120:123], v[36:39], v[76:79]
 v_cvt_pk_bf16_f32 v27, v122, v123
 v_mfma_f32_16x16x32_bf16 v[84:87], a[192:195], v[36:39], v[84:87]
 buffer_store_dwordx4 v[24:27], v12, s[20:23], s48 offen offset:0 sc1
 v_mfma_f32_16x16x32_bf16 v[92:95], v[232:235], v[36:39], v[92:95]
 s_waitcnt lgkmcnt(2)
 v_mfma_f32_16x16x32_bf16 v[64:67], a[52:55], v[40:43], v[64:67]
 ds_read_b128 v[56:59], v7 offset:28672
 v_mul_f32 v116, s50, v116
 v_mfma_f32_16x16x32_bf16 v[72:75], a[124:127], v[40:43], v[72:75]
 ds_read_b128 v[60:63], v7 offset:30720
 v_mfma_f32_16x16x32_bf16 v[80:83], a[196:199], v[40:43], v[80:83]
 s_add_u32 s43, s43, 36864
 s_cmp_eq_u32 s43, 147456
 v_mfma_f32_16x16x32_bf16 v[88:91], v[236:239], v[40:43], v[88:91]
 s_cselect_b32 s43, 0, s43
 s_add_u32 s44, s44, 36864
 v_mfma_f32_16x16x32_bf16 v[68:71], a[52:55], v[44:47], v[68:71]
 s_cmp_eq_u32 s44, 147456
 s_cselect_b32 s44, 0, s44
 v_mfma_f32_16x16x32_bf16 v[76:79], a[124:127], v[44:47], v[76:79]
 v_mul_f32 v117, s50, v117
 v_mfma_f32_16x16x32_bf16 v[84:87], a[196:199], v[44:47], v[84:87]
 v_mul_f32 v118, s50, v118
 v_mfma_f32_16x16x32_bf16 v[92:95], v[236:239], v[44:47], v[92:95]
 s_waitcnt lgkmcnt(2)
 v_mfma_f32_16x16x32_bf16 v[64:67], a[56:59], v[48:51], v[64:67]
 ds_read_b128 v[32:35], v6 offset:32768
 v_mul_f32 v119, s50, v119
 v_mfma_f32_16x16x32_bf16 v[72:75], a[128:131], v[48:51], v[72:75]
 ds_read_b128 v[36:39], v6 offset:34816
 v_mfma_f32_16x16x32_bf16 v[80:83], a[200:203], v[48:51], v[80:83]
 v_add_u32 v6, s43, v4
 v_mul_f32 v124, s50, v124
 v_mfma_f32_16x16x32_bf16 v[88:91], v[240:243], v[48:51], v[88:91]
 v_mfma_f32_16x16x32_bf16 v[68:71], a[56:59], v[52:55], v[68:71]
 v_mul_f32 v125, s50, v125
 v_mfma_f32_16x16x32_bf16 v[76:79], a[128:131], v[52:55], v[76:79]
 v_mul_f32 v126, s50, v126
 v_mfma_f32_16x16x32_bf16 v[84:87], a[200:203], v[52:55], v[84:87]
 v_mul_f32 v127, s50, v127
 v_mfma_f32_16x16x32_bf16 v[92:95], v[240:243], v[52:55], v[92:95]
 s_waitcnt lgkmcnt(2)
 v_mfma_f32_16x16x32_bf16 v[64:67], a[60:63], v[56:59], v[64:67]
 ds_read_b128 v[40:43], v7 offset:32768
 v_cvt_pk_bf16_f32 v28, v116, v117
 v_mfma_f32_16x16x32_bf16 v[72:75], a[132:135], v[56:59], v[72:75]
 ds_read_b128 v[44:47], v7 offset:34816
 v_mfma_f32_16x16x32_bf16 v[80:83], a[204:207], v[56:59], v[80:83]
 v_add_u32 v7, s43, v5
 v_cvt_pk_bf16_f32 v29, v124, v125
 v_mfma_f32_16x16x32_bf16 v[88:91], v[244:247], v[56:59], v[88:91]
 v_cvt_pk_bf16_f32 v30, v118, v119
 v_mfma_f32_16x16x32_bf16 v[68:71], a[60:63], v[60:63], v[68:71]
 v_mfma_f32_16x16x32_bf16 v[76:79], a[132:135], v[60:63], v[76:79]
 v_cvt_pk_bf16_f32 v31, v126, v127
 v_mfma_f32_16x16x32_bf16 v[84:87], a[204:207], v[60:63], v[84:87]
 buffer_store_dwordx4 v[28:31], v12, s[20:23], s48 offen offset:1024 sc1
 v_mfma_f32_16x16x32_bf16 v[92:95], v[244:247], v[60:63], v[92:95]
 s_waitcnt lgkmcnt(2)
 v_mfma_f32_16x16x32_bf16 v[64:67], a[64:67], v[32:35], v[64:67]
 s_waitcnt vmcnt(13)
 s_barrier
 ds_read_b128 v[48:51], v6 offset:0
 v_mfma_f32_16x16x32_bf16 v[72:75], a[136:139], v[32:35], v[72:75]
 ds_read_b128 v[52:55], v6 offset:2048
 v_mfma_f32_16x16x32_bf16 v[80:83], a[208:211], v[32:35], v[80:83]
 buffer_store_dword v14, v13, s[20:23], 0 offen sc1
 v_mfma_f32_16x16x32_bf16 v[88:91], v[248:251], v[32:35], v[88:91]
 v_mfma_f32_16x16x32_bf16 v[68:71], a[64:67], v[36:39], v[68:71]
 v_mfma_f32_16x16x32_bf16 v[76:79], a[136:139], v[36:39], v[76:79]
 v_mfma_f32_16x16x32_bf16 v[84:87], a[208:211], v[36:39], v[84:87]
 v_mfma_f32_16x16x32_bf16 v[92:95], v[248:251], v[36:39], v[92:95]
 s_waitcnt lgkmcnt(2)
 v_mfma_f32_16x16x32_bf16 v[64:67], a[68:71], v[40:43], v[64:67]
 ds_read_b128 v[56:59], v7 offset:0
 v_mfma_f32_16x16x32_bf16 v[72:75], a[140:143], v[40:43], v[72:75]
 ds_read_b128 v[60:63], v7 offset:2048
 v_mfma_f32_16x16x32_bf16 v[80:83], a[212:215], v[40:43], v[80:83]
 s_mul_i32 s45, s39, 262144
 s_add_u32 s47, s34, s45
 v_mfma_f32_16x16x32_bf16 v[88:91], v[252:255], v[40:43], v[88:91]
 s_add_u32 s48, s35, s45
 v_mov_b32 v14, s42
 v_mfma_f32_16x16x32_bf16 v[68:71], a[68:71], v[44:47], v[68:71]
 s_mov_b32 s39, s40
 s_mov_b32 s40, s41
 v_mfma_f32_16x16x32_bf16 v[76:79], a[140:143], v[44:47], v[76:79]
 s_add_u32 s42, s42, 1
 v_mfma_f32_16x16x32_bf16 v[84:87], a[212:215], v[44:47], v[84:87]
 v_mfma_f32_16x16x32_bf16 v[92:95], v[252:255], v[44:47], v[92:95]
 s_waitcnt lgkmcnt(2)
 v_mfma_f32_16x16x32_bf16 v[96:99], a[0:3], v[48:51], 0
 ds_read_b128 v[32:35], v6 offset:4096
 v_mfma_f32_16x16x32_bf16 v[104:107], a[72:75], v[48:51], 0
 ds_read_b128 v[36:39], v6 offset:6144
 v_mfma_f32_16x16x32_bf16 v[112:115], a[144:147], v[48:51], 0
 s_add_u32 s41, s40, 4
 v_mfma_f32_16x16x32_bf16 v[120:123], a[216:219], v[48:51], 0
 s_add_u32 s45, s42, 2
 s_mul_i32 s46, s41, 36864
 v_mfma_f32_16x16x32_bf16 v[100:103], a[0:3], v[52:55], 0
 s_cmp_lt_u32 s45, s36
 s_cselect_b32 s46, s46, 0
 v_mfma_f32_16x16x32_bf16 v[108:111], a[72:75], v[52:55], 0
 s_lshl_b32 s49, s4, 10
 s_add_u32 s49, s49, s44
 v_mfma_f32_16x16x32_bf16 v[116:119], a[144:147], v[52:55], 0
 v_mfma_f32_16x16x32_bf16 v[124:127], a[216:219], v[52:55], 0
 s_waitcnt lgkmcnt(2)
 v_mfma_f32_16x16x32_bf16 v[96:99], a[4:7], v[56:59], v[96:99]
 ds_read_b128 v[40:43], v7 offset:4096
 v_mfma_f32_16x16x32_bf16 v[104:107], a[76:79], v[56:59], v[104:107]
 ds_read_b128 v[44:47], v7 offset:6144
 v_mfma_f32_16x16x32_bf16 v[112:115], a[148:151], v[56:59], v[112:115]
 s_add_u32 m0, s49, 0
 v_mfma_f32_16x16x32_bf16 v[120:123], a[220:223], v[56:59], v[120:123]
 buffer_load_dwordx4 v10, s[8:11], s46 offen offset:0  lds
 v_mfma_f32_16x16x32_bf16 v[100:103], a[4:7], v[60:63], v[100:103]
 s_add_u32 m0, s49, 3968
 v_mfma_f32_16x16x32_bf16 v[108:111], a[76:79], v[60:63], v[108:111]
 buffer_load_dwordx4 v10, s[8:11], s46 offen offset:128  lds
 v_mfma_f32_16x16x32_bf16 v[116:119], a[148:151], v[60:63], v[116:119]
 v_mfma_f32_16x16x32_bf16 v[124:127], a[220:223], v[60:63], v[124:127]
 s_waitcnt lgkmcnt(2)
 v_mfma_f32_16x16x32_bf16 v[96:99], a[8:11], v[32:35], v[96:99]
 ds_read_b128 v[48:51], v6 offset:8192
 v_mfma_f32_16x16x32_bf16 v[104:107], a[80:83], v[32:35], v[104:107]
 ds_read_b128 v[52:55], v6 offset:10240
 v_mfma_f32_16x16x32_bf16 v[112:115], a[152:155], v[32:35], v[112:115]
 s_add_u32 m0, s49, 7936
 v_mfma_f32_16x16x32_bf16 v[120:123], a[224:227], v[32:35], v[120:123]
 buffer_load_dwordx4 v10, s[8:11], s46 offen offset:256  lds
 v_mfma_f32_16x16x32_bf16 v[100:103], a[8:11], v[36:39], v[100:103]
 s_add_u32 m0, s49, 11904
 v_mfma_f32_16x16x32_bf16 v[108:111], a[80:83], v[36:39], v[108:111]
 buffer_load_dwordx4 v10, s[8:11], s46 offen offset:384  lds
 v_mfma_f32_16x16x32_bf16 v[116:119], a[152:155], v[36:39], v[116:119]
 v_mfma_f32_16x16x32_bf16 v[124:127], a[224:227], v[36:39], v[124:127]
 s_waitcnt lgkmcnt(2)
 v_mfma_f32_16x16x32_bf16 v[96:99], a[12:15], v[40:43], v[96:99]
 ds_read_b128 v[56:59], v7 offset:8192
 v_mfma_f32_16x16x32_bf16 v[104:107], a[84:87], v[40:43], v[104:107]
 ds_read_b128 v[60:63], v7 offset:10240
 v_mfma_f32_16x16x32_bf16 v[112:115], a[156:159], v[40:43], v[112:115]
 s_add_u32 m0, s49, 15872
 v_mfma_f32_16x16x32_bf16 v[120:123], a[228:231], v[40:43], v[120:123]
 buffer_load_dwordx4 v10, s[8:11], s46 offen offset:512  lds
 v_mfma_f32_16x16x32_bf16 v[100:103], a[12:15], v[44:47], v[100:103]
 s_add_u32 m0, s49, 19840
 v_mfma_f32_16x16x32_bf16 v[108:111], a[84:87], v[44:47], v[108:111]
 buffer_load_dwordx4 v10, s[8:11], s46 offen offset:640  lds
 v_mfma_f32_16x16x32_bf16 v[116:119], a[156:159], v[44:47], v[116:119]
 v_mfma_f32_16x16x32_bf16 v[124:127], a[228:231], v[44:47], v[124:127]
 s_waitcnt lgkmcnt(2)
 v_mfma_f32_16x16x32_bf16 v[96:99], a[16:19], v[48:51], v[96:99]
 ds_read_b128 v[32:35], v6 offset:12288
 v_mfma_f32_16x16x32_bf16 v[104:107], a[88:91], v[48:51], v[104:107]
 ds_read_b128 v[36:39], v6 offset:14336
 v_mfma_f32_16x16x32_bf16 v[112:115], a[160:163], v[48:51], v[112:115]
 s_add_u32 m0, s49, 23808
 v_mfma_f32_16x16x32_bf16 v[120:123], a[232:235], v[48:51], v[120:123]
 buffer_load_dwordx4 v10, s[8:11], s46 offen offset:768  lds
 v_mfma_f32_16x16x32_bf16 v[100:103], a[16:19], v[52:55], v[100:103]
 s_add_u32 m0, s49, 27776
 v_mfma_f32_16x16x32_bf16 v[108:111], a[88:91], v[52:55], v[108:111]
 buffer_load_dwordx4 v10, s[8:11], s46 offen offset:896  lds
 v_mfma_f32_16x16x32_bf16 v[116:119], a[160:163], v[52:55], v[116:119]
 v_mfma_f32_16x16x32_bf16 v[124:127], a[232:235], v[52:55], v[124:127]
 s_waitcnt lgkmcnt(2)
 v_mfma_f32_16x16x32_bf16 v[96:99], a[20:23], v[56:59], v[96:99]
 ds_read_b128 v[40:43], v7 offset:12288
 v_mfma_f32_16x16x32_bf16 v[104:107], a[92:95], v[56:59], v[104:107]
 ds_read_b128 v[44:47], v7 offset:14336
 v_mfma_f32_16x16x32_bf16 v[112:115], a[164:167], v[56:59], v[112:115]
 s_add_u32 m0, s49, 31744
 v_mfma_f32_16x16x32_bf16 v[120:123], a[236:239], v[56:59], v[120:123]
 buffer_load_dwordx4 v10, s[8:11], s46 offen offset:1024  lds
 v_mfma_f32_16x16x32_bf16 v[100:103], a[20:23], v[60:63], v[100:103]
 v_mfma_f32_16x16x32_bf16 v[108:111], a[92:95], v[60:63], v[108:111]
 v_mfma_f32_16x16x32_bf16 v[116:119], a[164:167], v[60:63], v[116:119]
 v_mfma_f32_16x16x32_bf16 v[124:127], a[236:239], v[60:63], v[124:127]
 s_waitcnt lgkmcnt(2)
 v_mfma_f32_16x16x32_bf16 v[96:99], a[24:27], v[32:35], v[96:99]
 ds_read_b128 v[48:51], v6 offset:16384
 v_mul_f32 v64, s50, v64
 v_mfma_f32_16x16x32_bf16 v[104:107], a[96:99], v[32:35], v[104:107]
 ds_read_b128 v[52:55], v6 offset:18432
 v_mfma_f32_16x16x32_bf16 v[112:115], a[168:171], v[32:35], v[112:115]
 v_mul_f32 v65, s50, v65
 v_mfma_f32_16x16x32_bf16 v[120:123], a[240:243], v[32:35], v[120:123]
 v_mul_f32 v66, s50, v66
 v_mfma_f32_16x16x32_bf16 v[100:103], a[24:27], v[36:39], v[100:103]
 v_mul_f32 v67, s50, v67
 v_mfma_f32_16x16x32_bf16 v[108:111], a[96:99], v[36:39], v[108:111]
 v_mul_f32 v72, s50, v72
 v_mfma_f32_16x16x32_bf16 v[116:119], a[168:171], v[36:39], v[116:119]
 v_mul_f32 v73, s50, v73
 v_mfma_f32_16x16x32_bf16 v[124:127], a[240:243], v[36:39], v[124:127]
 s_waitcnt lgkmcnt(2)
 v_mfma_f32_16x16x32_bf16 v[96:99], a[28:31], v[40:43], v[96:99]
 ds_read_b128 v[56:59], v7 offset:16384
 v_mfma_f32_16x16x32_bf16 v[104:107], a[100:103], v[40:43], v[104:107]
 ds_read_b128 v[60:63], v7 offset:18432
 v_mul_f32 v74, s50, v74
 v_mfma_f32_16x16x32_bf16 v[112:115], a[172:175], v[40:43], v[112:115]
 v_mul_f32 v75, s50, v75
 v_mfma_f32_16x16x32_bf16 v[120:123], a[244:247], v[40:43], v[120:123]
 v_cvt_pk_bf16_f32 v16, v64, v65
 v_mfma_f32_16x16x32_bf16 v[100:103], a[28:31], v[44:47], v[100:103]
 v_mfma_f32_16x16x32_bf16 v[108:111], a[100:103], v[44:47], v[108:111]
 v_cvt_pk_bf16_f32 v17, v72, v73
 v_mfma_f32_16x16x32_bf16 v[116:119], a[172:175], v[44:47], v[116:119]
 v_cvt_pk_bf16_f32 v18, v66, v67
 v_mfma_f32_16x16x32_bf16 v[124:127], a[244:247], v[44:47], v[124:127]
 s_waitcnt lgkmcnt(2)
 v_cvt_pk_bf16_f32 v19, v74, v75
 v_mfma_f32_16x16x32_bf16 v[96:99], a[32:35], v[48:51], v[96:99]
 ds_read_b128 v[32:35], v6 offset:20480
 v_mfma_f32_16x16x32_bf16 v[104:107], a[104:107], v[48:51], v[104:107]
 ds_read_b128 v[36:39], v6 offset:22528
 v_mfma_f32_16x16x32_bf16 v[112:115], a[176:179], v[48:51], v[112:115]
 buffer_store_dwordx4 v[16:19], v12, s[20:23], s47 offen offset:0 sc1
 v_mfma_f32_16x16x32_bf16 v[120:123], a[248:251], v[48:51], v[120:123]
 v_mul_f32 v68, s50, v68
 v_mfma_f32_16x16x32_bf16 v[100:103], a[32:35], v[52:55], v[100:103]
 v_mul_f32 v69, s50, v69
 v_mfma_f32_16x16x32_bf16 v[108:111], a[104:107], v[52:55], v[108:111]
 v_mul_f32 v70, s50, v70
 v_mfma_f32_16x16x32_bf16 v[116:119], a[176:179], v[52:55], v[116:119]
 v_mul_f32 v71, s50, v71
 v_mfma_f32_16x16x32_bf16 v[124:127], a[248:251], v[52:55], v[124:127]
 s_waitcnt lgkmcnt(2)
 v_mfma_f32_16x16x32_bf16 v[96:99], a[36:39], v[56:59], v[96:99]
 ds_read_b128 v[40:43], v7 offset:20480
 v_mul_f32 v76, s50, v76
 v_mfma_f32_16x16x32_bf16 v[104:107], a[108:111], v[56:59], v[104:107]
 ds_read_b128 v[44:47], v7 offset:22528
 v_mfma_f32_16x16x32_bf16 v[112:115], a[180:183], v[56:59], v[112:115]
 v_mul_f32 v77, s50, v77
 v_mfma_f32_16x16x32_bf16 v[120:123], a[252:255], v[56:59], v[120:123]
 v_mul_f32 v78, s50, v78
 v_mfma_f32_16x16x32_bf16 v[100:103], a[36:39], v[60:63], v[100:103]
 v_mul_f32 v79, s50, v79
 v_mfma_f32_16x16x32_bf16 v[108:111], a[108:111], v[60:63], v[108:111]
 v_mfma_f32_16x16x32_bf16 v[116:119], a[180:183], v[60:63], v[116:119]
 v_cvt_pk_bf16_f32 v20, v68, v69
 v_mfma_f32_16x16x32_bf16 v[124:127], a[252:255], v[60:63], v[124:127]
 s_waitcnt lgkmcnt(2)
 v_cvt_pk_bf16_f32 v21, v76, v77
 v_mfma_f32_16x16x32_bf16 v[96:99], a[40:43], v[32:35], v[96:99]
 ds_read_b128 v[48:51], v6 offset:24576
 v_mfma_f32_16x16x32_bf16 v[104:107], a[112:115], v[32:35], v[104:107]
 ds_read_b128 v[52:55], v6 offset:26624
 v_cvt_pk_bf16_f32 v22, v70, v71
 v_mfma_f32_16x16x32_bf16 v[112:115], a[184:187], v[32:35], v[112:115]
 v_mfma_f32_16x16x32_bf16 v[120:123], v[224:227], v[32:35], v[120:123]
 v_cvt_pk_bf16_f32 v23, v78, v79
 v_mfma_f32_16x16x32_bf16 v[100:103], a[40:43], v[36:39], v[100:103]
 buffer_store_dwordx4 v[20:23], v12, s[20:23], s47 offen offset:1024 sc1
 v_mfma_f32_16x16x32_bf16 v[108:111], a[112:115], v[36:39], v[108:111]
 v_mul_f32 v80, s50, v80
 v_mfma_f32_16x16x32_bf16 v[116:119], a[184:187], v[36:39], v[116:119]
 v_mul_f32 v81, s50, v81
 v_mfma_f32_16x16x32_bf16 v[124:127], v[224:227], v[36:39], v[124:127]
 s_waitcnt lgkmcnt(2)
 v_mfma_f32_16x16x32_bf16 v[96:99], a[44:47], v[40:43], v[96:99]
 ds_read_b128 v[56:59], v7 offset:24576
 v_mul_f32 v82, s50, v82
 v_mfma_f32_16x16x32_bf16 v[104:107], a[116:119], v[40:43], v[104:107]
 ds_read_b128 v[60:63], v7 offset:26624
 v_mfma_f32_16x16x32_bf16 v[112:115], a[188:191], v[40:43], v[112:115]
 v_mul_f32 v83, s50, v83
 v_mfma_f32_16x16x32_bf16 v[120:123], v[228:231], v[40:43], v[120:123]
 v_mul_f32 v88, s50, v88
 v_mfma_f32_16x16x32_bf16 v[100:103], a[44:47], v[44:47], v[100:103]
 v_mul_f32 v89, s50, v89
 v_mfma_f32_16x16x32_bf16 v[108:111], a[116:119], v[44:47], v[108:111]
 v_mfma_f32_16x16x32_bf16 v[116:119], a[188:191], v[44:47], v[116:119]
 v_mul_f32 v90, s50, v90
 v_mfma_f32_16x16x32_bf16 v[124:127], v[228:231], v[44:47], v[124:127]
 s_waitcnt lgkmcnt(2)
 v_mul_f32 v91, s50, v91
 v_mfma_f32_16x16x32_bf16 v[96:99], a[48:51], v[48:51], v[96:99]
 ds_read_b128 v[32:35], v6 offset:28672
 v_mfma_f32_16x16x32_bf16 v[104:107], a[120:123], v[48:51], v[104:107]
 ds_read_b128 v[36:39], v6 offset:30720
 v_cvt_pk_bf16_f32 v24, v80, v81
 v_mfma_f32_16x16x32_bf16 v[112:115], a[192:195], v[48:51], v[112:115]
 v_mfma_f32_16x16x32_bf16 v[120:123], v[232:235], v[48:51], v[120:123]
 v_cvt_pk_bf16_f32 v25, v88, v89
 v_mfma_f32_16x16x32_bf16 v[100:103], a[48:51], v[52:55], v[100:103]
 v_cvt_pk_bf16_f32 v26, v82, v83
 v_mfma_f32_16x16x32_bf16 v[108:111], a[120:123], v[52:55], v[108:111]
 v_cvt_pk_bf16_f32 v27, v90, v91
 v_mfma_f32_16x16x32_bf16 v[116:119], a[192:195], v[52:55], v[116:119]
 buffer_store_dwordx4 v[24:27], v12, s[20:23], s48 offen offset:0 sc1
 v_mfma_f32_16x16x32_bf16 v[124:127], v[232:235], v[52:55], v[124:127]
 s_waitcnt lgkmcnt(2)
 v_mfma_f32_16x16x32_bf16 v[96:99], a[52:55], v[56:59], v[96:99]
 ds_read_b128 v[40:43], v7 offset:28672
 v_mul_f32 v84, s50, v84
 v_mfma_f32_16x16x32_bf16 v[104:107], a[124:127], v[56:59], v[104:107]
 ds_read_b128 v[44:47], v7 offset:30720
 v_mfma_f32_16x16x32_bf16 v[112:115], a[196:199], v[56:59], v[112:115]
 s_add_u32 s43, s43, 36864
 s_cmp_eq_u32 s43, 147456
 v_mfma_f32_16x16x32_bf16 v[120:123], v[236:239], v[56:59], v[120:123]
 s_cselect_b32 s43, 0, s43
 s_add_u32 s44, s44, 36864
 v_mfma_f32_16x16x32_bf16 v[100:103], a[52:55], v[60:63], v[100:103]
 s_cmp_eq_u32 s44, 147456
 s_cselect_b32 s44, 0, s44
 v_mfma_f32_16x16x32_bf16 v[108:111], a[124:127], v[60:63], v[108:111]
 v_mul_f32 v85, s50, v85
 v_mfma_f32_16x16x32_bf16 v[116:119], a[196:199], v[60:63], v[116:119]
 v_mul_f32 v86, s50, v86
 v_mfma_f32_16x16x32_bf16 v[124:127], v[236:239], v[60:63], v[124:127]
 s_waitcnt lgkmcnt(2)
 v_mfma_f32_16x16x32_bf16 v[96:99], a[56:59], v[32:35], v[96:99]
 ds_read_b128 v[48:51], v6 offset:32768
 v_mul_f32 v87, s50, v87
 v_mfma_f32_16x16x32_bf16 v[104:107], a[128:131], v[32:35], v[104:107]
 ds_read_b128 v[52:55], v6 offset:34816
 v_mfma_f32_16x16x32_bf16 v[112:115], a[200:203], v[32:35], v[112:115]
 v_add_u32 v6, s43, v4
 v_mul_f32 v92, s50, v92
 v_mfma_f32_16x16x32_bf16 v[120:123], v[240:243], v[32:35], v[120:123]
 v_mfma_f32_16x16x32_bf16 v[100:103], a[56:59], v[36:39], v[100:103]
 v_mul_f32 v93, s50, v93
 v_mfma_f32_16x16x32_bf16 v[108:111], a[128:131], v[36:39], v[108:111]
 v_mul_f32 v94, s50, v94
 v_mfma_f32_16x16x32_bf16 v[116:119], a[200:203], v[36:39], v[116:119]
 v_mul_f32 v95, s50, v95
 v_mfma_f32_16x16x32_bf16 v[124:127], v[240:243], v[36:39], v[124:127]
 s_waitcnt lgkmcnt(2)
 v_mfma_f32_16x16x32_bf16 v[96:99], a[60:63], v[40:43], v[96:99]
 ds_read_b128 v[56:59], v7 offset:32768
 v_cvt_pk_bf16_f32 v28, v84, v85
 v_mfma_f32_16x16x32_bf16 v[104:107], a[132:135], v[40:43], v[104:107]
 ds_read_b128 v[60:63], v7 offset:34816
 v_mfma_f32_16x16x32_bf16 v[112:115], a[204:207], v[40:43], v[112:115]
 v_add_u32 v7, s43, v5
 v_cvt_pk_bf16_f32 v29, v92, v93
 v_mfma_f32_16x16x32_bf16 v[120:123], v[244:247], v[40:43], v[120:123]
 v_cvt_pk_bf16_f32 v30, v86, v87
 v_mfma_f32_16x16x32_bf16 v[100:103], a[60:63], v[44:47], v[100:103]
 v_mfma_f32_16x16x32_bf16 v[108:111], a[132:135], v[44:47], v[108:111]
 v_cvt_pk_bf16_f32 v31, v94, v95
 v_mfma_f32_16x16x32_bf16 v[116:119], a[204:207], v[44:47], v[116:119]
 buffer_store_dwordx4 v[28:31], v12, s[20:23], s48 offen offset:1024 sc1
 v_mfma_f32_16x16x32_bf16 v[124:127], v[244:247], v[44:47], v[124:127]
 s_waitcnt lgkmcnt(2)
 v_mfma_f32_16x16x32_bf16 v[96:99], a[64:67], v[48:51], v[96:99]
 s_waitcnt vmcnt(13)
 s_barrier
 ds_read_b128 v[32:35], v6 offset:0
 v_mfma_f32_16x16x32_bf16 v[104:107], a[136:139], v[48:51], v[104:107]
 ds_read_b128 v[36:39], v6 offset:2048
 v_mfma_f32_16x16x32_bf16 v[112:115], a[208:211], v[48:51], v[112:115]
 buffer_store_dword v14, v13, s[20:23], 0 offen sc1
 v_mfma_f32_16x16x32_bf16 v[120:123], v[248:251], v[48:51], v[120:123]
 v_mfma_f32_16x16x32_bf16 v[100:103], a[64:67], v[52:55], v[100:103]
 v_mfma_f32_16x16x32_bf16 v[108:111], a[136:139], v[52:55], v[108:111]
 v_mfma_f32_16x16x32_bf16 v[116:119], a[208:211], v[52:55], v[116:119]
 v_mfma_f32_16x16x32_bf16 v[124:127], v[248:251], v[52:55], v[124:127]
 s_waitcnt lgkmcnt(2)
 v_mfma_f32_16x16x32_bf16 v[96:99], a[68:71], v[56:59], v[96:99]
 ds_read_b128 v[40:43], v7 offset:0
 v_mfma_f32_16x16x32_bf16 v[104:107], a[140:143], v[56:59], v[104:107]
 ds_read_b128 v[44:47], v7 offset:2048
 v_mfma_f32_16x16x32_bf16 v[112:115], a[212:215], v[56:59], v[112:115]
 s_mul_i32 s45, s39, 262144
 s_add_u32 s47, s34, s45
 v_mfma_f32_16x16x32_bf16 v[120:123], v[252:255], v[56:59], v[120:123]
 s_add_u32 s48, s35, s45
 v_mov_b32 v14, s42
 v_mfma_f32_16x16x32_bf16 v[100:103], a[68:71], v[60:63], v[100:103]
 s_mov_b32 s39, s40
 s_mov_b32 s40, s41
 v_mfma_f32_16x16x32_bf16 v[108:111], a[140:143], v[60:63], v[108:111]
 s_add_u32 s42, s42, 1
 s_cmp_lt_u32 s42, s36
 v_mfma_f32_16x16x32_bf16 v[116:119], a[212:215], v[60:63], v[116:119]
 v_mfma_f32_16x16x32_bf16 v[124:127], v[252:255], v[60:63], v[124:127]
 s_waitcnt lgkmcnt(2)
 s_cbranch_scc1 Lps_loop_37
 s_nop 7
 v_mul_f32 v96, s50, v96
 v_mul_f32 v97, s50, v97
 v_mul_f32 v98, s50, v98
 v_mul_f32 v99, s50, v99
 v_mul_f32 v104, s50, v104
 v_mul_f32 v105, s50, v105
 v_mul_f32 v106, s50, v106
 v_mul_f32 v107, s50, v107
 v_cvt_pk_bf16_f32 v16, v96, v97
 v_cvt_pk_bf16_f32 v17, v104, v105
 v_cvt_pk_bf16_f32 v18, v98, v99
 v_cvt_pk_bf16_f32 v19, v106, v107
 buffer_store_dwordx4 v[16:19], v12, s[20:23], s47 offen offset:0 sc1
 v_mul_f32 v100, s50, v100
 v_mul_f32 v101, s50, v101
 v_mul_f32 v102, s50, v102
 v_mul_f32 v103, s50, v103
 v_mul_f32 v108, s50, v108
 v_mul_f32 v109, s50, v109
 v_mul_f32 v110, s50, v110
 v_mul_f32 v111, s50, v111
 v_cvt_pk_bf16_f32 v20, v100, v101
 v_cvt_pk_bf16_f32 v21, v108, v109
 v_cvt_pk_bf16_f32 v22, v102, v103
 v_cvt_pk_bf16_f32 v23, v110, v111
 buffer_store_dwordx4 v[20:23], v12, s[20:23], s47 offen offset:1024 sc1
 v_mul_f32 v112, s50, v112
 v_mul_f32 v113, s50, v113
 v_mul_f32 v114, s50, v114
 v_mul_f32 v115, s50, v115
 v_mul_f32 v120, s50, v120
 v_mul_f32 v121, s50, v121
 v_mul_f32 v122, s50, v122
 v_mul_f32 v123, s50, v123
 v_cvt_pk_bf16_f32 v24, v112, v113
 v_cvt_pk_bf16_f32 v25, v120, v121
 v_cvt_pk_bf16_f32 v26, v114, v115
 v_cvt_pk_bf16_f32 v27, v122, v123
 buffer_store_dwordx4 v[24:27], v12, s[20:23], s48 offen offset:0 sc1
 v_mul_f32 v116, s50, v116
 v_mul_f32 v117, s50, v117
 v_mul_f32 v118, s50, v118
 v_mul_f32 v119, s50, v119
 v_mul_f32 v124, s50, v124
 v_mul_f32 v125, s50, v125
 v_mul_f32 v126, s50, v126
 v_mul_f32 v127, s50, v127
 v_cvt_pk_bf16_f32 v28, v116, v117
 v_cvt_pk_bf16_f32 v29, v124, v125
 v_cvt_pk_bf16_f32 v30, v118, v119
 v_cvt_pk_bf16_f32 v31, v126, v127
 buffer_store_dwordx4 v[28:31], v12, s[20:23], s48 offen offset:1024 sc1
 s_waitcnt vmcnt(0) lgkmcnt(0)
 s_barrier
 v_mov_b32 v14, s36
 buffer_store_dword v14, v13, s[20:23], 0 offen sc1
 s_sub_u32 s3, s5, 2
 s_add_u32 s7, s6, s3
 s_cmp_ge_u32 s7, 30
 s_cbranch_scc1 Lfin
 s_cmp_ge_u32 s6, 16
 s_cbranch_scc1 Lob
 s_load_dwordx2 s[8:9], s[0:1], 48
 s_mov_b32 s10, 0x240000
 s_mov_b32 s11, 0x20000
 s_load_dwordx2 s[12:13], s[0:1], 64
 s_mov_b32 s14, 0x480000
 s_mov_b32 s15, 0x20000
 s_load_dwordx2 s[16:17], s[0:1], 64
 s_mov_b32 s18, 0x480000
 s_mov_b32 s19, 0x20000
 s_lshl_b32 s32, s6, 9
 s_add_u32 s33, s32, 256
 s_mov_b32 s36, 32
 s_mov_b32 s37, s3
 s_lshl_b32 s52, s6, 1
 s_lshl_b32 s7, s3, 4
 s_add_u32 s7, s7, s6
 s_and_b32 s94, s7, 3
 s_lshr_b32 s7, s7, 2
 s_lshl_b32 s7, s7, 5
 s_add_u32 s7, s7, s94
 s_lshl_b32 s7, s7, 2
 s_add_u32 s59, s7, 0x3800
 s_waitcnt lgkmcnt(0)
 v_and_b32 v1, 63, v0
 v_lshrrev_b32 v2, 3, v0
 v_mul_u32_u24 v10, 1152, v2
 v_lshrrev_b32 v2, 4, v0
 v_xor_b32 v2, v2, v0
 v_and_b32 v2, 7, v2
 v_lshl_add_u32 v10, v2, 4, v10
 v_lshrrev_b32 v2, 4, v1
 v_bfe_u32 v3, v1, 1, 3
 v_xor_b32 v2, v2, v3
 v_and_b32 v3, 15, v1
 v_lshlrev_b32 v3, 7, v3
 v_lshl_add_u32 v4, v2, 4, v3
 v_xor_b32 v5, 64, v4
 v_lshrrev_b32 v2, 4, v0
 v_lshlrev_b32 v11, 13, v2
 v_lshrrev_b32 v2, 7, v0
 v_lshrrev_b32 v3, 4, v1
 v_lshl_add_u32 v3, v2, 2, v3
 v_bfe_u32 v2, v1, 1, 3
 v_xor_b32 v2, v2, v3
 v_lshl_add_u32 v11, v2, 5, v11
 v_and_b32 v2, 1, v1
 v_lshl_add_u32 v11, v2, 4, v11
 v_bfe_u32 v2, v1, 2, 3
 v_xor_b32 v3, s4, v2
 v_lshlrev_b32 v3, 5, v3
 v_and_b32 v2, 3, v2
 v_lshl_add_u32 v3, v2, 8, v3
 v_lshrrev_b32 v2, 4, v1
 v_lshl_add_u32 v3, v2, 11, v3
 v_and_b32 v2, 3, v1
 v_lshl_add_u32 v3, v2, 3, v3
 v_add_u32 v8, 73728, v3
 v_xor_b32 v3, 0x80, v3
 v_add_u32 v9, 73728, v3
 s_lshl_b32 s45, s4, 11
 v_lshl_add_u32 v12, v1, 4, s45
 s_mov_b32 s39, s37
 s_add_u32 s40, s39, 2
 s_lshl_b32 s49, s4, 10
 s_mul_i32 s46, s39, 36864
 s_add_u32 m0, s49, 0
 s_nop 0
 buffer_load_dwordx4 v10, s[8:11], s46 offen offset:0  lds
 s_add_u32 m0, s49, 3968
 s_nop 0
 buffer_load_dwordx4 v10, s[8:11], s46 offen offset:128  lds
 s_add_u32 m0, s49, 7936
 s_nop 0
 buffer_load_dwordx4 v10, s[8:11], s46 offen offset:256  lds
 s_add_u32 m0, s49, 11904
 s_nop 0
 buffer_load_dwordx4 v10, s[8:11], s46 offen offset:384  lds
 s_add_u32 m0, s49, 15872
 s_nop 0
 buffer_load_dwordx4 v10, s[8:11], s46 offen offset:512  lds
 s_add_u32 m0, s49, 19840
 s_nop 0
 buffer_load_dwordx4 v10, s[8:11], s46 offen offset:640  lds
 s_add_u32 m0, s49, 23808
 s_nop 0
 buffer_load_dwordx4 v10, s[8:11], s46 offen offset:768  lds
 s_add_u32 m0, s49, 27776
 s_nop 0
 buffer_load_dwordx4 v10, s[8:11], s46 offen offset:896  lds
 s_add_u32 m0, s49, 31744
 s_nop 0
 buffer_load_dwordx4 v10, s[8:11], s46 offen offset:1024  lds
 s_lshl_b32 s49, s4, 10
 s_add_u32 s49, s49, 36864
 s_mul_i32 s46, s40, 36864
 s_add_u32 m0, s49, 0
 s_nop 0
 buffer_load_dwordx4 v10, s[8:11], s46 offen offset:0  lds
 s_add_u32 m0, s49, 3968
 s_nop 0
 buffer_load_dwordx4 v10, s[8:11], s46 offen offset:128  lds
 s_add_u32 m0, s49, 7936
 s_nop 0
 buffer_load_dwordx4 v10, s[8:11], s46 offen offset:256  lds
 s_add_u32 m0, s49, 11904
 s_nop 0
 buffer_load_dwordx4 v10, s[8:11], s46 offen offset:384  lds
 s_add_u32 m0, s49, 15872
 s_nop 0
 buffer_load_dwordx4 v10, s[8:11], s46 offen offset:512  lds
 s_add_u32 m0, s49, 19840
 s_nop 0
 buffer_load_dwordx4 v10, s[8:11], s46 offen offset:640  lds
 s_add_u32 m0, s49, 23808
 s_nop 0
 buffer_load_dwordx4 v10, s[8:11], s46 offen offset:768  lds
 s_add_u32 m0, s49, 27776
 s_nop 0
 buffer_load_dwordx4 v10, s[8:11], s46 offen offset:896  lds
 s_add_u32 m0, s49, 31744
 s_nop 0
 buffer_load_dwordx4 v10, s[8:11], s46 offen offset:1024  lds
 s_lshl_b32 s49, s4, 10
 s_add_u32 m0, s49, 73728
 s_add_u32 s45, s32, 0
 buffer_load_dwordx4 v11, s[12:15], s45 offen  lds
 s_add_u32 m0, s49, 77824
 s_add_u32 s45, s32, 131072
 buffer_load_dwordx4 v11, s[12:15], s45 offen  lds
 s_add_u32 m0, s49, 81920
 s_add_u32 s45, s33, 0
 buffer_load_dwordx4 v11, s[16:19], s45 offen  lds
 s_add_u32 m0, s49, 86016
 s_add_u32 s45, s33, 131072
 buffer_load_dwordx4 v11, s[16:19], s45 offen  lds
 s_add_u32 m0, s49, 90112
 s_add_u32 s45, s32, 262144
 buffer_load_dwordx4 v11, s[12:15], s45 offen  lds
 s_add_u32 m0, s49, 94208
 s_add_u32 s45, s32, 393216
 buffer_load_dwordx4 v11, s[12:15], s45 offen  lds
 s_add_u32 m0, s49, 98304
 s_add_u32 s45, s33, 262144
 buffer_load_dwordx4 v11, s[16:19], s45 offen  lds
 s_add_u32 m0, s49, 102400
 s_add_u32 s45, s33, 393216
 buffer_load_dwordx4 v11, s[16:19], s45 offen  lds
 s_add_u32 m0, s49, 106496
 s_add_u32 s45, s32, 524288
 buffer_load_dwordx4 v11, s[12:15], s45 offen  lds
 s_add_u32 m0, s49, 110592
 s_add_u32 s45, s32, 655360
 buffer_load_dwordx4 v11, s[12:15], s45 offen  lds
 s_add_u32 m0, s49, 114688
 s_add_u32 s45, s33, 524288
 buffer_load_dwordx4 v11, s[16:19], s45 offen  lds
 s_add_u32 m0, s49, 118784
 s_add_u32 s45, s33, 655360
 buffer_load_dwordx4 v11, s[16:19], s45 offen  lds
 s_waitcnt vmcnt(8) lgkmcnt(0)
 s_barrier
 s_add_u32 m0, s49, 122880
 s_add_u32 s45, s32, 786432
 buffer_load_dwordx4 v11, s[12:15], s45 offen  lds
 s_add_u32 m0, s49, 126976
 s_add_u32 s45, s32, 917504
 buffer_load_dwordx4 v11, s[12:15], s45 offen  lds
 s_add_u32 m0, s49, 131072
 s_add_u32 s45, s33, 786432
 buffer_load_dwordx4 v11, s[16:19], s45 offen  lds
 s_add_u32 m0, s49, 135168
 s_add_u32 s45, s33, 917504
 buffer_load_dwordx4 v11, s[16:19], s45 offen  lds
 ds_read_b64_tr_b16 a[0:1], v8 offset:0
 ds_read_b64_tr_b16 a[2:3], v8 offset:1024
 ds_read_b64_tr_b16 a[72:73], v9 offset:0
 ds_read_b64_tr_b16 a[74:75], v9 offset:1024
 ds_read_b64_tr_b16 a[144:145], v8 offset:8192
 ds_read_b64_tr_b16 a[146:147], v8 offset:9216
 ds_read_b64_tr_b16 a[216:217], v9 offset:8192
 ds_read_b64_tr_b16 a[218:219], v9 offset:9216
 s_waitcnt vmcnt(8) lgkmcnt(0)
 s_barrier
 s_add_u32 m0, s49, 73728
 s_add_u32 s45, s32, 1048576
 buffer_load_dwordx4 v11, s[12:15], s45 offen  lds
 s_add_u32 m0, s49, 77824
 s_add_u32 s45, s32, 1179648
 buffer_load_dwordx4 v11, s[12:15], s45 offen  lds
 s_add_u32 m0, s49, 81920
 s_add_u32 s45, s33, 1048576
 buffer_load_dwordx4 v11, s[16:19], s45 offen  lds
 s_add_u32 m0, s49, 86016
 s_add_u32 s45, s33, 1179648
 buffer_load_dwordx4 v11, s[16:19], s45 offen  lds
 ds_read_b64_tr_b16 a[4:5], v8 offset:16384
 ds_read_b64_tr_b16 a[6:7], v8 offset:17408
 ds_read_b64_tr_b16 a[76:77], v9 offset:16384
 ds_read_b64_tr_b16 a[78:79], v9 offset:17408
 ds_read_b64_tr_b16 a[148:149], v8 offset:24576
 ds_read_b64_tr_b16 a[150:151], v8 offset:25600
 ds_read_b64_tr_b16 a[220:221], v9 offset:24576
 ds_read_b64_tr_b16 a[222:223], v9 offset:25600
 s_waitcnt vmcnt(8) lgkmcnt(0)
 s_barrier
 s_add_u32 m0, s49, 90112
 s_add_u32 s45, s32, 1310720
 buffer_load_dwordx4 v11, s[12:15], s45 offen  lds
 s_add_u32 m0, s49, 94208
 s_add_u32 s45, s32, 1441792
 buffer_load_dwordx4 v11, s[12:15], s45 offen  lds
 s_add_u32 m0, s49, 98304
 s_add_u32 s45, s33, 1310720
 buffer_load_dwordx4 v11, s[16:19], s45 offen  lds
 s_add_u32 m0, s49, 102400
 s_add_u32 s45, s33, 1441792
 buffer_load_dwordx4 v11, s[16:19], s45 offen  lds
 ds_read_b64_tr_b16 a[8:9], v8 offset:32768
 ds_read_b64_tr_b16 a[10:11], v8 offset:33792
 ds_read_b64_tr_b16 a[80:81], v9 offset:32768
 ds_read_b64_tr_b16 a[82:83], v9 offset:33792
 ds_read_b64_tr_b16 a[152:153], v8 offset:40960
 ds_read_b64_tr_b16 a[154:155], v8 offset:41984
 ds_read_b64_tr_b16 a[224:225], v9 offset:40960
 ds_read_b64_tr_b16 a[226:227], v9 offset:41984
 s_waitcnt vmcnt(8) lgkmcnt(0)
 s_barrier
 s_add_u32 m0, s49, 106496
 s_add_u32 s45, s32, 1572864
 buffer_load_dwordx4 v11, s[12:15], s45 offen  lds
 s_add_u32 m0, s49, 110592
 s_add_u32 s45, s32, 1703936
 buffer_load_dwordx4 v11, s[12:15], s45 offen  lds
 s_add_u32 m0, s49, 114688
 s_add_u32 s45, s33, 1572864
 buffer_load_dwordx4 v11, s[16:19], s45 offen  lds
 s_add_u32 m0, s49, 118784
 s_add_u32 s45, s33, 1703936
 buffer_load_dwordx4 v11, s[16:19], s45 offen  lds
 ds_read_b64_tr_b16 a[12:13], v8 offset:49152
 ds_read_b64_tr_b16 a[14:15], v8 offset:50176
 ds_read_b64_tr_b16 a[84:85], v9 offset:49152
 ds_read_b64_tr_b16 a[86:87], v9 offset:50176
 ds_read_b64_tr_b16 a[156:157], v8 offset:57344
 ds_read_b64_tr_b16 a[158:159], v8 offset:58368
 ds_read_b64_tr_b16 a[228:229], v9 offset:57344
 ds_read_b64_tr_b16 a[230:231], v9 offset:58368
 s_waitcnt vmcnt(8) lgkmcnt(0)
 s_barrier
 s_add_u32 m0, s49, 122880
 s_add_u32 s45, s32, 1835008
 buffer_load_dwordx4 v11, s[12:15], s45 offen  lds
 s_add_u32 m0, s49, 126976
 s_add_u32 s45, s32, 1966080
 buffer_load_dwordx4 v11, s[12:15], s45 offen  lds
 s_add_u32 m0, s49, 131072
 s_add_u32 s45, s33, 1835008
 buffer_load_dwordx4 v11, s[16:19], s45 offen  lds
 s_add_u32 m0, s49, 135168
 s_add_u32 s45, s33, 1966080
 buffer_load_dwordx4 v11, s[16:19], s45 offen  lds
 ds_read_b64_tr_b16 a[16:17], v8 offset:0
 ds_read_b64_tr_b16 a[18:19], v8 offset:1024
 ds_read_b64_tr_b16 a[88:89], v9 offset:0
 ds_read_b64_tr_b16 a[90:91], v9 offset:1024
 ds_read_b64_tr_b16 a[160:161], v8 offset:8192
 ds_read_b64_tr_b16 a[162:163], v8 offset:9216
 ds_read_b64_tr_b16 a[232:233], v9 offset:8192
 ds_read_b64_tr_b16 a[234:235], v9 offset:9216
 s_waitcnt vmcnt(8) lgkmcnt(0)
 s_barrier
 s_add_u32 m0, s49, 73728
 s_add_u32 s45, s32, 2097152
 buffer_load_dwordx4 v11, s[12:15], s45 offen  lds
 s_add_u32 m0, s49, 77824
 s_add_u32 s45, s32, 2228224
 buffer_load_dwordx4 v11, s[12:15], s45 offen  lds
 s_add_u32 m0, s49, 81920
 s_add_u32 s45, s33, 2097152
 buffer_load_dwordx4 v11, s[16:19], s45 offen  lds
 s_add_u32 m0, s49, 86016
 s_add_u32 s45, s33, 2228224
 buffer_load_dwordx4 v11, s[16:19], s45 offen  lds
 ds_read_b64_tr_b16 a[20:21], v8 offset:16384
 ds_read_b64_tr_b16 a[22:23], v8 offset:17408
 ds_read_b64_tr_b16 a[92:93], v9 offset:16384
 ds_read_b64_tr_b16 a[94:95], v9 offset:17408
 ds_read_b64_tr_b16 a[164:165], v8 offset:24576
 ds_read_b64_tr_b16 a[166:167], v8 offset:25600
 ds_read_b64_tr_b16 a[236:237], v9 offset:24576
 ds_read_b64_tr_b16 a[238:239], v9 offset:25600
 s_waitcnt vmcnt(8) lgkmcnt(0)
 s_barrier
 s_add_u32 m0, s49, 90112
 s_add_u32 s45, s32, 2359296
 buffer_load_dwordx4 v11, s[12:15], s45 offen  lds
 s_add_u32 m0, s49, 94208
 s_add_u32 s45, s32, 2490368
 buffer_load_dwordx4 v11, s[12:15], s45 offen  lds
 s_add_u32 m0, s49, 98304
 s_add_u32 s45, s33, 2359296
 buffer_load_dwordx4 v11, s[16:19], s45 offen  lds
 s_add_u32 m0, s49, 102400
 s_add_u32 s45, s33, 2490368
 buffer_load_dwordx4 v11, s[16:19], s45 offen  lds
 ds_read_b64_tr_b16 a[24:25], v8 offset:32768
 ds_read_b64_tr_b16 a[26:27], v8 offset:33792
 ds_read_b64_tr_b16 a[96:97], v9 offset:32768
 ds_read_b64_tr_b16 a[98:99], v9 offset:33792
 ds_read_b64_tr_b16 a[168:169], v8 offset:40960
 ds_read_b64_tr_b16 a[170:171], v8 offset:41984
 ds_read_b64_tr_b16 a[240:241], v9 offset:40960
 ds_read_b64_tr_b16 a[242:243], v9 offset:41984
 s_waitcnt vmcnt(8) lgkmcnt(0)
 s_barrier
 s_add_u32 m0, s49, 106496
 s_add_u32 s45, s32, 2621440
 buffer_load_dwordx4 v11, s[12:15], s45 offen  lds
 s_add_u32 m0, s49, 110592
 s_add_u32 s45, s32, 2752512
 buffer_load_dwordx4 v11, s[12:15], s45 offen  lds
 s_add_u32 m0, s49, 114688
 s_add_u32 s45, s33, 2621440
 buffer_load_dwordx4 v11, s[16:19], s45 offen  lds
 s_add_u32 m0, s49, 118784
 s_add_u32 s45, s33, 2752512
 buffer_load_dwordx4 v11, s[16:19], s45 offen  lds
 ds_read_b64_tr_b16 a[28:29], v8 offset:49152
 ds_read_b64_tr_b16 a[30:31], v8 offset:50176
 ds_read_b64_tr_b16 a[100:101], v9 offset:49152
 ds_read_b64_tr_b16 a[102:103], v9 offset:50176
 ds_read_b64_tr_b16 a[172:173], v8 offset:57344
 ds_read_b64_tr_b16 a[174:175], v8 offset:58368
 ds_read_b64_tr_b16 a[244:245], v9 offset:57344
 ds_read_b64_tr_b16 a[246:247], v9 offset:58368
 s_waitcnt vmcnt(8) lgkmcnt(0)
 s_barrier
 s_add_u32 m0, s49, 122880
 s_add_u32 s45, s32, 2883584
 buffer_load_dwordx4 v11, s[12:15], s45 offen  lds
 s_add_u32 m0, s49, 126976
 s_add_u32 s45, s32, 3014656
 buffer_load_dwordx4 v11, s[12:15], s45 offen  lds
 s_add_u32 m0, s49, 131072
 s_add_u32 s45, s33, 2883584
 buffer_load_dwordx4 v11, s[16:19], s45 offen  lds
 s_add_u32 m0, s49, 135168
 s_add_u32 s45, s33, 3014656
 buffer_load_dwordx4 v11, s[16:19], s45 offen  lds
 ds_read_b64_tr_b16 a[32:33], v8 offset:0
 ds_read_b64_tr_b16 a[34:35], v8 offset:1024
 ds_read_b64_tr_b16 a[104:105], v9 offset:0
 ds_read_b64_tr_b16 a[106:107], v9 offset:1024
 ds_read_b64_tr_b16 a[176:177], v8 offset:8192
 ds_read_b64_tr_b16 a[178:179], v8 offset:9216
 ds_read_b64_tr_b16 a[248:249], v9 offset:8192
 ds_read_b64_tr_b16 a[250:251], v9 offset:9216
 s_waitcnt vmcnt(8) lgkmcnt(0)
 s_barrier
 s_add_u32 m0, s49, 73728
 s_add_u32 s45, s32, 3145728
 buffer_load_dwordx4 v11, s[12:15], s45 offen  lds
 s_add_u32 m0, s49, 77824
 s_add_u32 s45, s32, 3276800
 buffer_load_dwordx4 v11, s[12:15], s45 offen  lds
 s_add_u32 m0, s49, 81920
 s_add_u32 s45, s33, 3145728
 buffer_load_dwordx4 v11, s[16:19], s45 offen  lds
 s_add_u32 m0, s49, 86016
 s_add_u32 s45, s33, 3276800
 buffer_load_dwordx4 v11, s[16:19], s45 offen  lds
 ds_read_b64_tr_b16 a[36:37], v8 offset:16384
 ds_read_b64_tr_b16 a[38:39], v8 offset:17408
 ds_read_b64_tr_b16 a[108:109], v9 offset:16384
 ds_read_b64_tr_b16 a[110:111], v9 offset:17408
 ds_read_b64_tr_b16 a[180:181], v8 offset:24576
 ds_read_b64_tr_b16 a[182:183], v8 offset:25600
 ds_read_b64_tr_b16 a[252:253], v9 offset:24576
 ds_read_b64_tr_b16 a[254:255], v9 offset:25600
 s_waitcnt vmcnt(8) lgkmcnt(0)
 s_barrier
 s_add_u32 m0, s49, 90112
 s_add_u32 s45, s32, 3407872
 buffer_load_dwordx4 v11, s[12:15], s45 offen  lds
 s_add_u32 m0, s49, 94208
 s_add_u32 s45, s32, 3538944
 buffer_load_dwordx4 v11, s[12:15], s45 offen  lds
 s_add_u32 m0, s49, 98304
 s_add_u32 s45, s33, 3407872
 buffer_load_dwordx4 v11, s[16:19], s45 offen  lds
 s_add_u32 m0, s49, 102400
 s_add_u32 s45, s33, 3538944
 buffer_load_dwordx4 v11, s[16:19], s45 offen  lds
 ds_read_b64_tr_b16 a[40:41], v8 offset:32768
 ds_read_b64_tr_b16 a[42:43], v8 offset:33792
 ds_read_b64_tr_b16 a[112:113], v9 offset:32768
 ds_read_b64_tr_b16 a[114:115], v9 offset:33792
 ds_read_b64_tr_b16 a[184:185], v8 offset:40960
 ds_read_b64_tr_b16 a[186:187], v8 offset:41984
 ds_read_b64_tr_b16 v[224:225], v9 offset:40960
 ds_read_b64_tr_b16 v[226:227], v9 offset:41984
 s_waitcnt vmcnt(8) lgkmcnt(0)
 s_barrier
 s_add_u32 m0, s49, 106496
 s_add_u32 s45, s32, 3670016
 buffer_load_dwordx4 v11, s[12:15], s45 offen  lds
 s_add_u32 m0, s49, 110592
 s_add_u32 s45, s32, 3801088
 buffer_load_dwordx4 v11, s[12:15], s45 offen  lds
 s_add_u32 m0, s49, 114688
 s_add_u32 s45, s33, 3670016
 buffer_load_dwordx4 v11, s[16:19], s45 offen  lds
 s_add_u32 m0, s49, 118784
 s_add_u32 s45, s33, 3801088
 buffer_load_dwordx4 v11, s[16:19], s45 offen  lds
 ds_read_b64_tr_b16 a[44:45], v8 offset:49152
 ds_read_b64_tr_b16 a[46:47], v8 offset:50176
 ds_read_b64_tr_b16 a[116:117], v9 offset:49152
 ds_read_b64_tr_b16 a[118:119], v9 offset:50176
 ds_read_b64_tr_b16 a[188:189], v8 offset:57344
 ds_read_b64_tr_b16 a[190:191], v8 offset:58368
 ds_read_b64_tr_b16 v[228:229], v9 offset:57344
 ds_read_b64_tr_b16 v[230:231], v9 offset:58368
 s_waitcnt vmcnt(8) lgkmcnt(0)
 s_barrier
 s_add_u32 m0, s49, 122880
 s_add_u32 s45, s32, 3932160
 buffer_load_dwordx4 v11, s[12:15], s45 offen  lds
 s_add_u32 m0, s49, 126976
 s_add_u32 s45, s32, 4063232
 buffer_load_dwordx4 v11, s[12:15], s45 offen  lds
 s_add_u32 m0, s49, 131072
 s_add_u32 s45, s33, 3932160
 buffer_load_dwordx4 v11, s[16:19], s45 offen  lds
 s_add_u32 m0, s49, 135168
 s_add_u32 s45, s33, 4063232
 buffer_load_dwordx4 v11, s[16:19], s45 offen  lds
 ds_read_b64_tr_b16 a[48:49], v8 offset:0
 ds_read_b64_tr_b16 a[50:51], v8 offset:1024
 ds_read_b64_tr_b16 a[120:121], v9 offset:0
 ds_read_b64_tr_b16 a[122:123], v9 offset:1024
 ds_read_b64_tr_b16 a[192:193], v8 offset:8192
 ds_read_b64_tr_b16 a[194:195], v8 offset:9216
 ds_read_b64_tr_b16 v[232:233], v9 offset:8192
 ds_read_b64_tr_b16 v[234:235], v9 offset:9216
 s_waitcnt vmcnt(8) lgkmcnt(0)
 s_barrier
 s_add_u32 m0, s49, 73728
 s_add_u32 s45, s32, 4194304
 buffer_load_dwordx4 v11, s[12:15], s45 offen  lds
 s_add_u32 m0, s49, 77824
 s_add_u32 s45, s32, 4325376
 buffer_load_dwordx4 v11, s[12:15], s45 offen  lds
 s_add_u32 m0, s49, 81920
 s_add_u32 s45, s33, 4194304
 buffer_load_dwordx4 v11, s[16:19], s45 offen  lds
 s_add_u32 m0, s49, 86016
 s_add_u32 s45, s33, 4325376
 buffer_load_dwordx4 v11, s[16:19], s45 offen  lds
 ds_read_b64_tr_b16 a[52:53], v8 offset:16384
 ds_read_b64_tr_b16 a[54:55], v8 offset:17408
 ds_read_b64_tr_b16 a[124:125], v9 offset:16384
 ds_read_b64_tr_b16 a[126:127], v9 offset:17408
 ds_read_b64_tr_b16 a[196:197], v8 offset:24576
 ds_read_b64_tr_b16 a[198:199], v8 offset:25600
 ds_read_b64_tr_b16 v[236:237], v9 offset:24576
 ds_read_b64_tr_b16 v[238:239], v9 offset:25600
 s_waitcnt vmcnt(8) lgkmcnt(0)
 s_barrier
 s_add_u32 m0, s49, 90112
 s_add_u32 s45, s32, 4456448
 buffer_load_dwordx4 v11, s[12:15], s45 offen  lds
 s_add_u32 m0, s49, 94208
 s_add_u32 s45, s32, 4587520
 buffer_load_dwordx4 v11, s[12:15], s45 offen  lds
 s_add_u32 m0, s49, 98304
 s_add_u32 s45, s33, 4456448
 buffer_load_dwordx4 v11, s[16:19], s45 offen  lds
 s_add_u32 m0, s49, 102400
 s_add_u32 s45, s33, 4587520
 buffer_load_dwordx4 v11, s[16:19], s45 offen  lds
 ds_read_b64_tr_b16 a[56:57], v8 offset:32768
 ds_read_b64_tr_b16 a[58:59], v8 offset:33792
 ds_read_b64_tr_b16 a[128:129], v9 offset:32768
 ds_read_b64_tr_b16 a[130:131], v9 offset:33792
 ds_read_b64_tr_b16 a[200:201], v8 offset:40960
 ds_read_b64_tr_b16 a[202:203], v8 offset:41984
 ds_read_b64_tr_b16 v[240:241], v9 offset:40960
 ds_read_b64_tr_b16 v[242:243], v9 offset:41984
 s_waitcnt vmcnt(8) lgkmcnt(0)
 s_barrier
 ds_read_b64_tr_b16 a[60:61], v8 offset:49152
 ds_read_b64_tr_b16 a[62:63], v8 offset:50176
 ds_read_b64_tr_b16 a[132:133], v9 offset:49152
 ds_read_b64_tr_b16 a[134:135], v9 offset:50176
 ds_read_b64_tr_b16 a[204:205], v8 offset:57344
 ds_read_b64_tr_b16 a[206:207], v8 offset:58368
 ds_read_b64_tr_b16 v[244:245], v9 offset:57344
 ds_read_b64_tr_b16 v[246:247], v9 offset:58368
 s_waitcnt vmcnt(4) lgkmcnt(0)
 s_barrier
 ds_read_b64_tr_b16 a[64:65], v8 offset:0
 ds_read_b64_tr_b16 a[66:67], v8 offset:1024
 ds_read_b64_tr_b16 a[136:137], v9 offset:0
 ds_read_b64_tr_b16 a[138:139], v9 offset:1024
 ds_read_b64_tr_b16 a[208:209], v8 offset:8192
 ds_read_b64_tr_b16 a[210:211], v8 offset:9216
 ds_read_b64_tr_b16 v[248:249], v9 offset:8192
 ds_read_b64_tr_b16 v[250:251], v9 offset:9216
 s_waitcnt vmcnt(0) lgkmcnt(0)
 s_barrier
 ds_read_b64_tr_b16 a[68:69], v8 offset:16384
 ds_read_b64_tr_b16 a[70:71], v8 offset:17408
 ds_read_b64_tr_b16 a[140:141], v9 offset:16384
 ds_read_b64_tr_b16 a[142:143], v9 offset:17408
 ds_read_b64_tr_b16 a[212:213], v8 offset:24576
 ds_read_b64_tr_b16 a[214:215], v8 offset:25600
 ds_read_b64_tr_b16 v[252:253], v9 offset:24576
 ds_read_b64_tr_b16 v[254:255], v9 offset:25600
 s_mov_b32 s50, 0x3e0293ee
 s_mov_b32 s42, 0
 s_mov_b32 s43, 0
 s_mov_b32 s44, 73728
 v_mov_b32 v6, v4
 v_mov_b32 v7, v5
 v_and_b32 v17, 63, v0
 v_lshlrev_b32 v1, 4, v17
 s_lshl_b32 s45, s4, 11
 s_add_u32 s45, s45, 147456
 v_add_u32 v2, s45, v1
 s_lshr_b32 s53, s4, 1
 s_and_b32 s54, s4, 1
 s_add_u32 s52, s52, s53
 s_lshl_b32 s53, s53, 13
 s_lshl_b32 s54, s54, 10
 s_add_u32 s45, s53, s54
 s_add_u32 s45, s45, 147456
 v_add_u32 v3, s45, v1
 s_lshl_b32 s63, s52, 13
 s_add_u32 s63, s63, s54
 s_add_u32 s63, s63, 0x7000000
 s_lshl_b32 s61, s52, 14
 s_add_u32 s61, s61, 0x3000000
 s_lshl_b32 s62, s52, 12
 s_add_u32 s62, s62, 0x400000
 s_lshl_b32 s57, s52, 7
 s_add_u32 s57, s57, 0x1000
 s_waitcnt lgkmcnt(0)
 v_min_u32 v8, 1, v0
 v_lshlrev_b32 v8, 28, v8
 s_mov_b32 s58, 0x40000
 v_mov_b32 v13, 0
 v_mov_b32 v14, 0
 v_min_u32 v15, 1, v17
 v_lshlrev_b32 v15, 28, v15
 v_bfe_u32 v18, v17, 3, 2
 v_and_b32 v19, 7, v17
 v_lshlrev_b32 v19, 7, v19
 v_lshl_add_u32 v18, v18, 11, v19
 v_lshrrev_b32 v19, 5, v17
 v_lshl_or_b32 v11, v19, 28, v18
 s_mov_b32 s56, s61
 v_mov_b32 v18, 0x44444444
 v_mov_b32 v19, 0xeeeeeeee
 v_and_b32 v20, 2, v17
 v_cmp_eq_u32 vcc, 0, v20
 s_nop 1
 v_cndmask_b32 v12, v19, v18, vcc
 v_mov_b32 v217, 0
 v_mov_b32 v218, 0
 v_mov_b32 v220, 0x3f803f80
 v_mov_b32 v221, 0x3f803f80
 v_mov_b32 v222, 0x3f803f80
 v_mov_b32 v223, 0x3f803f80
 v_and_b32 v18, 15, v17
 v_lshrrev_b32 v19, 4, v17
 v_lshlrev_b32 v19, 2, v19
 v_sub_u32 v18, v18, v19
 s_lshr_b32 s45, s54, 6
 v_add_u32 v18, s45, v18
 v_mov_b32 v19, 0xff800000
 v_cmp_le_i32 vcc, 0, v18
 s_nop 1
 v_cndmask_b32 v208, v19, v13, vcc
 v_cmp_le_i32 vcc, 1, v18
 s_nop 1
 v_cndmask_b32 v209, v19, v13, vcc
 v_cmp_le_i32 vcc, 2, v18
 s_nop 1
 v_cndmask_b32 v210, v19, v13, vcc
 v_cmp_le_i32 vcc, 3, v18
 s_nop 1
 v_cndmask_b32 v211, v19, v13, vcc
 v_cmp_le_i32 vcc, 16, v18
 s_nop 1
 v_cndmask_b32 v212, v19, v13, vcc
 v_cmp_le_i32 vcc, 17, v18
 s_nop 1
 v_cndmask_b32 v213, v19, v13, vcc
 v_cmp_le_i32 vcc, 18, v18
 s_nop 1
 v_cndmask_b32 v214, v19, v13, vcc
 v_cmp_le_i32 vcc, 19, v18
 s_nop 1
 v_cndmask_b32 v215, v19, v13, vcc
Lqs_38:
 buffer_load_dword v16, v15, s[20:23], s57 offen sc1
 s_waitcnt vmcnt(0)
 v_cmp_le_u32 vcc, 1, v16
 s_cbranch_vccnz Lqsk_39
 s_sleep 2
 s_sub_u32 s58, s58, 1
 s_cbranch_scc0 Lqs_38
 s_endpgm
Lqsk_39:
 s_waitcnt vmcnt(0) lgkmcnt(0)
 s_barrier
 ds_read_b128 v[32:35], v6 offset:0
 ds_read_b128 v[36:39], v6 offset:2048
 ds_read_b128 v[40:43], v7 offset:0
 ds_read_b128 v[44:47], v7 offset:2048
 s_waitcnt lgkmcnt(2)
Lqb_loop_40:
 v_mfma_f32_16x16x32_bf16 v[64:67], a[0:3], v[32:35], 0
 ds_read_b128 v[48:51], v6 offset:4096
 v_mfma_f32_16x16x32_bf16 v[72:75], a[72:75], v[32:35], 0
 ds_read_b128 v[52:55], v6 offset:6144
 v_mfma_f32_16x16x32_bf16 v[80:83], a[144:147], v[32:35], 0
 s_add_u32 s41, s40, 2
 v_mfma_f32_16x16x32_bf16 v[88:91], a[216:219], v[32:35], 0
 s_add_u32 s45, s42, 2
 s_mul_i32 s46, s41, 36864
 v_mfma_f32_16x16x32_bf16 v[68:71], a[0:3], v[36:39], 0
 s_cmp_lt_u32 s45, s36
 s_cselect_b32 s46, s46, 0
 v_mfma_f32_16x16x32_bf16 v[76:79], a[72:75], v[36:39], 0
 s_lshl_b32 s49, s4, 10
 s_add_u32 s49, s49, s44
 v_mfma_f32_16x16x32_bf16 v[84:87], a[144:147], v[36:39], 0
 s_lshl_b32 s53, s39, 19
 s_add_u32 s53, s53, s61
 v_mfma_f32_16x16x32_bf16 v[92:95], a[216:219], v[36:39], 0
 s_waitcnt lgkmcnt(2)
 v_mfma_f32_16x16x32_bf16 v[64:67], a[4:7], v[40:43], v[64:67]
 ds_read_b128 v[56:59], v7 offset:4096
 v_mfma_f32_16x16x32_bf16 v[72:75], a[76:79], v[40:43], v[72:75]
 ds_read_b128 v[60:63], v7 offset:6144
 v_mfma_f32_16x16x32_bf16 v[80:83], a[148:151], v[40:43], v[80:83]
 s_add_u32 m0, s49, 0
 v_mfma_f32_16x16x32_bf16 v[88:91], a[220:223], v[40:43], v[88:91]
 buffer_load_dwordx4 v10, s[8:11], s46 offen offset:0  lds
 v_mfma_f32_16x16x32_bf16 v[68:71], a[4:7], v[44:47], v[68:71]
 s_add_u32 m0, s49, 3968
 v_mfma_f32_16x16x32_bf16 v[76:79], a[76:79], v[44:47], v[76:79]
 buffer_load_dwordx4 v10, s[8:11], s46 offen offset:128  lds
 v_mfma_f32_16x16x32_bf16 v[84:87], a[148:151], v[44:47], v[84:87]
 s_lshl_b32 s55, s39, 17
 s_add_u32 s55, s55, s62
 v_mfma_f32_16x16x32_bf16 v[92:95], a[220:223], v[44:47], v[92:95]
 s_waitcnt lgkmcnt(2)
 v_mfma_f32_16x16x32_bf16 v[64:67], a[8:11], v[48:51], v[64:67]
 ds_read_b128 v[32:35], v6 offset:8192
 v_mfma_f32_16x16x32_bf16 v[72:75], a[80:83], v[48:51], v[72:75]
 ds_read_b128 v[36:39], v6 offset:10240
 v_mfma_f32_16x16x32_bf16 v[80:83], a[152:155], v[48:51], v[80:83]
 s_add_u32 m0, s49, 7936
 v_mfma_f32_16x16x32_bf16 v[88:91], a[224:227], v[48:51], v[88:91]
 buffer_load_dwordx4 v10, s[8:11], s46 offen offset:256  lds
 v_mfma_f32_16x16x32_bf16 v[68:71], a[8:11], v[52:55], v[68:71]
 s_add_u32 m0, s49, 11904
 v_mfma_f32_16x16x32_bf16 v[76:79], a[80:83], v[52:55], v[76:79]
 buffer_load_dwordx4 v10, s[8:11], s46 offen offset:384  lds
 v_mfma_f32_16x16x32_bf16 v[84:87], a[152:155], v[52:55], v[84:87]
 v_mfma_f32_16x16x32_bf16 v[92:95], a[224:227], v[52:55], v[92:95]
 s_waitcnt lgkmcnt(2)
 v_mfma_f32_16x16x32_bf16 v[64:67], a[12:15], v[56:59], v[64:67]
 ds_read_b128 v[40:43], v7 offset:8192
 v_mfma_f32_16x16x32_bf16 v[72:75], a[84:87], v[56:59], v[72:75]
 ds_read_b128 v[44:47], v7 offset:10240
 v_mfma_f32_16x16x32_bf16 v[80:83], a[156:159], v[56:59], v[80:83]
 s_add_u32 m0, s49, 15872
 v_mfma_f32_16x16x32_bf16 v[88:91], a[228:231], v[56:59], v[88:91]
 buffer_load_dwordx4 v10, s[8:11], s46 offen offset:512  lds
 v_mfma_f32_16x16x32_bf16 v[68:71], a[12:15], v[60:63], v[68:71]
 s_add_u32 m0, s49, 19840
 v_mfma_f32_16x16x32_bf16 v[76:79], a[84:87], v[60:63], v[76:79]
 buffer_load_dwordx4 v10, s[8:11], s46 offen offset:640  lds
 v_mfma_f32_16x16x32_bf16 v[84:87], a[156:159], v[60:63], v[84:87]
 s_add_u32 s60, s39, 1
 v_mfma_f32_16x16x32_bf16 v[92:95], a[228:231], v[60:63], v[92:95]
 s_waitcnt lgkmcnt(2)
 v_mfma_f32_16x16x32_bf16 v[64:67], a[16:19], v[32:35], v[64:67]
 ds_read_b128 v[48:51], v6 offset:12288
 v_mfma_f32_16x16x32_bf16 v[72:75], a[88:91], v[32:35], v[72:75]
 ds_read_b128 v[52:55], v6 offset:14336
 v_mfma_f32_16x16x32_bf16 v[80:83], a[160:163], v[32:35], v[80:83]
 s_add_u32 m0, s49, 23808
 v_mfma_f32_16x16x32_bf16 v[88:91], a[232:235], v[32:35], v[88:91]
 buffer_load_dwordx4 v10, s[8:11], s46 offen offset:768  lds
 v_mfma_f32_16x16x32_bf16 v[68:71], a[16:19], v[36:39], v[68:71]
 s_add_u32 m0, s49, 27776
 v_mfma_f32_16x16x32_bf16 v[76:79], a[88:91], v[36:39], v[76:79]
 buffer_load_dwordx4 v10, s[8:11], s46 offen offset:896  lds
 v_mfma_f32_16x16x32_bf16 v[84:87], a[160:163], v[36:39], v[84:87]
 v_mfma_f32_16x16x32_bf16 v[92:95], a[232:235], v[36:39], v[92:95]
 s_waitcnt lgkmcnt(2)
 v_mfma_f32_16x16x32_bf16 v[64:67], a[20:23], v[40:43], v[64:67]
 ds_read_b128 v[56:59], v7 offset:12288
 v_mfma_f32_16x16x32_bf16 v[72:75], a[92:95], v[40:43], v[72:75]
 ds_read_b128 v[60:63], v7 offset:14336
 v_mfma_f32_16x16x32_bf16 v[80:83], a[164:167], v[40:43], v[80:83]
 s_add_u32 m0, s49, 31744
 v_mfma_f32_16x16x32_bf16 v[88:91], a[236:239], v[40:43], v[88:91]
 buffer_load_dwordx4 v10, s[8:11], s46 offen offset:1024  lds
 v_mfma_f32_16x16x32_bf16 v[68:71], a[20:23], v[44:47], v[68:71]
 v_mfma_f32_16x16x32_bf16 v[76:79], a[92:95], v[44:47], v[76:79]
 v_mfma_f32_16x16x32_bf16 v[84:87], a[164:167], v[44:47], v[84:87]
 v_mfma_f32_16x16x32_bf16 v[92:95], a[236:239], v[44:47], v[92:95]
 s_waitcnt lgkmcnt(2)
 v_mfma_f32_16x16x32_bf16 v[64:67], a[24:27], v[48:51], v[64:67]
 ds_read_b128 v[32:35], v6 offset:16384
 v_mfma_f32_16x16x32_bf16 v[72:75], a[96:99], v[48:51], v[72:75]
 ds_read_b128 v[36:39], v6 offset:18432
 v_mfma_f32_16x16x32_bf16 v[80:83], a[168:171], v[48:51], v[80:83]
 s_waitcnt vmcnt(9)
 buffer_load_dword v17, v11, s[20:23], s56 offen sc1
 v_mfma_f32_16x16x32_bf16 v[88:91], a[240:243], v[48:51], v[88:91]
 s_barrier
 buffer_store_dword v14, v8, s[20:23], s59 offen sc1
 v_mfma_f32_16x16x32_bf16 v[68:71], a[24:27], v[52:55], v[68:71]
 buffer_load_dword v16, v15, s[20:23], s57 offen sc1
 v_mfma_f32_16x16x32_bf16 v[76:79], a[96:99], v[52:55], v[76:79]
 v_mfma_f32_16x16x32_bf16 v[84:87], a[168:171], v[52:55], v[84:87]
 s_lshl_b32 s56, s39, 18
 s_add_u32 s56, s56, s63
 v_mfma_f32_16x16x32_bf16 v[92:95], a[240:243], v[52:55], v[92:95]
 s_waitcnt lgkmcnt(2)
 v_mfma_f32_16x16x32_bf16 v[64:67], a[28:31], v[56:59], v[64:67]
 ds_read_b128 v[40:43], v7 offset:16384
 v_mfma_f32_16x16x32_bf16 v[72:75], a[100:103], v[56:59], v[72:75]
 ds_read_b128 v[44:47], v7 offset:18432
 v_mfma_f32_16x16x32_bf16 v[80:83], a[172:175], v[56:59], v[80:83]
 buffer_load_dwordx4 v[128:131], v1, s[20:23], s53 offen offset:0 sc1
 v_mfma_f32_16x16x32_bf16 v[88:91], a[244:247], v[56:59], v[88:91]
 v_mfma_f32_16x16x32_bf16 v[68:71], a[28:31], v[60:63], v[68:71]
 buffer_load_dwordx4 v[132:135], v1, s[20:23], s53 offen offset:1024 sc1
 v_mfma_f32_16x16x32_bf16 v[76:79], a[100:103], v[60:63], v[76:79]
 v_mfma_f32_16x16x32_bf16 v[84:87], a[172:175], v[60:63], v[84:87]
 v_mfma_f32_16x16x32_bf16 v[92:95], a[244:247], v[60:63], v[92:95]
 s_waitcnt lgkmcnt(2)
 v_mfma_f32_16x16x32_bf16 v[64:67], a[32:35], v[32:35], v[64:67]
 ds_read_b128 v[48:51], v6 offset:20480
 v_mfma_f32_16x16x32_bf16 v[72:75], a[104:107], v[32:35], v[72:75]
 ds_read_b128 v[52:55], v6 offset:22528
 v_mfma_f32_16x16x32_bf16 v[80:83], a[176:179], v[32:35], v[80:83]
 buffer_load_dwordx4 v[136:139], v1, s[20:23], s53 offen offset:2048 sc1
 v_mfma_f32_16x16x32_bf16 v[88:91], a[248:251], v[32:35], v[88:91]
 v_mfma_f32_16x16x32_bf16 v[68:71], a[32:35], v[36:39], v[68:71]
 buffer_load_dwordx4 v[140:143], v1, s[20:23], s53 offen offset:3072 sc1
 v_mfma_f32_16x16x32_bf16 v[76:79], a[104:107], v[36:39], v[76:79]
 v_mfma_f32_16x16x32_bf16 v[84:87], a[176:179], v[36:39], v[84:87]
 s_add_u32 s53, s53, 4096
 v_mfma_f32_16x16x32_bf16 v[92:95], a[248:251], v[36:39], v[92:95]
 s_waitcnt lgkmcnt(2)
 v_mfma_f32_16x16x32_bf16 v[64:67], a[36:39], v[40:43], v[64:67]
 ds_read_b128 v[56:59], v7 offset:20480
 v_mfma_f32_16x16x32_bf16 v[72:75], a[108:111], v[40:43], v[72:75]
 ds_read_b128 v[60:63], v7 offset:22528
 v_mfma_f32_16x16x32_bf16 v[80:83], a[180:183], v[40:43], v[80:83]
 buffer_load_dwordx4 v[144:147], v1, s[20:23], s53 offen offset:0 sc1
 v_mfma_f32_16x16x32_bf16 v[88:91], a[252:255], v[40:43], v[88:91]
 v_mfma_f32_16x16x32_bf16 v[68:71], a[36:39], v[44:47], v[68:71]
 buffer_load_dwordx4 v[148:151], v1, s[20:23], s53 offen offset:1024 sc1
 v_mfma_f32_16x16x32_bf16 v[76:79], a[108:111], v[44:47], v[76:79]
 v_mfma_f32_16x16x32_bf16 v[84:87], a[180:183], v[44:47], v[84:87]
 v_mfma_f32_16x16x32_bf16 v[92:95], a[252:255], v[44:47], v[92:95]
 s_waitcnt lgkmcnt(2)
 v_mfma_f32_16x16x32_bf16 v[64:67], a[40:43], v[48:51], v[64:67]
 ds_read_b128 v[32:35], v6 offset:24576
 v_mfma_f32_16x16x32_bf16 v[72:75], a[112:115], v[48:51], v[72:75]
 ds_read_b128 v[36:39], v6 offset:26624
 v_mfma_f32_16x16x32_bf16 v[80:83], a[184:187], v[48:51], v[80:83]
 buffer_load_dwordx4 v[152:155], v1, s[20:23], s53 offen offset:2048 sc1
 v_mfma_f32_16x16x32_bf16 v[88:91], v[224:227], v[48:51], v[88:91]
 v_mfma_f32_16x16x32_bf16 v[68:71], a[40:43], v[52:55], v[68:71]
 buffer_load_dwordx4 v[156:159], v1, s[20:23], s53 offen offset:3072 sc1
 v_mfma_f32_16x16x32_bf16 v[76:79], a[112:115], v[52:55], v[76:79]
 v_mfma_f32_16x16x32_bf16 v[84:87], a[184:187], v[52:55], v[84:87]
 s_add_u32 s53, s53, 4096
 v_mfma_f32_16x16x32_bf16 v[92:95], v[224:227], v[52:55], v[92:95]
 s_waitcnt lgkmcnt(2)
 v_mfma_f32_16x16x32_bf16 v[64:67], a[44:47], v[56:59], v[64:67]
 ds_read_b128 v[40:43], v7 offset:24576
 v_mfma_f32_16x16x32_bf16 v[72:75], a[116:119], v[56:59], v[72:75]
 ds_read_b128 v[44:47], v7 offset:26624
 v_mfma_f32_16x16x32_bf16 v[80:83], a[188:191], v[56:59], v[80:83]
 buffer_load_dwordx4 v[160:163], v1, s[20:23], s53 offen offset:0 sc1
 v_mfma_f32_16x16x32_bf16 v[88:91], v[228:231], v[56:59], v[88:91]
 v_mfma_f32_16x16x32_bf16 v[68:71], a[44:47], v[60:63], v[68:71]
 buffer_load_dwordx4 v[164:167], v1, s[20:23], s53 offen offset:1024 sc1
 v_mfma_f32_16x16x32_bf16 v[76:79], a[116:119], v[60:63], v[76:79]
 v_mfma_f32_16x16x32_bf16 v[84:87], a[188:191], v[60:63], v[84:87]
 v_mfma_f32_16x16x32_bf16 v[92:95], v[228:231], v[60:63], v[92:95]
 s_waitcnt lgkmcnt(2)
 v_mfma_f32_16x16x32_bf16 v[64:67], a[48:51], v[32:35], v[64:67]
 ds_read_b128 v[48:51], v6 offset:28672
 v_mfma_f32_16x16x32_bf16 v[72:75], a[120:123], v[32:35], v[72:75]
 ds_read_b128 v[52:55], v6 offset:30720
 v_mfma_f32_16x16x32_bf16 v[80:83], a[192:195], v[32:35], v[80:83]
 buffer_load_dwordx4 v[168:171], v1, s[20:23], s53 offen offset:2048 sc1
 v_mfma_f32_16x16x32_bf16 v[88:91], v[232:235], v[32:35], v[88:91]
 v_mfma_f32_16x16x32_bf16 v[68:71], a[48:51], v[36:39], v[68:71]
 buffer_load_dwordx4 v[172:175], v1, s[20:23], s53 offen offset:3072 sc1
 v_mfma_f32_16x16x32_bf16 v[76:79], a[120:123], v[36:39], v[76:79]
 v_mfma_f32_16x16x32_bf16 v[84:87], a[192:195], v[36:39], v[84:87]
 s_add_u32 s53, s53, 4096
 v_mfma_f32_16x16x32_bf16 v[92:95], v[232:235], v[36:39], v[92:95]
 s_waitcnt lgkmcnt(2)
 v_mfma_f32_16x16x32_bf16 v[64:67], a[52:55], v[40:43], v[64:67]
 ds_read_b128 v[56:59], v7 offset:28672
 v_mfma_f32_16x16x32_bf16 v[72:75], a[124:127], v[40:43], v[72:75]
 ds_read_b128 v[60:63], v7 offset:30720
 v_mfma_f32_16x16x32_bf16 v[80:83], a[196:199], v[40:43], v[80:83]
 s_add_u32 s43, s43, 36864
 s_cmp_eq_u32 s43, 147456
 buffer_load_dwordx4 v[176:179], v1, s[20:23], s53 offen offset:0 sc1
 v_mfma_f32_16x16x32_bf16 v[88:91], v[236:239], v[40:43], v[88:91]
 s_cselect_b32 s43, 0, s43
 s_add_u32 s44, s44, 36864
 v_mfma_f32_16x16x32_bf16 v[68:71], a[52:55], v[44:47], v[68:71]
 s_cmp_eq_u32 s44, 147456
 s_cselect_b32 s44, 0, s44
 buffer_load_dwordx4 v[180:183], v1, s[20:23], s53 offen offset:1024 sc1
 v_mfma_f32_16x16x32_bf16 v[76:79], a[124:127], v[44:47], v[76:79]
 v_mfma_f32_16x16x32_bf16 v[84:87], a[196:199], v[44:47], v[84:87]
 v_mfma_f32_16x16x32_bf16 v[92:95], v[236:239], v[44:47], v[92:95]
 s_waitcnt lgkmcnt(2)
 v_mfma_f32_16x16x32_bf16 v[64:67], a[56:59], v[48:51], v[64:67]
 ds_read_b128 v[32:35], v6 offset:32768
 v_mfma_f32_16x16x32_bf16 v[72:75], a[128:131], v[48:51], v[72:75]
 ds_read_b128 v[36:39], v6 offset:34816
 v_mfma_f32_16x16x32_bf16 v[80:83], a[200:203], v[48:51], v[80:83]
 v_add_u32 v6, s43, v4
 buffer_load_dwordx4 v[184:187], v1, s[20:23], s53 offen offset:2048 sc1
 v_mfma_f32_16x16x32_bf16 v[88:91], v[240:243], v[48:51], v[88:91]
 v_mfma_f32_16x16x32_bf16 v[68:71], a[56:59], v[52:55], v[68:71]
 buffer_load_dwordx4 v[188:191], v1, s[20:23], s53 offen offset:3072 sc1
 v_mfma_f32_16x16x32_bf16 v[76:79], a[128:131], v[52:55], v[76:79]
 v_mfma_f32_16x16x32_bf16 v[84:87], a[200:203], v[52:55], v[84:87]
 v_mfma_f32_16x16x32_bf16 v[92:95], v[240:243], v[52:55], v[92:95]
 s_waitcnt lgkmcnt(2)
 v_mfma_f32_16x16x32_bf16 v[64:67], a[60:63], v[56:59], v[64:67]
 ds_read_b128 v[40:43], v7 offset:32768
 v_mfma_f32_16x16x32_bf16 v[72:75], a[132:135], v[56:59], v[72:75]
 ds_read_b128 v[44:47], v7 offset:34816
 v_mfma_f32_16x16x32_bf16 v[80:83], a[204:207], v[56:59], v[80:83]
 v_add_u32 v7, s43, v5
 v_mfma_f32_16x16x32_bf16 v[88:91], v[244:247], v[56:59], v[88:91]
 v_mfma_f32_16x16x32_bf16 v[68:71], a[60:63], v[60:63], v[68:71]
 v_mfma_f32_16x16x32_bf16 v[76:79], a[132:135], v[60:63], v[76:79]
 v_mfma_f32_16x16x32_bf16 v[84:87], a[204:207], v[60:63], v[84:87]
 v_mfma_f32_16x16x32_bf16 v[92:95], v[244:247], v[60:63], v[92:95]
 s_waitcnt lgkmcnt(2)
 v_mfma_f32_16x16x32_bf16 v[64:67], a[64:67], v[32:35], v[64:67]
 s_waitcnt vmcnt(28)
 s_barrier
 ds_read_b128 v[48:51], v6 offset:0
 v_mfma_f32_16x16x32_bf16 v[72:75], a[136:139], v[32:35], v[72:75]
 ds_read_b128 v[52:55], v6 offset:2048
 v_mfma_f32_16x16x32_bf16 v[80:83], a[208:211], v[32:35], v[80:83]
 v_mfma_f32_16x16x32_bf16 v[88:91], v[248:251], v[32:35], v[88:91]
 s_waitcnt vmcnt(16)
 v_cmp_le_u32 vcc, s60, v16
 v_mfma_f32_16x16x32_bf16 v[68:71], a[64:67], v[36:39], v[68:71]
 v_mfma_f32_16x16x32_bf16 v[76:79], a[136:139], v[36:39], v[76:79]
 s_and_b32 s64, vcc_lo, 1
 s_cbranch_scc0 Lqsk_41
 buffer_load_dwordx4 v[192:195], v1, s[20:23], s55 offen offset:0 sc1
 buffer_load_dwordx4 v[196:199], v1, s[20:23], s55 offen offset:1024 sc1
 buffer_load_dwordx4 v[200:203], v1, s[20:23], s55 offen offset:2048 sc1
 buffer_load_dwordx4 v[204:207], v1, s[20:23], s55 offen offset:3072 sc1
Lqsk_41:
 v_mfma_f32_16x16x32_bf16 v[84:87], a[208:211], v[36:39], v[84:87]
 v_mfma_f32_16x16x32_bf16 v[92:95], v[248:251], v[36:39], v[92:95]
 s_waitcnt lgkmcnt(2)
 v_mfma_f32_16x16x32_bf16 v[64:67], a[68:71], v[40:43], v[64:67]
 ds_read_b128 v[56:59], v7 offset:0
 v_mfma_f32_16x16x32_bf16 v[72:75], a[140:143], v[40:43], v[72:75]
 ds_read_b128 v[60:63], v7 offset:2048
 v_mfma_f32_16x16x32_bf16 v[80:83], a[212:215], v[40:43], v[80:83]
 v_mfma_f32_16x16x32_bf16 v[88:91], v[252:255], v[40:43], v[88:91]
 s_mov_b32 s39, s40
 s_mov_b32 s40, s41
 v_mfma_f32_16x16x32_bf16 v[68:71], a[68:71], v[44:47], v[68:71]
 s_add_u32 s42, s42, 1
 v_mov_b32 v14, s42
 v_mfma_f32_16x16x32_bf16 v[76:79], a[140:143], v[44:47], v[76:79]
 v_mfma_f32_16x16x32_bf16 v[84:87], a[212:215], v[44:47], v[84:87]
 v_mfma_f32_16x16x32_bf16 v[92:95], v[252:255], v[44:47], v[92:95]
 s_waitcnt lgkmcnt(2)
 s_nop 7
 v_cvt_pk_bf16_f32 v16, v64, v72
 v_cvt_pk_bf16_f32 v17, v65, v73
 v_cvt_pk_bf16_f32 v18, v66, v74
 v_cvt_pk_bf16_f32 v19, v67, v75
 ds_write_b128 v2, v[16:19] offset:0
 v_cvt_pk_bf16_f32 v20, v68, v76
 v_cvt_pk_bf16_f32 v21, v69, v77
 v_cvt_pk_bf16_f32 v22, v70, v78
 v_cvt_pk_bf16_f32 v23, v71, v79
 ds_write_b128 v2, v[20:23] offset:1024
 v_cvt_pk_bf16_f32 v24, v80, v88
 v_cvt_pk_bf16_f32 v25, v81, v89
 v_cvt_pk_bf16_f32 v26, v82, v90
 v_cvt_pk_bf16_f32 v27, v83, v91
 ds_write_b128 v2, v[24:27] offset:8192
 v_cvt_pk_bf16_f32 v28, v84, v92
 v_cvt_pk_bf16_f32 v29, v85, v93
 v_cvt_pk_bf16_f32 v30, v86, v94
 v_cvt_pk_bf16_f32 v31, v87, v95
 ds_write_b128 v2, v[28:31] offset:9216
 v_mov_b64 v[120:121], 0
 v_mov_b64 v[122:123], 0
 s_waitcnt lgkmcnt(0)
 s_barrier
 ds_read_b128 v[96:99], v3 offset:0
 ds_read_b128 v[100:103], v3 offset:2048
 ds_read_b128 v[104:107], v3 offset:4096
 ds_read_b128 v[108:111], v3 offset:6144
 s_cmp_lg_u32 s64, 0
 s_cbranch_scc1 Lqpre_42
Lqs_43:
 buffer_load_dword v16, v15, s[20:23], s57 offen sc1
 s_waitcnt vmcnt(0)
 v_cmp_le_u32 vcc, s60, v16
 s_cbranch_vccnz Lqsk_44
 s_sleep 2
 s_sub_u32 s58, s58, 1
 s_cbranch_scc0 Lqs_43
 s_endpgm
Lqsk_44:
 buffer_load_dwordx4 v[192:195], v1, s[20:23], s55 offen offset:0 sc1
 buffer_load_dwordx4 v[196:199], v1, s[20:23], s55 offen offset:1024 sc1
 buffer_load_dwordx4 v[200:203], v1, s[20:23], s55 offen offset:2048 sc1
 buffer_load_dwordx4 v[204:207], v1, s[20:23], s55 offen offset:3072 sc1
Lqpre_42:
 s_waitcnt vmcnt(4) lgkmcnt(0)
 v_mfma_f32_16x16x32_bf16 v[112:115], v[128:131], v[96:99], v[208:211]
 v_mfma_f32_16x16x32_bf16 v[116:119], v[132:135], v[96:99], v[212:215]
 v_mfma_f32_16x16x32_bf16 v[112:115], v[136:139], v[100:103], v[112:115]
 v_mfma_f32_16x16x32_bf16 v[116:119], v[140:143], v[100:103], v[116:119]
 v_mfma_f32_16x16x32_bf16 v[112:115], v[144:147], v[104:107], v[112:115]
 v_mfma_f32_16x16x32_bf16 v[116:119], v[148:151], v[104:107], v[116:119]
 v_mfma_f32_16x16x32_bf16 v[112:115], v[152:155], v[108:111], v[112:115]
 v_mfma_f32_16x16x32_bf16 v[116:119], v[156:159], v[108:111], v[116:119]
 s_nop 7
 v_max3_f32 v24, v112, v113, v114
 v_max3_f32 v24, v24, v115, v116
 v_max3_f32 v24, v24, v117, v118
 v_max_f32 v24, v24, v119
 s_waitcnt vmcnt(2)
 v_mov_b64 v[16:17], v[192:193]
 v_mov_b64 v[18:19], v[196:197]
 s_nop 1
 v_smfmac_f32_16x16x64_bf16 v[120:123], v[16:19], v[96:103], v12
 s_waitcnt vmcnt(0)
 v_mov_b64 v[20:21], v[200:201]
 v_mov_b64 v[22:23], v[204:205]
 s_nop 1
 v_smfmac_f32_16x16x64_bf16 v[120:123], v[20:23], v[104:111], v12
 s_nop 7
 v_add_f32 v120, v120, v122
 v_add_f32 v121, v121, v123
 v_mul_f32 v120, s50, v120
 v_mul_f32 v121, s50, v121
 v_max3_f32 v24, v24, v120, v121
 v_mov_b32 v25, v24
 s_nop 1
 v_permlane16_swap_b32 v24, v25
 v_max_f32 v24, v24, v25
 v_mov_b32 v25, v24
 s_nop 1
 v_permlane32_swap_b32 v24, v25
 v_max_f32 v24, v24, v25
 v_sub_f32 v112, v112, v24
 v_sub_f32 v113, v113, v24
 v_sub_f32 v114, v114, v24
 v_sub_f32 v115, v115, v24
 v_sub_f32 v116, v116, v24
 v_sub_f32 v117, v117, v24
 v_sub_f32 v118, v118, v24
 v_sub_f32 v119, v119, v24
 v_sub_f32 v120, v120, v24
 v_sub_f32 v121, v121, v24
 v_exp_f32 v120, v120
 v_exp_f32 v121, v121
 v_exp_f32 v112, v112
 v_exp_f32 v113, v113
 v_exp_f32 v114, v114
 v_exp_f32 v115, v115
 v_exp_f32 v116, v116
 v_exp_f32 v117, v117
 v_exp_f32 v118, v118
 v_exp_f32 v119, v119
 v_cvt_pk_bf16_f32 v216, v120, v121
 v_cvt_pk_bf16_f32 v219, v120, v121
 v_cvt_pk_bf16_f32 v28, v112, v113
 v_cvt_pk_bf16_f32 v29, v116, v117
 v_cvt_pk_bf16_f32 v30, v114, v115
 v_cvt_pk_bf16_f32 v31, v118, v119
 v_mfma_f32_16x16x16_bf16 v[124:127], v[220:221], v[216:217], 0
 v_mfma_f32_16x16x16_bf16 v[64:67], v[194:195], v[216:217], 0
 v_mfma_f32_16x16x16_bf16 v[68:71], v[194:195], v[218:219], 0
 v_mfma_f32_16x16x16_bf16 v[72:75], v[198:199], v[216:217], 0
 v_mfma_f32_16x16x16_bf16 v[76:79], v[198:199], v[218:219], 0
 v_mfma_f32_16x16x16_bf16 v[80:83], v[202:203], v[216:217], 0
 v_mfma_f32_16x16x16_bf16 v[84:87], v[202:203], v[218:219], 0
 v_mfma_f32_16x16x16_bf16 v[88:91], v[206:207], v[216:217], 0
 v_mfma_f32_16x16x16_bf16 v[92:95], v[206:207], v[218:219], 0
 v_mfma_f32_16x16x32_bf16 v[124:127], v[220:223], v[28:31], v[124:127]
 v_mfma_f32_16x16x32_bf16 v[64:67], v[160:163], v[28:31], v[64:67]
 v_mfma_f32_16x16x32_bf16 v[68:71], v[164:167], v[28:31], v[68:71]
 v_mfma_f32_16x16x32_bf16 v[72:75], v[168:171], v[28:31], v[72:75]
 v_mfma_f32_16x16x32_bf16 v[76:79], v[172:175], v[28:31], v[76:79]
 v_mfma_f32_16x16x32_bf16 v[80:83], v[176:179], v[28:31], v[80:83]
 v_mfma_f32_16x16x32_bf16 v[84:87], v[180:183], v[28:31], v[84:87]
 v_mfma_f32_16x16x32_bf16 v[88:91], v[184:187], v[28:31], v[88:91]
 v_mfma_f32_16x16x32_bf16 v[92:95], v[188:191], v[28:31], v[92:95]
 v_rcp_f32 v124, v124
 s_add_u32 s45, s56, 4096
 v_mul_f32 v64, v64, v124
 v_mul_f32 v65, v65, v124
 v_mul_f32 v66, v66, v124
 v_mul_f32 v67, v67, v124
 v_mul_f32 v68, v68, v124
 v_mul_f32 v69, v69, v124
 v_mul_f32 v70, v70, v124
 v_mul_f32 v71, v71, v124
 v_cvt_pk_bf16_f32 v96, v64, v65
 v_cvt_pk_bf16_f32 v97, v68, v69
 v_cvt_pk_bf16_f32 v98, v66, v67
 v_cvt_pk_bf16_f32 v99, v70, v71
 buffer_store_dwordx4 v[96:99], v1, s[20:23], s56 offen offset:0 sc1
 v_mul_f32 v72, v72, v124
 v_mul_f32 v73, v73, v124
 v_mul_f32 v74, v74, v124
 v_mul_f32 v75, v75, v124
 v_mul_f32 v76, v76, v124
 v_mul_f32 v77, v77, v124
 v_mul_f32 v78, v78, v124
 v_mul_f32 v79, v79, v124
 v_cvt_pk_bf16_f32 v100, v72, v73
 v_cvt_pk_bf16_f32 v101, v76, v77
 v_cvt_pk_bf16_f32 v102, v74, v75
 v_cvt_pk_bf16_f32 v103, v78, v79
 buffer_store_dwordx4 v[100:103], v1, s[20:23], s56 offen offset:2048 sc1
 v_mul_f32 v80, v80, v124
 v_mul_f32 v81, v81, v124
 v_mul_f32 v82, v82, v124
 v_mul_f32 v83, v83, v124
 v_mul_f32 v84, v84, v124
 v_mul_f32 v85, v85, v124
 v_mul_f32 v86, v86, v124
 v_mul_f32 v87, v87, v124
 v_cvt_pk_bf16_f32 v104, v80, v81
 v_cvt_pk_bf16_f32 v105, v84, v85
 v_cvt_pk_bf16_f32 v106, v82, v83
 v_cvt_pk_bf16_f32 v107, v86, v87
 buffer_store_dwordx4 v[104:107], v1, s[20:23], s45 offen offset:0 sc1
 v_mul_f32 v88, v88, v124
 v_mul_f32 v89, v89, v124
 v_mul_f32 v90, v90, v124
 v_mul_f32 v91, v91, v124
 v_mul_f32 v92, v92, v124
 v_mul_f32 v93, v93, v124
 v_mul_f32 v94, v94, v124
 v_mul_f32 v95, v95, v124
 v_cvt_pk_bf16_f32 v108, v88, v89
 v_cvt_pk_bf16_f32 v109, v92, v93
 v_cvt_pk_bf16_f32 v110, v90, v91
 v_cvt_pk_bf16_f32 v111, v94, v95
 buffer_store_dwordx4 v[108:111], v1, s[20:23], s45 offen offset:2048 sc1
 v_mfma_f32_16x16x32_bf16 v[64:67], a[0:3], v[48:51], 0
 ds_read_b128 v[32:35], v6 offset:4096
 v_mfma_f32_16x16x32_bf16 v[72:75], a[72:75], v[48:51], 0
 ds_read_b128 v[36:39], v6 offset:6144
 v_mfma_f32_16x16x32_bf16 v[80:83], a[144:147], v[48:51], 0
 s_add_u32 s41, s40, 2
 v_mfma_f32_16x16x32_bf16 v[88:91], a[216:219], v[48:51], 0
 s_add_u32 s45, s42, 2
 s_mul_i32 s46, s41, 36864
 v_mfma_f32_16x16x32_bf16 v[68:71], a[0:3], v[52:55], 0
 s_cmp_lt_u32 s45, s36
 s_cselect_b32 s46, s46, 0
 v_mfma_f32_16x16x32_bf16 v[76:79], a[72:75], v[52:55], 0
 s_lshl_b32 s49, s4, 10
 s_add_u32 s49, s49, s44
 v_mfma_f32_16x16x32_bf16 v[84:87], a[144:147], v[52:55], 0
 s_lshl_b32 s53, s39, 19
 s_add_u32 s53, s53, s61
 v_mfma_f32_16x16x32_bf16 v[92:95], a[216:219], v[52:55], 0
 s_waitcnt lgkmcnt(2)
 v_mfma_f32_16x16x32_bf16 v[64:67], a[4:7], v[56:59], v[64:67]
 ds_read_b128 v[40:43], v7 offset:4096
 v_mfma_f32_16x16x32_bf16 v[72:75], a[76:79], v[56:59], v[72:75]
 ds_read_b128 v[44:47], v7 offset:6144
 v_mfma_f32_16x16x32_bf16 v[80:83], a[148:151], v[56:59], v[80:83]
 s_add_u32 m0, s49, 0
 v_mfma_f32_16x16x32_bf16 v[88:91], a[220:223], v[56:59], v[88:91]
 buffer_load_dwordx4 v10, s[8:11], s46 offen offset:0  lds
 v_mfma_f32_16x16x32_bf16 v[68:71], a[4:7], v[60:63], v[68:71]
 s_add_u32 m0, s49, 3968
 v_mfma_f32_16x16x32_bf16 v[76:79], a[76:79], v[60:63], v[76:79]
 buffer_load_dwordx4 v10, s[8:11], s46 offen offset:128  lds
 v_mfma_f32_16x16x32_bf16 v[84:87], a[148:151], v[60:63], v[84:87]
 s_lshl_b32 s55, s39, 17
 s_add_u32 s55, s55, s62
 v_mfma_f32_16x16x32_bf16 v[92:95], a[220:223], v[60:63], v[92:95]
 s_waitcnt lgkmcnt(2)
 v_mfma_f32_16x16x32_bf16 v[64:67], a[8:11], v[32:35], v[64:67]
 ds_read_b128 v[48:51], v6 offset:8192
 v_mfma_f32_16x16x32_bf16 v[72:75], a[80:83], v[32:35], v[72:75]
 ds_read_b128 v[52:55], v6 offset:10240
 v_mfma_f32_16x16x32_bf16 v[80:83], a[152:155], v[32:35], v[80:83]
 s_add_u32 m0, s49, 7936
 v_mfma_f32_16x16x32_bf16 v[88:91], a[224:227], v[32:35], v[88:91]
 buffer_load_dwordx4 v10, s[8:11], s46 offen offset:256  lds
 v_mfma_f32_16x16x32_bf16 v[68:71], a[8:11], v[36:39], v[68:71]
 s_add_u32 m0, s49, 11904
 v_mfma_f32_16x16x32_bf16 v[76:79], a[80:83], v[36:39], v[76:79]
 buffer_load_dwordx4 v10, s[8:11], s46 offen offset:384  lds
 v_mfma_f32_16x16x32_bf16 v[84:87], a[152:155], v[36:39], v[84:87]
 v_mfma_f32_16x16x32_bf16 v[92:95], a[224:227], v[36:39], v[92:95]
 s_waitcnt lgkmcnt(2)
 v_mfma_f32_16x16x32_bf16 v[64:67], a[12:15], v[40:43], v[64:67]
 ds_read_b128 v[56:59], v7 offset:8192
 v_mfma_f32_16x16x32_bf16 v[72:75], a[84:87], v[40:43], v[72:75]
 ds_read_b128 v[60:63], v7 offset:10240
 v_mfma_f32_16x16x32_bf16 v[80:83], a[156:159], v[40:43], v[80:83]
 s_add_u32 m0, s49, 15872
 v_mfma_f32_16x16x32_bf16 v[88:91], a[228:231], v[40:43], v[88:91]
 buffer_load_dwordx4 v10, s[8:11], s46 offen offset:512  lds
 v_mfma_f32_16x16x32_bf16 v[68:71], a[12:15], v[44:47], v[68:71]
 s_add_u32 m0, s49, 19840
 v_mfma_f32_16x16x32_bf16 v[76:79], a[84:87], v[44:47], v[76:79]
 buffer_load_dwordx4 v10, s[8:11], s46 offen offset:640  lds
 v_mfma_f32_16x16x32_bf16 v[84:87], a[156:159], v[44:47], v[84:87]
 s_add_u32 s60, s39, 1
 v_mfma_f32_16x16x32_bf16 v[92:95], a[228:231], v[44:47], v[92:95]
 s_waitcnt lgkmcnt(2)
 v_mfma_f32_16x16x32_bf16 v[64:67], a[16:19], v[48:51], v[64:67]
 ds_read_b128 v[32:35], v6 offset:12288
 v_mfma_f32_16x16x32_bf16 v[72:75], a[88:91], v[48:51], v[72:75]
 ds_read_b128 v[36:39], v6 offset:14336
 v_mfma_f32_16x16x32_bf16 v[80:83], a[160:163], v[48:51], v[80:83]
 s_add_u32 m0, s49, 23808
 v_mfma_f32_16x16x32_bf16 v[88:91], a[232:235], v[48:51], v[88:91]
 buffer_load_dwordx4 v10, s[8:11], s46 offen offset:768  lds
 v_mfma_f32_16x16x32_bf16 v[68:71], a[16:19], v[52:55], v[68:71]
 s_add_u32 m0, s49, 27776
 v_mfma_f32_16x16x32_bf16 v[76:79], a[88:91], v[52:55], v[76:79]
 buffer_load_dwordx4 v10, s[8:11], s46 offen offset:896  lds
 v_mfma_f32_16x16x32_bf16 v[84:87], a[160:163], v[52:55], v[84:87]
 v_mfma_f32_16x16x32_bf16 v[92:95], a[232:235], v[52:55], v[92:95]
 s_waitcnt lgkmcnt(2)
 v_mfma_f32_16x16x32_bf16 v[64:67], a[20:23], v[56:59], v[64:67]
 ds_read_b128 v[40:43], v7 offset:12288
 v_mfma_f32_16x16x32_bf16 v[72:75], a[92:95], v[56:59], v[72:75]
 ds_read_b128 v[44:47], v7 offset:14336
 v_mfma_f32_16x16x32_bf16 v[80:83], a[164:167], v[56:59], v[80:83]
 s_add_u32 m0, s49, 31744
 v_mfma_f32_16x16x32_bf16 v[88:91], a[236:239], v[56:59], v[88:91]
 buffer_load_dwordx4 v10, s[8:11], s46 offen offset:1024  lds
 v_mfma_f32_16x16x32_bf16 v[68:71], a[20:23], v[60:63], v[68:71]
 v_mfma_f32_16x16x32_bf16 v[76:79], a[92:95], v[60:63], v[76:79]
 v_mfma_f32_16x16x32_bf16 v[84:87], a[164:167], v[60:63], v[84:87]
 v_mfma_f32_16x16x32_bf16 v[92:95], a[236:239], v[60:63], v[92:95]
 s_waitcnt lgkmcnt(2)
 v_mfma_f32_16x16x32_bf16 v[64:67], a[24:27], v[32:35], v[64:67]
 ds_read_b128 v[48:51], v6 offset:16384
 v_mfma_f32_16x16x32_bf16 v[72:75], a[96:99], v[32:35], v[72:75]
 ds_read_b128 v[52:55], v6 offset:18432
 v_mfma_f32_16x16x32_bf16 v[80:83], a[168:171], v[32:35], v[80:83]
 s_waitcnt vmcnt(9)
 buffer_load_dword v17, v11, s[20:23], s56 offen sc1
 v_mfma_f32_16x16x32_bf16 v[88:91], a[240:243], v[32:35], v[88:91]
 s_barrier
 buffer_store_dword v14, v8, s[20:23], s59 offen sc1
 v_mfma_f32_16x16x32_bf16 v[68:71], a[24:27], v[36:39], v[68:71]
 buffer_load_dword v16, v15, s[20:23], s57 offen sc1
 v_mfma_f32_16x16x32_bf16 v[76:79], a[96:99], v[36:39], v[76:79]
 v_mfma_f32_16x16x32_bf16 v[84:87], a[168:171], v[36:39], v[84:87]
 s_lshl_b32 s56, s39, 18
 s_add_u32 s56, s56, s63
 v_mfma_f32_16x16x32_bf16 v[92:95], a[240:243], v[36:39], v[92:95]
 s_waitcnt lgkmcnt(2)
 v_mfma_f32_16x16x32_bf16 v[64:67], a[28:31], v[40:43], v[64:67]
 ds_read_b128 v[56:59], v7 offset:16384
 v_mfma_f32_16x16x32_bf16 v[72:75], a[100:103], v[40:43], v[72:75]
 ds_read_b128 v[60:63], v7 offset:18432
 v_mfma_f32_16x16x32_bf16 v[80:83], a[172:175], v[40:43], v[80:83]
 buffer_load_dwordx4 v[128:131], v1, s[20:23], s53 offen offset:0 sc1
 v_mfma_f32_16x16x32_bf16 v[88:91], a[244:247], v[40:43], v[88:91]
 v_mfma_f32_16x16x32_bf16 v[68:71], a[28:31], v[44:47], v[68:71]
 buffer_load_dwordx4 v[132:135], v1, s[20:23], s53 offen offset:1024 sc1
 v_mfma_f32_16x16x32_bf16 v[76:79], a[100:103], v[44:47], v[76:79]
 v_mfma_f32_16x16x32_bf16 v[84:87], a[172:175], v[44:47], v[84:87]
 v_mfma_f32_16x16x32_bf16 v[92:95], a[244:247], v[44:47], v[92:95]
 s_waitcnt lgkmcnt(2)
 v_mfma_f32_16x16x32_bf16 v[64:67], a[32:35], v[48:51], v[64:67]
 ds_read_b128 v[32:35], v6 offset:20480
 v_mfma_f32_16x16x32_bf16 v[72:75], a[104:107], v[48:51], v[72:75]
 ds_read_b128 v[36:39], v6 offset:22528
 v_mfma_f32_16x16x32_bf16 v[80:83], a[176:179], v[48:51], v[80:83]
 buffer_load_dwordx4 v[136:139], v1, s[20:23], s53 offen offset:2048 sc1
 v_mfma_f32_16x16x32_bf16 v[88:91], a[248:251], v[48:51], v[88:91]
 v_mfma_f32_16x16x32_bf16 v[68:71], a[32:35], v[52:55], v[68:71]
 buffer_load_dwordx4 v[140:143], v1, s[20:23], s53 offen offset:3072 sc1
 v_mfma_f32_16x16x32_bf16 v[76:79], a[104:107], v[52:55], v[76:79]
 v_mfma_f32_16x16x32_bf16 v[84:87], a[176:179], v[52:55], v[84:87]
 s_add_u32 s53, s53, 4096
 v_mfma_f32_16x16x32_bf16 v[92:95], a[248:251], v[52:55], v[92:95]
 s_waitcnt lgkmcnt(2)
 v_mfma_f32_16x16x32_bf16 v[64:67], a[36:39], v[56:59], v[64:67]
 ds_read_b128 v[40:43], v7 offset:20480
 v_mfma_f32_16x16x32_bf16 v[72:75], a[108:111], v[56:59], v[72:75]
 ds_read_b128 v[44:47], v7 offset:22528
 v_mfma_f32_16x16x32_bf16 v[80:83], a[180:183], v[56:59], v[80:83]
 buffer_load_dwordx4 v[144:147], v1, s[20:23], s53 offen offset:0 sc1
 v_mfma_f32_16x16x32_bf16 v[88:91], a[252:255], v[56:59], v[88:91]
 v_mfma_f32_16x16x32_bf16 v[68:71], a[36:39], v[60:63], v[68:71]
 buffer_load_dwordx4 v[148:151], v1, s[20:23], s53 offen offset:1024 sc1
 v_mfma_f32_16x16x32_bf16 v[76:79], a[108:111], v[60:63], v[76:79]
 v_mfma_f32_16x16x32_bf16 v[84:87], a[180:183], v[60:63], v[84:87]
 v_mfma_f32_16x16x32_bf16 v[92:95], a[252:255], v[60:63], v[92:95]
 s_waitcnt lgkmcnt(2)
 v_mfma_f32_16x16x32_bf16 v[64:67], a[40:43], v[32:35], v[64:67]
 ds_read_b128 v[48:51], v6 offset:24576
 v_mfma_f32_16x16x32_bf16 v[72:75], a[112:115], v[32:35], v[72:75]
 ds_read_b128 v[52:55], v6 offset:26624
 v_mfma_f32_16x16x32_bf16 v[80:83], a[184:187], v[32:35], v[80:83]
 buffer_load_dwordx4 v[152:155], v1, s[20:23], s53 offen offset:2048 sc1
 v_mfma_f32_16x16x32_bf16 v[88:91], v[224:227], v[32:35], v[88:91]
 v_mfma_f32_16x16x32_bf16 v[68:71], a[40:43], v[36:39], v[68:71]
 buffer_load_dwordx4 v[156:159], v1, s[20:23], s53 offen offset:3072 sc1
 v_mfma_f32_16x16x32_bf16 v[76:79], a[112:115], v[36:39], v[76:79]
 v_mfma_f32_16x16x32_bf16 v[84:87], a[184:187], v[36:39], v[84:87]
 s_add_u32 s53, s53, 4096
 v_mfma_f32_16x16x32_bf16 v[92:95], v[224:227], v[36:39], v[92:95]
 s_waitcnt lgkmcnt(2)
 v_mfma_f32_16x16x32_bf16 v[64:67], a[44:47], v[40:43], v[64:67]
 ds_read_b128 v[56:59], v7 offset:24576
 v_mfma_f32_16x16x32_bf16 v[72:75], a[116:119], v[40:43], v[72:75]
 ds_read_b128 v[60:63], v7 offset:26624
 v_mfma_f32_16x16x32_bf16 v[80:83], a[188:191], v[40:43], v[80:83]
 buffer_load_dwordx4 v[160:163], v1, s[20:23], s53 offen offset:0 sc1
 v_mfma_f32_16x16x32_bf16 v[88:91], v[228:231], v[40:43], v[88:91]
 v_mfma_f32_16x16x32_bf16 v[68:71], a[44:47], v[44:47], v[68:71]
 buffer_load_dwordx4 v[164:167], v1, s[20:23], s53 offen offset:1024 sc1
 v_mfma_f32_16x16x32_bf16 v[76:79], a[116:119], v[44:47], v[76:79]
 v_mfma_f32_16x16x32_bf16 v[84:87], a[188:191], v[44:47], v[84:87]
 v_mfma_f32_16x16x32_bf16 v[92:95], v[228:231], v[44:47], v[92:95]
 s_waitcnt lgkmcnt(2)
 v_mfma_f32_16x16x32_bf16 v[64:67], a[48:51], v[48:51], v[64:67]
 ds_read_b128 v[32:35], v6 offset:28672
 v_mfma_f32_16x16x32_bf16 v[72:75], a[120:123], v[48:51], v[72:75]
 ds_read_b128 v[36:39], v6 offset:30720
 v_mfma_f32_16x16x32_bf16 v[80:83], a[192:195], v[48:51], v[80:83]
 buffer_load_dwordx4 v[168:171], v1, s[20:23], s53 offen offset:2048 sc1
 v_mfma_f32_16x16x32_bf16 v[88:91], v[232:235], v[48:51], v[88:91]
 v_mfma_f32_16x16x32_bf16 v[68:71], a[48:51], v[52:55], v[68:71]
 buffer_load_dwordx4 v[172:175], v1, s[20:23], s53 offen offset:3072 sc1
 v_mfma_f32_16x16x32_bf16 v[76:79], a[120:123], v[52:55], v[76:79]
 v_mfma_f32_16x16x32_bf16 v[84:87], a[192:195], v[52:55], v[84:87]
 s_add_u32 s53, s53, 4096
 v_mfma_f32_16x16x32_bf16 v[92:95], v[232:235], v[52:55], v[92:95]
 s_waitcnt lgkmcnt(2)
 v_mfma_f32_16x16x32_bf16 v[64:67], a[52:55], v[56:59], v[64:67]
 ds_read_b128 v[40:43], v7 offset:28672
 v_mfma_f32_16x16x32_bf16 v[72:75], a[124:127], v[56:59], v[72:75]
 ds_read_b128 v[44:47], v7 offset:30720
 v_mfma_f32_16x16x32_bf16 v[80:83], a[196:199], v[56:59], v[80:83]
 s_add_u32 s43, s43, 36864
 s_cmp_eq_u32 s43, 147456
 buffer_load_dwordx4 v[176:179], v1, s[20:23], s53 offen offset:0 sc1
 v_mfma_f32_16x16x32_bf16 v[88:91], v[236:239], v[56:59], v[88:91]
 s_cselect_b32 s43, 0, s43
 s_add_u32 s44, s44, 36864
 v_mfma_f32_16x16x32_bf16 v[68:71], a[52:55], v[60:63], v[68:71]
 s_cmp_eq_u32 s44, 147456
 s_cselect_b32 s44, 0, s44
 buffer_load_dwordx4 v[180:183], v1, s[20:23], s53 offen offset:1024 sc1
 v_mfma_f32_16x16x32_bf16 v[76:79], a[124:127], v[60:63], v[76:79]
 v_mfma_f32_16x16x32_bf16 v[84:87], a[196:199], v[60:63], v[84:87]
 v_mfma_f32_16x16x32_bf16 v[92:95], v[236:239], v[60:63], v[92:95]
 s_waitcnt lgkmcnt(2)
 v_mfma_f32_16x16x32_bf16 v[64:67], a[56:59], v[32:35], v[64:67]
 ds_read_b128 v[48:51], v6 offset:32768
 v_mfma_f32_16x16x32_bf16 v[72:75], a[128:131], v[32:35], v[72:75]
 ds_read_b128 v[52:55], v6 offset:34816
 v_mfma_f32_16x16x32_bf16 v[80:83], a[200:203], v[32:35], v[80:83]
 v_add_u32 v6, s43, v4
 buffer_load_dwordx4 v[184:187], v1, s[20:23], s53 offen offset:2048 sc1
 v_mfma_f32_16x16x32_bf16 v[88:91], v[240:243], v[32:35], v[88:91]
 v_mfma_f32_16x16x32_bf16 v[68:71], a[56:59], v[36:39], v[68:71]
 buffer_load_dwordx4 v[188:191], v1, s[20:23], s53 offen offset:3072 sc1
 v_mfma_f32_16x16x32_bf16 v[76:79], a[128:131], v[36:39], v[76:79]
 v_mfma_f32_16x16x32_bf16 v[84:87], a[200:203], v[36:39], v[84:87]
 v_mfma_f32_16x16x32_bf16 v[92:95], v[240:243], v[36:39], v[92:95]
 s_waitcnt lgkmcnt(2)
 v_mfma_f32_16x16x32_bf16 v[64:67], a[60:63], v[40:43], v[64:67]
 ds_read_b128 v[56:59], v7 offset:32768
 v_mfma_f32_16x16x32_bf16 v[72:75], a[132:135], v[40:43], v[72:75]
 ds_read_b128 v[60:63], v7 offset:34816
 v_mfma_f32_16x16x32_bf16 v[80:83], a[204:207], v[40:43], v[80:83]
 v_add_u32 v7, s43, v5
 v_mfma_f32_16x16x32_bf16 v[88:91], v[244:247], v[40:43], v[88:91]
 v_mfma_f32_16x16x32_bf16 v[68:71], a[60:63], v[44:47], v[68:71]
 v_mfma_f32_16x16x32_bf16 v[76:79], a[132:135], v[44:47], v[76:79]
 v_mfma_f32_16x16x32_bf16 v[84:87], a[204:207], v[44:47], v[84:87]
 v_mfma_f32_16x16x32_bf16 v[92:95], v[244:247], v[44:47], v[92:95]
 s_waitcnt lgkmcnt(2)
 v_mfma_f32_16x16x32_bf16 v[64:67], a[64:67], v[48:51], v[64:67]
 s_waitcnt vmcnt(28)
 s_barrier
 ds_read_b128 v[32:35], v6 offset:0
 v_mfma_f32_16x16x32_bf16 v[72:75], a[136:139], v[48:51], v[72:75]
 ds_read_b128 v[36:39], v6 offset:2048
 v_mfma_f32_16x16x32_bf16 v[80:83], a[208:211], v[48:51], v[80:83]
 v_mfma_f32_16x16x32_bf16 v[88:91], v[248:251], v[48:51], v[88:91]
 s_waitcnt vmcnt(16)
 v_cmp_le_u32 vcc, s60, v16
 v_mfma_f32_16x16x32_bf16 v[68:71], a[64:67], v[52:55], v[68:71]
 v_mfma_f32_16x16x32_bf16 v[76:79], a[136:139], v[52:55], v[76:79]
 s_and_b32 s64, vcc_lo, 1
 s_cbranch_scc0 Lqsk_45
 buffer_load_dwordx4 v[192:195], v1, s[20:23], s55 offen offset:0 sc1
 buffer_load_dwordx4 v[196:199], v1, s[20:23], s55 offen offset:1024 sc1
 buffer_load_dwordx4 v[200:203], v1, s[20:23], s55 offen offset:2048 sc1
 buffer_load_dwordx4 v[204:207], v1, s[20:23], s55 offen offset:3072 sc1
Lqsk_45:
 v_mfma_f32_16x16x32_bf16 v[84:87], a[208:211], v[52:55], v[84:87]
 v_mfma_f32_16x16x32_bf16 v[92:95], v[248:251], v[52:55], v[92:95]
 s_waitcnt lgkmcnt(2)
 v_mfma_f32_16x16x32_bf16 v[64:67], a[68:71], v[56:59], v[64:67]
 ds_read_b128 v[40:43], v7 offset:0
 v_mfma_f32_16x16x32_bf16 v[72:75], a[140:143], v[56:59], v[72:75]
 ds_read_b128 v[44:47], v7 offset:2048
 v_mfma_f32_16x16x32_bf16 v[80:83], a[212:215], v[56:59], v[80:83]
 v_mfma_f32_16x16x32_bf16 v[88:91], v[252:255], v[56:59], v[88:91]
 s_mov_b32 s39, s40
 s_mov_b32 s40, s41
 v_mfma_f32_16x16x32_bf16 v[68:71], a[68:71], v[60:63], v[68:71]
 s_add_u32 s42, s42, 1
 v_mov_b32 v14, s42
 v_mfma_f32_16x16x32_bf16 v[76:79], a[140:143], v[60:63], v[76:79]
 v_mfma_f32_16x16x32_bf16 v[84:87], a[212:215], v[60:63], v[84:87]
 v_mfma_f32_16x16x32_bf16 v[92:95], v[252:255], v[60:63], v[92:95]
 s_waitcnt lgkmcnt(2)
 s_nop 7
 v_cvt_pk_bf16_f32 v16, v64, v72
 v_cvt_pk_bf16_f32 v17, v65, v73
 v_cvt_pk_bf16_f32 v18, v66, v74
 v_cvt_pk_bf16_f32 v19, v67, v75
 ds_write_b128 v2, v[16:19] offset:0
 v_cvt_pk_bf16_f32 v20, v68, v76
 v_cvt_pk_bf16_f32 v21, v69, v77
 v_cvt_pk_bf16_f32 v22, v70, v78
 v_cvt_pk_bf16_f32 v23, v71, v79
 ds_write_b128 v2, v[20:23] offset:1024
 v_cvt_pk_bf16_f32 v24, v80, v88
 v_cvt_pk_bf16_f32 v25, v81, v89
 v_cvt_pk_bf16_f32 v26, v82, v90
 v_cvt_pk_bf16_f32 v27, v83, v91
 ds_write_b128 v2, v[24:27] offset:8192
 v_cvt_pk_bf16_f32 v28, v84, v92
 v_cvt_pk_bf16_f32 v29, v85, v93
 v_cvt_pk_bf16_f32 v30, v86, v94
 v_cvt_pk_bf16_f32 v31, v87, v95
 ds_write_b128 v2, v[28:31] offset:9216
 v_mov_b64 v[120:121], 0
 v_mov_b64 v[122:123], 0
 s_waitcnt lgkmcnt(0)
 s_barrier
 ds_read_b128 v[96:99], v3 offset:0
 ds_read_b128 v[100:103], v3 offset:2048
 ds_read_b128 v[104:107], v3 offset:4096
 ds_read_b128 v[108:111], v3 offset:6144
 s_cmp_lg_u32 s64, 0
 s_cbranch_scc1 Lqpre_46
Lqs_47:
 buffer_load_dword v16, v15, s[20:23], s57 offen sc1
 s_waitcnt vmcnt(0)
 v_cmp_le_u32 vcc, s60, v16
 s_cbranch_vccnz Lqsk_48
 s_sleep 2
 s_sub_u32 s58, s58, 1
 s_cbranch_scc0 Lqs_47
 s_endpgm
Lqsk_48:
 buffer_load_dwordx4 v[192:195], v1, s[20:23], s55 offen offset:0 sc1
 buffer_load_dwordx4 v[196:199], v1, s[20:23], s55 offen offset:1024 sc1
 buffer_load_dwordx4 v[200:203], v1, s[20:23], s55 offen offset:2048 sc1
 buffer_load_dwordx4 v[204:207], v1, s[20:23], s55 offen offset:3072 sc1
Lqpre_46:
 s_waitcnt vmcnt(4) lgkmcnt(0)
 v_mfma_f32_16x16x32_bf16 v[112:115], v[128:131], v[96:99], v[208:211]
 v_mfma_f32_16x16x32_bf16 v[116:119], v[132:135], v[96:99], v[212:215]
 v_mfma_f32_16x16x32_bf16 v[112:115], v[136:139], v[100:103], v[112:115]
 v_mfma_f32_16x16x32_bf16 v[116:119], v[140:143], v[100:103], v[116:119]
 v_mfma_f32_16x16x32_bf16 v[112:115], v[144:147], v[104:107], v[112:115]
 v_mfma_f32_16x16x32_bf16 v[116:119], v[148:151], v[104:107], v[116:119]
 v_mfma_f32_16x16x32_bf16 v[112:115], v[152:155], v[108:111], v[112:115]
 v_mfma_f32_16x16x32_bf16 v[116:119], v[156:159], v[108:111], v[116:119]
 s_nop 7
 v_max3_f32 v24, v112, v113, v114
 v_max3_f32 v24, v24, v115, v116
 v_max3_f32 v24, v24, v117, v118
 v_max_f32 v24, v24, v119
 s_waitcnt vmcnt(2)
 v_mov_b64 v[16:17], v[192:193]
 v_mov_b64 v[18:19], v[196:197]
 s_nop 1
 v_smfmac_f32_16x16x64_bf16 v[120:123], v[16:19], v[96:103], v12
 s_waitcnt vmcnt(0)
 v_mov_b64 v[20:21], v[200:201]
 v_mov_b64 v[22:23], v[204:205]
 s_nop 1
 v_smfmac_f32_16x16x64_bf16 v[120:123], v[20:23], v[104:111], v12
 s_nop 7
 v_add_f32 v120, v120, v122
 v_add_f32 v121, v121, v123
 v_mul_f32 v120, s50, v120
 v_mul_f32 v121, s50, v121
 v_max3_f32 v24, v24, v120, v121
 v_mov_b32 v25, v24
 s_nop 1
 v_permlane16_swap_b32 v24, v25
 v_max_f32 v24, v24, v25
 v_mov_b32 v25, v24
 s_nop 1
 v_permlane32_swap_b32 v24, v25
 v_max_f32 v24, v24, v25
 v_sub_f32 v112, v112, v24
 v_sub_f32 v113, v113, v24
 v_sub_f32 v114, v114, v24
 v_sub_f32 v115, v115, v24
 v_sub_f32 v116, v116, v24
 v_sub_f32 v117, v117, v24
 v_sub_f32 v118, v118, v24
 v_sub_f32 v119, v119, v24
 v_sub_f32 v120, v120, v24
 v_sub_f32 v121, v121, v24
 v_exp_f32 v120, v120
 v_exp_f32 v121, v121
 v_exp_f32 v112, v112
 v_exp_f32 v113, v113
 v_exp_f32 v114, v114
 v_exp_f32 v115, v115
 v_exp_f32 v116, v116
 v_exp_f32 v117, v117
 v_exp_f32 v118, v118
 v_exp_f32 v119, v119
 v_cvt_pk_bf16_f32 v216, v120, v121
 v_cvt_pk_bf16_f32 v219, v120, v121
 v_cvt_pk_bf16_f32 v28, v112, v113
 v_cvt_pk_bf16_f32 v29, v116, v117
 v_cvt_pk_bf16_f32 v30, v114, v115
 v_cvt_pk_bf16_f32 v31, v118, v119
 v_mfma_f32_16x16x16_bf16 v[124:127], v[220:221], v[216:217], 0
 v_mfma_f32_16x16x16_bf16 v[64:67], v[194:195], v[216:217], 0
 v_mfma_f32_16x16x16_bf16 v[68:71], v[194:195], v[218:219], 0
 v_mfma_f32_16x16x16_bf16 v[72:75], v[198:199], v[216:217], 0
 v_mfma_f32_16x16x16_bf16 v[76:79], v[198:199], v[218:219], 0
 v_mfma_f32_16x16x16_bf16 v[80:83], v[202:203], v[216:217], 0
 v_mfma_f32_16x16x16_bf16 v[84:87], v[202:203], v[218:219], 0
 v_mfma_f32_16x16x16_bf16 v[88:91], v[206:207], v[216:217], 0
 v_mfma_f32_16x16x16_bf16 v[92:95], v[206:207], v[218:219], 0
 v_mfma_f32_16x16x32_bf16 v[124:127], v[220:223], v[28:31], v[124:127]
 v_mfma_f32_16x16x32_bf16 v[64:67], v[160:163], v[28:31], v[64:67]
 v_mfma_f32_16x16x32_bf16 v[68:71], v[164:167], v[28:31], v[68:71]
 v_mfma_f32_16x16x32_bf16 v[72:75], v[168:171], v[28:31], v[72:75]
 v_mfma_f32_16x16x32_bf16 v[76:79], v[172:175], v[28:31], v[76:79]
 v_mfma_f32_16x16x32_bf16 v[80:83], v[176:179], v[28:31], v[80:83]
 v_mfma_f32_16x16x32_bf16 v[84:87], v[180:183], v[28:31], v[84:87]
 v_mfma_f32_16x16x32_bf16 v[88:91], v[184:187], v[28:31], v[88:91]
 v_mfma_f32_16x16x32_bf16 v[92:95], v[188:191], v[28:31], v[92:95]
 v_rcp_f32 v124, v124
 s_add_u32 s45, s56, 4096
 v_mul_f32 v64, v64, v124
 v_mul_f32 v65, v65, v124
 v_mul_f32 v66, v66, v124
 v_mul_f32 v67, v67, v124
 v_mul_f32 v68, v68, v124
 v_mul_f32 v69, v69, v124
 v_mul_f32 v70, v70, v124
 v_mul_f32 v71, v71, v124
 v_cvt_pk_bf16_f32 v96, v64, v65
 v_cvt_pk_bf16_f32 v97, v68, v69
 v_cvt_pk_bf16_f32 v98, v66, v67
 v_cvt_pk_bf16_f32 v99, v70, v71
 buffer_store_dwordx4 v[96:99], v1, s[20:23], s56 offen offset:0 sc1
 v_mul_f32 v72, v72, v124
 v_mul_f32 v73, v73, v124
 v_mul_f32 v74, v74, v124
 v_mul_f32 v75, v75, v124
 v_mul_f32 v76, v76, v124
 v_mul_f32 v77, v77, v124
 v_mul_f32 v78, v78, v124
 v_mul_f32 v79, v79, v124
 v_cvt_pk_bf16_f32 v100, v72, v73
 v_cvt_pk_bf16_f32 v101, v76, v77
 v_cvt_pk_bf16_f32 v102, v74, v75
 v_cvt_pk_bf16_f32 v103, v78, v79
 buffer_store_dwordx4 v[100:103], v1, s[20:23], s56 offen offset:2048 sc1
 v_mul_f32 v80, v80, v124
 v_mul_f32 v81, v81, v124
 v_mul_f32 v82, v82, v124
 v_mul_f32 v83, v83, v124
 v_mul_f32 v84, v84, v124
 v_mul_f32 v85, v85, v124
 v_mul_f32 v86, v86, v124
 v_mul_f32 v87, v87, v124
 v_cvt_pk_bf16_f32 v104, v80, v81
 v_cvt_pk_bf16_f32 v105, v84, v85
 v_cvt_pk_bf16_f32 v106, v82, v83
 v_cvt_pk_bf16_f32 v107, v86, v87
 buffer_store_dwordx4 v[104:107], v1, s[20:23], s45 offen offset:0 sc1
 v_mul_f32 v88, v88, v124
 v_mul_f32 v89, v89, v124
 v_mul_f32 v90, v90, v124
 v_mul_f32 v91, v91, v124
 v_mul_f32 v92, v92, v124
 v_mul_f32 v93, v93, v124
 v_mul_f32 v94, v94, v124
 v_mul_f32 v95, v95, v124
 v_cvt_pk_bf16_f32 v108, v88, v89
 v_cvt_pk_bf16_f32 v109, v92, v93
 v_cvt_pk_bf16_f32 v110, v90, v91
 v_cvt_pk_bf16_f32 v111, v94, v95
 buffer_store_dwordx4 v[108:111], v1, s[20:23], s45 offen offset:2048 sc1
 s_cmp_lt_u32 s42, s36
 s_cbranch_scc1 Lqb_loop_40
 s_waitcnt vmcnt(0)
 buffer_load_dword v17, v11, s[20:23], s56 offen sc1
 s_barrier
 buffer_store_dword v14, v8, s[20:23], s59 offen sc1
 s_branch Lfin
Lob:
 s_load_dwordx2 s[8:9], s[0:1], 88
 s_mov_b32 s10, 0x480000
 s_mov_b32 s11, 0x20000
 s_sub_u32 s32, s6, 16
 s_mul_i32 s7, s3, 5
 s_add_u32 s7, s7, s6
 s_sub_u32 s7, s7, 25
 s_cmp_lt_u32 s6, 25
 s_cselect_b32 s32, s32, s7
 s_cselect_b32 s33, s3, 4
 s_cselect_b32 s34, 2, 1
 s_cselect_b32 s39, 6, 4
 s_cselect_b32 s35, 22, 20
 s_cselect_b32 s40, 0, 4
 s_mov_b32 s36, 0x7000000
 s_mov_b32 s37, 1152
 s_lshl_b32 s7, s4, 7
 s_add_u32 s38, s7, 0x3800
 s_mov_b32 s93, 1
 s_mov_b32 s92, 3
 s_mov_b32 s91, 9
 s_mov_b32 s90, 1
Los:
 s_load_dwordx2 s[24:25], s[0:1], 104
 s_mov_b32 s26, 0x480000
 s_mov_b32 s27, 0x20000
 s_waitcnt lgkmcnt(0)
 v_and_b32 v15, 63, v0
 v_lshlrev_b32 v1, 4, v15
 v_and_b32 v3, s92, v15
 v_lshlrev_b32 v3, 2, v3
 v_lshrrev_b32 v14, 4, v15
 v_min_u32 v14, 1, v14
 v_lshl_or_b32 v3, v14, 28, v3
 s_add_u32 s44, s32, s40
 s_and_b32 s44, s44, 7
 s_mov_b32 s50, 0x40000
 s_mul_i32 s49, s4, 40960
 v_add_u32 v5, s49, v1
 v_bfe_u32 v14, v15, 5, 1
 v_bfe_u32 v16, v15, 3, 1
 v_lshl_add_u32 v14, v14, 1, v16
 v_bfe_u32 v16, v15, 4, 1
 v_lshl_add_u32 v14, v16, 6, v14
 v_mul_u32_u24 v14, 1152, v14
 v_bfe_u32 v17, v15, 1, 2
 v_xor_b32 v17, v17, v16
 v_lshlrev_b32 v17, 5, v17
 v_and_b32 v16, 1, v15
 v_lshl_add_u32 v17, v16, 4, v17
 v_add_u32 v8, v14, v17
 v_xor_b32 v17, 64, v17
 v_add_u32 v9, v14, v17
 v_lshrrev_b32 v14, 4, v15
 v_bfe_u32 v16, v15, 2, 2
 v_lshl_add_u32 v14, v14, 3, v16
 v_lshlrev_b32 v14, 7, v14
 v_bfe_u32 v16, v15, 3, 2
 v_lshl_add_u32 v14, v16, 5, v14
 v_and_b32 v16, 3, v15
 v_lshl_add_u32 v14, v16, 3, v14
 v_xor_b32 v16, 0, v14
 v_add_u32 v10, s49, v16
 v_xor_b32 v16, 32, v14
 v_add_u32 v11, s49, v16
 v_xor_b32 v16, 64, v14
 v_add_u32 v12, s49, v16
 v_xor_b32 v16, 96, v14
 v_add_u32 v13, s49, v16
 s_lshl_b32 s47, s32, 7
 s_add_u32 s46, s44, 0
 s_and_b32 s46, s46, 7
 s_lshl_b32 s45, s4, 3
 s_add_u32 s46, s46, s45
 s_mul_i32 s46, s46, 147456
 s_add_u32 s46, s46, s47
 s_add_u32 m0, s49, 8192
 s_add_u32 s45, s46, 0
 buffer_load_dwordx4 v8, s[8:11], s45 offen  lds
 s_add_u32 m0, s49, 9216
 s_add_u32 s45, s46, 4608
 buffer_load_dwordx4 v9, s[8:11], s45 offen  lds
 s_add_u32 m0, s49, 10240
 s_add_u32 s45, s46, 9216
 buffer_load_dwordx4 v8, s[8:11], s45 offen  lds
 s_add_u32 m0, s49, 11264
 s_add_u32 s45, s46, 13824
 buffer_load_dwordx4 v9, s[8:11], s45 offen  lds
 s_add_u32 m0, s49, 12288
 s_add_u32 s45, s46, 18432
 buffer_load_dwordx4 v8, s[8:11], s45 offen  lds
 s_add_u32 m0, s49, 13312
 s_add_u32 s45, s46, 23040
 buffer_load_dwordx4 v9, s[8:11], s45 offen  lds
 s_add_u32 m0, s49, 14336
 s_add_u32 s45, s46, 27648
 buffer_load_dwordx4 v8, s[8:11], s45 offen  lds
 s_add_u32 m0, s49, 15360
 s_add_u32 s45, s46, 32256
 buffer_load_dwordx4 v9, s[8:11], s45 offen  lds
 s_add_u32 m0, s49, 16384
 s_add_u32 s45, s46, 36864
 buffer_load_dwordx4 v8, s[8:11], s45 offen  lds
 s_add_u32 m0, s49, 17408
 s_add_u32 s45, s46, 41472
 buffer_load_dwordx4 v9, s[8:11], s45 offen  lds
 s_add_u32 m0, s49, 18432
 s_add_u32 s45, s46, 46080
 buffer_load_dwordx4 v8, s[8:11], s45 offen  lds
 s_add_u32 m0, s49, 19456
 s_add_u32 s45, s46, 50688
 buffer_load_dwordx4 v9, s[8:11], s45 offen  lds
 s_add_u32 m0, s49, 20480
 s_add_u32 s45, s46, 55296
 buffer_load_dwordx4 v8, s[8:11], s45 offen  lds
 s_add_u32 m0, s49, 21504
 s_add_u32 s45, s46, 59904
 buffer_load_dwordx4 v9, s[8:11], s45 offen  lds
 s_add_u32 m0, s49, 22528
 s_add_u32 s45, s46, 64512
 buffer_load_dwordx4 v8, s[8:11], s45 offen  lds
 s_add_u32 m0, s49, 23552
 s_add_u32 s45, s46, 69120
 buffer_load_dwordx4 v9, s[8:11], s45 offen  lds
 s_add_u32 s46, s44, 1
 s_and_b32 s46, s46, 7
 s_lshl_b32 s45, s4, 3
 s_add_u32 s46, s46, s45
 s_mul_i32 s46, s46, 147456
 s_add_u32 s46, s46, s47
 s_add_u32 m0, s49, 24576
 s_add_u32 s45, s46, 0
 buffer_load_dwordx4 v8, s[8:11], s45 offen  lds
 s_add_u32 m0, s49, 25600
 s_add_u32 s45, s46, 4608
 buffer_load_dwordx4 v9, s[8:11], s45 offen  lds
 s_add_u32 m0, s49, 26624
 s_add_u32 s45, s46, 9216
 buffer_load_dwordx4 v8, s[8:11], s45 offen  lds
 s_add_u32 m0, s49, 27648
 s_add_u32 s45, s46, 13824
 buffer_load_dwordx4 v9, s[8:11], s45 offen  lds
 s_add_u32 m0, s49, 28672
 s_add_u32 s45, s46, 18432
 buffer_load_dwordx4 v8, s[8:11], s45 offen  lds
 s_add_u32 m0, s49, 29696
 s_add_u32 s45, s46, 23040
 buffer_load_dwordx4 v9, s[8:11], s45 offen  lds
 s_add_u32 m0, s49, 30720
 s_add_u32 s45, s46, 27648
 buffer_load_dwordx4 v8, s[8:11], s45 offen  lds
 s_add_u32 m0, s49, 31744
 s_add_u32 s45, s46, 32256
 buffer_load_dwordx4 v9, s[8:11], s45 offen  lds
 s_waitcnt vmcnt(20) lgkmcnt(0)
 s_add_u32 m0, s49, 32768
 s_add_u32 s45, s46, 36864
 buffer_load_dwordx4 v8, s[8:11], s45 offen  lds
 s_add_u32 m0, s49, 33792
 s_add_u32 s45, s46, 41472
 buffer_load_dwordx4 v9, s[8:11], s45 offen  lds
 s_add_u32 m0, s49, 34816
 s_add_u32 s45, s46, 46080
 buffer_load_dwordx4 v8, s[8:11], s45 offen  lds
 s_add_u32 m0, s49, 35840
 s_add_u32 s45, s46, 50688
 buffer_load_dwordx4 v9, s[8:11], s45 offen  lds
 ds_read_b64_tr_b16 a[0:1], v10 offset:8192
 ds_read_b64_tr_b16 a[2:3], v10 offset:8704
 ds_read_b64_tr_b16 a[4:5], v11 offset:8192
 ds_read_b64_tr_b16 a[6:7], v11 offset:8704
 ds_read_b64_tr_b16 a[8:9], v12 offset:8192
 ds_read_b64_tr_b16 a[10:11], v12 offset:8704
 ds_read_b64_tr_b16 v[16:17], v13 offset:8192
 ds_read_b64_tr_b16 v[18:19], v13 offset:8704
 s_waitcnt vmcnt(20) lgkmcnt(0)
 s_add_u32 m0, s49, 36864
 s_add_u32 s45, s46, 55296
 buffer_load_dwordx4 v8, s[8:11], s45 offen  lds
 s_add_u32 m0, s49, 37888
 s_add_u32 s45, s46, 59904
 buffer_load_dwordx4 v9, s[8:11], s45 offen  lds
 s_add_u32 m0, s49, 38912
 s_add_u32 s45, s46, 64512
 buffer_load_dwordx4 v8, s[8:11], s45 offen  lds
 s_add_u32 m0, s49, 39936
 s_add_u32 s45, s46, 69120
 buffer_load_dwordx4 v9, s[8:11], s45 offen  lds
 ds_write_b128 v5, v[16:19] offset:0
 ds_read_b64_tr_b16 a[12:13], v10 offset:12288
 ds_read_b64_tr_b16 a[14:15], v10 offset:12800
 ds_read_b64_tr_b16 a[16:17], v11 offset:12288
 ds_read_b64_tr_b16 a[18:19], v11 offset:12800
 ds_read_b64_tr_b16 a[20:21], v12 offset:12288
 ds_read_b64_tr_b16 a[22:23], v12 offset:12800
 ds_read_b64_tr_b16 v[20:21], v13 offset:12288
 ds_read_b64_tr_b16 v[22:23], v13 offset:12800
 s_waitcnt vmcnt(20) lgkmcnt(0)
 s_add_u32 s46, s44, 2
 s_and_b32 s46, s46, 7
 s_lshl_b32 s45, s4, 3
 s_add_u32 s46, s46, s45
 s_mul_i32 s46, s46, 147456
 s_add_u32 s46, s46, s47
 s_add_u32 m0, s49, 8192
 s_add_u32 s45, s46, 0
 buffer_load_dwordx4 v8, s[8:11], s45 offen  lds
 s_add_u32 m0, s49, 9216
 s_add_u32 s45, s46, 4608
 buffer_load_dwordx4 v9, s[8:11], s45 offen  lds
 s_add_u32 m0, s49, 10240
 s_add_u32 s45, s46, 9216
 buffer_load_dwordx4 v8, s[8:11], s45 offen  lds
 s_add_u32 m0, s49, 11264
 s_add_u32 s45, s46, 13824
 buffer_load_dwordx4 v9, s[8:11], s45 offen  lds
 ds_write_b128 v5, v[20:23] offset:1024
 ds_read_b64_tr_b16 a[24:25], v10 offset:16384
 ds_read_b64_tr_b16 a[26:27], v10 offset:16896
 ds_read_b64_tr_b16 a[28:29], v11 offset:16384
 ds_read_b64_tr_b16 a[30:31], v11 offset:16896
 ds_read_b64_tr_b16 a[32:33], v12 offset:16384
 ds_read_b64_tr_b16 a[34:35], v12 offset:16896
 ds_read_b64_tr_b16 v[16:17], v13 offset:16384
 ds_read_b64_tr_b16 v[18:19], v13 offset:16896
 s_waitcnt vmcnt(20) lgkmcnt(0)
 s_add_u32 m0, s49, 12288
 s_add_u32 s45, s46, 18432
 buffer_load_dwordx4 v8, s[8:11], s45 offen  lds
 s_add_u32 m0, s49, 13312
 s_add_u32 s45, s46, 23040
 buffer_load_dwordx4 v9, s[8:11], s45 offen  lds
 s_add_u32 m0, s49, 14336
 s_add_u32 s45, s46, 27648
 buffer_load_dwordx4 v8, s[8:11], s45 offen  lds
 s_add_u32 m0, s49, 15360
 s_add_u32 s45, s46, 32256
 buffer_load_dwordx4 v9, s[8:11], s45 offen  lds
 ds_write_b128 v5, v[16:19] offset:2048
 ds_read_b64_tr_b16 a[36:37], v10 offset:20480
 ds_read_b64_tr_b16 a[38:39], v10 offset:20992
 ds_read_b64_tr_b16 a[40:41], v11 offset:20480
 ds_read_b64_tr_b16 a[42:43], v11 offset:20992
 ds_read_b64_tr_b16 a[44:45], v12 offset:20480
 ds_read_b64_tr_b16 a[46:47], v12 offset:20992
 ds_read_b64_tr_b16 v[20:21], v13 offset:20480
 ds_read_b64_tr_b16 v[22:23], v13 offset:20992
 s_waitcnt vmcnt(20) lgkmcnt(0)
 s_add_u32 m0, s49, 16384
 s_add_u32 s45, s46, 36864
 buffer_load_dwordx4 v8, s[8:11], s45 offen  lds
 s_add_u32 m0, s49, 17408
 s_add_u32 s45, s46, 41472
 buffer_load_dwordx4 v9, s[8:11], s45 offen  lds
 s_add_u32 m0, s49, 18432
 s_add_u32 s45, s46, 46080
 buffer_load_dwordx4 v8, s[8:11], s45 offen  lds
 s_add_u32 m0, s49, 19456
 s_add_u32 s45, s46, 50688
 buffer_load_dwordx4 v9, s[8:11], s45 offen  lds
 ds_write_b128 v5, v[20:23] offset:3072
 ds_read_b64_tr_b16 a[48:49], v10 offset:24576
 ds_read_b64_tr_b16 a[50:51], v10 offset:25088
 ds_read_b64_tr_b16 a[52:53], v11 offset:24576
 ds_read_b64_tr_b16 a[54:55], v11 offset:25088
 ds_read_b64_tr_b16 a[56:57], v12 offset:24576
 ds_read_b64_tr_b16 a[58:59], v12 offset:25088
 ds_read_b64_tr_b16 v[16:17], v13 offset:24576
 ds_read_b64_tr_b16 v[18:19], v13 offset:25088
 s_waitcnt vmcnt(20) lgkmcnt(0)
 s_add_u32 m0, s49, 20480
 s_add_u32 s45, s46, 55296
 buffer_load_dwordx4 v8, s[8:11], s45 offen  lds
 s_add_u32 m0, s49, 21504
 s_add_u32 s45, s46, 59904
 buffer_load_dwordx4 v9, s[8:11], s45 offen  lds
 s_add_u32 m0, s49, 22528
 s_add_u32 s45, s46, 64512
 buffer_load_dwordx4 v8, s[8:11], s45 offen  lds
 s_add_u32 m0, s49, 23552
 s_add_u32 s45, s46, 69120
 buffer_load_dwordx4 v9, s[8:11], s45 offen  lds
 ds_write_b128 v5, v[16:19] offset:4096
 ds_read_b64_tr_b16 a[60:61], v10 offset:28672
 ds_read_b64_tr_b16 a[62:63], v10 offset:29184
 ds_read_b64_tr_b16 a[64:65], v11 offset:28672
 ds_read_b64_tr_b16 a[66:67], v11 offset:29184
 ds_read_b64_tr_b16 a[68:69], v12 offset:28672
 ds_read_b64_tr_b16 a[70:71], v12 offset:29184
 ds_read_b64_tr_b16 v[20:21], v13 offset:28672
 ds_read_b64_tr_b16 v[22:23], v13 offset:29184
 s_waitcnt vmcnt(20) lgkmcnt(0)
 s_add_u32 s46, s44, 3
 s_and_b32 s46, s46, 7
 s_lshl_b32 s45, s4, 3
 s_add_u32 s46, s46, s45
 s_mul_i32 s46, s46, 147456
 s_add_u32 s46, s46, s47
 s_add_u32 m0, s49, 24576
 s_add_u32 s45, s46, 0
 buffer_load_dwordx4 v8, s[8:11], s45 offen  lds
 s_add_u32 m0, s49, 25600
 s_add_u32 s45, s46, 4608
 buffer_load_dwordx4 v9, s[8:11], s45 offen  lds
 s_add_u32 m0, s49, 26624
 s_add_u32 s45, s46, 9216
 buffer_load_dwordx4 v8, s[8:11], s45 offen  lds
 s_add_u32 m0, s49, 27648
 s_add_u32 s45, s46, 13824
 buffer_load_dwordx4 v9, s[8:11], s45 offen  lds
 ds_write_b128 v5, v[20:23] offset:5120
 ds_read_b64_tr_b16 a[72:73], v10 offset:32768
 ds_read_b64_tr_b16 a[74:75], v10 offset:33280
 ds_read_b64_tr_b16 a[76:77], v11 offset:32768
 ds_read_b64_tr_b16 a[78:79], v11 offset:33280
 ds_read_b64_tr_b16 a[80:81], v12 offset:32768
 ds_read_b64_tr_b16 a[82:83], v12 offset:33280
 ds_read_b64_tr_b16 v[16:17], v13 offset:32768
 ds_read_b64_tr_b16 v[18:19], v13 offset:33280
 s_waitcnt vmcnt(20) lgkmcnt(0)
 s_add_u32 m0, s49, 28672
 s_add_u32 s45, s46, 18432
 buffer_load_dwordx4 v8, s[8:11], s45 offen  lds
 s_add_u32 m0, s49, 29696
 s_add_u32 s45, s46, 23040
 buffer_load_dwordx4 v9, s[8:11], s45 offen  lds
 s_add_u32 m0, s49, 30720
 s_add_u32 s45, s46, 27648
 buffer_load_dwordx4 v8, s[8:11], s45 offen  lds
 s_add_u32 m0, s49, 31744
 s_add_u32 s45, s46, 32256
 buffer_load_dwordx4 v9, s[8:11], s45 offen  lds
 ds_write_b128 v5, v[16:19] offset:6144
 ds_read_b64_tr_b16 a[84:85], v10 offset:36864
 ds_read_b64_tr_b16 a[86:87], v10 offset:37376
 ds_read_b64_tr_b16 a[88:89], v11 offset:36864
 ds_read_b64_tr_b16 a[90:91], v11 offset:37376
 ds_read_b64_tr_b16 a[92:93], v12 offset:36864
 ds_read_b64_tr_b16 a[94:95], v12 offset:37376
 ds_read_b64_tr_b16 v[20:21], v13 offset:36864
 ds_read_b64_tr_b16 v[22:23], v13 offset:37376
 s_waitcnt vmcnt(20) lgkmcnt(0)
 s_add_u32 m0, s49, 32768
 s_add_u32 s45, s46, 36864
 buffer_load_dwordx4 v8, s[8:11], s45 offen  lds
 s_add_u32 m0, s49, 33792
 s_add_u32 s45, s46, 41472
 buffer_load_dwordx4 v9, s[8:11], s45 offen  lds
 s_add_u32 m0, s49, 34816
 s_add_u32 s45, s46, 46080
 buffer_load_dwordx4 v8, s[8:11], s45 offen  lds
 s_add_u32 m0, s49, 35840
 s_add_u32 s45, s46, 50688
 buffer_load_dwordx4 v9, s[8:11], s45 offen  lds
 ds_write_b128 v5, v[20:23] offset:7168
 ds_read_b64_tr_b16 a[96:97], v10 offset:8192
 ds_read_b64_tr_b16 a[98:99], v10 offset:8704
 ds_read_b64_tr_b16 a[100:101], v11 offset:8192
 ds_read_b64_tr_b16 a[102:103], v11 offset:8704
 ds_read_b64_tr_b16 a[104:105], v12 offset:8192
 ds_read_b64_tr_b16 a[106:107], v12 offset:8704
 ds_read_b64_tr_b16 v[32:33], v13 offset:8192
 ds_read_b64_tr_b16 v[34:35], v13 offset:8704
 s_waitcnt vmcnt(20) lgkmcnt(0)
 s_add_u32 m0, s49, 36864
 s_add_u32 s45, s46, 55296
 buffer_load_dwordx4 v8, s[8:11], s45 offen  lds
 s_add_u32 m0, s49, 37888
 s_add_u32 s45, s46, 59904
 buffer_load_dwordx4 v9, s[8:11], s45 offen  lds
 s_add_u32 m0, s49, 38912
 s_add_u32 s45, s46, 64512
 buffer_load_dwordx4 v8, s[8:11], s45 offen  lds
 s_add_u32 m0, s49, 39936
 s_add_u32 s45, s46, 69120
 buffer_load_dwordx4 v9, s[8:11], s45 offen  lds
 ds_read_b64_tr_b16 a[108:109], v10 offset:12288
 ds_read_b64_tr_b16 a[110:111], v10 offset:12800
 ds_read_b64_tr_b16 a[112:113], v11 offset:12288
 ds_read_b64_tr_b16 a[114:115], v11 offset:12800
 ds_read_b64_tr_b16 a[116:117], v12 offset:12288
 ds_read_b64_tr_b16 a[118:119], v12 offset:12800
 ds_read_b64_tr_b16 v[36:37], v13 offset:12288
 ds_read_b64_tr_b16 v[38:39], v13 offset:12800
 s_waitcnt vmcnt(20) lgkmcnt(0)
 s_add_u32 s46, s44, 4
 s_and_b32 s46, s46, 7
 s_lshl_b32 s45, s4, 3
 s_add_u32 s46, s46, s45
 s_mul_i32 s46, s46, 147456
 s_add_u32 s46, s46, s47
 s_add_u32 m0, s49, 8192
 s_add_u32 s45, s46, 0
 buffer_load_dwordx4 v8, s[8:11], s45 offen  lds
 s_add_u32 m0, s49, 9216
 s_add_u32 s45, s46, 4608
 buffer_load_dwordx4 v9, s[8:11], s45 offen  lds
 s_add_u32 m0, s49, 10240
 s_add_u32 s45, s46, 9216
 buffer_load_dwordx4 v8, s[8:11], s45 offen  lds
 s_add_u32 m0, s49, 11264
 s_add_u32 s45, s46, 13824
 buffer_load_dwordx4 v9, s[8:11], s45 offen  lds
 ds_read_b64_tr_b16 a[120:121], v10 offset:16384
 ds_read_b64_tr_b16 a[122:123], v10 offset:16896
 ds_read_b64_tr_b16 a[124:125], v11 offset:16384
 ds_read_b64_tr_b16 a[126:127], v11 offset:16896
 ds_read_b64_tr_b16 a[128:129], v12 offset:16384
 ds_read_b64_tr_b16 a[130:131], v12 offset:16896
 ds_read_b64_tr_b16 v[40:41], v13 offset:16384
 ds_read_b64_tr_b16 v[42:43], v13 offset:16896
 s_waitcnt vmcnt(20) lgkmcnt(0)
 s_add_u32 m0, s49, 12288
 s_add_u32 s45, s46, 18432
 buffer_load_dwordx4 v8, s[8:11], s45 offen  lds
 s_add_u32 m0, s49, 13312
 s_add_u32 s45, s46, 23040
 buffer_load_dwordx4 v9, s[8:11], s45 offen  lds
 s_add_u32 m0, s49, 14336
 s_add_u32 s45, s46, 27648
 buffer_load_dwordx4 v8, s[8:11], s45 offen  lds
 s_add_u32 m0, s49, 15360
 s_add_u32 s45, s46, 32256
 buffer_load_dwordx4 v9, s[8:11], s45 offen  lds
 ds_read_b64_tr_b16 a[132:133], v10 offset:20480
 ds_read_b64_tr_b16 a[134:135], v10 offset:20992
 ds_read_b64_tr_b16 a[136:137], v11 offset:20480
 ds_read_b64_tr_b16 a[138:139], v11 offset:20992
 ds_read_b64_tr_b16 a[140:141], v12 offset:20480
 ds_read_b64_tr_b16 a[142:143], v12 offset:20992
 ds_read_b64_tr_b16 v[44:45], v13 offset:20480
 ds_read_b64_tr_b16 v[46:47], v13 offset:20992
 s_waitcnt vmcnt(20) lgkmcnt(0)
 s_add_u32 m0, s49, 16384
 s_add_u32 s45, s46, 36864
 buffer_load_dwordx4 v8, s[8:11], s45 offen  lds
 s_add_u32 m0, s49, 17408
 s_add_u32 s45, s46, 41472
 buffer_load_dwordx4 v9, s[8:11], s45 offen  lds
 s_add_u32 m0, s49, 18432
 s_add_u32 s45, s46, 46080
 buffer_load_dwordx4 v8, s[8:11], s45 offen  lds
 s_add_u32 m0, s49, 19456
 s_add_u32 s45, s46, 50688
 buffer_load_dwordx4 v9, s[8:11], s45 offen  lds
 ds_read_b64_tr_b16 a[144:145], v10 offset:24576
 ds_read_b64_tr_b16 a[146:147], v10 offset:25088
 ds_read_b64_tr_b16 a[148:149], v11 offset:24576
 ds_read_b64_tr_b16 a[150:151], v11 offset:25088
 ds_read_b64_tr_b16 a[152:153], v12 offset:24576
 ds_read_b64_tr_b16 a[154:155], v12 offset:25088
 ds_read_b64_tr_b16 v[48:49], v13 offset:24576
 ds_read_b64_tr_b16 v[50:51], v13 offset:25088
 s_waitcnt vmcnt(20) lgkmcnt(0)
 s_add_u32 m0, s49, 20480
 s_add_u32 s45, s46, 55296
 buffer_load_dwordx4 v8, s[8:11], s45 offen  lds
 s_add_u32 m0, s49, 21504
 s_add_u32 s45, s46, 59904
 buffer_load_dwordx4 v9, s[8:11], s45 offen  lds
 s_add_u32 m0, s49, 22528
 s_add_u32 s45, s46, 64512
 buffer_load_dwordx4 v8, s[8:11], s45 offen  lds
 s_add_u32 m0, s49, 23552
 s_add_u32 s45, s46, 69120
 buffer_load_dwordx4 v9, s[8:11], s45 offen  lds
 ds_read_b64_tr_b16 a[156:157], v10 offset:28672
 ds_read_b64_tr_b16 a[158:159], v10 offset:29184
 ds_read_b64_tr_b16 a[160:161], v11 offset:28672
 ds_read_b64_tr_b16 a[162:163], v11 offset:29184
 ds_read_b64_tr_b16 a[164:165], v12 offset:28672
 ds_read_b64_tr_b16 a[166:167], v12 offset:29184
 ds_read_b64_tr_b16 v[52:53], v13 offset:28672
 ds_read_b64_tr_b16 v[54:55], v13 offset:29184
 s_waitcnt vmcnt(20) lgkmcnt(0)
 s_add_u32 s46, s44, 5
 s_and_b32 s46, s46, 7
 s_lshl_b32 s45, s4, 3
 s_add_u32 s46, s46, s45
 s_mul_i32 s46, s46, 147456
 s_add_u32 s46, s46, s47
 s_add_u32 m0, s49, 24576
 s_add_u32 s45, s46, 0
 buffer_load_dwordx4 v8, s[8:11], s45 offen  lds
 s_add_u32 m0, s49, 25600
 s_add_u32 s45, s46, 4608
 buffer_load_dwordx4 v9, s[8:11], s45 offen  lds
 s_add_u32 m0, s49, 26624
 s_add_u32 s45, s46, 9216
 buffer_load_dwordx4 v8, s[8:11], s45 offen  lds
 s_add_u32 m0, s49, 27648
 s_add_u32 s45, s46, 13824
 buffer_load_dwordx4 v9, s[8:11], s45 offen  lds
 ds_read_b64_tr_b16 a[168:169], v10 offset:32768
 ds_read_b64_tr_b16 a[170:171], v10 offset:33280
 ds_read_b64_tr_b16 a[172:173], v11 offset:32768
 ds_read_b64_tr_b16 a[174:175], v11 offset:33280
 ds_read_b64_tr_b16 a[176:177], v12 offset:32768
 ds_read_b64_tr_b16 a[178:179], v12 offset:33280
 ds_read_b64_tr_b16 v[56:57], v13 offset:32768
 ds_read_b64_tr_b16 v[58:59], v13 offset:33280
 s_waitcnt vmcnt(20) lgkmcnt(0)
 s_add_u32 m0, s49, 28672
 s_add_u32 s45, s46, 18432
 buffer_load_dwordx4 v8, s[8:11], s45 offen  lds
 s_add_u32 m0, s49, 29696
 s_add_u32 s45, s46, 23040
 buffer_load_dwordx4 v9, s[8:11], s45 offen  lds
 s_add_u32 m0, s49, 30720
 s_add_u32 s45, s46, 27648
 buffer_load_dwordx4 v8, s[8:11], s45 offen  lds
 s_add_u32 m0, s49, 31744
 s_add_u32 s45, s46, 32256
 buffer_load_dwordx4 v9, s[8:11], s45 offen  lds
 ds_read_b64_tr_b16 a[180:181], v10 offset:36864
 ds_read_b64_tr_b16 a[182:183], v10 offset:37376
 ds_read_b64_tr_b16 a[184:185], v11 offset:36864
 ds_read_b64_tr_b16 a[186:187], v11 offset:37376
 ds_read_b64_tr_b16 a[188:189], v12 offset:36864
 ds_read_b64_tr_b16 a[190:191], v12 offset:37376
 ds_read_b64_tr_b16 v[60:61], v13 offset:36864
 ds_read_b64_tr_b16 v[62:63], v13 offset:37376
 s_waitcnt vmcnt(20) lgkmcnt(0)
 s_add_u32 m0, s49, 32768
 s_add_u32 s45, s46, 36864
 buffer_load_dwordx4 v8, s[8:11], s45 offen  lds
 s_add_u32 m0, s49, 33792
 s_add_u32 s45, s46, 41472
 buffer_load_dwordx4 v9, s[8:11], s45 offen  lds
 s_add_u32 m0, s49, 34816
 s_add_u32 s45, s46, 46080
 buffer_load_dwordx4 v8, s[8:11], s45 offen  lds
 s_add_u32 m0, s49, 35840
 s_add_u32 s45, s46, 50688
 buffer_load_dwordx4 v9, s[8:11], s45 offen  lds
 ds_read_b64_tr_b16 a[192:193], v10 offset:8192
 ds_read_b64_tr_b16 a[194:195], v10 offset:8704
 ds_read_b64_tr_b16 a[196:197], v11 offset:8192
 ds_read_b64_tr_b16 a[198:199], v11 offset:8704
 ds_read_b64_tr_b16 a[200:201], v12 offset:8192
 ds_read_b64_tr_b16 a[202:203], v12 offset:8704
 ds_read_b64_tr_b16 v[64:65], v13 offset:8192
 ds_read_b64_tr_b16 v[66:67], v13 offset:8704
 s_waitcnt vmcnt(20) lgkmcnt(0)
 s_add_u32 m0, s49, 36864
 s_add_u32 s45, s46, 55296
 buffer_load_dwordx4 v8, s[8:11], s45 offen  lds
 s_add_u32 m0, s49, 37888
 s_add_u32 s45, s46, 59904
 buffer_load_dwordx4 v9, s[8:11], s45 offen  lds
 s_add_u32 m0, s49, 38912
 s_add_u32 s45, s46, 64512
 buffer_load_dwordx4 v8, s[8:11], s45 offen  lds
 s_add_u32 m0, s49, 39936
 s_add_u32 s45, s46, 69120
 buffer_load_dwordx4 v9, s[8:11], s45 offen  lds
 ds_read_b64_tr_b16 a[204:205], v10 offset:12288
 ds_read_b64_tr_b16 a[206:207], v10 offset:12800
 ds_read_b64_tr_b16 a[208:209], v11 offset:12288
 ds_read_b64_tr_b16 a[210:211], v11 offset:12800
 ds_read_b64_tr_b16 a[212:213], v12 offset:12288
 ds_read_b64_tr_b16 a[214:215], v12 offset:12800
 ds_read_b64_tr_b16 v[68:69], v13 offset:12288
 ds_read_b64_tr_b16 v[70:71], v13 offset:12800
 s_waitcnt vmcnt(20) lgkmcnt(0)
 s_add_u32 s46, s44, 6
 s_and_b32 s46, s46, 7
 s_lshl_b32 s45, s4, 3
 s_add_u32 s46, s46, s45
 s_mul_i32 s46, s46, 147456
 s_add_u32 s46, s46, s47
 s_add_u32 m0, s49, 8192
 s_add_u32 s45, s46, 0
 buffer_load_dwordx4 v8, s[8:11], s45 offen  lds
 s_add_u32 m0, s49, 9216
 s_add_u32 s45, s46, 4608
 buffer_load_dwordx4 v9, s[8:11], s45 offen  lds
 s_add_u32 m0, s49, 10240
 s_add_u32 s45, s46, 9216
 buffer_load_dwordx4 v8, s[8:11], s45 offen  lds
 s_add_u32 m0, s49, 11264
 s_add_u32 s45, s46, 13824
 buffer_load_dwordx4 v9, s[8:11], s45 offen  lds
 ds_read_b64_tr_b16 a[216:217], v10 offset:16384
 ds_read_b64_tr_b16 a[218:219], v10 offset:16896
 ds_read_b64_tr_b16 a[220:221], v11 offset:16384
 ds_read_b64_tr_b16 a[222:223], v11 offset:16896
 ds_read_b64_tr_b16 a[224:225], v12 offset:16384
 ds_read_b64_tr_b16 a[226:227], v12 offset:16896
 ds_read_b64_tr_b16 v[72:73], v13 offset:16384
 ds_read_b64_tr_b16 v[74:75], v13 offset:16896
 s_waitcnt vmcnt(20) lgkmcnt(0)
 s_add_u32 m0, s49, 12288
 s_add_u32 s45, s46, 18432
 buffer_load_dwordx4 v8, s[8:11], s45 offen  lds
 s_add_u32 m0, s49, 13312
 s_add_u32 s45, s46, 23040
 buffer_load_dwordx4 v9, s[8:11], s45 offen  lds
 s_add_u32 m0, s49, 14336
 s_add_u32 s45, s46, 27648
 buffer_load_dwordx4 v8, s[8:11], s45 offen  lds
 s_add_u32 m0, s49, 15360
 s_add_u32 s45, s46, 32256
 buffer_load_dwordx4 v9, s[8:11], s45 offen  lds
 ds_read_b64_tr_b16 a[228:229], v10 offset:20480
 ds_read_b64_tr_b16 a[230:231], v10 offset:20992
 ds_read_b64_tr_b16 a[232:233], v11 offset:20480
 ds_read_b64_tr_b16 a[234:235], v11 offset:20992
 ds_read_b64_tr_b16 a[236:237], v12 offset:20480
 ds_read_b64_tr_b16 a[238:239], v12 offset:20992
 ds_read_b64_tr_b16 v[76:77], v13 offset:20480
 ds_read_b64_tr_b16 v[78:79], v13 offset:20992
 s_waitcnt vmcnt(20) lgkmcnt(0)
 s_add_u32 m0, s49, 16384
 s_add_u32 s45, s46, 36864
 buffer_load_dwordx4 v8, s[8:11], s45 offen  lds
 s_add_u32 m0, s49, 17408
 s_add_u32 s45, s46, 41472
 buffer_load_dwordx4 v9, s[8:11], s45 offen  lds
 s_add_u32 m0, s49, 18432
 s_add_u32 s45, s46, 46080
 buffer_load_dwordx4 v8, s[8:11], s45 offen  lds
 s_add_u32 m0, s49, 19456
 s_add_u32 s45, s46, 50688
 buffer_load_dwordx4 v9, s[8:11], s45 offen  lds
 ds_read_b64_tr_b16 a[240:241], v10 offset:24576
 ds_read_b64_tr_b16 a[242:243], v10 offset:25088
 ds_read_b64_tr_b16 a[244:245], v11 offset:24576
 ds_read_b64_tr_b16 a[246:247], v11 offset:25088
 ds_read_b64_tr_b16 a[248:249], v12 offset:24576
 ds_read_b64_tr_b16 a[250:251], v12 offset:25088
 ds_read_b64_tr_b16 v[80:81], v13 offset:24576
 ds_read_b64_tr_b16 v[82:83], v13 offset:25088
 s_waitcnt vmcnt(20) lgkmcnt(0)
 s_add_u32 m0, s49, 20480
 s_add_u32 s45, s46, 55296
 buffer_load_dwordx4 v8, s[8:11], s45 offen  lds
 s_add_u32 m0, s49, 21504
 s_add_u32 s45, s46, 59904
 buffer_load_dwordx4 v9, s[8:11], s45 offen  lds
 s_add_u32 m0, s49, 22528
 s_add_u32 s45, s46, 64512
 buffer_load_dwordx4 v8, s[8:11], s45 offen  lds
 s_add_u32 m0, s49, 23552
 s_add_u32 s45, s46, 69120
 buffer_load_dwordx4 v9, s[8:11], s45 offen  lds
 ds_read_b64_tr_b16 a[252:253], v10 offset:28672
 ds_read_b64_tr_b16 a[254:255], v10 offset:29184
 ds_read_b64_tr_b16 v[128:129], v11 offset:28672
 ds_read_b64_tr_b16 v[130:131], v11 offset:29184
 ds_read_b64_tr_b16 v[132:133], v12 offset:28672
 ds_read_b64_tr_b16 v[134:135], v12 offset:29184
 ds_read_b64_tr_b16 v[84:85], v13 offset:28672
 ds_read_b64_tr_b16 v[86:87], v13 offset:29184
 s_waitcnt vmcnt(20) lgkmcnt(0)
 s_add_u32 s46, s44, 7
 s_and_b32 s46, s46, 7
 s_lshl_b32 s45, s4, 3
 s_add_u32 s46, s46, s45
 s_mul_i32 s46, s46, 147456
 s_add_u32 s46, s46, s47
 s_add_u32 m0, s49, 24576
 s_add_u32 s45, s46, 0
 buffer_load_dwordx4 v8, s[8:11], s45 offen  lds
 s_add_u32 m0, s49, 25600
 s_add_u32 s45, s46, 4608
 buffer_load_dwordx4 v9, s[8:11], s45 offen  lds
 s_add_u32 m0, s49, 26624
 s_add_u32 s45, s46, 9216
 buffer_load_dwordx4 v8, s[8:11], s45 offen  lds
 s_add_u32 m0, s49, 27648
 s_add_u32 s45, s46, 13824
 buffer_load_dwordx4 v9, s[8:11], s45 offen  lds
 ds_read_b64_tr_b16 v[136:137], v10 offset:32768
 ds_read_b64_tr_b16 v[138:139], v10 offset:33280
 ds_read_b64_tr_b16 v[140:141], v11 offset:32768
 ds_read_b64_tr_b16 v[142:143], v11 offset:33280
 ds_read_b64_tr_b16 v[144:145], v12 offset:32768
 ds_read_b64_tr_b16 v[146:147], v12 offset:33280
 ds_read_b64_tr_b16 v[88:89], v13 offset:32768
 ds_read_b64_tr_b16 v[90:91], v13 offset:33280
 s_waitcnt vmcnt(20) lgkmcnt(0)
 s_add_u32 m0, s49, 28672
 s_add_u32 s45, s46, 18432
 buffer_load_dwordx4 v8, s[8:11], s45 offen  lds
 s_add_u32 m0, s49, 29696
 s_add_u32 s45, s46, 23040
 buffer_load_dwordx4 v9, s[8:11], s45 offen  lds
 s_add_u32 m0, s49, 30720
 s_add_u32 s45, s46, 27648
 buffer_load_dwordx4 v8, s[8:11], s45 offen  lds
 s_add_u32 m0, s49, 31744
 s_add_u32 s45, s46, 32256
 buffer_load_dwordx4 v9, s[8:11], s45 offen  lds
 ds_read_b64_tr_b16 v[148:149], v10 offset:36864
 ds_read_b64_tr_b16 v[150:151], v10 offset:37376
 ds_read_b64_tr_b16 v[152:153], v11 offset:36864
 ds_read_b64_tr_b16 v[154:155], v11 offset:37376
 ds_read_b64_tr_b16 v[156:157], v12 offset:36864
 ds_read_b64_tr_b16 v[158:159], v12 offset:37376
 ds_read_b64_tr_b16 v[92:93], v13 offset:36864
 ds_read_b64_tr_b16 v[94:95], v13 offset:37376
 s_waitcnt vmcnt(20) lgkmcnt(0)
 s_add_u32 m0, s49, 32768
 s_add_u32 s45, s46, 36864
 buffer_load_dwordx4 v8, s[8:11], s45 offen  lds
 s_add_u32 m0, s49, 33792
 s_add_u32 s45, s46, 41472
 buffer_load_dwordx4 v9, s[8:11], s45 offen  lds
 s_add_u32 m0, s49, 34816
 s_add_u32 s45, s46, 46080
 buffer_load_dwordx4 v8, s[8:11], s45 offen  lds
 s_add_u32 m0, s49, 35840
 s_add_u32 s45, s46, 50688
 buffer_load_dwordx4 v9, s[8:11], s45 offen  lds
 ds_read_b64_tr_b16 v[160:161], v10 offset:8192
 ds_read_b64_tr_b16 v[162:163], v10 offset:8704
 ds_read_b64_tr_b16 v[164:165], v11 offset:8192
 ds_read_b64_tr_b16 v[166:167], v11 offset:8704
 ds_read_b64_tr_b16 v[168:169], v12 offset:8192
 ds_read_b64_tr_b16 v[170:171], v12 offset:8704
 ds_read_b64_tr_b16 v[96:97], v13 offset:8192
 ds_read_b64_tr_b16 v[98:99], v13 offset:8704
 s_waitcnt vmcnt(20) lgkmcnt(0)
 s_add_u32 m0, s49, 36864
 s_add_u32 s45, s46, 55296
 buffer_load_dwordx4 v8, s[8:11], s45 offen  lds
 s_add_u32 m0, s49, 37888
 s_add_u32 s45, s46, 59904
 buffer_load_dwordx4 v9, s[8:11], s45 offen  lds
 s_add_u32 m0, s49, 38912
 s_add_u32 s45, s46, 64512
 buffer_load_dwordx4 v8, s[8:11], s45 offen  lds
 s_add_u32 m0, s49, 39936
 s_add_u32 s45, s46, 69120
 buffer_load_dwordx4 v9, s[8:11], s45 offen  lds
 ds_read_b64_tr_b16 v[172:173], v10 offset:12288
 ds_read_b64_tr_b16 v[174:175], v10 offset:12800
 ds_read_b64_tr_b16 v[176:177], v11 offset:12288
 ds_read_b64_tr_b16 v[178:179], v11 offset:12800
 ds_read_b64_tr_b16 v[180:181], v12 offset:12288
 ds_read_b64_tr_b16 v[182:183], v12 offset:12800
 ds_read_b64_tr_b16 v[100:101], v13 offset:12288
 ds_read_b64_tr_b16 v[102:103], v13 offset:12800
 s_waitcnt vmcnt(20) lgkmcnt(0)
 ds_read_b64_tr_b16 v[184:185], v10 offset:16384
 ds_read_b64_tr_b16 v[186:187], v10 offset:16896
 ds_read_b64_tr_b16 v[188:189], v11 offset:16384
 ds_read_b64_tr_b16 v[190:191], v11 offset:16896
 ds_read_b64_tr_b16 v[192:193], v12 offset:16384
 ds_read_b64_tr_b16 v[194:195], v12 offset:16896
 ds_read_b64_tr_b16 v[104:105], v13 offset:16384
 ds_read_b64_tr_b16 v[106:107], v13 offset:16896
 s_waitcnt vmcnt(16) lgkmcnt(0)
 ds_read_b64_tr_b16 v[196:197], v10 offset:20480
 ds_read_b64_tr_b16 v[198:199], v10 offset:20992
 ds_read_b64_tr_b16 v[200:201], v11 offset:20480
 ds_read_b64_tr_b16 v[202:203], v11 offset:20992
 ds_read_b64_tr_b16 v[204:205], v12 offset:20480
 ds_read_b64_tr_b16 v[206:207], v12 offset:20992
 ds_read_b64_tr_b16 v[108:109], v13 offset:20480
 ds_read_b64_tr_b16 v[110:111], v13 offset:20992
 s_waitcnt vmcnt(12) lgkmcnt(0)
 ds_read_b64_tr_b16 v[208:209], v10 offset:24576
 ds_read_b64_tr_b16 v[210:211], v10 offset:25088
 ds_read_b64_tr_b16 v[212:213], v11 offset:24576
 ds_read_b64_tr_b16 v[214:215], v11 offset:25088
 ds_read_b64_tr_b16 v[216:217], v12 offset:24576
 ds_read_b64_tr_b16 v[218:219], v12 offset:25088
 ds_read_b64_tr_b16 v[112:113], v13 offset:24576
 ds_read_b64_tr_b16 v[114:115], v13 offset:25088
 s_waitcnt vmcnt(8) lgkmcnt(0)
 ds_read_b64_tr_b16 v[220:221], v10 offset:28672
 ds_read_b64_tr_b16 v[222:223], v10 offset:29184
 ds_read_b64_tr_b16 v[224:225], v11 offset:28672
 ds_read_b64_tr_b16 v[226:227], v11 offset:29184
 ds_read_b64_tr_b16 v[228:229], v12 offset:28672
 ds_read_b64_tr_b16 v[230:231], v12 offset:29184
 ds_read_b64_tr_b16 v[116:117], v13 offset:28672
 ds_read_b64_tr_b16 v[118:119], v13 offset:29184
 s_waitcnt vmcnt(4) lgkmcnt(0)
 ds_read_b64_tr_b16 v[232:233], v10 offset:32768
 ds_read_b64_tr_b16 v[234:235], v10 offset:33280
 ds_read_b64_tr_b16 v[236:237], v11 offset:32768
 ds_read_b64_tr_b16 v[238:239], v11 offset:33280
 ds_read_b64_tr_b16 v[240:241], v12 offset:32768
 ds_read_b64_tr_b16 v[242:243], v12 offset:33280
 ds_read_b64_tr_b16 v[120:121], v13 offset:32768
 ds_read_b64_tr_b16 v[122:123], v13 offset:33280
 s_waitcnt vmcnt(0) lgkmcnt(0)
 ds_read_b64_tr_b16 v[244:245], v10 offset:36864
 ds_read_b64_tr_b16 v[246:247], v10 offset:37376
 ds_read_b64_tr_b16 v[248:249], v11 offset:36864
 ds_read_b64_tr_b16 v[250:251], v11 offset:37376
 ds_read_b64_tr_b16 v[252:253], v12 offset:36864
 ds_read_b64_tr_b16 v[254:255], v12 offset:37376
 ds_read_b64_tr_b16 v[124:125], v13 offset:36864
 ds_read_b64_tr_b16 v[126:127], v13 offset:37376
 s_waitcnt lgkmcnt(0)
 ds_write_b128 v5, v[32:35] offset:8192
 ds_write_b128 v5, v[36:39] offset:9216
 ds_write_b128 v5, v[40:43] offset:10240
 ds_write_b128 v5, v[44:47] offset:11264
 ds_write_b128 v5, v[48:51] offset:12288
 ds_write_b128 v5, v[52:55] offset:13312
 ds_write_b128 v5, v[56:59] offset:14336
 ds_write_b128 v5, v[60:63] offset:15360
 ds_write_b128 v5, v[64:67] offset:16384
 ds_write_b128 v5, v[68:71] offset:17408
 ds_write_b128 v5, v[72:75] offset:18432
 ds_write_b128 v5, v[76:79] offset:19456
 ds_write_b128 v5, v[80:83] offset:20480
 ds_write_b128 v5, v[84:87] offset:21504
 ds_write_b128 v5, v[88:91] offset:22528
 ds_write_b128 v5, v[92:95] offset:23552
 ds_write_b128 v5, v[96:99] offset:24576
 ds_write_b128 v5, v[100:103] offset:25600
 ds_write_b128 v5, v[104:107] offset:26624
 ds_write_b128 v5, v[108:111] offset:27648
 ds_write_b128 v5, v[112:115] offset:28672
 ds_write_b128 v5, v[116:119] offset:29696
 ds_write_b128 v5, v[120:123] offset:30720
 ds_write_b128 v5, v[124:127] offset:31744
 s_waitcnt lgkmcnt(0)
 v_lshrrev_b32 v13, 2, v15
 v_and_b32 v14, 3, v15
 s_lshr_b32 s45, s4, 1
 s_mul_i32 s45, s45, 36864
 s_and_b32 s46, s4, 1
 s_lshl_b32 s46, s46, 6
 s_add_u32 s45, s45, s46
 s_add_u32 s37, s37, s45
 v_mul_u32_u24 v6, 2304, v13
 v_lshl_add_u32 v6, v14, 4, v6
 v_lshl_add_u32 v13, v14, 2, v13
 v_and_b32 v13, 15, v13
 v_lshlrev_b32 v13, 4, v13
 s_lshl_b32 s45, s4, 11
 v_lshl_add_u32 v12, v14, 9, v13
 v_add_u32 v12, s45, v12
 v_lshrrev_b32 v13, 5, v15
 v_lshl_add_u32 v13, v13, 2, v15
 v_and_b32 v13, 15, v13
 v_and_or_b32 v13, v15, 48, v13
 v_lshlrev_b32 v13, 4, v13
 v_xor_b32 v14, 0x80, v13
 v_add_u32 v15, s49, v14
 v_add_u32 v14, s49, v13
 v_add_u32 v4, 32768, v12
 v_add_u32 v7, 114688, v12
 s_lshl_b32 s45, s32, 7
 s_add_u32 s37, s37, s45
 s_lshl_b32 s45, s4, 16
 s_add_u32 s36, s36, s45
 s_mov_b32 s42, s33
 s_mov_b32 s43, 0
 s_and_b32 s53, s42, s93
 s_lshl_b32 s53, s53, s91
 s_add_u32 s53, s53, s38
 s_lshr_b32 s51, s42, s90
 s_add_u32 s51, s51, 1
 ds_read_b128 v[16:19], v5 offset:0
 ds_read_b128 v[20:23], v5 offset:1024
Los0_49:
 buffer_load_dword v2, v3, s[20:23], s53 offen sc1
 s_waitcnt vmcnt(0)
 v_cmp_gt_u32 vcc, s51, v2
 s_and_b32 s52, vcc_lo, 0xffff
 s_cbranch_scc0 Los0k_50
 s_sleep 4
 s_sub_u32 s50, s50, 1
 s_cbranch_scc0 Los0_49
 s_endpgm
Los0k_50:
 s_lshl_b32 s48, s42, 18
 s_add_u32 s48, s48, s36
 s_add_u32 s52, s44, 0
 s_and_b32 s52, s52, 7
 s_lshl_b32 s52, s52, 13
 s_add_u32 s46, s48, s52
 s_add_u32 s47, s46, 4096
 buffer_load_dwordx4 v[32:35], v1, s[20:23], s46 offen offset:0 sc1
 buffer_load_dwordx4 v[36:39], v1, s[20:23], s46 offen offset:1024 sc1
 buffer_load_dwordx4 v[40:43], v1, s[20:23], s46 offen offset:2048 sc1
 buffer_load_dwordx4 v[44:47], v1, s[20:23], s46 offen offset:3072 sc1
 buffer_load_dwordx4 v[48:51], v1, s[20:23], s47 offen offset:0 sc1
 buffer_load_dwordx4 v[52:55], v1, s[20:23], s47 offen offset:1024 sc1
 buffer_load_dwordx4 v[56:59], v1, s[20:23], s47 offen offset:2048 sc1
 buffer_load_dwordx4 v[60:63], v1, s[20:23], s47 offen offset:3072 sc1
 s_add_u32 s52, s44, 1
 s_and_b32 s52, s52, 7
 s_lshl_b32 s52, s52, 13
 s_add_u32 s46, s48, s52
 s_add_u32 s47, s46, 4096
 buffer_load_dwordx4 v[64:67], v1, s[20:23], s46 offen offset:0 sc1
 buffer_load_dwordx4 v[68:71], v1, s[20:23], s46 offen offset:1024 sc1
 buffer_load_dwordx4 v[72:75], v1, s[20:23], s46 offen offset:2048 sc1
 buffer_load_dwordx4 v[76:79], v1, s[20:23], s46 offen offset:3072 sc1
 buffer_load_dwordx4 v[80:83], v1, s[20:23], s47 offen offset:0 sc1
 buffer_load_dwordx4 v[84:87], v1, s[20:23], s47 offen offset:1024 sc1
 buffer_load_dwordx4 v[88:91], v1, s[20:23], s47 offen offset:2048 sc1
 buffer_load_dwordx4 v[92:95], v1, s[20:23], s47 offen offset:3072 sc1
 .p2align 3
Losl_51:
 s_waitcnt vmcnt(14) lgkmcnt(1)
 v_mfma_f32_16x16x32_bf16 v[96:99], a[0:3], v[32:35], 0
 s_add_u32 s52, s44, 2
 s_and_b32 s52, s52, 7
 v_mfma_f32_16x16x32_bf16 v[100:103], a[4:7], v[32:35], 0
 s_lshl_b32 s52, s52, 13
 s_add_u32 s46, s48, s52
 v_mfma_f32_16x16x32_bf16 v[104:107], a[8:11], v[32:35], 0
 s_add_u32 s47, s46, 4096
 v_mfma_f32_16x16x32_bf16 v[108:111], v[16:19], v[32:35], 0
 buffer_load_dwordx4 v[32:35], v1, s[20:23], s46 offen offset:0 sc1
 v_mfma_f32_16x16x32_bf16 v[112:115], a[0:3], v[36:39], 0
 ds_read_b128 v[24:27], v5 offset:2048
 v_mfma_f32_16x16x32_bf16 v[116:119], a[4:7], v[36:39], 0
 v_mfma_f32_16x16x32_bf16 v[120:123], a[8:11], v[36:39], 0
 v_mfma_f32_16x16x32_bf16 v[124:127], v[16:19], v[36:39], 0
 buffer_load_dwordx4 v[36:39], v1, s[20:23], s46 offen offset:1024 sc1
 s_waitcnt vmcnt(14) lgkmcnt(1)
 v_mfma_f32_16x16x32_bf16 v[96:99], a[12:15], v[40:43], v[96:99]
 s_mov_b32 s41, s42
 s_add_u32 s43, s43, 1
 v_mfma_f32_16x16x32_bf16 v[100:103], a[16:19], v[40:43], v[100:103]
 s_cmp_lt_u32 s43, s35
 s_cselect_b32 s45, s34, 0
 v_mfma_f32_16x16x32_bf16 v[104:107], a[20:23], v[40:43], v[104:107]
 s_xor_b32 s34, s34, s39
 s_add_u32 s42, s42, s45
 v_mfma_f32_16x16x32_bf16 v[108:111], v[20:23], v[40:43], v[108:111]
 buffer_load_dwordx4 v[40:43], v1, s[20:23], s46 offen offset:2048 sc1
 v_mfma_f32_16x16x32_bf16 v[112:115], a[12:15], v[44:47], v[112:115]
 ds_read_b128 v[28:31], v5 offset:3072
 v_mfma_f32_16x16x32_bf16 v[116:119], a[16:19], v[44:47], v[116:119]
 v_mfma_f32_16x16x32_bf16 v[120:123], a[20:23], v[44:47], v[120:123]
 v_mfma_f32_16x16x32_bf16 v[124:127], v[20:23], v[44:47], v[124:127]
 buffer_load_dwordx4 v[44:47], v1, s[20:23], s46 offen offset:3072 sc1
 s_waitcnt vmcnt(14) lgkmcnt(1)
 v_mfma_f32_16x16x32_bf16 v[96:99], a[24:27], v[48:51], v[96:99]
 s_and_b32 s53, s42, s93
 s_lshl_b32 s53, s53, s91
 v_mfma_f32_16x16x32_bf16 v[100:103], a[28:31], v[48:51], v[100:103]
 s_add_u32 s53, s53, s38
 s_lshr_b32 s51, s42, s90
 v_mfma_f32_16x16x32_bf16 v[104:107], a[32:35], v[48:51], v[104:107]
 s_add_u32 s51, s51, 1
 v_mfma_f32_16x16x32_bf16 v[108:111], v[24:27], v[48:51], v[108:111]
 buffer_load_dwordx4 v[48:51], v1, s[20:23], s47 offen offset:0 sc1
 v_mfma_f32_16x16x32_bf16 v[112:115], a[24:27], v[52:55], v[112:115]
 ds_read_b128 v[16:19], v5 offset:4096
 v_mfma_f32_16x16x32_bf16 v[116:119], a[28:31], v[52:55], v[116:119]
 v_mfma_f32_16x16x32_bf16 v[120:123], a[32:35], v[52:55], v[120:123]
 v_mfma_f32_16x16x32_bf16 v[124:127], v[24:27], v[52:55], v[124:127]
 buffer_load_dwordx4 v[52:55], v1, s[20:23], s47 offen offset:1024 sc1
 s_waitcnt vmcnt(14) lgkmcnt(1)
 v_mfma_f32_16x16x32_bf16 v[96:99], a[36:39], v[56:59], v[96:99]
 s_mul_i32 s54, s41, 73728
 s_add_u32 s54, s54, s37
 v_mfma_f32_16x16x32_bf16 v[100:103], a[40:43], v[56:59], v[100:103]
 v_mfma_f32_16x16x32_bf16 v[104:107], a[44:47], v[56:59], v[104:107]
 v_mfma_f32_16x16x32_bf16 v[108:111], v[28:31], v[56:59], v[108:111]
 buffer_load_dwordx4 v[56:59], v1, s[20:23], s47 offen offset:2048 sc1
 v_mfma_f32_16x16x32_bf16 v[112:115], a[36:39], v[60:63], v[112:115]
 ds_read_b128 v[20:23], v5 offset:5120
 v_mfma_f32_16x16x32_bf16 v[116:119], a[40:43], v[60:63], v[116:119]
 v_mfma_f32_16x16x32_bf16 v[120:123], a[44:47], v[60:63], v[120:123]
 v_mfma_f32_16x16x32_bf16 v[124:127], v[28:31], v[60:63], v[124:127]
 buffer_load_dwordx4 v[60:63], v1, s[20:23], s47 offen offset:3072 sc1
 s_waitcnt vmcnt(14) lgkmcnt(1)
 v_mfma_f32_16x16x32_bf16 v[96:99], a[48:51], v[64:67], v[96:99]
 s_add_u32 s52, s44, 3
 s_and_b32 s52, s52, 7
 v_mfma_f32_16x16x32_bf16 v[100:103], a[52:55], v[64:67], v[100:103]
 s_lshl_b32 s52, s52, 13
 s_add_u32 s46, s48, s52
 v_mfma_f32_16x16x32_bf16 v[104:107], a[56:59], v[64:67], v[104:107]
 s_add_u32 s47, s46, 4096
 v_mfma_f32_16x16x32_bf16 v[108:111], v[16:19], v[64:67], v[108:111]
 buffer_load_dwordx4 v[64:67], v1, s[20:23], s46 offen offset:0 sc1
 v_mfma_f32_16x16x32_bf16 v[112:115], a[48:51], v[68:71], v[112:115]
 ds_read_b128 v[24:27], v5 offset:6144
 v_mfma_f32_16x16x32_bf16 v[116:119], a[52:55], v[68:71], v[116:119]
 v_mfma_f32_16x16x32_bf16 v[120:123], a[56:59], v[68:71], v[120:123]
 v_mfma_f32_16x16x32_bf16 v[124:127], v[16:19], v[68:71], v[124:127]
 buffer_load_dwordx4 v[68:71], v1, s[20:23], s46 offen offset:1024 sc1
 s_waitcnt vmcnt(14) lgkmcnt(1)
 v_mfma_f32_16x16x32_bf16 v[96:99], a[60:63], v[72:75], v[96:99]
 v_mfma_f32_16x16x32_bf16 v[100:103], a[64:67], v[72:75], v[100:103]
 v_mfma_f32_16x16x32_bf16 v[104:107], a[68:71], v[72:75], v[104:107]
 v_mfma_f32_16x16x32_bf16 v[108:111], v[20:23], v[72:75], v[108:111]
 buffer_load_dwordx4 v[72:75], v1, s[20:23], s46 offen offset:2048 sc1
 v_mfma_f32_16x16x32_bf16 v[112:115], a[60:63], v[76:79], v[112:115]
 ds_read_b128 v[28:31], v5 offset:7168
 v_mfma_f32_16x16x32_bf16 v[116:119], a[64:67], v[76:79], v[116:119]
 v_mfma_f32_16x16x32_bf16 v[120:123], a[68:71], v[76:79], v[120:123]
 v_mfma_f32_16x16x32_bf16 v[124:127], v[20:23], v[76:79], v[124:127]
 buffer_load_dwordx4 v[76:79], v1, s[20:23], s46 offen offset:3072 sc1
 s_waitcnt vmcnt(14) lgkmcnt(1)
 v_mfma_f32_16x16x32_bf16 v[96:99], a[72:75], v[80:83], v[96:99]
 v_mfma_f32_16x16x32_bf16 v[100:103], a[76:79], v[80:83], v[100:103]
 v_mfma_f32_16x16x32_bf16 v[104:107], a[80:83], v[80:83], v[104:107]
 v_mfma_f32_16x16x32_bf16 v[108:111], v[24:27], v[80:83], v[108:111]
 buffer_load_dwordx4 v[80:83], v1, s[20:23], s47 offen offset:0 sc1
 v_mfma_f32_16x16x32_bf16 v[112:115], a[72:75], v[84:87], v[112:115]
 ds_read_b128 v[16:19], v5 offset:8192
 v_mfma_f32_16x16x32_bf16 v[116:119], a[76:79], v[84:87], v[116:119]
 v_mfma_f32_16x16x32_bf16 v[120:123], a[80:83], v[84:87], v[120:123]
 v_mfma_f32_16x16x32_bf16 v[124:127], v[24:27], v[84:87], v[124:127]
 buffer_load_dwordx4 v[84:87], v1, s[20:23], s47 offen offset:1024 sc1
 s_waitcnt vmcnt(14) lgkmcnt(1)
 v_mfma_f32_16x16x32_bf16 v[96:99], a[84:87], v[88:91], v[96:99]
 v_mfma_f32_16x16x32_bf16 v[100:103], a[88:91], v[88:91], v[100:103]
 v_mfma_f32_16x16x32_bf16 v[104:107], a[92:95], v[88:91], v[104:107]
 v_mfma_f32_16x16x32_bf16 v[108:111], v[28:31], v[88:91], v[108:111]
 buffer_load_dwordx4 v[88:91], v1, s[20:23], s47 offen offset:2048 sc1
 v_mfma_f32_16x16x32_bf16 v[112:115], a[84:87], v[92:95], v[112:115]
 ds_read_b128 v[20:23], v5 offset:9216
 v_mfma_f32_16x16x32_bf16 v[116:119], a[88:91], v[92:95], v[116:119]
 v_mfma_f32_16x16x32_bf16 v[120:123], a[92:95], v[92:95], v[120:123]
 v_mfma_f32_16x16x32_bf16 v[124:127], v[28:31], v[92:95], v[124:127]
 buffer_load_dwordx4 v[92:95], v1, s[20:23], s47 offen offset:3072 sc1
 s_waitcnt vmcnt(14) lgkmcnt(1)
 v_mfma_f32_16x16x32_bf16 v[96:99], a[96:99], v[32:35], v[96:99]
 s_add_u32 s52, s44, 4
 s_and_b32 s52, s52, 7
 v_mfma_f32_16x16x32_bf16 v[100:103], a[100:103], v[32:35], v[100:103]
 s_lshl_b32 s52, s52, 13
 s_add_u32 s46, s48, s52
 v_mfma_f32_16x16x32_bf16 v[104:107], a[104:107], v[32:35], v[104:107]
 s_add_u32 s47, s46, 4096
 v_mfma_f32_16x16x32_bf16 v[108:111], v[16:19], v[32:35], v[108:111]
 buffer_load_dwordx4 v[32:35], v1, s[20:23], s46 offen offset:0 sc1
 v_mfma_f32_16x16x32_bf16 v[112:115], a[96:99], v[36:39], v[112:115]
 ds_read_b128 v[24:27], v5 offset:10240
 v_mfma_f32_16x16x32_bf16 v[116:119], a[100:103], v[36:39], v[116:119]
 v_mfma_f32_16x16x32_bf16 v[120:123], a[104:107], v[36:39], v[120:123]
 v_mfma_f32_16x16x32_bf16 v[124:127], v[16:19], v[36:39], v[124:127]
 buffer_load_dwordx4 v[36:39], v1, s[20:23], s46 offen offset:1024 sc1
 s_waitcnt vmcnt(14) lgkmcnt(1)
 v_mfma_f32_16x16x32_bf16 v[96:99], a[108:111], v[40:43], v[96:99]
 v_mfma_f32_16x16x32_bf16 v[100:103], a[112:115], v[40:43], v[100:103]
 v_mfma_f32_16x16x32_bf16 v[104:107], a[116:119], v[40:43], v[104:107]
 v_mfma_f32_16x16x32_bf16 v[108:111], v[20:23], v[40:43], v[108:111]
 buffer_load_dwordx4 v[40:43], v1, s[20:23], s46 offen offset:2048 sc1
 v_mfma_f32_16x16x32_bf16 v[112:115], a[108:111], v[44:47], v[112:115]
 ds_read_b128 v[28:31], v5 offset:11264
 v_mfma_f32_16x16x32_bf16 v[116:119], a[112:115], v[44:47], v[116:119]
 v_mfma_f32_16x16x32_bf16 v[120:123], a[116:119], v[44:47], v[120:123]
 v_mfma_f32_16x16x32_bf16 v[124:127], v[20:23], v[44:47], v[124:127]
 buffer_load_dwordx4 v[44:47], v1, s[20:23], s46 offen offset:3072 sc1
 s_waitcnt vmcnt(14) lgkmcnt(1)
 v_mfma_f32_16x16x32_bf16 v[96:99], a[120:123], v[48:51], v[96:99]
 s_barrier
 v_mfma_f32_16x16x32_bf16 v[100:103], a[124:127], v[48:51], v[100:103]
 v_mfma_f32_16x16x32_bf16 v[104:107], a[128:131], v[48:51], v[104:107]
 v_mfma_f32_16x16x32_bf16 v[108:111], v[24:27], v[48:51], v[108:111]
 buffer_load_dwordx4 v[48:51], v1, s[20:23], s47 offen offset:0 sc1
 v_mfma_f32_16x16x32_bf16 v[112:115], a[120:123], v[52:55], v[112:115]
 ds_read_b128 v[16:19], v5 offset:12288
 v_mfma_f32_16x16x32_bf16 v[116:119], a[124:127], v[52:55], v[116:119]
 v_mfma_f32_16x16x32_bf16 v[120:123], a[128:131], v[52:55], v[120:123]
 v_mfma_f32_16x16x32_bf16 v[124:127], v[24:27], v[52:55], v[124:127]
 buffer_load_dwordx4 v[52:55], v1, s[20:23], s47 offen offset:1024 sc1
 s_waitcnt vmcnt(14) lgkmcnt(1)
 v_mfma_f32_16x16x32_bf16 v[96:99], a[132:135], v[56:59], v[96:99]
 v_mfma_f32_16x16x32_bf16 v[100:103], a[136:139], v[56:59], v[100:103]
 v_mfma_f32_16x16x32_bf16 v[104:107], a[140:143], v[56:59], v[104:107]
 v_mfma_f32_16x16x32_bf16 v[108:111], v[28:31], v[56:59], v[108:111]
 buffer_load_dwordx4 v[56:59], v1, s[20:23], s47 offen offset:2048 sc1
 v_mfma_f32_16x16x32_bf16 v[112:115], a[132:135], v[60:63], v[112:115]
 ds_read_b128 v[20:23], v5 offset:13312
 v_mfma_f32_16x16x32_bf16 v[116:119], a[136:139], v[60:63], v[116:119]
 v_mfma_f32_16x16x32_bf16 v[120:123], a[140:143], v[60:63], v[120:123]
 v_mfma_f32_16x16x32_bf16 v[124:127], v[28:31], v[60:63], v[124:127]
 buffer_load_dwordx4 v[60:63], v1, s[20:23], s47 offen offset:3072 sc1
 s_waitcnt vmcnt(14) lgkmcnt(1)
 v_mfma_f32_16x16x32_bf16 v[96:99], a[144:147], v[64:67], v[96:99]
 s_add_u32 s52, s44, 5
 s_and_b32 s52, s52, 7
 v_mfma_f32_16x16x32_bf16 v[100:103], a[148:151], v[64:67], v[100:103]
 s_lshl_b32 s52, s52, 13
 s_add_u32 s46, s48, s52
 v_mfma_f32_16x16x32_bf16 v[104:107], a[152:155], v[64:67], v[104:107]
 s_add_u32 s47, s46, 4096
 v_mfma_f32_16x16x32_bf16 v[108:111], v[16:19], v[64:67], v[108:111]
 buffer_load_dwordx4 v[64:67], v1, s[20:23], s46 offen offset:0 sc1
 v_mfma_f32_16x16x32_bf16 v[112:115], a[144:147], v[68:71], v[112:115]
 ds_read_b128 v[24:27], v5 offset:14336
 v_mfma_f32_16x16x32_bf16 v[116:119], a[148:151], v[68:71], v[116:119]
 v_mfma_f32_16x16x32_bf16 v[120:123], a[152:155], v[68:71], v[120:123]
 v_mfma_f32_16x16x32_bf16 v[124:127], v[16:19], v[68:71], v[124:127]
 buffer_load_dwordx4 v[68:71], v1, s[20:23], s46 offen offset:1024 sc1
 s_waitcnt vmcnt(14) lgkmcnt(1)
 v_mfma_f32_16x16x32_bf16 v[96:99], a[156:159], v[72:75], v[96:99]
 buffer_load_dword v2, v3, s[20:23], s53 offen sc1
 v_mfma_f32_16x16x32_bf16 v[100:103], a[160:163], v[72:75], v[100:103]
 v_mfma_f32_16x16x32_bf16 v[104:107], a[164:167], v[72:75], v[104:107]
 v_mfma_f32_16x16x32_bf16 v[108:111], v[20:23], v[72:75], v[108:111]
 buffer_load_dwordx4 v[72:75], v1, s[20:23], s46 offen offset:2048 sc1
 v_mfma_f32_16x16x32_bf16 v[112:115], a[156:159], v[76:79], v[112:115]
 ds_read_b128 v[28:31], v5 offset:15360
 v_mfma_f32_16x16x32_bf16 v[116:119], a[160:163], v[76:79], v[116:119]
 v_mfma_f32_16x16x32_bf16 v[120:123], a[164:167], v[76:79], v[120:123]
 v_mfma_f32_16x16x32_bf16 v[124:127], v[20:23], v[76:79], v[124:127]
 buffer_load_dwordx4 v[76:79], v1, s[20:23], s46 offen offset:3072 sc1
 s_waitcnt vmcnt(14) lgkmcnt(1)
 v_mfma_f32_16x16x32_bf16 v[96:99], a[168:171], v[80:83], v[96:99]
 v_mfma_f32_16x16x32_bf16 v[100:103], a[172:175], v[80:83], v[100:103]
 v_mfma_f32_16x16x32_bf16 v[104:107], a[176:179], v[80:83], v[104:107]
 v_mfma_f32_16x16x32_bf16 v[108:111], v[24:27], v[80:83], v[108:111]
 buffer_load_dwordx4 v[80:83], v1, s[20:23], s47 offen offset:0 sc1
 v_mfma_f32_16x16x32_bf16 v[112:115], a[168:171], v[84:87], v[112:115]
 ds_read_b128 v[16:19], v5 offset:16384
 v_mfma_f32_16x16x32_bf16 v[116:119], a[172:175], v[84:87], v[116:119]
 v_mfma_f32_16x16x32_bf16 v[120:123], a[176:179], v[84:87], v[120:123]
 v_mfma_f32_16x16x32_bf16 v[124:127], v[24:27], v[84:87], v[124:127]
 buffer_load_dwordx4 v[84:87], v1, s[20:23], s47 offen offset:1024 sc1
 s_waitcnt vmcnt(14) lgkmcnt(1)
 v_mfma_f32_16x16x32_bf16 v[96:99], a[180:183], v[88:91], v[96:99]
 v_mfma_f32_16x16x32_bf16 v[100:103], a[184:187], v[88:91], v[100:103]
 v_mfma_f32_16x16x32_bf16 v[104:107], a[188:191], v[88:91], v[104:107]
 v_mfma_f32_16x16x32_bf16 v[108:111], v[28:31], v[88:91], v[108:111]
 buffer_load_dwordx4 v[88:91], v1, s[20:23], s47 offen offset:2048 sc1
 v_mfma_f32_16x16x32_bf16 v[112:115], a[180:183], v[92:95], v[112:115]
 ds_read_b128 v[20:23], v5 offset:17408
 v_mfma_f32_16x16x32_bf16 v[116:119], a[184:187], v[92:95], v[116:119]
 v_mfma_f32_16x16x32_bf16 v[120:123], a[188:191], v[92:95], v[120:123]
 v_mfma_f32_16x16x32_bf16 v[124:127], v[28:31], v[92:95], v[124:127]
 buffer_load_dwordx4 v[92:95], v1, s[20:23], s47 offen offset:3072 sc1
 s_waitcnt vmcnt(14) lgkmcnt(1)
 v_mfma_f32_16x16x32_bf16 v[96:99], a[192:195], v[32:35], v[96:99]
 s_add_u32 s52, s44, 6
 s_and_b32 s52, s52, 7
 v_mfma_f32_16x16x32_bf16 v[100:103], a[196:199], v[32:35], v[100:103]
 s_lshl_b32 s52, s52, 13
 s_add_u32 s46, s48, s52
 v_mfma_f32_16x16x32_bf16 v[104:107], a[200:203], v[32:35], v[104:107]
 s_add_u32 s47, s46, 4096
 v_mfma_f32_16x16x32_bf16 v[108:111], v[16:19], v[32:35], v[108:111]
 buffer_load_dwordx4 v[32:35], v1, s[20:23], s46 offen offset:0 sc1
 v_mfma_f32_16x16x32_bf16 v[112:115], a[192:195], v[36:39], v[112:115]
 ds_read_b128 v[24:27], v5 offset:18432
 v_mfma_f32_16x16x32_bf16 v[116:119], a[196:199], v[36:39], v[116:119]
 v_mfma_f32_16x16x32_bf16 v[120:123], a[200:203], v[36:39], v[120:123]
 v_mfma_f32_16x16x32_bf16 v[124:127], v[16:19], v[36:39], v[124:127]
 buffer_load_dwordx4 v[36:39], v1, s[20:23], s46 offen offset:1024 sc1
 s_waitcnt vmcnt(14) lgkmcnt(1)
 v_mfma_f32_16x16x32_bf16 v[96:99], a[204:207], v[40:43], v[96:99]
 v_mfma_f32_16x16x32_bf16 v[100:103], a[208:211], v[40:43], v[100:103]
 v_mfma_f32_16x16x32_bf16 v[104:107], a[212:215], v[40:43], v[104:107]
 v_mfma_f32_16x16x32_bf16 v[108:111], v[20:23], v[40:43], v[108:111]
 buffer_load_dwordx4 v[40:43], v1, s[20:23], s46 offen offset:2048 sc1
 v_mfma_f32_16x16x32_bf16 v[112:115], a[204:207], v[44:47], v[112:115]
 ds_read_b128 v[28:31], v5 offset:19456
 v_mfma_f32_16x16x32_bf16 v[116:119], a[208:211], v[44:47], v[116:119]
 v_mfma_f32_16x16x32_bf16 v[120:123], a[212:215], v[44:47], v[120:123]
 v_mfma_f32_16x16x32_bf16 v[124:127], v[20:23], v[44:47], v[124:127]
 buffer_load_dwordx4 v[44:47], v1, s[20:23], s46 offen offset:3072 sc1
 s_waitcnt vmcnt(14) lgkmcnt(1)
 v_mfma_f32_16x16x32_bf16 v[96:99], a[216:219], v[48:51], v[96:99]
 v_mfma_f32_16x16x32_bf16 v[100:103], a[220:223], v[48:51], v[100:103]
 v_mfma_f32_16x16x32_bf16 v[104:107], a[224:227], v[48:51], v[104:107]
 v_mfma_f32_16x16x32_bf16 v[108:111], v[24:27], v[48:51], v[108:111]
 buffer_load_dwordx4 v[48:51], v1, s[20:23], s47 offen offset:0 sc1
 v_mfma_f32_16x16x32_bf16 v[112:115], a[216:219], v[52:55], v[112:115]
 ds_read_b128 v[16:19], v5 offset:20480
 v_mfma_f32_16x16x32_bf16 v[116:119], a[220:223], v[52:55], v[116:119]
 v_mfma_f32_16x16x32_bf16 v[120:123], a[224:227], v[52:55], v[120:123]
 v_mfma_f32_16x16x32_bf16 v[124:127], v[24:27], v[52:55], v[124:127]
 buffer_load_dwordx4 v[52:55], v1, s[20:23], s47 offen offset:1024 sc1
 s_waitcnt vmcnt(14) lgkmcnt(1)
 v_mfma_f32_16x16x32_bf16 v[96:99], a[228:231], v[56:59], v[96:99]
 v_mfma_f32_16x16x32_bf16 v[100:103], a[232:235], v[56:59], v[100:103]
 v_mfma_f32_16x16x32_bf16 v[104:107], a[236:239], v[56:59], v[104:107]
 v_mfma_f32_16x16x32_bf16 v[108:111], v[28:31], v[56:59], v[108:111]
 buffer_load_dwordx4 v[56:59], v1, s[20:23], s47 offen offset:2048 sc1
 v_mfma_f32_16x16x32_bf16 v[112:115], a[228:231], v[60:63], v[112:115]
 ds_read_b128 v[20:23], v5 offset:21504
 v_mfma_f32_16x16x32_bf16 v[116:119], a[232:235], v[60:63], v[116:119]
 v_mfma_f32_16x16x32_bf16 v[120:123], a[236:239], v[60:63], v[120:123]
 v_mfma_f32_16x16x32_bf16 v[124:127], v[28:31], v[60:63], v[124:127]
 buffer_load_dwordx4 v[60:63], v1, s[20:23], s47 offen offset:3072 sc1
 s_waitcnt vmcnt(14) lgkmcnt(1)
 v_mfma_f32_16x16x32_bf16 v[96:99], a[240:243], v[64:67], v[96:99]
 s_add_u32 s52, s44, 7
 s_and_b32 s52, s52, 7
 v_mfma_f32_16x16x32_bf16 v[100:103], a[244:247], v[64:67], v[100:103]
 s_lshl_b32 s52, s52, 13
 s_add_u32 s46, s48, s52
 v_mfma_f32_16x16x32_bf16 v[104:107], a[248:251], v[64:67], v[104:107]
 s_add_u32 s47, s46, 4096
 v_mfma_f32_16x16x32_bf16 v[108:111], v[16:19], v[64:67], v[108:111]
 buffer_load_dwordx4 v[64:67], v1, s[20:23], s46 offen offset:0 sc1
 v_mfma_f32_16x16x32_bf16 v[112:115], a[240:243], v[68:71], v[112:115]
 ds_read_b128 v[24:27], v5 offset:22528
 v_mfma_f32_16x16x32_bf16 v[116:119], a[244:247], v[68:71], v[116:119]
 v_mfma_f32_16x16x32_bf16 v[120:123], a[248:251], v[68:71], v[120:123]
 v_mfma_f32_16x16x32_bf16 v[124:127], v[16:19], v[68:71], v[124:127]
 buffer_load_dwordx4 v[68:71], v1, s[20:23], s46 offen offset:1024 sc1
 s_waitcnt vmcnt(14) lgkmcnt(1)
 v_mfma_f32_16x16x32_bf16 v[96:99], a[252:255], v[72:75], v[96:99]
 v_mfma_f32_16x16x32_bf16 v[100:103], v[128:131], v[72:75], v[100:103]
 v_mfma_f32_16x16x32_bf16 v[104:107], v[132:135], v[72:75], v[104:107]
 v_mfma_f32_16x16x32_bf16 v[108:111], v[20:23], v[72:75], v[108:111]
 buffer_load_dwordx4 v[72:75], v1, s[20:23], s46 offen offset:2048 sc1
 v_mfma_f32_16x16x32_bf16 v[112:115], a[252:255], v[76:79], v[112:115]
 ds_read_b128 v[28:31], v5 offset:23552
 v_mfma_f32_16x16x32_bf16 v[116:119], v[128:131], v[76:79], v[116:119]
 v_mfma_f32_16x16x32_bf16 v[120:123], v[132:135], v[76:79], v[120:123]
 v_mfma_f32_16x16x32_bf16 v[124:127], v[20:23], v[76:79], v[124:127]
 buffer_load_dwordx4 v[76:79], v1, s[20:23], s46 offen offset:3072 sc1
 s_waitcnt vmcnt(14) lgkmcnt(1)
 v_mfma_f32_16x16x32_bf16 v[96:99], v[136:139], v[80:83], v[96:99]
 v_cmp_gt_u32 vcc, s51, v2
 v_mfma_f32_16x16x32_bf16 v[100:103], v[140:143], v[80:83], v[100:103]
 v_mfma_f32_16x16x32_bf16 v[104:107], v[144:147], v[80:83], v[104:107]
 v_mfma_f32_16x16x32_bf16 v[108:111], v[24:27], v[80:83], v[108:111]
 buffer_load_dwordx4 v[80:83], v1, s[20:23], s47 offen offset:0 sc1
 v_mfma_f32_16x16x32_bf16 v[112:115], v[136:139], v[84:87], v[112:115]
 ds_read_b128 v[16:19], v5 offset:24576
 v_mfma_f32_16x16x32_bf16 v[116:119], v[140:143], v[84:87], v[116:119]
 v_mfma_f32_16x16x32_bf16 v[120:123], v[144:147], v[84:87], v[120:123]
 v_mfma_f32_16x16x32_bf16 v[124:127], v[24:27], v[84:87], v[124:127]
 buffer_load_dwordx4 v[84:87], v1, s[20:23], s47 offen offset:1024 sc1
 s_waitcnt vmcnt(14) lgkmcnt(1)
 v_mfma_f32_16x16x32_bf16 v[96:99], v[148:151], v[88:91], v[96:99]
 s_and_b32 s52, vcc_lo, 0xffff
 s_cbranch_scc1 Losw_52
Loswk_53:
 v_mfma_f32_16x16x32_bf16 v[100:103], v[152:155], v[88:91], v[100:103]
 s_lshl_b32 s48, s42, 18
 s_add_u32 s48, s48, s36
 v_mfma_f32_16x16x32_bf16 v[104:107], v[156:159], v[88:91], v[104:107]
 v_mfma_f32_16x16x32_bf16 v[108:111], v[28:31], v[88:91], v[108:111]
 buffer_load_dwordx4 v[88:91], v1, s[20:23], s47 offen offset:2048 sc1
 v_mfma_f32_16x16x32_bf16 v[112:115], v[148:151], v[92:95], v[112:115]
 ds_read_b128 v[20:23], v5 offset:25600
 v_mfma_f32_16x16x32_bf16 v[116:119], v[152:155], v[92:95], v[116:119]
 v_mfma_f32_16x16x32_bf16 v[120:123], v[156:159], v[92:95], v[120:123]
 v_mfma_f32_16x16x32_bf16 v[124:127], v[28:31], v[92:95], v[124:127]
 buffer_load_dwordx4 v[92:95], v1, s[20:23], s47 offen offset:3072 sc1
 s_waitcnt vmcnt(14) lgkmcnt(1)
 v_mfma_f32_16x16x32_bf16 v[96:99], v[160:163], v[32:35], v[96:99]
 s_add_u32 s52, s44, 0
 s_and_b32 s52, s52, 7
 v_mfma_f32_16x16x32_bf16 v[100:103], v[164:167], v[32:35], v[100:103]
 s_lshl_b32 s52, s52, 13
 s_add_u32 s46, s48, s52
 v_mfma_f32_16x16x32_bf16 v[104:107], v[168:171], v[32:35], v[104:107]
 s_add_u32 s47, s46, 4096
 v_mfma_f32_16x16x32_bf16 v[108:111], v[16:19], v[32:35], v[108:111]
 buffer_load_dwordx4 v[32:35], v1, s[20:23], s46 offen offset:0 sc1
 v_mfma_f32_16x16x32_bf16 v[112:115], v[160:163], v[36:39], v[112:115]
 ds_read_b128 v[24:27], v5 offset:26624
 v_mfma_f32_16x16x32_bf16 v[116:119], v[164:167], v[36:39], v[116:119]
 v_mfma_f32_16x16x32_bf16 v[120:123], v[168:171], v[36:39], v[120:123]
 v_mfma_f32_16x16x32_bf16 v[124:127], v[16:19], v[36:39], v[124:127]
 buffer_load_dwordx4 v[36:39], v1, s[20:23], s46 offen offset:1024 sc1
 s_waitcnt vmcnt(14) lgkmcnt(1)
 v_mfma_f32_16x16x32_bf16 v[96:99], v[172:175], v[40:43], v[96:99]
 v_mfma_f32_16x16x32_bf16 v[100:103], v[176:179], v[40:43], v[100:103]
 v_mfma_f32_16x16x32_bf16 v[104:107], v[180:183], v[40:43], v[104:107]
 v_mfma_f32_16x16x32_bf16 v[108:111], v[20:23], v[40:43], v[108:111]
 buffer_load_dwordx4 v[40:43], v1, s[20:23], s46 offen offset:2048 sc1
 v_mfma_f32_16x16x32_bf16 v[112:115], v[172:175], v[44:47], v[112:115]
 ds_read_b128 v[28:31], v5 offset:27648
 v_mfma_f32_16x16x32_bf16 v[116:119], v[176:179], v[44:47], v[116:119]
 v_mfma_f32_16x16x32_bf16 v[120:123], v[180:183], v[44:47], v[120:123]
 v_mfma_f32_16x16x32_bf16 v[124:127], v[20:23], v[44:47], v[124:127]
 buffer_load_dwordx4 v[44:47], v1, s[20:23], s46 offen offset:3072 sc1
 s_waitcnt vmcnt(14) lgkmcnt(1)
 v_mfma_f32_16x16x32_bf16 v[96:99], v[184:187], v[48:51], v[96:99]
 v_mfma_f32_16x16x32_bf16 v[100:103], v[188:191], v[48:51], v[100:103]
 v_mfma_f32_16x16x32_bf16 v[104:107], v[192:195], v[48:51], v[104:107]
 v_mfma_f32_16x16x32_bf16 v[108:111], v[24:27], v[48:51], v[108:111]
 buffer_load_dwordx4 v[48:51], v1, s[20:23], s47 offen offset:0 sc1
 v_mfma_f32_16x16x32_bf16 v[112:115], v[184:187], v[52:55], v[112:115]
 ds_read_b128 v[16:19], v5 offset:28672
 v_mfma_f32_16x16x32_bf16 v[116:119], v[188:191], v[52:55], v[116:119]
 v_mfma_f32_16x16x32_bf16 v[120:123], v[192:195], v[52:55], v[120:123]
 v_mfma_f32_16x16x32_bf16 v[124:127], v[24:27], v[52:55], v[124:127]
 buffer_load_dwordx4 v[52:55], v1, s[20:23], s47 offen offset:1024 sc1
 s_waitcnt vmcnt(14) lgkmcnt(1)
 v_mfma_f32_16x16x32_bf16 v[96:99], v[196:199], v[56:59], v[96:99]
 v_mfma_f32_16x16x32_bf16 v[100:103], v[200:203], v[56:59], v[100:103]
 v_mfma_f32_16x16x32_bf16 v[104:107], v[204:207], v[56:59], v[104:107]
 v_mfma_f32_16x16x32_bf16 v[108:111], v[28:31], v[56:59], v[108:111]
 buffer_load_dwordx4 v[56:59], v1, s[20:23], s47 offen offset:2048 sc1
 v_mfma_f32_16x16x32_bf16 v[112:115], v[196:199], v[60:63], v[112:115]
 ds_read_b128 v[20:23], v5 offset:29696
 v_mfma_f32_16x16x32_bf16 v[116:119], v[200:203], v[60:63], v[116:119]
 v_mfma_f32_16x16x32_bf16 v[120:123], v[204:207], v[60:63], v[120:123]
 v_mfma_f32_16x16x32_bf16 v[124:127], v[28:31], v[60:63], v[124:127]
 buffer_load_dwordx4 v[60:63], v1, s[20:23], s47 offen offset:3072 sc1
 s_waitcnt vmcnt(14) lgkmcnt(1)
 v_mfma_f32_16x16x32_bf16 v[96:99], v[208:211], v[64:67], v[96:99]
 s_add_u32 s52, s44, 1
 s_and_b32 s52, s52, 7
 v_mfma_f32_16x16x32_bf16 v[100:103], v[212:215], v[64:67], v[100:103]
 s_lshl_b32 s52, s52, 13
 s_add_u32 s46, s48, s52
 v_mfma_f32_16x16x32_bf16 v[104:107], v[216:219], v[64:67], v[104:107]
 s_add_u32 s47, s46, 4096
 v_mfma_f32_16x16x32_bf16 v[108:111], v[16:19], v[64:67], v[108:111]
 buffer_load_dwordx4 v[64:67], v1, s[20:23], s46 offen offset:0 sc1
 v_mfma_f32_16x16x32_bf16 v[112:115], v[208:211], v[68:71], v[112:115]
 ds_read_b128 v[24:27], v5 offset:30720
 v_mfma_f32_16x16x32_bf16 v[116:119], v[212:215], v[68:71], v[116:119]
 v_mfma_f32_16x16x32_bf16 v[120:123], v[216:219], v[68:71], v[120:123]
 v_mfma_f32_16x16x32_bf16 v[124:127], v[16:19], v[68:71], v[124:127]
 buffer_load_dwordx4 v[68:71], v1, s[20:23], s46 offen offset:1024 sc1
 s_waitcnt vmcnt(14) lgkmcnt(1)
 v_mfma_f32_16x16x32_bf16 v[96:99], v[220:223], v[72:75], v[96:99]
 v_mfma_f32_16x16x32_bf16 v[100:103], v[224:227], v[72:75], v[100:103]
 v_mfma_f32_16x16x32_bf16 v[104:107], v[228:231], v[72:75], v[104:107]
 v_mfma_f32_16x16x32_bf16 v[108:111], v[20:23], v[72:75], v[108:111]
 buffer_load_dwordx4 v[72:75], v1, s[20:23], s46 offen offset:2048 sc1
 v_mfma_f32_16x16x32_bf16 v[112:115], v[220:223], v[76:79], v[112:115]
 ds_read_b128 v[28:31], v5 offset:31744
 v_mfma_f32_16x16x32_bf16 v[116:119], v[224:227], v[76:79], v[116:119]
 v_mfma_f32_16x16x32_bf16 v[120:123], v[228:231], v[76:79], v[120:123]
 v_mfma_f32_16x16x32_bf16 v[124:127], v[20:23], v[76:79], v[124:127]
 buffer_load_dwordx4 v[76:79], v1, s[20:23], s46 offen offset:3072 sc1
 s_waitcnt vmcnt(14) lgkmcnt(1)
 v_mfma_f32_16x16x32_bf16 v[96:99], v[232:235], v[80:83], v[96:99]
 v_mfma_f32_16x16x32_bf16 v[100:103], v[236:239], v[80:83], v[100:103]
 v_mfma_f32_16x16x32_bf16 v[104:107], v[240:243], v[80:83], v[104:107]
 v_mfma_f32_16x16x32_bf16 v[108:111], v[24:27], v[80:83], v[108:111]
 buffer_load_dwordx4 v[80:83], v1, s[20:23], s47 offen offset:0 sc1
 v_mfma_f32_16x16x32_bf16 v[112:115], v[232:235], v[84:87], v[112:115]
 ds_read_b128 v[16:19], v5 offset:0
 v_mfma_f32_16x16x32_bf16 v[116:119], v[236:239], v[84:87], v[116:119]
 v_mfma_f32_16x16x32_bf16 v[120:123], v[240:243], v[84:87], v[120:123]
 v_mfma_f32_16x16x32_bf16 v[124:127], v[24:27], v[84:87], v[124:127]
 buffer_load_dwordx4 v[84:87], v1, s[20:23], s47 offen offset:1024 sc1
 s_waitcnt vmcnt(14) lgkmcnt(1)
 v_mfma_f32_16x16x32_bf16 v[96:99], v[244:247], v[88:91], v[96:99]
 v_mfma_f32_16x16x32_bf16 v[100:103], v[248:251], v[88:91], v[100:103]
 v_mfma_f32_16x16x32_bf16 v[104:107], v[252:255], v[88:91], v[104:107]
 v_mfma_f32_16x16x32_bf16 v[108:111], v[28:31], v[88:91], v[108:111]
 buffer_load_dwordx4 v[88:91], v1, s[20:23], s47 offen offset:2048 sc1
 v_mfma_f32_16x16x32_bf16 v[112:115], v[244:247], v[92:95], v[112:115]
 ds_read_b128 v[20:23], v5 offset:1024
 v_mfma_f32_16x16x32_bf16 v[116:119], v[248:251], v[92:95], v[116:119]
 v_mfma_f32_16x16x32_bf16 v[120:123], v[252:255], v[92:95], v[120:123]
 v_mfma_f32_16x16x32_bf16 v[124:127], v[28:31], v[92:95], v[124:127]
 buffer_load_dwordx4 v[92:95], v1, s[20:23], s47 offen offset:3072 sc1
 s_cmp_lt_u32 s43, s35
 ds_write_b128 v14, v[96:99] offset:32768
 ds_write_b128 v15, v[100:103] offset:33792
 ds_write_b128 v14, v[104:107] offset:34816
 ds_write_b128 v15, v[108:111] offset:35840
 ds_write_b128 v14, v[112:115] offset:36864
 ds_write_b128 v15, v[116:119] offset:37888
 ds_write_b128 v14, v[120:123] offset:38912
 ds_write_b128 v15, v[124:127] offset:39936
 s_waitcnt lgkmcnt(0)
 s_barrier
 ds_read_b128 v[96:99], v4 offset:0
 ds_read_b128 v[100:103], v4 offset:256
 ds_read_b128 v[104:107], v4 offset:40960
 ds_read_b128 v[108:111], v4 offset:41216
 ds_read_b128 v[112:115], v7 offset:0
 ds_read_b128 v[116:119], v7 offset:256
 ds_read_b128 v[120:123], v7 offset:40960
 ds_read_b128 v[124:127], v7 offset:41216
 s_waitcnt lgkmcnt(4)
 v_pk_add_f32 v[96:97], v[96:97], v[104:105]
 v_pk_add_f32 v[98:99], v[98:99], v[106:107]
 v_pk_add_f32 v[100:101], v[100:101], v[108:109]
 v_pk_add_f32 v[102:103], v[102:103], v[110:111]
 s_waitcnt lgkmcnt(2)
 v_pk_add_f32 v[96:97], v[96:97], v[112:113]
 v_pk_add_f32 v[98:99], v[98:99], v[114:115]
 v_pk_add_f32 v[100:101], v[100:101], v[116:117]
 v_pk_add_f32 v[102:103], v[102:103], v[118:119]
 s_waitcnt lgkmcnt(0)
 v_pk_add_f32 v[96:97], v[96:97], v[120:121]
 v_pk_add_f32 v[98:99], v[98:99], v[122:123]
 v_pk_add_f32 v[100:101], v[100:101], v[124:125]
 v_pk_add_f32 v[102:103], v[102:103], v[126:127]
 v_cvt_pk_bf16_f32 v8, v96, v97
 v_cvt_pk_bf16_f32 v9, v98, v99
 v_cvt_pk_bf16_f32 v10, v100, v101
 v_cvt_pk_bf16_f32 v11, v102, v103
 buffer_store_dwordx4 v[8:11], v6, s[24:27], s54 offen
 s_cbranch_scc1 Losl_51
 s_branch Lose_54
Losw_52:
 buffer_load_dword v2, v3, s[20:23], s53 offen sc1
 s_waitcnt vmcnt(0)
 v_cmp_gt_u32 vcc, s51, v2
 s_and_b32 s52, vcc_lo, 0xffff
 s_cbranch_scc0 Loswk_53
 s_sleep 4
 s_sub_u32 s50, s50, 1
 s_cbranch_scc0 Losw_52
 s_endpgm
Lose_54:
 s_waitcnt vmcnt(0)
 s_branch Lfin
Lchain:
 s_load_dwordx2 s[8:9], s[0:1], 64
 s_mov_b32 s10, 0x480000
 s_mov_b32 s11, 0x20000
 s_load_dwordx2 s[12:13], s[0:1], 72
 s_mov_b32 s14, 0x480000
 s_mov_b32 s15, 0x20000
 s_load_dwordx2 s[16:17], s[0:1], 80
 s_mov_b32 s18, 0x480000
 s_mov_b32 s19, 0x20000
 s_load_dwordx2 s[24:25], s[0:1], 88
 s_mov_b32 s26, 0x480000
 s_mov_b32 s27, 0x20000
 s_load_dwordx2 s[28:29], s[0:1], 112
 s_mov_b32 s30, 0x100
 s_mov_b32 s31, 0x20000
 s_load_dwordx2 s[32:33], s[0:1], 56
 s_mov_b32 s34, 0x2400
 s_mov_b32 s35, 0x20000
 v_and_b32 v20, 63, v0
 v_lshlrev_b32 v3, 4, v20
 v_mov_b32 v7, 0
 s_mov_b32 s48, 0xcccccccc
 s_mov_b32 s49, 0xcccccccc
 v_mov_b32 v21, 0x44444444
 v_mov_b32 v22, 0xeeeeeeee
 v_cndmask_b32 v5, v21, v22, s[48:49]
 s_lshl_b32 s47, s4, 10
 s_add_u32 s47, s47, 19456
 v_and_b32 v21, 48, v20
 v_lshl_add_u32 v21, v21, 3, s47
 v_and_b32 v22, 8, v20
 v_lshl_add_u32 v21, v22, 2, v21
 v_and_b32 v22, 1, v20
 v_lshl_add_u32 v21, v22, 4, v21
 v_and_b32 v22, 6, v20
 v_lshl_add_u32 v8, v22, 1, v21
 v_and_b32 v21, 32, v20
 v_lshlrev_b32 v21, 5, v21
 v_and_b32 v22, 12, v20
 v_lshl_add_u32 v21, v22, 5, v21
 v_and_b32 v22, 1, v20
 v_lshl_add_u32 v21, v22, 6, v21
 v_and_b32 v22, 16, v20
 v_lshl_add_u32 v21, v22, 1, v21
 v_and_b32 v22, 2, v20
 v_lshl_add_u32 v9, v22, 3, v21
 v_lshrrev_b32 v21, 4, v0
 v_lshlrev_b32 v21, 7, v21
 v_and_b32 v22, 15, v20
 v_lshl_add_u32 v21, v22, 2, v21
 v_add_u32 v10, 17408, v21
 v_and_b32 v22, 1, v20
 v_and_b32 v21, 12, v20
 v_lshlrev_b32 v21, 5, v21
 v_lshl_add_u32 v21, v22, 6, v21
 v_and_b32 v22, 48, v20
 v_add_u32 v11, v21, v22
 s_mov_b32 s55, 0x3e0293ee
 s_mov_b32 s54, 0x40000
 s_lshl_b32 s47, s6, 6
 s_add_u32 s60, s47, 0x100000
 s_add_u32 s61, s47, 0x101000
 s_add_u32 s62, s47, 0x102000
 s_lshl_b32 s47, s6, 7
 s_add_u32 s56, s47, 0x0
 s_add_u32 s57, s47, 0x1000
 s_mul_i32 s47, s6, 10496
 s_add_u32 s40, s47, 0x102000
 s_lshl_b32 s58, s4, 11
 s_add_u32 s47, s47, s58
 s_add_u32 s39, s47, 0x100000
 s_lshl_b32 s42, s4, 11
 s_add_u32 s41, s42, 0x1e0000
 s_mov_b32 s43, 0x1e2000
 s_lshr_b32 s69, s4, 1
 s_lshl_b32 s69, s69, 11
 s_and_b32 s47, s4, 1
 s_lshl_b32 s47, s47, 3
 s_add_u32 s69, s69, s47
 s_lshl_b32 s47, s6, 5
 s_add_u32 s65, s47, 0x1e2000
 s_add_u32 s66, s47, 0x162000
 s_lshr_b32 s47, s6, 3
 s_lshl_b32 s47, s47, 9
 s_and_b32 s58, s6, 1
 s_lshl_b32 s58, s58, 8
 s_add_u32 s47, s47, s58
 s_and_b32 s58, s6, 6
 s_lshl_b32 s58, s58, 5
 s_add_u32 s47, s47, s58
 s_lshl_b32 s58, s4, 11
 s_add_u32 s47, s47, s58
 s_add_u32 s44, s47, 0x1e0000
 s_add_u32 s45, s47, 0x160000
 s_lshl_b32 s47, s6, 14
 s_add_u32 s37, s47, 0x3000000
 s_add_u32 s67, s37, s58
 s_add_u32 s59, s67, 8192
 s_lshl_b32 s47, s6, 12
 s_add_u32 s38, s47, 0x3e0000
 s_mov_b32 s36, 0
 s_mov_b32 s46, 0
 s_waitcnt lgkmcnt(0)
 v_and_b32 v30, 63, v0
 v_bfe_u32 v31, v30, 1, 2
 v_lshrrev_b32 v32, 5, v30
 v_xor_b32 v31, v31, v32
 v_lshlrev_b32 v31, 5, v31
 v_and_b32 v32, 1, v30
 v_lshl_add_u32 v31, v32, 4, v31
 v_xor_b32 v33, 64, v31
 v_lshrrev_b32 v32, 3, v30
 s_lshl_b32 s47, s4, 4
 v_and_b32 v34, 3, v32
 v_lshrrev_b32 v35, 2, v32
 v_lshl_add_u32 v34, v34, 1, v35
 v_add_u32 v34, s47, v34
 v_lshl_add_u32 v12, v34, 13, v31
 v_add_u32 v34, 8, v34
 v_lshl_add_u32 v13, v34, 13, v33
 v_and_b32 v34, 1, v32
 v_lshlrev_b32 v34, 6, v34
 v_and_b32 v35, 6, v32
 s_lshl_b32 s47, s4, 3
 v_add3_u32 v34, v34, v35, s47
 v_lshl_add_u32 v56, v34, 13, v31
 v_mul_u32_u24 v35, 1152, v34
 v_add_u32 v14, v35, v31
 v_add_u32 v34, 1, v34
 v_lshl_add_u32 v57, v34, 13, v33
 v_mul_u32_u24 v35, 1152, v34
 v_add_u32 v15, v35, v33
 v_bfe_u32 v31, v30, 4, 1
 v_bfe_u32 v32, v30, 3, 1
 v_lshl_add_u32 v33, v32, 1, v31
 v_xor_b32 v33, s4, v33
 v_lshlrev_b32 v33, 5, v33
 v_lshl_add_u32 v33, v31, 9, v33
 v_lshl_add_u32 v33, v32, 10, v33
 v_bfe_u32 v31, v30, 2, 1
 v_lshl_add_u32 v33, v31, 7, v33
 v_lshrrev_b32 v31, 5, v30
 v_lshl_add_u32 v33, v31, 11, v33
 v_and_b32 v31, 3, v30
 v_lshl_add_u32 v16, v31, 3, v33
 v_add_u32 v17, 0x10000, v16
 v_add_u32 v18, 0x20000, v16
 v_lshlrev_b32 v60, 4, v0
 v_add_u32 v61, 0x10000, v60
 v_add_u32 v62, 0x20000, v60
 s_lshl_b32 s70, s6, 8
 s_mul_i32 s71, s6, 147456
 s_lshl_b32 s72, s4, 11
 s_lshl_b32 s47, s4, 4
 v_add_u32 v31, s47, v30
 s_lshr_b32 s47, s4, 1
 s_lshl_b32 s47, s47, 5
 v_add_u32 v32, s47, v31
 v_lshrrev_b32 v33, 4, v30
 v_lshlrev_b32 v33, 28, v33
 v_lshl_or_b32 v58, v31, 13, v33
 v_lshl_or_b32 v19, v32, 13, v33
 v_mul_u32_u24 v32, 1152, v32
 v_or_b32 v59, v32, v33
 s_add_u32 m0, s72, 24576
 s_add_u32 s47, s70, 0
 buffer_load_dwordx4 v56, s[8:11], s47 offen  lds
 s_add_u32 m0, s72, 25600
 s_nop 0
 buffer_load_dwordx4 v57, s[8:11], s47 offen  lds
 s_add_u32 m0, s72, 32768
 s_add_u32 s47, s70, 128
 buffer_load_dwordx4 v56, s[8:11], s47 offen  lds
 s_add_u32 m0, s72, 33792
 s_nop 0
 buffer_load_dwordx4 v57, s[8:11], s47 offen  lds
 s_add_u32 m0, s72, 40960
 s_add_u32 s47, s70, 0
 buffer_load_dwordx4 v56, s[12:15], s47 offen  lds
 s_add_u32 m0, s72, 41984
 s_nop 0
 buffer_load_dwordx4 v57, s[12:15], s47 offen  lds
 s_add_u32 m0, s72, 49152
 s_add_u32 s47, s70, 0
 buffer_load_dwordx4 v56, s[16:19], s47 offen  lds
 s_add_u32 m0, s72, 50176
 s_nop 0
 buffer_load_dwordx4 v57, s[16:19], s47 offen  lds
 s_add_u32 m0, s72, 57344
 s_add_u32 s47, s70, 128
 buffer_load_dwordx4 v56, s[16:19], s47 offen  lds
 s_add_u32 m0, s72, 58368
 s_nop 0
 buffer_load_dwordx4 v57, s[16:19], s47 offen  lds
 s_add_u32 m0, s72, 65536
 s_add_u32 s47, s70, 262144
 buffer_load_dwordx4 v56, s[8:11], s47 offen  lds
 s_add_u32 m0, s72, 66560
 s_nop 0
 buffer_load_dwordx4 v57, s[8:11], s47 offen  lds
 s_add_u32 m0, s72, 73728
 s_add_u32 s47, s70, 262272
 buffer_load_dwordx4 v56, s[8:11], s47 offen  lds
 s_add_u32 m0, s72, 74752
 s_nop 0
 buffer_load_dwordx4 v57, s[8:11], s47 offen  lds
 s_add_u32 m0, s72, 81920
 s_add_u32 s47, s70, 262144
 buffer_load_dwordx4 v56, s[12:15], s47 offen  lds
 s_add_u32 m0, s72, 82944
 s_nop 0
 buffer_load_dwordx4 v57, s[12:15], s47 offen  lds
 s_waitcnt vmcnt(14)
 s_waitcnt lgkmcnt(0)
 s_barrier
 s_add_u32 m0, s72, 90112
 s_add_u32 s47, s70, 262144
 buffer_load_dwordx4 v56, s[16:19], s47 offen  lds
 s_add_u32 m0, s72, 91136
 s_nop 0
 buffer_load_dwordx4 v57, s[16:19], s47 offen  lds
 v_mbcnt_lo_u32_b32 v69, -1, 0
 v_min_u32 v69, 1, v69
 v_lshlrev_b32 v69, 28, v69
 buffer_load_dword v68, v69, s[28:31], 0 offen offset:4 sc1
 ds_read_b64_tr_b16 v[72:73], v16 offset:24576
 ds_read_b64_tr_b16 v[74:75], v16 offset:24832
 ds_read_b64_tr_b16 v[76:77], v16 offset:28672
 ds_read_b64_tr_b16 v[78:79], v16 offset:28928
 s_waitcnt vmcnt(15)
 s_waitcnt lgkmcnt(0)
 s_barrier
 s_add_u32 m0, s72, 98304
 s_add_u32 s47, s70, 262272
 buffer_load_dwordx4 v56, s[16:19], s47 offen  lds
 s_add_u32 m0, s72, 99328
 s_nop 0
 buffer_load_dwordx4 v57, s[16:19], s47 offen  lds
 ds_read_b64_tr_b16 v[80:81], v16 offset:32768
 ds_read_b64_tr_b16 v[82:83], v16 offset:33024
 ds_read_b64_tr_b16 v[84:85], v16 offset:36864
 ds_read_b64_tr_b16 v[86:87], v16 offset:37120
 s_waitcnt vmcnt(15)
 s_waitcnt lgkmcnt(0)
 s_barrier
 s_add_u32 m0, s72, 106496
 s_add_u32 s47, s70, 1048576
 buffer_load_dwordx4 v56, s[8:11], s47 offen  lds
 s_add_u32 m0, s72, 107520
 s_nop 0
 buffer_load_dwordx4 v57, s[8:11], s47 offen  lds
 ds_read_b64_tr_b16 v[88:89], v16 offset:40960
 ds_read_b64_tr_b16 v[90:91], v16 offset:41216
 ds_read_b64_tr_b16 v[92:93], v16 offset:45056
 ds_read_b64_tr_b16 v[94:95], v16 offset:45312
 s_waitcnt vmcnt(15)
 s_waitcnt lgkmcnt(0)
 s_barrier
 s_add_u32 m0, s72, 114688
 s_add_u32 s47, s70, 1048704
 buffer_load_dwordx4 v56, s[8:11], s47 offen  lds
 s_add_u32 m0, s72, 115712
 s_nop 0
 buffer_load_dwordx4 v57, s[8:11], s47 offen  lds
 ds_read_b64_tr_b16 v[96:97], v16 offset:49152
 ds_read_b64_tr_b16 v[98:99], v16 offset:49408
 ds_read_b64_tr_b16 v[100:101], v16 offset:53248
 ds_read_b64_tr_b16 v[102:103], v16 offset:53504
 s_waitcnt vmcnt(15)
 s_waitcnt lgkmcnt(0)
 s_barrier
 s_add_u32 m0, s72, 122880
 s_add_u32 s47, s70, 1048576
 buffer_load_dwordx4 v56, s[12:15], s47 offen  lds
 s_add_u32 m0, s72, 123904
 s_nop 0
 buffer_load_dwordx4 v57, s[12:15], s47 offen  lds
 ds_read_b64_tr_b16 v[104:105], v16 offset:57344
 ds_read_b64_tr_b16 v[106:107], v16 offset:57600
 ds_read_b64_tr_b16 v[108:109], v16 offset:61440
 ds_read_b64_tr_b16 v[110:111], v16 offset:61696
 s_waitcnt vmcnt(15)
 s_waitcnt lgkmcnt(0)
 s_barrier
 s_add_u32 m0, s72, 131072
 s_add_u32 s47, s70, 1048576
 buffer_load_dwordx4 v56, s[16:19], s47 offen  lds
 s_add_u32 m0, s72, 132096
 s_nop 0
 buffer_load_dwordx4 v57, s[16:19], s47 offen  lds
 ds_read_b64_tr_b16 v[112:113], v17 offset:0
 ds_read_b64_tr_b16 v[114:115], v17 offset:256
 ds_read_b64_tr_b16 v[116:117], v17 offset:4096
 ds_read_b64_tr_b16 v[118:119], v17 offset:4352
 s_waitcnt vmcnt(15)
 s_waitcnt lgkmcnt(0)
 s_barrier
 s_add_u32 m0, s72, 139264
 s_add_u32 s47, s70, 1048704
 buffer_load_dwordx4 v56, s[16:19], s47 offen  lds
 s_add_u32 m0, s72, 140288
 s_nop 0
 buffer_load_dwordx4 v57, s[16:19], s47 offen  lds
 ds_read_b64_tr_b16 v[120:121], v17 offset:8192
 ds_read_b64_tr_b16 v[122:123], v17 offset:8448
 ds_read_b64_tr_b16 v[124:125], v17 offset:12288
 ds_read_b64_tr_b16 v[126:127], v17 offset:12544
 s_waitcnt vmcnt(15)
 s_waitcnt lgkmcnt(0)
 s_barrier
 s_add_u32 m0, s72, 147456
 s_add_u32 s47, s70, 1310720
 buffer_load_dwordx4 v56, s[8:11], s47 offen  lds
 s_add_u32 m0, s72, 148480
 s_nop 0
 buffer_load_dwordx4 v57, s[8:11], s47 offen  lds
 ds_read_b64_tr_b16 v[128:129], v17 offset:16384
 ds_read_b64_tr_b16 v[130:131], v17 offset:16640
 ds_read_b64_tr_b16 v[132:133], v17 offset:20480
 ds_read_b64_tr_b16 v[134:135], v17 offset:20736
 s_waitcnt vmcnt(15)
 s_waitcnt lgkmcnt(0)
 s_barrier
 s_add_u32 m0, s72, 155648
 s_add_u32 s47, s70, 1310848
 buffer_load_dwordx4 v56, s[8:11], s47 offen  lds
 s_add_u32 m0, s72, 156672
 s_nop 0
 buffer_load_dwordx4 v57, s[8:11], s47 offen  lds
 ds_read_b64_tr_b16 v[136:137], v17 offset:24576
 ds_read_b64_tr_b16 v[138:139], v17 offset:24832
 ds_read_b64_tr_b16 v[140:141], v17 offset:28672
 ds_read_b64_tr_b16 v[142:143], v17 offset:28928
 s_waitcnt vmcnt(14)
 s_waitcnt lgkmcnt(0)
 s_barrier
 s_add_u32 m0, s72, 24576
 s_add_u32 s47, s70, 1310720
 buffer_load_dwordx4 v56, s[12:15], s47 offen  lds
 s_add_u32 m0, s72, 25600
 s_nop 0
 buffer_load_dwordx4 v57, s[12:15], s47 offen  lds
 s_branch Lrhc_56
Lrh_55:
 v_mbcnt_lo_u32_b32 v69, -1, 0
 v_min_u32 v69, 1, v69
 v_lshlrev_b32 v69, 28, v69
 buffer_load_dword v68, v69, s[28:31], 0 offen offset:4 sc1
 s_waitcnt vmcnt(0)
Lrhc_56:
 v_readfirstlane_b32 s89, v68
 s_cmp_eq_u32 s89, s88
 s_cbranch_scc1 Lrhk_57
 s_cmp_lg_u32 s89, 0
 s_cbranch_scc1 Lredo
 s_sub_u32 s95, s95, 1
 s_cbranch_scc0 Lrh_55
 s_endpgm
Lrhk_57:
 v_mov_b32 v20, 0
 v_mov_b32 v21, 0
 v_mov_b32 v22, 0
 v_mov_b32 v23, 0
 v_mov_b32 v27, -1
 v_bfe_u32 v24, v3, 8, 1
 v_bfe_u32 v25, v3, 9, 1
 v_lshl_or_b32 v24, v24, 1, v25
 v_bfe_u32 v25, v3, 5, 1
 v_lshl_or_b32 v24, v24, 1, v25
 v_and_b32 v25, 0xd0, v3
 v_lshlrev_b32 v25, 24, v25
 v_lshl_or_b32 v24, v24, 2, v25
 v_bfe_u32 v26, v3, 8, 2
 v_bfe_u32 v25, v3, 2, 4
 v_lshl_or_b32 v26, v26, 4, v25
 v_and_b32 v25, 0xc0, v3
 v_lshl_or_b32 v26, v25, 24, v26
 buffer_store_dwordx4 v[20:23], v3, s[20:23], s39 offen offset:0 sc1
 buffer_store_dwordx4 v[20:23], v3, s[20:23], s39 offen offset:1024 sc1
 buffer_store_dwordx4 v[20:23], v3, s[20:23], s40 offen offset:0 sc1
 buffer_store_dwordx4 v[20:23], v3, s[20:23], s40 offen offset:1024 sc1
 buffer_store_dword v27, v26, s[20:23], s44 offen sc1
 buffer_store_dword v27, v26, s[20:23], s45 offen sc1
 buffer_store_dword v27, v24, s[20:23], s65 offen sc1
 buffer_store_dword v27, v24, s[20:23], s66 offen sc1
 ds_read_b64_tr_b16 v[144:145], v17 offset:32768
 ds_read_b64_tr_b16 v[146:147], v17 offset:33024
 ds_read_b64_tr_b16 v[148:149], v17 offset:36864
 ds_read_b64_tr_b16 v[150:151], v17 offset:37120
 s_waitcnt vmcnt(22)
 s_waitcnt lgkmcnt(0)
 s_barrier
 s_add_u32 m0, s72, 32768
 s_add_u32 s47, s70, 1310720
 buffer_load_dwordx4 v56, s[16:19], s47 offen  lds
 s_add_u32 m0, s72, 33792
 s_nop 0
 buffer_load_dwordx4 v57, s[16:19], s47 offen  lds
 ds_read_b64_tr_b16 v[152:153], v17 offset:40960
 ds_read_b64_tr_b16 v[154:155], v17 offset:41216
 ds_read_b64_tr_b16 v[156:157], v17 offset:45056
 ds_read_b64_tr_b16 v[158:159], v17 offset:45312
 s_waitcnt vmcnt(22)
 s_waitcnt lgkmcnt(0)
 s_barrier
 s_add_u32 m0, s72, 40960
 s_add_u32 s47, s70, 1310848
 buffer_load_dwordx4 v56, s[16:19], s47 offen  lds
 s_add_u32 m0, s72, 41984
 s_nop 0
 buffer_load_dwordx4 v57, s[16:19], s47 offen  lds
 v_lshrrev_b32 v68, 4, v3
 v_bfe_u32 v69, v68, 2, 2
 v_and_b32 v70, 1, v68
 v_lshl_add_u32 v69, v69, 1, v70
 v_mul_u32_u24 v69, 1152, v69
 v_and_b32 v70, 48, v68
 v_and_b32 v71, 2, v68
 v_lshl_add_u32 v71, v71, 2, v70
 v_lshl_add_u32 v71, v71, 1, v69
 v_add_u32 v69, v70, v69
 s_lshr_b32 s47, s4, 1
 s_lshl_b32 s47, s47, 8
 s_and_b32 s58, s4, 1
 s_lshl_b32 s58, s58, 6
 s_add_u32 s47, s47, s58
 buffer_load_dwordx4 v[20:23], v69, s[32:35], s47 offen offset:0
 buffer_load_dwordx4 v[24:27], v69, s[32:35], s47 offen offset:128
 buffer_load_dwordx4 v[28:31], v69, s[32:35], s47 offen offset:512
 buffer_load_dwordx4 v[32:35], v69, s[32:35], s47 offen offset:640
 buffer_load_dwordx4 v[36:39], v71, s[32:35], 0 offen offset:1024
 ds_read_b64_tr_b16 v[160:161], v17 offset:49152
 ds_read_b64_tr_b16 v[162:163], v17 offset:49408
 ds_read_b64_tr_b16 v[164:165], v17 offset:53248
 ds_read_b64_tr_b16 v[166:167], v17 offset:53504
 s_waitcnt vmcnt(27)
 s_waitcnt lgkmcnt(0)
 s_barrier
 s_add_u32 m0, s72, 49152
 s_add_u32 s47, s70, 2097152
 buffer_load_dwordx4 v56, s[8:11], s47 offen  lds
 s_add_u32 m0, s72, 50176
 s_nop 0
 buffer_load_dwordx4 v57, s[8:11], s47 offen  lds
 ds_read_b64_tr_b16 v[168:169], v17 offset:57344
 ds_read_b64_tr_b16 v[170:171], v17 offset:57600
 ds_read_b64_tr_b16 v[172:173], v17 offset:61440
 ds_read_b64_tr_b16 v[174:175], v17 offset:61696
 s_waitcnt vmcnt(27)
 s_waitcnt lgkmcnt(0)
 s_barrier
 s_add_u32 m0, s72, 57344
 s_add_u32 s47, s70, 2097280
 buffer_load_dwordx4 v56, s[8:11], s47 offen  lds
 s_add_u32 m0, s72, 58368
 s_nop 0
 buffer_load_dwordx4 v57, s[8:11], s47 offen  lds
 ds_read_b64_tr_b16 v[176:177], v18 offset:0
 ds_read_b64_tr_b16 v[178:179], v18 offset:256
 ds_read_b64_tr_b16 v[180:181], v18 offset:4096
 ds_read_b64_tr_b16 v[182:183], v18 offset:4352
 s_waitcnt vmcnt(27)
 s_waitcnt lgkmcnt(0)
 s_barrier
 s_add_u32 m0, s72, 65536
 s_add_u32 s47, s70, 2097152
 buffer_load_dwordx4 v56, s[12:15], s47 offen  lds
 s_add_u32 m0, s72, 66560
 s_nop 0
 buffer_load_dwordx4 v57, s[12:15], s47 offen  lds
 ds_read_b64_tr_b16 v[184:185], v18 offset:8192
 ds_read_b64_tr_b16 v[186:187], v18 offset:8448
 ds_read_b64_tr_b16 v[188:189], v18 offset:12288
 ds_read_b64_tr_b16 v[190:191], v18 offset:12544
 s_waitcnt vmcnt(27)
 s_waitcnt lgkmcnt(0)
 s_barrier
 s_add_u32 m0, s72, 73728
 s_add_u32 s47, s70, 2097152
 buffer_load_dwordx4 v56, s[16:19], s47 offen  lds
 s_add_u32 m0, s72, 74752
 s_nop 0
 buffer_load_dwordx4 v57, s[16:19], s47 offen  lds
 ds_read_b64_tr_b16 v[192:193], v18 offset:16384
 ds_read_b64_tr_b16 v[194:195], v18 offset:16640
 ds_read_b64_tr_b16 v[196:197], v18 offset:20480
 ds_read_b64_tr_b16 v[198:199], v18 offset:20736
 s_waitcnt vmcnt(27)
 s_waitcnt lgkmcnt(0)
 s_barrier
 s_add_u32 m0, s72, 81920
 s_add_u32 s47, s70, 2097280
 buffer_load_dwordx4 v56, s[16:19], s47 offen  lds
 s_add_u32 m0, s72, 82944
 s_nop 0
 buffer_load_dwordx4 v57, s[16:19], s47 offen  lds
 ds_read_b64_tr_b16 v[200:201], v18 offset:24576
 ds_read_b64_tr_b16 v[202:203], v18 offset:24832
 ds_read_b64_tr_b16 v[204:205], v18 offset:28672
 ds_read_b64_tr_b16 v[206:207], v18 offset:28928
 s_waitcnt vmcnt(27)
 s_waitcnt lgkmcnt(0)
 s_barrier
 s_add_u32 m0, s72, 90112
 s_add_u32 s47, s70, 2359296
 buffer_load_dwordx4 v56, s[8:11], s47 offen  lds
 s_add_u32 m0, s72, 91136
 s_nop 0
 buffer_load_dwordx4 v57, s[8:11], s47 offen  lds
 ds_read_b64_tr_b16 v[208:209], v16 offset:24576
 ds_read_b64_tr_b16 v[210:211], v16 offset:24832
 ds_read_b64_tr_b16 v[212:213], v16 offset:28672
 ds_read_b64_tr_b16 v[214:215], v16 offset:28928
 s_waitcnt vmcnt(19)
 s_waitcnt lgkmcnt(0)
 s_barrier
 s_add_u32 m0, s72, 98304
 s_add_u32 s47, s70, 2359424
 buffer_load_dwordx4 v56, s[8:11], s47 offen  lds
 s_add_u32 m0, s72, 99328
 s_nop 0
 buffer_load_dwordx4 v57, s[8:11], s47 offen  lds
 ds_read_b64_tr_b16 v[216:217], v16 offset:32768
 ds_read_b64_tr_b16 v[218:219], v16 offset:33024
 ds_read_b64_tr_b16 v[220:221], v16 offset:36864
 ds_read_b64_tr_b16 v[222:223], v16 offset:37120
 s_waitcnt vmcnt(19)
 s_waitcnt lgkmcnt(0)
 s_barrier
 s_add_u32 m0, s72, 106496
 s_add_u32 s47, s70, 2359296
 buffer_load_dwordx4 v56, s[12:15], s47 offen  lds
 s_add_u32 m0, s72, 107520
 s_nop 0
 buffer_load_dwordx4 v57, s[12:15], s47 offen  lds
 ds_read_b64_tr_b16 v[224:225], v16 offset:40960
 ds_read_b64_tr_b16 v[226:227], v16 offset:41216
 ds_read_b64_tr_b16 v[228:229], v16 offset:45056
 ds_read_b64_tr_b16 v[230:231], v16 offset:45312
 s_waitcnt vmcnt(14)
 s_waitcnt lgkmcnt(0)
 s_barrier
 s_add_u32 m0, s72, 114688
 s_add_u32 s47, s70, 2359296
 buffer_load_dwordx4 v56, s[16:19], s47 offen  lds
 s_add_u32 m0, s72, 115712
 s_nop 0
 buffer_load_dwordx4 v57, s[16:19], s47 offen  lds
 s_getreg_b32 s73, hwreg(HW_REG_XCC_ID, 0, 3)
 s_lshl_b32 s73, s73, 3
 s_lshl_b64 s[74:75], 1, s73
 v_mov_b32 v64, s74
 v_mov_b32 v65, s75
 v_mov_b32 v66, 0x7ff00000
 v_cmp_eq_u32 vcc, 0, v0
 s_nop 1
 v_cndmask_b32 v66, v66, v7, vcc
 buffer_atomic_add_x2 v[64:65], v66, s[28:31], 0 offen offset:8
 ds_read_b64_tr_b16 v[232:233], v16 offset:49152
 ds_read_b64_tr_b16 v[234:235], v16 offset:49408
 ds_read_b64_tr_b16 v[236:237], v16 offset:53248
 ds_read_b64_tr_b16 v[238:239], v16 offset:53504
 s_waitcnt vmcnt(15)
 s_waitcnt lgkmcnt(0)
 s_barrier
 s_add_u32 m0, s72, 122880
 s_add_u32 s47, s70, 2359424
 buffer_load_dwordx4 v56, s[16:19], s47 offen  lds
 s_add_u32 m0, s72, 123904
 s_nop 0
 buffer_load_dwordx4 v57, s[16:19], s47 offen  lds
 v_mov_b32 v68, 0x05040100
 v_mov_b32 v69, 0x07060302
 v_cndmask_b32 v70, v68, v69, s[48:49]
 v_perm_b32 v20, v24, v20, v70
 v_perm_b32 v21, v25, v21, v70
 v_perm_b32 v22, v26, v22, v70
 v_perm_b32 v23, v27, v23, v70
 v_perm_b32 v28, v32, v28, v70
 v_perm_b32 v29, v33, v29, v70
 v_perm_b32 v30, v34, v30, v70
 v_perm_b32 v31, v35, v31, v70
 v_perm_b32 v24, v37, v36, v68
 v_perm_b32 v25, v39, v38, v68
 v_perm_b32 v26, v37, v36, v69
 v_perm_b32 v27, v39, v38, v69
 ds_write_b128 v60, v[20:23]
 ds_write_b128 v60, v[28:31] offset:4096
 ds_write_b128 v3, v[24:27] offset:8192
 ds_read_b64_tr_b16 v[240:241], v16 offset:57344
 ds_read_b64_tr_b16 v[242:243], v16 offset:57600
 ds_read_b64_tr_b16 v[244:245], v16 offset:61440
 ds_read_b64_tr_b16 v[246:247], v16 offset:61696
 s_waitcnt vmcnt(15)
 s_waitcnt lgkmcnt(0)
 s_barrier
 s_add_u32 m0, s72, 131072
 s_add_u32 s47, s70, 3145728
 buffer_load_dwordx4 v56, s[8:11], s47 offen  lds
 s_add_u32 m0, s72, 132096
 s_nop 0
 buffer_load_dwordx4 v57, s[8:11], s47 offen  lds
 ds_read_b64_tr_b16 v[248:249], v17 offset:0
 ds_read_b64_tr_b16 v[250:251], v17 offset:256
 ds_read_b64_tr_b16 v[252:253], v17 offset:4096
 ds_read_b64_tr_b16 v[254:255], v17 offset:4352
 s_waitcnt vmcnt(15)
 s_waitcnt lgkmcnt(0)
 s_barrier
 s_add_u32 m0, s72, 139264
 s_add_u32 s47, s70, 3145856
 buffer_load_dwordx4 v56, s[8:11], s47 offen  lds
 s_add_u32 m0, s72, 140288
 s_nop 0
 buffer_load_dwordx4 v57, s[8:11], s47 offen  lds
 ds_read_b64_tr_b16 a[0:1], v17 offset:8192
 ds_read_b64_tr_b16 a[2:3], v17 offset:8448
 ds_read_b64_tr_b16 a[4:5], v17 offset:12288
 ds_read_b64_tr_b16 a[6:7], v17 offset:12544
 s_waitcnt vmcnt(15)
 s_waitcnt lgkmcnt(0)
 s_barrier
 s_add_u32 m0, s72, 147456
 s_add_u32 s47, s70, 3145728
 buffer_load_dwordx4 v56, s[12:15], s47 offen  lds
 s_add_u32 m0, s72, 148480
 s_nop 0
 buffer_load_dwordx4 v57, s[12:15], s47 offen  lds
 ds_read_b64_tr_b16 a[8:9], v17 offset:16384
 ds_read_b64_tr_b16 a[10:11], v17 offset:16640
 ds_read_b64_tr_b16 a[12:13], v17 offset:20480
 ds_read_b64_tr_b16 a[14:15], v17 offset:20736
 s_waitcnt vmcnt(15)
 s_waitcnt lgkmcnt(0)
 s_barrier
 s_add_u32 m0, s72, 155648
 s_add_u32 s47, s70, 3145728
 buffer_load_dwordx4 v56, s[16:19], s47 offen  lds
 s_add_u32 m0, s72, 156672
 s_nop 0
 buffer_load_dwordx4 v57, s[16:19], s47 offen  lds
 ds_read_b64_tr_b16 a[16:17], v17 offset:24576
 ds_read_b64_tr_b16 a[18:19], v17 offset:24832
 ds_read_b64_tr_b16 a[20:21], v17 offset:28672
 ds_read_b64_tr_b16 a[22:23], v17 offset:28928
 s_waitcnt vmcnt(15)
 s_waitcnt lgkmcnt(0)
 s_barrier
 s_add_u32 m0, s72, 24576
 s_add_u32 s47, s70, 3145856
 buffer_load_dwordx4 v56, s[16:19], s47 offen  lds
 s_add_u32 m0, s72, 25600
 s_nop 0
 buffer_load_dwordx4 v57, s[16:19], s47 offen  lds
 ds_read_b64_tr_b16 a[24:25], v17 offset:32768
 ds_read_b64_tr_b16 a[26:27], v17 offset:33024
 ds_read_b64_tr_b16 a[28:29], v17 offset:36864
 ds_read_b64_tr_b16 a[30:31], v17 offset:37120
 s_waitcnt vmcnt(15)
 s_waitcnt lgkmcnt(0)
 s_barrier
 s_add_u32 m0, s72, 32768
 s_add_u32 s47, s70, 3407872
 buffer_load_dwordx4 v56, s[8:11], s47 offen  lds
 s_add_u32 m0, s72, 33792
 s_nop 0
 buffer_load_dwordx4 v57, s[8:11], s47 offen  lds
 ds_read_b64_tr_b16 a[32:33], v17 offset:40960
 ds_read_b64_tr_b16 a[34:35], v17 offset:41216
 ds_read_b64_tr_b16 a[36:37], v17 offset:45056
 ds_read_b64_tr_b16 a[38:39], v17 offset:45312
 s_waitcnt vmcnt(15)
 s_waitcnt lgkmcnt(0)
 s_barrier
 s_add_u32 m0, s72, 40960
 s_add_u32 s47, s70, 3408000
 buffer_load_dwordx4 v56, s[8:11], s47 offen  lds
 s_add_u32 m0, s72, 41984
 s_nop 0
 buffer_load_dwordx4 v57, s[8:11], s47 offen  lds
 ds_read_b64_tr_b16 a[40:41], v17 offset:49152
 ds_read_b64_tr_b16 a[42:43], v17 offset:49408
 ds_read_b64_tr_b16 a[44:45], v17 offset:53248
 ds_read_b64_tr_b16 a[46:47], v17 offset:53504
 s_waitcnt vmcnt(14)
 s_waitcnt lgkmcnt(0)
 s_barrier
 s_add_u32 m0, s72, 49152
 s_add_u32 s47, s70, 3407872
 buffer_load_dwordx4 v56, s[12:15], s47 offen  lds
 s_add_u32 m0, s72, 50176
 s_nop 0
 buffer_load_dwordx4 v57, s[12:15], s47 offen  lds
 ds_read_b64_tr_b16 a[48:49], v17 offset:57344
 ds_read_b64_tr_b16 a[50:51], v17 offset:57600
 ds_read_b64_tr_b16 a[52:53], v17 offset:61440
 ds_read_b64_tr_b16 a[54:55], v17 offset:61696
 s_waitcnt vmcnt(14)
 s_waitcnt lgkmcnt(0)
 s_barrier
 s_add_u32 m0, s72, 57344
 s_add_u32 s47, s70, 3407872
 buffer_load_dwordx4 v56, s[16:19], s47 offen  lds
 s_add_u32 m0, s72, 58368
 s_nop 0
 buffer_load_dwordx4 v57, s[16:19], s47 offen  lds
 ds_read_b64_tr_b16 a[56:57], v18 offset:0
 ds_read_b64_tr_b16 a[58:59], v18 offset:256
 ds_read_b64_tr_b16 a[60:61], v18 offset:4096
 ds_read_b64_tr_b16 a[62:63], v18 offset:4352
 s_waitcnt vmcnt(14)
 s_waitcnt lgkmcnt(0)
 s_barrier
 s_add_u32 m0, s72, 65536
 s_add_u32 s47, s70, 3408000
 buffer_load_dwordx4 v56, s[16:19], s47 offen  lds
 s_add_u32 m0, s72, 66560
 s_nop 0
 buffer_load_dwordx4 v57, s[16:19], s47 offen  lds
 ds_read_b64_tr_b16 a[64:65], v18 offset:8192
 ds_read_b64_tr_b16 a[66:67], v18 offset:8448
 ds_read_b64_tr_b16 a[68:69], v18 offset:12288
 ds_read_b64_tr_b16 a[70:71], v18 offset:12544
 s_waitcnt vmcnt(14)
 s_waitcnt lgkmcnt(0)
 s_barrier
 s_add_u32 m0, s72, 73728
 s_add_u32 s47, s70, 4194304
 buffer_load_dwordx4 v12, s[8:11], s47 offen  lds
 s_add_u32 m0, s72, 74752
 s_nop 0
 buffer_load_dwordx4 v13, s[8:11], s47 offen  lds
 ds_read_b64_tr_b16 a[72:73], v18 offset:16384
 ds_read_b64_tr_b16 a[74:75], v18 offset:16640
 ds_read_b64_tr_b16 a[76:77], v18 offset:20480
 ds_read_b64_tr_b16 a[78:79], v18 offset:20736
 s_waitcnt vmcnt(14)
 s_waitcnt lgkmcnt(0)
 s_barrier
 s_add_u32 m0, s72, 81920
 s_add_u32 s47, s70, 4194432
 buffer_load_dwordx4 v12, s[8:11], s47 offen  lds
 s_add_u32 m0, s72, 82944
 s_nop 0
 buffer_load_dwordx4 v13, s[8:11], s47 offen  lds
 ds_read_b64_tr_b16 a[80:81], v18 offset:24576
 ds_read_b64_tr_b16 a[82:83], v18 offset:24832
 ds_read_b64_tr_b16 a[84:85], v18 offset:28672
 ds_read_b64_tr_b16 a[86:87], v18 offset:28928
 s_waitcnt vmcnt(14)
 s_waitcnt lgkmcnt(0)
 s_barrier
 s_add_u32 m0, s72, 90112
 s_add_u32 s47, s70, 4194304
 buffer_load_dwordx4 v12, s[12:15], s47 offen  lds
 s_add_u32 m0, s72, 91136
 s_nop 0
 buffer_load_dwordx4 v13, s[12:15], s47 offen  lds
 v_min_u32 v65, 16, v3
 v_lshlrev_b32 v65, 24, v65
 buffer_load_dwordx4 v[68:71], v65, s[28:31], 0 offen sc1
 ds_read_b64_tr_b16 a[88:89], v16 offset:24576
 ds_read_b64_tr_b16 a[90:91], v16 offset:24832
 ds_read_b64_tr_b16 a[92:93], v16 offset:28672
 ds_read_b64_tr_b16 a[94:95], v16 offset:28928
 s_waitcnt vmcnt(15)
 s_waitcnt lgkmcnt(0)
 s_barrier
 s_add_u32 m0, s72, 98304
 s_add_u32 s47, s70, 4194304
 buffer_load_dwordx4 v12, s[16:19], s47 offen  lds
 s_add_u32 m0, s72, 99328
 s_nop 0
 buffer_load_dwordx4 v13, s[16:19], s47 offen  lds
 ds_read_b64_tr_b16 a[96:97], v16 offset:32768
 ds_read_b64_tr_b16 a[98:99], v16 offset:33024
 ds_read_b64_tr_b16 a[100:101], v16 offset:36864
 ds_read_b64_tr_b16 a[102:103], v16 offset:37120
 s_waitcnt vmcnt(15)
 s_waitcnt lgkmcnt(0)
 s_barrier
 s_add_u32 m0, s72, 106496
 s_add_u32 s47, s70, 4194432
 buffer_load_dwordx4 v12, s[16:19], s47 offen  lds
 s_add_u32 m0, s72, 107520
 s_nop 0
 buffer_load_dwordx4 v13, s[16:19], s47 offen  lds
 ds_read_b64_tr_b16 a[104:105], v16 offset:40960
 ds_read_b64_tr_b16 a[106:107], v16 offset:41216
 ds_read_b64_tr_b16 a[108:109], v16 offset:45056
 ds_read_b64_tr_b16 a[110:111], v16 offset:45312
 s_waitcnt vmcnt(15)
 s_waitcnt lgkmcnt(0)
 s_barrier
 s_add_u32 m0, s72, 114688
 s_add_u32 s47, s71, 0
 buffer_load_dwordx4 v14, s[24:27], s47 offen  lds
 s_add_u32 m0, s72, 115712
 s_nop 0
 buffer_load_dwordx4 v15, s[24:27], s47 offen  lds
 ds_read_b64_tr_b16 a[112:113], v16 offset:49152
 ds_read_b64_tr_b16 a[114:115], v16 offset:49408
 ds_read_b64_tr_b16 a[116:117], v16 offset:53248
 ds_read_b64_tr_b16 a[118:119], v16 offset:53504
 s_waitcnt vmcnt(15)
 s_waitcnt lgkmcnt(0)
 s_barrier
 s_add_u32 m0, s72, 122880
 s_add_u32 s47, s71, 128
 buffer_load_dwordx4 v14, s[24:27], s47 offen  lds
 s_add_u32 m0, s72, 123904
 s_nop 0
 buffer_load_dwordx4 v15, s[24:27], s47 offen  lds
 ds_read_b64_tr_b16 a[120:121], v16 offset:57344
 ds_read_b64_tr_b16 a[122:123], v16 offset:57600
 ds_read_b64_tr_b16 a[124:125], v16 offset:61440
 ds_read_b64_tr_b16 a[126:127], v16 offset:61696
 s_waitcnt vmcnt(15)
 s_waitcnt lgkmcnt(0)
 s_barrier
 s_add_u32 m0, s72, 131072
 s_add_u32 s47, s71, 256
 buffer_load_dwordx4 v14, s[24:27], s47 offen  lds
 s_add_u32 m0, s72, 132096
 s_nop 0
 buffer_load_dwordx4 v15, s[24:27], s47 offen  lds
 ds_read_b64_tr_b16 a[128:129], v17 offset:0
 ds_read_b64_tr_b16 a[130:131], v17 offset:256
 ds_read_b64_tr_b16 a[132:133], v17 offset:4096
 ds_read_b64_tr_b16 a[134:135], v17 offset:4352
 s_waitcnt vmcnt(15)
 s_waitcnt lgkmcnt(0)
 s_barrier
 s_add_u32 m0, s72, 139264
 s_add_u32 s47, s71, 384
 buffer_load_dwordx4 v14, s[24:27], s47 offen  lds
 s_add_u32 m0, s72, 140288
 s_nop 0
 buffer_load_dwordx4 v15, s[24:27], s47 offen  lds
 ds_read_b64_tr_b16 a[136:137], v17 offset:8192
 ds_read_b64_tr_b16 a[138:139], v17 offset:8448
 ds_read_b64_tr_b16 a[140:141], v17 offset:12288
 ds_read_b64_tr_b16 a[142:143], v17 offset:12544
 s_waitcnt vmcnt(15)
 s_waitcnt lgkmcnt(0)
 s_barrier
 s_add_u32 m0, s72, 147456
 s_add_u32 s47, s71, 512
 buffer_load_dwordx4 v14, s[24:27], s47 offen  lds
 s_add_u32 m0, s72, 148480
 s_nop 0
 buffer_load_dwordx4 v15, s[24:27], s47 offen  lds
 ds_read_b64_tr_b16 a[144:145], v17 offset:16384
 ds_read_b64_tr_b16 a[146:147], v17 offset:16640
 ds_read_b64_tr_b16 a[148:149], v17 offset:20480
 ds_read_b64_tr_b16 a[150:151], v17 offset:20736
 s_waitcnt vmcnt(15)
 s_waitcnt lgkmcnt(0)
 s_barrier
 s_add_u32 m0, s72, 155648
 s_add_u32 s47, s71, 640
 buffer_load_dwordx4 v14, s[24:27], s47 offen  lds
 s_add_u32 m0, s72, 156672
 s_nop 0
 buffer_load_dwordx4 v15, s[24:27], s47 offen  lds
 ds_read_b64_tr_b16 a[152:153], v17 offset:24576
 ds_read_b64_tr_b16 a[154:155], v17 offset:24832
 ds_read_b64_tr_b16 a[156:157], v17 offset:28672
 ds_read_b64_tr_b16 a[158:159], v17 offset:28928
 s_waitcnt vmcnt(14)
 s_waitcnt lgkmcnt(0)
 s_barrier
 s_add_u32 m0, s72, 24576
 s_add_u32 s47, s71, 768
 buffer_load_dwordx4 v14, s[24:27], s47 offen  lds
 s_add_u32 m0, s72, 25600
 s_nop 0
 buffer_load_dwordx4 v15, s[24:27], s47 offen  lds
 ds_read_b64_tr_b16 a[160:161], v17 offset:32768
 ds_read_b64_tr_b16 a[162:163], v17 offset:33024
 ds_read_b64_tr_b16 a[164:165], v17 offset:36864
 ds_read_b64_tr_b16 a[166:167], v17 offset:37120
 s_waitcnt vmcnt(14)
 s_waitcnt lgkmcnt(0)
 s_barrier
 s_add_u32 m0, s72, 32768
 s_add_u32 s47, s71, 896
 buffer_load_dwordx4 v14, s[24:27], s47 offen  lds
 s_add_u32 m0, s72, 33792
 s_nop 0
 buffer_load_dwordx4 v15, s[24:27], s47 offen  lds
 s_branch Lhsc_60
Lhs_59:
 buffer_load_dwordx4 v[68:71], v65, s[28:31], 0 offen sc1
 s_waitcnt vmcnt(0)
Lhsc_60:
 v_sad_u8 v69, v70, 0, 0
 v_sad_u8 v69, v71, 0, v69
 v_lshrrev_b32 v69, 5, v69
 v_min_u32 v68, v68, v69
 v_cmp_ne_u32 vcc, 0, v68
 s_cbranch_vccnz Lhsok_61
 s_sub_u32 s54, s54, 1
 s_cbranch_scc0 Lhs_59
 s_endpgm
Lhsok_61:
 v_readfirstlane_b32 s74, v70
 v_readfirstlane_b32 s75, v71
 buffer_load_dwordx4 v[20:23], v3, s[20:23], s39 offen offset:0 sc1
 buffer_load_dwordx4 v[20:23], v3, s[20:23], s39 offen offset:1024 sc1
 buffer_load_dwordx4 v[20:23], v3, s[20:23], s40 offen offset:0 sc1
 buffer_load_dwordx4 v[20:23], v3, s[20:23], s40 offen offset:1024 sc1
 v_min_u32 v67, 3, v0
 v_add_u32 v68, 1, v67
 v_and_b32 v68, 4, v68
 v_lshlrev_b32 v68, 26, v68
 v_lshl_or_b32 v68, v67, 7, v68
 s_mul_i32 s47, s6, 384
 s_add_u32 s47, s47, 0x160000
 buffer_load_dword v20, v68, s[20:23], s47 offen sc1
 s_mul_i32 s47, s6, 384
 s_add_u32 s47, s47, 0x1e0000
 buffer_load_dword v20, v68, s[20:23], s47 offen sc1
 v_lshlrev_b32 v67, 6, v0
 ds_read_b64_tr_b16 a[168:169], v17 offset:40960
 ds_read_b64_tr_b16 a[170:171], v17 offset:41216
 ds_read_b64_tr_b16 a[172:173], v17 offset:45056
 ds_read_b64_tr_b16 a[174:175], v17 offset:45312
 s_waitcnt vmcnt(20)
 s_waitcnt lgkmcnt(0)
 s_barrier
 s_add_u32 m0, s72, 40960
 s_add_u32 s47, s71, 37760
 buffer_load_dwordx4 v14, s[24:27], s47 offen  lds
 s_add_u32 m0, s72, 41984
 s_nop 0
 buffer_load_dwordx4 v15, s[24:27], s47 offen  lds
 ds_read_b64_tr_b16 a[176:177], v17 offset:49152
 ds_read_b64_tr_b16 a[178:179], v17 offset:49408
 ds_read_b64_tr_b16 a[180:181], v17 offset:53248
 ds_read_b64_tr_b16 a[182:183], v17 offset:53504
 s_waitcnt vmcnt(20)
 s_waitcnt lgkmcnt(0)
 s_barrier
 s_add_u32 m0, s72, 49152
 s_add_u32 s47, s71, 1024
 buffer_load_dwordx4 v14, s[24:27], s47 offen  lds
 s_add_u32 m0, s72, 50176
 s_nop 0
 buffer_load_dwordx4 v15, s[24:27], s47 offen  lds
 ds_read_b64_tr_b16 a[184:185], v17 offset:57344
 ds_read_b64_tr_b16 a[186:187], v17 offset:57600
 ds_read_b64_tr_b16 a[188:189], v17 offset:61440
 ds_read_b64_tr_b16 a[190:191], v17 offset:61696
 s_waitcnt vmcnt(20)
 s_waitcnt lgkmcnt(0)
 s_barrier
 s_add_u32 m0, s72, 57344
 s_add_u32 s47, s70, 1310848
 buffer_load_dwordx4 v56, s[12:15], s47 offen  lds
 s_add_u32 m0, s72, 58368
 s_nop 0
 buffer_load_dwordx4 v57, s[12:15], s47 offen  lds
 ds_read_b64_tr_b16 a[192:193], v18 offset:0
 ds_read_b64_tr_b16 a[194:195], v18 offset:256
 ds_read_b64_tr_b16 a[196:197], v18 offset:4096
 ds_read_b64_tr_b16 a[198:199], v18 offset:4352
 s_waitcnt vmcnt(20)
 s_waitcnt lgkmcnt(0)
 s_barrier
 s_add_u32 m0, s72, 65536
 s_add_u32 s47, s70, 2097280
 buffer_load_dwordx4 v56, s[12:15], s47 offen  lds
 s_add_u32 m0, s72, 66560
 s_nop 0
 buffer_load_dwordx4 v57, s[12:15], s47 offen  lds
 s_lshl_b32 s47, s6, 2
 s_add_u32 s47, s47, 0x4000
 v_mov_b32 v64, 1
 buffer_store_dword v64, v66, s[20:23], s47 offen
 ds_read_b64_tr_b16 a[200:201], v18 offset:8192
 ds_read_b64_tr_b16 a[202:203], v18 offset:8448
 ds_read_b64_tr_b16 a[204:205], v18 offset:12288
 ds_read_b64_tr_b16 a[206:207], v18 offset:12544
 s_waitcnt vmcnt(21)
 s_waitcnt lgkmcnt(0)
 s_barrier
 s_add_u32 m0, s72, 73728
 s_add_u32 s47, s70, 2359424
 buffer_load_dwordx4 v56, s[12:15], s47 offen  lds
 s_add_u32 m0, s72, 74752
 s_nop 0
 buffer_load_dwordx4 v57, s[12:15], s47 offen  lds
 ds_read_b64_tr_b16 a[208:209], v18 offset:16384
 ds_read_b64_tr_b16 a[210:211], v18 offset:16640
 ds_read_b64_tr_b16 a[212:213], v18 offset:20480
 ds_read_b64_tr_b16 a[214:215], v18 offset:20736
 s_waitcnt vmcnt(21)
 s_waitcnt lgkmcnt(0)
 s_barrier
 s_add_u32 m0, s72, 81920
 s_add_u32 s47, s70, 3145856
 buffer_load_dwordx4 v56, s[12:15], s47 offen  lds
 s_add_u32 m0, s72, 82944
 s_nop 0
 buffer_load_dwordx4 v57, s[12:15], s47 offen  lds
 ds_read_b64_tr_b16 a[216:217], v18 offset:24576
 ds_read_b64_tr_b16 a[218:219], v18 offset:24832
 ds_read_b64_tr_b16 a[220:221], v18 offset:28672
 ds_read_b64_tr_b16 a[222:223], v18 offset:28928
 s_waitcnt vmcnt(21)
 s_waitcnt lgkmcnt(0)
 s_barrier
 s_add_u32 m0, s72, 90112
 s_add_u32 s47, s70, 3408000
 buffer_load_dwordx4 v56, s[12:15], s47 offen  lds
 s_add_u32 m0, s72, 91136
 s_nop 0
 buffer_load_dwordx4 v57, s[12:15], s47 offen  lds
 ds_read_b64_tr_b16 a[224:225], v16 offset:24576
 ds_read_b64_tr_b16 a[226:227], v16 offset:24832
 ds_read_b64_tr_b16 a[228:229], v16 offset:28672
 ds_read_b64_tr_b16 a[230:231], v16 offset:28928
 s_waitcnt vmcnt(21)
 s_waitcnt lgkmcnt(0)
 s_barrier
 s_add_u32 m0, s72, 98304
 s_add_u32 s47, s71, 37888
 buffer_load_dwordx4 v14, s[24:27], s47 offen  lds
 s_add_u32 m0, s72, 99328
 s_nop 0
 buffer_load_dwordx4 v15, s[24:27], s47 offen  lds
 s_and_b32 s47, s6, 29
 s_cbranch_scc1 Lgt_62
 buffer_store_dword v64, v66, s[28:31], 0 offen offset:128 sc1
Lgt_62:
 ds_read_b64_tr_b16 a[232:233], v16 offset:32768
 ds_read_b64_tr_b16 a[234:235], v16 offset:33024
 ds_read_b64_tr_b16 a[236:237], v16 offset:36864
 ds_read_b64_tr_b16 a[238:239], v16 offset:37120
 s_waitcnt vmcnt(15)
 s_waitcnt lgkmcnt(0)
 s_barrier
 s_add_u32 m0, s72, 106496
 s_add_u32 s47, s71, 36864
 buffer_load_dwordx4 v14, s[24:27], s47 offen  lds
 s_add_u32 m0, s72, 107520
 s_nop 0
 buffer_load_dwordx4 v15, s[24:27], s47 offen  lds
 ds_read_b64_tr_b16 a[240:241], v16 offset:40960
 ds_read_b64_tr_b16 a[242:243], v16 offset:41216
 ds_read_b64_tr_b16 a[244:245], v16 offset:45056
 ds_read_b64_tr_b16 a[246:247], v16 offset:45312
 s_waitcnt vmcnt(15)
 s_waitcnt lgkmcnt(0)
 s_barrier
 s_add_u32 m0, s72, 114688
 s_add_u32 s47, s71, 36992
 buffer_load_dwordx4 v14, s[24:27], s47 offen  lds
 s_add_u32 m0, s72, 115712
 s_nop 0
 buffer_load_dwordx4 v15, s[24:27], s47 offen  lds
 ds_read_b64_tr_b16 a[248:249], v16 offset:49152
 ds_read_b64_tr_b16 a[250:251], v16 offset:49408
 ds_read_b64_tr_b16 a[252:253], v16 offset:53248
 ds_read_b64_tr_b16 a[254:255], v16 offset:53504
 s_waitcnt vmcnt(15)
 s_waitcnt lgkmcnt(0)
 s_barrier
 s_add_u32 m0, s72, 122880
 s_add_u32 s47, s71, 37120
 buffer_load_dwordx4 v14, s[24:27], s47 offen  lds
 s_add_u32 m0, s72, 123904
 s_nop 0
 buffer_load_dwordx4 v15, s[24:27], s47 offen  lds
 v_lshrrev_b32 v68, 2, v3
 s_mov_b32 s47, 0x4000
 buffer_load_dword v68, v68, s[20:23], s47 offen sc1
 ds_read_b64_tr_b16 v[48:49], v16 offset:57344
 ds_read_b64_tr_b16 v[50:51], v16 offset:57600
 ds_read_b64_tr_b16 v[52:53], v16 offset:61440
 ds_read_b64_tr_b16 v[54:55], v16 offset:61696
 s_waitcnt vmcnt(16)
 s_waitcnt lgkmcnt(0)
 s_barrier
 s_add_u32 m0, s72, 131072
 s_add_u32 s47, s71, 37248
 buffer_load_dwordx4 v14, s[24:27], s47 offen  lds
 s_add_u32 m0, s72, 132096
 s_nop 0
 buffer_load_dwordx4 v15, s[24:27], s47 offen  lds
 ds_write_b128 v60, v[48:51] offset:57344
 ds_write_b128 v60, v[52:55] offset:61440
 ds_read_b64_tr_b16 v[40:41], v17 offset:0
 ds_read_b64_tr_b16 v[42:43], v17 offset:256
 ds_read_b64_tr_b16 v[44:45], v17 offset:4096
 ds_read_b64_tr_b16 v[46:47], v17 offset:4352
 s_waitcnt vmcnt(15)
 s_waitcnt lgkmcnt(0)
 s_barrier
 s_add_u32 m0, s72, 139264
 s_add_u32 s47, s71, 37376
 buffer_load_dwordx4 v14, s[24:27], s47 offen  lds
 s_add_u32 m0, s72, 140288
 s_nop 0
 buffer_load_dwordx4 v15, s[24:27], s47 offen  lds
 ds_write_b128 v61, v[40:43] offset:0
 ds_write_b128 v61, v[44:47] offset:4096
 ds_read_b64_tr_b16 v[48:49], v17 offset:8192
 ds_read_b64_tr_b16 v[50:51], v17 offset:8448
 ds_read_b64_tr_b16 v[52:53], v17 offset:12288
 ds_read_b64_tr_b16 v[54:55], v17 offset:12544
 s_waitcnt vmcnt(15)
 s_waitcnt lgkmcnt(0)
 s_barrier
 s_add_u32 m0, s72, 147456
 s_add_u32 s47, s71, 37504
 buffer_load_dwordx4 v14, s[24:27], s47 offen  lds
 s_add_u32 m0, s72, 148480
 s_nop 0
 buffer_load_dwordx4 v15, s[24:27], s47 offen  lds
 ds_write_b128 v61, v[48:51] offset:8192
 ds_write_b128 v61, v[52:55] offset:12288
 ds_read_b64_tr_b16 v[40:41], v17 offset:16384
 ds_read_b64_tr_b16 v[42:43], v17 offset:16640
 ds_read_b64_tr_b16 v[44:45], v17 offset:20480
 ds_read_b64_tr_b16 v[46:47], v17 offset:20736
 s_waitcnt vmcnt(15)
 s_waitcnt lgkmcnt(0)
 s_barrier
 s_add_u32 m0, s72, 155648
 s_add_u32 s47, s71, 37632
 buffer_load_dwordx4 v14, s[24:27], s47 offen  lds
 s_add_u32 m0, s72, 156672
 s_nop 0
 buffer_load_dwordx4 v15, s[24:27], s47 offen  lds
 ds_write_b128 v61, v[40:43] offset:16384
 ds_write_b128 v61, v[44:47] offset:20480
 ds_read_b64_tr_b16 v[48:49], v17 offset:24576
 ds_read_b64_tr_b16 v[50:51], v17 offset:24832
 ds_read_b64_tr_b16 v[52:53], v17 offset:28672
 ds_read_b64_tr_b16 v[54:55], v17 offset:28928
 s_waitcnt vmcnt(15)
 s_waitcnt lgkmcnt(0)
 s_barrier
 s_add_u32 m0, s72, 24576
 s_add_u32 s47, s70, 4194432
 buffer_load_dwordx4 v12, s[12:15], s47 offen  lds
 s_add_u32 m0, s72, 25600
 s_nop 0
 buffer_load_dwordx4 v13, s[12:15], s47 offen  lds
 ds_write_b128 v61, v[48:51] offset:24576
 ds_write_b128 v61, v[52:55] offset:28672
 ds_read_b64_tr_b16 v[40:41], v17 offset:32768
 ds_read_b64_tr_b16 v[42:43], v17 offset:33024
 ds_read_b64_tr_b16 v[44:45], v17 offset:36864
 ds_read_b64_tr_b16 v[46:47], v17 offset:37120
 s_waitcnt vmcnt(15)
 s_waitcnt lgkmcnt(0)
 s_barrier
 s_add_u32 m0, s72, 32768
 s_add_u32 s47, s70, 128
 buffer_load_dwordx4 v56, s[12:15], s47 offen  lds
 s_add_u32 m0, s72, 33792
 s_nop 0
 buffer_load_dwordx4 v57, s[12:15], s47 offen  lds
 ds_write_b128 v61, v[40:43] offset:32768
 ds_write_b128 v61, v[44:47] offset:36864
 ds_read_b64_tr_b16 v[48:49], v17 offset:40960
 ds_read_b64_tr_b16 v[50:51], v17 offset:41216
 ds_read_b64_tr_b16 v[52:53], v17 offset:45056
 ds_read_b64_tr_b16 v[54:55], v17 offset:45312
 s_waitcnt vmcnt(15)
 s_waitcnt lgkmcnt(0)
 s_barrier
 s_add_u32 m0, s72, 40960
 s_add_u32 s47, s70, 262272
 buffer_load_dwordx4 v56, s[12:15], s47 offen  lds
 s_add_u32 m0, s72, 41984
 s_nop 0
 buffer_load_dwordx4 v57, s[12:15], s47 offen  lds
 ds_write_b128 v61, v[48:51] offset:40960
 ds_write_b128 v61, v[52:55] offset:45056
 ds_read_b64_tr_b16 v[40:41], v17 offset:49152
 ds_read_b64_tr_b16 v[42:43], v17 offset:49408
 ds_read_b64_tr_b16 v[44:45], v17 offset:53248
 ds_read_b64_tr_b16 v[46:47], v17 offset:53504
 s_waitcnt vmcnt(15)
 s_waitcnt lgkmcnt(0)
 s_barrier
 s_add_u32 m0, s72, 49152
 s_add_u32 s47, s70, 1048704
 buffer_load_dwordx4 v56, s[12:15], s47 offen  lds
 s_add_u32 m0, s72, 50176
 s_nop 0
 buffer_load_dwordx4 v57, s[12:15], s47 offen  lds
 buffer_load_dword v1, v65, s[20:23], s56 offen sc1
 ds_write_b128 v61, v[40:43] offset:49152
 ds_write_b128 v61, v[44:47] offset:53248
 ds_read_b64_tr_b16 v[48:49], v17 offset:57344
 ds_read_b64_tr_b16 v[50:51], v17 offset:57600
 ds_read_b64_tr_b16 v[52:53], v17 offset:61440
 ds_read_b64_tr_b16 v[54:55], v17 offset:61696
 s_waitcnt vmcnt(15)
 s_waitcnt lgkmcnt(0)
 s_barrier
 v_cmp_ne_u32 vcc, 0, v68
 s_mov_b32 s77, vcc_lo
 s_add_u32 s58, s6, 1
 s_and_b32 s58, s58, 31
 s_bitcmp1_b32 s77, s58
 s_cbranch_scc1 Lhlp_63
 s_lshl_b32 s76, s58, 8
 s_mul_i32 s80, s58, 147456
 s_add_u32 s47, s76, 2359424
 buffer_load_dword v63, v19, s[12:15], s47 offen
 s_add_u32 s47, s80, 37888
 buffer_load_dword v63, v59, s[24:27], s47 offen
 s_add_u32 s47, s80, 37120
 buffer_load_dword v63, v59, s[24:27], s47 offen
 s_add_u32 s47, s80, 37504
 buffer_load_dword v63, v59, s[24:27], s47 offen
 s_add_u32 s47, s76, 128
 buffer_load_dword v63, v19, s[12:15], s47 offen
Lhlp_63:
 s_add_u32 s58, s6, 2
 s_and_b32 s58, s58, 31
 s_bitcmp1_b32 s77, s58
 s_cbranch_scc1 Lhlp_64
 s_lshl_b32 s76, s58, 8
 s_mul_i32 s80, s58, 147456
 s_add_u32 s47, s76, 3145856
 buffer_load_dword v63, v19, s[12:15], s47 offen
 s_add_u32 s47, s80, 36864
 buffer_load_dword v63, v59, s[24:27], s47 offen
 s_add_u32 s47, s80, 37248
 buffer_load_dword v63, v59, s[24:27], s47 offen
 s_add_u32 s47, s80, 37632
 buffer_load_dword v63, v59, s[24:27], s47 offen
 s_add_u32 s47, s76, 262272
 buffer_load_dword v63, v19, s[12:15], s47 offen
Lhlp_64:
 s_add_u32 s58, s6, 3
 s_and_b32 s58, s58, 31
 s_bitcmp1_b32 s77, s58
 s_cbranch_scc1 Lhlp_65
 s_lshl_b32 s76, s58, 8
 s_mul_i32 s80, s58, 147456
 s_add_u32 s47, s76, 3408000
 buffer_load_dword v63, v19, s[12:15], s47 offen
 s_add_u32 s47, s80, 36992
 buffer_load_dword v63, v59, s[24:27], s47 offen
 s_add_u32 s47, s80, 37376
 buffer_load_dword v63, v59, s[24:27], s47 offen
 s_add_u32 s47, s76, 4194432
 buffer_load_dword v63, v58, s[12:15], s47 offen
 s_add_u32 s47, s76, 1048704
 buffer_load_dword v63, v19, s[12:15], s47 offen
Lhlp_65:
 ds_write_b128 v61, v[48:51] offset:57344
 ds_write_b128 v61, v[52:55] offset:61440
 ds_read_b64_tr_b16 v[40:41], v18 offset:0
 ds_read_b64_tr_b16 v[42:43], v18 offset:256
 ds_read_b64_tr_b16 v[44:45], v18 offset:4096
 ds_read_b64_tr_b16 v[46:47], v18 offset:4352
 s_waitcnt vmcnt(13)
 s_waitcnt lgkmcnt(0)
 s_barrier
 ds_write_b128 v62, v[40:43] offset:0
 ds_write_b128 v62, v[44:47] offset:4096
 ds_read_b64_tr_b16 v[48:49], v18 offset:8192
 ds_read_b64_tr_b16 v[50:51], v18 offset:8448
 ds_read_b64_tr_b16 v[52:53], v18 offset:12288
 ds_read_b64_tr_b16 v[54:55], v18 offset:12544
 s_waitcnt vmcnt(11)
 s_waitcnt lgkmcnt(0)
 s_barrier
 ds_write_b128 v62, v[48:51] offset:8192
 ds_write_b128 v62, v[52:55] offset:12288
 ds_read_b64_tr_b16 v[40:41], v18 offset:16384
 ds_read_b64_tr_b16 v[42:43], v18 offset:16640
 ds_read_b64_tr_b16 v[44:45], v18 offset:20480
 ds_read_b64_tr_b16 v[46:47], v18 offset:20736
 s_waitcnt vmcnt(9)
 s_waitcnt lgkmcnt(0)
 s_barrier
 ds_write_b128 v62, v[40:43] offset:16384
 ds_write_b128 v62, v[44:47] offset:20480
 ds_read_b64_tr_b16 v[48:49], v18 offset:24576
 ds_read_b64_tr_b16 v[50:51], v18 offset:24832
 ds_read_b64_tr_b16 v[52:53], v18 offset:28672
 ds_read_b64_tr_b16 v[54:55], v18 offset:28928
 s_waitcnt vmcnt(7)
 s_waitcnt lgkmcnt(0)
 s_barrier
 ds_write_b128 v62, v[48:51] offset:24576
 ds_write_b128 v62, v[52:55] offset:28672
 ds_read_b64_tr_b16 v[40:41], v16 offset:24576
 ds_read_b64_tr_b16 v[42:43], v16 offset:24832
 ds_read_b64_tr_b16 v[44:45], v16 offset:28672
 ds_read_b64_tr_b16 v[46:47], v16 offset:28928
 s_waitcnt vmcnt(5)
 s_waitcnt lgkmcnt(0)
 s_barrier
 ds_write_b128 v60, v[40:43] offset:24576
 ds_write_b128 v60, v[44:47] offset:28672
 ds_read_b64_tr_b16 v[48:49], v16 offset:32768
 ds_read_b64_tr_b16 v[50:51], v16 offset:33024
 ds_read_b64_tr_b16 v[52:53], v16 offset:36864
 ds_read_b64_tr_b16 v[54:55], v16 offset:37120
 s_waitcnt vmcnt(3)
 s_waitcnt lgkmcnt(0)
 s_barrier
 ds_write_b128 v60, v[48:51] offset:32768
 ds_write_b128 v60, v[52:55] offset:36864
 ds_read_b64_tr_b16 v[40:41], v16 offset:40960
 ds_read_b64_tr_b16 v[42:43], v16 offset:41216
 ds_read_b64_tr_b16 v[44:45], v16 offset:45056
 ds_read_b64_tr_b16 v[46:47], v16 offset:45312
 s_waitcnt vmcnt(1)
 s_waitcnt lgkmcnt(0)
 s_barrier
 ds_write_b128 v60, v[40:43] offset:40960
 ds_write_b128 v60, v[44:47] offset:45056
 ds_read_b64_tr_b16 v[48:49], v16 offset:49152
 ds_read_b64_tr_b16 v[50:51], v16 offset:49408
 ds_read_b64_tr_b16 v[52:53], v16 offset:53248
 ds_read_b64_tr_b16 v[54:55], v16 offset:53504
 s_waitcnt lgkmcnt(0)
 s_barrier
 ds_write_b128 v60, v[48:51] offset:49152
 ds_write_b128 v60, v[52:55] offset:53248
 v_lshlrev_b32 v0, 4, v0
 s_waitcnt vmcnt(0)
 v_cmp_le_u32 vcc, 2, v1
 s_cbranch_vccnz Lpbk_66
Lpb0_67:
 buffer_load_dword v1, v7, s[20:23], s56 offen sc1
 s_waitcnt vmcnt(0)
 v_cmp_le_u32 vcc, 2, v1
 s_cbranch_vccnz Lpb0ok_68
 s_sub_u32 s54, s54, 1
 s_cbranch_scc0 Lpb0_67
 s_endpgm
Lpb0ok_68:
Lpbk_66:
 s_lshl_b32 s47, s4, 11
 s_add_u32 m0, s47, 9216
 s_add_u32 s68, s37, 0x80000
 buffer_load_dwordx4 v3, s[20:23], s67 offen offset:0 sc1 lds
 buffer_load_dwordx4 v3, s[20:23], s67 offen offset:1024 sc1 lds
 buffer_load_dword v12, v67, s[20:23], s37 offen sc1
 buffer_load_dword v12, v67, s[20:23], s68 offen sc1
 v_mov_b64 v[68:69], 0
 v_mov_b64 v[70:71], 0
 s_add_u32 s68, s68, 0x80000
 s_mov_b32 s24, 0xf000f
 s_mov_b32 s25, 0xf000f
 s_mov_b32 s26, 0xf000f0
 s_mov_b32 s27, 0xf000f0
 s_mov_b32 s28, 0xf000f00
 s_mov_b32 s29, 0xf000f00
 s_mov_b32 s30, 0xf000f000
 s_mov_b32 s31, 0xf000f000
 s_mov_b32 s32, 0xaaaaaaaa
 s_mov_b32 s33, 0xaaaaaaaa
 s_mov_b32 s34, 0x3f803f80
 s_mov_b32 s35, 0x3f803f80
 s_mov_b32 s70, -1
 s_mov_b32 s71, 0
 s_lshl_b32 s47, s4, 12
 s_add_u32 s68, s68, s47
 v_mov_b32 v2, 0
 v_mov_b32 v4, 0
 s_waitcnt lgkmcnt(0)
 ds_read_b128 v[20:23], v0 offset:24576
 ds_read_b128 v[24:27], v0 offset:28672
 ds_read_b128 v[28:31], v0 offset:32768
 ds_read_b128 v[32:35], v0 offset:36864
 v_mov_b64 v[36:37], 0
 v_mov_b64 v[38:39], 0
 v_mov_b64 v[40:41], 0
 v_mov_b64 v[42:43], 0
 v_mov_b64 v[44:45], 0
 v_mov_b64 v[46:47], 0
 v_mov_b64 v[48:49], 0
 v_mov_b64 v[50:51], 0
 v_lshl_add_u32 v1, v3, 3, s68
 v_mov_b32 v6, s56
 v_cndmask_b32 v1, v6, v1, s[70:71]
 v_min_u32 v6, 16, v0
 v_lshlrev_b32 v6, 24, v6
 s_max_u32 s47, s36, 1
 v_add_u32 v2, -1, s47
 s_xor_b32 s44, s44, 0x80000
 s_xor_b32 s45, s45, 0x80000
 s_xor_b32 s65, s65, 0x80000
 s_xor_b32 s66, s66, 0x80000
 s_xor_b32 s41, s41, 0x80000
 s_xor_b32 s43, s43, 0x80000
 s_lshr_b64 s[74:75], s[74:75], s73
 s_and_b32 s74, s74, 0xff
 s_cmp_eq_u32 s74, 32
 s_waitcnt vmcnt(2)
 s_cbranch_scc0 Lslow_69
 .p2align 3
Lstep_71:
 s_mov_b64 exec, -1
 s_waitcnt lgkmcnt(0)
 s_barrier
 ds_read_b128 v[52:55], v3 offset:8192
 ds_read_b128 v[56:59], v3 offset:0
 ds_read_b128 v[60:63], v3 offset:1024
 buffer_store_dwordx4 v[64:67], v0, s[20:23], s38 offen sc1
 s_waitcnt lgkmcnt(2)
 v_smfmac_f32_16x16x64_bf16 v[36:39], v[52:55], a[136:143], v5
 v_smfmac_f32_16x16x64_bf16 v[40:43], v[52:55], a[144:151], v5
 buffer_store_dword v2, v6, s[20:23], s57 offen sc1
 v_smfmac_f32_16x16x64_bf16 v[44:47], v[52:55], a[152:159], v5
 s_waitcnt lgkmcnt(1)
 v_smfmac_f32_16x16x64_bf16 v[48:51], v[52:55], v[20:27], v5
 v_smfmac_f32_16x16x64_bf16 v[36:39], v[56:59], v[72:79], v5
 ds_read_b128 v[20:23], v0 offset:40960
 v_mov_b64 v[64:65], 0
 v_smfmac_f32_16x16x64_bf16 v[40:43], v[56:59], v[80:87], v5
 ds_read_b128 v[24:27], v0 offset:45056
 v_mov_b64 v[66:67], 0
 v_smfmac_f32_16x16x64_bf16 v[44:47], v[56:59], v[88:95], v5
 ds_read_b128 v[52:55], v3 offset:2048
 s_waitcnt lgkmcnt(3)
 v_smfmac_f32_16x16x64_bf16 v[48:51], v[56:59], v[28:35], v5
 v_smfmac_f32_16x16x64_bf16 v[36:39], v[60:63], v[112:119], v5
 ds_read_b128 v[28:31], v0 offset:49152
 v_smfmac_f32_16x16x64_bf16 v[40:43], v[60:63], v[120:127], v5
 ds_read_b128 v[32:35], v0 offset:53248
 v_smfmac_f32_16x16x64_bf16 v[44:47], v[60:63], v[128:135], v5
 ds_read_b128 v[56:59], v3 offset:3072
 v_smfmac_f32_16x16x64_bf16 v[64:67], v[60:63], v[136:143], v5
 v_smfmac_f32_16x16x64_bf16 v[68:71], v[60:63], v[144:151], v5
 s_waitcnt lgkmcnt(3)
 v_smfmac_f32_16x16x64_bf16 v[48:51], v[60:63], v[20:27], v5
 v_smfmac_f32_16x16x64_bf16 v[36:39], v[52:55], v[152:159], v5
 ds_read_b128 v[20:23], v0 offset:57344
 v_smfmac_f32_16x16x64_bf16 v[40:43], v[52:55], v[160:167], v5
 ds_read_b128 v[24:27], v0 offset:61440
 v_smfmac_f32_16x16x64_bf16 v[44:47], v[52:55], v[168:175], v5
 v_smfmac_f32_16x16x64_bf16 v[64:67], v[52:55], v[176:183], v5
 v_smfmac_f32_16x16x64_bf16 v[68:71], v[52:55], v[184:191], v5
 s_waitcnt lgkmcnt(2)
 v_add_u32 v0, 0x10000, v0
 v_smfmac_f32_16x16x64_bf16 v[48:51], v[52:55], v[28:35], v5
 s_branch Ljoin_74
 .p2align 3
LstepB_73:
 s_mov_b64 exec, -1
 buffer_load_dwordx4 v[12:15], v3, s[20:23], s41 offen offset:0 sc1
 buffer_load_dwordx4 v[16:19], v3, s[20:23], s41 offen offset:1024 sc1
 s_waitcnt lgkmcnt(0)
 s_barrier
 ds_read_b128 v[52:55], v3 offset:8192
 ds_read_b128 v[56:59], v3 offset:0
 ds_read_b128 v[60:63], v3 offset:1024
 buffer_store_dwordx4 v[64:67], v0, s[20:23], s38 offen sc1
 s_waitcnt lgkmcnt(2)
 v_smfmac_f32_16x16x64_bf16 v[36:39], v[52:55], a[136:143], v5
 v_smfmac_f32_16x16x64_bf16 v[40:43], v[52:55], a[144:151], v5
 v_smfmac_f32_16x16x64_bf16 v[44:47], v[52:55], a[152:159], v5
 s_waitcnt lgkmcnt(1)
 v_smfmac_f32_16x16x64_bf16 v[48:51], v[52:55], v[20:27], v5
 s_waitcnt vmcnt(3)
 v_smfmac_f32_16x16x64_bf16 v[36:39], v[56:59], v[72:79], v5
 ds_read_b128 v[20:23], v0 offset:40960
 v_mov_b64 v[64:65], 0
 v_smfmac_f32_16x16x64_bf16 v[40:43], v[56:59], v[80:87], v5
 ds_read_b128 v[24:27], v0 offset:45056
 v_mov_b64 v[66:67], 0
 v_smfmac_f32_16x16x64_bf16 v[44:47], v[56:59], v[88:95], v5
 ds_read_b128 v[52:55], v3 offset:2048
 s_waitcnt lgkmcnt(3)
 v_smfmac_f32_16x16x64_bf16 v[48:51], v[56:59], v[28:35], v5
 v_mov_b64 v[68:69], 0
 v_smfmac_f32_16x16x64_bf16 v[36:39], v[60:63], v[112:119], v5
 ds_read_b128 v[28:31], v0 offset:49152
 v_mov_b64 v[70:71], 0
 v_smfmac_f32_16x16x64_bf16 v[40:43], v[60:63], v[120:127], v5
 ds_read_b128 v[32:35], v0 offset:53248
 v_smfmac_f32_16x16x64_bf16 v[44:47], v[60:63], v[128:135], v5
 ds_read_b128 v[56:59], v3 offset:3072
 v_smfmac_f32_16x16x64_bf16 v[64:67], v[60:63], v[136:143], v5
 s_waitcnt vmcnt(1)
 ds_write_b128 v4, v[12:15] offset:0
 v_smfmac_f32_16x16x64_bf16 v[68:71], v[60:63], v[144:151], v5
 s_waitcnt lgkmcnt(4)
 v_smfmac_f32_16x16x64_bf16 v[48:51], v[60:63], v[20:27], v5
 ds_write_b128 v4, v[16:19] offset:1024
 v_max3_u32 v2, v12, v13, v14
 v_smfmac_f32_16x16x64_bf16 v[36:39], v[52:55], v[152:159], v5
 ds_read_b128 v[20:23], v0 offset:57344
 v_max3_u32 v2, v2, v15, v16
 v_smfmac_f32_16x16x64_bf16 v[40:43], v[52:55], v[160:167], v5
 ds_read_b128 v[24:27], v0 offset:61440
 v_max3_u32 v2, v2, v17, v18
 v_smfmac_f32_16x16x64_bf16 v[44:47], v[52:55], v[168:175], v5
 v_max_u32 v2, v2, v19
 v_smfmac_f32_16x16x64_bf16 v[64:67], v[52:55], v[176:183], v5
 v_cmp_eq_u32 vcc, -1, v2
 v_smfmac_f32_16x16x64_bf16 v[68:71], v[52:55], v[184:191], v5
 s_waitcnt lgkmcnt(4)
 v_add_u32 v0, 0x10000, v0
 v_smfmac_f32_16x16x64_bf16 v[48:51], v[52:55], v[28:35], v5
 s_cbranch_vccnz Lyr_75
Lyb_76:
 s_waitcnt lgkmcnt(2)
Ljoin_74:
 v_smfmac_f32_16x16x64_bf16 v[36:39], v[56:59], v[192:199], v5
 ds_read_b128 v[28:31], v0 offset:0
 buffer_load_dwordx4 v[12:15], v3, s[20:23], s59 offen offset:0 sc1
 v_smfmac_f32_16x16x64_bf16 v[40:43], v[56:59], v[200:207], v5
 ds_read_b128 v[32:35], v0 offset:4096
 buffer_load_dwordx4 v[16:19], v3, s[20:23], s59 offen offset:1024 sc1
 v_smfmac_f32_16x16x64_bf16 v[44:47], v[56:59], v[208:215], v5
 s_barrier
 ds_read_b128 v[60:63], v3 offset:4096
 v_smfmac_f32_16x16x64_bf16 v[64:67], v[56:59], v[216:223], v5
 ds_read_b128 v[52:55], v3 offset:5120
 v_smfmac_f32_16x16x64_bf16 v[68:71], v[56:59], v[224:231], v5
 s_waitcnt lgkmcnt(4)
 v_smfmac_f32_16x16x64_bf16 v[48:51], v[56:59], v[20:27], v5
 buffer_load_dword v1, v1, s[20:23], 0 offen sc1
 s_waitcnt lgkmcnt(1)
 v_smfmac_f32_16x16x64_bf16 v[36:39], v[60:63], v[232:239], v5
 ds_read_b128 v[20:23], v0 offset:8192
 v_smfmac_f32_16x16x64_bf16 v[40:43], v[60:63], v[240:247], v5
 ds_read_b128 v[24:27], v0 offset:12288
 v_smfmac_f32_16x16x64_bf16 v[44:47], v[60:63], v[248:255], v5
 ds_read_b128 v[56:59], v3 offset:6144
 s_waitcnt lgkmcnt(3)
 v_smfmac_f32_16x16x64_bf16 v[48:51], v[60:63], v[28:35], v5
 v_smfmac_f32_16x16x64_bf16 v[36:39], v[52:55], a[16:23], v5
 ds_read_b128 v[28:31], v0 offset:16384
 v_smfmac_f32_16x16x64_bf16 v[40:43], v[52:55], a[24:31], v5
 ds_read_b128 v[32:35], v0 offset:20480
 v_smfmac_f32_16x16x64_bf16 v[44:47], v[52:55], a[32:39], v5
 ds_read_b128 v[60:63], v3 offset:7168
 s_waitcnt lgkmcnt(3)
 v_smfmac_f32_16x16x64_bf16 v[48:51], v[52:55], v[20:27], v5
 v_smfmac_f32_16x16x64_bf16 v[36:39], v[56:59], a[56:63], v5
 ds_read_b128 v[20:23], v0 offset:24576
 v_smfmac_f32_16x16x64_bf16 v[40:43], v[56:59], a[64:71], v5
 ds_read_b128 v[24:27], v0 offset:28672
 s_waitcnt lgkmcnt(2)
 v_smfmac_f32_16x16x64_bf16 v[36:39], v[60:63], a[96:103], v5
 v_smfmac_f32_16x16x64_bf16 v[40:43], v[60:63], a[104:111], v5
 v_smfmac_f32_16x16x64_bf16 v[64:67], v[52:55], a[40:47], v5
 s_nop 0
 v_add_f32 v36, v36, v38
 v_smfmac_f32_16x16x64_bf16 v[68:71], v[52:55], a[48:55], v5
 ds_read_b128 v[52:55], v3 offset:8192
 v_add_f32 v37, v37, v39
 v_smfmac_f32_16x16x64_bf16 v[44:47], v[56:59], a[72:79], v5
 v_add_f32 v40, v40, v42
 v_add_f32 v41, v41, v43
 v_smfmac_f32_16x16x64_bf16 v[48:51], v[56:59], v[28:35], v5
 s_waitcnt lgkmcnt(1)
 v_cvt_pk_bf16_f32 v36, v36, v40
 v_smfmac_f32_16x16x64_bf16 v[44:47], v[60:63], a[112:119], v5
 ds_read_b128 v[32:35], v3 offset:11264
 v_cvt_pk_bf16_f32 v37, v37, v41
 v_smfmac_f32_16x16x64_bf16 v[48:51], v[60:63], v[20:27], v5
 ds_write2_b32 v10, v36, v37 offset0:0 offset1:16
 v_smfmac_f32_16x16x64_bf16 v[64:67], v[56:59], a[80:87], v5
 ds_read_b128 v[20:23], v3 offset:9216
 v_add_f32 v44, v44, v46
 v_add_f32 v45, v45, v47
 v_smfmac_f32_16x16x64_bf16 v[68:71], v[56:59], a[88:95], v5
 s_waitcnt lgkmcnt(3)
 v_add_f32 v48, v48, v50
 v_add_f32 v49, v49, v51
 v_cvt_pk_bf16_f32 v44, v44, v48
 v_cvt_pk_bf16_f32 v45, v45, v49
 ds_write2_b32 v8, v44, v45 offset0:0 offset1:16
 v_smfmac_f32_16x16x64_bf16 v[64:67], v[52:55], a[160:167], v5
 ds_read_b128 v[56:59], v3 offset:0
 v_mov_b64 v[28:29], 0
 v_smfmac_f32_16x16x64_bf16 v[68:71], v[52:55], a[168:175], v5
 ds_read_b128 v[52:55], v3 offset:4096
 v_mov_b64 v[30:31], 0
 v_smfmac_f32_16x16x64_bf16 v[64:67], v[60:63], a[120:127], v5
 ds_read_b128 v[24:27], v3 offset:10240
 v_smfmac_f32_16x16x64_bf16 v[68:71], v[60:63], a[128:135], v5
 s_waitcnt lgkmcnt(3)
 s_barrier
 ds_read_b128 v[36:39], v11 offset:17408
 s_waitcnt lgkmcnt(3)
 v_smfmac_f32_16x16x64_bf16 v[64:67], v[56:59], v[96:103], v5
 ds_read_b128 v[40:43], v11 offset:17920
 s_waitcnt lgkmcnt(3)
 v_smfmac_f32_16x16x64_bf16 v[68:71], v[56:59], v[104:111], v5
 ds_read_b128 v[60:63], v9 offset:19456
 ds_read_b128 v[44:47], v11 offset:18432
 v_smfmac_f32_16x16x64_bf16 v[64:67], v[52:55], a[0:7], v5
 ds_read_b128 v[48:51], v11 offset:18944
 v_smfmac_f32_16x16x64_bf16 v[68:71], v[52:55], a[8:15], v5
 ds_read_b128 v[52:55], v3 offset:12288
 s_waitcnt lgkmcnt(5)
 v_mfma_f32_16x16x32_bf16 v[20:23], v[20:23], v[36:39], 0
 ds_read_b128 v[56:59], v9 offset:21504
 v_mfma_f32_16x16x32_bf16 v[24:27], v[24:27], v[36:39], 0
 v_add_f32 v64, v64, v66
 v_add_f32 v65, v65, v67
 s_waitcnt lgkmcnt(5)
 v_mfma_f32_16x16x32_bf16 v[20:23], v[32:35], v[40:43], v[20:23]
 ds_read_b128 v[32:35], v3 offset:13312
 v_cvt_pk_bf16_f32 v2, v64, v65
 v_add_f32 v68, v68, v70
 s_waitcnt lgkmcnt(5)
 v_smfmac_f32_16x16x64_bf16 v[28:31], v[60:63], v[36:43], v5
 ds_read_b128 v[60:63], v3 offset:14336
 ds_read_b128 v[36:39], v3 offset:15360
 v_add_f32 v69, v69, v71
 s_waitcnt lgkmcnt(4)
 v_mfma_f32_16x16x32_bf16 v[24:27], v[52:55], v[40:43], v[24:27]
 ds_read_b128 v[52:55], v3 offset:16384
 v_cvt_pk_bf16_f32 v4, v68, v69
 s_waitcnt lgkmcnt(4)
 v_smfmac_f32_16x16x64_bf16 v[28:31], v[56:59], v[44:51], v5
 ds_read_b128 v[40:43], v0 offset:36864
 s_waitcnt lgkmcnt(4)
 v_mfma_f32_16x16x32_bf16 v[20:23], v[32:35], v[44:47], v[20:23]
 v_mov_b64 v[32:33], s[34:35]
 v_mov_b64 v[34:35], s[34:35]
 s_waitcnt lgkmcnt(3)
 v_mfma_f32_16x16x32_bf16 v[24:27], v[60:63], v[44:47], v[24:27]
 ds_read_b128 v[44:47], v0 offset:40960
 v_add_f32 v28, v28, v30
 v_add_f32 v29, v29, v31
 s_waitcnt lgkmcnt(3)
 v_mfma_f32_16x16x32_bf16 v[20:23], v[36:39], v[48:51], v[20:23]
 ds_read_b128 v[36:39], v0 offset:32768
 v_cndmask_b32 v28, v28, v29, s[48:49]
 v_mul_f32 v28, s55, v28
 s_waitcnt lgkmcnt(3)
 v_mfma_f32_16x16x32_bf16 v[24:27], v[52:55], v[48:51], v[24:27]
 ds_read_b128 v[48:51], v0 offset:45056
 v_exp_f32 v28, v28
 v_mov_b64 v[64:65], 0
 v_cndmask_b32 v29, 0, v28, s[48:49]
 v_cndmask_b32 v28, v28, 0, s[48:49]
 v_cvt_pk_bf16_f32 v6, v28, v29
 v_mov_b64 v[66:67], 0
 v_mov_b64 v[68:69], 0
 v_cndmask_b32 v20, v20, v24, s[48:49]
 v_cndmask_b32 v21, v21, v25, s[48:49]
 v_cndmask_b32 v22, v22, v26, s[48:49]
 v_cndmask_b32 v23, v23, v27, s[48:49]
 v_mfma_f32_16x16x16_bf16 v[60:63], v[6:7], v[32:33], 0
 s_waitcnt vmcnt(1)
 v_exp_f32 v20, v20
 v_mfma_f32_16x16x16_bf16 v[52:55], v[6:7], v[2:3], 0
 s_cmp_eq_u32 s36, 63
 v_exp_f32 v21, v21
 v_mfma_f32_16x16x16_bf16 v[56:59], v[6:7], v[4:5], 0
 v_exp_f32 v22, v22
 v_exp_f32 v23, v23
 v_cvt_pk_bf16_f32 v30, v20, v21
 v_cvt_pk_bf16_f32 v31, v22, v23
 v_mov_b64 v[70:71], 0
 v_mov_b64 v[20:21], 0
 v_smfmac_f32_16x16x32_bf16 v[60:63], v[30:31], v[32:35], v5
 v_mov_b64 v[22:23], 0
 v_mov_b64 v[24:25], 0
 v_smfmac_f32_16x16x32_bf16 v[52:55], v[30:31], v[12:15], v5
 v_mov_b64 v[26:27], 0
 v_smfmac_f32_16x16x32_bf16 v[56:59], v[30:31], v[16:19], v5
 s_nop 0
 v_add_f32 v60, v60, v62
 v_add_f32 v61, v61, v63
 v_rcp_f32 v60, v60
 v_rcp_f32 v61, v61
 v_add_f32 v52, v52, v54
 v_add_f32 v53, v53, v55
 v_mul_f32 v52, v52, v60
 v_mul_f32 v53, v53, v61
 v_add_f32 v56, v56, v58
 v_add_f32 v57, v57, v59
 v_mul_f32 v56, v56, v60
 v_mul_f32 v57, v57, v61
 v_cvt_pk_bf16_f32 v52, v52, v56
 v_cvt_pk_bf16_f32 v53, v53, v57
 ds_write2_b32 v8, v52, v53 offset0:128 offset1:144
 v_subrev_u32 v60, 0x21800000, v60
 v_subrev_u32 v61, 0x21800000, v61
 v_max_u32 v60, v60, v61
 v_cmp_lt_u32 vcc, 0x3c000000, v60
 s_cbranch_scc1 Lchexit_70
 v_mov_b64 v[28:29], 0
 v_mov_b64 v[30:31], 0
 v_mov_b64 v[32:33], 0
 v_mov_b64 v[34:35], 0
 s_cbranch_vccnz Lmx_77
Lmxb_78:
 s_waitcnt lgkmcnt(0)
 v_bfe_u32 v6, v0, 7, 5
 s_barrier
 ds_read_b128 v[52:55], v9 offset:19968
 v_mul_u32_u24 v6, 10496, v6
 ds_read_b128 v[56:59], v9 offset:22016
 ds_read_b128 v[12:15], v0 offset:49152
 v_bfe_u32 v60, v3, 4, 3
 ds_read_b128 v[16:19], v0 offset:53248
 s_add_u32 s67, s67, 0x80000
 v_lshl_add_u32 v6, v60, 3, v6
 s_xor_b32 s46, s46, 0x1
 s_add_u32 s59, s59, 0x80000
 v_mov_b64 v[60:61], 0
 s_add_u32 s38, s38, 0x20000
 v_mov_b64 v[62:63], 0
 s_waitcnt lgkmcnt(3)
 v_smfmac_f32_16x16x64_bf16 v[64:67], v[52:55], a[248:255], v5
 buffer_load_dwordx4 v3, s[20:23], s67 offen offset:0 sc1 lds
 v_smfmac_f32_16x16x64_bf16 v[68:71], v[52:55], a[176:183], v5
 s_waitcnt lgkmcnt(2)
 s_cmp_lt_u32 s36, 61
 v_smfmac_f32_16x16x64_bf16 v[64:67], v[56:59], v[36:43], v5
 ds_read_b128 v[36:39], v0 offset:57344
 buffer_load_dwordx4 v3, s[20:23], s67 offen offset:1024 sc1 lds
 v_smfmac_f32_16x16x64_bf16 v[20:23], v[52:55], a[184:191], v5
 ds_read_b128 v[40:43], v0 offset:61440
 s_cselect_b32 s47, 0x80000, 0
 v_add_u32 v0, 0x10000, v0
 v_smfmac_f32_16x16x64_bf16 v[68:71], v[56:59], v[44:51], v5
 ds_read_b128 v[44:47], v0 offset:0
 s_add_u32 s68, s68, s47
 v_add_f32 v64, v64, v66
 v_add_f32 v65, v65, v67
 v_cvt_pk_bf16_f32 v65, v65, v65
 v_smfmac_f32_16x16x64_bf16 v[24:27], v[52:55], a[192:199], v5
 ds_read_b128 v[48:51], v0 offset:4096
 s_waitcnt lgkmcnt(4)
 v_cvt_pk_bf16_f32 v64, v64, v64
 v_and_or_b32 v65, v65, -2, s46
 v_smfmac_f32_16x16x64_bf16 v[20:23], v[56:59], v[12:19], v5
 ds_read_b128 v[12:15], v0 offset:8192
 buffer_store_dwordx2 v[64:65], v6, s[20:23], s62 offen
 v_add_f32 v68, v68, v70
 v_add_f32 v69, v69, v71
 v_smfmac_f32_16x16x64_bf16 v[28:31], v[52:55], a[200:207], v5
 ds_read_b128 v[16:19], v0 offset:12288
 s_waitcnt lgkmcnt(4)
 v_mov_b64 v[64:65], 0
 v_mov_b64 v[66:67], 0
 v_smfmac_f32_16x16x64_bf16 v[24:27], v[56:59], v[36:43], v5
 ds_read_b128 v[36:39], v0 offset:16384
 s_add_u32 s36, s36, 1
 v_add_f32 v20, v20, v22
 v_add_f32 v21, v21, v23
 v_cvt_pk_bf16_f32 v69, v69, v21
 v_smfmac_f32_16x16x64_bf16 v[32:35], v[52:55], a[208:215], v5
 ds_read_b128 v[40:43], v0 offset:20480
 s_waitcnt lgkmcnt(4)
 v_cvt_pk_bf16_f32 v68, v68, v20
 v_and_or_b32 v69, v69, -2, s46
 v_smfmac_f32_16x16x64_bf16 v[28:31], v[56:59], v[44:51], v5
 ds_read_b128 v[44:47], v0 offset:24576
 buffer_store_dwordx2 v[68:69], v6, s[20:23], s60 offen offset:0
 v_add_f32 v24, v24, v26
 v_add_f32 v25, v25, v27
 v_smfmac_f32_16x16x64_bf16 v[60:63], v[52:55], a[216:223], v5
 ds_read_b128 v[48:51], v0 offset:28672
 s_waitcnt lgkmcnt(4)
 v_mov_b64 v[20:21], 0
 v_mov_b64 v[22:23], 0
 v_smfmac_f32_16x16x64_bf16 v[32:35], v[56:59], v[12:19], v5
 s_add_u32 s58, s36, 2
 s_min_u32 s58, s58, 64
 v_add_f32 v28, v28, v30
 v_add_f32 v29, v29, v31
 v_cvt_pk_bf16_f32 v25, v25, v29
 v_smfmac_f32_16x16x64_bf16 v[64:67], v[52:55], a[224:231], v5
 s_waitcnt lgkmcnt(2)
 s_xor_b32 s44, s44, 0x80000
 v_cvt_pk_bf16_f32 v24, v24, v28
 v_and_or_b32 v25, v25, -2, s46
 v_smfmac_f32_16x16x64_bf16 v[60:63], v[56:59], v[36:43], v5
 buffer_store_dwordx2 v[24:25], v6, s[20:23], s60 offen offset:2048
 v_add_f32 v32, v32, v34
 v_smfmac_f32_16x16x64_bf16 v[20:23], v[52:55], a[232:239], v5
 s_waitcnt lgkmcnt(0)
 s_xor_b32 s45, s45, 0x80000
 v_add_f32 v33, v33, v35
 v_smfmac_f32_16x16x64_bf16 v[64:67], v[56:59], v[44:51], v5
 s_xor_b32 s65, s65, 0x80000
 s_xor_b32 s66, s66, 0x80000
 v_add_f32 v60, v60, v62
 v_add_f32 v61, v61, v63
 v_smfmac_f32_16x16x64_bf16 v[20:23], v[56:59], a[240:247], v5
 s_cmp_eq_u32 s4, 0
 v_cvt_pk_bf16_f32 v33, v33, v61
 v_cvt_pk_bf16_f32 v32, v32, v60
 v_and_or_b32 v33, v33, -2, s46
 buffer_store_dwordx2 v[32:33], v6, s[20:23], s61 offen offset:0
 v_add_f32 v64, v64, v66
 v_add_f32 v65, v65, v67
 s_nop 0
 v_add_f32 v20, v20, v22
 v_add_f32 v21, v21, v23
 v_cvt_pk_bf16_f32 v65, v65, v21
 v_cvt_pk_bf16_f32 v64, v64, v20
 v_and_or_b32 v65, v65, -2, s46
 buffer_store_dwordx2 v[64:65], v6, s[20:23], s61 offen offset:2048
 s_cbranch_scc1 LwH_79
 s_cmp_eq_u32 s4, 1
 s_cbranch_scc1 Lw_80
 s_cmp_eq_u32 s4, 2
 s_cbranch_scc1 Lw_81
 s_xor_b32 s41, s41, 0x80000
 s_xor_b32 s43, s43, 0x80000
 v_mov_b32 v47, 0x3f80
 v_cndmask_b32 v47, v47, 1.0, s[32:33]
 v_cndmask_b32 v44, 0, v47, s[24:25]
 v_cndmask_b32 v45, 0, v47, s[26:27]
 v_cndmask_b32 v46, 0, v47, s[28:29]
 v_cndmask_b32 v47, 0, v47, s[30:31]
 v_bfe_u32 v52, v3, 8, 2
 v_bfe_u32 v58, v3, 2, 4
 v_lshl_or_b32 v52, v52, 4, v58
 v_and_b32 v58, 0xc0, v3
 v_lshl_or_b32 v52, v58, 24, v52
 v_subrev_u32 v0, 0x20000, v0
 v_mov_b32 v59, -1
 v_add_u32 v54, s42, v3
 v_add_u32 v58, s69, v9
 ds_read_b64 v[64:65], v58 offset:19456
 v_mov_b32 v66, v2
 v_mov_b32 v67, v4
 v_mov_b64 v[68:69], 0
 v_mov_b64 v[70:71], 0
 ds_read_b128 v[20:23], v0 offset:24576
 ds_read_b128 v[24:27], v0 offset:28672
 ds_read_b128 v[28:31], v0 offset:32768
 ds_read_b128 v[32:35], v0 offset:36864
 s_waitcnt vmcnt(0)
 buffer_load_dwordx4 v[36:39], v3, s[20:23], s39 offen offset:0 sc1
 buffer_load_dwordx4 v[40:43], v3, s[20:23], s39 offen offset:1024 sc1
 s_nop 15
 s_nop 10
 buffer_load_dwordx4 v[12:15], v3, s[20:23], s39 offen offset:0 sc1
 buffer_load_dwordx4 v[16:19], v3, s[20:23], s39 offen offset:1024 sc1
 s_waitcnt vmcnt(3)
 v_mfma_f32_16x16x32_bf16 v[48:51], v[44:47], v[36:39], 0
 s_waitcnt vmcnt(2)
 v_mfma_f32_16x16x32_bf16 v[48:51], v[44:47], v[40:43], v[48:51]
 v_bitop3_b32 v55, v37, v39, s46 bitop3:0x7e
 v_bitop3_b32 v56, v41, v43, s46 bitop3:0x7e
 v_bitop3_b32 v55, v55, 1, v56 bitop3:0xc8
 v_cmp_ne_u32 vcc, 0, v55
 s_nop 3
 v_add_f32_dpp v48, v48, v48 row_ror:4 row_mask:0xf bank_mask:0xf
 v_add_f32_dpp v49, v49, v49 row_ror:4 row_mask:0xf bank_mask:0xf
 s_cbranch_vccnz Lr2_83
 v_add_f32_dpp v48, v48, v48 row_ror:8 row_mask:0xf bank_mask:0xf
 v_add_f32_dpp v49, v49, v49 row_ror:8 row_mask:0xf bank_mask:0xf
 v_cvt_pk_bf16_f32 v48, v48, v49
 buffer_store_dword v48, v52, s[20:23], s44 offen
Lb1_84:
 buffer_store_dword v59, v52, s[20:23], s45 offen
 v_cmp_gt_u32 vcc, s58, v1
 v_mov_b64 v[36:37], 0
 v_mov_b64 v[38:39], 0
 v_mov_b64 v[40:41], 0
 v_mov_b64 v[42:43], 0
 v_mov_b64 v[44:45], 0
 v_mov_b64 v[46:47], 0
 v_mov_b64 v[48:49], 0
 v_mov_b64 v[50:51], 0
 s_cmp_lg_u32 vcc_hi, 0
 s_cbranch_scc1 Lfw_86
Lfok_85:
 v_lshl_add_u32 v1, v3, 3, s68
 v_mov_b32 v6, s56
 v_cndmask_b32 v1, v6, v1, s[70:71]
 v_mov_b32 v4, v54
 s_waitcnt vmcnt(0)
 s_nop 15
 s_nop 15
 s_nop 11
 s_branch LstepB_73
Lw_81:
 s_xor_b32 s41, s41, 0x80000
 s_xor_b32 s43, s43, 0x80000
 v_mov_b32 v47, 0x3f80
 v_cndmask_b32 v47, v47, 1.0, s[32:33]
 v_cndmask_b32 v44, 0, v47, s[24:25]
 v_cndmask_b32 v45, 0, v47, s[26:27]
 v_cndmask_b32 v46, 0, v47, s[28:29]
 v_cndmask_b32 v47, 0, v47, s[30:31]
 v_bfe_u32 v52, v3, 8, 2
 v_bfe_u32 v58, v3, 2, 4
 v_lshl_or_b32 v52, v52, 4, v58
 v_and_b32 v58, 0xc0, v3
 v_lshl_or_b32 v52, v58, 24, v52
 v_subrev_u32 v0, 0x20000, v0
 v_mov_b32 v59, -1
 v_add_u32 v54, s42, v3
 v_add_u32 v58, s69, v9
 ds_read_b64 v[64:65], v58 offset:19456
 v_mov_b32 v66, v2
 v_mov_b32 v67, v4
 v_mov_b64 v[68:69], 0
 v_mov_b64 v[70:71], 0
 ds_read_b128 v[20:23], v0 offset:24576
 ds_read_b128 v[24:27], v0 offset:28672
 ds_read_b128 v[28:31], v0 offset:32768
 ds_read_b128 v[32:35], v0 offset:36864
 s_waitcnt vmcnt(1)
 buffer_load_dwordx4 v[36:39], v3, s[20:23], s39 offen offset:0 sc1
 buffer_load_dwordx4 v[40:43], v3, s[20:23], s39 offen offset:1024 sc1
 s_nop 15
 s_nop 10
 buffer_load_dwordx4 v[12:15], v3, s[20:23], s39 offen offset:0 sc1
 buffer_load_dwordx4 v[16:19], v3, s[20:23], s39 offen offset:1024 sc1
 s_waitcnt vmcnt(3)
 v_mfma_f32_16x16x32_bf16 v[48:51], v[44:47], v[36:39], 0
 s_waitcnt vmcnt(2)
 v_mfma_f32_16x16x32_bf16 v[48:51], v[44:47], v[40:43], v[48:51]
 v_bitop3_b32 v55, v37, v39, s46 bitop3:0x7e
 v_bitop3_b32 v56, v41, v43, s46 bitop3:0x7e
 v_bitop3_b32 v55, v55, 1, v56 bitop3:0xc8
 v_cmp_ne_u32 vcc, 0, v55
 s_nop 3
 v_add_f32_dpp v48, v48, v48 row_ror:4 row_mask:0xf bank_mask:0xf
 v_add_f32_dpp v49, v49, v49 row_ror:4 row_mask:0xf bank_mask:0xf
 s_cbranch_vccnz Lr2_89
 v_add_f32_dpp v48, v48, v48 row_ror:8 row_mask:0xf bank_mask:0xf
 v_add_f32_dpp v49, v49, v49 row_ror:8 row_mask:0xf bank_mask:0xf
 v_cvt_pk_bf16_f32 v48, v48, v49
 buffer_store_dword v48, v52, s[20:23], s44 offen
Lb1_90:
 buffer_store_dword v59, v52, s[20:23], s45 offen
 v_cmp_gt_u32 vcc, s58, v1
 v_mov_b64 v[36:37], 0
 v_mov_b64 v[38:39], 0
 v_mov_b64 v[40:41], 0
 v_mov_b64 v[42:43], 0
 v_mov_b64 v[44:45], 0
 v_mov_b64 v[46:47], 0
 v_mov_b64 v[48:49], 0
 v_mov_b64 v[50:51], 0
 s_cmp_lg_u32 vcc_hi, 0
 s_cbranch_scc1 Lfw_92
Lfok_91:
 v_lshl_add_u32 v1, v3, 3, s68
 v_mov_b32 v6, s56
 v_cndmask_b32 v1, v6, v1, s[70:71]
 v_mov_b32 v4, v54
 s_nop 7
 buffer_load_dwordx4 v[68:71], v3, s[20:23], s43 offen offset:0 sc1
 s_nop 15
 s_nop 7
Lp2_93:
 buffer_load_dwordx4 v[68:71], v3, s[20:23], s43 offen offset:0 sc1
 s_waitcnt vmcnt(1)
 v_max3_u32 v55, v68, v69, v70
 v_max_u32 v55, v55, v71
 ds_write_b128 v3, v[68:71] offset:8192
 v_cmpx_eq_u32 vcc, -1, v55
 s_cbranch_execz LstepB_73
 buffer_load_dwordx4 v[68:71], v3, s[20:23], s43 offen offset:0 sc1
 s_waitcnt vmcnt(1)
 v_max3_u32 v55, v68, v69, v70
 v_max_u32 v55, v55, v71
 ds_write_b128 v3, v[68:71] offset:8192
 v_cmpx_eq_u32 vcc, -1, v55
 s_cbranch_execz LstepB_73
 buffer_load_dwordx4 v[68:71], v3, s[20:23], s43 offen offset:0 sc1
 s_waitcnt vmcnt(1)
 v_max3_u32 v55, v68, v69, v70
 v_max_u32 v55, v55, v71
 ds_write_b128 v3, v[68:71] offset:8192
 v_cmpx_eq_u32 vcc, -1, v55
 s_cbranch_execz LstepB_73
 s_sub_u32 s54, s54, 1
 s_cbranch_scc0 Lp2_93
 s_endpgm
Lw_80:
 s_waitcnt vmcnt(2)
 buffer_load_dwordx4 v[36:39], v3, s[20:23], s39 offen offset:0 sc1
 buffer_load_dwordx4 v[40:43], v3, s[20:23], s39 offen offset:1024 sc1
 s_xor_b32 s41, s41, 0x80000
 s_xor_b32 s43, s43, 0x80000
 v_mov_b32 v47, 0x3f80
 v_cndmask_b32 v47, v47, 1.0, s[32:33]
 v_cndmask_b32 v44, 0, v47, s[24:25]
 v_cndmask_b32 v45, 0, v47, s[26:27]
 v_cndmask_b32 v46, 0, v47, s[28:29]
 v_cndmask_b32 v47, 0, v47, s[30:31]
 v_bfe_u32 v52, v3, 8, 2
 v_bfe_u32 v58, v3, 2, 4
 v_lshl_or_b32 v52, v52, 4, v58
 v_and_b32 v58, 0xc0, v3
 v_lshl_or_b32 v52, v58, 24, v52
 v_subrev_u32 v0, 0x20000, v0
 v_mov_b32 v59, -1
 v_add_u32 v54, s42, v3
 v_add_u32 v58, s69, v9
 ds_read_b64 v[64:65], v58 offset:19456
 v_mov_b32 v66, v2
 v_mov_b32 v67, v4
 v_mov_b64 v[68:69], 0
 v_mov_b64 v[70:71], 0
 ds_read_b128 v[20:23], v0 offset:24576
 ds_read_b128 v[24:27], v0 offset:28672
 ds_read_b128 v[28:31], v0 offset:32768
 ds_read_b128 v[32:35], v0 offset:36864
 s_nop 3
 buffer_load_dwordx4 v[12:15], v3, s[20:23], s39 offen offset:0 sc1
 buffer_load_dwordx4 v[16:19], v3, s[20:23], s39 offen offset:1024 sc1
 s_waitcnt vmcnt(3)
 v_mfma_f32_16x16x32_bf16 v[48:51], v[44:47], v[36:39], 0
 s_waitcnt vmcnt(2)
 v_mfma_f32_16x16x32_bf16 v[48:51], v[44:47], v[40:43], v[48:51]
 v_bitop3_b32 v55, v37, v39, s46 bitop3:0x7e
 v_bitop3_b32 v56, v41, v43, s46 bitop3:0x7e
 v_bitop3_b32 v55, v55, 1, v56 bitop3:0xc8
 v_cmp_ne_u32 vcc, 0, v55
 s_nop 3
 v_add_f32_dpp v48, v48, v48 row_ror:4 row_mask:0xf bank_mask:0xf
 v_add_f32_dpp v49, v49, v49 row_ror:4 row_mask:0xf bank_mask:0xf
 s_cbranch_vccnz Lr2_95
 v_add_f32_dpp v48, v48, v48 row_ror:8 row_mask:0xf bank_mask:0xf
 v_add_f32_dpp v49, v49, v49 row_ror:8 row_mask:0xf bank_mask:0xf
 v_cvt_pk_bf16_f32 v48, v48, v49
 buffer_store_dword v48, v52, s[20:23], s44 offen
Lb1_96:
 buffer_store_dword v59, v52, s[20:23], s45 offen
 v_cmp_gt_u32 vcc, s58, v1
 v_mov_b64 v[36:37], 0
 v_mov_b64 v[38:39], 0
 v_mov_b64 v[40:41], 0
 v_mov_b64 v[42:43], 0
 v_mov_b64 v[44:45], 0
 v_mov_b64 v[46:47], 0
 v_mov_b64 v[48:49], 0
 v_mov_b64 v[50:51], 0
 s_cmp_lg_u32 vcc_hi, 0
 s_cbranch_scc1 Lfw_98
Lfok_97:
 v_lshl_add_u32 v1, v3, 3, s68
 v_mov_b32 v6, s56
 v_cndmask_b32 v1, v6, v1, s[70:71]
 v_min_u32 v6, 16, v0
 v_lshlrev_b32 v6, 24, v6
 s_max_u32 s47, s36, 1
 v_add_u32 v2, -1, s47
 s_nop 15
 s_nop 0
 buffer_load_dwordx4 v[12:15], v3, s[20:23], s41 offen offset:0 sc1
 buffer_load_dwordx4 v[16:19], v3, s[20:23], s41 offen offset:1024 sc1
 s_nop 15
 s_nop 7
Lp2_99:
 buffer_load_dwordx4 v[12:15], v3, s[20:23], s41 offen offset:0 sc1
 buffer_load_dwordx4 v[16:19], v3, s[20:23], s41 offen offset:1024 sc1
 s_waitcnt vmcnt(2)
 v_max3_u32 v55, v12, v13, v14
 v_max3_u32 v55, v55, v15, v16
 v_max3_u32 v55, v55, v17, v18
 v_max_u32 v55, v55, v19
 ds_write_b128 v54, v[12:15] offset:0
 ds_write_b128 v54, v[16:19] offset:1024
 v_cmpx_eq_u32 vcc, -1, v55
 s_cbranch_execz Lstep_71
 buffer_load_dwordx4 v[12:15], v3, s[20:23], s41 offen offset:0 sc1
 buffer_load_dwordx4 v[16:19], v3, s[20:23], s41 offen offset:1024 sc1
 s_waitcnt vmcnt(2)
 v_max3_u32 v55, v12, v13, v14
 v_max3_u32 v55, v55, v15, v16
 v_max3_u32 v55, v55, v17, v18
 v_max_u32 v55, v55, v19
 ds_write_b128 v54, v[12:15] offset:0
 ds_write_b128 v54, v[16:19] offset:1024
 v_cmpx_eq_u32 vcc, -1, v55
 s_cbranch_execz Lstep_71
 buffer_load_dwordx4 v[12:15], v3, s[20:23], s41 offen offset:0 sc1
 buffer_load_dwordx4 v[16:19], v3, s[20:23], s41 offen offset:1024 sc1
 s_waitcnt vmcnt(2)
 v_max3_u32 v55, v12, v13, v14
 v_max3_u32 v55, v55, v15, v16
 v_max3_u32 v55, v55, v17, v18
 v_max_u32 v55, v55, v19
 ds_write_b128 v54, v[12:15] offset:0
 ds_write_b128 v54, v[16:19] offset:1024
 v_cmpx_eq_u32 vcc, -1, v55
 s_cbranch_execz Lstep_71
 s_sub_u32 s54, s54, 1
 s_cbranch_scc0 Lp2_99
 s_endpgm
LwH_79:
 v_bfe_u32 v53, v3, 8, 1
 v_bfe_u32 v58, v3, 9, 1
 v_lshl_or_b32 v53, v53, 1, v58
 v_bfe_u32 v58, v3, 5, 1
 v_lshl_or_b32 v53, v53, 1, v58
 v_and_b32 v58, 0xd0, v3
 v_lshlrev_b32 v58, 24, v58
 v_lshl_or_b32 v53, v53, 2, v58
 s_waitcnt vmcnt(3)
 s_nop 7
 buffer_load_dwordx4 v[20:23], v3, s[20:23], s40 offen offset:0 sc1
 buffer_load_dwordx4 v[24:27], v3, s[20:23], s40 offen offset:1024 sc1
 buffer_load_dwordx4 v[36:39], v3, s[20:23], s39 offen offset:0 sc1
 buffer_load_dwordx4 v[40:43], v3, s[20:23], s39 offen offset:1024 sc1
 s_xor_b32 s41, s41, 0x80000
 s_xor_b32 s43, s43, 0x80000
 v_mov_b32 v47, 0x3f80
 v_cndmask_b32 v47, v47, 1.0, s[32:33]
 v_cndmask_b32 v44, 0, v47, s[24:25]
 v_cndmask_b32 v45, 0, v47, s[26:27]
 v_cndmask_b32 v46, 0, v47, s[28:29]
 v_cndmask_b32 v47, 0, v47, s[30:31]
 v_bfe_u32 v52, v3, 8, 2
 v_bfe_u32 v58, v3, 2, 4
 v_lshl_or_b32 v52, v52, 4, v58
 v_and_b32 v58, 0xc0, v3
 v_lshl_or_b32 v52, v58, 24, v52
 v_subrev_u32 v0, 0x20000, v0
 v_mov_b32 v59, -1
 v_add_u32 v54, s42, v3
 v_add_u32 v58, s69, v9
 ds_read_b64 v[64:65], v58 offset:19456
 v_mov_b32 v66, v2
 v_mov_b32 v67, v4
 v_mov_b64 v[68:69], 0
 v_mov_b64 v[70:71], 0
 s_waitcnt vmcnt(2)
 v_mfma_f32_16x16x32_bf16 v[28:31], v[44:47], v[20:23], 0
 v_mfma_f32_16x16x32_bf16 v[28:31], v[44:47], v[24:27], v[28:31]
 s_waitcnt vmcnt(1)
 v_mfma_f32_16x16x32_bf16 v[48:51], v[44:47], v[36:39], 0
 s_waitcnt vmcnt(0)
 v_mfma_f32_16x16x32_bf16 v[48:51], v[44:47], v[40:43], v[48:51]
 v_bitop3_b32 v55, v37, v39, s46 bitop3:0x7e
 v_bitop3_b32 v56, v41, v43, s46 bitop3:0x7e
 v_bitop3_b32 v57, v21, v23, s46 bitop3:0x7e
 v_or3_b32 v55, v55, v56, v57
 v_bitop3_b32 v56, v25, v27, s46 bitop3:0x7e
 v_bitop3_b32 v55, v55, 1, v56 bitop3:0xc8
 v_cmp_ne_u32 vcc, 0, v55
 v_add_f32_dpp v29, v29, v29 row_ror:4 row_mask:0xf bank_mask:0xf
 v_add_f32_dpp v48, v48, v48 row_ror:4 row_mask:0xf bank_mask:0xf
 v_add_f32_dpp v49, v49, v49 row_ror:4 row_mask:0xf bank_mask:0xf
 v_add_f32_dpp v29, v29, v29 row_ror:8 row_mask:0xf bank_mask:0xf
 v_add_f32_dpp v48, v48, v48 row_ror:8 row_mask:0xf bank_mask:0xf
 v_add_f32_dpp v49, v49, v49 row_ror:8 row_mask:0xf bank_mask:0xf
 s_cbranch_vccnz Lr1_100
 v_cvt_pk_bf16_f32 v48, v48, v49
 buffer_store_dword v48, v52, s[20:23], s44 offen
 v_mov_b32_dpp v30, v29 quad_perm:[1,0,3,2] row_mask:0xf bank_mask:0xf
 v_cvt_pk_bf16_f32 v29, v29, v30
 buffer_store_dword v29, v53, s[20:23], s65 offen
Lb1_101:
 buffer_store_dword v59, v52, s[20:23], s45 offen
 buffer_store_dword v59, v53, s[20:23], s66 offen
 v_cmp_gt_u32 vcc, s58, v1
 ds_read_b128 v[20:23], v0 offset:24576
 ds_read_b128 v[24:27], v0 offset:28672
 ds_read_b128 v[28:31], v0 offset:32768
 ds_read_b128 v[32:35], v0 offset:36864
 v_mov_b64 v[36:37], 0
 v_mov_b64 v[38:39], 0
 v_mov_b64 v[40:41], 0
 v_mov_b64 v[42:43], 0
 v_mov_b64 v[44:45], 0
 v_mov_b64 v[46:47], 0
 v_mov_b64 v[48:49], 0
 v_mov_b64 v[50:51], 0
 s_cmp_lg_u32 vcc_hi, 0
 s_cbranch_scc1 Lfw_103
Lfok_102:
 v_lshl_add_u32 v1, v3, 3, s68
 v_mov_b32 v6, s56
 v_cndmask_b32 v1, v6, v1, s[70:71]
 v_min_u32 v6, 16, v0
 v_lshlrev_b32 v6, 24, v6
 s_max_u32 s47, s36, 1
 v_add_u32 v2, -1, s47
 s_nop 10
 buffer_load_dwordx4 v[12:15], v3, s[20:23], s41 offen offset:0 sc1
 buffer_load_dwordx4 v[16:19], v3, s[20:23], s41 offen offset:1024 sc1
 s_nop 15
 s_nop 7
Lp2_104:
 buffer_load_dwordx4 v[12:15], v3, s[20:23], s41 offen offset:0 sc1
 buffer_load_dwordx4 v[16:19], v3, s[20:23], s41 offen offset:1024 sc1
 s_waitcnt vmcnt(2)
 v_max3_u32 v55, v12, v13, v14
 v_max3_u32 v55, v55, v15, v16
 v_max3_u32 v55, v55, v17, v18
 v_max_u32 v55, v55, v19
 ds_write_b128 v54, v[12:15] offset:0
 ds_write_b128 v54, v[16:19] offset:1024
 v_cmpx_eq_u32 vcc, -1, v55
 s_cbranch_execz Lstep_71
 buffer_load_dwordx4 v[12:15], v3, s[20:23], s41 offen offset:0 sc1
 buffer_load_dwordx4 v[16:19], v3, s[20:23], s41 offen offset:1024 sc1
 s_waitcnt vmcnt(2)
 v_max3_u32 v55, v12, v13, v14
 v_max3_u32 v55, v55, v15, v16
 v_max3_u32 v55, v55, v17, v18
 v_max_u32 v55, v55, v19
 ds_write_b128 v54, v[12:15] offset:0
 ds_write_b128 v54, v[16:19] offset:1024
 v_cmpx_eq_u32 vcc, -1, v55
 s_cbranch_execz Lstep_71
 buffer_load_dwordx4 v[12:15], v3, s[20:23], s41 offen offset:0 sc1
 buffer_load_dwordx4 v[16:19], v3, s[20:23], s41 offen offset:1024 sc1
 s_waitcnt vmcnt(2)
 v_max3_u32 v55, v12, v13, v14
 v_max3_u32 v55, v55, v15, v16
 v_max3_u32 v55, v55, v17, v18
 v_max_u32 v55, v55, v19
 ds_write_b128 v54, v[12:15] offset:0
 ds_write_b128 v54, v[16:19] offset:1024
 v_cmpx_eq_u32 vcc, -1, v55
 s_cbranch_execz Lstep_71
 s_sub_u32 s54, s54, 1
 s_cbranch_scc0 Lp2_104
 s_endpgm
Lr1_100:
 s_mov_b64 exec, vcc
Lrt_105:
 buffer_load_dwordx4 v[20:23], v3, s[20:23], s40 offen offset:0 sc1
 buffer_load_dwordx4 v[24:27], v3, s[20:23], s40 offen offset:1024 sc1
 buffer_load_dwordx4 v[36:39], v3, s[20:23], s39 offen offset:0 sc1
 buffer_load_dwordx4 v[40:43], v3, s[20:23], s39 offen offset:1024 sc1
 s_waitcnt vmcnt(4)
 v_bitop3_b32 v55, v37, v39, s46 bitop3:0x7e
 v_bitop3_b32 v56, v41, v43, s46 bitop3:0x7e
 v_bitop3_b32 v57, v21, v23, s46 bitop3:0x7e
 v_or3_b32 v55, v55, v56, v57
 v_bitop3_b32 v56, v25, v27, s46 bitop3:0x7e
 v_bitop3_b32 v55, v55, 1, v56 bitop3:0xc8
 v_cmpx_ne_u32 vcc, 0, v55
 s_cbranch_execz Lrte_106
 buffer_load_dwordx4 v[20:23], v3, s[20:23], s40 offen offset:0 sc1
 buffer_load_dwordx4 v[24:27], v3, s[20:23], s40 offen offset:1024 sc1
 buffer_load_dwordx4 v[36:39], v3, s[20:23], s39 offen offset:0 sc1
 buffer_load_dwordx4 v[40:43], v3, s[20:23], s39 offen offset:1024 sc1
 s_waitcnt vmcnt(4)
 v_bitop3_b32 v55, v37, v39, s46 bitop3:0x7e
 v_bitop3_b32 v56, v41, v43, s46 bitop3:0x7e
 v_bitop3_b32 v57, v21, v23, s46 bitop3:0x7e
 v_or3_b32 v55, v55, v56, v57
 v_bitop3_b32 v56, v25, v27, s46 bitop3:0x7e
 v_bitop3_b32 v55, v55, 1, v56 bitop3:0xc8
 v_cmpx_ne_u32 vcc, 0, v55
 s_cbranch_execz Lrte_106
 buffer_load_dwordx4 v[20:23], v3, s[20:23], s40 offen offset:0 sc1
 buffer_load_dwordx4 v[24:27], v3, s[20:23], s40 offen offset:1024 sc1
 buffer_load_dwordx4 v[36:39], v3, s[20:23], s39 offen offset:0 sc1
 buffer_load_dwordx4 v[40:43], v3, s[20:23], s39 offen offset:1024 sc1
 s_waitcnt vmcnt(4)
 v_bitop3_b32 v55, v37, v39, s46 bitop3:0x7e
 v_bitop3_b32 v56, v41, v43, s46 bitop3:0x7e
 v_bitop3_b32 v57, v21, v23, s46 bitop3:0x7e
 v_or3_b32 v55, v55, v56, v57
 v_bitop3_b32 v56, v25, v27, s46 bitop3:0x7e
 v_bitop3_b32 v55, v55, 1, v56 bitop3:0xc8
 v_cmpx_ne_u32 vcc, 0, v55
 s_cbranch_execz Lrte_106
 s_sub_u32 s54, s54, 1
 s_cbranch_scc0 Lrt_105
 s_endpgm
Lrte_106:
 s_mov_b64 exec, -1
 s_nop 2
 v_mfma_f32_16x16x32_bf16 v[28:31], v[44:47], v[20:23], 0
 v_mfma_f32_16x16x32_bf16 v[28:31], v[44:47], v[24:27], v[28:31]
 v_mfma_f32_16x16x32_bf16 v[48:51], v[44:47], v[36:39], 0
 v_mfma_f32_16x16x32_bf16 v[48:51], v[44:47], v[40:43], v[48:51]
 s_nop 6
 v_add_f32_dpp v29, v29, v29 row_ror:4 row_mask:0xf bank_mask:0xf
 v_add_f32_dpp v48, v48, v48 row_ror:4 row_mask:0xf bank_mask:0xf
 v_add_f32_dpp v49, v49, v49 row_ror:4 row_mask:0xf bank_mask:0xf
 v_add_f32_dpp v29, v29, v29 row_ror:8 row_mask:0xf bank_mask:0xf
 v_add_f32_dpp v48, v48, v48 row_ror:8 row_mask:0xf bank_mask:0xf
 v_add_f32_dpp v49, v49, v49 row_ror:8 row_mask:0xf bank_mask:0xf
 v_cvt_pk_bf16_f32 v48, v48, v49
 buffer_store_dword v48, v52, s[20:23], s44 offen
 v_mov_b32_dpp v30, v29 quad_perm:[1,0,3,2] row_mask:0xf bank_mask:0xf
 v_cvt_pk_bf16_f32 v29, v29, v30
 buffer_store_dword v29, v53, s[20:23], s65 offen
 s_waitcnt vmcnt(2)
 s_branch Lb1_101
Lyr_75:
 s_mov_b64 exec, vcc
Lrt_107:
 buffer_load_dwordx4 v[12:15], v3, s[20:23], s41 offen offset:0 sc1
 buffer_load_dwordx4 v[16:19], v3, s[20:23], s41 offen offset:1024 sc1
 s_waitcnt vmcnt(2)
 v_max3_u32 v2, v12, v13, v14
 v_max3_u32 v2, v2, v15, v16
 v_max3_u32 v2, v2, v17, v18
 v_max_u32 v2, v2, v19
 v_cmpx_eq_u32 vcc, -1, v2
 s_cbranch_execz Lrte_108
 buffer_load_dwordx4 v[12:15], v3, s[20:23], s41 offen offset:0 sc1
 buffer_load_dwordx4 v[16:19], v3, s[20:23], s41 offen offset:1024 sc1
 s_waitcnt vmcnt(2)
 v_max3_u32 v2, v12, v13, v14
 v_max3_u32 v2, v2, v15, v16
 v_max3_u32 v2, v2, v17, v18
 v_max_u32 v2, v2, v19
 v_cmpx_eq_u32 vcc, -1, v2
 s_cbranch_execz Lrte_108
 buffer_load_dwordx4 v[12:15], v3, s[20:23], s41 offen offset:0 sc1
 buffer_load_dwordx4 v[16:19], v3, s[20:23], s41 offen offset:1024 sc1
 s_waitcnt vmcnt(2)
 v_max3_u32 v2, v12, v13, v14
 v_max3_u32 v2, v2, v15, v16
 v_max3_u32 v2, v2, v17, v18
 v_max_u32 v2, v2, v19
 v_cmpx_eq_u32 vcc, -1, v2
 s_cbranch_execz Lrte_108
 s_sub_u32 s54, s54, 1
 s_cbranch_scc0 Lrt_107
 s_endpgm
Lrte_108:
 s_mov_b64 exec, -1
 ds_write_b128 v4, v[12:15] offset:0
 ds_write_b128 v4, v[16:19] offset:1024
 s_waitcnt lgkmcnt(0)
 s_branch Lyb_76
Lmx_77:
 s_waitcnt lgkmcnt(0)
 ds_read_b128 v[36:39], v11 offset:17408
 ds_read_b128 v[40:43], v11 offset:17920
 ds_read_b128 v[44:47], v11 offset:18432
 ds_read_b128 v[48:51], v11 offset:18944
 v_mov_b64 v[28:29], 0
 v_mov_b64 v[30:31], 0
 ds_read_b128 v[52:55], v3 offset:9216
 ds_read_b128 v[56:59], v3 offset:10240
 s_waitcnt lgkmcnt(0)
 v_mfma_f32_16x16x32_bf16 v[20:23], v[52:55], v[36:39], 0
 v_mfma_f32_16x16x32_bf16 v[24:27], v[56:59], v[36:39], 0
 ds_read_b128 v[52:55], v3 offset:11264
 ds_read_b128 v[56:59], v3 offset:12288
 s_waitcnt lgkmcnt(0)
 v_mfma_f32_16x16x32_bf16 v[20:23], v[52:55], v[40:43], v[20:23]
 v_mfma_f32_16x16x32_bf16 v[24:27], v[56:59], v[40:43], v[24:27]
 ds_read_b128 v[52:55], v3 offset:13312
 ds_read_b128 v[56:59], v3 offset:14336
 s_waitcnt lgkmcnt(0)
 v_mfma_f32_16x16x32_bf16 v[20:23], v[52:55], v[44:47], v[20:23]
 v_mfma_f32_16x16x32_bf16 v[24:27], v[56:59], v[44:47], v[24:27]
 ds_read_b128 v[52:55], v3 offset:15360
 ds_read_b128 v[56:59], v3 offset:16384
 s_waitcnt lgkmcnt(0)
 v_mfma_f32_16x16x32_bf16 v[20:23], v[52:55], v[48:51], v[20:23]
 v_mfma_f32_16x16x32_bf16 v[24:27], v[56:59], v[48:51], v[24:27]
 ds_read_b128 v[52:55], v9 offset:19456
 ds_read_b128 v[56:59], v9 offset:21504
 s_waitcnt lgkmcnt(0)
 v_smfmac_f32_16x16x64_bf16 v[28:31], v[52:55], v[36:43], v5
 v_smfmac_f32_16x16x64_bf16 v[28:31], v[56:59], v[44:51], v5
 ds_read_b128 v[36:39], v0 offset:32768
 ds_read_b128 v[40:43], v0 offset:36864
 ds_read_b128 v[44:47], v0 offset:40960
 ds_read_b128 v[48:51], v0 offset:45056
 v_mov_b64 v[32:33], s[34:35]
 v_mov_b64 v[34:35], s[34:35]
 s_nop 1
 v_add_f32 v28, v28, v30
 v_add_f32 v29, v29, v31
 v_mul_f32 v28, s55, v28
 v_mul_f32 v29, s55, v29
 v_max_f32 v30, v28, v29
 v_cndmask_b32 v28, v28, v29, s[48:49]
 v_max3_f32 v30, v30, v20, v21
 v_max3_f32 v30, v30, v22, v23
 v_max3_f32 v30, v30, v24, v25
 v_max3_f32 v31, v30, v26, v27
 v_max3_f32 v29, v30, v26, v27
 v_cndmask_b32 v20, v20, v24, s[48:49]
 v_cndmask_b32 v21, v21, v25, s[48:49]
 v_permlane16_swap_b32 v31, v29
 v_max_f32 v30, v31, v29
 v_max_f32 v6, v31, v29
 v_cndmask_b32 v22, v22, v26, s[48:49]
 v_cndmask_b32 v23, v23, v27, s[48:49]
 v_permlane32_swap_b32 v30, v6
 v_max_f32 v30, v30, v6
 v_sub_f32 v28, v28, v30
 v_sub_f32 v20, v20, v30
 v_sub_f32 v21, v21, v30
 v_sub_f32 v22, v22, v30
 v_sub_f32 v23, v23, v30
 v_exp_f32 v28, v28
 v_exp_f32 v20, v20
 v_exp_f32 v21, v21
 v_exp_f32 v22, v22
 v_exp_f32 v23, v23
 v_cndmask_b32 v29, 0, v28, s[48:49]
 v_cndmask_b32 v28, v28, 0, s[48:49]
 v_cvt_pk_bf16_f32 v6, v28, v29
 v_cvt_pk_bf16_f32 v30, v20, v21
 v_cvt_pk_bf16_f32 v31, v22, v23
 v_mfma_f32_16x16x16_bf16 v[60:63], v[6:7], v[32:33], 0
 v_mfma_f32_16x16x16_bf16 v[52:55], v[6:7], v[2:3], 0
 v_mfma_f32_16x16x16_bf16 v[56:59], v[6:7], v[4:5], 0
 v_smfmac_f32_16x16x32_bf16 v[60:63], v[30:31], v[32:35], v5
 v_smfmac_f32_16x16x32_bf16 v[52:55], v[30:31], v[12:15], v5
 v_smfmac_f32_16x16x32_bf16 v[56:59], v[30:31], v[16:19], v5
 s_nop 0
 v_add_f32 v60, v60, v62
 v_add_f32 v61, v61, v63
 v_rcp_f32 v60, v60
 v_rcp_f32 v61, v61
 v_add_f32 v52, v52, v54
 v_add_f32 v53, v53, v55
 v_mul_f32 v52, v52, v60
 v_mul_f32 v53, v53, v61
 v_add_f32 v56, v56, v58
 v_add_f32 v57, v57, v59
 v_mul_f32 v56, v56, v60
 v_mul_f32 v57, v57, v61
 v_cvt_pk_bf16_f32 v52, v52, v56
 v_cvt_pk_bf16_f32 v53, v53, v57
 ds_write2_b32 v8, v52, v53 offset0:128 offset1:144
 v_mov_b64 v[20:21], 0
 v_mov_b64 v[22:23], 0
 v_mov_b64 v[24:25], 0
 v_mov_b64 v[26:27], 0
 v_mov_b64 v[28:29], 0
 v_mov_b64 v[30:31], 0
 v_mov_b64 v[32:33], 0
 v_mov_b64 v[34:35], 0
 s_waitcnt lgkmcnt(0)
 s_branch Lmxb_78
Lr2_83:
 s_waitcnt vmcnt(1)
 v_mfma_f32_16x16x32_bf16 v[48:51], v[44:47], v[12:15], 0
 s_waitcnt vmcnt(0)
 v_mfma_f32_16x16x32_bf16 v[48:51], v[44:47], v[16:19], v[48:51]
 v_bitop3_b32 v55, v13, v15, s46 bitop3:0x7e
 v_bitop3_b32 v56, v17, v19, s46 bitop3:0x7e
 v_bitop3_b32 v55, v55, 1, v56 bitop3:0xc8
 v_cmp_ne_u32 vcc, 0, v55
 s_nop 3
 v_add_f32_dpp v48, v48, v48 row_ror:4 row_mask:0xf bank_mask:0xf
 v_add_f32_dpp v49, v49, v49 row_ror:4 row_mask:0xf bank_mask:0xf
 s_cbranch_vccnz Lr1_82
 v_add_f32_dpp v48, v48, v48 row_ror:8 row_mask:0xf bank_mask:0xf
 v_add_f32_dpp v49, v49, v49 row_ror:8 row_mask:0xf bank_mask:0xf
 v_cvt_pk_bf16_f32 v48, v48, v49
 buffer_store_dword v48, v52, s[20:23], s44 offen
 s_branch Lb1_84
Lr1_82:
 s_mov_b64 exec, vcc
Lrt_109:
 buffer_load_dwordx4 v[12:15], v3, s[20:23], s39 offen offset:0 sc1
 buffer_load_dwordx4 v[16:19], v3, s[20:23], s39 offen offset:1024 sc1
 s_waitcnt vmcnt(2)
 v_bitop3_b32 v55, v13, v15, s46 bitop3:0x7e
 v_bitop3_b32 v56, v17, v19, s46 bitop3:0x7e
 v_bitop3_b32 v55, v55, 1, v56 bitop3:0xc8
 v_cmpx_ne_u32 vcc, 0, v55
 s_cbranch_execz Lrte_110
 buffer_load_dwordx4 v[12:15], v3, s[20:23], s39 offen offset:0 sc1
 buffer_load_dwordx4 v[16:19], v3, s[20:23], s39 offen offset:1024 sc1
 s_waitcnt vmcnt(2)
 v_bitop3_b32 v55, v13, v15, s46 bitop3:0x7e
 v_bitop3_b32 v56, v17, v19, s46 bitop3:0x7e
 v_bitop3_b32 v55, v55, 1, v56 bitop3:0xc8
 v_cmpx_ne_u32 vcc, 0, v55
 s_cbranch_execz Lrte_110
 buffer_load_dwordx4 v[12:15], v3, s[20:23], s39 offen offset:0 sc1
 buffer_load_dwordx4 v[16:19], v3, s[20:23], s39 offen offset:1024 sc1
 s_waitcnt vmcnt(2)
 v_bitop3_b32 v55, v13, v15, s46 bitop3:0x7e
 v_bitop3_b32 v56, v17, v19, s46 bitop3:0x7e
 v_bitop3_b32 v55, v55, 1, v56 bitop3:0xc8
 v_cmpx_ne_u32 vcc, 0, v55
 s_cbranch_execz Lrte_110
 s_sub_u32 s54, s54, 1
 s_cbranch_scc0 Lrt_109
 s_endpgm
Lrte_110:
 s_mov_b64 exec, -1
 s_nop 2
 v_mfma_f32_16x16x32_bf16 v[48:51], v[44:47], v[12:15], 0
 v_mfma_f32_16x16x32_bf16 v[48:51], v[44:47], v[16:19], v[48:51]
 s_nop 7
 v_add_f32_dpp v48, v48, v48 row_ror:4 row_mask:0xf bank_mask:0xf
 v_add_f32_dpp v49, v49, v49 row_ror:4 row_mask:0xf bank_mask:0xf
 s_nop 0
 v_add_f32_dpp v48, v48, v48 row_ror:8 row_mask:0xf bank_mask:0xf
 v_add_f32_dpp v49, v49, v49 row_ror:8 row_mask:0xf bank_mask:0xf
 v_cvt_pk_bf16_f32 v48, v48, v49
 buffer_store_dword v48, v52, s[20:23], s44 offen
 s_branch Lb1_84
Lr2_89:
 s_waitcnt vmcnt(1)
 v_mfma_f32_16x16x32_bf16 v[48:51], v[44:47], v[12:15], 0
 s_waitcnt vmcnt(0)
 v_mfma_f32_16x16x32_bf16 v[48:51], v[44:47], v[16:19], v[48:51]
 v_bitop3_b32 v55, v13, v15, s46 bitop3:0x7e
 v_bitop3_b32 v56, v17, v19, s46 bitop3:0x7e
 v_bitop3_b32 v55, v55, 1, v56 bitop3:0xc8
 v_cmp_ne_u32 vcc, 0, v55
 s_nop 3
 v_add_f32_dpp v48, v48, v48 row_ror:4 row_mask:0xf bank_mask:0xf
 v_add_f32_dpp v49, v49, v49 row_ror:4 row_mask:0xf bank_mask:0xf
 s_cbranch_vccnz Lr1_88
 v_add_f32_dpp v48, v48, v48 row_ror:8 row_mask:0xf bank_mask:0xf
 v_add_f32_dpp v49, v49, v49 row_ror:8 row_mask:0xf bank_mask:0xf
 v_cvt_pk_bf16_f32 v48, v48, v49
 buffer_store_dword v48, v52, s[20:23], s44 offen
 s_branch Lb1_90
Lr1_88:
 s_mov_b64 exec, vcc
Lrt_111:
 buffer_load_dwordx4 v[12:15], v3, s[20:23], s39 offen offset:0 sc1
 buffer_load_dwordx4 v[16:19], v3, s[20:23], s39 offen offset:1024 sc1
 s_waitcnt vmcnt(2)
 v_bitop3_b32 v55, v13, v15, s46 bitop3:0x7e
 v_bitop3_b32 v56, v17, v19, s46 bitop3:0x7e
 v_bitop3_b32 v55, v55, 1, v56 bitop3:0xc8
 v_cmpx_ne_u32 vcc, 0, v55
 s_cbranch_execz Lrte_112
 buffer_load_dwordx4 v[12:15], v3, s[20:23], s39 offen offset:0 sc1
 buffer_load_dwordx4 v[16:19], v3, s[20:23], s39 offen offset:1024 sc1
 s_waitcnt vmcnt(2)
 v_bitop3_b32 v55, v13, v15, s46 bitop3:0x7e
 v_bitop3_b32 v56, v17, v19, s46 bitop3:0x7e
 v_bitop3_b32 v55, v55, 1, v56 bitop3:0xc8
 v_cmpx_ne_u32 vcc, 0, v55
 s_cbranch_execz Lrte_112
 buffer_load_dwordx4 v[12:15], v3, s[20:23], s39 offen offset:0 sc1
 buffer_load_dwordx4 v[16:19], v3, s[20:23], s39 offen offset:1024 sc1
 s_waitcnt vmcnt(2)
 v_bitop3_b32 v55, v13, v15, s46 bitop3:0x7e
 v_bitop3_b32 v56, v17, v19, s46 bitop3:0x7e
 v_bitop3_b32 v55, v55, 1, v56 bitop3:0xc8
 v_cmpx_ne_u32 vcc, 0, v55
 s_cbranch_execz Lrte_112
 s_sub_u32 s54, s54, 1
 s_cbranch_scc0 Lrt_111
 s_endpgm
Lrte_112:
 s_mov_b64 exec, -1
 s_nop 2
 v_mfma_f32_16x16x32_bf16 v[48:51], v[44:47], v[12:15], 0
 v_mfma_f32_16x16x32_bf16 v[48:51], v[44:47], v[16:19], v[48:51]
 s_nop 7
 v_add_f32_dpp v48, v48, v48 row_ror:4 row_mask:0xf bank_mask:0xf
 v_add_f32_dpp v49, v49, v49 row_ror:4 row_mask:0xf bank_mask:0xf
 s_nop 0
 v_add_f32_dpp v48, v48, v48 row_ror:8 row_mask:0xf bank_mask:0xf
 v_add_f32_dpp v49, v49, v49 row_ror:8 row_mask:0xf bank_mask:0xf
 v_cvt_pk_bf16_f32 v48, v48, v49
 buffer_store_dword v48, v52, s[20:23], s44 offen
 s_branch Lb1_90
Lr2_95:
 s_waitcnt vmcnt(1)
 v_mfma_f32_16x16x32_bf16 v[48:51], v[44:47], v[12:15], 0
 s_waitcnt vmcnt(0)
 v_mfma_f32_16x16x32_bf16 v[48:51], v[44:47], v[16:19], v[48:51]
 v_bitop3_b32 v55, v13, v15, s46 bitop3:0x7e
 v_bitop3_b32 v56, v17, v19, s46 bitop3:0x7e
 v_bitop3_b32 v55, v55, 1, v56 bitop3:0xc8
 v_cmp_ne_u32 vcc, 0, v55
 s_nop 3
 v_add_f32_dpp v48, v48, v48 row_ror:4 row_mask:0xf bank_mask:0xf
 v_add_f32_dpp v49, v49, v49 row_ror:4 row_mask:0xf bank_mask:0xf
 s_cbranch_vccnz Lr1_94
 v_add_f32_dpp v48, v48, v48 row_ror:8 row_mask:0xf bank_mask:0xf
 v_add_f32_dpp v49, v49, v49 row_ror:8 row_mask:0xf bank_mask:0xf
 v_cvt_pk_bf16_f32 v48, v48, v49
 buffer_store_dword v48, v52, s[20:23], s44 offen
 s_branch Lb1_96
Lr1_94:
 s_mov_b64 exec, vcc
Lrt_113:
 buffer_load_dwordx4 v[12:15], v3, s[20:23], s39 offen offset:0 sc1
 buffer_load_dwordx4 v[16:19], v3, s[20:23], s39 offen offset:1024 sc1
 s_waitcnt vmcnt(2)
 v_bitop3_b32 v55, v13, v15, s46 bitop3:0x7e
 v_bitop3_b32 v56, v17, v19, s46 bitop3:0x7e
 v_bitop3_b32 v55, v55, 1, v56 bitop3:0xc8
 v_cmpx_ne_u32 vcc, 0, v55
 s_cbranch_execz Lrte_114
 buffer_load_dwordx4 v[12:15], v3, s[20:23], s39 offen offset:0 sc1
 buffer_load_dwordx4 v[16:19], v3, s[20:23], s39 offen offset:1024 sc1
 s_waitcnt vmcnt(2)
 v_bitop3_b32 v55, v13, v15, s46 bitop3:0x7e
 v_bitop3_b32 v56, v17, v19, s46 bitop3:0x7e
 v_bitop3_b32 v55, v55, 1, v56 bitop3:0xc8
 v_cmpx_ne_u32 vcc, 0, v55
 s_cbranch_execz Lrte_114
 buffer_load_dwordx4 v[12:15], v3, s[20:23], s39 offen offset:0 sc1
 buffer_load_dwordx4 v[16:19], v3, s[20:23], s39 offen offset:1024 sc1
 s_waitcnt vmcnt(2)
 v_bitop3_b32 v55, v13, v15, s46 bitop3:0x7e
 v_bitop3_b32 v56, v17, v19, s46 bitop3:0x7e
 v_bitop3_b32 v55, v55, 1, v56 bitop3:0xc8
 v_cmpx_ne_u32 vcc, 0, v55
 s_cbranch_execz Lrte_114
 s_sub_u32 s54, s54, 1
 s_cbranch_scc0 Lrt_113
 s_endpgm
Lrte_114:
 s_mov_b64 exec, -1
 s_nop 2
 v_mfma_f32_16x16x32_bf16 v[48:51], v[44:47], v[12:15], 0
 v_mfma_f32_16x16x32_bf16 v[48:51], v[44:47], v[16:19], v[48:51]
 s_nop 7
 v_add_f32_dpp v48, v48, v48 row_ror:4 row_mask:0xf bank_mask:0xf
 v_add_f32_dpp v49, v49, v49 row_ror:4 row_mask:0xf bank_mask:0xf
 s_nop 0
 v_add_f32_dpp v48, v48, v48 row_ror:8 row_mask:0xf bank_mask:0xf
 v_add_f32_dpp v49, v49, v49 row_ror:8 row_mask:0xf bank_mask:0xf
 v_cvt_pk_bf16_f32 v48, v48, v49
 buffer_store_dword v48, v52, s[20:23], s44 offen
 s_branch Lb1_96
Lfw_86:
Lpb_115:
 buffer_load_dword v1, v7, s[20:23], s56 offen sc1
 s_waitcnt vmcnt(0)
 v_cmp_le_u32 vcc, s58, v1
 s_cbranch_vccnz Lpbok_116
 s_sub_u32 s54, s54, 1
 s_cbranch_scc0 Lpb_115
 s_endpgm
Lpbok_116:
 s_branch Lfok_85
Lfw_92:
Lpb_117:
 buffer_load_dword v1, v7, s[20:23], s56 offen sc1
 s_waitcnt vmcnt(0)
 v_cmp_le_u32 vcc, s58, v1
 s_cbranch_vccnz Lpbok_118
 s_sub_u32 s54, s54, 1
 s_cbranch_scc0 Lpb_117
 s_endpgm
Lpbok_118:
 s_branch Lfok_91
Lfw_98:
Lpb_119:
 buffer_load_dword v1, v7, s[20:23], s56 offen sc1
 s_waitcnt vmcnt(0)
 v_cmp_le_u32 vcc, s58, v1
 s_cbranch_vccnz Lpbok_120
 s_sub_u32 s54, s54, 1
 s_cbranch_scc0 Lpb_119
 s_endpgm
Lpbok_120:
 s_branch Lfok_97
Lfw_103:
Lpb_121:
 buffer_load_dword v1, v7, s[20:23], s56 offen sc1
 s_waitcnt vmcnt(0)
 v_cmp_le_u32 vcc, s58, v1
 s_cbranch_vccnz Lpbok_122
 s_sub_u32 s54, s54, 1
 s_cbranch_scc0 Lpb_121
 s_endpgm
Lpbok_122:
 s_branch Lfok_102
Lfail_72:
 s_endpgm
Lslow_69:
 .p2align 3
Lstep_123:
 s_mov_b64 exec, -1
 s_waitcnt lgkmcnt(0)
 s_barrier
 ds_read_b128 v[52:55], v3 offset:8192
 ds_read_b128 v[56:59], v3 offset:0
 ds_read_b128 v[60:63], v3 offset:1024
 buffer_store_dwordx4 v[64:67], v0, s[20:23], s38 offen sc1
 s_waitcnt lgkmcnt(2)
 v_smfmac_f32_16x16x64_bf16 v[36:39], v[52:55], a[136:143], v5
 v_smfmac_f32_16x16x64_bf16 v[40:43], v[52:55], a[144:151], v5
 buffer_store_dword v2, v6, s[20:23], s57 offen sc1
 v_smfmac_f32_16x16x64_bf16 v[44:47], v[52:55], a[152:159], v5
 s_waitcnt lgkmcnt(1)
 v_smfmac_f32_16x16x64_bf16 v[48:51], v[52:55], v[20:27], v5
 v_smfmac_f32_16x16x64_bf16 v[36:39], v[56:59], v[72:79], v5
 ds_read_b128 v[20:23], v0 offset:40960
 v_mov_b64 v[64:65], 0
 v_smfmac_f32_16x16x64_bf16 v[40:43], v[56:59], v[80:87], v5
 ds_read_b128 v[24:27], v0 offset:45056
 v_mov_b64 v[66:67], 0
 v_smfmac_f32_16x16x64_bf16 v[44:47], v[56:59], v[88:95], v5
 ds_read_b128 v[52:55], v3 offset:2048
 s_waitcnt lgkmcnt(3)
 v_smfmac_f32_16x16x64_bf16 v[48:51], v[56:59], v[28:35], v5
 v_smfmac_f32_16x16x64_bf16 v[36:39], v[60:63], v[112:119], v5
 ds_read_b128 v[28:31], v0 offset:49152
 v_smfmac_f32_16x16x64_bf16 v[40:43], v[60:63], v[120:127], v5
 ds_read_b128 v[32:35], v0 offset:53248
 v_smfmac_f32_16x16x64_bf16 v[44:47], v[60:63], v[128:135], v5
 ds_read_b128 v[56:59], v3 offset:3072
 v_smfmac_f32_16x16x64_bf16 v[64:67], v[60:63], v[136:143], v5
 v_smfmac_f32_16x16x64_bf16 v[68:71], v[60:63], v[144:151], v5
 s_waitcnt lgkmcnt(3)
 v_smfmac_f32_16x16x64_bf16 v[48:51], v[60:63], v[20:27], v5
 v_smfmac_f32_16x16x64_bf16 v[36:39], v[52:55], v[152:159], v5
 ds_read_b128 v[20:23], v0 offset:57344
 v_smfmac_f32_16x16x64_bf16 v[40:43], v[52:55], v[160:167], v5
 ds_read_b128 v[24:27], v0 offset:61440
 v_smfmac_f32_16x16x64_bf16 v[44:47], v[52:55], v[168:175], v5
 v_smfmac_f32_16x16x64_bf16 v[64:67], v[52:55], v[176:183], v5
 v_smfmac_f32_16x16x64_bf16 v[68:71], v[52:55], v[184:191], v5
 s_waitcnt lgkmcnt(2)
 v_add_u32 v0, 0x10000, v0
 v_smfmac_f32_16x16x64_bf16 v[48:51], v[52:55], v[28:35], v5
 s_branch Ljoin_126
 .p2align 3
LstepB_125:
 s_mov_b64 exec, -1
 buffer_load_dwordx4 v[12:15], v3, s[20:23], s41 offen offset:0 sc1
 buffer_load_dwordx4 v[16:19], v3, s[20:23], s41 offen offset:1024 sc1
 s_waitcnt lgkmcnt(0)
 s_barrier
 ds_read_b128 v[52:55], v3 offset:8192
 ds_read_b128 v[56:59], v3 offset:0
 ds_read_b128 v[60:63], v3 offset:1024
 buffer_store_dwordx4 v[64:67], v0, s[20:23], s38 offen sc1
 s_waitcnt lgkmcnt(2)
 v_smfmac_f32_16x16x64_bf16 v[36:39], v[52:55], a[136:143], v5
 v_smfmac_f32_16x16x64_bf16 v[40:43], v[52:55], a[144:151], v5
 v_smfmac_f32_16x16x64_bf16 v[44:47], v[52:55], a[152:159], v5
 s_waitcnt lgkmcnt(1)
 v_smfmac_f32_16x16x64_bf16 v[48:51], v[52:55], v[20:27], v5
 s_waitcnt vmcnt(3)
 v_smfmac_f32_16x16x64_bf16 v[36:39], v[56:59], v[72:79], v5
 ds_read_b128 v[20:23], v0 offset:40960
 v_mov_b64 v[64:65], 0
 v_smfmac_f32_16x16x64_bf16 v[40:43], v[56:59], v[80:87], v5
 ds_read_b128 v[24:27], v0 offset:45056
 v_mov_b64 v[66:67], 0
 v_smfmac_f32_16x16x64_bf16 v[44:47], v[56:59], v[88:95], v5
 ds_read_b128 v[52:55], v3 offset:2048
 s_waitcnt lgkmcnt(3)
 v_smfmac_f32_16x16x64_bf16 v[48:51], v[56:59], v[28:35], v5
 v_mov_b64 v[68:69], 0
 v_smfmac_f32_16x16x64_bf16 v[36:39], v[60:63], v[112:119], v5
 ds_read_b128 v[28:31], v0 offset:49152
 v_mov_b64 v[70:71], 0
 v_smfmac_f32_16x16x64_bf16 v[40:43], v[60:63], v[120:127], v5
 ds_read_b128 v[32:35], v0 offset:53248
 v_smfmac_f32_16x16x64_bf16 v[44:47], v[60:63], v[128:135], v5
 ds_read_b128 v[56:59], v3 offset:3072
 v_smfmac_f32_16x16x64_bf16 v[64:67], v[60:63], v[136:143], v5
 s_waitcnt vmcnt(1)
 ds_write_b128 v4, v[12:15] offset:0
 v_smfmac_f32_16x16x64_bf16 v[68:71], v[60:63], v[144:151], v5
 s_waitcnt lgkmcnt(4)
 v_smfmac_f32_16x16x64_bf16 v[48:51], v[60:63], v[20:27], v5
 ds_write_b128 v4, v[16:19] offset:1024
 v_max3_u32 v2, v12, v13, v14
 v_smfmac_f32_16x16x64_bf16 v[36:39], v[52:55], v[152:159], v5
 ds_read_b128 v[20:23], v0 offset:57344
 v_max3_u32 v2, v2, v15, v16
 v_smfmac_f32_16x16x64_bf16 v[40:43], v[52:55], v[160:167], v5
 ds_read_b128 v[24:27], v0 offset:61440
 v_max3_u32 v2, v2, v17, v18
 v_smfmac_f32_16x16x64_bf16 v[44:47], v[52:55], v[168:175], v5
 v_max_u32 v2, v2, v19
 v_smfmac_f32_16x16x64_bf16 v[64:67], v[52:55], v[176:183], v5
 v_cmp_eq_u32 vcc, -1, v2
 v_smfmac_f32_16x16x64_bf16 v[68:71], v[52:55], v[184:191], v5
 s_waitcnt lgkmcnt(4)
 v_add_u32 v0, 0x10000, v0
 v_smfmac_f32_16x16x64_bf16 v[48:51], v[52:55], v[28:35], v5
 s_cbranch_vccnz Lyr_127
Lyb_128:
 s_waitcnt lgkmcnt(2)
Ljoin_126:
 v_smfmac_f32_16x16x64_bf16 v[36:39], v[56:59], v[192:199], v5
 ds_read_b128 v[28:31], v0 offset:0
 buffer_load_dwordx4 v[12:15], v3, s[20:23], s59 offen offset:0 sc1
 v_smfmac_f32_16x16x64_bf16 v[40:43], v[56:59], v[200:207], v5
 ds_read_b128 v[32:35], v0 offset:4096
 buffer_load_dwordx4 v[16:19], v3, s[20:23], s59 offen offset:1024 sc1
 v_smfmac_f32_16x16x64_bf16 v[44:47], v[56:59], v[208:215], v5
 s_barrier
 ds_read_b128 v[60:63], v3 offset:4096
 v_smfmac_f32_16x16x64_bf16 v[64:67], v[56:59], v[216:223], v5
 ds_read_b128 v[52:55], v3 offset:5120
 v_smfmac_f32_16x16x64_bf16 v[68:71], v[56:59], v[224:231], v5
 s_waitcnt lgkmcnt(4)
 v_smfmac_f32_16x16x64_bf16 v[48:51], v[56:59], v[20:27], v5
 buffer_load_dword v1, v1, s[20:23], 0 offen sc1
 s_waitcnt lgkmcnt(1)
 v_smfmac_f32_16x16x64_bf16 v[36:39], v[60:63], v[232:239], v5
 ds_read_b128 v[20:23], v0 offset:8192
 v_smfmac_f32_16x16x64_bf16 v[40:43], v[60:63], v[240:247], v5
 ds_read_b128 v[24:27], v0 offset:12288
 v_smfmac_f32_16x16x64_bf16 v[44:47], v[60:63], v[248:255], v5
 ds_read_b128 v[56:59], v3 offset:6144
 s_waitcnt lgkmcnt(3)
 v_smfmac_f32_16x16x64_bf16 v[48:51], v[60:63], v[28:35], v5
 v_smfmac_f32_16x16x64_bf16 v[36:39], v[52:55], a[16:23], v5
 ds_read_b128 v[28:31], v0 offset:16384
 v_smfmac_f32_16x16x64_bf16 v[40:43], v[52:55], a[24:31], v5
 ds_read_b128 v[32:35], v0 offset:20480
 v_smfmac_f32_16x16x64_bf16 v[44:47], v[52:55], a[32:39], v5
 ds_read_b128 v[60:63], v3 offset:7168
 s_waitcnt lgkmcnt(3)
 v_smfmac_f32_16x16x64_bf16 v[48:51], v[52:55], v[20:27], v5
 v_smfmac_f32_16x16x64_bf16 v[36:39], v[56:59], a[56:63], v5
 ds_read_b128 v[20:23], v0 offset:24576
 v_smfmac_f32_16x16x64_bf16 v[40:43], v[56:59], a[64:71], v5
 ds_read_b128 v[24:27], v0 offset:28672
 s_waitcnt lgkmcnt(2)
 v_smfmac_f32_16x16x64_bf16 v[36:39], v[60:63], a[96:103], v5
 v_smfmac_f32_16x16x64_bf16 v[40:43], v[60:63], a[104:111], v5
 v_smfmac_f32_16x16x64_bf16 v[64:67], v[52:55], a[40:47], v5
 s_nop 0
 v_add_f32 v36, v36, v38
 v_smfmac_f32_16x16x64_bf16 v[68:71], v[52:55], a[48:55], v5
 ds_read_b128 v[52:55], v3 offset:8192
 v_add_f32 v37, v37, v39
 v_smfmac_f32_16x16x64_bf16 v[44:47], v[56:59], a[72:79], v5
 v_add_f32 v40, v40, v42
 v_add_f32 v41, v41, v43
 v_smfmac_f32_16x16x64_bf16 v[48:51], v[56:59], v[28:35], v5
 s_waitcnt lgkmcnt(1)
 v_cvt_pk_bf16_f32 v36, v36, v40
 v_smfmac_f32_16x16x64_bf16 v[44:47], v[60:63], a[112:119], v5
 ds_read_b128 v[32:35], v3 offset:11264
 v_cvt_pk_bf16_f32 v37, v37, v41
 v_smfmac_f32_16x16x64_bf16 v[48:51], v[60:63], v[20:27], v5
 ds_write2_b32 v10, v36, v37 offset0:0 offset1:16
 v_smfmac_f32_16x16x64_bf16 v[64:67], v[56:59], a[80:87], v5
 ds_read_b128 v[20:23], v3 offset:9216
 v_add_f32 v44, v44, v46
 v_add_f32 v45, v45, v47
 v_smfmac_f32_16x16x64_bf16 v[68:71], v[56:59], a[88:95], v5
 s_waitcnt lgkmcnt(3)
 v_add_f32 v48, v48, v50
 v_add_f32 v49, v49, v51
 v_cvt_pk_bf16_f32 v44, v44, v48
 v_cvt_pk_bf16_f32 v45, v45, v49
 ds_write2_b32 v8, v44, v45 offset0:0 offset1:16
 v_smfmac_f32_16x16x64_bf16 v[64:67], v[52:55], a[160:167], v5
 ds_read_b128 v[56:59], v3 offset:0
 v_mov_b64 v[28:29], 0
 v_smfmac_f32_16x16x64_bf16 v[68:71], v[52:55], a[168:175], v5
 ds_read_b128 v[52:55], v3 offset:4096
 v_mov_b64 v[30:31], 0
 v_smfmac_f32_16x16x64_bf16 v[64:67], v[60:63], a[120:127], v5
 ds_read_b128 v[24:27], v3 offset:10240
 v_smfmac_f32_16x16x64_bf16 v[68:71], v[60:63], a[128:135], v5
 s_waitcnt lgkmcnt(3)
 s_barrier
 ds_read_b128 v[36:39], v11 offset:17408
 s_waitcnt lgkmcnt(3)
 v_smfmac_f32_16x16x64_bf16 v[64:67], v[56:59], v[96:103], v5
 ds_read_b128 v[40:43], v11 offset:17920
 s_waitcnt lgkmcnt(3)
 v_smfmac_f32_16x16x64_bf16 v[68:71], v[56:59], v[104:111], v5
 ds_read_b128 v[60:63], v9 offset:19456
 ds_read_b128 v[44:47], v11 offset:18432
 v_smfmac_f32_16x16x64_bf16 v[64:67], v[52:55], a[0:7], v5
 ds_read_b128 v[48:51], v11 offset:18944
 v_smfmac_f32_16x16x64_bf16 v[68:71], v[52:55], a[8:15], v5
 ds_read_b128 v[52:55], v3 offset:12288
 s_waitcnt lgkmcnt(5)
 v_mfma_f32_16x16x32_bf16 v[20:23], v[20:23], v[36:39], 0
 ds_read_b128 v[56:59], v9 offset:21504
 v_mfma_f32_16x16x32_bf16 v[24:27], v[24:27], v[36:39], 0
 v_add_f32 v64, v64, v66
 v_add_f32 v65, v65, v67
 s_waitcnt lgkmcnt(5)
 v_mfma_f32_16x16x32_bf16 v[20:23], v[32:35], v[40:43], v[20:23]
 ds_read_b128 v[32:35], v3 offset:13312
 v_cvt_pk_bf16_f32 v2, v64, v65
 v_add_f32 v68, v68, v70
 s_waitcnt lgkmcnt(5)
 v_smfmac_f32_16x16x64_bf16 v[28:31], v[60:63], v[36:43], v5
 ds_read_b128 v[60:63], v3 offset:14336
 ds_read_b128 v[36:39], v3 offset:15360
 v_add_f32 v69, v69, v71
 s_waitcnt lgkmcnt(4)
 v_mfma_f32_16x16x32_bf16 v[24:27], v[52:55], v[40:43], v[24:27]
 ds_read_b128 v[52:55], v3 offset:16384
 v_cvt_pk_bf16_f32 v4, v68, v69
 s_waitcnt lgkmcnt(4)
 v_smfmac_f32_16x16x64_bf16 v[28:31], v[56:59], v[44:51], v5
 ds_read_b128 v[40:43], v0 offset:36864
 s_waitcnt lgkmcnt(4)
 v_mfma_f32_16x16x32_bf16 v[20:23], v[32:35], v[44:47], v[20:23]
 v_mov_b64 v[32:33], s[34:35]
 v_mov_b64 v[34:35], s[34:35]
 s_waitcnt lgkmcnt(3)
 v_mfma_f32_16x16x32_bf16 v[24:27], v[60:63], v[44:47], v[24:27]
 ds_read_b128 v[44:47], v0 offset:40960
 v_add_f32 v28, v28, v30
 v_add_f32 v29, v29, v31
 s_waitcnt lgkmcnt(3)
 v_mfma_f32_16x16x32_bf16 v[20:23], v[36:39], v[48:51], v[20:23]
 ds_read_b128 v[36:39], v0 offset:32768
 v_cndmask_b32 v28, v28, v29, s[48:49]
 v_mul_f32 v28, s55, v28
 s_waitcnt lgkmcnt(3)
 v_mfma_f32_16x16x32_bf16 v[24:27], v[52:55], v[48:51], v[24:27]
 ds_read_b128 v[48:51], v0 offset:45056
 v_exp_f32 v28, v28
 v_mov_b64 v[64:65], 0
 v_cndmask_b32 v29, 0, v28, s[48:49]
 v_cndmask_b32 v28, v28, 0, s[48:49]
 v_cvt_pk_bf16_f32 v6, v28, v29
 v_mov_b64 v[66:67], 0
 v_mov_b64 v[68:69], 0
 v_cndmask_b32 v20, v20, v24, s[48:49]
 v_cndmask_b32 v21, v21, v25, s[48:49]
 v_cndmask_b32 v22, v22, v26, s[48:49]
 v_cndmask_b32 v23, v23, v27, s[48:49]
 v_mfma_f32_16x16x16_bf16 v[60:63], v[6:7], v[32:33], 0
 s_waitcnt vmcnt(1)
 v_exp_f32 v20, v20
 v_mfma_f32_16x16x16_bf16 v[52:55], v[6:7], v[2:3], 0
 s_cmp_eq_u32 s36, 63
 v_exp_f32 v21, v21
 v_mfma_f32_16x16x16_bf16 v[56:59], v[6:7], v[4:5], 0
 v_exp_f32 v22, v22
 v_exp_f32 v23, v23
 v_cvt_pk_bf16_f32 v30, v20, v21
 v_cvt_pk_bf16_f32 v31, v22, v23
 v_mov_b64 v[70:71], 0
 v_mov_b64 v[20:21], 0
 v_smfmac_f32_16x16x32_bf16 v[60:63], v[30:31], v[32:35], v5
 v_mov_b64 v[22:23], 0
 v_mov_b64 v[24:25], 0
 v_smfmac_f32_16x16x32_bf16 v[52:55], v[30:31], v[12:15], v5
 v_mov_b64 v[26:27], 0
 v_smfmac_f32_16x16x32_bf16 v[56:59], v[30:31], v[16:19], v5
 s_nop 0
 v_add_f32 v60, v60, v62
 v_add_f32 v61, v61, v63
 v_rcp_f32 v60, v60
 v_rcp_f32 v61, v61
 v_add_f32 v52, v52, v54
 v_add_f32 v53, v53, v55
 v_mul_f32 v52, v52, v60
 v_mul_f32 v53, v53, v61
 v_add_f32 v56, v56, v58
 v_add_f32 v57, v57, v59
 v_mul_f32 v56, v56, v60
 v_mul_f32 v57, v57, v61
 v_cvt_pk_bf16_f32 v52, v52, v56
 v_cvt_pk_bf16_f32 v53, v53, v57
 ds_write2_b32 v8, v52, v53 offset0:128 offset1:144
 v_subrev_u32 v60, 0x21800000, v60
 v_subrev_u32 v61, 0x21800000, v61
 v_max_u32 v60, v60, v61
 v_cmp_lt_u32 vcc, 0x3c000000, v60
 s_cbranch_scc1 Lchexit_70
 v_mov_b64 v[28:29], 0
 v_mov_b64 v[30:31], 0
 v_mov_b64 v[32:33], 0
 v_mov_b64 v[34:35], 0
 s_cbranch_vccnz Lmx_129
Lmxb_130:
 s_waitcnt lgkmcnt(0)
 v_bfe_u32 v6, v0, 7, 5
 s_barrier
 ds_read_b128 v[52:55], v9 offset:19968
 v_mul_u32_u24 v6, 10496, v6
 ds_read_b128 v[56:59], v9 offset:22016
 ds_read_b128 v[12:15], v0 offset:49152
 v_bfe_u32 v60, v3, 4, 3
 ds_read_b128 v[16:19], v0 offset:53248
 s_add_u32 s67, s67, 0x80000
 v_lshl_add_u32 v6, v60, 3, v6
 s_xor_b32 s46, s46, 0x1
 s_add_u32 s59, s59, 0x80000
 v_mov_b64 v[60:61], 0
 s_add_u32 s38, s38, 0x20000
 v_mov_b64 v[62:63], 0
 s_waitcnt lgkmcnt(3)
 v_smfmac_f32_16x16x64_bf16 v[64:67], v[52:55], a[248:255], v5
 buffer_load_dwordx4 v3, s[20:23], s67 offen offset:0 sc1 lds
 v_smfmac_f32_16x16x64_bf16 v[68:71], v[52:55], a[176:183], v5
 s_waitcnt lgkmcnt(2)
 s_cmp_lt_u32 s36, 61
 v_smfmac_f32_16x16x64_bf16 v[64:67], v[56:59], v[36:43], v5
 ds_read_b128 v[36:39], v0 offset:57344
 buffer_load_dwordx4 v3, s[20:23], s67 offen offset:1024 sc1 lds
 v_smfmac_f32_16x16x64_bf16 v[20:23], v[52:55], a[184:191], v5
 ds_read_b128 v[40:43], v0 offset:61440
 s_cselect_b32 s47, 0x80000, 0
 v_add_u32 v0, 0x10000, v0
 v_smfmac_f32_16x16x64_bf16 v[68:71], v[56:59], v[44:51], v5
 ds_read_b128 v[44:47], v0 offset:0
 s_add_u32 s68, s68, s47
 v_add_f32 v64, v64, v66
 v_add_f32 v65, v65, v67
 v_cvt_pk_bf16_f32 v65, v65, v65
 v_smfmac_f32_16x16x64_bf16 v[24:27], v[52:55], a[192:199], v5
 ds_read_b128 v[48:51], v0 offset:4096
 s_waitcnt lgkmcnt(4)
 v_cvt_pk_bf16_f32 v64, v64, v64
 v_and_or_b32 v65, v65, -2, s46
 v_smfmac_f32_16x16x64_bf16 v[20:23], v[56:59], v[12:19], v5
 ds_read_b128 v[12:15], v0 offset:8192
 buffer_store_dwordx2 v[64:65], v6, s[20:23], s62 offen sc1
 v_add_f32 v68, v68, v70
 v_add_f32 v69, v69, v71
 v_smfmac_f32_16x16x64_bf16 v[28:31], v[52:55], a[200:207], v5
 ds_read_b128 v[16:19], v0 offset:12288
 s_waitcnt lgkmcnt(4)
 v_mov_b64 v[64:65], 0
 v_mov_b64 v[66:67], 0
 v_smfmac_f32_16x16x64_bf16 v[24:27], v[56:59], v[36:43], v5
 ds_read_b128 v[36:39], v0 offset:16384
 s_add_u32 s36, s36, 1
 v_add_f32 v20, v20, v22
 v_add_f32 v21, v21, v23
 v_cvt_pk_bf16_f32 v69, v69, v21
 v_smfmac_f32_16x16x64_bf16 v[32:35], v[52:55], a[208:215], v5
 ds_read_b128 v[40:43], v0 offset:20480
 s_waitcnt lgkmcnt(4)
 v_cvt_pk_bf16_f32 v68, v68, v20
 v_and_or_b32 v69, v69, -2, s46
 v_smfmac_f32_16x16x64_bf16 v[28:31], v[56:59], v[44:51], v5
 ds_read_b128 v[44:47], v0 offset:24576
 buffer_store_dwordx2 v[68:69], v6, s[20:23], s60 offen offset:0 sc1
 v_add_f32 v24, v24, v26
 v_add_f32 v25, v25, v27
 v_smfmac_f32_16x16x64_bf16 v[60:63], v[52:55], a[216:223], v5
 ds_read_b128 v[48:51], v0 offset:28672
 s_waitcnt lgkmcnt(4)
 v_mov_b64 v[20:21], 0
 v_mov_b64 v[22:23], 0
 v_smfmac_f32_16x16x64_bf16 v[32:35], v[56:59], v[12:19], v5
 s_add_u32 s58, s36, 2
 s_min_u32 s58, s58, 64
 v_add_f32 v28, v28, v30
 v_add_f32 v29, v29, v31
 v_cvt_pk_bf16_f32 v25, v25, v29
 v_smfmac_f32_16x16x64_bf16 v[64:67], v[52:55], a[224:231], v5
 s_waitcnt lgkmcnt(2)
 s_xor_b32 s44, s44, 0x80000
 v_cvt_pk_bf16_f32 v24, v24, v28
 v_and_or_b32 v25, v25, -2, s46
 v_smfmac_f32_16x16x64_bf16 v[60:63], v[56:59], v[36:43], v5
 buffer_store_dwordx2 v[24:25], v6, s[20:23], s60 offen offset:2048 sc1
 v_add_f32 v32, v32, v34
 v_smfmac_f32_16x16x64_bf16 v[20:23], v[52:55], a[232:239], v5
 s_waitcnt lgkmcnt(0)
 s_xor_b32 s45, s45, 0x80000
 v_add_f32 v33, v33, v35
 v_smfmac_f32_16x16x64_bf16 v[64:67], v[56:59], v[44:51], v5
 s_xor_b32 s65, s65, 0x80000
 s_xor_b32 s66, s66, 0x80000
 v_add_f32 v60, v60, v62
 v_add_f32 v61, v61, v63
 v_smfmac_f32_16x16x64_bf16 v[20:23], v[56:59], a[240:247], v5
 s_cmp_eq_u32 s4, 0
 v_cvt_pk_bf16_f32 v33, v33, v61
 v_cvt_pk_bf16_f32 v32, v32, v60
 v_and_or_b32 v33, v33, -2, s46
 buffer_store_dwordx2 v[32:33], v6, s[20:23], s61 offen offset:0 sc1
 v_add_f32 v64, v64, v66
 v_add_f32 v65, v65, v67
 s_nop 0
 v_add_f32 v20, v20, v22
 v_add_f32 v21, v21, v23
 v_cvt_pk_bf16_f32 v65, v65, v21
 v_cvt_pk_bf16_f32 v64, v64, v20
 v_and_or_b32 v65, v65, -2, s46
 buffer_store_dwordx2 v[64:65], v6, s[20:23], s61 offen offset:2048 sc1
 s_cbranch_scc1 LwH_131
 s_cmp_eq_u32 s4, 1
 s_cbranch_scc1 Lw_132
 s_cmp_eq_u32 s4, 2
 s_cbranch_scc1 Lw_133
 s_xor_b32 s41, s41, 0x80000
 s_xor_b32 s43, s43, 0x80000
 v_mov_b32 v47, 0x3f80
 v_cndmask_b32 v47, v47, 1.0, s[32:33]
 v_cndmask_b32 v44, 0, v47, s[24:25]
 v_cndmask_b32 v45, 0, v47, s[26:27]
 v_cndmask_b32 v46, 0, v47, s[28:29]
 v_cndmask_b32 v47, 0, v47, s[30:31]
 v_bfe_u32 v52, v3, 8, 2
 v_bfe_u32 v58, v3, 2, 4
 v_lshl_or_b32 v52, v52, 4, v58
 v_and_b32 v58, 0xc0, v3
 v_lshl_or_b32 v52, v58, 24, v52
 v_subrev_u32 v0, 0x20000, v0
 v_mov_b32 v59, -1
 v_add_u32 v54, s42, v3
 v_add_u32 v58, s69, v9
 ds_read_b64 v[64:65], v58 offset:19456
 v_mov_b32 v66, v2
 v_mov_b32 v67, v4
 v_mov_b64 v[68:69], 0
 v_mov_b64 v[70:71], 0
 ds_read_b128 v[20:23], v0 offset:24576
 ds_read_b128 v[24:27], v0 offset:28672
 ds_read_b128 v[28:31], v0 offset:32768
 ds_read_b128 v[32:35], v0 offset:36864
 s_waitcnt vmcnt(0)
 buffer_load_dwordx4 v[36:39], v3, s[20:23], s39 offen offset:0 sc1
 buffer_load_dwordx4 v[40:43], v3, s[20:23], s39 offen offset:1024 sc1
 s_nop 15
 s_nop 10
 buffer_load_dwordx4 v[12:15], v3, s[20:23], s39 offen offset:0 sc1
 buffer_load_dwordx4 v[16:19], v3, s[20:23], s39 offen offset:1024 sc1
 s_waitcnt vmcnt(3)
 v_mfma_f32_16x16x32_bf16 v[48:51], v[44:47], v[36:39], 0
 s_waitcnt vmcnt(2)
 v_mfma_f32_16x16x32_bf16 v[48:51], v[44:47], v[40:43], v[48:51]
 v_bitop3_b32 v55, v37, v39, s46 bitop3:0x7e
 v_bitop3_b32 v56, v41, v43, s46 bitop3:0x7e
 v_bitop3_b32 v55, v55, 1, v56 bitop3:0xc8
 v_cmp_ne_u32 vcc, 0, v55
 s_nop 3
 v_add_f32_dpp v48, v48, v48 row_ror:4 row_mask:0xf bank_mask:0xf
 v_add_f32_dpp v49, v49, v49 row_ror:4 row_mask:0xf bank_mask:0xf
 s_cbranch_vccnz Lr2_135
 v_add_f32_dpp v48, v48, v48 row_ror:8 row_mask:0xf bank_mask:0xf
 v_add_f32_dpp v49, v49, v49 row_ror:8 row_mask:0xf bank_mask:0xf
 v_cvt_pk_bf16_f32 v48, v48, v49
 buffer_store_dword v48, v52, s[20:23], s44 offen sc1
Lb1_136:
 buffer_store_dword v59, v52, s[20:23], s45 offen sc1
 v_cmp_gt_u32 vcc, s58, v1
 v_mov_b64 v[36:37], 0
 v_mov_b64 v[38:39], 0
 v_mov_b64 v[40:41], 0
 v_mov_b64 v[42:43], 0
 v_mov_b64 v[44:45], 0
 v_mov_b64 v[46:47], 0
 v_mov_b64 v[48:49], 0
 v_mov_b64 v[50:51], 0
 s_cmp_lg_u32 vcc_hi, 0
 s_cbranch_scc1 Lfw_138
Lfok_137:
 v_lshl_add_u32 v1, v3, 3, s68
 v_mov_b32 v6, s56
 v_cndmask_b32 v1, v6, v1, s[70:71]
 v_mov_b32 v4, v54
 s_waitcnt vmcnt(0)
 s_nop 15
 s_nop 15
 s_nop 11
 s_branch LstepB_125
Lw_133:
 s_xor_b32 s41, s41, 0x80000
 s_xor_b32 s43, s43, 0x80000
 v_mov_b32 v47, 0x3f80
 v_cndmask_b32 v47, v47, 1.0, s[32:33]
 v_cndmask_b32 v44, 0, v47, s[24:25]
 v_cndmask_b32 v45, 0, v47, s[26:27]
 v_cndmask_b32 v46, 0, v47, s[28:29]
 v_cndmask_b32 v47, 0, v47, s[30:31]
 v_bfe_u32 v52, v3, 8, 2
 v_bfe_u32 v58, v3, 2, 4
 v_lshl_or_b32 v52, v52, 4, v58
 v_and_b32 v58, 0xc0, v3
 v_lshl_or_b32 v52, v58, 24, v52
 v_subrev_u32 v0, 0x20000, v0
 v_mov_b32 v59, -1
 v_add_u32 v54, s42, v3
 v_add_u32 v58, s69, v9
 ds_read_b64 v[64:65], v58 offset:19456
 v_mov_b32 v66, v2
 v_mov_b32 v67, v4
 v_mov_b64 v[68:69], 0
 v_mov_b64 v[70:71], 0
 ds_read_b128 v[20:23], v0 offset:24576
 ds_read_b128 v[24:27], v0 offset:28672
 ds_read_b128 v[28:31], v0 offset:32768
 ds_read_b128 v[32:35], v0 offset:36864
 s_waitcnt vmcnt(1)
 buffer_load_dwordx4 v[36:39], v3, s[20:23], s39 offen offset:0 sc1
 buffer_load_dwordx4 v[40:43], v3, s[20:23], s39 offen offset:1024 sc1
 s_nop 15
 s_nop 10
 buffer_load_dwordx4 v[12:15], v3, s[20:23], s39 offen offset:0 sc1
 buffer_load_dwordx4 v[16:19], v3, s[20:23], s39 offen offset:1024 sc1
 s_waitcnt vmcnt(3)
 v_mfma_f32_16x16x32_bf16 v[48:51], v[44:47], v[36:39], 0
 s_waitcnt vmcnt(2)
 v_mfma_f32_16x16x32_bf16 v[48:51], v[44:47], v[40:43], v[48:51]
 v_bitop3_b32 v55, v37, v39, s46 bitop3:0x7e
 v_bitop3_b32 v56, v41, v43, s46 bitop3:0x7e
 v_bitop3_b32 v55, v55, 1, v56 bitop3:0xc8
 v_cmp_ne_u32 vcc, 0, v55
 s_nop 3
 v_add_f32_dpp v48, v48, v48 row_ror:4 row_mask:0xf bank_mask:0xf
 v_add_f32_dpp v49, v49, v49 row_ror:4 row_mask:0xf bank_mask:0xf
 s_cbranch_vccnz Lr2_141
 v_add_f32_dpp v48, v48, v48 row_ror:8 row_mask:0xf bank_mask:0xf
 v_add_f32_dpp v49, v49, v49 row_ror:8 row_mask:0xf bank_mask:0xf
 v_cvt_pk_bf16_f32 v48, v48, v49
 buffer_store_dword v48, v52, s[20:23], s44 offen sc1
Lb1_142:
 buffer_store_dword v59, v52, s[20:23], s45 offen sc1
 v_cmp_gt_u32 vcc, s58, v1
 v_mov_b64 v[36:37], 0
 v_mov_b64 v[38:39], 0
 v_mov_b64 v[40:41], 0
 v_mov_b64 v[42:43], 0
 v_mov_b64 v[44:45], 0
 v_mov_b64 v[46:47], 0
 v_mov_b64 v[48:49], 0
 v_mov_b64 v[50:51], 0
 s_cmp_lg_u32 vcc_hi, 0
 s_cbranch_scc1 Lfw_144
Lfok_143:
 v_lshl_add_u32 v1, v3, 3, s68
 v_mov_b32 v6, s56
 v_cndmask_b32 v1, v6, v1, s[70:71]
 v_mov_b32 v4, v54
 s_nop 7
 buffer_load_dwordx4 v[68:71], v3, s[20:23], s43 offen offset:0 sc1
 s_nop 15
 s_nop 7
Lp2_145:
 buffer_load_dwordx4 v[68:71], v3, s[20:23], s43 offen offset:0 sc1
 s_waitcnt vmcnt(1)
 v_max3_u32 v55, v68, v69, v70
 v_max_u32 v55, v55, v71
 ds_write_b128 v3, v[68:71] offset:8192
 v_cmpx_eq_u32 vcc, -1, v55
 s_cbranch_execz LstepB_125
 buffer_load_dwordx4 v[68:71], v3, s[20:23], s43 offen offset:0 sc1
 s_waitcnt vmcnt(1)
 v_max3_u32 v55, v68, v69, v70
 v_max_u32 v55, v55, v71
 ds_write_b128 v3, v[68:71] offset:8192
 v_cmpx_eq_u32 vcc, -1, v55
 s_cbranch_execz LstepB_125
 buffer_load_dwordx4 v[68:71], v3, s[20:23], s43 offen offset:0 sc1
 s_waitcnt vmcnt(1)
 v_max3_u32 v55, v68, v69, v70
 v_max_u32 v55, v55, v71
 ds_write_b128 v3, v[68:71] offset:8192
 v_cmpx_eq_u32 vcc, -1, v55
 s_cbranch_execz LstepB_125
 s_sub_u32 s54, s54, 1
 s_cbranch_scc0 Lp2_145
 s_endpgm
Lw_132:
 s_waitcnt vmcnt(2)
 buffer_load_dwordx4 v[36:39], v3, s[20:23], s39 offen offset:0 sc1
 buffer_load_dwordx4 v[40:43], v3, s[20:23], s39 offen offset:1024 sc1
 s_xor_b32 s41, s41, 0x80000
 s_xor_b32 s43, s43, 0x80000
 v_mov_b32 v47, 0x3f80
 v_cndmask_b32 v47, v47, 1.0, s[32:33]
 v_cndmask_b32 v44, 0, v47, s[24:25]
 v_cndmask_b32 v45, 0, v47, s[26:27]
 v_cndmask_b32 v46, 0, v47, s[28:29]
 v_cndmask_b32 v47, 0, v47, s[30:31]
 v_bfe_u32 v52, v3, 8, 2
 v_bfe_u32 v58, v3, 2, 4
 v_lshl_or_b32 v52, v52, 4, v58
 v_and_b32 v58, 0xc0, v3
 v_lshl_or_b32 v52, v58, 24, v52
 v_subrev_u32 v0, 0x20000, v0
 v_mov_b32 v59, -1
 v_add_u32 v54, s42, v3
 v_add_u32 v58, s69, v9
 ds_read_b64 v[64:65], v58 offset:19456
 v_mov_b32 v66, v2
 v_mov_b32 v67, v4
 v_mov_b64 v[68:69], 0
 v_mov_b64 v[70:71], 0
 ds_read_b128 v[20:23], v0 offset:24576
 ds_read_b128 v[24:27], v0 offset:28672
 ds_read_b128 v[28:31], v0 offset:32768
 ds_read_b128 v[32:35], v0 offset:36864
 s_nop 3
 buffer_load_dwordx4 v[12:15], v3, s[20:23], s39 offen offset:0 sc1
 buffer_load_dwordx4 v[16:19], v3, s[20:23], s39 offen offset:1024 sc1
 s_waitcnt vmcnt(3)
 v_mfma_f32_16x16x32_bf16 v[48:51], v[44:47], v[36:39], 0
 s_waitcnt vmcnt(2)
 v_mfma_f32_16x16x32_bf16 v[48:51], v[44:47], v[40:43], v[48:51]
 v_bitop3_b32 v55, v37, v39, s46 bitop3:0x7e
 v_bitop3_b32 v56, v41, v43, s46 bitop3:0x7e
 v_bitop3_b32 v55, v55, 1, v56 bitop3:0xc8
 v_cmp_ne_u32 vcc, 0, v55
 s_nop 3
 v_add_f32_dpp v48, v48, v48 row_ror:4 row_mask:0xf bank_mask:0xf
 v_add_f32_dpp v49, v49, v49 row_ror:4 row_mask:0xf bank_mask:0xf
 s_cbranch_vccnz Lr2_147
 v_add_f32_dpp v48, v48, v48 row_ror:8 row_mask:0xf bank_mask:0xf
 v_add_f32_dpp v49, v49, v49 row_ror:8 row_mask:0xf bank_mask:0xf
 v_cvt_pk_bf16_f32 v48, v48, v49
 buffer_store_dword v48, v52, s[20:23], s44 offen sc1
Lb1_148:
 buffer_store_dword v59, v52, s[20:23], s45 offen sc1
 v_cmp_gt_u32 vcc, s58, v1
 v_mov_b64 v[36:37], 0
 v_mov_b64 v[38:39], 0
 v_mov_b64 v[40:41], 0
 v_mov_b64 v[42:43], 0
 v_mov_b64 v[44:45], 0
 v_mov_b64 v[46:47], 0
 v_mov_b64 v[48:49], 0
 v_mov_b64 v[50:51], 0
 s_cmp_lg_u32 vcc_hi, 0
 s_cbranch_scc1 Lfw_150
Lfok_149:
 v_lshl_add_u32 v1, v3, 3, s68
 v_mov_b32 v6, s56
 v_cndmask_b32 v1, v6, v1, s[70:71]
 v_min_u32 v6, 16, v0
 v_lshlrev_b32 v6, 24, v6
 s_max_u32 s47, s36, 1
 v_add_u32 v2, -1, s47
 s_nop 15
 s_nop 0
 buffer_load_dwordx4 v[12:15], v3, s[20:23], s41 offen offset:0 sc1
 buffer_load_dwordx4 v[16:19], v3, s[20:23], s41 offen offset:1024 sc1
 s_nop 15
 s_nop 7
Lp2_151:
 buffer_load_dwordx4 v[12:15], v3, s[20:23], s41 offen offset:0 sc1
 buffer_load_dwordx4 v[16:19], v3, s[20:23], s41 offen offset:1024 sc1
 s_waitcnt vmcnt(2)
 v_max3_u32 v55, v12, v13, v14
 v_max3_u32 v55, v55, v15, v16
 v_max3_u32 v55, v55, v17, v18
 v_max_u32 v55, v55, v19
 ds_write_b128 v54, v[12:15] offset:0
 ds_write_b128 v54, v[16:19] offset:1024
 v_cmpx_eq_u32 vcc, -1, v55
 s_cbranch_execz Lstep_123
 buffer_load_dwordx4 v[12:15], v3, s[20:23], s41 offen offset:0 sc1
 buffer_load_dwordx4 v[16:19], v3, s[20:23], s41 offen offset:1024 sc1
 s_waitcnt vmcnt(2)
 v_max3_u32 v55, v12, v13, v14
 v_max3_u32 v55, v55, v15, v16
 v_max3_u32 v55, v55, v17, v18
 v_max_u32 v55, v55, v19
 ds_write_b128 v54, v[12:15] offset:0
 ds_write_b128 v54, v[16:19] offset:1024
 v_cmpx_eq_u32 vcc, -1, v55
 s_cbranch_execz Lstep_123
 buffer_load_dwordx4 v[12:15], v3, s[20:23], s41 offen offset:0 sc1
 buffer_load_dwordx4 v[16:19], v3, s[20:23], s41 offen offset:1024 sc1
 s_waitcnt vmcnt(2)
 v_max3_u32 v55, v12, v13, v14
 v_max3_u32 v55, v55, v15, v16
 v_max3_u32 v55, v55, v17, v18
 v_max_u32 v55, v55, v19
 ds_write_b128 v54, v[12:15] offset:0
 ds_write_b128 v54, v[16:19] offset:1024
 v_cmpx_eq_u32 vcc, -1, v55
 s_cbranch_execz Lstep_123
 s_sub_u32 s54, s54, 1
 s_cbranch_scc0 Lp2_151
 s_endpgm
LwH_131:
 v_bfe_u32 v53, v3, 8, 1
 v_bfe_u32 v58, v3, 9, 1
 v_lshl_or_b32 v53, v53, 1, v58
 v_bfe_u32 v58, v3, 5, 1
 v_lshl_or_b32 v53, v53, 1, v58
 v_and_b32 v58, 0xd0, v3
 v_lshlrev_b32 v58, 24, v58
 v_lshl_or_b32 v53, v53, 2, v58
 s_waitcnt vmcnt(3)
 s_nop 7
 buffer_load_dwordx4 v[20:23], v3, s[20:23], s40 offen offset:0 sc1
 buffer_load_dwordx4 v[24:27], v3, s[20:23], s40 offen offset:1024 sc1
 buffer_load_dwordx4 v[36:39], v3, s[20:23], s39 offen offset:0 sc1
 buffer_load_dwordx4 v[40:43], v3, s[20:23], s39 offen offset:1024 sc1
 s_xor_b32 s41, s41, 0x80000
 s_xor_b32 s43, s43, 0x80000
 v_mov_b32 v47, 0x3f80
 v_cndmask_b32 v47, v47, 1.0, s[32:33]
 v_cndmask_b32 v44, 0, v47, s[24:25]
 v_cndmask_b32 v45, 0, v47, s[26:27]
 v_cndmask_b32 v46, 0, v47, s[28:29]
 v_cndmask_b32 v47, 0, v47, s[30:31]
 v_bfe_u32 v52, v3, 8, 2
 v_bfe_u32 v58, v3, 2, 4
 v_lshl_or_b32 v52, v52, 4, v58
 v_and_b32 v58, 0xc0, v3
 v_lshl_or_b32 v52, v58, 24, v52
 v_subrev_u32 v0, 0x20000, v0
 v_mov_b32 v59, -1
 v_add_u32 v54, s42, v3
 v_add_u32 v58, s69, v9
 ds_read_b64 v[64:65], v58 offset:19456
 v_mov_b32 v66, v2
 v_mov_b32 v67, v4
 v_mov_b64 v[68:69], 0
 v_mov_b64 v[70:71], 0
 s_waitcnt vmcnt(2)
 v_mfma_f32_16x16x32_bf16 v[28:31], v[44:47], v[20:23], 0
 v_mfma_f32_16x16x32_bf16 v[28:31], v[44:47], v[24:27], v[28:31]
 s_waitcnt vmcnt(1)
 v_mfma_f32_16x16x32_bf16 v[48:51], v[44:47], v[36:39], 0
 s_waitcnt vmcnt(0)
 v_mfma_f32_16x16x32_bf16 v[48:51], v[44:47], v[40:43], v[48:51]
 v_bitop3_b32 v55, v37, v39, s46 bitop3:0x7e
 v_bitop3_b32 v56, v41, v43, s46 bitop3:0x7e
 v_bitop3_b32 v57, v21, v23, s46 bitop3:0x7e
 v_or3_b32 v55, v55, v56, v57
 v_bitop3_b32 v56, v25, v27, s46 bitop3:0x7e
 v_bitop3_b32 v55, v55, 1, v56 bitop3:0xc8
 v_cmp_ne_u32 vcc, 0, v55
 v_add_f32_dpp v29, v29, v29 row_ror:4 row_mask:0xf bank_mask:0xf
 v_add_f32_dpp v48, v48, v48 row_ror:4 row_mask:0xf bank_mask:0xf
 v_add_f32_dpp v49, v49, v49 row_ror:4 row_mask:0xf bank_mask:0xf
 v_add_f32_dpp v29, v29, v29 row_ror:8 row_mask:0xf bank_mask:0xf
 v_add_f32_dpp v48, v48, v48 row_ror:8 row_mask:0xf bank_mask:0xf
 v_add_f32_dpp v49, v49, v49 row_ror:8 row_mask:0xf bank_mask:0xf
 s_cbranch_vccnz Lr1_152
 v_cvt_pk_bf16_f32 v48, v48, v49
 buffer_store_dword v48, v52, s[20:23], s44 offen sc1
 v_mov_b32_dpp v30, v29 quad_perm:[1,0,3,2] row_mask:0xf bank_mask:0xf
 v_cvt_pk_bf16_f32 v29, v29, v30
 buffer_store_dword v29, v53, s[20:23], s65 offen sc1
Lb1_153:
 buffer_store_dword v59, v52, s[20:23], s45 offen sc1
 buffer_store_dword v59, v53, s[20:23], s66 offen sc1
 v_cmp_gt_u32 vcc, s58, v1
 ds_read_b128 v[20:23], v0 offset:24576
 ds_read_b128 v[24:27], v0 offset:28672
 ds_read_b128 v[28:31], v0 offset:32768
 ds_read_b128 v[32:35], v0 offset:36864
 v_mov_b64 v[36:37], 0
 v_mov_b64 v[38:39], 0
 v_mov_b64 v[40:41], 0
 v_mov_b64 v[42:43], 0
 v_mov_b64 v[44:45], 0
 v_mov_b64 v[46:47], 0
 v_mov_b64 v[48:49], 0
 v_mov_b64 v[50:51], 0
 s_cmp_lg_u32 vcc_hi, 0
 s_cbranch_scc1 Lfw_155
Lfok_154:
 v_lshl_add_u32 v1, v3, 3, s68
 v_mov_b32 v6, s56
 v_cndmask_b32 v1, v6, v1, s[70:71]
 v_min_u32 v6, 16, v0
 v_lshlrev_b32 v6, 24, v6
 s_max_u32 s47, s36, 1
 v_add_u32 v2, -1, s47
 s_nop 10
 buffer_load_dwordx4 v[12:15], v3, s[20:23], s41 offen offset:0 sc1
 buffer_load_dwordx4 v[16:19], v3, s[20:23], s41 offen offset:1024 sc1
 s_nop 15
 s_nop 7
Lp2_156:
 buffer_load_dwordx4 v[12:15], v3, s[20:23], s41 offen offset:0 sc1
 buffer_load_dwordx4 v[16:19], v3, s[20:23], s41 offen offset:1024 sc1
 s_waitcnt vmcnt(2)
 v_max3_u32 v55, v12, v13, v14
 v_max3_u32 v55, v55, v15, v16
 v_max3_u32 v55, v55, v17, v18
 v_max_u32 v55, v55, v19
 ds_write_b128 v54, v[12:15] offset:0
 ds_write_b128 v54, v[16:19] offset:1024
 v_cmpx_eq_u32 vcc, -1, v55
 s_cbranch_execz Lstep_123
 buffer_load_dwordx4 v[12:15], v3, s[20:23], s41 offen offset:0 sc1
 buffer_load_dwordx4 v[16:19], v3, s[20:23], s41 offen offset:1024 sc1
 s_waitcnt vmcnt(2)
 v_max3_u32 v55, v12, v13, v14
 v_max3_u32 v55, v55, v15, v16
 v_max3_u32 v55, v55, v17, v18
 v_max_u32 v55, v55, v19
 ds_write_b128 v54, v[12:15] offset:0
 ds_write_b128 v54, v[16:19] offset:1024
 v_cmpx_eq_u32 vcc, -1, v55
 s_cbranch_execz Lstep_123
 buffer_load_dwordx4 v[12:15], v3, s[20:23], s41 offen offset:0 sc1
 buffer_load_dwordx4 v[16:19], v3, s[20:23], s41 offen offset:1024 sc1
 s_waitcnt vmcnt(2)
 v_max3_u32 v55, v12, v13, v14
 v_max3_u32 v55, v55, v15, v16
 v_max3_u32 v55, v55, v17, v18
 v_max_u32 v55, v55, v19
 ds_write_b128 v54, v[12:15] offset:0
 ds_write_b128 v54, v[16:19] offset:1024
 v_cmpx_eq_u32 vcc, -1, v55
 s_cbranch_execz Lstep_123
 s_sub_u32 s54, s54, 1
 s_cbranch_scc0 Lp2_156
 s_endpgm
Lr1_152:
 s_mov_b64 exec, vcc
Lrt_157:
 buffer_load_dwordx4 v[20:23], v3, s[20:23], s40 offen offset:0 sc1
 buffer_load_dwordx4 v[24:27], v3, s[20:23], s40 offen offset:1024 sc1
 buffer_load_dwordx4 v[36:39], v3, s[20:23], s39 offen offset:0 sc1
 buffer_load_dwordx4 v[40:43], v3, s[20:23], s39 offen offset:1024 sc1
 s_waitcnt vmcnt(4)
 v_bitop3_b32 v55, v37, v39, s46 bitop3:0x7e
 v_bitop3_b32 v56, v41, v43, s46 bitop3:0x7e
 v_bitop3_b32 v57, v21, v23, s46 bitop3:0x7e
 v_or3_b32 v55, v55, v56, v57
 v_bitop3_b32 v56, v25, v27, s46 bitop3:0x7e
 v_bitop3_b32 v55, v55, 1, v56 bitop3:0xc8
 v_cmpx_ne_u32 vcc, 0, v55
 s_cbranch_execz Lrte_158
 buffer_load_dwordx4 v[20:23], v3, s[20:23], s40 offen offset:0 sc1
 buffer_load_dwordx4 v[24:27], v3, s[20:23], s40 offen offset:1024 sc1
 buffer_load_dwordx4 v[36:39], v3, s[20:23], s39 offen offset:0 sc1
 buffer_load_dwordx4 v[40:43], v3, s[20:23], s39 offen offset:1024 sc1
 s_waitcnt vmcnt(4)
 v_bitop3_b32 v55, v37, v39, s46 bitop3:0x7e
 v_bitop3_b32 v56, v41, v43, s46 bitop3:0x7e
 v_bitop3_b32 v57, v21, v23, s46 bitop3:0x7e
 v_or3_b32 v55, v55, v56, v57
 v_bitop3_b32 v56, v25, v27, s46 bitop3:0x7e
 v_bitop3_b32 v55, v55, 1, v56 bitop3:0xc8
 v_cmpx_ne_u32 vcc, 0, v55
 s_cbranch_execz Lrte_158
 buffer_load_dwordx4 v[20:23], v3, s[20:23], s40 offen offset:0 sc1
 buffer_load_dwordx4 v[24:27], v3, s[20:23], s40 offen offset:1024 sc1
 buffer_load_dwordx4 v[36:39], v3, s[20:23], s39 offen offset:0 sc1
 buffer_load_dwordx4 v[40:43], v3, s[20:23], s39 offen offset:1024 sc1
 s_waitcnt vmcnt(4)
 v_bitop3_b32 v55, v37, v39, s46 bitop3:0x7e
 v_bitop3_b32 v56, v41, v43, s46 bitop3:0x7e
 v_bitop3_b32 v57, v21, v23, s46 bitop3:0x7e
 v_or3_b32 v55, v55, v56, v57
 v_bitop3_b32 v56, v25, v27, s46 bitop3:0x7e
 v_bitop3_b32 v55, v55, 1, v56 bitop3:0xc8
 v_cmpx_ne_u32 vcc, 0, v55
 s_cbranch_execz Lrte_158
 s_sub_u32 s54, s54, 1
 s_cbranch_scc0 Lrt_157
 s_endpgm
Lrte_158:
 s_mov_b64 exec, -1
 s_nop 2
 v_mfma_f32_16x16x32_bf16 v[28:31], v[44:47], v[20:23], 0
 v_mfma_f32_16x16x32_bf16 v[28:31], v[44:47], v[24:27], v[28:31]
 v_mfma_f32_16x16x32_bf16 v[48:51], v[44:47], v[36:39], 0
 v_mfma_f32_16x16x32_bf16 v[48:51], v[44:47], v[40:43], v[48:51]
 s_nop 6
 v_add_f32_dpp v29, v29, v29 row_ror:4 row_mask:0xf bank_mask:0xf
 v_add_f32_dpp v48, v48, v48 row_ror:4 row_mask:0xf bank_mask:0xf
 v_add_f32_dpp v49, v49, v49 row_ror:4 row_mask:0xf bank_mask:0xf
 v_add_f32_dpp v29, v29, v29 row_ror:8 row_mask:0xf bank_mask:0xf
 v_add_f32_dpp v48, v48, v48 row_ror:8 row_mask:0xf bank_mask:0xf
 v_add_f32_dpp v49, v49, v49 row_ror:8 row_mask:0xf bank_mask:0xf
 v_cvt_pk_bf16_f32 v48, v48, v49
 buffer_store_dword v48, v52, s[20:23], s44 offen sc1
 v_mov_b32_dpp v30, v29 quad_perm:[1,0,3,2] row_mask:0xf bank_mask:0xf
 v_cvt_pk_bf16_f32 v29, v29, v30
 buffer_store_dword v29, v53, s[20:23], s65 offen sc1
 s_waitcnt vmcnt(2)
 s_branch Lb1_153
Lyr_127:
 s_mov_b64 exec, vcc
Lrt_159:
 buffer_load_dwordx4 v[12:15], v3, s[20:23], s41 offen offset:0 sc1
 buffer_load_dwordx4 v[16:19], v3, s[20:23], s41 offen offset:1024 sc1
 s_waitcnt vmcnt(2)
 v_max3_u32 v2, v12, v13, v14
 v_max3_u32 v2, v2, v15, v16
 v_max3_u32 v2, v2, v17, v18
 v_max_u32 v2, v2, v19
 v_cmpx_eq_u32 vcc, -1, v2
 s_cbranch_execz Lrte_160
 buffer_load_dwordx4 v[12:15], v3, s[20:23], s41 offen offset:0 sc1
 buffer_load_dwordx4 v[16:19], v3, s[20:23], s41 offen offset:1024 sc1
 s_waitcnt vmcnt(2)
 v_max3_u32 v2, v12, v13, v14
 v_max3_u32 v2, v2, v15, v16
 v_max3_u32 v2, v2, v17, v18
 v_max_u32 v2, v2, v19
 v_cmpx_eq_u32 vcc, -1, v2
 s_cbranch_execz Lrte_160
 buffer_load_dwordx4 v[12:15], v3, s[20:23], s41 offen offset:0 sc1
 buffer_load_dwordx4 v[16:19], v3, s[20:23], s41 offen offset:1024 sc1
 s_waitcnt vmcnt(2)
 v_max3_u32 v2, v12, v13, v14
 v_max3_u32 v2, v2, v15, v16
 v_max3_u32 v2, v2, v17, v18
 v_max_u32 v2, v2, v19
 v_cmpx_eq_u32 vcc, -1, v2
 s_cbranch_execz Lrte_160
 s_sub_u32 s54, s54, 1
 s_cbranch_scc0 Lrt_159
 s_endpgm
Lrte_160:
 s_mov_b64 exec, -1
 ds_write_b128 v4, v[12:15] offset:0
 ds_write_b128 v4, v[16:19] offset:1024
 s_waitcnt lgkmcnt(0)
 s_branch Lyb_128
Lmx_129:
 s_waitcnt lgkmcnt(0)
 ds_read_b128 v[36:39], v11 offset:17408
 ds_read_b128 v[40:43], v11 offset:17920
 ds_read_b128 v[44:47], v11 offset:18432
 ds_read_b128 v[48:51], v11 offset:18944
 v_mov_b64 v[28:29], 0
 v_mov_b64 v[30:31], 0
 ds_read_b128 v[52:55], v3 offset:9216
 ds_read_b128 v[56:59], v3 offset:10240
 s_waitcnt lgkmcnt(0)
 v_mfma_f32_16x16x32_bf16 v[20:23], v[52:55], v[36:39], 0
 v_mfma_f32_16x16x32_bf16 v[24:27], v[56:59], v[36:39], 0
 ds_read_b128 v[52:55], v3 offset:11264
 ds_read_b128 v[56:59], v3 offset:12288
 s_waitcnt lgkmcnt(0)
 v_mfma_f32_16x16x32_bf16 v[20:23], v[52:55], v[40:43], v[20:23]
 v_mfma_f32_16x16x32_bf16 v[24:27], v[56:59], v[40:43], v[24:27]
 ds_read_b128 v[52:55], v3 offset:13312
 ds_read_b128 v[56:59], v3 offset:14336
 s_waitcnt lgkmcnt(0)
 v_mfma_f32_16x16x32_bf16 v[20:23], v[52:55], v[44:47], v[20:23]
 v_mfma_f32_16x16x32_bf16 v[24:27], v[56:59], v[44:47], v[24:27]
 ds_read_b128 v[52:55], v3 offset:15360
 ds_read_b128 v[56:59], v3 offset:16384
 s_waitcnt lgkmcnt(0)
 v_mfma_f32_16x16x32_bf16 v[20:23], v[52:55], v[48:51], v[20:23]
 v_mfma_f32_16x16x32_bf16 v[24:27], v[56:59], v[48:51], v[24:27]
 ds_read_b128 v[52:55], v9 offset:19456
 ds_read_b128 v[56:59], v9 offset:21504
 s_waitcnt lgkmcnt(0)
 v_smfmac_f32_16x16x64_bf16 v[28:31], v[52:55], v[36:43], v5
 v_smfmac_f32_16x16x64_bf16 v[28:31], v[56:59], v[44:51], v5
 ds_read_b128 v[36:39], v0 offset:32768
 ds_read_b128 v[40:43], v0 offset:36864
 ds_read_b128 v[44:47], v0 offset:40960
 ds_read_b128 v[48:51], v0 offset:45056
 v_mov_b64 v[32:33], s[34:35]
 v_mov_b64 v[34:35], s[34:35]
 s_nop 1
 v_add_f32 v28, v28, v30
 v_add_f32 v29, v29, v31
 v_mul_f32 v28, s55, v28
 v_mul_f32 v29, s55, v29
 v_max_f32 v30, v28, v29
 v_cndmask_b32 v28, v28, v29, s[48:49]
 v_max3_f32 v30, v30, v20, v21
 v_max3_f32 v30, v30, v22, v23
 v_max3_f32 v30, v30, v24, v25
 v_max3_f32 v31, v30, v26, v27
 v_max3_f32 v29, v30, v26, v27
 v_cndmask_b32 v20, v20, v24, s[48:49]
 v_cndmask_b32 v21, v21, v25, s[48:49]
 v_permlane16_swap_b32 v31, v29
 v_max_f32 v30, v31, v29
 v_max_f32 v6, v31, v29
 v_cndmask_b32 v22, v22, v26, s[48:49]
 v_cndmask_b32 v23, v23, v27, s[48:49]
 v_permlane32_swap_b32 v30, v6
 v_max_f32 v30, v30, v6
 v_sub_f32 v28, v28, v30
 v_sub_f32 v20, v20, v30
 v_sub_f32 v21, v21, v30
 v_sub_f32 v22, v22, v30
 v_sub_f32 v23, v23, v30
 v_exp_f32 v28, v28
 v_exp_f32 v20, v20
 v_exp_f32 v21, v21
 v_exp_f32 v22, v22
 v_exp_f32 v23, v23
 v_cndmask_b32 v29, 0, v28, s[48:49]
 v_cndmask_b32 v28, v28, 0, s[48:49]
 v_cvt_pk_bf16_f32 v6, v28, v29
 v_cvt_pk_bf16_f32 v30, v20, v21
 v_cvt_pk_bf16_f32 v31, v22, v23
 v_mfma_f32_16x16x16_bf16 v[60:63], v[6:7], v[32:33], 0
 v_mfma_f32_16x16x16_bf16 v[52:55], v[6:7], v[2:3], 0
 v_mfma_f32_16x16x16_bf16 v[56:59], v[6:7], v[4:5], 0
 v_smfmac_f32_16x16x32_bf16 v[60:63], v[30:31], v[32:35], v5
 v_smfmac_f32_16x16x32_bf16 v[52:55], v[30:31], v[12:15], v5
 v_smfmac_f32_16x16x32_bf16 v[56:59], v[30:31], v[16:19], v5
 s_nop 0
 v_add_f32 v60, v60, v62
 v_add_f32 v61, v61, v63
 v_rcp_f32 v60, v60
 v_rcp_f32 v61, v61
 v_add_f32 v52, v52, v54
 v_add_f32 v53, v53, v55
 v_mul_f32 v52, v52, v60
 v_mul_f32 v53, v53, v61
 v_add_f32 v56, v56, v58
 v_add_f32 v57, v57, v59
 v_mul_f32 v56, v56, v60
 v_mul_f32 v57, v57, v61
 v_cvt_pk_bf16_f32 v52, v52, v56
 v_cvt_pk_bf16_f32 v53, v53, v57
 ds_write2_b32 v8, v52, v53 offset0:128 offset1:144
 v_mov_b64 v[20:21], 0
 v_mov_b64 v[22:23], 0
 v_mov_b64 v[24:25], 0
 v_mov_b64 v[26:27], 0
 v_mov_b64 v[28:29], 0
 v_mov_b64 v[30:31], 0
 v_mov_b64 v[32:33], 0
 v_mov_b64 v[34:35], 0
 s_waitcnt lgkmcnt(0)
 s_branch Lmxb_130
Lr2_135:
 s_waitcnt vmcnt(1)
 v_mfma_f32_16x16x32_bf16 v[48:51], v[44:47], v[12:15], 0
 s_waitcnt vmcnt(0)
 v_mfma_f32_16x16x32_bf16 v[48:51], v[44:47], v[16:19], v[48:51]
 v_bitop3_b32 v55, v13, v15, s46 bitop3:0x7e
 v_bitop3_b32 v56, v17, v19, s46 bitop3:0x7e
 v_bitop3_b32 v55, v55, 1, v56 bitop3:0xc8
 v_cmp_ne_u32 vcc, 0, v55
 s_nop 3
 v_add_f32_dpp v48, v48, v48 row_ror:4 row_mask:0xf bank_mask:0xf
 v_add_f32_dpp v49, v49, v49 row_ror:4 row_mask:0xf bank_mask:0xf
 s_cbranch_vccnz Lr1_134
 v_add_f32_dpp v48, v48, v48 row_ror:8 row_mask:0xf bank_mask:0xf
 v_add_f32_dpp v49, v49, v49 row_ror:8 row_mask:0xf bank_mask:0xf
 v_cvt_pk_bf16_f32 v48, v48, v49
 buffer_store_dword v48, v52, s[20:23], s44 offen sc1
 s_branch Lb1_136
Lr1_134:
 s_mov_b64 exec, vcc
Lrt_161:
 buffer_load_dwordx4 v[12:15], v3, s[20:23], s39 offen offset:0 sc1
 buffer_load_dwordx4 v[16:19], v3, s[20:23], s39 offen offset:1024 sc1
 s_waitcnt vmcnt(2)
 v_bitop3_b32 v55, v13, v15, s46 bitop3:0x7e
 v_bitop3_b32 v56, v17, v19, s46 bitop3:0x7e
 v_bitop3_b32 v55, v55, 1, v56 bitop3:0xc8
 v_cmpx_ne_u32 vcc, 0, v55
 s_cbranch_execz Lrte_162
 buffer_load_dwordx4 v[12:15], v3, s[20:23], s39 offen offset:0 sc1
 buffer_load_dwordx4 v[16:19], v3, s[20:23], s39 offen offset:1024 sc1
 s_waitcnt vmcnt(2)
 v_bitop3_b32 v55, v13, v15, s46 bitop3:0x7e
 v_bitop3_b32 v56, v17, v19, s46 bitop3:0x7e
 v_bitop3_b32 v55, v55, 1, v56 bitop3:0xc8
 v_cmpx_ne_u32 vcc, 0, v55
 s_cbranch_execz Lrte_162
 buffer_load_dwordx4 v[12:15], v3, s[20:23], s39 offen offset:0 sc1
 buffer_load_dwordx4 v[16:19], v3, s[20:23], s39 offen offset:1024 sc1
 s_waitcnt vmcnt(2)
 v_bitop3_b32 v55, v13, v15, s46 bitop3:0x7e
 v_bitop3_b32 v56, v17, v19, s46 bitop3:0x7e
 v_bitop3_b32 v55, v55, 1, v56 bitop3:0xc8
 v_cmpx_ne_u32 vcc, 0, v55
 s_cbranch_execz Lrte_162
 s_sub_u32 s54, s54, 1
 s_cbranch_scc0 Lrt_161
 s_endpgm
Lrte_162:
 s_mov_b64 exec, -1
 s_nop 2
 v_mfma_f32_16x16x32_bf16 v[48:51], v[44:47], v[12:15], 0
 v_mfma_f32_16x16x32_bf16 v[48:51], v[44:47], v[16:19], v[48:51]
 s_nop 7
 v_add_f32_dpp v48, v48, v48 row_ror:4 row_mask:0xf bank_mask:0xf
 v_add_f32_dpp v49, v49, v49 row_ror:4 row_mask:0xf bank_mask:0xf
 s_nop 0
 v_add_f32_dpp v48, v48, v48 row_ror:8 row_mask:0xf bank_mask:0xf
 v_add_f32_dpp v49, v49, v49 row_ror:8 row_mask:0xf bank_mask:0xf
 v_cvt_pk_bf16_f32 v48, v48, v49
 buffer_store_dword v48, v52, s[20:23], s44 offen sc1
 s_branch Lb1_136
Lr2_141:
 s_waitcnt vmcnt(1)
 v_mfma_f32_16x16x32_bf16 v[48:51], v[44:47], v[12:15], 0
 s_waitcnt vmcnt(0)
 v_mfma_f32_16x16x32_bf16 v[48:51], v[44:47], v[16:19], v[48:51]
 v_bitop3_b32 v55, v13, v15, s46 bitop3:0x7e
 v_bitop3_b32 v56, v17, v19, s46 bitop3:0x7e
 v_bitop3_b32 v55, v55, 1, v56 bitop3:0xc8
 v_cmp_ne_u32 vcc, 0, v55
 s_nop 3
 v_add_f32_dpp v48, v48, v48 row_ror:4 row_mask:0xf bank_mask:0xf
 v_add_f32_dpp v49, v49, v49 row_ror:4 row_mask:0xf bank_mask:0xf
 s_cbranch_vccnz Lr1_140
 v_add_f32_dpp v48, v48, v48 row_ror:8 row_mask:0xf bank_mask:0xf
 v_add_f32_dpp v49, v49, v49 row_ror:8 row_mask:0xf bank_mask:0xf
 v_cvt_pk_bf16_f32 v48, v48, v49
 buffer_store_dword v48, v52, s[20:23], s44 offen sc1
 s_branch Lb1_142
Lr1_140:
 s_mov_b64 exec, vcc
Lrt_163:
 buffer_load_dwordx4 v[12:15], v3, s[20:23], s39 offen offset:0 sc1
 buffer_load_dwordx4 v[16:19], v3, s[20:23], s39 offen offset:1024 sc1
 s_waitcnt vmcnt(2)
 v_bitop3_b32 v55, v13, v15, s46 bitop3:0x7e
 v_bitop3_b32 v56, v17, v19, s46 bitop3:0x7e
 v_bitop3_b32 v55, v55, 1, v56 bitop3:0xc8
 v_cmpx_ne_u32 vcc, 0, v55
 s_cbranch_execz Lrte_164
 buffer_load_dwordx4 v[12:15], v3, s[20:23], s39 offen offset:0 sc1
 buffer_load_dwordx4 v[16:19], v3, s[20:23], s39 offen offset:1024 sc1
 s_waitcnt vmcnt(2)
 v_bitop3_b32 v55, v13, v15, s46 bitop3:0x7e
 v_bitop3_b32 v56, v17, v19, s46 bitop3:0x7e
 v_bitop3_b32 v55, v55, 1, v56 bitop3:0xc8
 v_cmpx_ne_u32 vcc, 0, v55
 s_cbranch_execz Lrte_164
 buffer_load_dwordx4 v[12:15], v3, s[20:23], s39 offen offset:0 sc1
 buffer_load_dwordx4 v[16:19], v3, s[20:23], s39 offen offset:1024 sc1
 s_waitcnt vmcnt(2)
 v_bitop3_b32 v55, v13, v15, s46 bitop3:0x7e
 v_bitop3_b32 v56, v17, v19, s46 bitop3:0x7e
 v_bitop3_b32 v55, v55, 1, v56 bitop3:0xc8
 v_cmpx_ne_u32 vcc, 0, v55
 s_cbranch_execz Lrte_164
 s_sub_u32 s54, s54, 1
 s_cbranch_scc0 Lrt_163
 s_endpgm
Lrte_164:
 s_mov_b64 exec, -1
 s_nop 2
 v_mfma_f32_16x16x32_bf16 v[48:51], v[44:47], v[12:15], 0
 v_mfma_f32_16x16x32_bf16 v[48:51], v[44:47], v[16:19], v[48:51]
 s_nop 7
 v_add_f32_dpp v48, v48, v48 row_ror:4 row_mask:0xf bank_mask:0xf
 v_add_f32_dpp v49, v49, v49 row_ror:4 row_mask:0xf bank_mask:0xf
 s_nop 0
 v_add_f32_dpp v48, v48, v48 row_ror:8 row_mask:0xf bank_mask:0xf
 v_add_f32_dpp v49, v49, v49 row_ror:8 row_mask:0xf bank_mask:0xf
 v_cvt_pk_bf16_f32 v48, v48, v49
 buffer_store_dword v48, v52, s[20:23], s44 offen sc1
 s_branch Lb1_142
Lr2_147:
 s_waitcnt vmcnt(1)
 v_mfma_f32_16x16x32_bf16 v[48:51], v[44:47], v[12:15], 0
 s_waitcnt vmcnt(0)
 v_mfma_f32_16x16x32_bf16 v[48:51], v[44:47], v[16:19], v[48:51]
 v_bitop3_b32 v55, v13, v15, s46 bitop3:0x7e
 v_bitop3_b32 v56, v17, v19, s46 bitop3:0x7e
 v_bitop3_b32 v55, v55, 1, v56 bitop3:0xc8
 v_cmp_ne_u32 vcc, 0, v55
 s_nop 3
 v_add_f32_dpp v48, v48, v48 row_ror:4 row_mask:0xf bank_mask:0xf
 v_add_f32_dpp v49, v49, v49 row_ror:4 row_mask:0xf bank_mask:0xf
 s_cbranch_vccnz Lr1_146
 v_add_f32_dpp v48, v48, v48 row_ror:8 row_mask:0xf bank_mask:0xf
 v_add_f32_dpp v49, v49, v49 row_ror:8 row_mask:0xf bank_mask:0xf
 v_cvt_pk_bf16_f32 v48, v48, v49
 buffer_store_dword v48, v52, s[20:23], s44 offen sc1
 s_branch Lb1_148
Lr1_146:
 s_mov_b64 exec, vcc
Lrt_165:
 buffer_load_dwordx4 v[12:15], v3, s[20:23], s39 offen offset:0 sc1
 buffer_load_dwordx4 v[16:19], v3, s[20:23], s39 offen offset:1024 sc1
 s_waitcnt vmcnt(2)
 v_bitop3_b32 v55, v13, v15, s46 bitop3:0x7e
 v_bitop3_b32 v56, v17, v19, s46 bitop3:0x7e
 v_bitop3_b32 v55, v55, 1, v56 bitop3:0xc8
 v_cmpx_ne_u32 vcc, 0, v55
 s_cbranch_execz Lrte_166
 buffer_load_dwordx4 v[12:15], v3, s[20:23], s39 offen offset:0 sc1
 buffer_load_dwordx4 v[16:19], v3, s[20:23], s39 offen offset:1024 sc1
 s_waitcnt vmcnt(2)
 v_bitop3_b32 v55, v13, v15, s46 bitop3:0x7e
 v_bitop3_b32 v56, v17, v19, s46 bitop3:0x7e
 v_bitop3_b32 v55, v55, 1, v56 bitop3:0xc8
 v_cmpx_ne_u32 vcc, 0, v55
 s_cbranch_execz Lrte_166
 buffer_load_dwordx4 v[12:15], v3, s[20:23], s39 offen offset:0 sc1
 buffer_load_dwordx4 v[16:19], v3, s[20:23], s39 offen offset:1024 sc1
 s_waitcnt vmcnt(2)
 v_bitop3_b32 v55, v13, v15, s46 bitop3:0x7e
 v_bitop3_b32 v56, v17, v19, s46 bitop3:0x7e
 v_bitop3_b32 v55, v55, 1, v56 bitop3:0xc8
 v_cmpx_ne_u32 vcc, 0, v55
 s_cbranch_execz Lrte_166
 s_sub_u32 s54, s54, 1
 s_cbranch_scc0 Lrt_165
 s_endpgm
Lrte_166:
 s_mov_b64 exec, -1
 s_nop 2
 v_mfma_f32_16x16x32_bf16 v[48:51], v[44:47], v[12:15], 0
 v_mfma_f32_16x16x32_bf16 v[48:51], v[44:47], v[16:19], v[48:51]
 s_nop 7
 v_add_f32_dpp v48, v48, v48 row_ror:4 row_mask:0xf bank_mask:0xf
 v_add_f32_dpp v49, v49, v49 row_ror:4 row_mask:0xf bank_mask:0xf
 s_nop 0
 v_add_f32_dpp v48, v48, v48 row_ror:8 row_mask:0xf bank_mask:0xf
 v_add_f32_dpp v49, v49, v49 row_ror:8 row_mask:0xf bank_mask:0xf
 v_cvt_pk_bf16_f32 v48, v48, v49
 buffer_store_dword v48, v52, s[20:23], s44 offen sc1
 s_branch Lb1_148
Lfw_138:
Lpb_167:
 buffer_load_dword v1, v7, s[20:23], s56 offen sc1
 s_waitcnt vmcnt(0)
 v_cmp_le_u32 vcc, s58, v1
 s_cbranch_vccnz Lpbok_168
 s_sub_u32 s54, s54, 1
 s_cbranch_scc0 Lpb_167
 s_endpgm
Lpbok_168:
 s_branch Lfok_137
Lfw_144:
Lpb_169:
 buffer_load_dword v1, v7, s[20:23], s56 offen sc1
 s_waitcnt vmcnt(0)
 v_cmp_le_u32 vcc, s58, v1
 s_cbranch_vccnz Lpbok_170
 s_sub_u32 s54, s54, 1
 s_cbranch_scc0 Lpb_169
 s_endpgm
Lpbok_170:
 s_branch Lfok_143
Lfw_150:
Lpb_171:
 buffer_load_dword v1, v7, s[20:23], s56 offen sc1
 s_waitcnt vmcnt(0)
 v_cmp_le_u32 vcc, s58, v1
 s_cbranch_vccnz Lpbok_172
 s_sub_u32 s54, s54, 1
 s_cbranch_scc0 Lpb_171
 s_endpgm
Lpbok_172:
 s_branch Lfok_149
Lfw_155:
Lpb_173:
 buffer_load_dword v1, v7, s[20:23], s56 offen sc1
 s_waitcnt vmcnt(0)
 v_cmp_le_u32 vcc, s58, v1
 s_cbranch_vccnz Lpbok_174
 s_sub_u32 s54, s54, 1
 s_cbranch_scc0 Lpb_173
 s_endpgm
Lpbok_174:
 s_branch Lfok_154
Lfail_124:
 s_endpgm
Lchexit_70:
 s_add_u32 s38, s38, 0x10000
 v_add_u32 v6, s69, v9
 ds_read_b64 v[64:65], v6 offset:19456
 v_mov_b32 v66, v2
 v_mov_b32 v67, v4
 s_waitcnt lgkmcnt(0)
 buffer_store_dwordx4 v[64:67], v0, s[20:23], s38 offen sc1
 s_waitcnt vmcnt(0) lgkmcnt(0)
 s_barrier
 v_subrev_u32 v0, 0x10000, v0
 v_min_u32 v0, 16, v0
 v_lshlrev_b32 v0, 24, v0
 v_mov_b32 v6, 64
 buffer_store_dword v6, v0, s[20:23], s57 offen sc1
Lfin:
Lend:
 s_endpgm
Lredo:
 s_mov_b32 s88, s89
 s_waitcnt vmcnt(0) lgkmcnt(0)
 s_barrier
 s_branch Lrole
.section .rodata,"a"
.p2align 6
.amdhsa_kernel concat_heads__compressed_kv_cla__memory_aug_recurrent_mem_tr__prompt_kernel
  .amdhsa_next_free_vgpr 512
  .amdhsa_next_free_sgpr 102
  .amdhsa_accum_offset 256
  .amdhsa_group_segment_fixed_size 0
  .amdhsa_kernarg_size 128
  .amdhsa_user_sgpr_count 2
  .amdhsa_user_sgpr_kernarg_segment_ptr 1
  .amdhsa_system_sgpr_workgroup_id_x 1
  .amdhsa_float_denorm_mode_32 3
.end_amdhsa_kernel
```

```asm
; @launch grid=(256,1,1) block=(256,1,1) lds=163840
.amdgcn_target "amdgcn-amd-amdhsa--gfx950"
.text
.globl concat_heads__compressed_kv_cla__memory_aug_recurrent_mem_tr__prompt_kernel
.p2align 8
.type concat_heads__compressed_kv_cla__memory_aug_recurrent_mem_tr__prompt_kernel,@function
concat_heads__compressed_kv_cla__memory_aug_recurrent_mem_tr__prompt_kernel:
 s_cmp_ge_u32 s2, 256
 s_cbranch_scc1 Lend
 s_load_dwordx2 s[20:21], s[0:1], 120
 s_mov_b32 s22, 0x10000000
 s_mov_b32 s23, 0x20000
 s_load_dwordx2 s[28:29], s[0:1], 112
 s_mov_b32 s30, 0x100
 s_mov_b32 s31, 0x20000
 v_lshrrev_b32 v1, 6, v0
 s_lshr_b32 s6, s2, 3
 s_lshr_b32 s86, s2, 5
 v_readfirstlane_b32 s4, v1
 s_getreg_b32 s73, hwreg(HW_REG_XCC_ID, 0, 3)
 s_sub_u32 s88, s73, s2
 s_and_b32 s88, s88, 7
 s_add_u32 s88, s88, 1
 s_mov_b32 s95, 0x40000
 s_waitcnt lgkmcnt(0)
 s_cmp_eq_u32 s2, 0
 s_cbranch_scc0 Lrole
 v_min_u32 v1, 1, v0
 v_lshlrev_b32 v1, 28, v1
 v_mov_b32 v2, s88
 buffer_store_dword v2, v1, s[28:31], 0 offen offset:4 sc1
Lrole:
 s_add_u32 s5, s2, s88
 s_sub_u32 s5, s5, 1
 s_and_b32 s5, s5, 7
 s_lshl_b32 s5, s5, 2
 s_lshr_b32 s5, 0x76532041, s5
 s_and_b32 s5, s5, 7
 s_getpc_b64 s[8:9]
Lpc:
 s_lshl_b32 s7, s6, 13
 s_cmp_le_u32 s7, Lend - Lpc
 s_cselect_b32 s3, s4, 1
 s_cmp_eq_u32 s3, 0
 s_cbranch_scc0 Lcpf
 v_lshl_add_u32 v1, v0, 7, s7
 v_min_u32 v1, Lend - Lpc, v1
 global_load_dword v255, v1, s[8:9]
Lcpf:
 s_cmp_eq_u32 s5, 0
 s_cbranch_scc1 Lchain
 s_cmp_eq_u32 s5, 1
 s_cbranch_scc1 Lpb
 s_cmp_lt_u32 s5, 4
 s_cbranch_scc1 Lqa
 s_load_dwordx2 s[8:9], s[0:1], 8
 s_mov_b32 s10, 0x200000
 s_mov_b32 s11, 0x20000
 s_load_dwordx2 s[12:13], s[0:1], 24
 s_mov_b32 s14, 0x400000
 s_mov_b32 s15, 0x20000
 s_load_dwordx2 s[16:17], s[0:1], 32
 s_mov_b32 s18, 0x400000
 s_mov_b32 s19, 0x20000
 s_sub_u32 s3, s5, 4
 s_lshl_b32 s3, s3, 3
 s_lshr_b32 s7, s6, 2
 s_add_u32 s3, s3, s7
 s_lshl_b32 s32, s3, 8
 s_mov_b32 s33, s32
 s_lshl_b32 s34, s3, 14
 s_add_u32 s34, s34, 0x1000000
 s_add_u32 s35, s34, 8192
 s_mov_b32 s36, 16
 s_and_b32 s37, s6, 3
 s_lshl_b32 s7, s3, 5
 s_add_u32 s7, s7, s37
 s_lshl_b32 s7, s7, 2
 s_add_u32 s7, s7, 0x2000
 v_min_u32 v1, 1, v0
 v_lshlrev_b32 v1, 28, v1
 v_add_u32 v13, s7, v1
 s_waitcnt lgkmcnt(0)
 v_and_b32 v1, 63, v0
 v_lshrrev_b32 v2, 3, v0
 v_mul_u32_u24 v10, 1024, v2
 v_lshrrev_b32 v2, 4, v0
 v_xor_b32 v2, v2, v0
 v_and_b32 v2, 7, v2
 v_lshl_add_u32 v10, v2, 4, v10
 v_lshrrev_b32 v2, 4, v1
 v_bfe_u32 v3, v1, 1, 3
 v_xor_b32 v2, v2, v3
 v_and_b32 v3, 15, v1
 v_lshlrev_b32 v3, 7, v3
 v_lshl_add_u32 v4, v2, 4, v3
 v_xor_b32 v5, 64, v4
 v_lshrrev_b32 v2, 4, v0
 v_lshlrev_b32 v11, 13, v2
 v_lshrrev_b32 v2, 7, v0
 v_lshrrev_b32 v3, 4, v1
 v_lshl_add_u32 v3, v2, 2, v3
 v_bfe_u32 v2, v1, 1, 3
 v_xor_b32 v2, v2, v3
 v_lshl_add_u32 v11, v2, 5, v11
 v_and_b32 v2, 1, v1
 v_lshl_add_u32 v11, v2, 4, v11
 v_bfe_u32 v2, v1, 2, 3
 v_xor_b32 v3, s4, v2
 v_lshlrev_b32 v3, 5, v3
 v_and_b32 v2, 3, v2
 v_lshl_add_u32 v3, v2, 8, v3
 v_lshrrev_b32 v2, 4, v1
 v_lshl_add_u32 v3, v2, 11, v3
 v_and_b32 v2, 3, v1
 v_lshl_add_u32 v3, v2, 3, v3
 v_add_u32 v8, 65536, v3
 v_xor_b32 v3, 0x80, v3
 v_add_u32 v9, 65536, v3
 s_lshl_b32 s45, s4, 11
 v_lshl_add_u32 v12, v1, 4, s45
 s_mov_b32 s39, s37
 s_add_u32 s40, s39, 4
 s_min_u32 s40, s40, 63
 s_lshl_b32 s49, s4, 10
 s_mul_i32 s46, s39, 32768
 s_add_u32 m0, s49, 0
 s_nop 0
 buffer_load_dwordx4 v10, s[8:11], s46 offen offset:0  lds
 s_add_u32 m0, s49, 3968
 s_nop 0
 buffer_load_dwordx4 v10, s[8:11], s46 offen offset:128  lds
 s_add_u32 m0, s49, 7936
 s_nop 0
 buffer_load_dwordx4 v10, s[8:11], s46 offen offset:256  lds
 s_add_u32 m0, s49, 11904
 s_nop 0
 buffer_load_dwordx4 v10, s[8:11], s46 offen offset:384  lds
 s_add_u32 m0, s49, 15872
 s_nop 0
 buffer_load_dwordx4 v10, s[8:11], s46 offen offset:512  lds
 s_add_u32 m0, s49, 19840
 s_nop 0
 buffer_load_dwordx4 v10, s[8:11], s46 offen offset:640  lds
 s_add_u32 m0, s49, 23808
 s_nop 0
 buffer_load_dwordx4 v10, s[8:11], s46 offen offset:768  lds
 s_add_u32 m0, s49, 27776
 s_nop 0
 buffer_load_dwordx4 v10, s[8:11], s46 offen offset:896  lds
 s_lshl_b32 s49, s4, 10
 s_add_u32 s49, s49, 32768
 s_mul_i32 s46, s40, 32768
 s_add_u32 m0, s49, 0
 s_nop 0
 buffer_load_dwordx4 v10, s[8:11], s46 offen offset:0  lds
 s_add_u32 m0, s49, 3968
 s_nop 0
 buffer_load_dwordx4 v10, s[8:11], s46 offen offset:128  lds
 s_add_u32 m0, s49, 7936
 s_nop 0
 buffer_load_dwordx4 v10, s[8:11], s46 offen offset:256  lds
 s_add_u32 m0, s49, 11904
 s_nop 0
 buffer_load_dwordx4 v10, s[8:11], s46 offen offset:384  lds
 s_add_u32 m0, s49, 15872
 s_nop 0
 buffer_load_dwordx4 v10, s[8:11], s46 offen offset:512  lds
 s_add_u32 m0, s49, 19840
 s_nop 0
 buffer_load_dwordx4 v10, s[8:11], s46 offen offset:640  lds
 s_add_u32 m0, s49, 23808
 s_nop 0
 buffer_load_dwordx4 v10, s[8:11], s46 offen offset:768  lds
 s_add_u32 m0, s49, 27776
 s_nop 0
 buffer_load_dwordx4 v10, s[8:11], s46 offen offset:896  lds
 s_lshl_b32 s49, s4, 10
 s_add_u32 m0, s49, 65536
 s_add_u32 s45, s32, 0
 buffer_load_dwordx4 v11, s[12:15], s45 offen  lds
 s_add_u32 m0, s49, 69632
 s_add_u32 s45, s32, 131072
 buffer_load_dwordx4 v11, s[12:15], s45 offen  lds
 s_add_u32 m0, s49, 73728
 s_add_u32 s45, s33, 0
 buffer_load_dwordx4 v11, s[16:19], s45 offen  lds
 s_add_u32 m0, s49, 77824
 s_add_u32 s45, s33, 131072
 buffer_load_dwordx4 v11, s[16:19], s45 offen  lds
 s_add_u32 m0, s49, 81920
 s_add_u32 s45, s32, 262144
 buffer_load_dwordx4 v11, s[12:15], s45 offen  lds
 s_add_u32 m0, s49, 86016
 s_add_u32 s45, s32, 393216
 buffer_load_dwordx4 v11, s[12:15], s45 offen  lds
 s_add_u32 m0, s49, 90112
 s_add_u32 s45, s33, 262144
 buffer_load_dwordx4 v11, s[16:19], s45 offen  lds
 s_add_u32 m0, s49, 94208
 s_add_u32 s45, s33, 393216
 buffer_load_dwordx4 v11, s[16:19], s45 offen  lds
 s_add_u32 m0, s49, 98304
 s_add_u32 s45, s32, 524288
 buffer_load_dwordx4 v11, s[12:15], s45 offen  lds
 s_add_u32 m0, s49, 102400
 s_add_u32 s45, s32, 655360
 buffer_load_dwordx4 v11, s[12:15], s45 offen  lds
 s_add_u32 m0, s49, 106496
 s_add_u32 s45, s33, 524288
 buffer_load_dwordx4 v11, s[16:19], s45 offen  lds
 s_add_u32 m0, s49, 110592
 s_add_u32 s45, s33, 655360
 buffer_load_dwordx4 v11, s[16:19], s45 offen  lds
 s_waitcnt vmcnt(8) lgkmcnt(0)
 s_barrier
 s_add_u32 m0, s49, 114688
 s_add_u32 s45, s32, 786432
 buffer_load_dwordx4 v11, s[12:15], s45 offen  lds
 s_add_u32 m0, s49, 118784
 s_add_u32 s45, s32, 917504
 buffer_load_dwordx4 v11, s[12:15], s45 offen  lds
 s_add_u32 m0, s49, 122880
 s_add_u32 s45, s33, 786432
 buffer_load_dwordx4 v11, s[16:19], s45 offen  lds
 s_add_u32 m0, s49, 126976
 s_add_u32 s45, s33, 917504
 buffer_load_dwordx4 v11, s[16:19], s45 offen  lds
 ds_read_b64_tr_b16 a[0:1], v8 offset:0
 ds_read_b64_tr_b16 a[2:3], v8 offset:1024
 ds_read_b64_tr_b16 a[64:65], v9 offset:0
 ds_read_b64_tr_b16 a[66:67], v9 offset:1024
 ds_read_b64_tr_b16 a[128:129], v8 offset:8192
 ds_read_b64_tr_b16 a[130:131], v8 offset:9216
 ds_read_b64_tr_b16 a[192:193], v9 offset:8192
 ds_read_b64_tr_b16 a[194:195], v9 offset:9216
 s_waitcnt vmcnt(8) lgkmcnt(0)
 s_barrier
 s_add_u32 m0, s49, 65536
 s_add_u32 s45, s32, 1048576
 buffer_load_dwordx4 v11, s[12:15], s45 offen  lds
 s_add_u32 m0, s49, 69632
 s_add_u32 s45, s32, 1179648
 buffer_load_dwordx4 v11, s[12:15], s45 offen  lds
 s_add_u32 m0, s49, 73728
 s_add_u32 s45, s33, 1048576
 buffer_load_dwordx4 v11, s[16:19], s45 offen  lds
 s_add_u32 m0, s49, 77824
 s_add_u32 s45, s33, 1179648
 buffer_load_dwordx4 v11, s[16:19], s45 offen  lds
 ds_read_b64_tr_b16 a[4:5], v8 offset:16384
 ds_read_b64_tr_b16 a[6:7], v8 offset:17408
 ds_read_b64_tr_b16 a[68:69], v9 offset:16384
 ds_read_b64_tr_b16 a[70:71], v9 offset:17408
 ds_read_b64_tr_b16 a[132:133], v8 offset:24576
 ds_read_b64_tr_b16 a[134:135], v8 offset:25600
 ds_read_b64_tr_b16 a[196:197], v9 offset:24576
 ds_read_b64_tr_b16 a[198:199], v9 offset:25600
 s_waitcnt vmcnt(8) lgkmcnt(0)
 s_barrier
 s_add_u32 m0, s49, 81920
 s_add_u32 s45, s32, 1310720
 buffer_load_dwordx4 v11, s[12:15], s45 offen  lds
 s_add_u32 m0, s49, 86016
 s_add_u32 s45, s32, 1441792
 buffer_load_dwordx4 v11, s[12:15], s45 offen  lds
 s_add_u32 m0, s49, 90112
 s_add_u32 s45, s33, 1310720
 buffer_load_dwordx4 v11, s[16:19], s45 offen  lds
 s_add_u32 m0, s49, 94208
 s_add_u32 s45, s33, 1441792
 buffer_load_dwordx4 v11, s[16:19], s45 offen  lds
 ds_read_b64_tr_b16 a[8:9], v8 offset:32768
 ds_read_b64_tr_b16 a[10:11], v8 offset:33792
 ds_read_b64_tr_b16 a[72:73], v9 offset:32768
 ds_read_b64_tr_b16 a[74:75], v9 offset:33792
 ds_read_b64_tr_b16 a[136:137], v8 offset:40960
 ds_read_b64_tr_b16 a[138:139], v8 offset:41984
 ds_read_b64_tr_b16 a[200:201], v9 offset:40960
 ds_read_b64_tr_b16 a[202:203], v9 offset:41984
 s_waitcnt vmcnt(8) lgkmcnt(0)
 s_barrier
 s_add_u32 m0, s49, 98304
 s_add_u32 s45, s32, 1572864
 buffer_load_dwordx4 v11, s[12:15], s45 offen  lds
 s_add_u32 m0, s49, 102400
 s_add_u32 s45, s32, 1703936
 buffer_load_dwordx4 v11, s[12:15], s45 offen  lds
 s_add_u32 m0, s49, 106496
 s_add_u32 s45, s33, 1572864
 buffer_load_dwordx4 v11, s[16:19], s45 offen  lds
 s_add_u32 m0, s49, 110592
 s_add_u32 s45, s33, 1703936
 buffer_load_dwordx4 v11, s[16:19], s45 offen  lds
 ds_read_b64_tr_b16 a[12:13], v8 offset:49152
 ds_read_b64_tr_b16 a[14:15], v8 offset:50176
 ds_read_b64_tr_b16 a[76:77], v9 offset:49152
 ds_read_b64_tr_b16 a[78:79], v9 offset:50176
 ds_read_b64_tr_b16 a[140:141], v8 offset:57344
 ds_read_b64_tr_b16 a[142:143], v8 offset:58368
 ds_read_b64_tr_b16 a[204:205], v9 offset:57344
 ds_read_b64_tr_b16 a[206:207], v9 offset:58368
 s_waitcnt vmcnt(8) lgkmcnt(0)
 s_barrier
 s_add_u32 m0, s49, 114688
 s_add_u32 s45, s32, 1835008
 buffer_load_dwordx4 v11, s[12:15], s45 offen  lds
 s_add_u32 m0, s49, 118784
 s_add_u32 s45, s32, 1966080
 buffer_load_dwordx4 v11, s[12:15], s45 offen  lds
 s_add_u32 m0, s49, 122880
 s_add_u32 s45, s33, 1835008
 buffer_load_dwordx4 v11, s[16:19], s45 offen  lds
 s_add_u32 m0, s49, 126976
 s_add_u32 s45, s33, 1966080
 buffer_load_dwordx4 v11, s[16:19], s45 offen  lds
 ds_read_b64_tr_b16 a[16:17], v8 offset:0
 ds_read_b64_tr_b16 a[18:19], v8 offset:1024
 ds_read_b64_tr_b16 a[80:81], v9 offset:0
 ds_read_b64_tr_b16 a[82:83], v9 offset:1024
 ds_read_b64_tr_b16 a[144:145], v8 offset:8192
 ds_read_b64_tr_b16 a[146:147], v8 offset:9216
 ds_read_b64_tr_b16 a[208:209], v9 offset:8192
 ds_read_b64_tr_b16 a[210:211], v9 offset:9216
 s_waitcnt vmcnt(8) lgkmcnt(0)
 s_barrier
 s_add_u32 m0, s49, 65536
 s_add_u32 s45, s32, 2097152
 buffer_load_dwordx4 v11, s[12:15], s45 offen  lds
 s_add_u32 m0, s49, 69632
 s_add_u32 s45, s32, 2228224
 buffer_load_dwordx4 v11, s[12:15], s45 offen  lds
 s_add_u32 m0, s49, 73728
 s_add_u32 s45, s33, 2097152
 buffer_load_dwordx4 v11, s[16:19], s45 offen  lds
 s_add_u32 m0, s49, 77824
 s_add_u32 s45, s33, 2228224
 buffer_load_dwordx4 v11, s[16:19], s45 offen  lds
 ds_read_b64_tr_b16 a[20:21], v8 offset:16384
 ds_read_b64_tr_b16 a[22:23], v8 offset:17408
 ds_read_b64_tr_b16 a[84:85], v9 offset:16384
 ds_read_b64_tr_b16 a[86:87], v9 offset:17408
 ds_read_b64_tr_b16 a[148:149], v8 offset:24576
 ds_read_b64_tr_b16 a[150:151], v8 offset:25600
 ds_read_b64_tr_b16 a[212:213], v9 offset:24576
 ds_read_b64_tr_b16 a[214:215], v9 offset:25600
 s_waitcnt vmcnt(8) lgkmcnt(0)
 s_barrier
 s_add_u32 m0, s49, 81920
 s_add_u32 s45, s32, 2359296
 buffer_load_dwordx4 v11, s[12:15], s45 offen  lds
 s_add_u32 m0, s49, 86016
 s_add_u32 s45, s32, 2490368
 buffer_load_dwordx4 v11, s[12:15], s45 offen  lds
 s_add_u32 m0, s49, 90112
 s_add_u32 s45, s33, 2359296
 buffer_load_dwordx4 v11, s[16:19], s45 offen  lds
 s_add_u32 m0, s49, 94208
 s_add_u32 s45, s33, 2490368
 buffer_load_dwordx4 v11, s[16:19], s45 offen  lds
 ds_read_b64_tr_b16 a[24:25], v8 offset:32768
 ds_read_b64_tr_b16 a[26:27], v8 offset:33792
 ds_read_b64_tr_b16 a[88:89], v9 offset:32768
 ds_read_b64_tr_b16 a[90:91], v9 offset:33792
 ds_read_b64_tr_b16 a[152:153], v8 offset:40960
 ds_read_b64_tr_b16 a[154:155], v8 offset:41984
 ds_read_b64_tr_b16 a[216:217], v9 offset:40960
 ds_read_b64_tr_b16 a[218:219], v9 offset:41984
 s_waitcnt vmcnt(8) lgkmcnt(0)
 s_barrier
 s_add_u32 m0, s49, 98304
 s_add_u32 s45, s32, 2621440
 buffer_load_dwordx4 v11, s[12:15], s45 offen  lds
 s_add_u32 m0, s49, 102400
 s_add_u32 s45, s32, 2752512
 buffer_load_dwordx4 v11, s[12:15], s45 offen  lds
 s_add_u32 m0, s49, 106496
 s_add_u32 s45, s33, 2621440
 buffer_load_dwordx4 v11, s[16:19], s45 offen  lds
 s_add_u32 m0, s49, 110592
 s_add_u32 s45, s33, 2752512
 buffer_load_dwordx4 v11, s[16:19], s45 offen  lds
 ds_read_b64_tr_b16 a[28:29], v8 offset:49152
 ds_read_b64_tr_b16 a[30:31], v8 offset:50176
 ds_read_b64_tr_b16 a[92:93], v9 offset:49152
 ds_read_b64_tr_b16 a[94:95], v9 offset:50176
 ds_read_b64_tr_b16 a[156:157], v8 offset:57344
 ds_read_b64_tr_b16 a[158:159], v8 offset:58368
 ds_read_b64_tr_b16 a[220:221], v9 offset:57344
 ds_read_b64_tr_b16 a[222:223], v9 offset:58368
 s_waitcnt vmcnt(8) lgkmcnt(0)
 s_barrier
 s_add_u32 m0, s49, 114688
 s_add_u32 s45, s32, 2883584
 buffer_load_dwordx4 v11, s[12:15], s45 offen  lds
 s_add_u32 m0, s49, 118784
 s_add_u32 s45, s32, 3014656
 buffer_load_dwordx4 v11, s[12:15], s45 offen  lds
 s_add_u32 m0, s49, 122880
 s_add_u32 s45, s33, 2883584
 buffer_load_dwordx4 v11, s[16:19], s45 offen  lds
 s_add_u32 m0, s49, 126976
 s_add_u32 s45, s33, 3014656
 buffer_load_dwordx4 v11, s[16:19], s45 offen  lds
 ds_read_b64_tr_b16 a[32:33], v8 offset:0
 ds_read_b64_tr_b16 a[34:35], v8 offset:1024
 ds_read_b64_tr_b16 a[96:97], v9 offset:0
 ds_read_b64_tr_b16 a[98:99], v9 offset:1024
 ds_read_b64_tr_b16 a[160:161], v8 offset:8192
 ds_read_b64_tr_b16 a[162:163], v8 offset:9216
 ds_read_b64_tr_b16 a[224:225], v9 offset:8192
 ds_read_b64_tr_b16 a[226:227], v9 offset:9216
 s_waitcnt vmcnt(8) lgkmcnt(0)
 s_barrier
 s_add_u32 m0, s49, 65536
 s_add_u32 s45, s32, 3145728
 buffer_load_dwordx4 v11, s[12:15], s45 offen  lds
 s_add_u32 m0, s49, 69632
 s_add_u32 s45, s32, 3276800
 buffer_load_dwordx4 v11, s[12:15], s45 offen  lds
 s_add_u32 m0, s49, 73728
 s_add_u32 s45, s33, 3145728
 buffer_load_dwordx4 v11, s[16:19], s45 offen  lds
 s_add_u32 m0, s49, 77824
 s_add_u32 s45, s33, 3276800
 buffer_load_dwordx4 v11, s[16:19], s45 offen  lds
 ds_read_b64_tr_b16 a[36:37], v8 offset:16384
 ds_read_b64_tr_b16 a[38:39], v8 offset:17408
 ds_read_b64_tr_b16 a[100:101], v9 offset:16384
 ds_read_b64_tr_b16 a[102:103], v9 offset:17408
 ds_read_b64_tr_b16 a[164:165], v8 offset:24576
 ds_read_b64_tr_b16 a[166:167], v8 offset:25600
 ds_read_b64_tr_b16 a[228:229], v9 offset:24576
 ds_read_b64_tr_b16 a[230:231], v9 offset:25600
 s_waitcnt vmcnt(8) lgkmcnt(0)
 s_barrier
 s_add_u32 m0, s49, 81920
 s_add_u32 s45, s32, 3407872
 buffer_load_dwordx4 v11, s[12:15], s45 offen  lds
 s_add_u32 m0, s49, 86016
 s_add_u32 s45, s32, 3538944
 buffer_load_dwordx4 v11, s[12:15], s45 offen  lds
 s_add_u32 m0, s49, 90112
 s_add_u32 s45, s33, 3407872
 buffer_load_dwordx4 v11, s[16:19], s45 offen  lds
 s_add_u32 m0, s49, 94208
 s_add_u32 s45, s33, 3538944
 buffer_load_dwordx4 v11, s[16:19], s45 offen  lds
 ds_read_b64_tr_b16 a[40:41], v8 offset:32768
 ds_read_b64_tr_b16 a[42:43], v8 offset:33792
 ds_read_b64_tr_b16 a[104:105], v9 offset:32768
 ds_read_b64_tr_b16 a[106:107], v9 offset:33792
 ds_read_b64_tr_b16 a[168:169], v8 offset:40960
 ds_read_b64_tr_b16 a[170:171], v8 offset:41984
 ds_read_b64_tr_b16 a[232:233], v9 offset:40960
 ds_read_b64_tr_b16 a[234:235], v9 offset:41984
 s_waitcnt vmcnt(8) lgkmcnt(0)
 s_barrier
 s_add_u32 m0, s49, 98304
 s_add_u32 s45, s32, 3670016
 buffer_load_dwordx4 v11, s[12:15], s45 offen  lds
 s_add_u32 m0, s49, 102400
 s_add_u32 s45, s32, 3801088
 buffer_load_dwordx4 v11, s[12:15], s45 offen  lds
 s_add_u32 m0, s49, 106496
 s_add_u32 s45, s33, 3670016
 buffer_load_dwordx4 v11, s[16:19], s45 offen  lds
 s_add_u32 m0, s49, 110592
 s_add_u32 s45, s33, 3801088
 buffer_load_dwordx4 v11, s[16:19], s45 offen  lds
 ds_read_b64_tr_b16 a[44:45], v8 offset:49152
 ds_read_b64_tr_b16 a[46:47], v8 offset:50176
 ds_read_b64_tr_b16 a[108:109], v9 offset:49152
 ds_read_b64_tr_b16 a[110:111], v9 offset:50176
 ds_read_b64_tr_b16 a[172:173], v8 offset:57344
 ds_read_b64_tr_b16 a[174:175], v8 offset:58368
 ds_read_b64_tr_b16 a[236:237], v9 offset:57344
 ds_read_b64_tr_b16 a[238:239], v9 offset:58368
 s_waitcnt vmcnt(8) lgkmcnt(0)
 s_barrier
 s_add_u32 m0, s49, 114688
 s_add_u32 s45, s32, 3932160
 buffer_load_dwordx4 v11, s[12:15], s45 offen  lds
 s_add_u32 m0, s49, 118784
 s_add_u32 s45, s32, 4063232
 buffer_load_dwordx4 v11, s[12:15], s45 offen  lds
 s_add_u32 m0, s49, 122880
 s_add_u32 s45, s33, 3932160
 buffer_load_dwordx4 v11, s[16:19], s45 offen  lds
 s_add_u32 m0, s49, 126976
 s_add_u32 s45, s33, 4063232
 buffer_load_dwordx4 v11, s[16:19], s45 offen  lds
 ds_read_b64_tr_b16 a[48:49], v8 offset:0
 ds_read_b64_tr_b16 a[50:51], v8 offset:1024
 ds_read_b64_tr_b16 a[112:113], v9 offset:0
 ds_read_b64_tr_b16 a[114:115], v9 offset:1024
 ds_read_b64_tr_b16 a[176:177], v8 offset:8192
 ds_read_b64_tr_b16 a[178:179], v8 offset:9216
 ds_read_b64_tr_b16 a[240:241], v9 offset:8192
 ds_read_b64_tr_b16 a[242:243], v9 offset:9216
 s_waitcnt vmcnt(8) lgkmcnt(0)
 s_barrier
 ds_read_b64_tr_b16 a[52:53], v8 offset:16384
 ds_read_b64_tr_b16 a[54:55], v8 offset:17408
 ds_read_b64_tr_b16 a[116:117], v9 offset:16384
 ds_read_b64_tr_b16 a[118:119], v9 offset:17408
 ds_read_b64_tr_b16 a[180:181], v8 offset:24576
 ds_read_b64_tr_b16 a[182:183], v8 offset:25600
 ds_read_b64_tr_b16 a[244:245], v9 offset:24576
 ds_read_b64_tr_b16 a[246:247], v9 offset:25600
 s_waitcnt vmcnt(4) lgkmcnt(0)
 s_barrier
 ds_read_b64_tr_b16 a[56:57], v8 offset:32768
 ds_read_b64_tr_b16 a[58:59], v8 offset:33792
 ds_read_b64_tr_b16 a[120:121], v9 offset:32768
 ds_read_b64_tr_b16 a[122:123], v9 offset:33792
 ds_read_b64_tr_b16 a[184:185], v8 offset:40960
 ds_read_b64_tr_b16 a[186:187], v8 offset:41984
 ds_read_b64_tr_b16 a[248:249], v9 offset:40960
 ds_read_b64_tr_b16 a[250:251], v9 offset:41984
 s_waitcnt vmcnt(0) lgkmcnt(0)
 s_barrier
 ds_read_b64_tr_b16 a[60:61], v8 offset:49152
 ds_read_b64_tr_b16 a[62:63], v8 offset:50176
 ds_read_b64_tr_b16 a[124:125], v9 offset:49152
 ds_read_b64_tr_b16 a[126:127], v9 offset:50176
 ds_read_b64_tr_b16 a[188:189], v8 offset:57344
 ds_read_b64_tr_b16 a[190:191], v8 offset:58368
 ds_read_b64_tr_b16 a[252:253], v9 offset:57344
 ds_read_b64_tr_b16 a[254:255], v9 offset:58368
 s_mov_b32 s50, 0x3e0293ee
 s_mov_b32 s42, 0
 s_mov_b32 s43, 0
 s_mov_b32 s44, 65536
 v_mov_b32 v6, v4
 v_mov_b32 v7, v5
Lrh_3:
 v_mbcnt_lo_u32_b32 v21, -1, 0
 v_min_u32 v21, 1, v21
 v_lshlrev_b32 v21, 28, v21
 buffer_load_dword v20, v21, s[28:31], 0 offen offset:4 sc1
 s_waitcnt vmcnt(0)
Lrhc_4:
 v_readfirstlane_b32 s89, v20
 s_cmp_eq_u32 s89, s88
 s_cbranch_scc1 Lrhk_5
 s_cmp_lg_u32 s89, 0
 s_cbranch_scc1 Lredo
 s_sub_u32 s95, s95, 1
 s_cbranch_scc0 Lrh_3
 s_endpgm
Lrhk_5:
 s_cmp_lg_u32 s4, 0
 s_cbranch_scc1 Lfrk_2
 v_min_u32 v21, 1, v0
 v_lshlrev_b32 v21, 28, v21
Lfr_1:
 buffer_load_dword v20, v21, s[28:31], 0 offen offset:0 sc1
 s_waitcnt vmcnt(0)
 v_cmp_eq_u32 vcc, 1, v20
 s_cbranch_vccnz Lfrk_2
 s_sub_u32 s95, s95, 1
 s_cbranch_scc0 Lfr_1
 s_endpgm
Lfrk_2:
 s_lshl_b32 s47, s2, 13
 s_add_u32 s47, s47, 0x8000000
 s_mov_b32 s48, s47
 v_mov_b32 v14, 0
 s_waitcnt vmcnt(0) lgkmcnt(0)
 s_barrier
 ds_read_b128 v[32:35], v6 offset:0
 ds_read_b128 v[36:39], v6 offset:2048
 ds_read_b128 v[40:43], v7 offset:0
 ds_read_b128 v[44:47], v7 offset:2048
 s_mul_i32 s45, s86, 4096
 v_lshl_add_u32 v1, v0, 7, s45
 v_add_u32 v1, 262144, v1
 v_mov_b32 v2, 0x7ff00000
 v_cmp_gt_u32 vcc, 32, v0
 s_nop 1
 v_cndmask_b32 v1, v2, v1, vcc
 s_waitcnt lgkmcnt(2)
Lps_loop_6:
 v_mfma_f32_16x16x32_bf16 v[64:67], a[0:3], v[32:35], 0
 ds_read_b128 v[48:51], v6 offset:4096
 v_mfma_f32_16x16x32_bf16 v[72:75], a[64:67], v[32:35], 0
 ds_read_b128 v[52:55], v6 offset:6144
 v_mfma_f32_16x16x32_bf16 v[80:83], v[32:35], a[128:131], 0
 s_add_u32 s41, s40, 4
 v_mfma_f32_16x16x32_bf16 v[88:91], v[32:35], a[192:195], 0
 s_add_u32 s45, s42, 2
 s_mul_i32 s46, s41, 32768
 v_mfma_f32_16x16x32_bf16 v[68:71], a[0:3], v[36:39], 0
 s_cmp_lt_u32 s45, s36
 s_cselect_b32 s46, s46, 0
 v_mfma_f32_16x16x32_bf16 v[76:79], a[64:67], v[36:39], 0
 s_lshl_b32 s49, s4, 10
 s_add_u32 s49, s49, s44
 v_mfma_f32_16x16x32_bf16 v[84:87], v[36:39], a[128:131], 0
 v_mfma_f32_16x16x32_bf16 v[92:95], v[36:39], a[192:195], 0
 s_waitcnt lgkmcnt(2)
 v_mfma_f32_16x16x32_bf16 v[64:67], a[4:7], v[40:43], v[64:67]
 ds_read_b128 v[56:59], v7 offset:4096
 v_mfma_f32_16x16x32_bf16 v[72:75], a[68:71], v[40:43], v[72:75]
 ds_read_b128 v[60:63], v7 offset:6144
 v_mfma_f32_16x16x32_bf16 v[80:83], v[40:43], a[132:135], v[80:83]
 s_add_u32 m0, s49, 0
 v_mfma_f32_16x16x32_bf16 v[88:91], v[40:43], a[196:199], v[88:91]
 buffer_load_dwordx4 v10, s[8:11], s46 offen offset:0  lds
 v_mfma_f32_16x16x32_bf16 v[68:71], a[4:7], v[44:47], v[68:71]
 s_add_u32 m0, s49, 3968
 v_mfma_f32_16x16x32_bf16 v[76:79], a[68:71], v[44:47], v[76:79]
 buffer_load_dwordx4 v10, s[8:11], s46 offen offset:128  lds
 v_mfma_f32_16x16x32_bf16 v[84:87], v[44:47], a[132:135], v[84:87]
 v_mfma_f32_16x16x32_bf16 v[92:95], v[44:47], a[196:199], v[92:95]
 s_waitcnt lgkmcnt(2)
 v_mfma_f32_16x16x32_bf16 v[64:67], a[8:11], v[48:51], v[64:67]
 ds_read_b128 v[32:35], v6 offset:8192
 v_mfma_f32_16x16x32_bf16 v[72:75], a[72:75], v[48:51], v[72:75]
 ds_read_b128 v[36:39], v6 offset:10240
 v_mfma_f32_16x16x32_bf16 v[80:83], v[48:51], a[136:139], v[80:83]
 s_add_u32 m0, s49, 7936
 v_mfma_f32_16x16x32_bf16 v[88:91], v[48:51], a[200:203], v[88:91]
 buffer_load_dwordx4 v10, s[8:11], s46 offen offset:256  lds
 v_mfma_f32_16x16x32_bf16 v[68:71], a[8:11], v[52:55], v[68:71]
 s_add_u32 m0, s49, 11904
 v_mfma_f32_16x16x32_bf16 v[76:79], a[72:75], v[52:55], v[76:79]
 buffer_load_dwordx4 v10, s[8:11], s46 offen offset:384  lds
 v_mfma_f32_16x16x32_bf16 v[84:87], v[52:55], a[136:139], v[84:87]
 v_mfma_f32_16x16x32_bf16 v[92:95], v[52:55], a[200:203], v[92:95]
 s_waitcnt lgkmcnt(2)
 v_mfma_f32_16x16x32_bf16 v[64:67], a[12:15], v[56:59], v[64:67]
 ds_read_b128 v[40:43], v7 offset:8192
 v_mfma_f32_16x16x32_bf16 v[72:75], a[76:79], v[56:59], v[72:75]
 ds_read_b128 v[44:47], v7 offset:10240
 v_mfma_f32_16x16x32_bf16 v[80:83], v[56:59], a[140:143], v[80:83]
 s_add_u32 m0, s49, 15872
 v_mfma_f32_16x16x32_bf16 v[88:91], v[56:59], a[204:207], v[88:91]
 buffer_load_dwordx4 v10, s[8:11], s46 offen offset:512  lds
 v_mfma_f32_16x16x32_bf16 v[68:71], a[12:15], v[60:63], v[68:71]
 s_add_u32 m0, s49, 19840
 v_mfma_f32_16x16x32_bf16 v[76:79], a[76:79], v[60:63], v[76:79]
 buffer_load_dwordx4 v10, s[8:11], s46 offen offset:640  lds
 v_mfma_f32_16x16x32_bf16 v[84:87], v[60:63], a[140:143], v[84:87]
 v_mfma_f32_16x16x32_bf16 v[92:95], v[60:63], a[204:207], v[92:95]
 s_waitcnt lgkmcnt(2)
 v_mfma_f32_16x16x32_bf16 v[64:67], a[16:19], v[32:35], v[64:67]
 ds_read_b128 v[48:51], v6 offset:12288
 v_mfma_f32_16x16x32_bf16 v[72:75], a[80:83], v[32:35], v[72:75]
 ds_read_b128 v[52:55], v6 offset:14336
 v_mfma_f32_16x16x32_bf16 v[80:83], v[32:35], a[144:147], v[80:83]
 s_add_u32 m0, s49, 23808
 v_mfma_f32_16x16x32_bf16 v[88:91], v[32:35], a[208:211], v[88:91]
 buffer_load_dwordx4 v10, s[8:11], s46 offen offset:768  lds
 v_mfma_f32_16x16x32_bf16 v[68:71], a[16:19], v[36:39], v[68:71]
 s_add_u32 m0, s49, 27776
 v_mfma_f32_16x16x32_bf16 v[76:79], a[80:83], v[36:39], v[76:79]
 buffer_load_dwordx4 v10, s[8:11], s46 offen offset:896  lds
 v_mfma_f32_16x16x32_bf16 v[84:87], v[36:39], a[144:147], v[84:87]
 v_mfma_f32_16x16x32_bf16 v[92:95], v[36:39], a[208:211], v[92:95]
 s_waitcnt lgkmcnt(2)
 v_mfma_f32_16x16x32_bf16 v[64:67], a[20:23], v[40:43], v[64:67]
 ds_read_b128 v[56:59], v7 offset:12288
 v_mfma_f32_16x16x32_bf16 v[72:75], a[84:87], v[40:43], v[72:75]
 ds_read_b128 v[60:63], v7 offset:14336
 v_mfma_f32_16x16x32_bf16 v[80:83], v[40:43], a[148:151], v[80:83]
 v_mfma_f32_16x16x32_bf16 v[88:91], v[40:43], a[212:215], v[88:91]
 v_mfma_f32_16x16x32_bf16 v[68:71], a[20:23], v[44:47], v[68:71]
 v_add_u32 v2, s46, v1
 v_mfma_f32_16x16x32_bf16 v[76:79], a[84:87], v[44:47], v[76:79]
 buffer_load_dword v15, v2, s[8:11], 0 offen
 v_mfma_f32_16x16x32_bf16 v[84:87], v[44:47], a[148:151], v[84:87]
 v_mfma_f32_16x16x32_bf16 v[92:95], v[44:47], a[212:215], v[92:95]
 s_waitcnt lgkmcnt(2)
 v_mfma_f32_16x16x32_bf16 v[64:67], a[24:27], v[48:51], v[64:67]
 ds_read_b128 v[32:35], v6 offset:16384
 v_mfma_f32_16x16x32_bf16 v[72:75], a[88:91], v[48:51], v[72:75]
 ds_read_b128 v[36:39], v6 offset:18432
 v_mfma_f32_16x16x32_bf16 v[80:83], v[48:51], a[152:155], v[80:83]
 v_cvt_pk_bf16_f32 v16, v96, v97
 v_mfma_f32_16x16x32_bf16 v[88:91], v[48:51], a[216:219], v[88:91]
 v_cvt_pk_bf16_f32 v17, v104, v105
 v_mfma_f32_16x16x32_bf16 v[68:71], a[24:27], v[52:55], v[68:71]
 v_mfma_f32_16x16x32_bf16 v[76:79], a[88:91], v[52:55], v[76:79]
 v_cvt_pk_bf16_f32 v18, v98, v99
 v_mfma_f32_16x16x32_bf16 v[84:87], v[52:55], a[152:155], v[84:87]
 v_mfma_f32_16x16x32_bf16 v[92:95], v[52:55], a[216:219], v[92:95]
 s_waitcnt lgkmcnt(2)
 v_mfma_f32_16x16x32_bf16 v[64:67], a[28:31], v[56:59], v[64:67]
 ds_read_b128 v[40:43], v7 offset:16384
 v_mfma_f32_16x16x32_bf16 v[72:75], a[92:95], v[56:59], v[72:75]
 ds_read_b128 v[44:47], v7 offset:18432
 v_mfma_f32_16x16x32_bf16 v[80:83], v[56:59], a[156:159], v[80:83]
 v_cvt_pk_bf16_f32 v19, v106, v107
 v_mfma_f32_16x16x32_bf16 v[88:91], v[56:59], a[220:223], v[88:91]
 v_mfma_f32_16x16x32_bf16 v[68:71], a[28:31], v[60:63], v[68:71]
 buffer_store_dwordx4 v[16:19], v12, s[20:23], s47 offen offset:0 sc1
 v_mfma_f32_16x16x32_bf16 v[76:79], a[92:95], v[60:63], v[76:79]
 v_cvt_pk_bf16_f32 v20, v100, v101
 v_mfma_f32_16x16x32_bf16 v[84:87], v[60:63], a[156:159], v[84:87]
 v_mfma_f32_16x16x32_bf16 v[92:95], v[60:63], a[220:223], v[92:95]
 s_waitcnt lgkmcnt(2)
 v_mfma_f32_16x16x32_bf16 v[64:67], a[32:35], v[32:35], v[64:67]
 ds_read_b128 v[48:51], v6 offset:20480
 v_mfma_f32_16x16x32_bf16 v[72:75], a[96:99], v[32:35], v[72:75]
 ds_read_b128 v[52:55], v6 offset:22528
 v_mfma_f32_16x16x32_bf16 v[80:83], v[32:35], a[160:163], v[80:83]
 v_cvt_pk_bf16_f32 v21, v108, v109
 v_mfma_f32_16x16x32_bf16 v[88:91], v[32:35], a[224:227], v[88:91]
 v_mfma_f32_16x16x32_bf16 v[68:71], a[32:35], v[36:39], v[68:71]
 v_cvt_pk_bf16_f32 v22, v102, v103
 v_mfma_f32_16x16x32_bf16 v[76:79], a[96:99], v[36:39], v[76:79]
 v_mfma_f32_16x16x32_bf16 v[84:87], v[36:39], a[160:163], v[84:87]
 v_cvt_pk_bf16_f32 v23, v110, v111
 v_mfma_f32_16x16x32_bf16 v[92:95], v[36:39], a[224:227], v[92:95]
 s_waitcnt lgkmcnt(2)
 v_mfma_f32_16x16x32_bf16 v[64:67], a[36:39], v[40:43], v[64:67]
 ds_read_b128 v[56:59], v7 offset:20480
 v_mfma_f32_16x16x32_bf16 v[72:75], a[100:103], v[40:43], v[72:75]
 ds_read_b128 v[60:63], v7 offset:22528
 v_mfma_f32_16x16x32_bf16 v[80:83], v[40:43], a[164:167], v[80:83]
 buffer_store_dwordx4 v[20:23], v12, s[20:23], s47 offen offset:1024 sc1
 v_mfma_f32_16x16x32_bf16 v[88:91], v[40:43], a[228:231], v[88:91]
 v_mfma_f32_16x16x32_bf16 v[68:71], a[36:39], v[44:47], v[68:71]
 v_cvt_pk_bf16_f32 v24, v112, v113
 v_mfma_f32_16x16x32_bf16 v[76:79], a[100:103], v[44:47], v[76:79]
 v_mfma_f32_16x16x32_bf16 v[84:87], v[44:47], a[164:167], v[84:87]
 v_cvt_pk_bf16_f32 v25, v116, v117
 v_mfma_f32_16x16x32_bf16 v[92:95], v[44:47], a[228:231], v[92:95]
 s_waitcnt lgkmcnt(2)
 v_mfma_f32_16x16x32_bf16 v[64:67], a[40:43], v[48:51], v[64:67]
 ds_read_b128 v[32:35], v6 offset:24576
 v_mfma_f32_16x16x32_bf16 v[72:75], a[104:107], v[48:51], v[72:75]
 ds_read_b128 v[36:39], v6 offset:26624
 v_mfma_f32_16x16x32_bf16 v[80:83], v[48:51], a[168:171], v[80:83]
 v_mfma_f32_16x16x32_bf16 v[88:91], v[48:51], a[232:235], v[88:91]
 v_cvt_pk_bf16_f32 v26, v114, v115
 v_mfma_f32_16x16x32_bf16 v[68:71], a[40:43], v[52:55], v[68:71]
 v_cvt_pk_bf16_f32 v27, v118, v119
 v_mfma_f32_16x16x32_bf16 v[76:79], a[104:107], v[52:55], v[76:79]
 v_mfma_f32_16x16x32_bf16 v[84:87], v[52:55], a[168:171], v[84:87]
 buffer_store_dwordx4 v[24:27], v12, s[20:23], s48 offen offset:0 sc1
 v_mfma_f32_16x16x32_bf16 v[92:95], v[52:55], a[232:235], v[92:95]
 s_waitcnt lgkmcnt(2)
 v_mfma_f32_16x16x32_bf16 v[64:67], a[44:47], v[56:59], v[64:67]
 ds_read_b128 v[40:43], v7 offset:24576
 v_mfma_f32_16x16x32_bf16 v[72:75], a[108:111], v[56:59], v[72:75]
 ds_read_b128 v[44:47], v7 offset:26624
 v_mfma_f32_16x16x32_bf16 v[80:83], v[56:59], a[172:175], v[80:83]
 s_add_u32 s43, s43, 32768
 s_cmp_eq_u32 s43, 131072
 v_mfma_f32_16x16x32_bf16 v[88:91], v[56:59], a[236:239], v[88:91]
 s_cselect_b32 s43, 0, s43
 s_add_u32 s44, s44, 32768
 v_mfma_f32_16x16x32_bf16 v[68:71], a[44:47], v[60:63], v[68:71]
 s_cmp_eq_u32 s44, 131072
 s_cselect_b32 s44, 0, s44
 v_mfma_f32_16x16x32_bf16 v[76:79], a[108:111], v[60:63], v[76:79]
 v_mfma_f32_16x16x32_bf16 v[84:87], v[60:63], a[172:175], v[84:87]
 v_cvt_pk_bf16_f32 v28, v120, v121
 v_mfma_f32_16x16x32_bf16 v[92:95], v[60:63], a[236:239], v[92:95]
 s_waitcnt lgkmcnt(2)
 v_mfma_f32_16x16x32_bf16 v[64:67], a[48:51], v[32:35], v[64:67]
 ds_read_b128 v[48:51], v6 offset:28672
 v_mfma_f32_16x16x32_bf16 v[72:75], a[112:115], v[32:35], v[72:75]
 ds_read_b128 v[52:55], v6 offset:30720
 v_mfma_f32_16x16x32_bf16 v[80:83], v[32:35], a[176:179], v[80:83]
 v_add_u32 v6, s43, v4
 v_mfma_f32_16x16x32_bf16 v[88:91], v[32:35], a[240:243], v[88:91]
 v_mfma_f32_16x16x32_bf16 v[68:71], a[48:51], v[36:39], v[68:71]
 v_cvt_pk_bf16_f32 v29, v124, v125
 v_mfma_f32_16x16x32_bf16 v[76:79], a[112:115], v[36:39], v[76:79]
 v_cvt_pk_bf16_f32 v30, v122, v123
 v_mfma_f32_16x16x32_bf16 v[84:87], v[36:39], a[176:179], v[84:87]
 v_mfma_f32_16x16x32_bf16 v[92:95], v[36:39], a[240:243], v[92:95]
 s_waitcnt lgkmcnt(2)
 v_mfma_f32_16x16x32_bf16 v[64:67], a[52:55], v[40:43], v[64:67]
 ds_read_b128 v[56:59], v7 offset:28672
 v_mfma_f32_16x16x32_bf16 v[72:75], a[116:119], v[40:43], v[72:75]
 ds_read_b128 v[60:63], v7 offset:30720
 v_mfma_f32_16x16x32_bf16 v[80:83], v[40:43], a[180:183], v[80:83]
 v_add_u32 v7, s43, v5
 v_mfma_f32_16x16x32_bf16 v[88:91], v[40:43], a[244:247], v[88:91]
 v_cvt_pk_bf16_f32 v31, v126, v127
 v_mfma_f32_16x16x32_bf16 v[68:71], a[52:55], v[44:47], v[68:71]
 v_mfma_f32_16x16x32_bf16 v[76:79], a[116:119], v[44:47], v[76:79]
 buffer_store_dwordx4 v[28:31], v12, s[20:23], s48 offen offset:1024 sc1
 v_mfma_f32_16x16x32_bf16 v[84:87], v[44:47], a[180:183], v[84:87]
 v_mfma_f32_16x16x32_bf16 v[92:95], v[44:47], a[244:247], v[92:95]
 s_waitcnt lgkmcnt(2)
 v_mfma_f32_16x16x32_bf16 v[64:67], a[56:59], v[48:51], v[64:67]
 s_waitcnt vmcnt(13)
 s_barrier
 ds_read_b128 v[32:35], v6 offset:0
 v_mfma_f32_16x16x32_bf16 v[72:75], a[120:123], v[48:51], v[72:75]
 ds_read_b128 v[36:39], v6 offset:2048
 v_mfma_f32_16x16x32_bf16 v[80:83], v[48:51], a[184:187], v[80:83]
 v_mfma_f32_16x16x32_bf16 v[88:91], v[48:51], a[248:251], v[88:91]
 v_mfma_f32_16x16x32_bf16 v[68:71], a[56:59], v[52:55], v[68:71]
 v_mfma_f32_16x16x32_bf16 v[76:79], a[120:123], v[52:55], v[76:79]
 v_mfma_f32_16x16x32_bf16 v[84:87], v[52:55], a[184:187], v[84:87]
 v_mfma_f32_16x16x32_bf16 v[92:95], v[52:55], a[248:251], v[92:95]
 s_waitcnt lgkmcnt(2)
 v_mfma_f32_16x16x32_bf16 v[64:67], a[60:63], v[56:59], v[64:67]
 ds_read_b128 v[40:43], v7 offset:0
 v_mfma_f32_16x16x32_bf16 v[72:75], a[124:127], v[56:59], v[72:75]
 ds_read_b128 v[44:47], v7 offset:2048
 v_mfma_f32_16x16x32_bf16 v[80:83], v[56:59], a[188:191], v[80:83]
 s_mul_i32 s45, s39, 524288
 s_add_u32 s47, s34, s45
 v_mfma_f32_16x16x32_bf16 v[88:91], v[56:59], a[252:255], v[88:91]
 s_add_u32 s48, s35, s45
 v_mov_b32 v14, s42
 v_mfma_f32_16x16x32_bf16 v[68:71], a[60:63], v[60:63], v[68:71]
 s_mov_b32 s39, s40
 s_mov_b32 s40, s41
 v_mfma_f32_16x16x32_bf16 v[76:79], a[124:127], v[60:63], v[76:79]
 s_add_u32 s42, s42, 1
 v_mfma_f32_16x16x32_bf16 v[84:87], v[60:63], a[188:191], v[84:87]
 v_mfma_f32_16x16x32_bf16 v[92:95], v[60:63], a[252:255], v[92:95]
 s_waitcnt lgkmcnt(2)
 v_mfma_f32_16x16x32_bf16 v[96:99], a[0:3], v[32:35], 0
 ds_read_b128 v[48:51], v6 offset:4096
 v_mfma_f32_16x16x32_bf16 v[104:107], a[64:67], v[32:35], 0
 ds_read_b128 v[52:55], v6 offset:6144
 v_mfma_f32_16x16x32_bf16 v[112:115], v[32:35], a[128:131], 0
 s_add_u32 s41, s40, 4
 v_mfma_f32_16x16x32_bf16 v[120:123], v[32:35], a[192:195], 0
 s_add_u32 s45, s42, 2
 s_mul_i32 s46, s41, 32768
 v_mfma_f32_16x16x32_bf16 v[100:103], a[0:3], v[36:39], 0
 s_cmp_lt_u32 s45, s36
 s_cselect_b32 s46, s46, 0
 v_mfma_f32_16x16x32_bf16 v[108:111], a[64:67], v[36:39], 0
 s_lshl_b32 s49, s4, 10
 s_add_u32 s49, s49, s44
 v_mfma_f32_16x16x32_bf16 v[116:119], v[36:39], a[128:131], 0
 v_mfma_f32_16x16x32_bf16 v[124:127], v[36:39], a[192:195], 0
 s_waitcnt lgkmcnt(2)
 v_mfma_f32_16x16x32_bf16 v[96:99], a[4:7], v[40:43], v[96:99]
 ds_read_b128 v[56:59], v7 offset:4096
 v_mfma_f32_16x16x32_bf16 v[104:107], a[68:71], v[40:43], v[104:107]
 ds_read_b128 v[60:63], v7 offset:6144
 v_mfma_f32_16x16x32_bf16 v[112:115], v[40:43], a[132:135], v[112:115]
 s_add_u32 m0, s49, 0
 v_mfma_f32_16x16x32_bf16 v[120:123], v[40:43], a[196:199], v[120:123]
 buffer_load_dwordx4 v10, s[8:11], s46 offen offset:0  lds
 v_mfma_f32_16x16x32_bf16 v[100:103], a[4:7], v[44:47], v[100:103]
 s_add_u32 m0, s49, 3968
 v_mfma_f32_16x16x32_bf16 v[108:111], a[68:71], v[44:47], v[108:111]
 buffer_load_dwordx4 v10, s[8:11], s46 offen offset:128  lds
 v_mfma_f32_16x16x32_bf16 v[116:119], v[44:47], a[132:135], v[116:119]
 v_mfma_f32_16x16x32_bf16 v[124:127], v[44:47], a[196:199], v[124:127]
 s_waitcnt lgkmcnt(2)
 v_mfma_f32_16x16x32_bf16 v[96:99], a[8:11], v[48:51], v[96:99]
 ds_read_b128 v[32:35], v6 offset:8192
 v_mfma_f32_16x16x32_bf16 v[104:107], a[72:75], v[48:51], v[104:107]
 ds_read_b128 v[36:39], v6 offset:10240
 v_mfma_f32_16x16x32_bf16 v[112:115], v[48:51], a[136:139], v[112:115]
 s_add_u32 m0, s49, 7936
 v_mfma_f32_16x16x32_bf16 v[120:123], v[48:51], a[200:203], v[120:123]
 buffer_load_dwordx4 v10, s[8:11], s46 offen offset:256  lds
 v_mfma_f32_16x16x32_bf16 v[100:103], a[8:11], v[52:55], v[100:103]
 s_add_u32 m0, s49, 11904
 v_mfma_f32_16x16x32_bf16 v[108:111], a[72:75], v[52:55], v[108:111]
 buffer_load_dwordx4 v10, s[8:11], s46 offen offset:384  lds
 v_mfma_f32_16x16x32_bf16 v[116:119], v[52:55], a[136:139], v[116:119]
 v_mfma_f32_16x16x32_bf16 v[124:127], v[52:55], a[200:203], v[124:127]
 s_waitcnt lgkmcnt(2)
 v_mfma_f32_16x16x32_bf16 v[96:99], a[12:15], v[56:59], v[96:99]
 ds_read_b128 v[40:43], v7 offset:8192
 v_mfma_f32_16x16x32_bf16 v[104:107], a[76:79], v[56:59], v[104:107]
 ds_read_b128 v[44:47], v7 offset:10240
 v_mfma_f32_16x16x32_bf16 v[112:115], v[56:59], a[140:143], v[112:115]
 s_add_u32 m0, s49, 15872
 v_mfma_f32_16x16x32_bf16 v[120:123], v[56:59], a[204:207], v[120:123]
 buffer_load_dwordx4 v10, s[8:11], s46 offen offset:512  lds
 v_mfma_f32_16x16x32_bf16 v[100:103], a[12:15], v[60:63], v[100:103]
 s_add_u32 m0, s49, 19840
 v_mfma_f32_16x16x32_bf16 v[108:111], a[76:79], v[60:63], v[108:111]
 buffer_load_dwordx4 v10, s[8:11], s46 offen offset:640  lds
 v_mfma_f32_16x16x32_bf16 v[116:119], v[60:63], a[140:143], v[116:119]
 v_mfma_f32_16x16x32_bf16 v[124:127], v[60:63], a[204:207], v[124:127]
 s_waitcnt lgkmcnt(2)
 v_mfma_f32_16x16x32_bf16 v[96:99], a[16:19], v[32:35], v[96:99]
 ds_read_b128 v[48:51], v6 offset:12288
 v_mfma_f32_16x16x32_bf16 v[104:107], a[80:83], v[32:35], v[104:107]
 ds_read_b128 v[52:55], v6 offset:14336
 v_mfma_f32_16x16x32_bf16 v[112:115], v[32:35], a[144:147], v[112:115]
 s_add_u32 m0, s49, 23808
 v_mfma_f32_16x16x32_bf16 v[120:123], v[32:35], a[208:211], v[120:123]
 buffer_load_dwordx4 v10, s[8:11], s46 offen offset:768  lds
 v_mfma_f32_16x16x32_bf16 v[100:103], a[16:19], v[36:39], v[100:103]
 s_add_u32 m0, s49, 27776
 v_mfma_f32_16x16x32_bf16 v[108:111], a[80:83], v[36:39], v[108:111]
 buffer_load_dwordx4 v10, s[8:11], s46 offen offset:896  lds
 v_mfma_f32_16x16x32_bf16 v[116:119], v[36:39], a[144:147], v[116:119]
 v_mfma_f32_16x16x32_bf16 v[124:127], v[36:39], a[208:211], v[124:127]
 s_waitcnt lgkmcnt(2)
 v_mfma_f32_16x16x32_bf16 v[96:99], a[20:23], v[40:43], v[96:99]
 ds_read_b128 v[56:59], v7 offset:12288
 v_mfma_f32_16x16x32_bf16 v[104:107], a[84:87], v[40:43], v[104:107]
 ds_read_b128 v[60:63], v7 offset:14336
 v_mfma_f32_16x16x32_bf16 v[112:115], v[40:43], a[148:151], v[112:115]
 v_mfma_f32_16x16x32_bf16 v[120:123], v[40:43], a[212:215], v[120:123]
 v_mfma_f32_16x16x32_bf16 v[100:103], a[20:23], v[44:47], v[100:103]
 v_add_u32 v2, s46, v1
 v_mfma_f32_16x16x32_bf16 v[108:111], a[84:87], v[44:47], v[108:111]
 buffer_load_dword v15, v2, s[8:11], 0 offen
 v_mfma_f32_16x16x32_bf16 v[116:119], v[44:47], a[148:151], v[116:119]
 v_mfma_f32_16x16x32_bf16 v[124:127], v[44:47], a[212:215], v[124:127]
 s_waitcnt lgkmcnt(2)
 v_mfma_f32_16x16x32_bf16 v[96:99], a[24:27], v[48:51], v[96:99]
 ds_read_b128 v[32:35], v6 offset:16384
 v_mfma_f32_16x16x32_bf16 v[104:107], a[88:91], v[48:51], v[104:107]
 ds_read_b128 v[36:39], v6 offset:18432
 v_mfma_f32_16x16x32_bf16 v[112:115], v[48:51], a[152:155], v[112:115]
 v_cvt_pk_bf16_f32 v16, v64, v65
 v_mfma_f32_16x16x32_bf16 v[120:123], v[48:51], a[216:219], v[120:123]
 v_cvt_pk_bf16_f32 v17, v72, v73
 v_mfma_f32_16x16x32_bf16 v[100:103], a[24:27], v[52:55], v[100:103]
 v_mfma_f32_16x16x32_bf16 v[108:111], a[88:91], v[52:55], v[108:111]
 v_cvt_pk_bf16_f32 v18, v66, v67
 v_mfma_f32_16x16x32_bf16 v[116:119], v[52:55], a[152:155], v[116:119]
 v_mfma_f32_16x16x32_bf16 v[124:127], v[52:55], a[216:219], v[124:127]
 s_waitcnt lgkmcnt(2)
 v_mfma_f32_16x16x32_bf16 v[96:99], a[28:31], v[56:59], v[96:99]
 ds_read_b128 v[40:43], v7 offset:16384
 v_mfma_f32_16x16x32_bf16 v[104:107], a[92:95], v[56:59], v[104:107]
 ds_read_b128 v[44:47], v7 offset:18432
 v_mfma_f32_16x16x32_bf16 v[112:115], v[56:59], a[156:159], v[112:115]
 v_cvt_pk_bf16_f32 v19, v74, v75
 v_mfma_f32_16x16x32_bf16 v[120:123], v[56:59], a[220:223], v[120:123]
 v_mfma_f32_16x16x32_bf16 v[100:103], a[28:31], v[60:63], v[100:103]
 buffer_store_dwordx4 v[16:19], v12, s[20:23], s47 offen offset:0 sc1
 v_mfma_f32_16x16x32_bf16 v[108:111], a[92:95], v[60:63], v[108:111]
 v_cvt_pk_bf16_f32 v20, v68, v69
 v_mfma_f32_16x16x32_bf16 v[116:119], v[60:63], a[156:159], v[116:119]
 v_mfma_f32_16x16x32_bf16 v[124:127], v[60:63], a[220:223], v[124:127]
 s_waitcnt lgkmcnt(2)
 v_mfma_f32_16x16x32_bf16 v[96:99], a[32:35], v[32:35], v[96:99]
 ds_read_b128 v[48:51], v6 offset:20480
 v_mfma_f32_16x16x32_bf16 v[104:107], a[96:99], v[32:35], v[104:107]
 ds_read_b128 v[52:55], v6 offset:22528
 v_mfma_f32_16x16x32_bf16 v[112:115], v[32:35], a[160:163], v[112:115]
 v_cvt_pk_bf16_f32 v21, v76, v77
 v_mfma_f32_16x16x32_bf16 v[120:123], v[32:35], a[224:227], v[120:123]
 v_mfma_f32_16x16x32_bf16 v[100:103], a[32:35], v[36:39], v[100:103]
 v_cvt_pk_bf16_f32 v22, v70, v71
 v_mfma_f32_16x16x32_bf16 v[108:111], a[96:99], v[36:39], v[108:111]
 v_mfma_f32_16x16x32_bf16 v[116:119], v[36:39], a[160:163], v[116:119]
 v_cvt_pk_bf16_f32 v23, v78, v79
 v_mfma_f32_16x16x32_bf16 v[124:127], v[36:39], a[224:227], v[124:127]
 s_waitcnt lgkmcnt(2)
 v_mfma_f32_16x16x32_bf16 v[96:99], a[36:39], v[40:43], v[96:99]
 ds_read_b128 v[56:59], v7 offset:20480
 v_mfma_f32_16x16x32_bf16 v[104:107], a[100:103], v[40:43], v[104:107]
 ds_read_b128 v[60:63], v7 offset:22528
 v_mfma_f32_16x16x32_bf16 v[112:115], v[40:43], a[164:167], v[112:115]
 buffer_store_dwordx4 v[20:23], v12, s[20:23], s47 offen offset:1024 sc1
 v_mfma_f32_16x16x32_bf16 v[120:123], v[40:43], a[228:231], v[120:123]
 v_mfma_f32_16x16x32_bf16 v[100:103], a[36:39], v[44:47], v[100:103]
 v_cvt_pk_bf16_f32 v24, v80, v81
 v_mfma_f32_16x16x32_bf16 v[108:111], a[100:103], v[44:47], v[108:111]
 v_mfma_f32_16x16x32_bf16 v[116:119], v[44:47], a[164:167], v[116:119]
 v_cvt_pk_bf16_f32 v25, v84, v85
 v_mfma_f32_16x16x32_bf16 v[124:127], v[44:47], a[228:231], v[124:127]
 s_waitcnt lgkmcnt(2)
 v_mfma_f32_16x16x32_bf16 v[96:99], a[40:43], v[48:51], v[96:99]
 ds_read_b128 v[32:35], v6 offset:24576
 v_mfma_f32_16x16x32_bf16 v[104:107], a[104:107], v[48:51], v[104:107]
 ds_read_b128 v[36:39], v6 offset:26624
 v_mfma_f32_16x16x32_bf16 v[112:115], v[48:51], a[168:171], v[112:115]
 v_mfma_f32_16x16x32_bf16 v[120:123], v[48:51], a[232:235], v[120:123]
 v_cvt_pk_bf16_f32 v26, v82, v83
 v_mfma_f32_16x16x32_bf16 v[100:103], a[40:43], v[52:55], v[100:103]
 v_cvt_pk_bf16_f32 v27, v86, v87
 v_mfma_f32_16x16x32_bf16 v[108:111], a[104:107], v[52:55], v[108:111]
 v_mfma_f32_16x16x32_bf16 v[116:119], v[52:55], a[168:171], v[116:119]
 buffer_store_dwordx4 v[24:27], v12, s[20:23], s48 offen offset:0 sc1
 v_mfma_f32_16x16x32_bf16 v[124:127], v[52:55], a[232:235], v[124:127]
 s_waitcnt lgkmcnt(2)
 v_mfma_f32_16x16x32_bf16 v[96:99], a[44:47], v[56:59], v[96:99]
 ds_read_b128 v[40:43], v7 offset:24576
 v_mfma_f32_16x16x32_bf16 v[104:107], a[108:111], v[56:59], v[104:107]
 ds_read_b128 v[44:47], v7 offset:26624
 v_mfma_f32_16x16x32_bf16 v[112:115], v[56:59], a[172:175], v[112:115]
 s_add_u32 s43, s43, 32768
 s_cmp_eq_u32 s43, 131072
 v_mfma_f32_16x16x32_bf16 v[120:123], v[56:59], a[236:239], v[120:123]
 s_cselect_b32 s43, 0, s43
 s_add_u32 s44, s44, 32768
 v_mfma_f32_16x16x32_bf16 v[100:103], a[44:47], v[60:63], v[100:103]
 s_cmp_eq_u32 s44, 131072
 s_cselect_b32 s44, 0, s44
 v_mfma_f32_16x16x32_bf16 v[108:111], a[108:111], v[60:63], v[108:111]
 v_mfma_f32_16x16x32_bf16 v[116:119], v[60:63], a[172:175], v[116:119]
 v_cvt_pk_bf16_f32 v28, v88, v89
 v_mfma_f32_16x16x32_bf16 v[124:127], v[60:63], a[236:239], v[124:127]
 s_waitcnt lgkmcnt(2)
 v_mfma_f32_16x16x32_bf16 v[96:99], a[48:51], v[32:35], v[96:99]
 ds_read_b128 v[48:51], v6 offset:28672
 v_mfma_f32_16x16x32_bf16 v[104:107], a[112:115], v[32:35], v[104:107]
 ds_read_b128 v[52:55], v6 offset:30720
 v_mfma_f32_16x16x32_bf16 v[112:115], v[32:35], a[176:179], v[112:115]
 v_add_u32 v6, s43, v4
 v_mfma_f32_16x16x32_bf16 v[120:123], v[32:35], a[240:243], v[120:123]
 v_mfma_f32_16x16x32_bf16 v[100:103], a[48:51], v[36:39], v[100:103]
 v_cvt_pk_bf16_f32 v29, v92, v93
 v_mfma_f32_16x16x32_bf16 v[108:111], a[112:115], v[36:39], v[108:111]
 v_cvt_pk_bf16_f32 v30, v90, v91
 v_mfma_f32_16x16x32_bf16 v[116:119], v[36:39], a[176:179], v[116:119]
 v_mfma_f32_16x16x32_bf16 v[124:127], v[36:39], a[240:243], v[124:127]
 s_waitcnt lgkmcnt(2)
 v_mfma_f32_16x16x32_bf16 v[96:99], a[52:55], v[40:43], v[96:99]
 ds_read_b128 v[56:59], v7 offset:28672
 v_mfma_f32_16x16x32_bf16 v[104:107], a[116:119], v[40:43], v[104:107]
 ds_read_b128 v[60:63], v7 offset:30720
 v_mfma_f32_16x16x32_bf16 v[112:115], v[40:43], a[180:183], v[112:115]
 v_add_u32 v7, s43, v5
 v_mfma_f32_16x16x32_bf16 v[120:123], v[40:43], a[244:247], v[120:123]
 v_cvt_pk_bf16_f32 v31, v94, v95
 v_mfma_f32_16x16x32_bf16 v[100:103], a[52:55], v[44:47], v[100:103]
 v_mfma_f32_16x16x32_bf16 v[108:111], a[116:119], v[44:47], v[108:111]
 buffer_store_dwordx4 v[28:31], v12, s[20:23], s48 offen offset:1024 sc1
 v_mfma_f32_16x16x32_bf16 v[116:119], v[44:47], a[180:183], v[116:119]
 v_mfma_f32_16x16x32_bf16 v[124:127], v[44:47], a[244:247], v[124:127]
 s_waitcnt lgkmcnt(2)
 v_mfma_f32_16x16x32_bf16 v[96:99], a[56:59], v[48:51], v[96:99]
 s_waitcnt vmcnt(13)
 s_barrier
 ds_read_b128 v[32:35], v6 offset:0
 v_mfma_f32_16x16x32_bf16 v[104:107], a[120:123], v[48:51], v[104:107]
 ds_read_b128 v[36:39], v6 offset:2048
 v_mfma_f32_16x16x32_bf16 v[112:115], v[48:51], a[184:187], v[112:115]
 v_mfma_f32_16x16x32_bf16 v[120:123], v[48:51], a[248:251], v[120:123]
 v_mfma_f32_16x16x32_bf16 v[100:103], a[56:59], v[52:55], v[100:103]
 v_mfma_f32_16x16x32_bf16 v[108:111], a[120:123], v[52:55], v[108:111]
 v_mfma_f32_16x16x32_bf16 v[116:119], v[52:55], a[184:187], v[116:119]
 v_mfma_f32_16x16x32_bf16 v[124:127], v[52:55], a[248:251], v[124:127]
 s_waitcnt lgkmcnt(2)
 v_mfma_f32_16x16x32_bf16 v[96:99], a[60:63], v[56:59], v[96:99]
 ds_read_b128 v[40:43], v7 offset:0
 v_mfma_f32_16x16x32_bf16 v[104:107], a[124:127], v[56:59], v[104:107]
 ds_read_b128 v[44:47], v7 offset:2048
 v_mfma_f32_16x16x32_bf16 v[112:115], v[56:59], a[188:191], v[112:115]
 s_mul_i32 s45, s39, 524288
 s_add_u32 s47, s34, s45
 v_mfma_f32_16x16x32_bf16 v[120:123], v[56:59], a[252:255], v[120:123]
 s_add_u32 s48, s35, s45
 v_mov_b32 v14, s42
 v_mfma_f32_16x16x32_bf16 v[100:103], a[60:63], v[60:63], v[100:103]
 s_mov_b32 s39, s40
 s_mov_b32 s40, s41
 v_mfma_f32_16x16x32_bf16 v[108:111], a[124:127], v[60:63], v[108:111]
 s_add_u32 s42, s42, 1
 s_cmp_lt_u32 s42, s36
 v_mfma_f32_16x16x32_bf16 v[116:119], v[60:63], a[188:191], v[116:119]
 v_mfma_f32_16x16x32_bf16 v[124:127], v[60:63], a[252:255], v[124:127]
 s_waitcnt lgkmcnt(2)
 s_cbranch_scc1 Lps_loop_6
 s_nop 7
 v_cvt_pk_bf16_f32 v16, v96, v97
 v_cvt_pk_bf16_f32 v17, v104, v105
 v_cvt_pk_bf16_f32 v18, v98, v99
 v_cvt_pk_bf16_f32 v19, v106, v107
 buffer_store_dwordx4 v[16:19], v12, s[20:23], s47 offen offset:0 sc1
 v_cvt_pk_bf16_f32 v20, v100, v101
 v_cvt_pk_bf16_f32 v21, v108, v109
 v_cvt_pk_bf16_f32 v22, v102, v103
 v_cvt_pk_bf16_f32 v23, v110, v111
 buffer_store_dwordx4 v[20:23], v12, s[20:23], s47 offen offset:1024 sc1
 v_cvt_pk_bf16_f32 v24, v112, v113
 v_cvt_pk_bf16_f32 v25, v116, v117
 v_cvt_pk_bf16_f32 v26, v114, v115
 v_cvt_pk_bf16_f32 v27, v118, v119
 buffer_store_dwordx4 v[24:27], v12, s[20:23], s48 offen offset:0 sc1
 v_cvt_pk_bf16_f32 v28, v120, v121
 v_cvt_pk_bf16_f32 v29, v124, v125
 v_cvt_pk_bf16_f32 v30, v122, v123
 v_cvt_pk_bf16_f32 v31, v126, v127
 buffer_store_dwordx4 v[28:31], v12, s[20:23], s48 offen offset:1024 sc1
 s_waitcnt vmcnt(0) lgkmcnt(0)
 s_barrier
 v_mov_b32 v14, s36
 buffer_store_dword v14, v13, s[20:23], 0 offen sc1
 s_mov_b32 s32, s3
 s_and_b32 s33, s6, 3
 s_sub_u32 s34, 7, s33
 v_and_b32 v1, 63, v0
 v_lshlrev_b32 v1, 4, v1
 v_mov_b32 v4, 0xff800000
 v_min_u32 v5, 1, v0
 v_lshlrev_b32 v5, 28, v5
 v_mov_b32 v6, 0x3f803f80
 v_accvgpr_write_b32 a192, v6
 v_accvgpr_write_b32 a193, v6
 v_accvgpr_write_b32 a194, v6
 v_accvgpr_write_b32 a195, v6
 s_mov_b32 s52, 0xfff0ffff
 s_mov_b32 s53, 0xf000ff00
 s_mov_b32 s54, 0xffe0fffe
 s_mov_b32 s55, 0xe000fe00
 s_mov_b32 s56, 0xffc0fffc
 s_mov_b32 s57, 0xc000fc00
 s_mov_b32 s58, 0xff80fff8
 s_mov_b32 s59, 0x8000f800
 s_mov_b32 s73, 0x53800000
 s_mov_b32 s74, 0x21800000
 s_lshl_b32 s50, s4, 12
 s_lshl_b32 s45, s32, 14
 s_add_u32 s45, s45, s50
 s_add_u32 s45, s45, 0x1000000
 s_lshl_b32 s36, s33, 3
 s_add_u32 s36, s36, 8
 s_lshl_b32 s47, s34, 3
 s_add_u32 s47, s47, 8
 s_mov_b32 s35, 0
 s_mov_b32 s38, 0
 s_mov_b32 s46, 0
 s_lshl_b32 s7, s3, 7
 s_add_u32 s7, s7, 0x2000
 s_lshr_b32 s94, s3, 1
 s_lshl_b32 s94, s94, 7
 s_add_u32 s94, s94, 0x3000
 v_min_u32 v10, 16, v1
 v_lshlrev_b32 v10, 24, v10
Law_7:
 buffer_load_dwordx4 v[240:243], v10, s[20:23], s94 offen sc1
 buffer_load_dwordx4 v[244:247], v10, s[20:23], s7 offen sc1
 s_waitcnt vmcnt(0)
 v_min3_u32 v240, v240, v241, v242
 v_min_u32 v240, v240, v243
 v_lshlrev_b32 v240, 1, v240
 v_min3_u32 v240, v240, v244, v245
 v_min3_u32 v240, v240, v246, v247
 v_cmp_le_u32 vcc, 16, v240
 s_cbranch_vccnz Lawk_8
 s_sleep 2
 s_sub_u32 s95, s95, 1
 s_cbranch_scc0 Law_7
 s_endpgm
Lawk_8:
 s_lshl_b32 s37, s35, 19
 s_add_u32 m0, s38, s50
 s_add_u32 s37, s37, s45
 buffer_load_dwordx4 v1, s[20:23], s37 offen offset:0 sc1 lds
 buffer_load_dwordx4 v1, s[20:23], s37 offen offset:1024 sc1 lds
 buffer_load_dwordx4 v1, s[20:23], s37 offen offset:2048 sc1 lds
 buffer_load_dwordx4 v1, s[20:23], s37 offen offset:3072 sc1 lds
 s_add_u32 s38, s38, 0x4000
 s_and_b32 s38, s38, 0x1ffff
 s_add_u32 s35, s35, 1
 s_cmp_eq_u32 s35, s36
 s_cselect_b32 s36, s47, s36
 s_cselect_b32 s35, 0, s35
 s_lshl_b32 s44, s33, 3
 s_add_u32 s44, s44, s4
 s_lshl_b32 s44, s44, 5
 s_add_u32 s44, s44, s32
 s_lshl_b32 s44, s44, 13
 s_add_u32 s44, s44, 0x5000000
 buffer_load_dwordx4 a[0:3], v1, s[20:23], s44 offen offset:0 sc1
 buffer_load_dwordx4 a[16:19], v1, s[20:23], s44 offen offset:1024 sc1
 buffer_load_dwordx4 a[4:7], v1, s[20:23], s44 offen offset:2048 sc1
 buffer_load_dwordx4 a[20:23], v1, s[20:23], s44 offen offset:3072 sc1
 s_add_u32 s44, s44, 4096
 buffer_load_dwordx4 a[8:11], v1, s[20:23], s44 offen offset:0 sc1
 buffer_load_dwordx4 a[24:27], v1, s[20:23], s44 offen offset:1024 sc1
 buffer_load_dwordx4 a[12:15], v1, s[20:23], s44 offen offset:2048 sc1
 buffer_load_dwordx4 a[28:31], v1, s[20:23], s44 offen offset:3072 sc1
 s_lshl_b32 s44, s33, 3
 s_add_u32 s44, s44, 7
 s_sub_u32 s44, s44, s4
 s_lshl_b32 s44, s44, 5
 s_add_u32 s44, s44, s32
 s_lshl_b32 s44, s44, 13
 s_add_u32 s44, s44, 0x5000000
 buffer_load_dwordx4 a[32:35], v1, s[20:23], s44 offen offset:0 sc1
 buffer_load_dwordx4 a[48:51], v1, s[20:23], s44 offen offset:1024 sc1
 buffer_load_dwordx4 a[36:39], v1, s[20:23], s44 offen offset:2048 sc1
 buffer_load_dwordx4 a[52:55], v1, s[20:23], s44 offen offset:3072 sc1
 s_add_u32 s44, s44, 4096
 buffer_load_dwordx4 a[40:43], v1, s[20:23], s44 offen offset:0 sc1
 buffer_load_dwordx4 a[56:59], v1, s[20:23], s44 offen offset:1024 sc1
 buffer_load_dwordx4 a[44:47], v1, s[20:23], s44 offen offset:2048 sc1
 buffer_load_dwordx4 a[60:63], v1, s[20:23], s44 offen offset:3072 sc1
 s_lshl_b32 s37, s35, 19
 s_add_u32 m0, s38, s50
 s_add_u32 s37, s37, s45
 buffer_load_dwordx4 v1, s[20:23], s37 offen offset:0 sc1 lds
 buffer_load_dwordx4 v1, s[20:23], s37 offen offset:1024 sc1 lds
 buffer_load_dwordx4 v1, s[20:23], s37 offen offset:2048 sc1 lds
 buffer_load_dwordx4 v1, s[20:23], s37 offen offset:3072 sc1 lds
 s_add_u32 s38, s38, 0x4000
 s_and_b32 s38, s38, 0x1ffff
 s_add_u32 s35, s35, 1
 s_cmp_eq_u32 s35, s36
 s_cselect_b32 s36, s47, s36
 s_cselect_b32 s35, 0, s35
 s_lshl_b32 s37, s35, 19
 s_add_u32 m0, s38, s50
 s_add_u32 s37, s37, s45
 buffer_load_dwordx4 v1, s[20:23], s37 offen offset:0 sc1 lds
 buffer_load_dwordx4 v1, s[20:23], s37 offen offset:1024 sc1 lds
 buffer_load_dwordx4 v1, s[20:23], s37 offen offset:2048 sc1 lds
 buffer_load_dwordx4 v1, s[20:23], s37 offen offset:3072 sc1 lds
 s_add_u32 s38, s38, 0x4000
 s_and_b32 s38, s38, 0x1ffff
 s_add_u32 s35, s35, 1
 s_cmp_eq_u32 s35, s36
 s_cselect_b32 s36, s47, s36
 s_cselect_b32 s35, 0, s35
 s_waitcnt vmcnt(8)
 s_barrier
 v_mov_b32 v2, v1
 ds_read_b128 a[128:131], v2 offset:0
 ds_read_b128 a[132:135], v2 offset:1024
 ds_read_b128 a[136:139], v2 offset:2048
 ds_read_b128 a[140:143], v2 offset:3072
 ds_read_b128 a[144:147], v2 offset:4096
 ds_read_b128 a[148:151], v2 offset:5120
 ds_read_b128 a[152:155], v2 offset:6144
 ds_read_b128 a[156:159], v2 offset:7168
 s_mov_b32 s39, 0
 s_add_u32 s39, s39, 0x4000
 s_and_b32 s39, s39, 0x1ffff
 v_mov_b32 v3, v2
 v_add_u32 v2, s39, v1
Lablk_9:
 s_lshl_b32 s43, s33, 3
 s_add_u32 s41, s43, s4
 s_add_u32 s42, s43, 7
 s_sub_u32 s42, s42, s4
 s_mov_b32 s49, 0
 s_waitcnt lgkmcnt(0)
 v_mfma_f32_16x16x32_bf16 v[48:51], a[128:131], a[0:3], 0
 s_cmp_lt_u32 s49, s41
 v_mov_b64 v[176:177], 0
 v_mov_b64 v[178:179], 0
 v_mfma_f32_16x16x32_bf16 v[56:59], a[128:131], a[16:19], 0
 s_cselect_b64 s[68:69], -1, 0
 v_mov_b64 v[180:181], 0
 v_mov_b64 v[182:183], 0
 v_mfma_f32_16x16x32_bf16 v[64:67], a[128:131], a[32:35], 0
 v_mfma_f32_16x16x32_bf16 v[72:75], a[128:131], a[48:51], 0
 s_cmp_le_u32 s49, s41
 v_mov_b64 v[184:185], 0
 v_mov_b64 v[186:187], 0
 v_mfma_f32_16x16x32_bf16 v[48:51], a[136:139], a[4:7], v[48:51]
 v_mfma_f32_16x16x32_bf16 v[56:59], a[136:139], a[20:23], v[56:59]
 s_cselect_b64 s[70:71], -1, 0
 v_mov_b64 v[188:189], 0
 v_mov_b64 v[190:191], 0
 v_mfma_f32_16x16x32_bf16 v[64:67], a[136:139], a[36:39], v[64:67]
 v_mfma_f32_16x16x32_bf16 v[72:75], a[136:139], a[52:55], v[72:75]
 s_cmp_eq_u32 s49, s41
 v_mov_b64 v[192:193], 0
 v_mov_b64 v[194:195], 0
 v_mfma_f32_16x16x32_bf16 v[48:51], a[144:147], a[8:11], v[48:51]
 s_cselect_b64 s[60:61], s[52:53], s[68:69]
 v_mfma_f32_16x16x32_bf16 v[56:59], a[144:147], a[24:27], v[56:59]
 v_mov_b64 v[196:197], 0
 v_mov_b64 v[198:199], 0
 v_mfma_f32_16x16x32_bf16 v[64:67], a[144:147], a[40:43], v[64:67]
 s_cselect_b64 s[62:63], s[54:55], s[68:69]
 v_mfma_f32_16x16x32_bf16 v[72:75], a[144:147], a[56:59], v[72:75]
 v_mov_b64 v[200:201], 0
 v_mov_b64 v[202:203], 0
 v_mfma_f32_16x16x32_bf16 v[48:51], a[152:155], a[12:15], v[48:51]
 s_cselect_b64 s[64:65], s[56:57], s[68:69]
 v_mfma_f32_16x16x32_bf16 v[56:59], a[152:155], a[28:31], v[56:59]
 v_mov_b64 v[204:205], 0
 v_mov_b64 v[206:207], 0
 v_mfma_f32_16x16x32_bf16 v[64:67], a[152:155], a[44:47], v[64:67]
 s_cselect_b64 s[66:67], s[58:59], s[68:69]
 v_mfma_f32_16x16x32_bf16 v[72:75], a[152:155], a[60:63], v[72:75]
 s_nop 4
 v_max3_f32 v12, v48, v49, v50
 v_max3_f32 v13, v56, v57, v58
 v_max3_f32 v14, v64, v65, v66
 v_max3_f32 v15, v72, v73, v74
 v_max_f32 v12, v12, v51
 v_max_f32 v13, v13, v59
 v_max_f32 v14, v14, v67
 v_max_f32 v15, v15, v75
 v_mov_b32 v6, v12
 v_mov_b32 v7, v13
 v_mov_b32 v8, v14
 v_mov_b32 v9, v15
 v_permlane16_swap_b32 v12, v6
 v_permlane16_swap_b32 v13, v7
 v_permlane16_swap_b32 v14, v8
 v_permlane16_swap_b32 v15, v9
 v_max_f32 v12, v12, v6
 v_max_f32 v13, v13, v7
 v_max_f32 v14, v14, v8
 v_max_f32 v15, v15, v9
 v_mov_b32 v6, v12
 v_mov_b32 v7, v13
 v_mov_b32 v8, v14
 v_mov_b32 v9, v15
 v_permlane32_swap_b32 v12, v6
 v_permlane32_swap_b32 v13, v7
 v_permlane32_swap_b32 v14, v8
 v_permlane32_swap_b32 v15, v9
 v_max_f32 v12, v12, v6
 v_max_f32 v13, v13, v7
 v_max_f32 v14, v14, v8
 v_max_f32 v15, v15, v9
 v_sub_f32 v12, 0, v12
 v_sub_f32 v13, 0, v13
 v_sub_f32 v14, 0, v14
 v_sub_f32 v15, 0, v15
 v_cndmask_b32 v80, v4, v12, s[60:61]
 v_cndmask_b32 v81, v4, v12, s[62:63]
 v_cndmask_b32 v82, v4, v12, s[64:65]
 v_cndmask_b32 v83, v4, v12, s[66:67]
 v_cndmask_b32 v84, v4, v12, s[68:69]
 v_cndmask_b32 v85, v4, v12, s[68:69]
 v_cndmask_b32 v86, v4, v12, s[68:69]
 v_cndmask_b32 v87, v4, v12, s[68:69]
 v_cndmask_b32 v88, v4, v13, s[70:71]
 v_cndmask_b32 v89, v4, v13, s[70:71]
 v_cndmask_b32 v90, v4, v13, s[70:71]
 v_cndmask_b32 v91, v4, v13, s[70:71]
 v_cndmask_b32 v92, v4, v13, s[60:61]
 v_cndmask_b32 v93, v4, v13, s[62:63]
 v_cndmask_b32 v94, v4, v13, s[64:65]
 v_cndmask_b32 v95, v4, v13, s[66:67]
 v_mov_b32 v96, v14
 v_mov_b32 v97, v14
 v_mov_b32 v98, v14
 v_mov_b32 v99, v14
 v_mov_b32 v100, v14
 v_mov_b32 v101, v14
 v_mov_b32 v102, v14
 v_mov_b32 v103, v14
 v_mov_b32 v104, v15
 v_mov_b32 v105, v15
 v_mov_b32 v106, v15
 v_mov_b32 v107, v15
 v_mov_b32 v108, v15
 v_mov_b32 v109, v15
 v_mov_b32 v110, v15
 v_mov_b32 v111, v15
 s_waitcnt lgkmcnt(0)
 v_mfma_f32_16x16x32_bf16 v[48:51], a[128:131], a[0:3], v[80:83]
 ds_read_b128 a[160:163], v3 offset:8192
 v_mov_b64 v[208:209], 0
 v_mov_b64 v[210:211], 0
 v_mfma_f32_16x16x32_bf16 v[56:59], a[128:131], a[16:19], v[88:91]
 v_mov_b64 v[212:213], 0
 v_mov_b64 v[214:215], 0
 v_mfma_f32_16x16x32_bf16 v[52:55], a[132:135], a[0:3], v[84:87]
 ds_read_b128 a[164:167], v3 offset:9216
 v_mfma_f32_16x16x32_bf16 v[60:63], a[132:135], a[16:19], v[92:95]
 v_mov_b64 v[216:217], 0
 v_mov_b64 v[218:219], 0
 v_mfma_f32_16x16x32_bf16 v[48:51], a[136:139], a[4:7], v[48:51]
 ds_read_b128 a[168:171], v3 offset:10240
 v_mov_b64 v[220:221], 0
 v_mov_b64 v[222:223], 0
 v_mfma_f32_16x16x32_bf16 v[56:59], a[136:139], a[20:23], v[56:59]
 v_mfma_f32_16x16x32_bf16 v[52:55], a[140:143], a[4:7], v[52:55]
 ds_read_b128 a[172:175], v3 offset:11264
 v_mov_b64 v[224:225], 0
 v_mov_b64 v[226:227], 0
 v_mfma_f32_16x16x32_bf16 v[60:63], a[140:143], a[20:23], v[60:63]
 v_mov_b64 v[228:229], 0
 v_mov_b64 v[230:231], 0
 v_mfma_f32_16x16x32_bf16 v[48:51], a[144:147], a[8:11], v[48:51]
 ds_read_b128 a[176:179], v3 offset:12288
 v_mfma_f32_16x16x32_bf16 v[56:59], a[144:147], a[24:27], v[56:59]
 v_mov_b64 v[232:233], 0
 v_mov_b64 v[234:235], 0
 v_mfma_f32_16x16x32_bf16 v[52:55], a[148:151], a[8:11], v[52:55]
 ds_read_b128 a[180:183], v3 offset:13312
 v_mov_b64 v[236:237], 0
 v_mov_b64 v[238:239], 0
 v_mfma_f32_16x16x32_bf16 v[60:63], a[148:151], a[24:27], v[60:63]
 v_mfma_f32_16x16x32_bf16 v[48:51], a[152:155], a[12:15], v[48:51]
 ds_read_b128 a[184:187], v3 offset:14336
 v_mov_b64 v[40:41], 0
 v_mov_b64 v[42:43], 0
 v_mfma_f32_16x16x32_bf16 v[56:59], a[152:155], a[28:31], v[56:59]
 v_mov_b64 v[44:45], 0
 v_mov_b64 v[46:47], 0
 v_mfma_f32_16x16x32_bf16 v[52:55], a[156:159], a[12:15], v[52:55]
 ds_read_b128 a[188:191], v3 offset:15360
 v_mfma_f32_16x16x32_bf16 v[60:63], a[156:159], a[28:31], v[60:63]
 v_mfma_f32_16x16x32_bf16 v[64:67], a[128:131], a[32:35], v[96:99]
 s_waitcnt vmcnt(4)
 s_barrier
 v_mfma_f32_16x16x32_bf16 v[72:75], a[128:131], a[48:51], v[104:107]
 ds_read_b128 a[128:131], v2 offset:0
 v_mfma_f32_16x16x32_bf16 v[68:71], a[132:135], a[32:35], v[100:103]
 s_add_u32 s49, s49, 1
 v_mfma_f32_16x16x32_bf16 v[76:79], a[132:135], a[48:51], v[108:111]
 ds_read_b128 a[132:135], v2 offset:1024
 v_exp_f32 v48, v48
 v_exp_f32 v49, v49
 v_mfma_f32_16x16x32_bf16 v[64:67], a[136:139], a[36:39], v[64:67]
 s_cmp_lt_u32 s49, s41
 v_exp_f32 v52, v52
 v_exp_f32 v53, v53
 v_mfma_f32_16x16x32_bf16 v[72:75], a[136:139], a[52:55], v[72:75]
 ds_read_b128 a[136:139], v2 offset:2048
 v_exp_f32 v50, v50
 v_mfma_f32_16x16x32_bf16 v[68:71], a[140:143], a[36:39], v[68:71]
 s_cselect_b64 s[68:69], -1, 0
 v_cvt_pk_bf16_f32 v16, v48, v49
 v_cvt_pk_bf16_f32 v17, v52, v53
 v_exp_f32 v51, v51
 v_mfma_f32_16x16x32_bf16 v[76:79], a[140:143], a[52:55], v[76:79]
 ds_read_b128 a[140:143], v2 offset:3072
 v_exp_f32 v54, v54
 v_exp_f32 v55, v55
 v_mfma_f32_16x16x32_bf16 v[64:67], a[144:147], a[40:43], v[64:67]
 v_cvt_pk_bf16_f32 v18, v50, v51
 v_cvt_pk_bf16_f32 v19, v54, v55
 v_mfma_f32_16x16x32_bf16 v[72:75], a[144:147], a[56:59], v[72:75]
 ds_read_b128 a[144:147], v2 offset:4096
 v_exp_f32 v56, v56
 v_exp_f32 v57, v57
 v_mfma_f32_16x16x32_bf16 v[68:71], a[148:151], a[40:43], v[68:71]
 s_cmp_le_u32 s49, s41
 v_exp_f32 v60, v60
 v_exp_f32 v61, v61
 v_mfma_f32_16x16x32_bf16 v[76:79], a[148:151], a[56:59], v[76:79]
 ds_read_b128 a[148:151], v2 offset:5120
 v_exp_f32 v58, v58
 v_mfma_f32_16x16x32_bf16 v[64:67], a[152:155], a[44:47], v[64:67]
 s_cselect_b64 s[70:71], -1, 0
 v_cvt_pk_bf16_f32 v20, v56, v57
 v_cvt_pk_bf16_f32 v21, v60, v61
 v_exp_f32 v59, v59
 v_mfma_f32_16x16x32_bf16 v[72:75], a[152:155], a[60:63], v[72:75]
 ds_read_b128 a[152:155], v2 offset:6144
 v_exp_f32 v62, v62
 v_exp_f32 v63, v63
 v_mfma_f32_16x16x32_bf16 v[68:71], a[156:159], a[44:47], v[68:71]
 v_cvt_pk_bf16_f32 v22, v58, v59
 v_cvt_pk_bf16_f32 v23, v62, v63
 v_mfma_f32_16x16x32_bf16 v[76:79], a[156:159], a[60:63], v[76:79]
 ds_read_b128 a[156:159], v2 offset:7168
 s_waitcnt lgkmcnt(8)
 v_mfma_f32_16x16x32_bf16 v[112:115], a[160:163], v[16:19], 0
 s_add_u32 s39, s39, 0x4000
 s_and_b32 s39, s39, 0x1ffff
 v_mfma_f32_16x16x32_bf16 v[144:147], a[160:163], v[20:23], 0
 s_cmp_eq_u32 s49, s41
 v_mfma_f32_16x16x32_bf16 v[116:119], a[164:167], v[16:19], 0
 s_cselect_b64 s[60:61], s[52:53], s[68:69]
 v_mfma_f32_16x16x32_bf16 v[148:151], a[164:167], v[20:23], 0
 s_cselect_b64 s[62:63], s[54:55], s[68:69]
 v_mov_b32 v3, v2
 v_add_u32 v2, s39, v1
 v_exp_f32 v64, v64
 v_mfma_f32_16x16x32_bf16 v[120:123], a[168:171], v[16:19], 0
 s_cselect_b64 s[64:65], s[56:57], s[68:69]
 v_exp_f32 v65, v65
 v_mfma_f32_16x16x32_bf16 v[152:155], a[168:171], v[20:23], 0
 s_cselect_b64 s[66:67], s[58:59], s[68:69]
 v_exp_f32 v68, v68
 v_mfma_f32_16x16x32_bf16 v[124:127], a[172:175], v[16:19], 0
 s_lshl_b32 s37, s35, 19
 v_exp_f32 v69, v69
 v_exp_f32 v66, v66
 v_mfma_f32_16x16x32_bf16 v[156:159], a[172:175], v[20:23], 0
 s_add_u32 m0, s38, s50
 v_cvt_pk_bf16_f32 v24, v64, v65
 v_cvt_pk_bf16_f32 v25, v68, v69
 v_mfma_f32_16x16x32_bf16 v[128:131], a[176:179], v[16:19], 0
 s_add_u32 s37, s37, s45
 v_exp_f32 v67, v67
 v_mfma_f32_16x16x32_bf16 v[160:163], a[176:179], v[20:23], 0
 buffer_load_dwordx4 v1, s[20:23], s37 offen offset:0 sc1 lds
 buffer_load_dwordx4 v1, s[20:23], s37 offen offset:1024 sc1 lds
 v_exp_f32 v70, v70
 v_mfma_f32_16x16x32_bf16 v[132:135], a[180:183], v[16:19], 0
 buffer_load_dwordx4 v1, s[20:23], s37 offen offset:2048 sc1 lds
 v_exp_f32 v71, v71
 v_cvt_pk_bf16_f32 v26, v66, v67
 v_cvt_pk_bf16_f32 v27, v70, v71
 v_mfma_f32_16x16x32_bf16 v[164:167], a[180:183], v[20:23], 0
 buffer_load_dwordx4 v1, s[20:23], s37 offen offset:3072 sc1 lds
 v_cndmask_b32 v80, v4, v12, s[60:61]
 v_cndmask_b32 v81, v4, v12, s[62:63]
 v_mfma_f32_16x16x32_bf16 v[136:139], a[184:187], v[16:19], 0
 s_add_u32 s38, s38, 0x4000
 v_cndmask_b32 v82, v4, v12, s[64:65]
 v_cndmask_b32 v83, v4, v12, s[66:67]
 v_mfma_f32_16x16x32_bf16 v[168:171], a[184:187], v[20:23], 0
 s_and_b32 s38, s38, 0x1ffff
 v_cndmask_b32 v84, v4, v12, s[68:69]
 v_cndmask_b32 v85, v4, v12, s[68:69]
 v_mfma_f32_16x16x32_bf16 v[140:143], a[188:191], v[16:19], 0
 s_add_u32 s35, s35, 1
 v_cndmask_b32 v86, v4, v12, s[68:69]
 v_cndmask_b32 v87, v4, v12, s[68:69]
 v_cndmask_b32 v88, v4, v13, s[70:71]
 v_cndmask_b32 v89, v4, v13, s[70:71]
 v_mfma_f32_16x16x32_bf16 v[172:175], a[188:191], v[20:23], 0
 s_cmp_eq_u32 s35, s36
 v_cndmask_b32 v90, v4, v13, s[70:71]
 v_cndmask_b32 v91, v4, v13, s[70:71]
 v_mfma_f32_16x16x32_bf16 v[32:35], a[192:195], v[16:19], 0
 s_cselect_b32 s36, s47, s36
 v_cndmask_b32 v92, v4, v13, s[60:61]
 v_cndmask_b32 v93, v4, v13, s[62:63]
 v_mfma_f32_16x16x32_bf16 v[36:39], a[192:195], v[20:23], 0
 s_cselect_b32 s35, 0, s35
 v_cndmask_b32 v94, v4, v13, s[64:65]
 v_cndmask_b32 v95, v4, v13, s[66:67]
 s_cmp_eq_u32 s43, 0
 s_cbranch_scc1 Lamk_14
 s_sub_u32 s40, s43, 1
 .p2align 3
Lapl_13:
 s_waitcnt lgkmcnt(0)
 v_mfma_f32_16x16x32_bf16 v[48:51], a[128:131], a[0:3], v[80:83]
 v_exp_f32 v72, v72
 v_mfma_f32_16x16x32_bf16 v[56:59], a[128:131], a[16:19], v[88:91]
 v_exp_f32 v73, v73
 v_mfma_f32_16x16x32_bf16 v[52:55], a[132:135], a[0:3], v[84:87]
 v_mfma_f32_16x16x32_bf16 v[60:63], a[132:135], a[16:19], v[92:95]
 v_exp_f32 v76, v76
 v_mfma_f32_16x16x32_bf16 v[48:51], a[136:139], a[4:7], v[48:51]
 v_exp_f32 v77, v77
 v_mfma_f32_16x16x32_bf16 v[56:59], a[136:139], a[20:23], v[56:59]
 v_mfma_f32_16x16x32_bf16 v[52:55], a[140:143], a[4:7], v[52:55]
 v_exp_f32 v74, v74
 v_mfma_f32_16x16x32_bf16 v[60:63], a[140:143], a[20:23], v[60:63]
 v_cvt_pk_bf16_f32 v28, v72, v73
 v_cvt_pk_bf16_f32 v29, v76, v77
 v_mfma_f32_16x16x32_bf16 v[48:51], a[144:147], a[8:11], v[48:51]
 v_mfma_f32_16x16x32_bf16 v[56:59], a[144:147], a[24:27], v[56:59]
 v_exp_f32 v75, v75
 v_mfma_f32_16x16x32_bf16 v[52:55], a[148:151], a[8:11], v[52:55]
 v_exp_f32 v78, v78
 v_mfma_f32_16x16x32_bf16 v[60:63], a[148:151], a[24:27], v[60:63]
 v_mfma_f32_16x16x32_bf16 v[48:51], a[152:155], a[12:15], v[48:51]
 v_exp_f32 v79, v79
 v_mfma_f32_16x16x32_bf16 v[56:59], a[152:155], a[28:31], v[56:59]
 v_cvt_pk_bf16_f32 v30, v74, v75
 v_cvt_pk_bf16_f32 v31, v78, v79
 v_mfma_f32_16x16x32_bf16 v[52:55], a[156:159], a[12:15], v[52:55]
 v_mfma_f32_16x16x32_bf16 v[60:63], a[156:159], a[28:31], v[60:63]
 v_mfma_f32_16x16x32_bf16 v[176:179], a[160:163], v[24:27], v[176:179]
 v_mfma_f32_16x16x32_bf16 v[208:211], a[160:163], v[28:31], v[208:211]
 ds_read_b128 a[160:163], v3 offset:8192
 v_mfma_f32_16x16x32_bf16 v[180:183], a[164:167], v[24:27], v[180:183]
 v_mfma_f32_16x16x32_bf16 v[212:215], a[164:167], v[28:31], v[212:215]
 ds_read_b128 a[164:167], v3 offset:9216
 v_exp_f32 v48, v48
 v_mfma_f32_16x16x32_bf16 v[184:187], a[168:171], v[24:27], v[184:187]
 v_exp_f32 v49, v49
 v_mfma_f32_16x16x32_bf16 v[216:219], a[168:171], v[28:31], v[216:219]
 ds_read_b128 a[168:171], v3 offset:10240
 v_exp_f32 v52, v52
 v_mfma_f32_16x16x32_bf16 v[188:191], a[172:175], v[24:27], v[188:191]
 v_mfma_f32_16x16x32_bf16 v[220:223], a[172:175], v[28:31], v[220:223]
 ds_read_b128 a[172:175], v3 offset:11264
 v_exp_f32 v53, v53
 v_mfma_f32_16x16x32_bf16 v[192:195], a[176:179], v[24:27], v[192:195]
 v_exp_f32 v50, v50
 v_mfma_f32_16x16x32_bf16 v[224:227], a[176:179], v[28:31], v[224:227]
 ds_read_b128 a[176:179], v3 offset:12288
 v_mfma_f32_16x16x32_bf16 v[196:199], a[180:183], v[24:27], v[196:199]
 v_cvt_pk_bf16_f32 v16, v48, v49
 v_cvt_pk_bf16_f32 v17, v52, v53
 v_mfma_f32_16x16x32_bf16 v[228:231], a[180:183], v[28:31], v[228:231]
 ds_read_b128 a[180:183], v3 offset:13312
 v_exp_f32 v51, v51
 v_mfma_f32_16x16x32_bf16 v[200:203], a[184:187], v[24:27], v[200:203]
 v_exp_f32 v54, v54
 v_mfma_f32_16x16x32_bf16 v[232:235], a[184:187], v[28:31], v[232:235]
 ds_read_b128 a[184:187], v3 offset:14336
 v_mfma_f32_16x16x32_bf16 v[204:207], a[188:191], v[24:27], v[204:207]
 v_exp_f32 v55, v55
 v_mfma_f32_16x16x32_bf16 v[236:239], a[188:191], v[28:31], v[236:239]
 ds_read_b128 a[188:191], v3 offset:15360
 v_cvt_pk_bf16_f32 v18, v50, v51
 v_cvt_pk_bf16_f32 v19, v54, v55
 v_mfma_f32_16x16x32_bf16 v[40:43], a[192:195], v[24:27], v[40:43]
 v_mfma_f32_16x16x32_bf16 v[44:47], a[192:195], v[28:31], v[44:47]
 v_mfma_f32_16x16x32_bf16 v[64:67], a[128:131], a[32:35], v[96:99]
 s_waitcnt vmcnt(4)
 s_barrier
 v_exp_f32 v56, v56
 v_mfma_f32_16x16x32_bf16 v[72:75], a[128:131], a[48:51], v[104:107]
 ds_read_b128 a[128:131], v2 offset:0
 v_exp_f32 v57, v57
 v_mfma_f32_16x16x32_bf16 v[68:71], a[132:135], a[32:35], v[100:103]
 s_add_u32 s39, s39, 0x4000
 v_mfma_f32_16x16x32_bf16 v[76:79], a[132:135], a[48:51], v[108:111]
 ds_read_b128 a[132:135], v2 offset:1024
 v_exp_f32 v60, v60
 v_mfma_f32_16x16x32_bf16 v[64:67], a[136:139], a[36:39], v[64:67]
 v_exp_f32 v61, v61
 v_mfma_f32_16x16x32_bf16 v[72:75], a[136:139], a[52:55], v[72:75]
 ds_read_b128 a[136:139], v2 offset:2048
 v_mfma_f32_16x16x32_bf16 v[68:71], a[140:143], a[36:39], v[68:71]
 v_exp_f32 v58, v58
 v_mfma_f32_16x16x32_bf16 v[76:79], a[140:143], a[52:55], v[76:79]
 ds_read_b128 a[140:143], v2 offset:3072
 v_cvt_pk_bf16_f32 v20, v56, v57
 v_cvt_pk_bf16_f32 v21, v60, v61
 v_mfma_f32_16x16x32_bf16 v[64:67], a[144:147], a[40:43], v[64:67]
 s_and_b32 s39, s39, 0x1ffff
 v_mfma_f32_16x16x32_bf16 v[72:75], a[144:147], a[56:59], v[72:75]
 ds_read_b128 a[144:147], v2 offset:4096
 v_exp_f32 v59, v59
 v_mfma_f32_16x16x32_bf16 v[68:71], a[148:151], a[40:43], v[68:71]
 v_exp_f32 v62, v62
 v_mfma_f32_16x16x32_bf16 v[76:79], a[148:151], a[56:59], v[76:79]
 ds_read_b128 a[148:151], v2 offset:5120
 v_mfma_f32_16x16x32_bf16 v[64:67], a[152:155], a[44:47], v[64:67]
 v_exp_f32 v63, v63
 v_mfma_f32_16x16x32_bf16 v[72:75], a[152:155], a[60:63], v[72:75]
 ds_read_b128 a[152:155], v2 offset:6144
 v_cvt_pk_bf16_f32 v22, v58, v59
 v_cvt_pk_bf16_f32 v23, v62, v63
 v_mfma_f32_16x16x32_bf16 v[68:71], a[156:159], a[44:47], v[68:71]
 v_mfma_f32_16x16x32_bf16 v[76:79], a[156:159], a[60:63], v[76:79]
 ds_read_b128 a[156:159], v2 offset:7168
 s_waitcnt lgkmcnt(8)
 v_mfma_f32_16x16x32_bf16 v[112:115], a[160:163], v[16:19], v[112:115]
 s_lshl_b32 s37, s35, 19
 v_mov_b32 v3, v2
 v_add_u32 v2, s39, v1
 v_mfma_f32_16x16x32_bf16 v[144:147], a[160:163], v[20:23], v[144:147]
 s_add_u32 m0, s38, s50
 v_mfma_f32_16x16x32_bf16 v[116:119], a[164:167], v[16:19], v[116:119]
 s_add_u32 s37, s37, s45
 v_mfma_f32_16x16x32_bf16 v[148:151], a[164:167], v[20:23], v[148:151]
 buffer_load_dwordx4 v1, s[20:23], s37 offen offset:0 sc1 lds
 v_exp_f32 v64, v64
 v_mfma_f32_16x16x32_bf16 v[120:123], a[168:171], v[16:19], v[120:123]
 buffer_load_dwordx4 v1, s[20:23], s37 offen offset:1024 sc1 lds
 v_mfma_f32_16x16x32_bf16 v[152:155], a[168:171], v[20:23], v[152:155]
 v_exp_f32 v65, v65
 v_mfma_f32_16x16x32_bf16 v[124:127], a[172:175], v[16:19], v[124:127]
 buffer_load_dwordx4 v1, s[20:23], s37 offen offset:2048 sc1 lds
 v_exp_f32 v68, v68
 v_mfma_f32_16x16x32_bf16 v[156:159], a[172:175], v[20:23], v[156:159]
 buffer_load_dwordx4 v1, s[20:23], s37 offen offset:3072 sc1 lds
 v_exp_f32 v69, v69
 v_mfma_f32_16x16x32_bf16 v[128:131], a[176:179], v[16:19], v[128:131]
 s_add_u32 s38, s38, 0x4000
 v_mfma_f32_16x16x32_bf16 v[160:163], a[176:179], v[20:23], v[160:163]
 s_and_b32 s38, s38, 0x1ffff
 v_exp_f32 v66, v66
 v_mfma_f32_16x16x32_bf16 v[132:135], a[180:183], v[16:19], v[132:135]
 s_add_u32 s35, s35, 1
 v_cvt_pk_bf16_f32 v24, v64, v65
 v_cvt_pk_bf16_f32 v25, v68, v69
 v_mfma_f32_16x16x32_bf16 v[164:167], a[180:183], v[20:23], v[164:167]
 v_exp_f32 v67, v67
 v_mfma_f32_16x16x32_bf16 v[136:139], a[184:187], v[16:19], v[136:139]
 s_cmp_eq_u32 s35, s36
 v_mfma_f32_16x16x32_bf16 v[168:171], a[184:187], v[20:23], v[168:171]
 s_cselect_b32 s36, s47, s36
 v_exp_f32 v70, v70
 v_mfma_f32_16x16x32_bf16 v[140:143], a[188:191], v[16:19], v[140:143]
 s_cselect_b32 s35, 0, s35
 v_exp_f32 v71, v71
 v_mfma_f32_16x16x32_bf16 v[172:175], a[188:191], v[20:23], v[172:175]
 s_add_u32 s49, s49, 1
 v_cvt_pk_bf16_f32 v26, v66, v67
 v_cvt_pk_bf16_f32 v27, v70, v71
 v_mfma_f32_16x16x32_bf16 v[32:35], a[192:195], v[16:19], v[32:35]
 s_cmp_lt_u32 s49, s40
 v_mfma_f32_16x16x32_bf16 v[36:39], a[192:195], v[20:23], v[36:39]
 s_cbranch_scc1 Lapl_13
Lamk_14:
 s_add_u32 s40, s43, 4
 .p2align 3
Lamk_16:
 s_waitcnt lgkmcnt(0)
 v_mfma_f32_16x16x32_bf16 v[48:51], a[128:131], a[0:3], v[80:83]
 s_add_u32 s49, s49, 1
 v_exp_f32 v72, v72
 v_mfma_f32_16x16x32_bf16 v[56:59], a[128:131], a[16:19], v[88:91]
 s_cmp_lt_u32 s49, s41
 v_exp_f32 v73, v73
 v_mfma_f32_16x16x32_bf16 v[52:55], a[132:135], a[0:3], v[84:87]
 v_mfma_f32_16x16x32_bf16 v[60:63], a[132:135], a[16:19], v[92:95]
 s_cselect_b64 s[68:69], -1, 0
 v_exp_f32 v76, v76
 v_mfma_f32_16x16x32_bf16 v[48:51], a[136:139], a[4:7], v[48:51]
 s_cmp_le_u32 s49, s41
 v_exp_f32 v77, v77
 v_mfma_f32_16x16x32_bf16 v[56:59], a[136:139], a[20:23], v[56:59]
 v_mfma_f32_16x16x32_bf16 v[52:55], a[140:143], a[4:7], v[52:55]
 s_cselect_b64 s[70:71], -1, 0
 v_exp_f32 v74, v74
 v_mfma_f32_16x16x32_bf16 v[60:63], a[140:143], a[20:23], v[60:63]
 v_cvt_pk_bf16_f32 v28, v72, v73
 v_cvt_pk_bf16_f32 v29, v76, v77
 v_mfma_f32_16x16x32_bf16 v[48:51], a[144:147], a[8:11], v[48:51]
 s_cmp_eq_u32 s49, s41
 v_mfma_f32_16x16x32_bf16 v[56:59], a[144:147], a[24:27], v[56:59]
 s_cselect_b64 s[60:61], s[52:53], s[68:69]
 v_exp_f32 v75, v75
 v_mfma_f32_16x16x32_bf16 v[52:55], a[148:151], a[8:11], v[52:55]
 v_exp_f32 v78, v78
 v_mfma_f32_16x16x32_bf16 v[60:63], a[148:151], a[24:27], v[60:63]
 s_cselect_b64 s[62:63], s[54:55], s[68:69]
 v_mfma_f32_16x16x32_bf16 v[48:51], a[152:155], a[12:15], v[48:51]
 s_cselect_b64 s[64:65], s[56:57], s[68:69]
 v_exp_f32 v79, v79
 v_mfma_f32_16x16x32_bf16 v[56:59], a[152:155], a[28:31], v[56:59]
 v_cvt_pk_bf16_f32 v30, v74, v75
 v_cvt_pk_bf16_f32 v31, v78, v79
 v_mfma_f32_16x16x32_bf16 v[52:55], a[156:159], a[12:15], v[52:55]
 s_cselect_b64 s[66:67], s[58:59], s[68:69]
 v_mfma_f32_16x16x32_bf16 v[60:63], a[156:159], a[28:31], v[60:63]
 v_mfma_f32_16x16x32_bf16 v[176:179], a[160:163], v[24:27], v[176:179]
 v_mfma_f32_16x16x32_bf16 v[208:211], a[160:163], v[28:31], v[208:211]
 ds_read_b128 a[160:163], v3 offset:8192
 v_mfma_f32_16x16x32_bf16 v[180:183], a[164:167], v[24:27], v[180:183]
 v_mfma_f32_16x16x32_bf16 v[212:215], a[164:167], v[28:31], v[212:215]
 ds_read_b128 a[164:167], v3 offset:9216
 v_exp_f32 v48, v48
 v_mfma_f32_16x16x32_bf16 v[184:187], a[168:171], v[24:27], v[184:187]
 v_exp_f32 v49, v49
 v_mfma_f32_16x16x32_bf16 v[216:219], a[168:171], v[28:31], v[216:219]
 ds_read_b128 a[168:171], v3 offset:10240
 v_exp_f32 v52, v52
 v_mfma_f32_16x16x32_bf16 v[188:191], a[172:175], v[24:27], v[188:191]
 v_exp_f32 v53, v53
 v_mfma_f32_16x16x32_bf16 v[220:223], a[172:175], v[28:31], v[220:223]
 ds_read_b128 a[172:175], v3 offset:11264
 v_exp_f32 v50, v50
 v_mfma_f32_16x16x32_bf16 v[192:195], a[176:179], v[24:27], v[192:195]
 v_cvt_pk_bf16_f32 v16, v48, v49
 v_cvt_pk_bf16_f32 v17, v52, v53
 v_mfma_f32_16x16x32_bf16 v[224:227], a[176:179], v[28:31], v[224:227]
 ds_read_b128 a[176:179], v3 offset:12288
 v_exp_f32 v51, v51
 v_mfma_f32_16x16x32_bf16 v[196:199], a[180:183], v[24:27], v[196:199]
 v_exp_f32 v54, v54
 v_mfma_f32_16x16x32_bf16 v[228:231], a[180:183], v[28:31], v[228:231]
 ds_read_b128 a[180:183], v3 offset:13312
 v_exp_f32 v55, v55
 v_mfma_f32_16x16x32_bf16 v[200:203], a[184:187], v[24:27], v[200:203]
 v_cvt_pk_bf16_f32 v18, v50, v51
 v_cvt_pk_bf16_f32 v19, v54, v55
 v_mfma_f32_16x16x32_bf16 v[232:235], a[184:187], v[28:31], v[232:235]
 ds_read_b128 a[184:187], v3 offset:14336
 v_cndmask_b32 v80, v4, v12, s[60:61]
 v_cndmask_b32 v81, v4, v12, s[62:63]
 v_mfma_f32_16x16x32_bf16 v[204:207], a[188:191], v[24:27], v[204:207]
 v_cndmask_b32 v82, v4, v12, s[64:65]
 v_cndmask_b32 v83, v4, v12, s[66:67]
 v_mfma_f32_16x16x32_bf16 v[236:239], a[188:191], v[28:31], v[236:239]
 ds_read_b128 a[188:191], v3 offset:15360
 v_cndmask_b32 v84, v4, v12, s[68:69]
 v_cndmask_b32 v85, v4, v12, s[68:69]
 v_mfma_f32_16x16x32_bf16 v[40:43], a[192:195], v[24:27], v[40:43]
 v_cndmask_b32 v86, v4, v12, s[68:69]
 v_cndmask_b32 v87, v4, v12, s[68:69]
 v_mfma_f32_16x16x32_bf16 v[44:47], a[192:195], v[28:31], v[44:47]
 v_mfma_f32_16x16x32_bf16 v[64:67], a[128:131], a[32:35], v[96:99]
 s_waitcnt vmcnt(4)
 s_barrier
 v_exp_f32 v56, v56
 v_mfma_f32_16x16x32_bf16 v[72:75], a[128:131], a[48:51], v[104:107]
 ds_read_b128 a[128:131], v2 offset:0
 v_exp_f32 v57, v57
 v_mfma_f32_16x16x32_bf16 v[68:71], a[132:135], a[32:35], v[100:103]
 s_add_u32 s39, s39, 0x4000
 v_exp_f32 v60, v60
 v_mfma_f32_16x16x32_bf16 v[76:79], a[132:135], a[48:51], v[108:111]
 ds_read_b128 a[132:135], v2 offset:1024
 v_exp_f32 v61, v61
 v_mfma_f32_16x16x32_bf16 v[64:67], a[136:139], a[36:39], v[64:67]
 v_exp_f32 v58, v58
 v_mfma_f32_16x16x32_bf16 v[72:75], a[136:139], a[52:55], v[72:75]
 ds_read_b128 a[136:139], v2 offset:2048
 v_cvt_pk_bf16_f32 v20, v56, v57
 v_cvt_pk_bf16_f32 v21, v60, v61
 v_mfma_f32_16x16x32_bf16 v[68:71], a[140:143], a[36:39], v[68:71]
 v_exp_f32 v59, v59
 v_mfma_f32_16x16x32_bf16 v[76:79], a[140:143], a[52:55], v[76:79]
 ds_read_b128 a[140:143], v2 offset:3072
 v_exp_f32 v62, v62
 v_mfma_f32_16x16x32_bf16 v[64:67], a[144:147], a[40:43], v[64:67]
 s_and_b32 s39, s39, 0x1ffff
 v_exp_f32 v63, v63
 v_mfma_f32_16x16x32_bf16 v[72:75], a[144:147], a[56:59], v[72:75]
 ds_read_b128 a[144:147], v2 offset:4096
 v_cvt_pk_bf16_f32 v22, v58, v59
 v_cvt_pk_bf16_f32 v23, v62, v63
 v_mfma_f32_16x16x32_bf16 v[68:71], a[148:151], a[40:43], v[68:71]
 v_cndmask_b32 v88, v4, v13, s[70:71]
 v_cndmask_b32 v89, v4, v13, s[70:71]
 v_mfma_f32_16x16x32_bf16 v[76:79], a[148:151], a[56:59], v[76:79]
 ds_read_b128 a[148:151], v2 offset:5120
 v_cndmask_b32 v90, v4, v13, s[70:71]
 v_cndmask_b32 v91, v4, v13, s[70:71]
 v_mfma_f32_16x16x32_bf16 v[64:67], a[152:155], a[44:47], v[64:67]
 v_cndmask_b32 v92, v4, v13, s[60:61]
 v_cndmask_b32 v93, v4, v13, s[62:63]
 v_mfma_f32_16x16x32_bf16 v[72:75], a[152:155], a[60:63], v[72:75]
 ds_read_b128 a[152:155], v2 offset:6144
 v_cndmask_b32 v94, v4, v13, s[64:65]
 v_cndmask_b32 v95, v4, v13, s[66:67]
 v_mfma_f32_16x16x32_bf16 v[68:71], a[156:159], a[44:47], v[68:71]
 v_mfma_f32_16x16x32_bf16 v[76:79], a[156:159], a[60:63], v[76:79]
 ds_read_b128 a[156:159], v2 offset:7168
 s_waitcnt lgkmcnt(8)
 v_mfma_f32_16x16x32_bf16 v[112:115], a[160:163], v[16:19], v[112:115]
 s_lshl_b32 s37, s35, 19
 v_mov_b32 v3, v2
 v_add_u32 v2, s39, v1
 v_mfma_f32_16x16x32_bf16 v[144:147], a[160:163], v[20:23], v[144:147]
 s_add_u32 m0, s38, s50
 v_mfma_f32_16x16x32_bf16 v[116:119], a[164:167], v[16:19], v[116:119]
 s_add_u32 s37, s37, s45
 v_mfma_f32_16x16x32_bf16 v[148:151], a[164:167], v[20:23], v[148:151]
 buffer_load_dwordx4 v1, s[20:23], s37 offen offset:0 sc1 lds
 v_exp_f32 v64, v64
 v_mfma_f32_16x16x32_bf16 v[120:123], a[168:171], v[16:19], v[120:123]
 v_mfma_f32_16x16x32_bf16 v[152:155], a[168:171], v[20:23], v[152:155]
 buffer_load_dwordx4 v1, s[20:23], s37 offen offset:1024 sc1 lds
 v_exp_f32 v65, v65
 v_mfma_f32_16x16x32_bf16 v[124:127], a[172:175], v[16:19], v[124:127]
 buffer_load_dwordx4 v1, s[20:23], s37 offen offset:2048 sc1 lds
 v_exp_f32 v68, v68
 v_mfma_f32_16x16x32_bf16 v[156:159], a[172:175], v[20:23], v[156:159]
 buffer_load_dwordx4 v1, s[20:23], s37 offen offset:3072 sc1 lds
 v_exp_f32 v69, v69
 v_mfma_f32_16x16x32_bf16 v[128:131], a[176:179], v[16:19], v[128:131]
 v_mfma_f32_16x16x32_bf16 v[160:163], a[176:179], v[20:23], v[160:163]
 s_add_u32 s38, s38, 0x4000
 v_exp_f32 v66, v66
 v_mfma_f32_16x16x32_bf16 v[132:135], a[180:183], v[16:19], v[132:135]
 s_and_b32 s38, s38, 0x1ffff
 v_cvt_pk_bf16_f32 v24, v64, v65
 v_cvt_pk_bf16_f32 v25, v68, v69
 v_mfma_f32_16x16x32_bf16 v[164:167], a[180:183], v[20:23], v[164:167]
 s_add_u32 s35, s35, 1
 v_exp_f32 v67, v67
 v_mfma_f32_16x16x32_bf16 v[136:139], a[184:187], v[16:19], v[136:139]
 s_cmp_eq_u32 s35, s36
 v_mfma_f32_16x16x32_bf16 v[168:171], a[184:187], v[20:23], v[168:171]
 v_exp_f32 v70, v70
 v_mfma_f32_16x16x32_bf16 v[140:143], a[188:191], v[16:19], v[140:143]
 s_cselect_b32 s36, s47, s36
 v_exp_f32 v71, v71
 v_mfma_f32_16x16x32_bf16 v[172:175], a[188:191], v[20:23], v[172:175]
 s_cselect_b32 s35, 0, s35
 v_cvt_pk_bf16_f32 v26, v66, v67
 v_cvt_pk_bf16_f32 v27, v70, v71
 v_mfma_f32_16x16x32_bf16 v[32:35], a[192:195], v[16:19], v[32:35]
 s_cmp_lt_u32 s49, s40
 v_mfma_f32_16x16x32_bf16 v[36:39], a[192:195], v[20:23], v[36:39]
 s_cbranch_scc1 Lamk_16
 s_add_u32 s40, s43, 8
 s_cmp_eq_u32 s46, 0
 s_cbranch_scc0 Laq2_17
 v_min_u32 v10, 16, v1
 v_lshlrev_b32 v10, 24, v10
Law_19:
 buffer_load_dwordx4 v[240:243], v10, s[20:23], s94 offen sc1
 s_waitcnt vmcnt(0)
 v_min3_u32 v240, v240, v241, v242
 v_min_u32 v240, v240, v243
 v_cmp_le_u32 vcc, 16, v240
 s_cbranch_vccnz Lawk_20
 s_sleep 2
 s_sub_u32 s95, s95, 1
 s_cbranch_scc0 Law_19
 s_endpgm
Lawk_20:
 s_lshl_b32 s44, s34, 3
 s_add_u32 s44, s44, s4
 s_lshl_b32 s44, s44, 5
 s_add_u32 s44, s44, s32
 s_lshl_b32 s44, s44, 13
 s_add_u32 s44, s44, 0x5000000
 buffer_load_dwordx4 a[64:67], v1, s[20:23], s44 offen offset:0 sc1
 buffer_load_dwordx4 a[80:83], v1, s[20:23], s44 offen offset:1024 sc1
 buffer_load_dwordx4 a[68:71], v1, s[20:23], s44 offen offset:2048 sc1
 buffer_load_dwordx4 a[84:87], v1, s[20:23], s44 offen offset:3072 sc1
 s_add_u32 s44, s44, 4096
 buffer_load_dwordx4 a[72:75], v1, s[20:23], s44 offen offset:0 sc1
 buffer_load_dwordx4 a[88:91], v1, s[20:23], s44 offen offset:1024 sc1
 buffer_load_dwordx4 a[76:79], v1, s[20:23], s44 offen offset:2048 sc1
 buffer_load_dwordx4 a[92:95], v1, s[20:23], s44 offen offset:3072 sc1
 s_lshl_b32 s44, s34, 3
 s_add_u32 s44, s44, 7
 s_sub_u32 s44, s44, s4
 s_lshl_b32 s44, s44, 5
 s_add_u32 s44, s44, s32
 s_lshl_b32 s44, s44, 13
 s_add_u32 s44, s44, 0x5000000
 buffer_load_dwordx4 a[96:99], v1, s[20:23], s44 offen offset:0 sc1
 buffer_load_dwordx4 a[112:115], v1, s[20:23], s44 offen offset:1024 sc1
 buffer_load_dwordx4 a[100:103], v1, s[20:23], s44 offen offset:2048 sc1
 buffer_load_dwordx4 a[116:119], v1, s[20:23], s44 offen offset:3072 sc1
 s_add_u32 s44, s44, 4096
 buffer_load_dwordx4 a[104:107], v1, s[20:23], s44 offen offset:0 sc1
 buffer_load_dwordx4 a[120:123], v1, s[20:23], s44 offen offset:1024 sc1
 buffer_load_dwordx4 a[108:111], v1, s[20:23], s44 offen offset:2048 sc1
 buffer_load_dwordx4 a[124:127], v1, s[20:23], s44 offen offset:3072 sc1
 s_branch Laq2_18
Laq2_17:
 v_mov_b32 v6, 1
 buffer_store_dword v6, v5, s[20:23], s72 offen sc1
Laq2_18:
 s_cmp_lt_u32 s49, s42
 s_cselect_b64 s[68:69], -1, 0
 s_cmp_le_u32 s49, s42
 s_cselect_b64 s[70:71], -1, 0
 s_cmp_eq_u32 s49, s42
 s_cselect_b64 s[60:61], s[52:53], s[68:69]
 s_cselect_b64 s[62:63], s[54:55], s[68:69]
 s_cselect_b64 s[64:65], s[56:57], s[68:69]
 s_cselect_b64 s[66:67], s[58:59], s[68:69]
 v_mfma_f32_16x16x32_bf16 v[176:179], a[160:163], v[24:27], v[176:179]
 v_cndmask_b32 v96, v4, v14, s[60:61]
 v_cndmask_b32 v97, v4, v14, s[62:63]
 v_mfma_f32_16x16x32_bf16 v[180:183], a[164:167], v[24:27], v[180:183]
 v_cndmask_b32 v98, v4, v14, s[64:65]
 v_cndmask_b32 v99, v4, v14, s[66:67]
 v_mfma_f32_16x16x32_bf16 v[184:187], a[168:171], v[24:27], v[184:187]
 v_cndmask_b32 v100, v4, v14, s[68:69]
 v_cndmask_b32 v101, v4, v14, s[68:69]
 v_mfma_f32_16x16x32_bf16 v[188:191], a[172:175], v[24:27], v[188:191]
 v_exp_f32 v72, v72
 v_mfma_f32_16x16x32_bf16 v[192:195], a[176:179], v[24:27], v[192:195]
 v_exp_f32 v73, v73
 v_mfma_f32_16x16x32_bf16 v[196:199], a[180:183], v[24:27], v[196:199]
 v_exp_f32 v76, v76
 v_mfma_f32_16x16x32_bf16 v[200:203], a[184:187], v[24:27], v[200:203]
 v_exp_f32 v77, v77
 v_mfma_f32_16x16x32_bf16 v[204:207], a[188:191], v[24:27], v[204:207]
 v_exp_f32 v74, v74
 v_mfma_f32_16x16x32_bf16 v[40:43], a[192:195], v[24:27], v[40:43]
 v_cndmask_b32 v102, v4, v14, s[68:69]
 v_cndmask_b32 v103, v4, v14, s[68:69]
 s_nop 0
 .p2align 3
Lam1_15:
 s_waitcnt lgkmcnt(0)
 v_mfma_f32_16x16x32_bf16 v[64:67], a[128:131], a[32:35], v[96:99]
 v_cvt_pk_bf16_f32 v28, v72, v73
 v_cvt_pk_bf16_f32 v29, v76, v77
 v_mfma_f32_16x16x32_bf16 v[68:71], a[132:135], a[32:35], v[100:103]
 v_exp_f32 v75, v75
 v_mfma_f32_16x16x32_bf16 v[64:67], a[136:139], a[36:39], v[64:67]
 v_exp_f32 v78, v78
 v_mfma_f32_16x16x32_bf16 v[68:71], a[140:143], a[36:39], v[68:71]
 v_exp_f32 v79, v79
 v_mfma_f32_16x16x32_bf16 v[64:67], a[144:147], a[40:43], v[64:67]
 v_cvt_pk_bf16_f32 v30, v74, v75
 v_cvt_pk_bf16_f32 v31, v78, v79
 v_mfma_f32_16x16x32_bf16 v[68:71], a[148:151], a[40:43], v[68:71]
 v_cndmask_b32 v104, v4, v15, s[70:71]
 v_cndmask_b32 v105, v4, v15, s[70:71]
 v_mfma_f32_16x16x32_bf16 v[64:67], a[152:155], a[44:47], v[64:67]
 v_mfma_f32_16x16x32_bf16 v[68:71], a[156:159], a[44:47], v[68:71]
 v_mfma_f32_16x16x32_bf16 v[208:211], a[160:163], v[28:31], v[208:211]
 ds_read_b128 a[160:163], v3 offset:8192
 v_cndmask_b32 v106, v4, v15, s[70:71]
 v_cndmask_b32 v107, v4, v15, s[70:71]
 v_mfma_f32_16x16x32_bf16 v[212:215], a[164:167], v[28:31], v[212:215]
 ds_read_b128 a[164:167], v3 offset:9216
 v_cndmask_b32 v108, v4, v15, s[60:61]
 v_cndmask_b32 v109, v4, v15, s[62:63]
 v_mfma_f32_16x16x32_bf16 v[216:219], a[168:171], v[28:31], v[216:219]
 ds_read_b128 a[168:171], v3 offset:10240
 v_cndmask_b32 v110, v4, v15, s[64:65]
 v_cndmask_b32 v111, v4, v15, s[66:67]
 v_mfma_f32_16x16x32_bf16 v[220:223], a[172:175], v[28:31], v[220:223]
 ds_read_b128 a[172:175], v3 offset:11264
 v_exp_f32 v64, v64
 v_mfma_f32_16x16x32_bf16 v[224:227], a[176:179], v[28:31], v[224:227]
 ds_read_b128 a[176:179], v3 offset:12288
 v_exp_f32 v65, v65
 v_mfma_f32_16x16x32_bf16 v[228:231], a[180:183], v[28:31], v[228:231]
 ds_read_b128 a[180:183], v3 offset:13312
 v_exp_f32 v68, v68
 v_mfma_f32_16x16x32_bf16 v[232:235], a[184:187], v[28:31], v[232:235]
 ds_read_b128 a[184:187], v3 offset:14336
 v_exp_f32 v69, v69
 v_mfma_f32_16x16x32_bf16 v[236:239], a[188:191], v[28:31], v[236:239]
 ds_read_b128 a[188:191], v3 offset:15360
 v_exp_f32 v66, v66
 v_mfma_f32_16x16x32_bf16 v[44:47], a[192:195], v[28:31], v[44:47]
 v_mfma_f32_16x16x32_bf16 v[72:75], a[128:131], a[48:51], v[104:107]
 s_waitcnt vmcnt(4)
 s_barrier
 ds_read_b128 a[128:131], v2 offset:0
 s_add_u32 s39, s39, 0x4000
 v_cvt_pk_bf16_f32 v24, v64, v65
 v_cvt_pk_bf16_f32 v25, v68, v69
 v_mfma_f32_16x16x32_bf16 v[76:79], a[132:135], a[48:51], v[108:111]
 ds_read_b128 a[132:135], v2 offset:1024
 v_exp_f32 v67, v67
 v_mfma_f32_16x16x32_bf16 v[72:75], a[136:139], a[52:55], v[72:75]
 ds_read_b128 a[136:139], v2 offset:2048
 v_exp_f32 v70, v70
 v_mfma_f32_16x16x32_bf16 v[76:79], a[140:143], a[52:55], v[76:79]
 ds_read_b128 a[140:143], v2 offset:3072
 v_mfma_f32_16x16x32_bf16 v[72:75], a[144:147], a[56:59], v[72:75]
 ds_read_b128 a[144:147], v2 offset:4096
 s_and_b32 s39, s39, 0x1ffff
 v_exp_f32 v71, v71
 v_mfma_f32_16x16x32_bf16 v[76:79], a[148:151], a[56:59], v[76:79]
 ds_read_b128 a[148:151], v2 offset:5120
 v_cvt_pk_bf16_f32 v26, v66, v67
 v_cvt_pk_bf16_f32 v27, v70, v71
 v_mfma_f32_16x16x32_bf16 v[72:75], a[152:155], a[60:63], v[72:75]
 ds_read_b128 a[152:155], v2 offset:6144
 v_mfma_f32_16x16x32_bf16 v[76:79], a[156:159], a[60:63], v[76:79]
 ds_read_b128 a[156:159], v2 offset:7168
 s_waitcnt lgkmcnt(8)
 s_add_u32 s49, s49, 1
 s_cmp_lt_u32 s49, s42
 s_cselect_b64 s[68:69], -1, 0
 s_cmp_le_u32 s49, s42
 s_cselect_b64 s[70:71], -1, 0
 s_cmp_eq_u32 s49, s42
 s_cselect_b64 s[60:61], s[52:53], s[68:69]
 s_cselect_b64 s[62:63], s[54:55], s[68:69]
 s_cselect_b64 s[64:65], s[56:57], s[68:69]
 s_cselect_b64 s[66:67], s[58:59], s[68:69]
 v_mfma_f32_16x16x32_bf16 v[176:179], a[160:163], v[24:27], v[176:179]
 s_lshl_b32 s37, s35, 19
 s_add_u32 m0, s38, s50
 v_mov_b32 v3, v2
 v_add_u32 v2, s39, v1
 v_cndmask_b32 v96, v4, v14, s[60:61]
 v_cndmask_b32 v97, v4, v14, s[62:63]
 v_mfma_f32_16x16x32_bf16 v[180:183], a[164:167], v[24:27], v[180:183]
 s_add_u32 s37, s37, s45
 buffer_load_dwordx4 v1, s[20:23], s37 offen offset:0 sc1 lds
 v_cndmask_b32 v98, v4, v14, s[64:65]
 v_cndmask_b32 v99, v4, v14, s[66:67]
 v_mfma_f32_16x16x32_bf16 v[184:187], a[168:171], v[24:27], v[184:187]
 buffer_load_dwordx4 v1, s[20:23], s37 offen offset:1024 sc1 lds
 v_exp_f32 v72, v72
 v_mfma_f32_16x16x32_bf16 v[188:191], a[172:175], v[24:27], v[188:191]
 buffer_load_dwordx4 v1, s[20:23], s37 offen offset:2048 sc1 lds
 buffer_load_dwordx4 v1, s[20:23], s37 offen offset:3072 sc1 lds
 v_exp_f32 v73, v73
 v_mfma_f32_16x16x32_bf16 v[192:195], a[176:179], v[24:27], v[192:195]
 s_add_u32 s38, s38, 0x4000
 v_exp_f32 v76, v76
 v_mfma_f32_16x16x32_bf16 v[196:199], a[180:183], v[24:27], v[196:199]
 s_and_b32 s38, s38, 0x1ffff
 s_add_u32 s35, s35, 1
 v_exp_f32 v77, v77
 v_mfma_f32_16x16x32_bf16 v[200:203], a[184:187], v[24:27], v[200:203]
 s_cmp_eq_u32 s35, s36
 v_exp_f32 v74, v74
 v_mfma_f32_16x16x32_bf16 v[204:207], a[188:191], v[24:27], v[204:207]
 s_cselect_b32 s36, s47, s36
 s_cselect_b32 s35, 0, s35
 v_cndmask_b32 v100, v4, v14, s[68:69]
 v_cndmask_b32 v101, v4, v14, s[68:69]
 v_mfma_f32_16x16x32_bf16 v[40:43], a[192:195], v[24:27], v[40:43]
 s_cmp_lt_u32 s49, s40
 v_cndmask_b32 v102, v4, v14, s[68:69]
 v_cndmask_b32 v103, v4, v14, s[68:69]
 s_cbranch_scc1 Lam1_15
 v_cvt_pk_bf16_f32 v28, v72, v73
 v_cvt_pk_bf16_f32 v29, v76, v77
 v_exp_f32 v75, v75
 v_exp_f32 v78, v78
 v_exp_f32 v79, v79
 v_cvt_pk_bf16_f32 v30, v74, v75
 v_cvt_pk_bf16_f32 v31, v78, v79
 s_nop 1
 v_mfma_f32_16x16x32_bf16 v[44:47], a[192:195], v[28:31], v[44:47]
 v_mfma_f32_16x16x32_bf16 v[208:211], a[160:163], v[28:31], v[208:211]
 v_mfma_f32_16x16x32_bf16 v[212:215], a[164:167], v[28:31], v[212:215]
 v_mfma_f32_16x16x32_bf16 v[216:219], a[168:171], v[28:31], v[216:219]
 v_mfma_f32_16x16x32_bf16 v[220:223], a[172:175], v[28:31], v[220:223]
 v_mfma_f32_16x16x32_bf16 v[224:227], a[176:179], v[28:31], v[224:227]
 v_mfma_f32_16x16x32_bf16 v[228:231], a[180:183], v[28:31], v[228:231]
 v_mfma_f32_16x16x32_bf16 v[232:235], a[184:187], v[28:31], v[232:235]
 v_mfma_f32_16x16x32_bf16 v[236:239], a[188:191], v[28:31], v[236:239]
 v_cmp_ngt_f32 s[60:61], s73, v32
 v_cmp_nlt_f32 vcc, s74, v32
 s_or_b64 s[60:61], s[60:61], vcc
 v_cmp_ngt_f32 s[62:63], s73, v36
 v_cmp_nlt_f32 vcc, s74, v36
 s_or_b64 s[62:63], s[62:63], vcc
 v_cmp_ngt_f32 s[64:65], s73, v40
 v_cmp_nlt_f32 vcc, s74, v40
 s_or_b64 s[64:65], s[64:65], vcc
 v_cmp_ngt_f32 s[66:67], s73, v44
 v_cmp_nlt_f32 vcc, s74, v44
 s_or_b64 s[66:67], s[66:67], vcc
 s_or_b64 s[60:61], s[60:61], s[62:63]
 s_or_b64 s[64:65], s[64:65], s[66:67]
 s_or_b64 s[60:61], s[60:61], s[64:65]
 s_cbranch_scc1 Laslow_10
Laback_11:
 v_rcp_f32 v32, v32
 v_rcp_f32 v36, v36
 v_rcp_f32 v40, v40
 v_rcp_f32 v44, v44
 s_lshl_b32 s40, s41, 5
 s_add_u32 s40, s40, s32
 s_lshl_b32 s40, s40, 13
 s_add_u32 s40, s40, 0x6000000
 s_add_u32 s44, s40, 4096
 v_pk_mul_f32 v[112:113], v[112:113], v[32:33] op_sel_hi:[1,0]
 v_pk_mul_f32 v[114:115], v[114:115], v[32:33] op_sel_hi:[1,0]
 v_pk_mul_f32 v[116:117], v[116:117], v[32:33] op_sel_hi:[1,0]
 v_pk_mul_f32 v[118:119], v[118:119], v[32:33] op_sel_hi:[1,0]
 v_cvt_pk_bf16_f32 v240, v112, v113
 v_cvt_pk_bf16_f32 v241, v116, v117
 v_cvt_pk_bf16_f32 v242, v114, v115
 v_cvt_pk_bf16_f32 v243, v118, v119
 buffer_store_dwordx4 v[240:243], v1, s[20:23], s40 offen offset:0 sc1
 v_pk_mul_f32 v[120:121], v[120:121], v[32:33] op_sel_hi:[1,0]
 v_pk_mul_f32 v[122:123], v[122:123], v[32:33] op_sel_hi:[1,0]
 v_pk_mul_f32 v[124:125], v[124:125], v[32:33] op_sel_hi:[1,0]
 v_pk_mul_f32 v[126:127], v[126:127], v[32:33] op_sel_hi:[1,0]
 v_cvt_pk_bf16_f32 v244, v120, v121
 v_cvt_pk_bf16_f32 v245, v124, v125
 v_cvt_pk_bf16_f32 v246, v122, v123
 v_cvt_pk_bf16_f32 v247, v126, v127
 buffer_store_dwordx4 v[244:247], v1, s[20:23], s40 offen offset:2048 sc1
 v_pk_mul_f32 v[128:129], v[128:129], v[32:33] op_sel_hi:[1,0]
 v_pk_mul_f32 v[130:131], v[130:131], v[32:33] op_sel_hi:[1,0]
 v_pk_mul_f32 v[132:133], v[132:133], v[32:33] op_sel_hi:[1,0]
 v_pk_mul_f32 v[134:135], v[134:135], v[32:33] op_sel_hi:[1,0]
 v_cvt_pk_bf16_f32 v248, v128, v129
 v_cvt_pk_bf16_f32 v249, v132, v133
 v_cvt_pk_bf16_f32 v250, v130, v131
 v_cvt_pk_bf16_f32 v251, v134, v135
 buffer_store_dwordx4 v[248:251], v1, s[20:23], s44 offen offset:0 sc1
 v_pk_mul_f32 v[136:137], v[136:137], v[32:33] op_sel_hi:[1,0]
 v_pk_mul_f32 v[138:139], v[138:139], v[32:33] op_sel_hi:[1,0]
 v_pk_mul_f32 v[140:141], v[140:141], v[32:33] op_sel_hi:[1,0]
 v_pk_mul_f32 v[142:143], v[142:143], v[32:33] op_sel_hi:[1,0]
 v_cvt_pk_bf16_f32 v252, v136, v137
 v_cvt_pk_bf16_f32 v253, v140, v141
 v_cvt_pk_bf16_f32 v254, v138, v139
 v_cvt_pk_bf16_f32 v255, v142, v143
 buffer_store_dwordx4 v[252:255], v1, s[20:23], s44 offen offset:2048 sc1
 v_pk_mul_f32 v[144:145], v[144:145], v[36:37] op_sel_hi:[1,0]
 v_pk_mul_f32 v[146:147], v[146:147], v[36:37] op_sel_hi:[1,0]
 v_pk_mul_f32 v[148:149], v[148:149], v[36:37] op_sel_hi:[1,0]
 v_pk_mul_f32 v[150:151], v[150:151], v[36:37] op_sel_hi:[1,0]
 v_cvt_pk_bf16_f32 v240, v144, v145
 v_cvt_pk_bf16_f32 v241, v148, v149
 v_cvt_pk_bf16_f32 v242, v146, v147
 v_cvt_pk_bf16_f32 v243, v150, v151
 buffer_store_dwordx4 v[240:243], v1, s[20:23], s40 offen offset:1024 sc1
 v_pk_mul_f32 v[152:153], v[152:153], v[36:37] op_sel_hi:[1,0]
 v_pk_mul_f32 v[154:155], v[154:155], v[36:37] op_sel_hi:[1,0]
 v_pk_mul_f32 v[156:157], v[156:157], v[36:37] op_sel_hi:[1,0]
 v_pk_mul_f32 v[158:159], v[158:159], v[36:37] op_sel_hi:[1,0]
 v_cvt_pk_bf16_f32 v244, v152, v153
 v_cvt_pk_bf16_f32 v245, v156, v157
 v_cvt_pk_bf16_f32 v246, v154, v155
 v_cvt_pk_bf16_f32 v247, v158, v159
 buffer_store_dwordx4 v[244:247], v1, s[20:23], s40 offen offset:3072 sc1
 v_pk_mul_f32 v[160:161], v[160:161], v[36:37] op_sel_hi:[1,0]
 v_pk_mul_f32 v[162:163], v[162:163], v[36:37] op_sel_hi:[1,0]
 v_pk_mul_f32 v[164:165], v[164:165], v[36:37] op_sel_hi:[1,0]
 v_pk_mul_f32 v[166:167], v[166:167], v[36:37] op_sel_hi:[1,0]
 v_cvt_pk_bf16_f32 v248, v160, v161
 v_cvt_pk_bf16_f32 v249, v164, v165
 v_cvt_pk_bf16_f32 v250, v162, v163
 v_cvt_pk_bf16_f32 v251, v166, v167
 buffer_store_dwordx4 v[248:251], v1, s[20:23], s44 offen offset:1024 sc1
 v_pk_mul_f32 v[168:169], v[168:169], v[36:37] op_sel_hi:[1,0]
 v_pk_mul_f32 v[170:171], v[170:171], v[36:37] op_sel_hi:[1,0]
 v_pk_mul_f32 v[172:173], v[172:173], v[36:37] op_sel_hi:[1,0]
 v_pk_mul_f32 v[174:175], v[174:175], v[36:37] op_sel_hi:[1,0]
 v_cvt_pk_bf16_f32 v252, v168, v169
 v_cvt_pk_bf16_f32 v253, v172, v173
 v_cvt_pk_bf16_f32 v254, v170, v171
 v_cvt_pk_bf16_f32 v255, v174, v175
 buffer_store_dwordx4 v[252:255], v1, s[20:23], s44 offen offset:3072 sc1
 s_lshl_b32 s40, s42, 5
 s_add_u32 s40, s40, s32
 s_lshl_b32 s40, s40, 13
 s_add_u32 s40, s40, 0x6000000
 s_add_u32 s44, s40, 4096
 v_pk_mul_f32 v[176:177], v[176:177], v[40:41] op_sel_hi:[1,0]
 v_pk_mul_f32 v[178:179], v[178:179], v[40:41] op_sel_hi:[1,0]
 v_pk_mul_f32 v[180:181], v[180:181], v[40:41] op_sel_hi:[1,0]
 v_pk_mul_f32 v[182:183], v[182:183], v[40:41] op_sel_hi:[1,0]
 v_cvt_pk_bf16_f32 v240, v176, v177
 v_cvt_pk_bf16_f32 v241, v180, v181
 v_cvt_pk_bf16_f32 v242, v178, v179
 v_cvt_pk_bf16_f32 v243, v182, v183
 buffer_store_dwordx4 v[240:243], v1, s[20:23], s40 offen offset:0 sc1
 v_pk_mul_f32 v[184:185], v[184:185], v[40:41] op_sel_hi:[1,0]
 v_pk_mul_f32 v[186:187], v[186:187], v[40:41] op_sel_hi:[1,0]
 v_pk_mul_f32 v[188:189], v[188:189], v[40:41] op_sel_hi:[1,0]
 v_pk_mul_f32 v[190:191], v[190:191], v[40:41] op_sel_hi:[1,0]
 v_cvt_pk_bf16_f32 v244, v184, v185
 v_cvt_pk_bf16_f32 v245, v188, v189
 v_cvt_pk_bf16_f32 v246, v186, v187
 v_cvt_pk_bf16_f32 v247, v190, v191
 buffer_store_dwordx4 v[244:247], v1, s[20:23], s40 offen offset:2048 sc1
 v_pk_mul_f32 v[192:193], v[192:193], v[40:41] op_sel_hi:[1,0]
 v_pk_mul_f32 v[194:195], v[194:195], v[40:41] op_sel_hi:[1,0]
 v_pk_mul_f32 v[196:197], v[196:197], v[40:41] op_sel_hi:[1,0]
 v_pk_mul_f32 v[198:199], v[198:199], v[40:41] op_sel_hi:[1,0]
 v_cvt_pk_bf16_f32 v248, v192, v193
 v_cvt_pk_bf16_f32 v249, v196, v197
 v_cvt_pk_bf16_f32 v250, v194, v195
 v_cvt_pk_bf16_f32 v251, v198, v199
 buffer_store_dwordx4 v[248:251], v1, s[20:23], s44 offen offset:0 sc1
 v_pk_mul_f32 v[200:201], v[200:201], v[40:41] op_sel_hi:[1,0]
 v_pk_mul_f32 v[202:203], v[202:203], v[40:41] op_sel_hi:[1,0]
 v_pk_mul_f32 v[204:205], v[204:205], v[40:41] op_sel_hi:[1,0]
 v_pk_mul_f32 v[206:207], v[206:207], v[40:41] op_sel_hi:[1,0]
 v_cvt_pk_bf16_f32 v252, v200, v201
 v_cvt_pk_bf16_f32 v253, v204, v205
 v_cvt_pk_bf16_f32 v254, v202, v203
 v_cvt_pk_bf16_f32 v255, v206, v207
 buffer_store_dwordx4 v[252:255], v1, s[20:23], s44 offen offset:2048 sc1
 v_pk_mul_f32 v[208:209], v[208:209], v[44:45] op_sel_hi:[1,0]
 v_pk_mul_f32 v[210:211], v[210:211], v[44:45] op_sel_hi:[1,0]
 v_pk_mul_f32 v[212:213], v[212:213], v[44:45] op_sel_hi:[1,0]
 v_pk_mul_f32 v[214:215], v[214:215], v[44:45] op_sel_hi:[1,0]
 v_cvt_pk_bf16_f32 v240, v208, v209
 v_cvt_pk_bf16_f32 v241, v212, v213
 v_cvt_pk_bf16_f32 v242, v210, v211
 v_cvt_pk_bf16_f32 v243, v214, v215
 buffer_store_dwordx4 v[240:243], v1, s[20:23], s40 offen offset:1024 sc1
 v_pk_mul_f32 v[216:217], v[216:217], v[44:45] op_sel_hi:[1,0]
 v_pk_mul_f32 v[218:219], v[218:219], v[44:45] op_sel_hi:[1,0]
 v_pk_mul_f32 v[220:221], v[220:221], v[44:45] op_sel_hi:[1,0]
 v_pk_mul_f32 v[222:223], v[222:223], v[44:45] op_sel_hi:[1,0]
 v_cvt_pk_bf16_f32 v244, v216, v217
 v_cvt_pk_bf16_f32 v245, v220, v221
 v_cvt_pk_bf16_f32 v246, v218, v219
 v_cvt_pk_bf16_f32 v247, v222, v223
 buffer_store_dwordx4 v[244:247], v1, s[20:23], s40 offen offset:3072 sc1
 v_pk_mul_f32 v[224:225], v[224:225], v[44:45] op_sel_hi:[1,0]
 v_pk_mul_f32 v[226:227], v[226:227], v[44:45] op_sel_hi:[1,0]
 v_pk_mul_f32 v[228:229], v[228:229], v[44:45] op_sel_hi:[1,0]
 v_pk_mul_f32 v[230:231], v[230:231], v[44:45] op_sel_hi:[1,0]
 v_cvt_pk_bf16_f32 v248, v224, v225
 v_cvt_pk_bf16_f32 v249, v228, v229
 v_cvt_pk_bf16_f32 v250, v226, v227
 v_cvt_pk_bf16_f32 v251, v230, v231
 buffer_store_dwordx4 v[248:251], v1, s[20:23], s44 offen offset:1024 sc1
 v_pk_mul_f32 v[232:233], v[232:233], v[44:45] op_sel_hi:[1,0]
 v_pk_mul_f32 v[234:235], v[234:235], v[44:45] op_sel_hi:[1,0]
 v_pk_mul_f32 v[236:237], v[236:237], v[44:45] op_sel_hi:[1,0]
 v_pk_mul_f32 v[238:239], v[238:239], v[44:45] op_sel_hi:[1,0]
 v_cvt_pk_bf16_f32 v252, v232, v233
 v_cvt_pk_bf16_f32 v253, v236, v237
 v_cvt_pk_bf16_f32 v254, v234, v235
 v_cvt_pk_bf16_f32 v255, v238, v239
 buffer_store_dwordx4 v[252:255], v1, s[20:23], s44 offen offset:3072 sc1
 s_lshl_b32 s72, s33, 5
 s_add_u32 s72, s72, s32
 s_lshl_b32 s72, s72, 2
 s_add_u32 s72, s72, 0x4000
 s_cmp_eq_u32 s46, 1
 s_cbranch_scc1 Ladone_12
 s_mov_b32 s46, 1
 s_mov_b32 s33, s34
 s_waitcnt vmcnt(16)
 v_accvgpr_mov_b32 a0, a64
 v_accvgpr_mov_b32 a1, a65
 v_accvgpr_mov_b32 a2, a66
 v_accvgpr_mov_b32 a3, a67
 v_accvgpr_mov_b32 a4, a68
 v_accvgpr_mov_b32 a5, a69
 v_accvgpr_mov_b32 a6, a70
 v_accvgpr_mov_b32 a7, a71
 v_accvgpr_mov_b32 a8, a72
 v_accvgpr_mov_b32 a9, a73
 v_accvgpr_mov_b32 a10, a74
 v_accvgpr_mov_b32 a11, a75
 v_accvgpr_mov_b32 a12, a76
 v_accvgpr_mov_b32 a13, a77
 v_accvgpr_mov_b32 a14, a78
 v_accvgpr_mov_b32 a15, a79
 v_accvgpr_mov_b32 a16, a80
 v_accvgpr_mov_b32 a17, a81
 v_accvgpr_mov_b32 a18, a82
 v_accvgpr_mov_b32 a19, a83
 v_accvgpr_mov_b32 a20, a84
 v_accvgpr_mov_b32 a21, a85
 v_accvgpr_mov_b32 a22, a86
 v_accvgpr_mov_b32 a23, a87
 v_accvgpr_mov_b32 a24, a88
 v_accvgpr_mov_b32 a25, a89
 v_accvgpr_mov_b32 a26, a90
 v_accvgpr_mov_b32 a27, a91
 v_accvgpr_mov_b32 a28, a92
 v_accvgpr_mov_b32 a29, a93
 v_accvgpr_mov_b32 a30, a94
 v_accvgpr_mov_b32 a31, a95
 v_accvgpr_mov_b32 a32, a96
 v_accvgpr_mov_b32 a33, a97
 v_accvgpr_mov_b32 a34, a98
 v_accvgpr_mov_b32 a35, a99
 v_accvgpr_mov_b32 a36, a100
 v_accvgpr_mov_b32 a37, a101
 v_accvgpr_mov_b32 a38, a102
 v_accvgpr_mov_b32 a39, a103
 v_accvgpr_mov_b32 a40, a104
 v_accvgpr_mov_b32 a41, a105
 v_accvgpr_mov_b32 a42, a106
 v_accvgpr_mov_b32 a43, a107
 v_accvgpr_mov_b32 a44, a108
 v_accvgpr_mov_b32 a45, a109
 v_accvgpr_mov_b32 a46, a110
 v_accvgpr_mov_b32 a47, a111
 v_accvgpr_mov_b32 a48, a112
 v_accvgpr_mov_b32 a49, a113
 v_accvgpr_mov_b32 a50, a114
 v_accvgpr_mov_b32 a51, a115
 v_accvgpr_mov_b32 a52, a116
 v_accvgpr_mov_b32 a53, a117
 v_accvgpr_mov_b32 a54, a118
 v_accvgpr_mov_b32 a55, a119
 v_accvgpr_mov_b32 a56, a120
 v_accvgpr_mov_b32 a57, a121
 v_accvgpr_mov_b32 a58, a122
 v_accvgpr_mov_b32 a59, a123
 v_accvgpr_mov_b32 a60, a124
 v_accvgpr_mov_b32 a61, a125
 v_accvgpr_mov_b32 a62, a126
 v_accvgpr_mov_b32 a63, a127
 s_branch Lablk_9
Laslow_10:
 s_waitcnt vmcnt(0) lgkmcnt(0)
 v_mov_b32 v12, 0
 v_mov_b32 v240, v4
 v_mov_b32 v13, 0
 v_mov_b32 v241, v4
 v_mov_b32 v14, 0
 v_mov_b32 v242, v4
 v_mov_b32 v15, 0
 v_mov_b32 v243, v4
 s_mov_b32 s49, 0
Lsl_21:
 s_lshl_b32 s37, s49, 19
 s_add_u32 s37, s37, s45
 s_sub_u32 s37, s37, s50
 s_add_u32 s44, s37, 0
 buffer_load_dwordx4 a[128:131], v1, s[20:23], s44 offen offset:0 sc1
 buffer_load_dwordx4 a[132:135], v1, s[20:23], s44 offen offset:1024 sc1
 buffer_load_dwordx4 a[136:139], v1, s[20:23], s44 offen offset:2048 sc1
 buffer_load_dwordx4 a[140:143], v1, s[20:23], s44 offen offset:3072 sc1
 s_add_u32 s44, s37, 4096
 buffer_load_dwordx4 a[144:147], v1, s[20:23], s44 offen offset:0 sc1
 buffer_load_dwordx4 a[148:151], v1, s[20:23], s44 offen offset:1024 sc1
 buffer_load_dwordx4 a[152:155], v1, s[20:23], s44 offen offset:2048 sc1
 buffer_load_dwordx4 a[156:159], v1, s[20:23], s44 offen offset:3072 sc1
 s_cmp_lt_u32 s49, s41
 s_cselect_b64 s[68:69], -1, 0
 s_cmp_le_u32 s49, s41
 s_cselect_b64 s[70:71], -1, 0
 s_cmp_eq_u32 s49, s41
 s_cselect_b64 s[60:61], s[52:53], s[68:69]
 s_cselect_b64 s[62:63], s[54:55], s[68:69]
 s_cselect_b64 s[64:65], s[56:57], s[68:69]
 s_cselect_b64 s[66:67], s[58:59], s[68:69]
 v_cndmask_b32 v80, v4, v12, s[60:61]
 v_cndmask_b32 v81, v4, v12, s[62:63]
 v_cndmask_b32 v82, v4, v12, s[64:65]
 v_cndmask_b32 v83, v4, v12, s[66:67]
 v_cndmask_b32 v84, v4, v12, s[68:69]
 v_cndmask_b32 v85, v4, v12, s[68:69]
 v_cndmask_b32 v86, v4, v12, s[68:69]
 v_cndmask_b32 v87, v4, v12, s[68:69]
 v_cndmask_b32 v88, v4, v13, s[70:71]
 v_cndmask_b32 v89, v4, v13, s[70:71]
 v_cndmask_b32 v90, v4, v13, s[70:71]
 v_cndmask_b32 v91, v4, v13, s[70:71]
 v_cndmask_b32 v92, v4, v13, s[60:61]
 v_cndmask_b32 v93, v4, v13, s[62:63]
 v_cndmask_b32 v94, v4, v13, s[64:65]
 v_cndmask_b32 v95, v4, v13, s[66:67]
 s_cmp_lt_u32 s49, s42
 s_cselect_b64 s[68:69], -1, 0
 s_cmp_le_u32 s49, s42
 s_cselect_b64 s[70:71], -1, 0
 s_cmp_eq_u32 s49, s42
 s_cselect_b64 s[60:61], s[52:53], s[68:69]
 s_cselect_b64 s[62:63], s[54:55], s[68:69]
 s_cselect_b64 s[64:65], s[56:57], s[68:69]
 s_cselect_b64 s[66:67], s[58:59], s[68:69]
 v_cndmask_b32 v96, v4, v14, s[60:61]
 v_cndmask_b32 v97, v4, v14, s[62:63]
 v_cndmask_b32 v98, v4, v14, s[64:65]
 v_cndmask_b32 v99, v4, v14, s[66:67]
 v_cndmask_b32 v100, v4, v14, s[68:69]
 v_cndmask_b32 v101, v4, v14, s[68:69]
 v_cndmask_b32 v102, v4, v14, s[68:69]
 v_cndmask_b32 v103, v4, v14, s[68:69]
 v_cndmask_b32 v104, v4, v15, s[70:71]
 v_cndmask_b32 v105, v4, v15, s[70:71]
 v_cndmask_b32 v106, v4, v15, s[70:71]
 v_cndmask_b32 v107, v4, v15, s[70:71]
 v_cndmask_b32 v108, v4, v15, s[60:61]
 v_cndmask_b32 v109, v4, v15, s[62:63]
 v_cndmask_b32 v110, v4, v15, s[64:65]
 v_cndmask_b32 v111, v4, v15, s[66:67]
 s_waitcnt vmcnt(0)
 s_nop 0
 v_mfma_f32_16x16x32_bf16 v[48:51], a[128:131], a[0:3], v[80:83]
 v_mfma_f32_16x16x32_bf16 v[56:59], a[128:131], a[16:19], v[88:91]
 v_mfma_f32_16x16x32_bf16 v[64:67], a[128:131], a[32:35], v[96:99]
 v_mfma_f32_16x16x32_bf16 v[72:75], a[128:131], a[48:51], v[104:107]
 v_mfma_f32_16x16x32_bf16 v[52:55], a[132:135], a[0:3], v[84:87]
 v_mfma_f32_16x16x32_bf16 v[60:63], a[132:135], a[16:19], v[92:95]
 v_mfma_f32_16x16x32_bf16 v[68:71], a[132:135], a[32:35], v[100:103]
 v_mfma_f32_16x16x32_bf16 v[76:79], a[132:135], a[48:51], v[108:111]
 v_mfma_f32_16x16x32_bf16 v[48:51], a[136:139], a[4:7], v[48:51]
 v_mfma_f32_16x16x32_bf16 v[56:59], a[136:139], a[20:23], v[56:59]
 v_mfma_f32_16x16x32_bf16 v[64:67], a[136:139], a[36:39], v[64:67]
 v_mfma_f32_16x16x32_bf16 v[72:75], a[136:139], a[52:55], v[72:75]
 v_mfma_f32_16x16x32_bf16 v[52:55], a[140:143], a[4:7], v[52:55]
 v_mfma_f32_16x16x32_bf16 v[60:63], a[140:143], a[20:23], v[60:63]
 v_mfma_f32_16x16x32_bf16 v[68:71], a[140:143], a[36:39], v[68:71]
 v_mfma_f32_16x16x32_bf16 v[76:79], a[140:143], a[52:55], v[76:79]
 v_mfma_f32_16x16x32_bf16 v[48:51], a[144:147], a[8:11], v[48:51]
 v_mfma_f32_16x16x32_bf16 v[56:59], a[144:147], a[24:27], v[56:59]
 v_mfma_f32_16x16x32_bf16 v[64:67], a[144:147], a[40:43], v[64:67]
 v_mfma_f32_16x16x32_bf16 v[72:75], a[144:147], a[56:59], v[72:75]
 v_mfma_f32_16x16x32_bf16 v[52:55], a[148:151], a[8:11], v[52:55]
 v_mfma_f32_16x16x32_bf16 v[60:63], a[148:151], a[24:27], v[60:63]
 v_mfma_f32_16x16x32_bf16 v[68:71], a[148:151], a[40:43], v[68:71]
 v_mfma_f32_16x16x32_bf16 v[76:79], a[148:151], a[56:59], v[76:79]
 v_mfma_f32_16x16x32_bf16 v[48:51], a[152:155], a[12:15], v[48:51]
 v_mfma_f32_16x16x32_bf16 v[56:59], a[152:155], a[28:31], v[56:59]
 v_mfma_f32_16x16x32_bf16 v[64:67], a[152:155], a[44:47], v[64:67]
 v_mfma_f32_16x16x32_bf16 v[72:75], a[152:155], a[60:63], v[72:75]
 v_mfma_f32_16x16x32_bf16 v[52:55], a[156:159], a[12:15], v[52:55]
 v_mfma_f32_16x16x32_bf16 v[60:63], a[156:159], a[28:31], v[60:63]
 v_mfma_f32_16x16x32_bf16 v[68:71], a[156:159], a[44:47], v[68:71]
 v_mfma_f32_16x16x32_bf16 v[76:79], a[156:159], a[60:63], v[76:79]
 s_nop 7
 v_max3_f32 v240, v240, v48, v49
 v_max3_f32 v240, v240, v50, v51
 v_max3_f32 v240, v240, v52, v53
 v_max3_f32 v240, v240, v54, v55
 v_max3_f32 v241, v241, v56, v57
 v_max3_f32 v241, v241, v58, v59
 v_max3_f32 v241, v241, v60, v61
 v_max3_f32 v241, v241, v62, v63
 v_max3_f32 v242, v242, v64, v65
 v_max3_f32 v242, v242, v66, v67
 v_max3_f32 v242, v242, v68, v69
 v_max3_f32 v242, v242, v70, v71
 v_max3_f32 v243, v243, v72, v73
 v_max3_f32 v243, v243, v74, v75
 v_max3_f32 v243, v243, v76, v77
 v_max3_f32 v243, v243, v78, v79
 s_add_u32 s49, s49, 1
 s_cmp_le_u32 s49, s42
 s_cbranch_scc1 Lsl_21
 v_mov_b32 v244, v240
 v_mov_b32 v245, v241
 v_mov_b32 v246, v242
 v_mov_b32 v247, v243
 v_permlane16_swap_b32 v240, v244
 v_permlane16_swap_b32 v241, v245
 v_permlane16_swap_b32 v242, v246
 v_permlane16_swap_b32 v243, v247
 v_max_f32 v240, v240, v244
 v_max_f32 v241, v241, v245
 v_max_f32 v242, v242, v246
 v_max_f32 v243, v243, v247
 v_mov_b32 v244, v240
 v_mov_b32 v245, v241
 v_mov_b32 v246, v242
 v_mov_b32 v247, v243
 v_permlane32_swap_b32 v240, v244
 v_permlane32_swap_b32 v241, v245
 v_permlane32_swap_b32 v242, v246
 v_permlane32_swap_b32 v243, v247
 v_max_f32 v240, v240, v244
 v_max_f32 v241, v241, v245
 v_max_f32 v242, v242, v246
 v_max_f32 v243, v243, v247
 v_sub_f32 v12, 0, v240
 v_sub_f32 v13, 0, v241
 v_sub_f32 v14, 0, v242
 v_sub_f32 v15, 0, v243
 v_mov_b64 v[112:113], 0
 v_mov_b64 v[114:115], 0
 v_mov_b64 v[116:117], 0
 v_mov_b64 v[118:119], 0
 v_mov_b64 v[120:121], 0
 v_mov_b64 v[122:123], 0
 v_mov_b64 v[124:125], 0
 v_mov_b64 v[126:127], 0
 v_mov_b64 v[128:129], 0
 v_mov_b64 v[130:131], 0
 v_mov_b64 v[132:133], 0
 v_mov_b64 v[134:135], 0
 v_mov_b64 v[136:137], 0
 v_mov_b64 v[138:139], 0
 v_mov_b64 v[140:141], 0
 v_mov_b64 v[142:143], 0
 v_mov_b64 v[144:145], 0
 v_mov_b64 v[146:147], 0
 v_mov_b64 v[148:149], 0
 v_mov_b64 v[150:151], 0
 v_mov_b64 v[152:153], 0
 v_mov_b64 v[154:155], 0
 v_mov_b64 v[156:157], 0
 v_mov_b64 v[158:159], 0
 v_mov_b64 v[160:161], 0
 v_mov_b64 v[162:163], 0
 v_mov_b64 v[164:165], 0
 v_mov_b64 v[166:167], 0
 v_mov_b64 v[168:169], 0
 v_mov_b64 v[170:171], 0
 v_mov_b64 v[172:173], 0
 v_mov_b64 v[174:175], 0
 v_mov_b64 v[176:177], 0
 v_mov_b64 v[178:179], 0
 v_mov_b64 v[180:181], 0
 v_mov_b64 v[182:183], 0
 v_mov_b64 v[184:185], 0
 v_mov_b64 v[186:187], 0
 v_mov_b64 v[188:189], 0
 v_mov_b64 v[190:191], 0
 v_mov_b64 v[192:193], 0
 v_mov_b64 v[194:195], 0
 v_mov_b64 v[196:197], 0
 v_mov_b64 v[198:199], 0
 v_mov_b64 v[200:201], 0
 v_mov_b64 v[202:203], 0
 v_mov_b64 v[204:205], 0
 v_mov_b64 v[206:207], 0
 v_mov_b64 v[208:209], 0
 v_mov_b64 v[210:211], 0
 v_mov_b64 v[212:213], 0
 v_mov_b64 v[214:215], 0
 v_mov_b64 v[216:217], 0
 v_mov_b64 v[218:219], 0
 v_mov_b64 v[220:221], 0
 v_mov_b64 v[222:223], 0
 v_mov_b64 v[224:225], 0
 v_mov_b64 v[226:227], 0
 v_mov_b64 v[228:229], 0
 v_mov_b64 v[230:231], 0
 v_mov_b64 v[232:233], 0
 v_mov_b64 v[234:235], 0
 v_mov_b64 v[236:237], 0
 v_mov_b64 v[238:239], 0
 v_mov_b64 v[32:33], 0
 v_mov_b64 v[34:35], 0
 v_mov_b64 v[36:37], 0
 v_mov_b64 v[38:39], 0
 v_mov_b64 v[40:41], 0
 v_mov_b64 v[42:43], 0
 v_mov_b64 v[44:45], 0
 v_mov_b64 v[46:47], 0
 s_mov_b32 s49, 0
Lsl_22:
 s_lshl_b32 s37, s49, 19
 s_add_u32 s37, s37, s45
 s_sub_u32 s37, s37, s50
 s_add_u32 s44, s37, 0
 buffer_load_dwordx4 a[128:131], v1, s[20:23], s44 offen offset:0 sc1
 buffer_load_dwordx4 a[132:135], v1, s[20:23], s44 offen offset:1024 sc1
 buffer_load_dwordx4 a[136:139], v1, s[20:23], s44 offen offset:2048 sc1
 buffer_load_dwordx4 a[140:143], v1, s[20:23], s44 offen offset:3072 sc1
 s_add_u32 s44, s37, 4096
 buffer_load_dwordx4 a[144:147], v1, s[20:23], s44 offen offset:0 sc1
 buffer_load_dwordx4 a[148:151], v1, s[20:23], s44 offen offset:1024 sc1
 buffer_load_dwordx4 a[152:155], v1, s[20:23], s44 offen offset:2048 sc1
 buffer_load_dwordx4 a[156:159], v1, s[20:23], s44 offen offset:3072 sc1
 s_add_u32 s44, s37, 8192
 buffer_load_dwordx4 a[160:163], v1, s[20:23], s44 offen offset:0 sc1
 buffer_load_dwordx4 a[164:167], v1, s[20:23], s44 offen offset:1024 sc1
 buffer_load_dwordx4 a[168:171], v1, s[20:23], s44 offen offset:2048 sc1
 buffer_load_dwordx4 a[172:175], v1, s[20:23], s44 offen offset:3072 sc1
 s_add_u32 s44, s37, 12288
 buffer_load_dwordx4 a[176:179], v1, s[20:23], s44 offen offset:0 sc1
 buffer_load_dwordx4 a[180:183], v1, s[20:23], s44 offen offset:1024 sc1
 buffer_load_dwordx4 a[184:187], v1, s[20:23], s44 offen offset:2048 sc1
 buffer_load_dwordx4 a[188:191], v1, s[20:23], s44 offen offset:3072 sc1
 s_cmp_lt_u32 s49, s41
 s_cselect_b64 s[68:69], -1, 0
 s_cmp_le_u32 s49, s41
 s_cselect_b64 s[70:71], -1, 0
 s_cmp_eq_u32 s49, s41
 s_cselect_b64 s[60:61], s[52:53], s[68:69]
 s_cselect_b64 s[62:63], s[54:55], s[68:69]
 s_cselect_b64 s[64:65], s[56:57], s[68:69]
 s_cselect_b64 s[66:67], s[58:59], s[68:69]
 v_cndmask_b32 v80, v4, v12, s[60:61]
 v_cndmask_b32 v81, v4, v12, s[62:63]
 v_cndmask_b32 v82, v4, v12, s[64:65]
 v_cndmask_b32 v83, v4, v12, s[66:67]
 v_cndmask_b32 v84, v4, v12, s[68:69]
 v_cndmask_b32 v85, v4, v12, s[68:69]
 v_cndmask_b32 v86, v4, v12, s[68:69]
 v_cndmask_b32 v87, v4, v12, s[68:69]
 v_cndmask_b32 v88, v4, v13, s[70:71]
 v_cndmask_b32 v89, v4, v13, s[70:71]
 v_cndmask_b32 v90, v4, v13, s[70:71]
 v_cndmask_b32 v91, v4, v13, s[70:71]
 v_cndmask_b32 v92, v4, v13, s[60:61]
 v_cndmask_b32 v93, v4, v13, s[62:63]
 v_cndmask_b32 v94, v4, v13, s[64:65]
 v_cndmask_b32 v95, v4, v13, s[66:67]
 s_cmp_lt_u32 s49, s42
 s_cselect_b64 s[68:69], -1, 0
 s_cmp_le_u32 s49, s42
 s_cselect_b64 s[70:71], -1, 0
 s_cmp_eq_u32 s49, s42
 s_cselect_b64 s[60:61], s[52:53], s[68:69]
 s_cselect_b64 s[62:63], s[54:55], s[68:69]
 s_cselect_b64 s[64:65], s[56:57], s[68:69]
 s_cselect_b64 s[66:67], s[58:59], s[68:69]
 v_cndmask_b32 v96, v4, v14, s[60:61]
 v_cndmask_b32 v97, v4, v14, s[62:63]
 v_cndmask_b32 v98, v4, v14, s[64:65]
 v_cndmask_b32 v99, v4, v14, s[66:67]
 v_cndmask_b32 v100, v4, v14, s[68:69]
 v_cndmask_b32 v101, v4, v14, s[68:69]
 v_cndmask_b32 v102, v4, v14, s[68:69]
 v_cndmask_b32 v103, v4, v14, s[68:69]
 v_cndmask_b32 v104, v4, v15, s[70:71]
 v_cndmask_b32 v105, v4, v15, s[70:71]
 v_cndmask_b32 v106, v4, v15, s[70:71]
 v_cndmask_b32 v107, v4, v15, s[70:71]
 v_cndmask_b32 v108, v4, v15, s[60:61]
 v_cndmask_b32 v109, v4, v15, s[62:63]
 v_cndmask_b32 v110, v4, v15, s[64:65]
 v_cndmask_b32 v111, v4, v15, s[66:67]
 s_waitcnt vmcnt(0)
 s_nop 0
 v_mfma_f32_16x16x32_bf16 v[48:51], a[128:131], a[0:3], v[80:83]
 v_mfma_f32_16x16x32_bf16 v[56:59], a[128:131], a[16:19], v[88:91]
 v_mfma_f32_16x16x32_bf16 v[64:67], a[128:131], a[32:35], v[96:99]
 v_mfma_f32_16x16x32_bf16 v[72:75], a[128:131], a[48:51], v[104:107]
 v_mfma_f32_16x16x32_bf16 v[52:55], a[132:135], a[0:3], v[84:87]
 v_mfma_f32_16x16x32_bf16 v[60:63], a[132:135], a[16:19], v[92:95]
 v_mfma_f32_16x16x32_bf16 v[68:71], a[132:135], a[32:35], v[100:103]
 v_mfma_f32_16x16x32_bf16 v[76:79], a[132:135], a[48:51], v[108:111]
 v_mfma_f32_16x16x32_bf16 v[48:51], a[136:139], a[4:7], v[48:51]
 v_mfma_f32_16x16x32_bf16 v[56:59], a[136:139], a[20:23], v[56:59]
 v_mfma_f32_16x16x32_bf16 v[64:67], a[136:139], a[36:39], v[64:67]
 v_mfma_f32_16x16x32_bf16 v[72:75], a[136:139], a[52:55], v[72:75]
 v_mfma_f32_16x16x32_bf16 v[52:55], a[140:143], a[4:7], v[52:55]
 v_mfma_f32_16x16x32_bf16 v[60:63], a[140:143], a[20:23], v[60:63]
 v_mfma_f32_16x16x32_bf16 v[68:71], a[140:143], a[36:39], v[68:71]
 v_mfma_f32_16x16x32_bf16 v[76:79], a[140:143], a[52:55], v[76:79]
 v_mfma_f32_16x16x32_bf16 v[48:51], a[144:147], a[8:11], v[48:51]
 v_mfma_f32_16x16x32_bf16 v[56:59], a[144:147], a[24:27], v[56:59]
 v_mfma_f32_16x16x32_bf16 v[64:67], a[144:147], a[40:43], v[64:67]
 v_mfma_f32_16x16x32_bf16 v[72:75], a[144:147], a[56:59], v[72:75]
 v_mfma_f32_16x16x32_bf16 v[52:55], a[148:151], a[8:11], v[52:55]
 v_mfma_f32_16x16x32_bf16 v[60:63], a[148:151], a[24:27], v[60:63]
 v_mfma_f32_16x16x32_bf16 v[68:71], a[148:151], a[40:43], v[68:71]
 v_mfma_f32_16x16x32_bf16 v[76:79], a[148:151], a[56:59], v[76:79]
 v_mfma_f32_16x16x32_bf16 v[48:51], a[152:155], a[12:15], v[48:51]
 v_mfma_f32_16x16x32_bf16 v[56:59], a[152:155], a[28:31], v[56:59]
 v_mfma_f32_16x16x32_bf16 v[64:67], a[152:155], a[44:47], v[64:67]
 v_mfma_f32_16x16x32_bf16 v[72:75], a[152:155], a[60:63], v[72:75]
 v_mfma_f32_16x16x32_bf16 v[52:55], a[156:159], a[12:15], v[52:55]
 v_mfma_f32_16x16x32_bf16 v[60:63], a[156:159], a[28:31], v[60:63]
 v_mfma_f32_16x16x32_bf16 v[68:71], a[156:159], a[44:47], v[68:71]
 v_mfma_f32_16x16x32_bf16 v[76:79], a[156:159], a[60:63], v[76:79]
 s_nop 7
 v_exp_f32 v48, v48
 v_exp_f32 v49, v49
 v_exp_f32 v52, v52
 v_exp_f32 v53, v53
 v_exp_f32 v50, v50
 v_cvt_pk_bf16_f32 v16, v48, v49
 v_cvt_pk_bf16_f32 v17, v52, v53
 v_exp_f32 v51, v51
 v_exp_f32 v54, v54
 v_exp_f32 v55, v55
 v_cvt_pk_bf16_f32 v18, v50, v51
 v_cvt_pk_bf16_f32 v19, v54, v55
 v_exp_f32 v56, v56
 v_exp_f32 v57, v57
 v_exp_f32 v60, v60
 v_exp_f32 v61, v61
 v_exp_f32 v58, v58
 v_cvt_pk_bf16_f32 v20, v56, v57
 v_cvt_pk_bf16_f32 v21, v60, v61
 v_exp_f32 v59, v59
 v_exp_f32 v62, v62
 v_exp_f32 v63, v63
 v_cvt_pk_bf16_f32 v22, v58, v59
 v_cvt_pk_bf16_f32 v23, v62, v63
 v_exp_f32 v64, v64
 v_exp_f32 v65, v65
 v_exp_f32 v68, v68
 v_exp_f32 v69, v69
 v_exp_f32 v66, v66
 v_cvt_pk_bf16_f32 v24, v64, v65
 v_cvt_pk_bf16_f32 v25, v68, v69
 v_exp_f32 v67, v67
 v_exp_f32 v70, v70
 v_exp_f32 v71, v71
 v_cvt_pk_bf16_f32 v26, v66, v67
 v_cvt_pk_bf16_f32 v27, v70, v71
 v_exp_f32 v72, v72
 v_exp_f32 v73, v73
 v_exp_f32 v76, v76
 v_exp_f32 v77, v77
 v_exp_f32 v74, v74
 v_cvt_pk_bf16_f32 v28, v72, v73
 v_cvt_pk_bf16_f32 v29, v76, v77
 v_exp_f32 v75, v75
 v_exp_f32 v78, v78
 v_exp_f32 v79, v79
 v_cvt_pk_bf16_f32 v30, v74, v75
 v_cvt_pk_bf16_f32 v31, v78, v79
 s_nop 1
 v_mfma_f32_16x16x32_bf16 v[112:115], a[160:163], v[16:19], v[112:115]
 v_mfma_f32_16x16x32_bf16 v[144:147], a[160:163], v[20:23], v[144:147]
 v_mfma_f32_16x16x32_bf16 v[176:179], a[160:163], v[24:27], v[176:179]
 v_mfma_f32_16x16x32_bf16 v[208:211], a[160:163], v[28:31], v[208:211]
 v_mfma_f32_16x16x32_bf16 v[116:119], a[164:167], v[16:19], v[116:119]
 v_mfma_f32_16x16x32_bf16 v[148:151], a[164:167], v[20:23], v[148:151]
 v_mfma_f32_16x16x32_bf16 v[180:183], a[164:167], v[24:27], v[180:183]
 v_mfma_f32_16x16x32_bf16 v[212:215], a[164:167], v[28:31], v[212:215]
 v_mfma_f32_16x16x32_bf16 v[120:123], a[168:171], v[16:19], v[120:123]
 v_mfma_f32_16x16x32_bf16 v[152:155], a[168:171], v[20:23], v[152:155]
 v_mfma_f32_16x16x32_bf16 v[184:187], a[168:171], v[24:27], v[184:187]
 v_mfma_f32_16x16x32_bf16 v[216:219], a[168:171], v[28:31], v[216:219]
 v_mfma_f32_16x16x32_bf16 v[124:127], a[172:175], v[16:19], v[124:127]
 v_mfma_f32_16x16x32_bf16 v[156:159], a[172:175], v[20:23], v[156:159]
 v_mfma_f32_16x16x32_bf16 v[188:191], a[172:175], v[24:27], v[188:191]
 v_mfma_f32_16x16x32_bf16 v[220:223], a[172:175], v[28:31], v[220:223]
 v_mfma_f32_16x16x32_bf16 v[128:131], a[176:179], v[16:19], v[128:131]
 v_mfma_f32_16x16x32_bf16 v[160:163], a[176:179], v[20:23], v[160:163]
 v_mfma_f32_16x16x32_bf16 v[192:195], a[176:179], v[24:27], v[192:195]
 v_mfma_f32_16x16x32_bf16 v[224:227], a[176:179], v[28:31], v[224:227]
 v_mfma_f32_16x16x32_bf16 v[132:135], a[180:183], v[16:19], v[132:135]
 v_mfma_f32_16x16x32_bf16 v[164:167], a[180:183], v[20:23], v[164:167]
 v_mfma_f32_16x16x32_bf16 v[196:199], a[180:183], v[24:27], v[196:199]
 v_mfma_f32_16x16x32_bf16 v[228:231], a[180:183], v[28:31], v[228:231]
 v_mfma_f32_16x16x32_bf16 v[136:139], a[184:187], v[16:19], v[136:139]
 v_mfma_f32_16x16x32_bf16 v[168:171], a[184:187], v[20:23], v[168:171]
 v_mfma_f32_16x16x32_bf16 v[200:203], a[184:187], v[24:27], v[200:203]
 v_mfma_f32_16x16x32_bf16 v[232:235], a[184:187], v[28:31], v[232:235]
 v_mfma_f32_16x16x32_bf16 v[140:143], a[188:191], v[16:19], v[140:143]
 v_mfma_f32_16x16x32_bf16 v[172:175], a[188:191], v[20:23], v[172:175]
 v_mfma_f32_16x16x32_bf16 v[204:207], a[188:191], v[24:27], v[204:207]
 v_mfma_f32_16x16x32_bf16 v[236:239], a[188:191], v[28:31], v[236:239]
 v_mfma_f32_16x16x32_bf16 v[32:35], a[192:195], v[16:19], v[32:35]
 v_mfma_f32_16x16x32_bf16 v[36:39], a[192:195], v[20:23], v[36:39]
 v_mfma_f32_16x16x32_bf16 v[40:43], a[192:195], v[24:27], v[40:43]
 v_mfma_f32_16x16x32_bf16 v[44:47], a[192:195], v[28:31], v[44:47]
 s_add_u32 s49, s49, 1
 s_cmp_le_u32 s49, s42
 s_cbranch_scc1 Lsl_22
 ds_read_b128 a[128:131], v3 offset:0
 ds_read_b128 a[132:135], v3 offset:1024
 ds_read_b128 a[136:139], v3 offset:2048
 ds_read_b128 a[140:143], v3 offset:3072
 ds_read_b128 a[144:147], v3 offset:4096
 ds_read_b128 a[148:151], v3 offset:5120
 ds_read_b128 a[152:155], v3 offset:6144
 ds_read_b128 a[156:159], v3 offset:7168
 s_branch Laback_11
Ladone_12:
 s_waitcnt vmcnt(0) lgkmcnt(0)
 s_barrier
 v_mov_b32 v6, 1
 buffer_store_dword v6, v5, s[20:23], s72 offen sc1
 s_cmp_ge_u32 s6, 27
 s_cbranch_scc1 Lfin
 s_load_dwordx2 s[8:9], s[0:1], 40
 s_mov_b32 s10, 0x480000
 s_mov_b32 s11, 0x20000
 s_mul_i32 s7, s6, 29
 s_lshr_b32 s7, s7, 8
 s_mul_i32 s94, s7, 9
 s_sub_u32 s32, s6, s94
 s_mul_i32 s40, s7, 3
 s_lshl_b32 s7, s7, 2
 s_add_u32 s7, s7, s5
 s_sub_u32 s33, s7, 4
 s_mov_b32 s34, 12
 s_cmp_lt_u32 s33, 4
 s_cselect_b32 s35, 6, 5
 s_mov_b32 s36, 0x6000000
 s_mov_b32 s37, 0
 s_lshl_b32 s38, s4, 5
 s_add_u32 s38, s38, 0x4000
 s_mov_b32 s39, 0
 s_mov_b32 s93, 0x38
 s_mov_b32 s92, 7
 s_mov_b32 s91, 4
 s_mov_b32 s90, 31
 s_branch Los
Lpb:
 s_load_dwordx2 s[8:9], s[0:1], 48
 s_mov_b32 s10, 0x240000
 s_mov_b32 s11, 0x20000
 s_load_dwordx2 s[12:13], s[0:1], 72
 s_mov_b32 s14, 0x480000
 s_mov_b32 s15, 0x20000
 s_load_dwordx2 s[16:17], s[0:1], 80
 s_mov_b32 s18, 0x480000
 s_mov_b32 s19, 0x20000
 s_lshl_b32 s32, s6, 8
 s_mov_b32 s33, s32
 s_lshl_b32 s34, s6, 14
 s_add_u32 s34, s34, 0x3000000
 s_add_u32 s35, s34, 8192
 s_mov_b32 s36, 64
 s_mov_b32 s37, 0
 s_lshl_b32 s7, s6, 7
 s_add_u32 s7, s7, 0x0
 v_min_u32 v1, 1, v0
 v_lshlrev_b32 v1, 28, v1
 v_add_u32 v13, s7, v1
 s_waitcnt lgkmcnt(0)
 v_and_b32 v1, 63, v0
 v_lshrrev_b32 v2, 3, v0
 v_mul_u32_u24 v10, 1152, v2
 v_lshrrev_b32 v2, 4, v0
 v_xor_b32 v2, v2, v0
 v_and_b32 v2, 7, v2
 v_lshl_add_u32 v10, v2, 4, v10
 v_lshrrev_b32 v2, 4, v1
 v_bfe_u32 v3, v1, 1, 3
 v_xor_b32 v2, v2, v3
 v_and_b32 v3, 15, v1
 v_lshlrev_b32 v3, 7, v3
 v_lshl_add_u32 v4, v2, 4, v3
 v_xor_b32 v5, 64, v4
 v_lshrrev_b32 v2, 4, v0
 v_lshlrev_b32 v11, 13, v2
 v_lshrrev_b32 v2, 7, v0
 v_lshrrev_b32 v3, 4, v1
 v_lshl_add_u32 v3, v2, 2, v3
 v_bfe_u32 v2, v1, 1, 3
 v_xor_b32 v2, v2, v3
 v_lshl_add_u32 v11, v2, 5, v11
 v_and_b32 v2, 1, v1
 v_lshl_add_u32 v11, v2, 4, v11
 v_bfe_u32 v2, v1, 2, 3
 v_xor_b32 v3, s4, v2
 v_lshlrev_b32 v3, 5, v3
 v_and_b32 v2, 3, v2
 v_lshl_add_u32 v3, v2, 8, v3
 v_lshrrev_b32 v2, 4, v1
 v_lshl_add_u32 v3, v2, 11, v3
 v_and_b32 v2, 3, v1
 v_lshl_add_u32 v3, v2, 3, v3
 v_add_u32 v8, 73728, v3
 v_xor_b32 v3, 0x80, v3
 v_add_u32 v9, 73728, v3
 s_lshl_b32 s45, s4, 11
 v_lshl_add_u32 v12, v1, 4, s45
 s_mov_b32 s39, s37
 s_add_u32 s40, s39, 1
 s_min_u32 s40, s40, 63
 s_lshl_b32 s49, s4, 10
 s_mul_i32 s46, s39, 36864
 s_add_u32 m0, s49, 0
 s_nop 0
 buffer_load_dwordx4 v10, s[8:11], s46 offen offset:0  lds
 s_add_u32 m0, s49, 3968
 s_nop 0
 buffer_load_dwordx4 v10, s[8:11], s46 offen offset:128  lds
 s_add_u32 m0, s49, 7936
 s_nop 0
 buffer_load_dwordx4 v10, s[8:11], s46 offen offset:256  lds
 s_add_u32 m0, s49, 11904
 s_nop 0
 buffer_load_dwordx4 v10, s[8:11], s46 offen offset:384  lds
 s_add_u32 m0, s49, 15872
 s_nop 0
 buffer_load_dwordx4 v10, s[8:11], s46 offen offset:512  lds
 s_add_u32 m0, s49, 19840
 s_nop 0
 buffer_load_dwordx4 v10, s[8:11], s46 offen offset:640  lds
 s_add_u32 m0, s49, 23808
 s_nop 0
 buffer_load_dwordx4 v10, s[8:11], s46 offen offset:768  lds
 s_add_u32 m0, s49, 27776
 s_nop 0
 buffer_load_dwordx4 v10, s[8:11], s46 offen offset:896  lds
 s_add_u32 m0, s49, 31744
 s_nop 0
 buffer_load_dwordx4 v10, s[8:11], s46 offen offset:1024  lds
 s_lshl_b32 s49, s4, 10
 s_add_u32 s49, s49, 36864
 s_mul_i32 s46, s40, 36864
 s_add_u32 m0, s49, 0
 s_nop 0
 buffer_load_dwordx4 v10, s[8:11], s46 offen offset:0  lds
 s_add_u32 m0, s49, 3968
 s_nop 0
 buffer_load_dwordx4 v10, s[8:11], s46 offen offset:128  lds
 s_add_u32 m0, s49, 7936
 s_nop 0
 buffer_load_dwordx4 v10, s[8:11], s46 offen offset:256  lds
 s_add_u32 m0, s49, 11904
 s_nop 0
 buffer_load_dwordx4 v10, s[8:11], s46 offen offset:384  lds
 s_add_u32 m0, s49, 15872
 s_nop 0
 buffer_load_dwordx4 v10, s[8:11], s46 offen offset:512  lds
 s_add_u32 m0, s49, 19840
 s_nop 0
 buffer_load_dwordx4 v10, s[8:11], s46 offen offset:640  lds
 s_add_u32 m0, s49, 23808
 s_nop 0
 buffer_load_dwordx4 v10, s[8:11], s46 offen offset:768  lds
 s_add_u32 m0, s49, 27776
 s_nop 0
 buffer_load_dwordx4 v10, s[8:11], s46 offen offset:896  lds
 s_add_u32 m0, s49, 31744
 s_nop 0
 buffer_load_dwordx4 v10, s[8:11], s46 offen offset:1024  lds
 s_lshl_b32 s49, s4, 10
 s_add_u32 m0, s49, 73728
 s_add_u32 s45, s32, 0
 buffer_load_dwordx4 v11, s[12:15], s45 offen  lds
 s_add_u32 m0, s49, 77824
 s_add_u32 s45, s32, 131072
 buffer_load_dwordx4 v11, s[12:15], s45 offen  lds
 s_add_u32 m0, s49, 81920
 s_add_u32 s45, s33, 0
 buffer_load_dwordx4 v11, s[16:19], s45 offen  lds
 s_add_u32 m0, s49, 86016
 s_add_u32 s45, s33, 131072
 buffer_load_dwordx4 v11, s[16:19], s45 offen  lds
 s_add_u32 m0, s49, 90112
 s_add_u32 s45, s32, 262144
 buffer_load_dwordx4 v11, s[12:15], s45 offen  lds
 s_add_u32 m0, s49, 94208
 s_add_u32 s45, s32, 393216
 buffer_load_dwordx4 v11, s[12:15], s45 offen  lds
 s_add_u32 m0, s49, 98304
 s_add_u32 s45, s33, 262144
 buffer_load_dwordx4 v11, s[16:19], s45 offen  lds
 s_add_u32 m0, s49, 102400
 s_add_u32 s45, s33, 393216
 buffer_load_dwordx4 v11, s[16:19], s45 offen  lds
 s_add_u32 m0, s49, 106496
 s_add_u32 s45, s32, 524288
 buffer_load_dwordx4 v11, s[12:15], s45 offen  lds
 s_add_u32 m0, s49, 110592
 s_add_u32 s45, s32, 655360
 buffer_load_dwordx4 v11, s[12:15], s45 offen  lds
 s_add_u32 m0, s49, 114688
 s_add_u32 s45, s33, 524288
 buffer_load_dwordx4 v11, s[16:19], s45 offen  lds
 s_add_u32 m0, s49, 118784
 s_add_u32 s45, s33, 655360
 buffer_load_dwordx4 v11, s[16:19], s45 offen  lds
 s_waitcnt vmcnt(8) lgkmcnt(0)
 s_barrier
 s_add_u32 m0, s49, 122880
 s_add_u32 s45, s32, 786432
 buffer_load_dwordx4 v11, s[12:15], s45 offen  lds
 s_add_u32 m0, s49, 126976
 s_add_u32 s45, s32, 917504
 buffer_load_dwordx4 v11, s[12:15], s45 offen  lds
 s_add_u32 m0, s49, 131072
 s_add_u32 s45, s33, 786432
 buffer_load_dwordx4 v11, s[16:19], s45 offen  lds
 s_add_u32 m0, s49, 135168
 s_add_u32 s45, s33, 917504
 buffer_load_dwordx4 v11, s[16:19], s45 offen  lds
 ds_read_b64_tr_b16 a[0:1], v8 offset:0
 ds_read_b64_tr_b16 a[2:3], v8 offset:1024
 ds_read_b64_tr_b16 a[72:73], v9 offset:0
 ds_read_b64_tr_b16 a[74:75], v9 offset:1024
 ds_read_b64_tr_b16 a[144:145], v8 offset:8192
 ds_read_b64_tr_b16 a[146:147], v8 offset:9216
 ds_read_b64_tr_b16 a[216:217], v9 offset:8192
 ds_read_b64_tr_b16 a[218:219], v9 offset:9216
 s_waitcnt vmcnt(8) lgkmcnt(0)
 s_barrier
 s_add_u32 m0, s49, 73728
 s_add_u32 s45, s32, 1048576
 buffer_load_dwordx4 v11, s[12:15], s45 offen  lds
 s_add_u32 m0, s49, 77824
 s_add_u32 s45, s32, 1179648
 buffer_load_dwordx4 v11, s[12:15], s45 offen  lds
 s_add_u32 m0, s49, 81920
 s_add_u32 s45, s33, 1048576
 buffer_load_dwordx4 v11, s[16:19], s45 offen  lds
 s_add_u32 m0, s49, 86016
 s_add_u32 s45, s33, 1179648
 buffer_load_dwordx4 v11, s[16:19], s45 offen  lds
 ds_read_b64_tr_b16 a[4:5], v8 offset:16384
 ds_read_b64_tr_b16 a[6:7], v8 offset:17408
 ds_read_b64_tr_b16 a[76:77], v9 offset:16384
 ds_read_b64_tr_b16 a[78:79], v9 offset:17408
 ds_read_b64_tr_b16 a[148:149], v8 offset:24576
 ds_read_b64_tr_b16 a[150:151], v8 offset:25600
 ds_read_b64_tr_b16 a[220:221], v9 offset:24576
 ds_read_b64_tr_b16 a[222:223], v9 offset:25600
 s_waitcnt vmcnt(8) lgkmcnt(0)
 s_barrier
 s_add_u32 m0, s49, 90112
 s_add_u32 s45, s32, 1310720
 buffer_load_dwordx4 v11, s[12:15], s45 offen  lds
 s_add_u32 m0, s49, 94208
 s_add_u32 s45, s32, 1441792
 buffer_load_dwordx4 v11, s[12:15], s45 offen  lds
 s_add_u32 m0, s49, 98304
 s_add_u32 s45, s33, 1310720
 buffer_load_dwordx4 v11, s[16:19], s45 offen  lds
 s_add_u32 m0, s49, 102400
 s_add_u32 s45, s33, 1441792
 buffer_load_dwordx4 v11, s[16:19], s45 offen  lds
 ds_read_b64_tr_b16 a[8:9], v8 offset:32768
 ds_read_b64_tr_b16 a[10:11], v8 offset:33792
 ds_read_b64_tr_b16 a[80:81], v9 offset:32768
 ds_read_b64_tr_b16 a[82:83], v9 offset:33792
 ds_read_b64_tr_b16 a[152:153], v8 offset:40960
 ds_read_b64_tr_b16 a[154:155], v8 offset:41984
 ds_read_b64_tr_b16 a[224:225], v9 offset:40960
 ds_read_b64_tr_b16 a[226:227], v9 offset:41984
 s_waitcnt vmcnt(8) lgkmcnt(0)
 s_barrier
 s_add_u32 m0, s49, 106496
 s_add_u32 s45, s32, 1572864
 buffer_load_dwordx4 v11, s[12:15], s45 offen  lds
 s_add_u32 m0, s49, 110592
 s_add_u32 s45, s32, 1703936
 buffer_load_dwordx4 v11, s[12:15], s45 offen  lds
 s_add_u32 m0, s49, 114688
 s_add_u32 s45, s33, 1572864
 buffer_load_dwordx4 v11, s[16:19], s45 offen  lds
 s_add_u32 m0, s49, 118784
 s_add_u32 s45, s33, 1703936
 buffer_load_dwordx4 v11, s[16:19], s45 offen  lds
 ds_read_b64_tr_b16 a[12:13], v8 offset:49152
 ds_read_b64_tr_b16 a[14:15], v8 offset:50176
 ds_read_b64_tr_b16 a[84:85], v9 offset:49152
 ds_read_b64_tr_b16 a[86:87], v9 offset:50176
 ds_read_b64_tr_b16 a[156:157], v8 offset:57344
 ds_read_b64_tr_b16 a[158:159], v8 offset:58368
 ds_read_b64_tr_b16 a[228:229], v9 offset:57344
 ds_read_b64_tr_b16 a[230:231], v9 offset:58368
 s_waitcnt vmcnt(8) lgkmcnt(0)
 s_barrier
 s_add_u32 m0, s49, 122880
 s_add_u32 s45, s32, 1835008
 buffer_load_dwordx4 v11, s[12:15], s45 offen  lds
 s_add_u32 m0, s49, 126976
 s_add_u32 s45, s32, 1966080
 buffer_load_dwordx4 v11, s[12:15], s45 offen  lds
 s_add_u32 m0, s49, 131072
 s_add_u32 s45, s33, 1835008
 buffer_load_dwordx4 v11, s[16:19], s45 offen  lds
 s_add_u32 m0, s49, 135168
 s_add_u32 s45, s33, 1966080
 buffer_load_dwordx4 v11, s[16:19], s45 offen  lds
 ds_read_b64_tr_b16 a[16:17], v8 offset:0
 ds_read_b64_tr_b16 a[18:19], v8 offset:1024
 ds_read_b64_tr_b16 a[88:89], v9 offset:0
 ds_read_b64_tr_b16 a[90:91], v9 offset:1024
 ds_read_b64_tr_b16 a[160:161], v8 offset:8192
 ds_read_b64_tr_b16 a[162:163], v8 offset:9216
 ds_read_b64_tr_b16 a[232:233], v9 offset:8192
 ds_read_b64_tr_b16 a[234:235], v9 offset:9216
 s_waitcnt vmcnt(8) lgkmcnt(0)
 s_barrier
 s_add_u32 m0, s49, 73728
 s_add_u32 s45, s32, 2097152
 buffer_load_dwordx4 v11, s[12:15], s45 offen  lds
 s_add_u32 m0, s49, 77824
 s_add_u32 s45, s32, 2228224
 buffer_load_dwordx4 v11, s[12:15], s45 offen  lds
 s_add_u32 m0, s49, 81920
 s_add_u32 s45, s33, 2097152
 buffer_load_dwordx4 v11, s[16:19], s45 offen  lds
 s_add_u32 m0, s49, 86016
 s_add_u32 s45, s33, 2228224
 buffer_load_dwordx4 v11, s[16:19], s45 offen  lds
 ds_read_b64_tr_b16 a[20:21], v8 offset:16384
 ds_read_b64_tr_b16 a[22:23], v8 offset:17408
 ds_read_b64_tr_b16 a[92:93], v9 offset:16384
 ds_read_b64_tr_b16 a[94:95], v9 offset:17408
 ds_read_b64_tr_b16 a[164:165], v8 offset:24576
 ds_read_b64_tr_b16 a[166:167], v8 offset:25600
 ds_read_b64_tr_b16 a[236:237], v9 offset:24576
 ds_read_b64_tr_b16 a[238:239], v9 offset:25600
 s_waitcnt vmcnt(8) lgkmcnt(0)
 s_barrier
 s_add_u32 m0, s49, 90112
 s_add_u32 s45, s32, 2359296
 buffer_load_dwordx4 v11, s[12:15], s45 offen  lds
 s_add_u32 m0, s49, 94208
 s_add_u32 s45, s32, 2490368
 buffer_load_dwordx4 v11, s[12:15], s45 offen  lds
 s_add_u32 m0, s49, 98304
 s_add_u32 s45, s33, 2359296
 buffer_load_dwordx4 v11, s[16:19], s45 offen  lds
 s_add_u32 m0, s49, 102400
 s_add_u32 s45, s33, 2490368
 buffer_load_dwordx4 v11, s[16:19], s45 offen  lds
 ds_read_b64_tr_b16 a[24:25], v8 offset:32768
 ds_read_b64_tr_b16 a[26:27], v8 offset:33792
 ds_read_b64_tr_b16 a[96:97], v9 offset:32768
 ds_read_b64_tr_b16 a[98:99], v9 offset:33792
 ds_read_b64_tr_b16 a[168:169], v8 offset:40960
 ds_read_b64_tr_b16 a[170:171], v8 offset:41984
 ds_read_b64_tr_b16 a[240:241], v9 offset:40960
 ds_read_b64_tr_b16 a[242:243], v9 offset:41984
 s_waitcnt vmcnt(8) lgkmcnt(0)
 s_barrier
 s_add_u32 m0, s49, 106496
 s_add_u32 s45, s32, 2621440
 buffer_load_dwordx4 v11, s[12:15], s45 offen  lds
 s_add_u32 m0, s49, 110592
 s_add_u32 s45, s32, 2752512
 buffer_load_dwordx4 v11, s[12:15], s45 offen  lds
 s_add_u32 m0, s49, 114688
 s_add_u32 s45, s33, 2621440
 buffer_load_dwordx4 v11, s[16:19], s45 offen  lds
 s_add_u32 m0, s49, 118784
 s_add_u32 s45, s33, 2752512
 buffer_load_dwordx4 v11, s[16:19], s45 offen  lds
 ds_read_b64_tr_b16 a[28:29], v8 offset:49152
 ds_read_b64_tr_b16 a[30:31], v8 offset:50176
 ds_read_b64_tr_b16 a[100:101], v9 offset:49152
 ds_read_b64_tr_b16 a[102:103], v9 offset:50176
 ds_read_b64_tr_b16 a[172:173], v8 offset:57344
 ds_read_b64_tr_b16 a[174:175], v8 offset:58368
 ds_read_b64_tr_b16 a[244:245], v9 offset:57344
 ds_read_b64_tr_b16 a[246:247], v9 offset:58368
 s_waitcnt vmcnt(8) lgkmcnt(0)
 s_barrier
 s_add_u32 m0, s49, 122880
 s_add_u32 s45, s32, 2883584
 buffer_load_dwordx4 v11, s[12:15], s45 offen  lds
 s_add_u32 m0, s49, 126976
 s_add_u32 s45, s32, 3014656
 buffer_load_dwordx4 v11, s[12:15], s45 offen  lds
 s_add_u32 m0, s49, 131072
 s_add_u32 s45, s33, 2883584
 buffer_load_dwordx4 v11, s[16:19], s45 offen  lds
 s_add_u32 m0, s49, 135168
 s_add_u32 s45, s33, 3014656
 buffer_load_dwordx4 v11, s[16:19], s45 offen  lds
 ds_read_b64_tr_b16 a[32:33], v8 offset:0
 ds_read_b64_tr_b16 a[34:35], v8 offset:1024
 ds_read_b64_tr_b16 a[104:105], v9 offset:0
 ds_read_b64_tr_b16 a[106:107], v9 offset:1024
 ds_read_b64_tr_b16 a[176:177], v8 offset:8192
 ds_read_b64_tr_b16 a[178:179], v8 offset:9216
 ds_read_b64_tr_b16 a[248:249], v9 offset:8192
 ds_read_b64_tr_b16 a[250:251], v9 offset:9216
 s_waitcnt vmcnt(8) lgkmcnt(0)
 s_barrier
 s_add_u32 m0, s49, 73728
 s_add_u32 s45, s32, 3145728
 buffer_load_dwordx4 v11, s[12:15], s45 offen  lds
 s_add_u32 m0, s49, 77824
 s_add_u32 s45, s32, 3276800
 buffer_load_dwordx4 v11, s[12:15], s45 offen  lds
 s_add_u32 m0, s49, 81920
 s_add_u32 s45, s33, 3145728
 buffer_load_dwordx4 v11, s[16:19], s45 offen  lds
 s_add_u32 m0, s49, 86016
 s_add_u32 s45, s33, 3276800
 buffer_load_dwordx4 v11, s[16:19], s45 offen  lds
 ds_read_b64_tr_b16 a[36:37], v8 offset:16384
 ds_read_b64_tr_b16 a[38:39], v8 offset:17408
 ds_read_b64_tr_b16 a[108:109], v9 offset:16384
 ds_read_b64_tr_b16 a[110:111], v9 offset:17408
 ds_read_b64_tr_b16 a[180:181], v8 offset:24576
 ds_read_b64_tr_b16 a[182:183], v8 offset:25600
 ds_read_b64_tr_b16 a[252:253], v9 offset:24576
 ds_read_b64_tr_b16 a[254:255], v9 offset:25600
 s_waitcnt vmcnt(8) lgkmcnt(0)
 s_barrier
 s_add_u32 m0, s49, 90112
 s_add_u32 s45, s32, 3407872
 buffer_load_dwordx4 v11, s[12:15], s45 offen  lds
 s_add_u32 m0, s49, 94208
 s_add_u32 s45, s32, 3538944
 buffer_load_dwordx4 v11, s[12:15], s45 offen  lds
 s_add_u32 m0, s49, 98304
 s_add_u32 s45, s33, 3407872
 buffer_load_dwordx4 v11, s[16:19], s45 offen  lds
 s_add_u32 m0, s49, 102400
 s_add_u32 s45, s33, 3538944
 buffer_load_dwordx4 v11, s[16:19], s45 offen  lds
 ds_read_b64_tr_b16 a[40:41], v8 offset:32768
 ds_read_b64_tr_b16 a[42:43], v8 offset:33792
 ds_read_b64_tr_b16 a[112:113], v9 offset:32768
 ds_read_b64_tr_b16 a[114:115], v9 offset:33792
 ds_read_b64_tr_b16 a[184:185], v8 offset:40960
 ds_read_b64_tr_b16 a[186:187], v8 offset:41984
 ds_read_b64_tr_b16 v[224:225], v9 offset:40960
 ds_read_b64_tr_b16 v[226:227], v9 offset:41984
 s_waitcnt vmcnt(8) lgkmcnt(0)
 s_barrier
 s_add_u32 m0, s49, 106496
 s_add_u32 s45, s32, 3670016
 buffer_load_dwordx4 v11, s[12:15], s45 offen  lds
 s_add_u32 m0, s49, 110592
 s_add_u32 s45, s32, 3801088
 buffer_load_dwordx4 v11, s[12:15], s45 offen  lds
 s_add_u32 m0, s49, 114688
 s_add_u32 s45, s33, 3670016
 buffer_load_dwordx4 v11, s[16:19], s45 offen  lds
 s_add_u32 m0, s49, 118784
 s_add_u32 s45, s33, 3801088
 buffer_load_dwordx4 v11, s[16:19], s45 offen  lds
 ds_read_b64_tr_b16 a[44:45], v8 offset:49152
 ds_read_b64_tr_b16 a[46:47], v8 offset:50176
 ds_read_b64_tr_b16 a[116:117], v9 offset:49152
 ds_read_b64_tr_b16 a[118:119], v9 offset:50176
 ds_read_b64_tr_b16 a[188:189], v8 offset:57344
 ds_read_b64_tr_b16 a[190:191], v8 offset:58368
 ds_read_b64_tr_b16 v[228:229], v9 offset:57344
 ds_read_b64_tr_b16 v[230:231], v9 offset:58368
 s_waitcnt vmcnt(8) lgkmcnt(0)
 s_barrier
 s_add_u32 m0, s49, 122880
 s_add_u32 s45, s32, 3932160
 buffer_load_dwordx4 v11, s[12:15], s45 offen  lds
 s_add_u32 m0, s49, 126976
 s_add_u32 s45, s32, 4063232
 buffer_load_dwordx4 v11, s[12:15], s45 offen  lds
 s_add_u32 m0, s49, 131072
 s_add_u32 s45, s33, 3932160
 buffer_load_dwordx4 v11, s[16:19], s45 offen  lds
 s_add_u32 m0, s49, 135168
 s_add_u32 s45, s33, 4063232
 buffer_load_dwordx4 v11, s[16:19], s45 offen  lds
 ds_read_b64_tr_b16 a[48:49], v8 offset:0
 ds_read_b64_tr_b16 a[50:51], v8 offset:1024
 ds_read_b64_tr_b16 a[120:121], v9 offset:0
 ds_read_b64_tr_b16 a[122:123], v9 offset:1024
 ds_read_b64_tr_b16 a[192:193], v8 offset:8192
 ds_read_b64_tr_b16 a[194:195], v8 offset:9216
 ds_read_b64_tr_b16 v[232:233], v9 offset:8192
 ds_read_b64_tr_b16 v[234:235], v9 offset:9216
 s_waitcnt vmcnt(8) lgkmcnt(0)
 s_barrier
 s_add_u32 m0, s49, 73728
 s_add_u32 s45, s32, 4194304
 buffer_load_dwordx4 v11, s[12:15], s45 offen  lds
 s_add_u32 m0, s49, 77824
 s_add_u32 s45, s32, 4325376
 buffer_load_dwordx4 v11, s[12:15], s45 offen  lds
 s_add_u32 m0, s49, 81920
 s_add_u32 s45, s33, 4194304
 buffer_load_dwordx4 v11, s[16:19], s45 offen  lds
 s_add_u32 m0, s49, 86016
 s_add_u32 s45, s33, 4325376
 buffer_load_dwordx4 v11, s[16:19], s45 offen  lds
 ds_read_b64_tr_b16 a[52:53], v8 offset:16384
 ds_read_b64_tr_b16 a[54:55], v8 offset:17408
 ds_read_b64_tr_b16 a[124:125], v9 offset:16384
 ds_read_b64_tr_b16 a[126:127], v9 offset:17408
 ds_read_b64_tr_b16 a[196:197], v8 offset:24576
 ds_read_b64_tr_b16 a[198:199], v8 offset:25600
 ds_read_b64_tr_b16 v[236:237], v9 offset:24576
 ds_read_b64_tr_b16 v[238:239], v9 offset:25600
 s_waitcnt vmcnt(8) lgkmcnt(0)
 s_barrier
 s_add_u32 m0, s49, 90112
 s_add_u32 s45, s32, 4456448
 buffer_load_dwordx4 v11, s[12:15], s45 offen  lds
 s_add_u32 m0, s49, 94208
 s_add_u32 s45, s32, 4587520
 buffer_load_dwordx4 v11, s[12:15], s45 offen  lds
 s_add_u32 m0, s49, 98304
 s_add_u32 s45, s33, 4456448
 buffer_load_dwordx4 v11, s[16:19], s45 offen  lds
 s_add_u32 m0, s49, 102400
 s_add_u32 s45, s33, 4587520
 buffer_load_dwordx4 v11, s[16:19], s45 offen  lds
 ds_read_b64_tr_b16 a[56:57], v8 offset:32768
 ds_read_b64_tr_b16 a[58:59], v8 offset:33792
 ds_read_b64_tr_b16 a[128:129], v9 offset:32768
 ds_read_b64_tr_b16 a[130:131], v9 offset:33792
 ds_read_b64_tr_b16 a[200:201], v8 offset:40960
 ds_read_b64_tr_b16 a[202:203], v8 offset:41984
 ds_read_b64_tr_b16 v[240:241], v9 offset:40960
 ds_read_b64_tr_b16 v[242:243], v9 offset:41984
 s_waitcnt vmcnt(8) lgkmcnt(0)
 s_barrier
 ds_read_b64_tr_b16 a[60:61], v8 offset:49152
 ds_read_b64_tr_b16 a[62:63], v8 offset:50176
 ds_read_b64_tr_b16 a[132:133], v9 offset:49152
 ds_read_b64_tr_b16 a[134:135], v9 offset:50176
 ds_read_b64_tr_b16 a[204:205], v8 offset:57344
 ds_read_b64_tr_b16 a[206:207], v8 offset:58368
 ds_read_b64_tr_b16 v[244:245], v9 offset:57344
 ds_read_b64_tr_b16 v[246:247], v9 offset:58368
 s_waitcnt vmcnt(4) lgkmcnt(0)
 s_barrier
 ds_read_b64_tr_b16 a[64:65], v8 offset:0
 ds_read_b64_tr_b16 a[66:67], v8 offset:1024
 ds_read_b64_tr_b16 a[136:137], v9 offset:0
 ds_read_b64_tr_b16 a[138:139], v9 offset:1024
 ds_read_b64_tr_b16 a[208:209], v8 offset:8192
 ds_read_b64_tr_b16 a[210:211], v8 offset:9216
 ds_read_b64_tr_b16 v[248:249], v9 offset:8192
 ds_read_b64_tr_b16 v[250:251], v9 offset:9216
 s_waitcnt vmcnt(0) lgkmcnt(0)
 s_barrier
 ds_read_b64_tr_b16 a[68:69], v8 offset:16384
 ds_read_b64_tr_b16 a[70:71], v8 offset:17408
 ds_read_b64_tr_b16 a[140:141], v9 offset:16384
 ds_read_b64_tr_b16 a[142:143], v9 offset:17408
 ds_read_b64_tr_b16 a[212:213], v8 offset:24576
 ds_read_b64_tr_b16 a[214:215], v8 offset:25600
 ds_read_b64_tr_b16 v[252:253], v9 offset:24576
 ds_read_b64_tr_b16 v[254:255], v9 offset:25600
 s_mov_b32 s50, 0x3e0293ee
 s_mov_b32 s42, 0
 s_mov_b32 s43, 0
 s_mov_b32 s44, 73728
 v_mov_b32 v6, v4
 v_mov_b32 v7, v5
Lrh_25:
 v_mbcnt_lo_u32_b32 v21, -1, 0
 v_min_u32 v21, 1, v21
 v_lshlrev_b32 v21, 28, v21
 buffer_load_dword v20, v21, s[28:31], 0 offen offset:4 sc1
 s_waitcnt vmcnt(0)
Lrhc_26:
 v_readfirstlane_b32 s89, v20
 s_cmp_eq_u32 s89, s88
 s_cbranch_scc1 Lrhk_27
 s_cmp_lg_u32 s89, 0
 s_cbranch_scc1 Lredo
 s_sub_u32 s95, s95, 1
 s_cbranch_scc0 Lrh_25
 s_endpgm
Lrhk_27:
 s_cmp_lg_u32 s4, 0
 s_cbranch_scc1 Lfrk_24
 v_min_u32 v21, 1, v0
 v_lshlrev_b32 v21, 28, v21
Lfr_23:
 buffer_load_dword v20, v21, s[28:31], 0 offen offset:0 sc1
 s_waitcnt vmcnt(0)
 v_cmp_eq_u32 vcc, 1, v20
 s_cbranch_vccnz Lfrk_24
 s_sub_u32 s95, s95, 1
 s_cbranch_scc0 Lfr_23
 s_endpgm
Lfrk_24:
 s_lshl_b32 s47, s2, 13
 s_add_u32 s47, s47, 0x8000000
 s_mov_b32 s48, s47
 v_mov_b32 v14, 0
 s_waitcnt vmcnt(0) lgkmcnt(0)
 s_barrier
 ds_read_b128 v[32:35], v6 offset:0
 ds_read_b128 v[36:39], v6 offset:2048
 ds_read_b128 v[40:43], v7 offset:0
 ds_read_b128 v[44:47], v7 offset:2048
 s_mul_i32 s45, s6, 1152
 v_lshl_add_u32 v1, v0, 7, s45
 v_add_u32 v1, 110592, v1
 v_mov_b32 v2, 0x7ff00000
 v_cmp_gt_u32 vcc, 9, v0
 s_nop 1
 v_cndmask_b32 v1, v2, v1, vcc
 s_waitcnt lgkmcnt(2)
Lps_loop_28:
 v_mfma_f32_16x16x32_bf16 v[64:67], a[0:3], v[32:35], 0
 ds_read_b128 v[48:51], v6 offset:4096
 v_mfma_f32_16x16x32_bf16 v[72:75], a[72:75], v[32:35], 0
 ds_read_b128 v[52:55], v6 offset:6144
 v_mfma_f32_16x16x32_bf16 v[80:83], v[32:35], a[144:147], 0
 s_add_u32 s41, s40, 1
 v_mfma_f32_16x16x32_bf16 v[88:91], v[32:35], a[216:219], 0
 s_add_u32 s45, s42, 2
 s_mul_i32 s46, s41, 36864
 v_mfma_f32_16x16x32_bf16 v[68:71], a[0:3], v[36:39], 0
 s_cmp_lt_u32 s45, s36
 s_cselect_b32 s46, s46, 0
 v_mfma_f32_16x16x32_bf16 v[76:79], a[72:75], v[36:39], 0
 s_lshl_b32 s49, s4, 10
 s_add_u32 s49, s49, s44
 v_mfma_f32_16x16x32_bf16 v[84:87], v[36:39], a[144:147], 0
 v_mul_f32 v96, s50, v96
 v_mul_f32 v97, s50, v97
 v_mfma_f32_16x16x32_bf16 v[92:95], v[36:39], a[216:219], 0
 s_waitcnt lgkmcnt(2)
 v_mfma_f32_16x16x32_bf16 v[64:67], a[4:7], v[40:43], v[64:67]
 ds_read_b128 v[56:59], v7 offset:4096
 v_mul_f32 v98, s50, v98
 v_mfma_f32_16x16x32_bf16 v[72:75], a[76:79], v[40:43], v[72:75]
 ds_read_b128 v[60:63], v7 offset:6144
 v_mul_f32 v99, s50, v99
 v_mfma_f32_16x16x32_bf16 v[80:83], v[40:43], a[148:151], v[80:83]
 v_mul_f32 v104, s50, v104
 v_mfma_f32_16x16x32_bf16 v[88:91], v[40:43], a[220:223], v[88:91]
 v_mul_f32 v105, s50, v105
 v_mfma_f32_16x16x32_bf16 v[68:71], a[4:7], v[44:47], v[68:71]
 v_mul_f32 v106, s50, v106
 v_mul_f32 v107, s50, v107
 v_mfma_f32_16x16x32_bf16 v[76:79], a[76:79], v[44:47], v[76:79]
 v_cvt_pk_bf16_f32 v16, v96, v104
 v_mfma_f32_16x16x32_bf16 v[84:87], v[44:47], a[148:151], v[84:87]
 v_cvt_pk_bf16_f32 v17, v97, v105
 v_mfma_f32_16x16x32_bf16 v[92:95], v[44:47], a[220:223], v[92:95]
 s_waitcnt lgkmcnt(2)
 v_cvt_pk_bf16_f32 v18, v98, v106
 v_mfma_f32_16x16x32_bf16 v[64:67], a[8:11], v[48:51], v[64:67]
 ds_read_b128 v[32:35], v6 offset:8192
 v_cvt_pk_bf16_f32 v19, v99, v107
 v_mfma_f32_16x16x32_bf16 v[72:75], a[80:83], v[48:51], v[72:75]
 ds_read_b128 v[36:39], v6 offset:10240
 v_mfma_f32_16x16x32_bf16 v[80:83], v[48:51], a[152:155], v[80:83]
 buffer_store_dwordx4 v[16:19], v12, s[20:23], s47 offen offset:0 sc1
 v_mul_f32 v100, s50, v100
 v_mfma_f32_16x16x32_bf16 v[88:91], v[48:51], a[224:227], v[88:91]
 v_mul_f32 v101, s50, v101
 v_mfma_f32_16x16x32_bf16 v[68:71], a[8:11], v[52:55], v[68:71]
 v_mul_f32 v102, s50, v102
 v_mfma_f32_16x16x32_bf16 v[76:79], a[80:83], v[52:55], v[76:79]
 v_mul_f32 v103, s50, v103
 v_mul_f32 v108, s50, v108
 v_mfma_f32_16x16x32_bf16 v[84:87], v[52:55], a[152:155], v[84:87]
 v_mul_f32 v109, s50, v109
 v_mfma_f32_16x16x32_bf16 v[92:95], v[52:55], a[224:227], v[92:95]
 s_waitcnt lgkmcnt(2)
 v_mfma_f32_16x16x32_bf16 v[64:67], a[12:15], v[56:59], v[64:67]
 ds_read_b128 v[40:43], v7 offset:8192
 v_mul_f32 v110, s50, v110
 v_mfma_f32_16x16x32_bf16 v[72:75], a[84:87], v[56:59], v[72:75]
 ds_read_b128 v[44:47], v7 offset:10240
 v_mul_f32 v111, s50, v111
 v_mfma_f32_16x16x32_bf16 v[80:83], v[56:59], a[156:159], v[80:83]
 v_cvt_pk_bf16_f32 v20, v100, v108
 v_mfma_f32_16x16x32_bf16 v[88:91], v[56:59], a[228:231], v[88:91]
 v_cvt_pk_bf16_f32 v21, v101, v109
 v_mfma_f32_16x16x32_bf16 v[68:71], a[12:15], v[60:63], v[68:71]
 v_cvt_pk_bf16_f32 v22, v102, v110
 v_cvt_pk_bf16_f32 v23, v103, v111
 v_mfma_f32_16x16x32_bf16 v[76:79], a[84:87], v[60:63], v[76:79]
 buffer_store_dwordx4 v[20:23], v12, s[20:23], s47 offen offset:1024 sc1
 v_mfma_f32_16x16x32_bf16 v[84:87], v[60:63], a[156:159], v[84:87]
 v_cvt_pk_bf16_f32 v24, v112, v113
 v_mfma_f32_16x16x32_bf16 v[92:95], v[60:63], a[228:231], v[92:95]
 s_waitcnt lgkmcnt(2)
 v_cvt_pk_bf16_f32 v25, v116, v117
 v_mfma_f32_16x16x32_bf16 v[64:67], a[16:19], v[32:35], v[64:67]
 ds_read_b128 v[48:51], v6 offset:12288
 v_cvt_pk_bf16_f32 v26, v114, v115
 v_mfma_f32_16x16x32_bf16 v[72:75], a[88:91], v[32:35], v[72:75]
 ds_read_b128 v[52:55], v6 offset:14336
 v_mfma_f32_16x16x32_bf16 v[80:83], v[32:35], a[160:163], v[80:83]
 v_cvt_pk_bf16_f32 v27, v118, v119
 buffer_store_dwordx4 v[24:27], v12, s[20:23], s48 offen offset:0 sc1
 v_mfma_f32_16x16x32_bf16 v[88:91], v[32:35], a[232:235], v[88:91]
 v_cvt_pk_bf16_f32 v28, v120, v121
 v_mfma_f32_16x16x32_bf16 v[68:71], a[16:19], v[36:39], v[68:71]
 v_cvt_pk_bf16_f32 v29, v124, v125
 v_mfma_f32_16x16x32_bf16 v[76:79], a[88:91], v[36:39], v[76:79]
 v_cvt_pk_bf16_f32 v30, v122, v123
 v_cvt_pk_bf16_f32 v31, v126, v127
 v_mfma_f32_16x16x32_bf16 v[84:87], v[36:39], a[160:163], v[84:87]
 buffer_store_dwordx4 v[28:31], v12, s[20:23], s48 offen offset:1024 sc1
 v_mfma_f32_16x16x32_bf16 v[92:95], v[36:39], a[232:235], v[92:95]
 s_waitcnt lgkmcnt(2)
 v_mfma_f32_16x16x32_bf16 v[64:67], a[20:23], v[40:43], v[64:67]
 ds_read_b128 v[56:59], v7 offset:12288
 v_mfma_f32_16x16x32_bf16 v[72:75], a[92:95], v[40:43], v[72:75]
 ds_read_b128 v[60:63], v7 offset:14336
 v_mfma_f32_16x16x32_bf16 v[80:83], v[40:43], a[164:167], v[80:83]
 s_add_u32 m0, s49, 0
 v_mfma_f32_16x16x32_bf16 v[88:91], v[40:43], a[236:239], v[88:91]
 buffer_load_dwordx4 v10, s[8:11], s46 offen offset:0  lds
 v_mfma_f32_16x16x32_bf16 v[68:71], a[20:23], v[44:47], v[68:71]
 s_add_u32 m0, s49, 3968
 v_mfma_f32_16x16x32_bf16 v[76:79], a[92:95], v[44:47], v[76:79]
 buffer_load_dwordx4 v10, s[8:11], s46 offen offset:128  lds
 v_mfma_f32_16x16x32_bf16 v[84:87], v[44:47], a[164:167], v[84:87]
 v_mfma_f32_16x16x32_bf16 v[92:95], v[44:47], a[236:239], v[92:95]
 s_waitcnt lgkmcnt(2)
 v_mfma_f32_16x16x32_bf16 v[64:67], a[24:27], v[48:51], v[64:67]
 ds_read_b128 v[32:35], v6 offset:16384
 v_mfma_f32_16x16x32_bf16 v[72:75], a[96:99], v[48:51], v[72:75]
 ds_read_b128 v[36:39], v6 offset:18432
 v_mfma_f32_16x16x32_bf16 v[80:83], v[48:51], a[168:171], v[80:83]
 s_add_u32 m0, s49, 7936
 v_mfma_f32_16x16x32_bf16 v[88:91], v[48:51], a[240:243], v[88:91]
 buffer_load_dwordx4 v10, s[8:11], s46 offen offset:256  lds
 v_mfma_f32_16x16x32_bf16 v[68:71], a[24:27], v[52:55], v[68:71]
 s_add_u32 m0, s49, 11904
 v_mfma_f32_16x16x32_bf16 v[76:79], a[96:99], v[52:55], v[76:79]
 buffer_load_dwordx4 v10, s[8:11], s46 offen offset:384  lds
 v_mfma_f32_16x16x32_bf16 v[84:87], v[52:55], a[168:171], v[84:87]
 v_mfma_f32_16x16x32_bf16 v[92:95], v[52:55], a[240:243], v[92:95]
 s_waitcnt lgkmcnt(2)
 v_mfma_f32_16x16x32_bf16 v[64:67], a[28:31], v[56:59], v[64:67]
 ds_read_b128 v[40:43], v7 offset:16384
 v_mfma_f32_16x16x32_bf16 v[72:75], a[100:103], v[56:59], v[72:75]
 ds_read_b128 v[44:47], v7 offset:18432
 v_mfma_f32_16x16x32_bf16 v[80:83], v[56:59], a[172:175], v[80:83]
 s_add_u32 m0, s49, 15872
 v_mfma_f32_16x16x32_bf16 v[88:91], v[56:59], a[244:247], v[88:91]
 buffer_load_dwordx4 v10, s[8:11], s46 offen offset:512  lds
 v_mfma_f32_16x16x32_bf16 v[68:71], a[28:31], v[60:63], v[68:71]
 s_add_u32 m0, s49, 19840
 v_mfma_f32_16x16x32_bf16 v[76:79], a[100:103], v[60:63], v[76:79]
 buffer_load_dwordx4 v10, s[8:11], s46 offen offset:640  lds
 v_mfma_f32_16x16x32_bf16 v[84:87], v[60:63], a[172:175], v[84:87]
 v_mfma_f32_16x16x32_bf16 v[92:95], v[60:63], a[244:247], v[92:95]
 s_waitcnt lgkmcnt(2)
 v_mfma_f32_16x16x32_bf16 v[64:67], a[32:35], v[32:35], v[64:67]
 ds_read_b128 v[48:51], v6 offset:20480
 v_mfma_f32_16x16x32_bf16 v[72:75], a[104:107], v[32:35], v[72:75]
 ds_read_b128 v[52:55], v6 offset:22528
 v_mfma_f32_16x16x32_bf16 v[80:83], v[32:35], a[176:179], v[80:83]
 s_add_u32 m0, s49, 23808
 v_mfma_f32_16x16x32_bf16 v[88:91], v[32:35], a[248:251], v[88:91]
 buffer_load_dwordx4 v10, s[8:11], s46 offen offset:768  lds
 v_mfma_f32_16x16x32_bf16 v[68:71], a[32:35], v[36:39], v[68:71]
 s_add_u32 m0, s49, 27776
 v_mfma_f32_16x16x32_bf16 v[76:79], a[104:107], v[36:39], v[76:79]
 buffer_load_dwordx4 v10, s[8:11], s46 offen offset:896  lds
 v_mfma_f32_16x16x32_bf16 v[84:87], v[36:39], a[176:179], v[84:87]
 v_mfma_f32_16x16x32_bf16 v[92:95], v[36:39], a[248:251], v[92:95]
 s_waitcnt lgkmcnt(2)
 v_mfma_f32_16x16x32_bf16 v[64:67], a[36:39], v[40:43], v[64:67]
 ds_read_b128 v[56:59], v7 offset:20480
 v_mfma_f32_16x16x32_bf16 v[72:75], a[108:111], v[40:43], v[72:75]
 ds_read_b128 v[60:63], v7 offset:22528
 v_mfma_f32_16x16x32_bf16 v[80:83], v[40:43], a[180:183], v[80:83]
 s_add_u32 m0, s49, 31744
 v_mfma_f32_16x16x32_bf16 v[88:91], v[40:43], a[252:255], v[88:91]
 buffer_load_dwordx4 v10, s[8:11], s46 offen offset:1024  lds
 v_mfma_f32_16x16x32_bf16 v[68:71], a[36:39], v[44:47], v[68:71]
 v_add_u32 v2, s46, v1
 v_mfma_f32_16x16x32_bf16 v[76:79], a[108:111], v[44:47], v[76:79]
 buffer_load_dword v15, v2, s[8:11], 0 offen
 v_mfma_f32_16x16x32_bf16 v[84:87], v[44:47], a[180:183], v[84:87]
 v_mfma_f32_16x16x32_bf16 v[92:95], v[44:47], a[252:255], v[92:95]
 s_waitcnt lgkmcnt(2)
 v_mfma_f32_16x16x32_bf16 v[64:67], a[40:43], v[48:51], v[64:67]
 ds_read_b128 v[32:35], v6 offset:24576
 v_mfma_f32_16x16x32_bf16 v[72:75], a[112:115], v[48:51], v[72:75]
 ds_read_b128 v[36:39], v6 offset:26624
 v_mfma_f32_16x16x32_bf16 v[80:83], v[48:51], a[184:187], v[80:83]
 v_mfma_f32_16x16x32_bf16 v[88:91], v[48:51], v[224:227], v[88:91]
 v_mfma_f32_16x16x32_bf16 v[68:71], a[40:43], v[52:55], v[68:71]
 v_mfma_f32_16x16x32_bf16 v[76:79], a[112:115], v[52:55], v[76:79]
 v_mfma_f32_16x16x32_bf16 v[84:87], v[52:55], a[184:187], v[84:87]
 v_mfma_f32_16x16x32_bf16 v[92:95], v[52:55], v[224:227], v[92:95]
 s_waitcnt lgkmcnt(2)
 v_mfma_f32_16x16x32_bf16 v[64:67], a[44:47], v[56:59], v[64:67]
 ds_read_b128 v[40:43], v7 offset:24576
 v_mfma_f32_16x16x32_bf16 v[72:75], a[116:119], v[56:59], v[72:75]
 ds_read_b128 v[44:47], v7 offset:26624
 v_mfma_f32_16x16x32_bf16 v[80:83], v[56:59], a[188:191], v[80:83]
 v_mfma_f32_16x16x32_bf16 v[88:91], v[56:59], v[228:231], v[88:91]
 v_mfma_f32_16x16x32_bf16 v[68:71], a[44:47], v[60:63], v[68:71]
 v_mfma_f32_16x16x32_bf16 v[76:79], a[116:119], v[60:63], v[76:79]
 v_mfma_f32_16x16x32_bf16 v[84:87], v[60:63], a[188:191], v[84:87]
 v_mfma_f32_16x16x32_bf16 v[92:95], v[60:63], v[228:231], v[92:95]
 s_waitcnt lgkmcnt(2)
 v_mfma_f32_16x16x32_bf16 v[64:67], a[48:51], v[32:35], v[64:67]
 ds_read_b128 v[48:51], v6 offset:28672
 v_mfma_f32_16x16x32_bf16 v[72:75], a[120:123], v[32:35], v[72:75]
 ds_read_b128 v[52:55], v6 offset:30720
 v_mfma_f32_16x16x32_bf16 v[80:83], v[32:35], a[192:195], v[80:83]
 v_mfma_f32_16x16x32_bf16 v[88:91], v[32:35], v[232:235], v[88:91]
 v_mfma_f32_16x16x32_bf16 v[68:71], a[48:51], v[36:39], v[68:71]
 v_mfma_f32_16x16x32_bf16 v[76:79], a[120:123], v[36:39], v[76:79]
 v_mfma_f32_16x16x32_bf16 v[84:87], v[36:39], a[192:195], v[84:87]
 v_mfma_f32_16x16x32_bf16 v[92:95], v[36:39], v[232:235], v[92:95]
 s_waitcnt lgkmcnt(2)
 v_mfma_f32_16x16x32_bf16 v[64:67], a[52:55], v[40:43], v[64:67]
 ds_read_b128 v[56:59], v7 offset:28672
 v_mfma_f32_16x16x32_bf16 v[72:75], a[124:127], v[40:43], v[72:75]
 ds_read_b128 v[60:63], v7 offset:30720
 v_mfma_f32_16x16x32_bf16 v[80:83], v[40:43], a[196:199], v[80:83]
 s_add_u32 s43, s43, 36864
 s_cmp_eq_u32 s43, 147456
 v_mfma_f32_16x16x32_bf16 v[88:91], v[40:43], v[236:239], v[88:91]
 s_cselect_b32 s43, 0, s43
 s_add_u32 s44, s44, 36864
 v_mfma_f32_16x16x32_bf16 v[68:71], a[52:55], v[44:47], v[68:71]
 s_cmp_eq_u32 s44, 147456
 s_cselect_b32 s44, 0, s44
 v_mfma_f32_16x16x32_bf16 v[76:79], a[124:127], v[44:47], v[76:79]
 v_mfma_f32_16x16x32_bf16 v[84:87], v[44:47], a[196:199], v[84:87]
 v_mfma_f32_16x16x32_bf16 v[92:95], v[44:47], v[236:239], v[92:95]
 s_waitcnt lgkmcnt(2)
 v_mfma_f32_16x16x32_bf16 v[64:67], a[56:59], v[48:51], v[64:67]
 ds_read_b128 v[32:35], v6 offset:32768
 v_mfma_f32_16x16x32_bf16 v[72:75], a[128:131], v[48:51], v[72:75]
 ds_read_b128 v[36:39], v6 offset:34816
 v_mfma_f32_16x16x32_bf16 v[80:83], v[48:51], a[200:203], v[80:83]
 v_add_u32 v6, s43, v4
 v_mfma_f32_16x16x32_bf16 v[88:91], v[48:51], v[240:243], v[88:91]
 v_mfma_f32_16x16x32_bf16 v[68:71], a[56:59], v[52:55], v[68:71]
 v_mfma_f32_16x16x32_bf16 v[76:79], a[128:131], v[52:55], v[76:79]
 v_mfma_f32_16x16x32_bf16 v[84:87], v[52:55], a[200:203], v[84:87]
 v_mfma_f32_16x16x32_bf16 v[92:95], v[52:55], v[240:243], v[92:95]
 s_waitcnt lgkmcnt(2)
 v_mfma_f32_16x16x32_bf16 v[64:67], a[60:63], v[56:59], v[64:67]
 ds_read_b128 v[40:43], v7 offset:32768
 v_mfma_f32_16x16x32_bf16 v[72:75], a[132:135], v[56:59], v[72:75]
 ds_read_b128 v[44:47], v7 offset:34816
 v_mfma_f32_16x16x32_bf16 v[80:83], v[56:59], a[204:207], v[80:83]
 v_add_u32 v7, s43, v5
 v_mfma_f32_16x16x32_bf16 v[88:91], v[56:59], v[244:247], v[88:91]
 v_mfma_f32_16x16x32_bf16 v[68:71], a[60:63], v[60:63], v[68:71]
 v_mfma_f32_16x16x32_bf16 v[76:79], a[132:135], v[60:63], v[76:79]
 v_mfma_f32_16x16x32_bf16 v[84:87], v[60:63], a[204:207], v[84:87]
 v_mfma_f32_16x16x32_bf16 v[92:95], v[60:63], v[244:247], v[92:95]
 s_waitcnt lgkmcnt(2)
 v_mfma_f32_16x16x32_bf16 v[64:67], a[64:67], v[32:35], v[64:67]
 s_waitcnt vmcnt(10)
 s_barrier
 ds_read_b128 v[48:51], v6 offset:0
 v_mfma_f32_16x16x32_bf16 v[72:75], a[136:139], v[32:35], v[72:75]
 ds_read_b128 v[52:55], v6 offset:2048
 v_mfma_f32_16x16x32_bf16 v[80:83], v[32:35], a[208:211], v[80:83]
 buffer_store_dword v14, v13, s[20:23], 0 offen sc1
 v_mfma_f32_16x16x32_bf16 v[88:91], v[32:35], v[248:251], v[88:91]
 v_mfma_f32_16x16x32_bf16 v[68:71], a[64:67], v[36:39], v[68:71]
 v_mfma_f32_16x16x32_bf16 v[76:79], a[136:139], v[36:39], v[76:79]
 v_mfma_f32_16x16x32_bf16 v[84:87], v[36:39], a[208:211], v[84:87]
 v_mfma_f32_16x16x32_bf16 v[92:95], v[36:39], v[248:251], v[92:95]
 s_waitcnt lgkmcnt(2)
 v_mfma_f32_16x16x32_bf16 v[64:67], a[68:71], v[40:43], v[64:67]
 ds_read_b128 v[56:59], v7 offset:0
 v_mfma_f32_16x16x32_bf16 v[72:75], a[140:143], v[40:43], v[72:75]
 ds_read_b128 v[60:63], v7 offset:2048
 v_mfma_f32_16x16x32_bf16 v[80:83], v[40:43], a[212:215], v[80:83]
 s_mul_i32 s45, s39, 524288
 s_add_u32 s47, s34, s45
 v_mfma_f32_16x16x32_bf16 v[88:91], v[40:43], v[252:255], v[88:91]
 s_add_u32 s48, s35, s45
 v_add_u32 v14, 1, v14
 v_mfma_f32_16x16x32_bf16 v[68:71], a[68:71], v[44:47], v[68:71]
 s_mov_b32 s39, s40
 s_mov_b32 s40, s41
 v_mfma_f32_16x16x32_bf16 v[76:79], a[140:143], v[44:47], v[76:79]
 s_add_u32 s42, s42, 1
 v_mfma_f32_16x16x32_bf16 v[84:87], v[44:47], a[212:215], v[84:87]
 v_mfma_f32_16x16x32_bf16 v[92:95], v[44:47], v[252:255], v[92:95]
 s_waitcnt lgkmcnt(2)
 v_mfma_f32_16x16x32_bf16 v[96:99], a[0:3], v[48:51], 0
 ds_read_b128 v[32:35], v6 offset:4096
 v_mfma_f32_16x16x32_bf16 v[104:107], a[72:75], v[48:51], 0
 ds_read_b128 v[36:39], v6 offset:6144
 v_mfma_f32_16x16x32_bf16 v[112:115], v[48:51], a[144:147], 0
 s_add_u32 s41, s40, 1
 v_mfma_f32_16x16x32_bf16 v[120:123], v[48:51], a[216:219], 0
 s_add_u32 s45, s42, 2
 s_mul_i32 s46, s41, 36864
 v_mfma_f32_16x16x32_bf16 v[100:103], a[0:3], v[52:55], 0
 s_cmp_lt_u32 s45, s36
 s_cselect_b32 s46, s46, 0
 v_mfma_f32_16x16x32_bf16 v[108:111], a[72:75], v[52:55], 0
 s_lshl_b32 s49, s4, 10
 s_add_u32 s49, s49, s44
 v_mfma_f32_16x16x32_bf16 v[116:119], v[52:55], a[144:147], 0
 v_mul_f32 v64, s50, v64
 v_mul_f32 v65, s50, v65
 v_mfma_f32_16x16x32_bf16 v[124:127], v[52:55], a[216:219], 0
 s_waitcnt lgkmcnt(2)
 v_mfma_f32_16x16x32_bf16 v[96:99], a[4:7], v[56:59], v[96:99]
 ds_read_b128 v[40:43], v7 offset:4096
 v_mul_f32 v66, s50, v66
 v_mfma_f32_16x16x32_bf16 v[104:107], a[76:79], v[56:59], v[104:107]
 ds_read_b128 v[44:47], v7 offset:6144
 v_mul_f32 v67, s50, v67
 v_mfma_f32_16x16x32_bf16 v[112:115], v[56:59], a[148:151], v[112:115]
 v_mul_f32 v72, s50, v72
 v_mfma_f32_16x16x32_bf16 v[120:123], v[56:59], a[220:223], v[120:123]
 v_mul_f32 v73, s50, v73
 v_mfma_f32_16x16x32_bf16 v[100:103], a[4:7], v[60:63], v[100:103]
 v_mul_f32 v74, s50, v74
 v_mul_f32 v75, s50, v75
 v_mfma_f32_16x16x32_bf16 v[108:111], a[76:79], v[60:63], v[108:111]
 v_cvt_pk_bf16_f32 v16, v64, v72
 v_mfma_f32_16x16x32_bf16 v[116:119], v[60:63], a[148:151], v[116:119]
 v_cvt_pk_bf16_f32 v17, v65, v73
 v_mfma_f32_16x16x32_bf16 v[124:127], v[60:63], a[220:223], v[124:127]
 s_waitcnt lgkmcnt(2)
 v_cvt_pk_bf16_f32 v18, v66, v74
 v_mfma_f32_16x16x32_bf16 v[96:99], a[8:11], v[32:35], v[96:99]
 ds_read_b128 v[48:51], v6 offset:8192
 v_cvt_pk_bf16_f32 v19, v67, v75
 v_mfma_f32_16x16x32_bf16 v[104:107], a[80:83], v[32:35], v[104:107]
 ds_read_b128 v[52:55], v6 offset:10240
 v_mfma_f32_16x16x32_bf16 v[112:115], v[32:35], a[152:155], v[112:115]
 buffer_store_dwordx4 v[16:19], v12, s[20:23], s47 offen offset:0 sc1
 v_mul_f32 v68, s50, v68
 v_mfma_f32_16x16x32_bf16 v[120:123], v[32:35], a[224:227], v[120:123]
 v_mul_f32 v69, s50, v69
 v_mfma_f32_16x16x32_bf16 v[100:103], a[8:11], v[36:39], v[100:103]
 v_mul_f32 v70, s50, v70
 v_mfma_f32_16x16x32_bf16 v[108:111], a[80:83], v[36:39], v[108:111]
 v_mul_f32 v71, s50, v71
 v_mul_f32 v76, s50, v76
 v_mfma_f32_16x16x32_bf16 v[116:119], v[36:39], a[152:155], v[116:119]
 v_mul_f32 v77, s50, v77
 v_mfma_f32_16x16x32_bf16 v[124:127], v[36:39], a[224:227], v[124:127]
 s_waitcnt lgkmcnt(2)
 v_mfma_f32_16x16x32_bf16 v[96:99], a[12:15], v[40:43], v[96:99]
 ds_read_b128 v[56:59], v7 offset:8192
 v_mul_f32 v78, s50, v78
 v_mfma_f32_16x16x32_bf16 v[104:107], a[84:87], v[40:43], v[104:107]
 ds_read_b128 v[60:63], v7 offset:10240
 v_mul_f32 v79, s50, v79
 v_mfma_f32_16x16x32_bf16 v[112:115], v[40:43], a[156:159], v[112:115]
 v_cvt_pk_bf16_f32 v20, v68, v76
 v_mfma_f32_16x16x32_bf16 v[120:123], v[40:43], a[228:231], v[120:123]
 v_cvt_pk_bf16_f32 v21, v69, v77
 v_mfma_f32_16x16x32_bf16 v[100:103], a[12:15], v[44:47], v[100:103]
 v_cvt_pk_bf16_f32 v22, v70, v78
 v_cvt_pk_bf16_f32 v23, v71, v79
 v_mfma_f32_16x16x32_bf16 v[108:111], a[84:87], v[44:47], v[108:111]
 buffer_store_dwordx4 v[20:23], v12, s[20:23], s47 offen offset:1024 sc1
 v_mfma_f32_16x16x32_bf16 v[116:119], v[44:47], a[156:159], v[116:119]
 v_cvt_pk_bf16_f32 v24, v80, v81
 v_mfma_f32_16x16x32_bf16 v[124:127], v[44:47], a[228:231], v[124:127]
 s_waitcnt lgkmcnt(2)
 v_cvt_pk_bf16_f32 v25, v84, v85
 v_mfma_f32_16x16x32_bf16 v[96:99], a[16:19], v[48:51], v[96:99]
 ds_read_b128 v[32:35], v6 offset:12288
 v_cvt_pk_bf16_f32 v26, v82, v83
 v_mfma_f32_16x16x32_bf16 v[104:107], a[88:91], v[48:51], v[104:107]
 ds_read_b128 v[36:39], v6 offset:14336
 v_mfma_f32_16x16x32_bf16 v[112:115], v[48:51], a[160:163], v[112:115]
 v_cvt_pk_bf16_f32 v27, v86, v87
 buffer_store_dwordx4 v[24:27], v12, s[20:23], s48 offen offset:0 sc1
 v_mfma_f32_16x16x32_bf16 v[120:123], v[48:51], a[232:235], v[120:123]
 v_cvt_pk_bf16_f32 v28, v88, v89
 v_mfma_f32_16x16x32_bf16 v[100:103], a[16:19], v[52:55], v[100:103]
 v_cvt_pk_bf16_f32 v29, v92, v93
 v_mfma_f32_16x16x32_bf16 v[108:111], a[88:91], v[52:55], v[108:111]
 v_cvt_pk_bf16_f32 v30, v90, v91
 v_cvt_pk_bf16_f32 v31, v94, v95
 v_mfma_f32_16x16x32_bf16 v[116:119], v[52:55], a[160:163], v[116:119]
 buffer_store_dwordx4 v[28:31], v12, s[20:23], s48 offen offset:1024 sc1
 v_mfma_f32_16x16x32_bf16 v[124:127], v[52:55], a[232:235], v[124:127]
 s_waitcnt lgkmcnt(2)
 v_mfma_f32_16x16x32_bf16 v[96:99], a[20:23], v[56:59], v[96:99]
 ds_read_b128 v[40:43], v7 offset:12288
 v_mfma_f32_16x16x32_bf16 v[104:107], a[92:95], v[56:59], v[104:107]
 ds_read_b128 v[44:47], v7 offset:14336
 v_mfma_f32_16x16x32_bf16 v[112:115], v[56:59], a[164:167], v[112:115]
 s_add_u32 m0, s49, 0
 v_mfma_f32_16x16x32_bf16 v[120:123], v[56:59], a[236:239], v[120:123]
 buffer_load_dwordx4 v10, s[8:11], s46 offen offset:0  lds
 v_mfma_f32_16x16x32_bf16 v[100:103], a[20:23], v[60:63], v[100:103]
 s_add_u32 m0, s49, 3968
 v_mfma_f32_16x16x32_bf16 v[108:111], a[92:95], v[60:63], v[108:111]
 buffer_load_dwordx4 v10, s[8:11], s46 offen offset:128  lds
 v_mfma_f32_16x16x32_bf16 v[116:119], v[60:63], a[164:167], v[116:119]
 v_mfma_f32_16x16x32_bf16 v[124:127], v[60:63], a[236:239], v[124:127]
 s_waitcnt lgkmcnt(2)
 v_mfma_f32_16x16x32_bf16 v[96:99], a[24:27], v[32:35], v[96:99]
 ds_read_b128 v[48:51], v6 offset:16384
 v_mfma_f32_16x16x32_bf16 v[104:107], a[96:99], v[32:35], v[104:107]
 ds_read_b128 v[52:55], v6 offset:18432
 v_mfma_f32_16x16x32_bf16 v[112:115], v[32:35], a[168:171], v[112:115]
 s_add_u32 m0, s49, 7936
 v_mfma_f32_16x16x32_bf16 v[120:123], v[32:35], a[240:243], v[120:123]
 buffer_load_dwordx4 v10, s[8:11], s46 offen offset:256  lds
 v_mfma_f32_16x16x32_bf16 v[100:103], a[24:27], v[36:39], v[100:103]
 s_add_u32 m0, s49, 11904
 v_mfma_f32_16x16x32_bf16 v[108:111], a[96:99], v[36:39], v[108:111]
 buffer_load_dwordx4 v10, s[8:11], s46 offen offset:384  lds
 v_mfma_f32_16x16x32_bf16 v[116:119], v[36:39], a[168:171], v[116:119]
 v_mfma_f32_16x16x32_bf16 v[124:127], v[36:39], a[240:243], v[124:127]
 s_waitcnt lgkmcnt(2)
 v_mfma_f32_16x16x32_bf16 v[96:99], a[28:31], v[40:43], v[96:99]
 ds_read_b128 v[56:59], v7 offset:16384
 v_mfma_f32_16x16x32_bf16 v[104:107], a[100:103], v[40:43], v[104:107]
 ds_read_b128 v[60:63], v7 offset:18432
 v_mfma_f32_16x16x32_bf16 v[112:115], v[40:43], a[172:175], v[112:115]
 s_add_u32 m0, s49, 15872
 v_mfma_f32_16x16x32_bf16 v[120:123], v[40:43], a[244:247], v[120:123]
 buffer_load_dwordx4 v10, s[8:11], s46 offen offset:512  lds
 v_mfma_f32_16x16x32_bf16 v[100:103], a[28:31], v[44:47], v[100:103]
 s_add_u32 m0, s49, 19840
 v_mfma_f32_16x16x32_bf16 v[108:111], a[100:103], v[44:47], v[108:111]
 buffer_load_dwordx4 v10, s[8:11], s46 offen offset:640  lds
 v_mfma_f32_16x16x32_bf16 v[116:119], v[44:47], a[172:175], v[116:119]
 v_mfma_f32_16x16x32_bf16 v[124:127], v[44:47], a[244:247], v[124:127]
 s_waitcnt lgkmcnt(2)
 v_mfma_f32_16x16x32_bf16 v[96:99], a[32:35], v[48:51], v[96:99]
 ds_read_b128 v[32:35], v6 offset:20480
 v_mfma_f32_16x16x32_bf16 v[104:107], a[104:107], v[48:51], v[104:107]
 ds_read_b128 v[36:39], v6 offset:22528
 v_mfma_f32_16x16x32_bf16 v[112:115], v[48:51], a[176:179], v[112:115]
 s_add_u32 m0, s49, 23808
 v_mfma_f32_16x16x32_bf16 v[120:123], v[48:51], a[248:251], v[120:123]
 buffer_load_dwordx4 v10, s[8:11], s46 offen offset:768  lds
 v_mfma_f32_16x16x32_bf16 v[100:103], a[32:35], v[52:55], v[100:103]
 s_add_u32 m0, s49, 27776
 v_mfma_f32_16x16x32_bf16 v[108:111], a[104:107], v[52:55], v[108:111]
 buffer_load_dwordx4 v10, s[8:11], s46 offen offset:896  lds
 v_mfma_f32_16x16x32_bf16 v[116:119], v[52:55], a[176:179], v[116:119]
 v_mfma_f32_16x16x32_bf16 v[124:127], v[52:55], a[248:251], v[124:127]
 s_waitcnt lgkmcnt(2)
 v_mfma_f32_16x16x32_bf16 v[96:99], a[36:39], v[56:59], v[96:99]
 ds_read_b128 v[40:43], v7 offset:20480
 v_mfma_f32_16x16x32_bf16 v[104:107], a[108:111], v[56:59], v[104:107]
 ds_read_b128 v[44:47], v7 offset:22528
 v_mfma_f32_16x16x32_bf16 v[112:115], v[56:59], a[180:183], v[112:115]
 s_add_u32 m0, s49, 31744
 v_mfma_f32_16x16x32_bf16 v[120:123], v[56:59], a[252:255], v[120:123]
 buffer_load_dwordx4 v10, s[8:11], s46 offen offset:1024  lds
 v_mfma_f32_16x16x32_bf16 v[100:103], a[36:39], v[60:63], v[100:103]
 v_add_u32 v2, s46, v1
 v_mfma_f32_16x16x32_bf16 v[108:111], a[108:111], v[60:63], v[108:111]
 buffer_load_dword v15, v2, s[8:11], 0 offen
 v_mfma_f32_16x16x32_bf16 v[116:119], v[60:63], a[180:183], v[116:119]
 v_mfma_f32_16x16x32_bf16 v[124:127], v[60:63], a[252:255], v[124:127]
 s_waitcnt lgkmcnt(2)
 v_mfma_f32_16x16x32_bf16 v[96:99], a[40:43], v[32:35], v[96:99]
 ds_read_b128 v[48:51], v6 offset:24576
 v_mfma_f32_16x16x32_bf16 v[104:107], a[112:115], v[32:35], v[104:107]
 ds_read_b128 v[52:55], v6 offset:26624
 v_mfma_f32_16x16x32_bf16 v[112:115], v[32:35], a[184:187], v[112:115]
 v_mfma_f32_16x16x32_bf16 v[120:123], v[32:35], v[224:227], v[120:123]
 v_mfma_f32_16x16x32_bf16 v[100:103], a[40:43], v[36:39], v[100:103]
 v_mfma_f32_16x16x32_bf16 v[108:111], a[112:115], v[36:39], v[108:111]
 v_mfma_f32_16x16x32_bf16 v[116:119], v[36:39], a[184:187], v[116:119]
 v_mfma_f32_16x16x32_bf16 v[124:127], v[36:39], v[224:227], v[124:127]
 s_waitcnt lgkmcnt(2)
 v_mfma_f32_16x16x32_bf16 v[96:99], a[44:47], v[40:43], v[96:99]
 ds_read_b128 v[56:59], v7 offset:24576
 v_mfma_f32_16x16x32_bf16 v[104:107], a[116:119], v[40:43], v[104:107]
 ds_read_b128 v[60:63], v7 offset:26624
 v_mfma_f32_16x16x32_bf16 v[112:115], v[40:43], a[188:191], v[112:115]
 v_mfma_f32_16x16x32_bf16 v[120:123], v[40:43], v[228:231], v[120:123]
 v_mfma_f32_16x16x32_bf16 v[100:103], a[44:47], v[44:47], v[100:103]
 v_mfma_f32_16x16x32_bf16 v[108:111], a[116:119], v[44:47], v[108:111]
 v_mfma_f32_16x16x32_bf16 v[116:119], v[44:47], a[188:191], v[116:119]
 v_mfma_f32_16x16x32_bf16 v[124:127], v[44:47], v[228:231], v[124:127]
 s_waitcnt lgkmcnt(2)
 v_mfma_f32_16x16x32_bf16 v[96:99], a[48:51], v[48:51], v[96:99]
 ds_read_b128 v[32:35], v6 offset:28672
 v_mfma_f32_16x16x32_bf16 v[104:107], a[120:123], v[48:51], v[104:107]
 ds_read_b128 v[36:39], v6 offset:30720
 v_mfma_f32_16x16x32_bf16 v[112:115], v[48:51], a[192:195], v[112:115]
 v_mfma_f32_16x16x32_bf16 v[120:123], v[48:51], v[232:235], v[120:123]
 v_mfma_f32_16x16x32_bf16 v[100:103], a[48:51], v[52:55], v[100:103]
 v_mfma_f32_16x16x32_bf16 v[108:111], a[120:123], v[52:55], v[108:111]
 v_mfma_f32_16x16x32_bf16 v[116:119], v[52:55], a[192:195], v[116:119]
 v_mfma_f32_16x16x32_bf16 v[124:127], v[52:55], v[232:235], v[124:127]
 s_waitcnt lgkmcnt(2)
 v_mfma_f32_16x16x32_bf16 v[96:99], a[52:55], v[56:59], v[96:99]
 ds_read_b128 v[40:43], v7 offset:28672
 v_mfma_f32_16x16x32_bf16 v[104:107], a[124:127], v[56:59], v[104:107]
 ds_read_b128 v[44:47], v7 offset:30720
 v_mfma_f32_16x16x32_bf16 v[112:115], v[56:59], a[196:199], v[112:115]
 s_add_u32 s43, s43, 36864
 s_cmp_eq_u32 s43, 147456
 v_mfma_f32_16x16x32_bf16 v[120:123], v[56:59], v[236:239], v[120:123]
 s_cselect_b32 s43, 0, s43
 s_add_u32 s44, s44, 36864
 v_mfma_f32_16x16x32_bf16 v[100:103], a[52:55], v[60:63], v[100:103]
 s_cmp_eq_u32 s44, 147456
 s_cselect_b32 s44, 0, s44
 v_mfma_f32_16x16x32_bf16 v[108:111], a[124:127], v[60:63], v[108:111]
 v_mfma_f32_16x16x32_bf16 v[116:119], v[60:63], a[196:199], v[116:119]
 v_mfma_f32_16x16x32_bf16 v[124:127], v[60:63], v[236:239], v[124:127]
 s_waitcnt lgkmcnt(2)
 v_mfma_f32_16x16x32_bf16 v[96:99], a[56:59], v[32:35], v[96:99]
 ds_read_b128 v[48:51], v6 offset:32768
 v_mfma_f32_16x16x32_bf16 v[104:107], a[128:131], v[32:35], v[104:107]
 ds_read_b128 v[52:55], v6 offset:34816
 v_mfma_f32_16x16x32_bf16 v[112:115], v[32:35], a[200:203], v[112:115]
 v_add_u32 v6, s43, v4
 v_mfma_f32_16x16x32_bf16 v[120:123], v[32:35], v[240:243], v[120:123]
 v_mfma_f32_16x16x32_bf16 v[100:103], a[56:59], v[36:39], v[100:103]
 v_mfma_f32_16x16x32_bf16 v[108:111], a[128:131], v[36:39], v[108:111]
 v_mfma_f32_16x16x32_bf16 v[116:119], v[36:39], a[200:203], v[116:119]
 v_mfma_f32_16x16x32_bf16 v[124:127], v[36:39], v[240:243], v[124:127]
 s_waitcnt lgkmcnt(2)
 v_mfma_f32_16x16x32_bf16 v[96:99], a[60:63], v[40:43], v[96:99]
 ds_read_b128 v[56:59], v7 offset:32768
 v_mfma_f32_16x16x32_bf16 v[104:107], a[132:135], v[40:43], v[104:107]
 ds_read_b128 v[60:63], v7 offset:34816
 v_mfma_f32_16x16x32_bf16 v[112:115], v[40:43], a[204:207], v[112:115]
 v_add_u32 v7, s43, v5
 v_mfma_f32_16x16x32_bf16 v[120:123], v[40:43], v[244:247], v[120:123]
 v_mfma_f32_16x16x32_bf16 v[100:103], a[60:63], v[44:47], v[100:103]
 v_mfma_f32_16x16x32_bf16 v[108:111], a[132:135], v[44:47], v[108:111]
 v_mfma_f32_16x16x32_bf16 v[116:119], v[44:47], a[204:207], v[116:119]
 v_mfma_f32_16x16x32_bf16 v[124:127], v[44:47], v[244:247], v[124:127]
 s_waitcnt lgkmcnt(2)
 v_mfma_f32_16x16x32_bf16 v[96:99], a[64:67], v[48:51], v[96:99]
 s_waitcnt vmcnt(10)
 s_barrier
 ds_read_b128 v[32:35], v6 offset:0
 v_mfma_f32_16x16x32_bf16 v[104:107], a[136:139], v[48:51], v[104:107]
 ds_read_b128 v[36:39], v6 offset:2048
 v_mfma_f32_16x16x32_bf16 v[112:115], v[48:51], a[208:211], v[112:115]
 buffer_store_dword v14, v13, s[20:23], 0 offen sc1
 v_mfma_f32_16x16x32_bf16 v[120:123], v[48:51], v[248:251], v[120:123]
 v_mfma_f32_16x16x32_bf16 v[100:103], a[64:67], v[52:55], v[100:103]
 v_mfma_f32_16x16x32_bf16 v[108:111], a[136:139], v[52:55], v[108:111]
 v_mfma_f32_16x16x32_bf16 v[116:119], v[52:55], a[208:211], v[116:119]
 v_mfma_f32_16x16x32_bf16 v[124:127], v[52:55], v[248:251], v[124:127]
 s_waitcnt lgkmcnt(2)
 v_mfma_f32_16x16x32_bf16 v[96:99], a[68:71], v[56:59], v[96:99]
 ds_read_b128 v[40:43], v7 offset:0
 v_mfma_f32_16x16x32_bf16 v[104:107], a[140:143], v[56:59], v[104:107]
 ds_read_b128 v[44:47], v7 offset:2048
 v_mfma_f32_16x16x32_bf16 v[112:115], v[56:59], a[212:215], v[112:115]
 s_mul_i32 s45, s39, 524288
 s_add_u32 s47, s34, s45
 v_mfma_f32_16x16x32_bf16 v[120:123], v[56:59], v[252:255], v[120:123]
 s_add_u32 s48, s35, s45
 v_add_u32 v14, 1, v14
 v_mfma_f32_16x16x32_bf16 v[100:103], a[68:71], v[60:63], v[100:103]
 s_mov_b32 s39, s40
 s_mov_b32 s40, s41
 v_mfma_f32_16x16x32_bf16 v[108:111], a[140:143], v[60:63], v[108:111]
 s_add_u32 s42, s42, 1
 s_cmp_lt_u32 s42, s36
 v_mfma_f32_16x16x32_bf16 v[116:119], v[60:63], a[212:215], v[116:119]
 v_mfma_f32_16x16x32_bf16 v[124:127], v[60:63], v[252:255], v[124:127]
 s_waitcnt lgkmcnt(2)
 s_cbranch_scc1 Lps_loop_28
 s_nop 7
 v_mul_f32 v96, s50, v96
 v_mul_f32 v97, s50, v97
 v_mul_f32 v98, s50, v98
 v_mul_f32 v99, s50, v99
 v_mul_f32 v104, s50, v104
 v_mul_f32 v105, s50, v105
 v_mul_f32 v106, s50, v106
 v_mul_f32 v107, s50, v107
 v_cvt_pk_bf16_f32 v16, v96, v104
 v_cvt_pk_bf16_f32 v17, v97, v105
 v_cvt_pk_bf16_f32 v18, v98, v106
 v_cvt_pk_bf16_f32 v19, v99, v107
 buffer_store_dwordx4 v[16:19], v12, s[20:23], s47 offen offset:0 sc1
 v_mul_f32 v100, s50, v100
 v_mul_f32 v101, s50, v101
 v_mul_f32 v102, s50, v102
 v_mul_f32 v103, s50, v103
 v_mul_f32 v108, s50, v108
 v_mul_f32 v109, s50, v109
 v_mul_f32 v110, s50, v110
 v_mul_f32 v111, s50, v111
 v_cvt_pk_bf16_f32 v20, v100, v108
 v_cvt_pk_bf16_f32 v21, v101, v109
 v_cvt_pk_bf16_f32 v22, v102, v110
 v_cvt_pk_bf16_f32 v23, v103, v111
 buffer_store_dwordx4 v[20:23], v12, s[20:23], s47 offen offset:1024 sc1
 v_cvt_pk_bf16_f32 v24, v112, v113
 v_cvt_pk_bf16_f32 v25, v116, v117
 v_cvt_pk_bf16_f32 v26, v114, v115
 v_cvt_pk_bf16_f32 v27, v118, v119
 buffer_store_dwordx4 v[24:27], v12, s[20:23], s48 offen offset:0 sc1
 v_cvt_pk_bf16_f32 v28, v120, v121
 v_cvt_pk_bf16_f32 v29, v124, v125
 v_cvt_pk_bf16_f32 v30, v122, v123
 v_cvt_pk_bf16_f32 v31, v126, v127
 buffer_store_dwordx4 v[28:31], v12, s[20:23], s48 offen offset:1024 sc1
 s_waitcnt vmcnt(0) lgkmcnt(0)
 s_barrier
 v_mov_b32 v14, s36
 buffer_store_dword v14, v13, s[20:23], 0 offen sc1
 s_cmp_ge_u32 s6, 25
 s_cbranch_scc1 Lfin
 s_mov_b32 s3, 2
 s_branch Lqb
Lqa:
 s_load_dwordx2 s[8:9], s[0:1], 0
 s_mov_b32 s10, 0x240000
 s_mov_b32 s11, 0x20000
 s_load_dwordx2 s[12:13], s[0:1], 16
 s_mov_b32 s14, 0x480000
 s_mov_b32 s15, 0x20000
 s_load_dwordx2 s[16:17], s[0:1], 16
 s_mov_b32 s18, 0x480000
 s_mov_b32 s19, 0x20000
 s_lshl_b32 s7, s5, 5
 s_add_u32 s7, s7, s6
 s_cmp_eq_u32 s7, 127
 s_cbranch_scc0 Lqa1
Lrh_29:
 v_mbcnt_lo_u32_b32 v5, -1, 0
 v_min_u32 v5, 1, v5
 v_lshlrev_b32 v5, 28, v5
 buffer_load_dword v4, v5, s[28:31], 0 offen offset:4 sc1
 s_waitcnt vmcnt(0)
Lrhc_30:
 v_readfirstlane_b32 s89, v4
 s_cmp_eq_u32 s89, s88
 s_cbranch_scc1 Lrhk_31
 s_cmp_lg_u32 s89, 0
 s_cbranch_scc1 Lredo
 s_sub_u32 s95, s95, 1
 s_cbranch_scc0 Lrh_29
 s_endpgm
Lrhk_31:
 v_mov_b32 v4, 0
 v_mov_b32 v5, 0
 v_mov_b32 v6, 0
 v_mov_b32 v7, 0
 v_lshlrev_b32 v1, 4, v0
 s_mov_b32 s7, 0
 buffer_store_dwordx4 v[4:7], v1, s[20:23], s7 offen sc1
 s_mov_b32 s7, 4096
 buffer_store_dwordx4 v[4:7], v1, s[20:23], s7 offen sc1
 s_mov_b32 s7, 8192
 buffer_store_dwordx4 v[4:7], v1, s[20:23], s7 offen sc1
 s_mov_b32 s7, 12288
 buffer_store_dwordx4 v[4:7], v1, s[20:23], s7 offen sc1
 s_mov_b32 s7, 16384
 buffer_store_dwordx4 v[4:7], v1, s[20:23], s7 offen sc1
 v_min_u32 v1, 1, v0
 v_lshlrev_b32 v1, 28, v1
 v_mov_b32 v2, 1
 s_waitcnt vmcnt(0)
 s_barrier
 buffer_store_dword v2, v1, s[28:31], 0 offen sc1
Lqa1:
 s_sub_u32 s3, s5, 2
 s_lshl_b32 s3, s3, 3
 s_lshr_b32 s7, s6, 2
 s_add_u32 s3, s3, s7
 s_lshl_b32 s32, s3, 9
 s_add_u32 s33, s32, 256
 s_lshl_b32 s34, s3, 14
 s_add_u32 s34, s34, 0x5000000
 s_add_u32 s35, s34, 8192
 s_mov_b32 s36, 16
 s_and_b32 s37, s6, 3
 s_lshl_b32 s7, s3, 5
 s_add_u32 s7, s7, s37
 s_lshl_b32 s7, s7, 2
 s_add_u32 s7, s7, 0x3000
 v_min_u32 v1, 1, v0
 v_lshlrev_b32 v1, 28, v1
 v_add_u32 v13, s7, v1
 s_waitcnt lgkmcnt(0)
 v_and_b32 v1, 63, v0
 v_lshrrev_b32 v2, 3, v0
 v_mul_u32_u24 v10, 1152, v2
 v_lshrrev_b32 v2, 4, v0
 v_xor_b32 v2, v2, v0
 v_and_b32 v2, 7, v2
 v_lshl_add_u32 v10, v2, 4, v10
 v_lshrrev_b32 v2, 4, v1
 v_bfe_u32 v3, v1, 1, 3
 v_xor_b32 v2, v2, v3
 v_and_b32 v3, 15, v1
 v_lshlrev_b32 v3, 7, v3
 v_lshl_add_u32 v4, v2, 4, v3
 v_xor_b32 v5, 64, v4
 v_lshrrev_b32 v2, 4, v0
 v_lshlrev_b32 v11, 13, v2
 v_lshrrev_b32 v2, 7, v0
 v_lshrrev_b32 v3, 4, v1
 v_lshl_add_u32 v3, v2, 2, v3
 v_bfe_u32 v2, v1, 1, 3
 v_xor_b32 v2, v2, v3
 v_lshl_add_u32 v11, v2, 5, v11
 v_and_b32 v2, 1, v1
 v_lshl_add_u32 v11, v2, 4, v11
 v_bfe_u32 v2, v1, 2, 3
 v_xor_b32 v3, s4, v2
 v_lshlrev_b32 v3, 5, v3
 v_and_b32 v2, 3, v2
 v_lshl_add_u32 v3, v2, 8, v3
 v_lshrrev_b32 v2, 4, v1
 v_lshl_add_u32 v3, v2, 11, v3
 v_and_b32 v2, 3, v1
 v_lshl_add_u32 v3, v2, 3, v3
 v_add_u32 v8, 73728, v3
 v_xor_b32 v3, 0x80, v3
 v_add_u32 v9, 73728, v3
 s_lshl_b32 s45, s4, 11
 v_lshl_add_u32 v12, v1, 4, s45
 s_mov_b32 s39, s37
 s_add_u32 s40, s39, 4
 s_min_u32 s40, s40, 63
 s_lshl_b32 s49, s4, 10
 s_mul_i32 s46, s39, 36864
 s_add_u32 m0, s49, 0
 s_nop 0
 buffer_load_dwordx4 v10, s[8:11], s46 offen offset:0  lds
 s_add_u32 m0, s49, 3968
 s_nop 0
 buffer_load_dwordx4 v10, s[8:11], s46 offen offset:128  lds
 s_add_u32 m0, s49, 7936
 s_nop 0
 buffer_load_dwordx4 v10, s[8:11], s46 offen offset:256  lds
 s_add_u32 m0, s49, 11904
 s_nop 0
 buffer_load_dwordx4 v10, s[8:11], s46 offen offset:384  lds
 s_add_u32 m0, s49, 15872
 s_nop 0
 buffer_load_dwordx4 v10, s[8:11], s46 offen offset:512  lds
 s_add_u32 m0, s49, 19840
 s_nop 0
 buffer_load_dwordx4 v10, s[8:11], s46 offen offset:640  lds
 s_add_u32 m0, s49, 23808
 s_nop 0
 buffer_load_dwordx4 v10, s[8:11], s46 offen offset:768  lds
 s_add_u32 m0, s49, 27776
 s_nop 0
 buffer_load_dwordx4 v10, s[8:11], s46 offen offset:896  lds
 s_add_u32 m0, s49, 31744
 s_nop 0
 buffer_load_dwordx4 v10, s[8:11], s46 offen offset:1024  lds
 s_lshl_b32 s49, s4, 10
 s_add_u32 s49, s49, 36864
 s_mul_i32 s46, s40, 36864
 s_add_u32 m0, s49, 0
 s_nop 0
 buffer_load_dwordx4 v10, s[8:11], s46 offen offset:0  lds
 s_add_u32 m0, s49, 3968
 s_nop 0
 buffer_load_dwordx4 v10, s[8:11], s46 offen offset:128  lds
 s_add_u32 m0, s49, 7936
 s_nop 0
 buffer_load_dwordx4 v10, s[8:11], s46 offen offset:256  lds
 s_add_u32 m0, s49, 11904
 s_nop 0
 buffer_load_dwordx4 v10, s[8:11], s46 offen offset:384  lds
 s_add_u32 m0, s49, 15872
 s_nop 0
 buffer_load_dwordx4 v10, s[8:11], s46 offen offset:512  lds
 s_add_u32 m0, s49, 19840
 s_nop 0
 buffer_load_dwordx4 v10, s[8:11], s46 offen offset:640  lds
 s_add_u32 m0, s49, 23808
 s_nop 0
 buffer_load_dwordx4 v10, s[8:11], s46 offen offset:768  lds
 s_add_u32 m0, s49, 27776
 s_nop 0
 buffer_load_dwordx4 v10, s[8:11], s46 offen offset:896  lds
 s_add_u32 m0, s49, 31744
 s_nop 0
 buffer_load_dwordx4 v10, s[8:11], s46 offen offset:1024  lds
 s_lshl_b32 s49, s4, 10
 s_add_u32 m0, s49, 73728
 s_add_u32 s45, s32, 0
 buffer_load_dwordx4 v11, s[12:15], s45 offen  lds
 s_add_u32 m0, s49, 77824
 s_add_u32 s45, s32, 131072
 buffer_load_dwordx4 v11, s[12:15], s45 offen  lds
 s_add_u32 m0, s49, 81920
 s_add_u32 s45, s33, 0
 buffer_load_dwordx4 v11, s[16:19], s45 offen  lds
 s_add_u32 m0, s49, 86016
 s_add_u32 s45, s33, 131072
 buffer_load_dwordx4 v11, s[16:19], s45 offen  lds
 s_add_u32 m0, s49, 90112
 s_add_u32 s45, s32, 262144
 buffer_load_dwordx4 v11, s[12:15], s45 offen  lds
 s_add_u32 m0, s49, 94208
 s_add_u32 s45, s32, 393216
 buffer_load_dwordx4 v11, s[12:15], s45 offen  lds
 s_add_u32 m0, s49, 98304
 s_add_u32 s45, s33, 262144
 buffer_load_dwordx4 v11, s[16:19], s45 offen  lds
 s_add_u32 m0, s49, 102400
 s_add_u32 s45, s33, 393216
 buffer_load_dwordx4 v11, s[16:19], s45 offen  lds
 s_add_u32 m0, s49, 106496
 s_add_u32 s45, s32, 524288
 buffer_load_dwordx4 v11, s[12:15], s45 offen  lds
 s_add_u32 m0, s49, 110592
 s_add_u32 s45, s32, 655360
 buffer_load_dwordx4 v11, s[12:15], s45 offen  lds
 s_add_u32 m0, s49, 114688
 s_add_u32 s45, s33, 524288
 buffer_load_dwordx4 v11, s[16:19], s45 offen  lds
 s_add_u32 m0, s49, 118784
 s_add_u32 s45, s33, 655360
 buffer_load_dwordx4 v11, s[16:19], s45 offen  lds
 s_waitcnt vmcnt(8) lgkmcnt(0)
 s_barrier
 s_add_u32 m0, s49, 122880
 s_add_u32 s45, s32, 786432
 buffer_load_dwordx4 v11, s[12:15], s45 offen  lds
 s_add_u32 m0, s49, 126976
 s_add_u32 s45, s32, 917504
 buffer_load_dwordx4 v11, s[12:15], s45 offen  lds
 s_add_u32 m0, s49, 131072
 s_add_u32 s45, s33, 786432
 buffer_load_dwordx4 v11, s[16:19], s45 offen  lds
 s_add_u32 m0, s49, 135168
 s_add_u32 s45, s33, 917504
 buffer_load_dwordx4 v11, s[16:19], s45 offen  lds
 ds_read_b64_tr_b16 a[0:1], v8 offset:0
 ds_read_b64_tr_b16 a[2:3], v8 offset:1024
 ds_read_b64_tr_b16 a[72:73], v9 offset:0
 ds_read_b64_tr_b16 a[74:75], v9 offset:1024
 ds_read_b64_tr_b16 a[144:145], v8 offset:8192
 ds_read_b64_tr_b16 a[146:147], v8 offset:9216
 ds_read_b64_tr_b16 a[216:217], v9 offset:8192
 ds_read_b64_tr_b16 a[218:219], v9 offset:9216
 s_waitcnt vmcnt(8) lgkmcnt(0)
 s_barrier
 s_add_u32 m0, s49, 73728
 s_add_u32 s45, s32, 1048576
 buffer_load_dwordx4 v11, s[12:15], s45 offen  lds
 s_add_u32 m0, s49, 77824
 s_add_u32 s45, s32, 1179648
 buffer_load_dwordx4 v11, s[12:15], s45 offen  lds
 s_add_u32 m0, s49, 81920
 s_add_u32 s45, s33, 1048576
 buffer_load_dwordx4 v11, s[16:19], s45 offen  lds
 s_add_u32 m0, s49, 86016
 s_add_u32 s45, s33, 1179648
 buffer_load_dwordx4 v11, s[16:19], s45 offen  lds
 ds_read_b64_tr_b16 a[4:5], v8 offset:16384
 ds_read_b64_tr_b16 a[6:7], v8 offset:17408
 ds_read_b64_tr_b16 a[76:77], v9 offset:16384
 ds_read_b64_tr_b16 a[78:79], v9 offset:17408
 ds_read_b64_tr_b16 a[148:149], v8 offset:24576
 ds_read_b64_tr_b16 a[150:151], v8 offset:25600
 ds_read_b64_tr_b16 a[220:221], v9 offset:24576
 ds_read_b64_tr_b16 a[222:223], v9 offset:25600
 s_waitcnt vmcnt(8) lgkmcnt(0)
 s_barrier
 s_add_u32 m0, s49, 90112
 s_add_u32 s45, s32, 1310720
 buffer_load_dwordx4 v11, s[12:15], s45 offen  lds
 s_add_u32 m0, s49, 94208
 s_add_u32 s45, s32, 1441792
 buffer_load_dwordx4 v11, s[12:15], s45 offen  lds
 s_add_u32 m0, s49, 98304
 s_add_u32 s45, s33, 1310720
 buffer_load_dwordx4 v11, s[16:19], s45 offen  lds
 s_add_u32 m0, s49, 102400
 s_add_u32 s45, s33, 1441792
 buffer_load_dwordx4 v11, s[16:19], s45 offen  lds
 ds_read_b64_tr_b16 a[8:9], v8 offset:32768
 ds_read_b64_tr_b16 a[10:11], v8 offset:33792
 ds_read_b64_tr_b16 a[80:81], v9 offset:32768
 ds_read_b64_tr_b16 a[82:83], v9 offset:33792
 ds_read_b64_tr_b16 a[152:153], v8 offset:40960
 ds_read_b64_tr_b16 a[154:155], v8 offset:41984
 ds_read_b64_tr_b16 a[224:225], v9 offset:40960
 ds_read_b64_tr_b16 a[226:227], v9 offset:41984
 s_waitcnt vmcnt(8) lgkmcnt(0)
 s_barrier
 s_add_u32 m0, s49, 106496
 s_add_u32 s45, s32, 1572864
 buffer_load_dwordx4 v11, s[12:15], s45 offen  lds
 s_add_u32 m0, s49, 110592
 s_add_u32 s45, s32, 1703936
 buffer_load_dwordx4 v11, s[12:15], s45 offen  lds
 s_add_u32 m0, s49, 114688
 s_add_u32 s45, s33, 1572864
 buffer_load_dwordx4 v11, s[16:19], s45 offen  lds
 s_add_u32 m0, s49, 118784
 s_add_u32 s45, s33, 1703936
 buffer_load_dwordx4 v11, s[16:19], s45 offen  lds
 ds_read_b64_tr_b16 a[12:13], v8 offset:49152
 ds_read_b64_tr_b16 a[14:15], v8 offset:50176
 ds_read_b64_tr_b16 a[84:85], v9 offset:49152
 ds_read_b64_tr_b16 a[86:87], v9 offset:50176
 ds_read_b64_tr_b16 a[156:157], v8 offset:57344
 ds_read_b64_tr_b16 a[158:159], v8 offset:58368
 ds_read_b64_tr_b16 a[228:229], v9 offset:57344
 ds_read_b64_tr_b16 a[230:231], v9 offset:58368
 s_waitcnt vmcnt(8) lgkmcnt(0)
 s_barrier
 s_add_u32 m0, s49, 122880
 s_add_u32 s45, s32, 1835008
 buffer_load_dwordx4 v11, s[12:15], s45 offen  lds
 s_add_u32 m0, s49, 126976
 s_add_u32 s45, s32, 1966080
 buffer_load_dwordx4 v11, s[12:15], s45 offen  lds
 s_add_u32 m0, s49, 131072
 s_add_u32 s45, s33, 1835008
 buffer_load_dwordx4 v11, s[16:19], s45 offen  lds
 s_add_u32 m0, s49, 135168
 s_add_u32 s45, s33, 1966080
 buffer_load_dwordx4 v11, s[16:19], s45 offen  lds
 ds_read_b64_tr_b16 a[16:17], v8 offset:0
 ds_read_b64_tr_b16 a[18:19], v8 offset:1024
 ds_read_b64_tr_b16 a[88:89], v9 offset:0
 ds_read_b64_tr_b16 a[90:91], v9 offset:1024
 ds_read_b64_tr_b16 a[160:161], v8 offset:8192
 ds_read_b64_tr_b16 a[162:163], v8 offset:9216
 ds_read_b64_tr_b16 a[232:233], v9 offset:8192
 ds_read_b64_tr_b16 a[234:235], v9 offset:9216
 s_waitcnt vmcnt(8) lgkmcnt(0)
 s_barrier
 s_add_u32 m0, s49, 73728
 s_add_u32 s45, s32, 2097152
 buffer_load_dwordx4 v11, s[12:15], s45 offen  lds
 s_add_u32 m0, s49, 77824
 s_add_u32 s45, s32, 2228224
 buffer_load_dwordx4 v11, s[12:15], s45 offen  lds
 s_add_u32 m0, s49, 81920
 s_add_u32 s45, s33, 2097152
 buffer_load_dwordx4 v11, s[16:19], s45 offen  lds
 s_add_u32 m0, s49, 86016
 s_add_u32 s45, s33, 2228224
 buffer_load_dwordx4 v11, s[16:19], s45 offen  lds
 ds_read_b64_tr_b16 a[20:21], v8 offset:16384
 ds_read_b64_tr_b16 a[22:23], v8 offset:17408
 ds_read_b64_tr_b16 a[92:93], v9 offset:16384
 ds_read_b64_tr_b16 a[94:95], v9 offset:17408
 ds_read_b64_tr_b16 a[164:165], v8 offset:24576
 ds_read_b64_tr_b16 a[166:167], v8 offset:25600
 ds_read_b64_tr_b16 a[236:237], v9 offset:24576
 ds_read_b64_tr_b16 a[238:239], v9 offset:25600
 s_waitcnt vmcnt(8) lgkmcnt(0)
 s_barrier
 s_add_u32 m0, s49, 90112
 s_add_u32 s45, s32, 2359296
 buffer_load_dwordx4 v11, s[12:15], s45 offen  lds
 s_add_u32 m0, s49, 94208
 s_add_u32 s45, s32, 2490368
 buffer_load_dwordx4 v11, s[12:15], s45 offen  lds
 s_add_u32 m0, s49, 98304
 s_add_u32 s45, s33, 2359296
 buffer_load_dwordx4 v11, s[16:19], s45 offen  lds
 s_add_u32 m0, s49, 102400
 s_add_u32 s45, s33, 2490368
 buffer_load_dwordx4 v11, s[16:19], s45 offen  lds
 ds_read_b64_tr_b16 a[24:25], v8 offset:32768
 ds_read_b64_tr_b16 a[26:27], v8 offset:33792
 ds_read_b64_tr_b16 a[96:97], v9 offset:32768
 ds_read_b64_tr_b16 a[98:99], v9 offset:33792
 ds_read_b64_tr_b16 a[168:169], v8 offset:40960
 ds_read_b64_tr_b16 a[170:171], v8 offset:41984
 ds_read_b64_tr_b16 a[240:241], v9 offset:40960
 ds_read_b64_tr_b16 a[242:243], v9 offset:41984
 s_waitcnt vmcnt(8) lgkmcnt(0)
 s_barrier
 s_add_u32 m0, s49, 106496
 s_add_u32 s45, s32, 2621440
 buffer_load_dwordx4 v11, s[12:15], s45 offen  lds
 s_add_u32 m0, s49, 110592
 s_add_u32 s45, s32, 2752512
 buffer_load_dwordx4 v11, s[12:15], s45 offen  lds
 s_add_u32 m0, s49, 114688
 s_add_u32 s45, s33, 2621440
 buffer_load_dwordx4 v11, s[16:19], s45 offen  lds
 s_add_u32 m0, s49, 118784
 s_add_u32 s45, s33, 2752512
 buffer_load_dwordx4 v11, s[16:19], s45 offen  lds
 ds_read_b64_tr_b16 a[28:29], v8 offset:49152
 ds_read_b64_tr_b16 a[30:31], v8 offset:50176
 ds_read_b64_tr_b16 a[100:101], v9 offset:49152
 ds_read_b64_tr_b16 a[102:103], v9 offset:50176
 ds_read_b64_tr_b16 a[172:173], v8 offset:57344
 ds_read_b64_tr_b16 a[174:175], v8 offset:58368
 ds_read_b64_tr_b16 a[244:245], v9 offset:57344
 ds_read_b64_tr_b16 a[246:247], v9 offset:58368
 s_waitcnt vmcnt(8) lgkmcnt(0)
 s_barrier
 s_add_u32 m0, s49, 122880
 s_add_u32 s45, s32, 2883584
 buffer_load_dwordx4 v11, s[12:15], s45 offen  lds
 s_add_u32 m0, s49, 126976
 s_add_u32 s45, s32, 3014656
 buffer_load_dwordx4 v11, s[12:15], s45 offen  lds
 s_add_u32 m0, s49, 131072
 s_add_u32 s45, s33, 2883584
 buffer_load_dwordx4 v11, s[16:19], s45 offen  lds
 s_add_u32 m0, s49, 135168
 s_add_u32 s45, s33, 3014656
 buffer_load_dwordx4 v11, s[16:19], s45 offen  lds
 ds_read_b64_tr_b16 a[32:33], v8 offset:0
 ds_read_b64_tr_b16 a[34:35], v8 offset:1024
 ds_read_b64_tr_b16 a[104:105], v9 offset:0
 ds_read_b64_tr_b16 a[106:107], v9 offset:1024
 ds_read_b64_tr_b16 a[176:177], v8 offset:8192
 ds_read_b64_tr_b16 a[178:179], v8 offset:9216
 ds_read_b64_tr_b16 a[248:249], v9 offset:8192
 ds_read_b64_tr_b16 a[250:251], v9 offset:9216
 s_waitcnt vmcnt(8) lgkmcnt(0)
 s_barrier
 s_add_u32 m0, s49, 73728
 s_add_u32 s45, s32, 3145728
 buffer_load_dwordx4 v11, s[12:15], s45 offen  lds
 s_add_u32 m0, s49, 77824
 s_add_u32 s45, s32, 3276800
 buffer_load_dwordx4 v11, s[12:15], s45 offen  lds
 s_add_u32 m0, s49, 81920
 s_add_u32 s45, s33, 3145728
 buffer_load_dwordx4 v11, s[16:19], s45 offen  lds
 s_add_u32 m0, s49, 86016
 s_add_u32 s45, s33, 3276800
 buffer_load_dwordx4 v11, s[16:19], s45 offen  lds
 ds_read_b64_tr_b16 a[36:37], v8 offset:16384
 ds_read_b64_tr_b16 a[38:39], v8 offset:17408
 ds_read_b64_tr_b16 a[108:109], v9 offset:16384
 ds_read_b64_tr_b16 a[110:111], v9 offset:17408
 ds_read_b64_tr_b16 a[180:181], v8 offset:24576
 ds_read_b64_tr_b16 a[182:183], v8 offset:25600
 ds_read_b64_tr_b16 a[252:253], v9 offset:24576
 ds_read_b64_tr_b16 a[254:255], v9 offset:25600
 s_waitcnt vmcnt(8) lgkmcnt(0)
 s_barrier
 s_add_u32 m0, s49, 90112
 s_add_u32 s45, s32, 3407872
 buffer_load_dwordx4 v11, s[12:15], s45 offen  lds
 s_add_u32 m0, s49, 94208
 s_add_u32 s45, s32, 3538944
 buffer_load_dwordx4 v11, s[12:15], s45 offen  lds
 s_add_u32 m0, s49, 98304
 s_add_u32 s45, s33, 3407872
 buffer_load_dwordx4 v11, s[16:19], s45 offen  lds
 s_add_u32 m0, s49, 102400
 s_add_u32 s45, s33, 3538944
 buffer_load_dwordx4 v11, s[16:19], s45 offen  lds
 ds_read_b64_tr_b16 a[40:41], v8 offset:32768
 ds_read_b64_tr_b16 a[42:43], v8 offset:33792
 ds_read_b64_tr_b16 a[112:113], v9 offset:32768
 ds_read_b64_tr_b16 a[114:115], v9 offset:33792
 ds_read_b64_tr_b16 a[184:185], v8 offset:40960
 ds_read_b64_tr_b16 a[186:187], v8 offset:41984
 ds_read_b64_tr_b16 v[224:225], v9 offset:40960
 ds_read_b64_tr_b16 v[226:227], v9 offset:41984
 s_waitcnt vmcnt(8) lgkmcnt(0)
 s_barrier
 s_add_u32 m0, s49, 106496
 s_add_u32 s45, s32, 3670016
 buffer_load_dwordx4 v11, s[12:15], s45 offen  lds
 s_add_u32 m0, s49, 110592
 s_add_u32 s45, s32, 3801088
 buffer_load_dwordx4 v11, s[12:15], s45 offen  lds
 s_add_u32 m0, s49, 114688
 s_add_u32 s45, s33, 3670016
 buffer_load_dwordx4 v11, s[16:19], s45 offen  lds
 s_add_u32 m0, s49, 118784
 s_add_u32 s45, s33, 3801088
 buffer_load_dwordx4 v11, s[16:19], s45 offen  lds
 ds_read_b64_tr_b16 a[44:45], v8 offset:49152
 ds_read_b64_tr_b16 a[46:47], v8 offset:50176
 ds_read_b64_tr_b16 a[116:117], v9 offset:49152
 ds_read_b64_tr_b16 a[118:119], v9 offset:50176
 ds_read_b64_tr_b16 a[188:189], v8 offset:57344
 ds_read_b64_tr_b16 a[190:191], v8 offset:58368
 ds_read_b64_tr_b16 v[228:229], v9 offset:57344
 ds_read_b64_tr_b16 v[230:231], v9 offset:58368
 s_waitcnt vmcnt(8) lgkmcnt(0)
 s_barrier
 s_add_u32 m0, s49, 122880
 s_add_u32 s45, s32, 3932160
 buffer_load_dwordx4 v11, s[12:15], s45 offen  lds
 s_add_u32 m0, s49, 126976
 s_add_u32 s45, s32, 4063232
 buffer_load_dwordx4 v11, s[12:15], s45 offen  lds
 s_add_u32 m0, s49, 131072
 s_add_u32 s45, s33, 3932160
 buffer_load_dwordx4 v11, s[16:19], s45 offen  lds
 s_add_u32 m0, s49, 135168
 s_add_u32 s45, s33, 4063232
 buffer_load_dwordx4 v11, s[16:19], s45 offen  lds
 ds_read_b64_tr_b16 a[48:49], v8 offset:0
 ds_read_b64_tr_b16 a[50:51], v8 offset:1024
 ds_read_b64_tr_b16 a[120:121], v9 offset:0
 ds_read_b64_tr_b16 a[122:123], v9 offset:1024
 ds_read_b64_tr_b16 a[192:193], v8 offset:8192
 ds_read_b64_tr_b16 a[194:195], v8 offset:9216
 ds_read_b64_tr_b16 v[232:233], v9 offset:8192
 ds_read_b64_tr_b16 v[234:235], v9 offset:9216
 s_waitcnt vmcnt(8) lgkmcnt(0)
 s_barrier
 s_add_u32 m0, s49, 73728
 s_add_u32 s45, s32, 4194304
 buffer_load_dwordx4 v11, s[12:15], s45 offen  lds
 s_add_u32 m0, s49, 77824
 s_add_u32 s45, s32, 4325376
 buffer_load_dwordx4 v11, s[12:15], s45 offen  lds
 s_add_u32 m0, s49, 81920
 s_add_u32 s45, s33, 4194304
 buffer_load_dwordx4 v11, s[16:19], s45 offen  lds
 s_add_u32 m0, s49, 86016
 s_add_u32 s45, s33, 4325376
 buffer_load_dwordx4 v11, s[16:19], s45 offen  lds
 ds_read_b64_tr_b16 a[52:53], v8 offset:16384
 ds_read_b64_tr_b16 a[54:55], v8 offset:17408
 ds_read_b64_tr_b16 a[124:125], v9 offset:16384
 ds_read_b64_tr_b16 a[126:127], v9 offset:17408
 ds_read_b64_tr_b16 a[196:197], v8 offset:24576
 ds_read_b64_tr_b16 a[198:199], v8 offset:25600
 ds_read_b64_tr_b16 v[236:237], v9 offset:24576
 ds_read_b64_tr_b16 v[238:239], v9 offset:25600
 s_waitcnt vmcnt(8) lgkmcnt(0)
 s_barrier
 s_add_u32 m0, s49, 90112
 s_add_u32 s45, s32, 4456448
 buffer_load_dwordx4 v11, s[12:15], s45 offen  lds
 s_add_u32 m0, s49, 94208
 s_add_u32 s45, s32, 4587520
 buffer_load_dwordx4 v11, s[12:15], s45 offen  lds
 s_add_u32 m0, s49, 98304
 s_add_u32 s45, s33, 4456448
 buffer_load_dwordx4 v11, s[16:19], s45 offen  lds
 s_add_u32 m0, s49, 102400
 s_add_u32 s45, s33, 4587520
 buffer_load_dwordx4 v11, s[16:19], s45 offen  lds
 ds_read_b64_tr_b16 a[56:57], v8 offset:32768
 ds_read_b64_tr_b16 a[58:59], v8 offset:33792
 ds_read_b64_tr_b16 a[128:129], v9 offset:32768
 ds_read_b64_tr_b16 a[130:131], v9 offset:33792
 ds_read_b64_tr_b16 a[200:201], v8 offset:40960
 ds_read_b64_tr_b16 a[202:203], v8 offset:41984
 ds_read_b64_tr_b16 v[240:241], v9 offset:40960
 ds_read_b64_tr_b16 v[242:243], v9 offset:41984
 s_waitcnt vmcnt(8) lgkmcnt(0)
 s_barrier
 ds_read_b64_tr_b16 a[60:61], v8 offset:49152
 ds_read_b64_tr_b16 a[62:63], v8 offset:50176
 ds_read_b64_tr_b16 a[132:133], v9 offset:49152
 ds_read_b64_tr_b16 a[134:135], v9 offset:50176
 ds_read_b64_tr_b16 a[204:205], v8 offset:57344
 ds_read_b64_tr_b16 a[206:207], v8 offset:58368
 ds_read_b64_tr_b16 v[244:245], v9 offset:57344
 ds_read_b64_tr_b16 v[246:247], v9 offset:58368
 s_waitcnt vmcnt(4) lgkmcnt(0)
 s_barrier
 ds_read_b64_tr_b16 a[64:65], v8 offset:0
 ds_read_b64_tr_b16 a[66:67], v8 offset:1024
 ds_read_b64_tr_b16 a[136:137], v9 offset:0
 ds_read_b64_tr_b16 a[138:139], v9 offset:1024
 ds_read_b64_tr_b16 a[208:209], v8 offset:8192
 ds_read_b64_tr_b16 a[210:211], v8 offset:9216
 ds_read_b64_tr_b16 v[248:249], v9 offset:8192
 ds_read_b64_tr_b16 v[250:251], v9 offset:9216
 s_waitcnt vmcnt(0) lgkmcnt(0)
 s_barrier
 ds_read_b64_tr_b16 a[68:69], v8 offset:16384
 ds_read_b64_tr_b16 a[70:71], v8 offset:17408
 ds_read_b64_tr_b16 a[140:141], v9 offset:16384
 ds_read_b64_tr_b16 a[142:143], v9 offset:17408
 ds_read_b64_tr_b16 a[212:213], v8 offset:24576
 ds_read_b64_tr_b16 a[214:215], v8 offset:25600
 ds_read_b64_tr_b16 v[252:253], v9 offset:24576
 ds_read_b64_tr_b16 v[254:255], v9 offset:25600
 s_mov_b32 s50, 0x3e0293ee
 s_mov_b32 s42, 0
 s_mov_b32 s43, 0
 s_mov_b32 s44, 73728
 v_mov_b32 v6, v4
 v_mov_b32 v7, v5
Lrh_34:
 v_mbcnt_lo_u32_b32 v21, -1, 0
 v_min_u32 v21, 1, v21
 v_lshlrev_b32 v21, 28, v21
 buffer_load_dword v20, v21, s[28:31], 0 offen offset:4 sc1
 s_waitcnt vmcnt(0)
Lrhc_35:
 v_readfirstlane_b32 s89, v20
 s_cmp_eq_u32 s89, s88
 s_cbranch_scc1 Lrhk_36
 s_cmp_lg_u32 s89, 0
 s_cbranch_scc1 Lredo
 s_sub_u32 s95, s95, 1
 s_cbranch_scc0 Lrh_34
 s_endpgm
Lrhk_36:
 s_cmp_lg_u32 s4, 0
 s_cbranch_scc1 Lfrk_33
 v_min_u32 v21, 1, v0
 v_lshlrev_b32 v21, 28, v21
Lfr_32:
 buffer_load_dword v20, v21, s[28:31], 0 offen offset:0 sc1
 s_waitcnt vmcnt(0)
 v_cmp_eq_u32 vcc, 1, v20
 s_cbranch_vccnz Lfrk_33
 s_sub_u32 s95, s95, 1
 s_cbranch_scc0 Lfr_32
 s_endpgm
Lfrk_33:
 s_lshl_b32 s47, s2, 13
 s_add_u32 s47, s47, 0x8000000
 s_mov_b32 s48, s47
 v_mov_b32 v14, 0
 s_waitcnt vmcnt(0) lgkmcnt(0)
 s_barrier
 ds_read_b128 v[32:35], v6 offset:0
 ds_read_b128 v[36:39], v6 offset:2048
 ds_read_b128 v[40:43], v7 offset:0
 ds_read_b128 v[44:47], v7 offset:2048
 s_mul_i32 s45, s86, 4608
 v_lshl_add_u32 v1, v0, 7, s45
 v_add_u32 v1, 294912, v1
 v_mov_b32 v2, 0x7ff00000
 v_cmp_gt_u32 vcc, 36, v0
 s_nop 1
 v_cndmask_b32 v1, v2, v1, vcc
 s_waitcnt lgkmcnt(2)
Lps_loop_37:
 v_mfma_f32_16x16x32_bf16 v[64:67], a[0:3], v[32:35], 0
 ds_read_b128 v[48:51], v6 offset:4096
 v_mfma_f32_16x16x32_bf16 v[72:75], a[72:75], v[32:35], 0
 ds_read_b128 v[52:55], v6 offset:6144
 v_mfma_f32_16x16x32_bf16 v[80:83], a[144:147], v[32:35], 0
 s_add_u32 s41, s40, 4
 v_mfma_f32_16x16x32_bf16 v[88:91], a[216:219], v[32:35], 0
 s_add_u32 s45, s42, 2
 s_mul_i32 s46, s41, 36864
 v_mfma_f32_16x16x32_bf16 v[68:71], a[0:3], v[36:39], 0
 s_cmp_lt_u32 s45, s36
 s_cselect_b32 s46, s46, 0
 v_mfma_f32_16x16x32_bf16 v[76:79], a[72:75], v[36:39], 0
 s_lshl_b32 s49, s4, 10
 s_add_u32 s49, s49, s44
 v_mfma_f32_16x16x32_bf16 v[84:87], a[144:147], v[36:39], 0
 v_mfma_f32_16x16x32_bf16 v[92:95], a[216:219], v[36:39], 0
 s_waitcnt lgkmcnt(2)
 v_mfma_f32_16x16x32_bf16 v[64:67], a[4:7], v[40:43], v[64:67]
 ds_read_b128 v[56:59], v7 offset:4096
 v_mfma_f32_16x16x32_bf16 v[72:75], a[76:79], v[40:43], v[72:75]
 ds_read_b128 v[60:63], v7 offset:6144
 v_mfma_f32_16x16x32_bf16 v[80:83], a[148:151], v[40:43], v[80:83]
 s_add_u32 m0, s49, 0
 v_mfma_f32_16x16x32_bf16 v[88:91], a[220:223], v[40:43], v[88:91]
 buffer_load_dwordx4 v10, s[8:11], s46 offen offset:0  lds
 v_mfma_f32_16x16x32_bf16 v[68:71], a[4:7], v[44:47], v[68:71]
 s_add_u32 m0, s49, 3968
 v_mfma_f32_16x16x32_bf16 v[76:79], a[76:79], v[44:47], v[76:79]
 buffer_load_dwordx4 v10, s[8:11], s46 offen offset:128  lds
 v_mfma_f32_16x16x32_bf16 v[84:87], a[148:151], v[44:47], v[84:87]
 v_mfma_f32_16x16x32_bf16 v[92:95], a[220:223], v[44:47], v[92:95]
 s_waitcnt lgkmcnt(2)
 v_mfma_f32_16x16x32_bf16 v[64:67], a[8:11], v[48:51], v[64:67]
 ds_read_b128 v[32:35], v6 offset:8192
 v_mfma_f32_16x16x32_bf16 v[72:75], a[80:83], v[48:51], v[72:75]
 ds_read_b128 v[36:39], v6 offset:10240
 v_mfma_f32_16x16x32_bf16 v[80:83], a[152:155], v[48:51], v[80:83]
 s_add_u32 m0, s49, 7936
 v_mfma_f32_16x16x32_bf16 v[88:91], a[224:227], v[48:51], v[88:91]
 buffer_load_dwordx4 v10, s[8:11], s46 offen offset:256  lds
 v_mfma_f32_16x16x32_bf16 v[68:71], a[8:11], v[52:55], v[68:71]
 s_add_u32 m0, s49, 11904
 v_mfma_f32_16x16x32_bf16 v[76:79], a[80:83], v[52:55], v[76:79]
 buffer_load_dwordx4 v10, s[8:11], s46 offen offset:384  lds
 v_mfma_f32_16x16x32_bf16 v[84:87], a[152:155], v[52:55], v[84:87]
 v_mfma_f32_16x16x32_bf16 v[92:95], a[224:227], v[52:55], v[92:95]
 s_waitcnt lgkmcnt(2)
 v_mfma_f32_16x16x32_bf16 v[64:67], a[12:15], v[56:59], v[64:67]
 ds_read_b128 v[40:43], v7 offset:8192
 v_mfma_f32_16x16x32_bf16 v[72:75], a[84:87], v[56:59], v[72:75]
 ds_read_b128 v[44:47], v7 offset:10240
 v_mfma_f32_16x16x32_bf16 v[80:83], a[156:159], v[56:59], v[80:83]
 s_add_u32 m0, s49, 15872
 v_mfma_f32_16x16x32_bf16 v[88:91], a[228:231], v[56:59], v[88:91]
 buffer_load_dwordx4 v10, s[8:11], s46 offen offset:512  lds
 v_mfma_f32_16x16x32_bf16 v[68:71], a[12:15], v[60:63], v[68:71]
 s_add_u32 m0, s49, 19840
 v_mfma_f32_16x16x32_bf16 v[76:79], a[84:87], v[60:63], v[76:79]
 buffer_load_dwordx4 v10, s[8:11], s46 offen offset:640  lds
 v_mfma_f32_16x16x32_bf16 v[84:87], a[156:159], v[60:63], v[84:87]
 v_mfma_f32_16x16x32_bf16 v[92:95], a[228:231], v[60:63], v[92:95]
 s_waitcnt lgkmcnt(2)
 v_mfma_f32_16x16x32_bf16 v[64:67], a[16:19], v[32:35], v[64:67]
 ds_read_b128 v[48:51], v6 offset:12288
 v_mfma_f32_16x16x32_bf16 v[72:75], a[88:91], v[32:35], v[72:75]
 ds_read_b128 v[52:55], v6 offset:14336
 v_mfma_f32_16x16x32_bf16 v[80:83], a[160:163], v[32:35], v[80:83]
 s_add_u32 m0, s49, 23808
 v_mfma_f32_16x16x32_bf16 v[88:91], a[232:235], v[32:35], v[88:91]
 buffer_load_dwordx4 v10, s[8:11], s46 offen offset:768  lds
 v_mfma_f32_16x16x32_bf16 v[68:71], a[16:19], v[36:39], v[68:71]
 s_add_u32 m0, s49, 27776
 v_mfma_f32_16x16x32_bf16 v[76:79], a[88:91], v[36:39], v[76:79]
 buffer_load_dwordx4 v10, s[8:11], s46 offen offset:896  lds
 v_mfma_f32_16x16x32_bf16 v[84:87], a[160:163], v[36:39], v[84:87]
 v_mfma_f32_16x16x32_bf16 v[92:95], a[232:235], v[36:39], v[92:95]
 s_waitcnt lgkmcnt(2)
 v_mfma_f32_16x16x32_bf16 v[64:67], a[20:23], v[40:43], v[64:67]
 ds_read_b128 v[56:59], v7 offset:12288
 v_mfma_f32_16x16x32_bf16 v[72:75], a[92:95], v[40:43], v[72:75]
 ds_read_b128 v[60:63], v7 offset:14336
 v_mfma_f32_16x16x32_bf16 v[80:83], a[164:167], v[40:43], v[80:83]
 s_add_u32 m0, s49, 31744
 v_mfma_f32_16x16x32_bf16 v[88:91], a[236:239], v[40:43], v[88:91]
 buffer_load_dwordx4 v10, s[8:11], s46 offen offset:1024  lds
 v_mfma_f32_16x16x32_bf16 v[68:71], a[20:23], v[44:47], v[68:71]
 v_add_u32 v2, s46, v1
 v_mfma_f32_16x16x32_bf16 v[76:79], a[92:95], v[44:47], v[76:79]
 buffer_load_dword v15, v2, s[8:11], 0 offen
 v_mfma_f32_16x16x32_bf16 v[84:87], a[164:167], v[44:47], v[84:87]
 v_mfma_f32_16x16x32_bf16 v[92:95], a[236:239], v[44:47], v[92:95]
 s_waitcnt lgkmcnt(2)
 v_mfma_f32_16x16x32_bf16 v[64:67], a[24:27], v[48:51], v[64:67]
 ds_read_b128 v[32:35], v6 offset:16384
 v_mul_f32 v96, s50, v96
 v_mfma_f32_16x16x32_bf16 v[72:75], a[96:99], v[48:51], v[72:75]
 ds_read_b128 v[36:39], v6 offset:18432
 v_mfma_f32_16x16x32_bf16 v[80:83], a[168:171], v[48:51], v[80:83]
 v_mul_f32 v97, s50, v97
 v_mfma_f32_16x16x32_bf16 v[88:91], a[240:243], v[48:51], v[88:91]
 v_mul_f32 v98, s50, v98
 v_mfma_f32_16x16x32_bf16 v[68:71], a[24:27], v[52:55], v[68:71]
 v_mul_f32 v99, s50, v99
 v_mfma_f32_16x16x32_bf16 v[76:79], a[96:99], v[52:55], v[76:79]
 v_mul_f32 v104, s50, v104
 v_mfma_f32_16x16x32_bf16 v[84:87], a[168:171], v[52:55], v[84:87]
 v_mul_f32 v105, s50, v105
 v_mfma_f32_16x16x32_bf16 v[92:95], a[240:243], v[52:55], v[92:95]
 s_waitcnt lgkmcnt(2)
 v_mfma_f32_16x16x32_bf16 v[64:67], a[28:31], v[56:59], v[64:67]
 ds_read_b128 v[40:43], v7 offset:16384
 v_mfma_f32_16x16x32_bf16 v[72:75], a[100:103], v[56:59], v[72:75]
 ds_read_b128 v[44:47], v7 offset:18432
 v_mul_f32 v106, s50, v106
 v_mfma_f32_16x16x32_bf16 v[80:83], a[172:175], v[56:59], v[80:83]
 v_mul_f32 v107, s50, v107
 v_mfma_f32_16x16x32_bf16 v[88:91], a[244:247], v[56:59], v[88:91]
 v_cvt_pk_bf16_f32 v16, v96, v97
 v_mfma_f32_16x16x32_bf16 v[68:71], a[28:31], v[60:63], v[68:71]
 v_mfma_f32_16x16x32_bf16 v[76:79], a[100:103], v[60:63], v[76:79]
 v_cvt_pk_bf16_f32 v17, v104, v105
 v_mfma_f32_16x16x32_bf16 v[84:87], a[172:175], v[60:63], v[84:87]
 v_cvt_pk_bf16_f32 v18, v98, v99
 v_mfma_f32_16x16x32_bf16 v[92:95], a[244:247], v[60:63], v[92:95]
 s_waitcnt lgkmcnt(2)
 v_cvt_pk_bf16_f32 v19, v106, v107
 v_mfma_f32_16x16x32_bf16 v[64:67], a[32:35], v[32:35], v[64:67]
 ds_read_b128 v[48:51], v6 offset:20480
 v_mfma_f32_16x16x32_bf16 v[72:75], a[104:107], v[32:35], v[72:75]
 ds_read_b128 v[52:55], v6 offset:22528
 v_mfma_f32_16x16x32_bf16 v[80:83], a[176:179], v[32:35], v[80:83]
 buffer_store_dwordx4 v[16:19], v12, s[20:23], s47 offen offset:0 sc1
 v_mfma_f32_16x16x32_bf16 v[88:91], a[248:251], v[32:35], v[88:91]
 v_mul_f32 v100, s50, v100
 v_mfma_f32_16x16x32_bf16 v[68:71], a[32:35], v[36:39], v[68:71]
 v_mul_f32 v101, s50, v101
 v_mfma_f32_16x16x32_bf16 v[76:79], a[104:107], v[36:39], v[76:79]
 v_mul_f32 v102, s50, v102
 v_mfma_f32_16x16x32_bf16 v[84:87], a[176:179], v[36:39], v[84:87]
 v_mul_f32 v103, s50, v103
 v_mfma_f32_16x16x32_bf16 v[92:95], a[248:251], v[36:39], v[92:95]
 s_waitcnt lgkmcnt(2)
 v_mfma_f32_16x16x32_bf16 v[64:67], a[36:39], v[40:43], v[64:67]
 ds_read_b128 v[56:59], v7 offset:20480
 v_mul_f32 v108, s50, v108
 v_mfma_f32_16x16x32_bf16 v[72:75], a[108:111], v[40:43], v[72:75]
 ds_read_b128 v[60:63], v7 offset:22528
 v_mfma_f32_16x16x32_bf16 v[80:83], a[180:183], v[40:43], v[80:83]
 v_mul_f32 v109, s50, v109
 v_mfma_f32_16x16x32_bf16 v[88:91], a[252:255], v[40:43], v[88:91]
 v_mul_f32 v110, s50, v110
 v_mfma_f32_16x16x32_bf16 v[68:71], a[36:39], v[44:47], v[68:71]
 v_mul_f32 v111, s50, v111
 v_mfma_f32_16x16x32_bf16 v[76:79], a[108:111], v[44:47], v[76:79]
 v_mfma_f32_16x16x32_bf16 v[84:87], a[180:183], v[44:47], v[84:87]
 v_cvt_pk_bf16_f32 v20, v100, v101
 v_mfma_f32_16x16x32_bf16 v[92:95], a[252:255], v[44:47], v[92:95]
 s_waitcnt lgkmcnt(2)
 v_cvt_pk_bf16_f32 v21, v108, v109
 v_mfma_f32_16x16x32_bf16 v[64:67], a[40:43], v[48:51], v[64:67]
 ds_read_b128 v[32:35], v6 offset:24576
 v_mfma_f32_16x16x32_bf16 v[72:75], a[112:115], v[48:51], v[72:75]
 ds_read_b128 v[36:39], v6 offset:26624
 v_cvt_pk_bf16_f32 v22, v102, v103
 v_mfma_f32_16x16x32_bf16 v[80:83], a[184:187], v[48:51], v[80:83]
 v_mfma_f32_16x16x32_bf16 v[88:91], v[224:227], v[48:51], v[88:91]
 v_cvt_pk_bf16_f32 v23, v110, v111
 v_mfma_f32_16x16x32_bf16 v[68:71], a[40:43], v[52:55], v[68:71]
 buffer_store_dwordx4 v[20:23], v12, s[20:23], s47 offen offset:1024 sc1
 v_mfma_f32_16x16x32_bf16 v[76:79], a[112:115], v[52:55], v[76:79]
 v_mul_f32 v112, s50, v112
 v_mfma_f32_16x16x32_bf16 v[84:87], a[184:187], v[52:55], v[84:87]
 v_mul_f32 v113, s50, v113
 v_mfma_f32_16x16x32_bf16 v[92:95], v[224:227], v[52:55], v[92:95]
 s_waitcnt lgkmcnt(2)
 v_mfma_f32_16x16x32_bf16 v[64:67], a[44:47], v[56:59], v[64:67]
 ds_read_b128 v[40:43], v7 offset:24576
 v_mul_f32 v114, s50, v114
 v_mfma_f32_16x16x32_bf16 v[72:75], a[116:119], v[56:59], v[72:75]
 ds_read_b128 v[44:47], v7 offset:26624
 v_mfma_f32_16x16x32_bf16 v[80:83], a[188:191], v[56:59], v[80:83]
 v_mul_f32 v115, s50, v115
 v_mfma_f32_16x16x32_bf16 v[88:91], v[228:231], v[56:59], v[88:91]
 v_mul_f32 v120, s50, v120
 v_mfma_f32_16x16x32_bf16 v[68:71], a[44:47], v[60:63], v[68:71]
 v_mul_f32 v121, s50, v121
 v_mfma_f32_16x16x32_bf16 v[76:79], a[116:119], v[60:63], v[76:79]
 v_mfma_f32_16x16x32_bf16 v[84:87], a[188:191], v[60:63], v[84:87]
 v_mul_f32 v122, s50, v122
 v_mfma_f32_16x16x32_bf16 v[92:95], v[228:231], v[60:63], v[92:95]
 s_waitcnt lgkmcnt(2)
 v_mul_f32 v123, s50, v123
 v_mfma_f32_16x16x32_bf16 v[64:67], a[48:51], v[32:35], v[64:67]
 ds_read_b128 v[48:51], v6 offset:28672
 v_mfma_f32_16x16x32_bf16 v[72:75], a[120:123], v[32:35], v[72:75]
 ds_read_b128 v[52:55], v6 offset:30720
 v_cvt_pk_bf16_f32 v24, v112, v113
 v_mfma_f32_16x16x32_bf16 v[80:83], a[192:195], v[32:35], v[80:83]
 v_mfma_f32_16x16x32_bf16 v[88:91], v[232:235], v[32:35], v[88:91]
 v_cvt_pk_bf16_f32 v25, v120, v121
 v_mfma_f32_16x16x32_bf16 v[68:71], a[48:51], v[36:39], v[68:71]
 v_cvt_pk_bf16_f32 v26, v114, v115
 v_mfma_f32_16x16x32_bf16 v[76:79], a[120:123], v[36:39], v[76:79]
 v_cvt_pk_bf16_f32 v27, v122, v123
 v_mfma_f32_16x16x32_bf16 v[84:87], a[192:195], v[36:39], v[84:87]
 buffer_store_dwordx4 v[24:27], v12, s[20:23], s48 offen offset:0 sc1
 v_mfma_f32_16x16x32_bf16 v[92:95], v[232:235], v[36:39], v[92:95]
 s_waitcnt lgkmcnt(2)
 v_mfma_f32_16x16x32_bf16 v[64:67], a[52:55], v[40:43], v[64:67]
 ds_read_b128 v[56:59], v7 offset:28672
 v_mul_f32 v116, s50, v116
 v_mfma_f32_16x16x32_bf16 v[72:75], a[124:127], v[40:43], v[72:75]
 ds_read_b128 v[60:63], v7 offset:30720
 v_mfma_f32_16x16x32_bf16 v[80:83], a[196:199], v[40:43], v[80:83]
 s_add_u32 s43, s43, 36864
 s_cmp_eq_u32 s43, 147456
 v_mfma_f32_16x16x32_bf16 v[88:91], v[236:239], v[40:43], v[88:91]
 s_cselect_b32 s43, 0, s43
 s_add_u32 s44, s44, 36864
 v_mfma_f32_16x16x32_bf16 v[68:71], a[52:55], v[44:47], v[68:71]
 s_cmp_eq_u32 s44, 147456
 s_cselect_b32 s44, 0, s44
 v_mfma_f32_16x16x32_bf16 v[76:79], a[124:127], v[44:47], v[76:79]
 v_mul_f32 v117, s50, v117
 v_mfma_f32_16x16x32_bf16 v[84:87], a[196:199], v[44:47], v[84:87]
 v_mul_f32 v118, s50, v118
 v_mfma_f32_16x16x32_bf16 v[92:95], v[236:239], v[44:47], v[92:95]
 s_waitcnt lgkmcnt(2)
 v_mfma_f32_16x16x32_bf16 v[64:67], a[56:59], v[48:51], v[64:67]
 ds_read_b128 v[32:35], v6 offset:32768
 v_mul_f32 v119, s50, v119
 v_mfma_f32_16x16x32_bf16 v[72:75], a[128:131], v[48:51], v[72:75]
 ds_read_b128 v[36:39], v6 offset:34816
 v_mfma_f32_16x16x32_bf16 v[80:83], a[200:203], v[48:51], v[80:83]
 v_add_u32 v6, s43, v4
 v_mul_f32 v124, s50, v124
 v_mfma_f32_16x16x32_bf16 v[88:91], v[240:243], v[48:51], v[88:91]
 v_mfma_f32_16x16x32_bf16 v[68:71], a[56:59], v[52:55], v[68:71]
 v_mul_f32 v125, s50, v125
 v_mfma_f32_16x16x32_bf16 v[76:79], a[128:131], v[52:55], v[76:79]
 v_mul_f32 v126, s50, v126
 v_mfma_f32_16x16x32_bf16 v[84:87], a[200:203], v[52:55], v[84:87]
 v_mul_f32 v127, s50, v127
 v_mfma_f32_16x16x32_bf16 v[92:95], v[240:243], v[52:55], v[92:95]
 s_waitcnt lgkmcnt(2)
 v_mfma_f32_16x16x32_bf16 v[64:67], a[60:63], v[56:59], v[64:67]
 ds_read_b128 v[40:43], v7 offset:32768
 v_cvt_pk_bf16_f32 v28, v116, v117
 v_mfma_f32_16x16x32_bf16 v[72:75], a[132:135], v[56:59], v[72:75]
 ds_read_b128 v[44:47], v7 offset:34816
 v_mfma_f32_16x16x32_bf16 v[80:83], a[204:207], v[56:59], v[80:83]
 v_add_u32 v7, s43, v5
 v_cvt_pk_bf16_f32 v29, v124, v125
 v_mfma_f32_16x16x32_bf16 v[88:91], v[244:247], v[56:59], v[88:91]
 v_cvt_pk_bf16_f32 v30, v118, v119
 v_mfma_f32_16x16x32_bf16 v[68:71], a[60:63], v[60:63], v[68:71]
 v_mfma_f32_16x16x32_bf16 v[76:79], a[132:135], v[60:63], v[76:79]
 v_cvt_pk_bf16_f32 v31, v126, v127
 v_mfma_f32_16x16x32_bf16 v[84:87], a[204:207], v[60:63], v[84:87]
 buffer_store_dwordx4 v[28:31], v12, s[20:23], s48 offen offset:1024 sc1
 v_mfma_f32_16x16x32_bf16 v[92:95], v[244:247], v[60:63], v[92:95]
 s_waitcnt lgkmcnt(2)
 v_mfma_f32_16x16x32_bf16 v[64:67], a[64:67], v[32:35], v[64:67]
 s_waitcnt vmcnt(14)
 s_barrier
 ds_read_b128 v[48:51], v6 offset:0
 v_mfma_f32_16x16x32_bf16 v[72:75], a[136:139], v[32:35], v[72:75]
 ds_read_b128 v[52:55], v6 offset:2048
 v_mfma_f32_16x16x32_bf16 v[80:83], a[208:211], v[32:35], v[80:83]
 buffer_store_dword v14, v13, s[20:23], 0 offen sc1
 v_mfma_f32_16x16x32_bf16 v[88:91], v[248:251], v[32:35], v[88:91]
 v_mfma_f32_16x16x32_bf16 v[68:71], a[64:67], v[36:39], v[68:71]
 v_mfma_f32_16x16x32_bf16 v[76:79], a[136:139], v[36:39], v[76:79]
 v_mfma_f32_16x16x32_bf16 v[84:87], a[208:211], v[36:39], v[84:87]
 v_mfma_f32_16x16x32_bf16 v[92:95], v[248:251], v[36:39], v[92:95]
 s_waitcnt lgkmcnt(2)
 v_mfma_f32_16x16x32_bf16 v[64:67], a[68:71], v[40:43], v[64:67]
 ds_read_b128 v[56:59], v7 offset:0
 v_mfma_f32_16x16x32_bf16 v[72:75], a[140:143], v[40:43], v[72:75]
 ds_read_b128 v[60:63], v7 offset:2048
 v_mfma_f32_16x16x32_bf16 v[80:83], a[212:215], v[40:43], v[80:83]
 s_mul_i32 s45, s39, 262144
 s_add_u32 s47, s34, s45
 v_mfma_f32_16x16x32_bf16 v[88:91], v[252:255], v[40:43], v[88:91]
 s_add_u32 s48, s35, s45
 v_mov_b32 v14, s42
 v_mfma_f32_16x16x32_bf16 v[68:71], a[68:71], v[44:47], v[68:71]
 s_mov_b32 s39, s40
 s_mov_b32 s40, s41
 v_mfma_f32_16x16x32_bf16 v[76:79], a[140:143], v[44:47], v[76:79]
 s_add_u32 s42, s42, 1
 v_mfma_f32_16x16x32_bf16 v[84:87], a[212:215], v[44:47], v[84:87]
 v_mfma_f32_16x16x32_bf16 v[92:95], v[252:255], v[44:47], v[92:95]
 s_waitcnt lgkmcnt(2)
 v_mfma_f32_16x16x32_bf16 v[96:99], a[0:3], v[48:51], 0
 ds_read_b128 v[32:35], v6 offset:4096
 v_mfma_f32_16x16x32_bf16 v[104:107], a[72:75], v[48:51], 0
 ds_read_b128 v[36:39], v6 offset:6144
 v_mfma_f32_16x16x32_bf16 v[112:115], a[144:147], v[48:51], 0
 s_add_u32 s41, s40, 4
 v_mfma_f32_16x16x32_bf16 v[120:123], a[216:219], v[48:51], 0
 s_add_u32 s45, s42, 2
 s_mul_i32 s46, s41, 36864
 v_mfma_f32_16x16x32_bf16 v[100:103], a[0:3], v[52:55], 0
 s_cmp_lt_u32 s45, s36
 s_cselect_b32 s46, s46, 0
 v_mfma_f32_16x16x32_bf16 v[108:111], a[72:75], v[52:55], 0
 s_lshl_b32 s49, s4, 10
 s_add_u32 s49, s49, s44
 v_mfma_f32_16x16x32_bf16 v[116:119], a[144:147], v[52:55], 0
 v_mfma_f32_16x16x32_bf16 v[124:127], a[216:219], v[52:55], 0
 s_waitcnt lgkmcnt(2)
 v_mfma_f32_16x16x32_bf16 v[96:99], a[4:7], v[56:59], v[96:99]
 ds_read_b128 v[40:43], v7 offset:4096
 v_mfma_f32_16x16x32_bf16 v[104:107], a[76:79], v[56:59], v[104:107]
 ds_read_b128 v[44:47], v7 offset:6144
 v_mfma_f32_16x16x32_bf16 v[112:115], a[148:151], v[56:59], v[112:115]
 s_add_u32 m0, s49, 0
 v_mfma_f32_16x16x32_bf16 v[120:123], a[220:223], v[56:59], v[120:123]
 buffer_load_dwordx4 v10, s[8:11], s46 offen offset:0  lds
 v_mfma_f32_16x16x32_bf16 v[100:103], a[4:7], v[60:63], v[100:103]
 s_add_u32 m0, s49, 3968
 v_mfma_f32_16x16x32_bf16 v[108:111], a[76:79], v[60:63], v[108:111]
 buffer_load_dwordx4 v10, s[8:11], s46 offen offset:128  lds
 v_mfma_f32_16x16x32_bf16 v[116:119], a[148:151], v[60:63], v[116:119]
 v_mfma_f32_16x16x32_bf16 v[124:127], a[220:223], v[60:63], v[124:127]
 s_waitcnt lgkmcnt(2)
 v_mfma_f32_16x16x32_bf16 v[96:99], a[8:11], v[32:35], v[96:99]
 ds_read_b128 v[48:51], v6 offset:8192
 v_mfma_f32_16x16x32_bf16 v[104:107], a[80:83], v[32:35], v[104:107]
 ds_read_b128 v[52:55], v6 offset:10240
 v_mfma_f32_16x16x32_bf16 v[112:115], a[152:155], v[32:35], v[112:115]
 s_add_u32 m0, s49, 7936
 v_mfma_f32_16x16x32_bf16 v[120:123], a[224:227], v[32:35], v[120:123]
 buffer_load_dwordx4 v10, s[8:11], s46 offen offset:256  lds
 v_mfma_f32_16x16x32_bf16 v[100:103], a[8:11], v[36:39], v[100:103]
 s_add_u32 m0, s49, 11904
 v_mfma_f32_16x16x32_bf16 v[108:111], a[80:83], v[36:39], v[108:111]
 buffer_load_dwordx4 v10, s[8:11], s46 offen offset:384  lds
 v_mfma_f32_16x16x32_bf16 v[116:119], a[152:155], v[36:39], v[116:119]
 v_mfma_f32_16x16x32_bf16 v[124:127], a[224:227], v[36:39], v[124:127]
 s_waitcnt lgkmcnt(2)
 v_mfma_f32_16x16x32_bf16 v[96:99], a[12:15], v[40:43], v[96:99]
 ds_read_b128 v[56:59], v7 offset:8192
 v_mfma_f32_16x16x32_bf16 v[104:107], a[84:87], v[40:43], v[104:107]
 ds_read_b128 v[60:63], v7 offset:10240
 v_mfma_f32_16x16x32_bf16 v[112:115], a[156:159], v[40:43], v[112:115]
 s_add_u32 m0, s49, 15872
 v_mfma_f32_16x16x32_bf16 v[120:123], a[228:231], v[40:43], v[120:123]
 buffer_load_dwordx4 v10, s[8:11], s46 offen offset:512  lds
 v_mfma_f32_16x16x32_bf16 v[100:103], a[12:15], v[44:47], v[100:103]
 s_add_u32 m0, s49, 19840
 v_mfma_f32_16x16x32_bf16 v[108:111], a[84:87], v[44:47], v[108:111]
 buffer_load_dwordx4 v10, s[8:11], s46 offen offset:640  lds
 v_mfma_f32_16x16x32_bf16 v[116:119], a[156:159], v[44:47], v[116:119]
 v_mfma_f32_16x16x32_bf16 v[124:127], a[228:231], v[44:47], v[124:127]
 s_waitcnt lgkmcnt(2)
 v_mfma_f32_16x16x32_bf16 v[96:99], a[16:19], v[48:51], v[96:99]
 ds_read_b128 v[32:35], v6 offset:12288
 v_mfma_f32_16x16x32_bf16 v[104:107], a[88:91], v[48:51], v[104:107]
 ds_read_b128 v[36:39], v6 offset:14336
 v_mfma_f32_16x16x32_bf16 v[112:115], a[160:163], v[48:51], v[112:115]
 s_add_u32 m0, s49, 23808
 v_mfma_f32_16x16x32_bf16 v[120:123], a[232:235], v[48:51], v[120:123]
 buffer_load_dwordx4 v10, s[8:11], s46 offen offset:768  lds
 v_mfma_f32_16x16x32_bf16 v[100:103], a[16:19], v[52:55], v[100:103]
 s_add_u32 m0, s49, 27776
 v_mfma_f32_16x16x32_bf16 v[108:111], a[88:91], v[52:55], v[108:111]
 buffer_load_dwordx4 v10, s[8:11], s46 offen offset:896  lds
 v_mfma_f32_16x16x32_bf16 v[116:119], a[160:163], v[52:55], v[116:119]
 v_mfma_f32_16x16x32_bf16 v[124:127], a[232:235], v[52:55], v[124:127]
 s_waitcnt lgkmcnt(2)
 v_mfma_f32_16x16x32_bf16 v[96:99], a[20:23], v[56:59], v[96:99]
 ds_read_b128 v[40:43], v7 offset:12288
 v_mfma_f32_16x16x32_bf16 v[104:107], a[92:95], v[56:59], v[104:107]
 ds_read_b128 v[44:47], v7 offset:14336
 v_mfma_f32_16x16x32_bf16 v[112:115], a[164:167], v[56:59], v[112:115]
 s_add_u32 m0, s49, 31744
 v_mfma_f32_16x16x32_bf16 v[120:123], a[236:239], v[56:59], v[120:123]
 buffer_load_dwordx4 v10, s[8:11], s46 offen offset:1024  lds
 v_mfma_f32_16x16x32_bf16 v[100:103], a[20:23], v[60:63], v[100:103]
 v_add_u32 v2, s46, v1
 v_mfma_f32_16x16x32_bf16 v[108:111], a[92:95], v[60:63], v[108:111]
 buffer_load_dword v15, v2, s[8:11], 0 offen
 v_mfma_f32_16x16x32_bf16 v[116:119], a[164:167], v[60:63], v[116:119]
 v_mfma_f32_16x16x32_bf16 v[124:127], a[236:239], v[60:63], v[124:127]
 s_waitcnt lgkmcnt(2)
 v_mfma_f32_16x16x32_bf16 v[96:99], a[24:27], v[32:35], v[96:99]
 ds_read_b128 v[48:51], v6 offset:16384
 v_mul_f32 v64, s50, v64
 v_mfma_f32_16x16x32_bf16 v[104:107], a[96:99], v[32:35], v[104:107]
 ds_read_b128 v[52:55], v6 offset:18432
 v_mfma_f32_16x16x32_bf16 v[112:115], a[168:171], v[32:35], v[112:115]
 v_mul_f32 v65, s50, v65
 v_mfma_f32_16x16x32_bf16 v[120:123], a[240:243], v[32:35], v[120:123]
 v_mul_f32 v66, s50, v66
 v_mfma_f32_16x16x32_bf16 v[100:103], a[24:27], v[36:39], v[100:103]
 v_mul_f32 v67, s50, v67
 v_mfma_f32_16x16x32_bf16 v[108:111], a[96:99], v[36:39], v[108:111]
 v_mul_f32 v72, s50, v72
 v_mfma_f32_16x16x32_bf16 v[116:119], a[168:171], v[36:39], v[116:119]
 v_mul_f32 v73, s50, v73
 v_mfma_f32_16x16x32_bf16 v[124:127], a[240:243], v[36:39], v[124:127]
 s_waitcnt lgkmcnt(2)
 v_mfma_f32_16x16x32_bf16 v[96:99], a[28:31], v[40:43], v[96:99]
 ds_read_b128 v[56:59], v7 offset:16384
 v_mfma_f32_16x16x32_bf16 v[104:107], a[100:103], v[40:43], v[104:107]
 ds_read_b128 v[60:63], v7 offset:18432
 v_mul_f32 v74, s50, v74
 v_mfma_f32_16x16x32_bf16 v[112:115], a[172:175], v[40:43], v[112:115]
 v_mul_f32 v75, s50, v75
 v_mfma_f32_16x16x32_bf16 v[120:123], a[244:247], v[40:43], v[120:123]
 v_cvt_pk_bf16_f32 v16, v64, v65
 v_mfma_f32_16x16x32_bf16 v[100:103], a[28:31], v[44:47], v[100:103]
 v_mfma_f32_16x16x32_bf16 v[108:111], a[100:103], v[44:47], v[108:111]
 v_cvt_pk_bf16_f32 v17, v72, v73
 v_mfma_f32_16x16x32_bf16 v[116:119], a[172:175], v[44:47], v[116:119]
 v_cvt_pk_bf16_f32 v18, v66, v67
 v_mfma_f32_16x16x32_bf16 v[124:127], a[244:247], v[44:47], v[124:127]
 s_waitcnt lgkmcnt(2)
 v_cvt_pk_bf16_f32 v19, v74, v75
 v_mfma_f32_16x16x32_bf16 v[96:99], a[32:35], v[48:51], v[96:99]
 ds_read_b128 v[32:35], v6 offset:20480
 v_mfma_f32_16x16x32_bf16 v[104:107], a[104:107], v[48:51], v[104:107]
 ds_read_b128 v[36:39], v6 offset:22528
 v_mfma_f32_16x16x32_bf16 v[112:115], a[176:179], v[48:51], v[112:115]
 buffer_store_dwordx4 v[16:19], v12, s[20:23], s47 offen offset:0 sc1
 v_mfma_f32_16x16x32_bf16 v[120:123], a[248:251], v[48:51], v[120:123]
 v_mul_f32 v68, s50, v68
 v_mfma_f32_16x16x32_bf16 v[100:103], a[32:35], v[52:55], v[100:103]
 v_mul_f32 v69, s50, v69
 v_mfma_f32_16x16x32_bf16 v[108:111], a[104:107], v[52:55], v[108:111]
 v_mul_f32 v70, s50, v70
 v_mfma_f32_16x16x32_bf16 v[116:119], a[176:179], v[52:55], v[116:119]
 v_mul_f32 v71, s50, v71
 v_mfma_f32_16x16x32_bf16 v[124:127], a[248:251], v[52:55], v[124:127]
 s_waitcnt lgkmcnt(2)
 v_mfma_f32_16x16x32_bf16 v[96:99], a[36:39], v[56:59], v[96:99]
 ds_read_b128 v[40:43], v7 offset:20480
 v_mul_f32 v76, s50, v76
 v_mfma_f32_16x16x32_bf16 v[104:107], a[108:111], v[56:59], v[104:107]
 ds_read_b128 v[44:47], v7 offset:22528
 v_mfma_f32_16x16x32_bf16 v[112:115], a[180:183], v[56:59], v[112:115]
 v_mul_f32 v77, s50, v77
 v_mfma_f32_16x16x32_bf16 v[120:123], a[252:255], v[56:59], v[120:123]
 v_mul_f32 v78, s50, v78
 v_mfma_f32_16x16x32_bf16 v[100:103], a[36:39], v[60:63], v[100:103]
 v_mul_f32 v79, s50, v79
 v_mfma_f32_16x16x32_bf16 v[108:111], a[108:111], v[60:63], v[108:111]
 v_mfma_f32_16x16x32_bf16 v[116:119], a[180:183], v[60:63], v[116:119]
 v_cvt_pk_bf16_f32 v20, v68, v69
 v_mfma_f32_16x16x32_bf16 v[124:127], a[252:255], v[60:63], v[124:127]
 s_waitcnt lgkmcnt(2)
 v_cvt_pk_bf16_f32 v21, v76, v77
 v_mfma_f32_16x16x32_bf16 v[96:99], a[40:43], v[32:35], v[96:99]
 ds_read_b128 v[48:51], v6 offset:24576
 v_mfma_f32_16x16x32_bf16 v[104:107], a[112:115], v[32:35], v[104:107]
 ds_read_b128 v[52:55], v6 offset:26624
 v_cvt_pk_bf16_f32 v22, v70, v71
 v_mfma_f32_16x16x32_bf16 v[112:115], a[184:187], v[32:35], v[112:115]
 v_mfma_f32_16x16x32_bf16 v[120:123], v[224:227], v[32:35], v[120:123]
 v_cvt_pk_bf16_f32 v23, v78, v79
 v_mfma_f32_16x16x32_bf16 v[100:103], a[40:43], v[36:39], v[100:103]
 buffer_store_dwordx4 v[20:23], v12, s[20:23], s47 offen offset:1024 sc1
 v_mfma_f32_16x16x32_bf16 v[108:111], a[112:115], v[36:39], v[108:111]
 v_mul_f32 v80, s50, v80
 v_mfma_f32_16x16x32_bf16 v[116:119], a[184:187], v[36:39], v[116:119]
 v_mul_f32 v81, s50, v81
 v_mfma_f32_16x16x32_bf16 v[124:127], v[224:227], v[36:39], v[124:127]
 s_waitcnt lgkmcnt(2)
 v_mfma_f32_16x16x32_bf16 v[96:99], a[44:47], v[40:43], v[96:99]
 ds_read_b128 v[56:59], v7 offset:24576
 v_mul_f32 v82, s50, v82
 v_mfma_f32_16x16x32_bf16 v[104:107], a[116:119], v[40:43], v[104:107]
 ds_read_b128 v[60:63], v7 offset:26624
 v_mfma_f32_16x16x32_bf16 v[112:115], a[188:191], v[40:43], v[112:115]
 v_mul_f32 v83, s50, v83
 v_mfma_f32_16x16x32_bf16 v[120:123], v[228:231], v[40:43], v[120:123]
 v_mul_f32 v88, s50, v88
 v_mfma_f32_16x16x32_bf16 v[100:103], a[44:47], v[44:47], v[100:103]
 v_mul_f32 v89, s50, v89
 v_mfma_f32_16x16x32_bf16 v[108:111], a[116:119], v[44:47], v[108:111]
 v_mfma_f32_16x16x32_bf16 v[116:119], a[188:191], v[44:47], v[116:119]
 v_mul_f32 v90, s50, v90
 v_mfma_f32_16x16x32_bf16 v[124:127], v[228:231], v[44:47], v[124:127]
 s_waitcnt lgkmcnt(2)
 v_mul_f32 v91, s50, v91
 v_mfma_f32_16x16x32_bf16 v[96:99], a[48:51], v[48:51], v[96:99]
 ds_read_b128 v[32:35], v6 offset:28672
 v_mfma_f32_16x16x32_bf16 v[104:107], a[120:123], v[48:51], v[104:107]
 ds_read_b128 v[36:39], v6 offset:30720
 v_cvt_pk_bf16_f32 v24, v80, v81
 v_mfma_f32_16x16x32_bf16 v[112:115], a[192:195], v[48:51], v[112:115]
 v_mfma_f32_16x16x32_bf16 v[120:123], v[232:235], v[48:51], v[120:123]
 v_cvt_pk_bf16_f32 v25, v88, v89
 v_mfma_f32_16x16x32_bf16 v[100:103], a[48:51], v[52:55], v[100:103]
 v_cvt_pk_bf16_f32 v26, v82, v83
 v_mfma_f32_16x16x32_bf16 v[108:111], a[120:123], v[52:55], v[108:111]
 v_cvt_pk_bf16_f32 v27, v90, v91
 v_mfma_f32_16x16x32_bf16 v[116:119], a[192:195], v[52:55], v[116:119]
 buffer_store_dwordx4 v[24:27], v12, s[20:23], s48 offen offset:0 sc1
 v_mfma_f32_16x16x32_bf16 v[124:127], v[232:235], v[52:55], v[124:127]
 s_waitcnt lgkmcnt(2)
 v_mfma_f32_16x16x32_bf16 v[96:99], a[52:55], v[56:59], v[96:99]
 ds_read_b128 v[40:43], v7 offset:28672
 v_mul_f32 v84, s50, v84
 v_mfma_f32_16x16x32_bf16 v[104:107], a[124:127], v[56:59], v[104:107]
 ds_read_b128 v[44:47], v7 offset:30720
 v_mfma_f32_16x16x32_bf16 v[112:115], a[196:199], v[56:59], v[112:115]
 s_add_u32 s43, s43, 36864
 s_cmp_eq_u32 s43, 147456
 v_mfma_f32_16x16x32_bf16 v[120:123], v[236:239], v[56:59], v[120:123]
 s_cselect_b32 s43, 0, s43
 s_add_u32 s44, s44, 36864
 v_mfma_f32_16x16x32_bf16 v[100:103], a[52:55], v[60:63], v[100:103]
 s_cmp_eq_u32 s44, 147456
 s_cselect_b32 s44, 0, s44
 v_mfma_f32_16x16x32_bf16 v[108:111], a[124:127], v[60:63], v[108:111]
 v_mul_f32 v85, s50, v85
 v_mfma_f32_16x16x32_bf16 v[116:119], a[196:199], v[60:63], v[116:119]
 v_mul_f32 v86, s50, v86
 v_mfma_f32_16x16x32_bf16 v[124:127], v[236:239], v[60:63], v[124:127]
 s_waitcnt lgkmcnt(2)
 v_mfma_f32_16x16x32_bf16 v[96:99], a[56:59], v[32:35], v[96:99]
 ds_read_b128 v[48:51], v6 offset:32768
 v_mul_f32 v87, s50, v87
 v_mfma_f32_16x16x32_bf16 v[104:107], a[128:131], v[32:35], v[104:107]
 ds_read_b128 v[52:55], v6 offset:34816
 v_mfma_f32_16x16x32_bf16 v[112:115], a[200:203], v[32:35], v[112:115]
 v_add_u32 v6, s43, v4
 v_mul_f32 v92, s50, v92
 v_mfma_f32_16x16x32_bf16 v[120:123], v[240:243], v[32:35], v[120:123]
 v_mfma_f32_16x16x32_bf16 v[100:103], a[56:59], v[36:39], v[100:103]
 v_mul_f32 v93, s50, v93
 v_mfma_f32_16x16x32_bf16 v[108:111], a[128:131], v[36:39], v[108:111]
 v_mul_f32 v94, s50, v94
 v_mfma_f32_16x16x32_bf16 v[116:119], a[200:203], v[36:39], v[116:119]
 v_mul_f32 v95, s50, v95
 v_mfma_f32_16x16x32_bf16 v[124:127], v[240:243], v[36:39], v[124:127]
 s_waitcnt lgkmcnt(2)
 v_mfma_f32_16x16x32_bf16 v[96:99], a[60:63], v[40:43], v[96:99]
 ds_read_b128 v[56:59], v7 offset:32768
 v_cvt_pk_bf16_f32 v28, v84, v85
 v_mfma_f32_16x16x32_bf16 v[104:107], a[132:135], v[40:43], v[104:107]
 ds_read_b128 v[60:63], v7 offset:34816
 v_mfma_f32_16x16x32_bf16 v[112:115], a[204:207], v[40:43], v[112:115]
 v_add_u32 v7, s43, v5
 v_cvt_pk_bf16_f32 v29, v92, v93
 v_mfma_f32_16x16x32_bf16 v[120:123], v[244:247], v[40:43], v[120:123]
 v_cvt_pk_bf16_f32 v30, v86, v87
 v_mfma_f32_16x16x32_bf16 v[100:103], a[60:63], v[44:47], v[100:103]
 v_mfma_f32_16x16x32_bf16 v[108:111], a[132:135], v[44:47], v[108:111]
 v_cvt_pk_bf16_f32 v31, v94, v95
 v_mfma_f32_16x16x32_bf16 v[116:119], a[204:207], v[44:47], v[116:119]
 buffer_store_dwordx4 v[28:31], v12, s[20:23], s48 offen offset:1024 sc1
 v_mfma_f32_16x16x32_bf16 v[124:127], v[244:247], v[44:47], v[124:127]
 s_waitcnt lgkmcnt(2)
 v_mfma_f32_16x16x32_bf16 v[96:99], a[64:67], v[48:51], v[96:99]
 s_waitcnt vmcnt(14)
 s_barrier
 ds_read_b128 v[32:35], v6 offset:0
 v_mfma_f32_16x16x32_bf16 v[104:107], a[136:139], v[48:51], v[104:107]
 ds_read_b128 v[36:39], v6 offset:2048
 v_mfma_f32_16x16x32_bf16 v[112:115], a[208:211], v[48:51], v[112:115]
 buffer_store_dword v14, v13, s[20:23], 0 offen sc1
 v_mfma_f32_16x16x32_bf16 v[120:123], v[248:251], v[48:51], v[120:123]
 v_mfma_f32_16x16x32_bf16 v[100:103], a[64:67], v[52:55], v[100:103]
 v_mfma_f32_16x16x32_bf16 v[108:111], a[136:139], v[52:55], v[108:111]
 v_mfma_f32_16x16x32_bf16 v[116:119], a[208:211], v[52:55], v[116:119]
 v_mfma_f32_16x16x32_bf16 v[124:127], v[248:251], v[52:55], v[124:127]
 s_waitcnt lgkmcnt(2)
 v_mfma_f32_16x16x32_bf16 v[96:99], a[68:71], v[56:59], v[96:99]
 ds_read_b128 v[40:43], v7 offset:0
 v_mfma_f32_16x16x32_bf16 v[104:107], a[140:143], v[56:59], v[104:107]
 ds_read_b128 v[44:47], v7 offset:2048
 v_mfma_f32_16x16x32_bf16 v[112:115], a[212:215], v[56:59], v[112:115]
 s_mul_i32 s45, s39, 262144
 s_add_u32 s47, s34, s45
 v_mfma_f32_16x16x32_bf16 v[120:123], v[252:255], v[56:59], v[120:123]
 s_add_u32 s48, s35, s45
 v_mov_b32 v14, s42
 v_mfma_f32_16x16x32_bf16 v[100:103], a[68:71], v[60:63], v[100:103]
 s_mov_b32 s39, s40
 s_mov_b32 s40, s41
 v_mfma_f32_16x16x32_bf16 v[108:111], a[140:143], v[60:63], v[108:111]
 s_add_u32 s42, s42, 1
 s_cmp_lt_u32 s42, s36
 v_mfma_f32_16x16x32_bf16 v[116:119], a[212:215], v[60:63], v[116:119]
 v_mfma_f32_16x16x32_bf16 v[124:127], v[252:255], v[60:63], v[124:127]
 s_waitcnt lgkmcnt(2)
 s_cbranch_scc1 Lps_loop_37
 s_nop 7
 v_mul_f32 v96, s50, v96
 v_mul_f32 v97, s50, v97
 v_mul_f32 v98, s50, v98
 v_mul_f32 v99, s50, v99
 v_mul_f32 v104, s50, v104
 v_mul_f32 v105, s50, v105
 v_mul_f32 v106, s50, v106
 v_mul_f32 v107, s50, v107
 v_cvt_pk_bf16_f32 v16, v96, v97
 v_cvt_pk_bf16_f32 v17, v104, v105
 v_cvt_pk_bf16_f32 v18, v98, v99
 v_cvt_pk_bf16_f32 v19, v106, v107
 buffer_store_dwordx4 v[16:19], v12, s[20:23], s47 offen offset:0 sc1
 v_mul_f32 v100, s50, v100
 v_mul_f32 v101, s50, v101
 v_mul_f32 v102, s50, v102
 v_mul_f32 v103, s50, v103
 v_mul_f32 v108, s50, v108
 v_mul_f32 v109, s50, v109
 v_mul_f32 v110, s50, v110
 v_mul_f32 v111, s50, v111
 v_cvt_pk_bf16_f32 v20, v100, v101
 v_cvt_pk_bf16_f32 v21, v108, v109
 v_cvt_pk_bf16_f32 v22, v102, v103
 v_cvt_pk_bf16_f32 v23, v110, v111
 buffer_store_dwordx4 v[20:23], v12, s[20:23], s47 offen offset:1024 sc1
 v_mul_f32 v112, s50, v112
 v_mul_f32 v113, s50, v113
 v_mul_f32 v114, s50, v114
 v_mul_f32 v115, s50, v115
 v_mul_f32 v120, s50, v120
 v_mul_f32 v121, s50, v121
 v_mul_f32 v122, s50, v122
 v_mul_f32 v123, s50, v123
 v_cvt_pk_bf16_f32 v24, v112, v113
 v_cvt_pk_bf16_f32 v25, v120, v121
 v_cvt_pk_bf16_f32 v26, v114, v115
 v_cvt_pk_bf16_f32 v27, v122, v123
 buffer_store_dwordx4 v[24:27], v12, s[20:23], s48 offen offset:0 sc1
 v_mul_f32 v116, s50, v116
 v_mul_f32 v117, s50, v117
 v_mul_f32 v118, s50, v118
 v_mul_f32 v119, s50, v119
 v_mul_f32 v124, s50, v124
 v_mul_f32 v125, s50, v125
 v_mul_f32 v126, s50, v126
 v_mul_f32 v127, s50, v127
 v_cvt_pk_bf16_f32 v28, v116, v117
 v_cvt_pk_bf16_f32 v29, v124, v125
 v_cvt_pk_bf16_f32 v30, v118, v119
 v_cvt_pk_bf16_f32 v31, v126, v127
 buffer_store_dwordx4 v[28:31], v12, s[20:23], s48 offen offset:1024 sc1
 s_waitcnt vmcnt(0) lgkmcnt(0)
 s_barrier
 v_mov_b32 v14, s36
 buffer_store_dword v14, v13, s[20:23], 0 offen sc1
 s_sub_u32 s3, s5, 2
 s_add_u32 s7, s6, s3
 s_cmp_ge_u32 s7, 30
 s_cbranch_scc1 Lfin
Lqb:
 s_cmp_ge_u32 s6, 16
 s_cbranch_scc1 Lob
 s_load_dwordx2 s[8:9], s[0:1], 48
 s_mov_b32 s10, 0x240000
 s_mov_b32 s11, 0x20000
 s_load_dwordx2 s[12:13], s[0:1], 64
 s_mov_b32 s14, 0x480000
 s_mov_b32 s15, 0x20000
 s_load_dwordx2 s[16:17], s[0:1], 64
 s_mov_b32 s18, 0x480000
 s_mov_b32 s19, 0x20000
 s_lshl_b32 s32, s6, 9
 s_add_u32 s33, s32, 256
 s_sub_u32 s36, 32, s3
 s_cmp_eq_u32 s3, 2
 s_cselect_b32 s36, 1, s36
 s_cselect_b32 s37, 63, s3
 s_lshl_b32 s52, s6, 1
 s_lshl_b32 s7, s3, 4
 s_add_u32 s7, s7, s6
 s_and_b32 s94, s7, 3
 s_lshr_b32 s7, s7, 2
 s_lshl_b32 s7, s7, 5
 s_add_u32 s7, s7, s94
 s_lshl_b32 s7, s7, 2
 s_add_u32 s59, s7, 0x3800
 s_waitcnt lgkmcnt(0)
 v_and_b32 v1, 63, v0
 v_lshrrev_b32 v2, 3, v0
 v_mul_u32_u24 v10, 1152, v2
 v_lshrrev_b32 v2, 4, v0
 v_xor_b32 v2, v2, v0
 v_and_b32 v2, 7, v2
 v_lshl_add_u32 v10, v2, 4, v10
 v_lshrrev_b32 v2, 4, v1
 v_bfe_u32 v3, v1, 1, 3
 v_xor_b32 v2, v2, v3
 v_and_b32 v3, 15, v1
 v_lshlrev_b32 v3, 7, v3
 v_lshl_add_u32 v4, v2, 4, v3
 v_xor_b32 v5, 64, v4
 v_lshrrev_b32 v2, 4, v0
 v_lshlrev_b32 v11, 13, v2
 v_lshrrev_b32 v2, 7, v0
 v_lshrrev_b32 v3, 4, v1
 v_lshl_add_u32 v3, v2, 2, v3
 v_bfe_u32 v2, v1, 1, 3
 v_xor_b32 v2, v2, v3
 v_lshl_add_u32 v11, v2, 5, v11
 v_and_b32 v2, 1, v1
 v_lshl_add_u32 v11, v2, 4, v11
 v_bfe_u32 v2, v1, 2, 3
 v_xor_b32 v3, s4, v2
 v_lshlrev_b32 v3, 5, v3
 v_and_b32 v2, 3, v2
 v_lshl_add_u32 v3, v2, 8, v3
 v_lshrrev_b32 v2, 4, v1
 v_lshl_add_u32 v3, v2, 11, v3
 v_and_b32 v2, 3, v1
 v_lshl_add_u32 v3, v2, 3, v3
 v_add_u32 v8, 73728, v3
 v_xor_b32 v3, 0x80, v3
 v_add_u32 v9, 73728, v3
 s_lshl_b32 s45, s4, 11
 v_lshl_add_u32 v12, v1, 4, s45
 s_mov_b32 s39, s37
 s_add_u32 s40, s39, 2
 s_min_u32 s40, s40, 63
 s_lshl_b32 s49, s4, 10
 s_mul_i32 s46, s39, 36864
 s_add_u32 m0, s49, 0
 s_nop 0
 buffer_load_dwordx4 v10, s[8:11], s46 offen offset:0  lds
 s_add_u32 m0, s49, 3968
 s_nop 0
 buffer_load_dwordx4 v10, s[8:11], s46 offen offset:128  lds
 s_add_u32 m0, s49, 7936
 s_nop 0
 buffer_load_dwordx4 v10, s[8:11], s46 offen offset:256  lds
 s_add_u32 m0, s49, 11904
 s_nop 0
 buffer_load_dwordx4 v10, s[8:11], s46 offen offset:384  lds
 s_add_u32 m0, s49, 15872
 s_nop 0
 buffer_load_dwordx4 v10, s[8:11], s46 offen offset:512  lds
 s_add_u32 m0, s49, 19840
 s_nop 0
 buffer_load_dwordx4 v10, s[8:11], s46 offen offset:640  lds
 s_add_u32 m0, s49, 23808
 s_nop 0
 buffer_load_dwordx4 v10, s[8:11], s46 offen offset:768  lds
 s_add_u32 m0, s49, 27776
 s_nop 0
 buffer_load_dwordx4 v10, s[8:11], s46 offen offset:896  lds
 s_add_u32 m0, s49, 31744
 s_nop 0
 buffer_load_dwordx4 v10, s[8:11], s46 offen offset:1024  lds
 s_lshl_b32 s49, s4, 10
 s_add_u32 s49, s49, 36864
 s_mul_i32 s46, s40, 36864
 s_add_u32 m0, s49, 0
 s_nop 0
 buffer_load_dwordx4 v10, s[8:11], s46 offen offset:0  lds
 s_add_u32 m0, s49, 3968
 s_nop 0
 buffer_load_dwordx4 v10, s[8:11], s46 offen offset:128  lds
 s_add_u32 m0, s49, 7936
 s_nop 0
 buffer_load_dwordx4 v10, s[8:11], s46 offen offset:256  lds
 s_add_u32 m0, s49, 11904
 s_nop 0
 buffer_load_dwordx4 v10, s[8:11], s46 offen offset:384  lds
 s_add_u32 m0, s49, 15872
 s_nop 0
 buffer_load_dwordx4 v10, s[8:11], s46 offen offset:512  lds
 s_add_u32 m0, s49, 19840
 s_nop 0
 buffer_load_dwordx4 v10, s[8:11], s46 offen offset:640  lds
 s_add_u32 m0, s49, 23808
 s_nop 0
 buffer_load_dwordx4 v10, s[8:11], s46 offen offset:768  lds
 s_add_u32 m0, s49, 27776
 s_nop 0
 buffer_load_dwordx4 v10, s[8:11], s46 offen offset:896  lds
 s_add_u32 m0, s49, 31744
 s_nop 0
 buffer_load_dwordx4 v10, s[8:11], s46 offen offset:1024  lds
 s_lshl_b32 s49, s4, 10
 s_add_u32 m0, s49, 73728
 s_add_u32 s45, s32, 0
 buffer_load_dwordx4 v11, s[12:15], s45 offen  lds
 s_add_u32 m0, s49, 77824
 s_add_u32 s45, s32, 131072
 buffer_load_dwordx4 v11, s[12:15], s45 offen  lds
 s_add_u32 m0, s49, 81920
 s_add_u32 s45, s33, 0
 buffer_load_dwordx4 v11, s[16:19], s45 offen  lds
 s_add_u32 m0, s49, 86016
 s_add_u32 s45, s33, 131072
 buffer_load_dwordx4 v11, s[16:19], s45 offen  lds
 s_add_u32 m0, s49, 90112
 s_add_u32 s45, s32, 262144
 buffer_load_dwordx4 v11, s[12:15], s45 offen  lds
 s_add_u32 m0, s49, 94208
 s_add_u32 s45, s32, 393216
 buffer_load_dwordx4 v11, s[12:15], s45 offen  lds
 s_add_u32 m0, s49, 98304
 s_add_u32 s45, s33, 262144
 buffer_load_dwordx4 v11, s[16:19], s45 offen  lds
 s_add_u32 m0, s49, 102400
 s_add_u32 s45, s33, 393216
 buffer_load_dwordx4 v11, s[16:19], s45 offen  lds
 s_add_u32 m0, s49, 106496
 s_add_u32 s45, s32, 524288
 buffer_load_dwordx4 v11, s[12:15], s45 offen  lds
 s_add_u32 m0, s49, 110592
 s_add_u32 s45, s32, 655360
 buffer_load_dwordx4 v11, s[12:15], s45 offen  lds
 s_add_u32 m0, s49, 114688
 s_add_u32 s45, s33, 524288
 buffer_load_dwordx4 v11, s[16:19], s45 offen  lds
 s_add_u32 m0, s49, 118784
 s_add_u32 s45, s33, 655360
 buffer_load_dwordx4 v11, s[16:19], s45 offen  lds
 s_waitcnt vmcnt(8) lgkmcnt(0)
 s_barrier
 s_add_u32 m0, s49, 122880
 s_add_u32 s45, s32, 786432
 buffer_load_dwordx4 v11, s[12:15], s45 offen  lds
 s_add_u32 m0, s49, 126976
 s_add_u32 s45, s32, 917504
 buffer_load_dwordx4 v11, s[12:15], s45 offen  lds
 s_add_u32 m0, s49, 131072
 s_add_u32 s45, s33, 786432
 buffer_load_dwordx4 v11, s[16:19], s45 offen  lds
 s_add_u32 m0, s49, 135168
 s_add_u32 s45, s33, 917504
 buffer_load_dwordx4 v11, s[16:19], s45 offen  lds
 ds_read_b64_tr_b16 a[0:1], v8 offset:0
 ds_read_b64_tr_b16 a[2:3], v8 offset:1024
 ds_read_b64_tr_b16 a[72:73], v9 offset:0
 ds_read_b64_tr_b16 a[74:75], v9 offset:1024
 ds_read_b64_tr_b16 a[144:145], v8 offset:8192
 ds_read_b64_tr_b16 a[146:147], v8 offset:9216
 ds_read_b64_tr_b16 a[216:217], v9 offset:8192
 ds_read_b64_tr_b16 a[218:219], v9 offset:9216
 s_waitcnt vmcnt(8) lgkmcnt(0)
 s_barrier
 s_add_u32 m0, s49, 73728
 s_add_u32 s45, s32, 1048576
 buffer_load_dwordx4 v11, s[12:15], s45 offen  lds
 s_add_u32 m0, s49, 77824
 s_add_u32 s45, s32, 1179648
 buffer_load_dwordx4 v11, s[12:15], s45 offen  lds
 s_add_u32 m0, s49, 81920
 s_add_u32 s45, s33, 1048576
 buffer_load_dwordx4 v11, s[16:19], s45 offen  lds
 s_add_u32 m0, s49, 86016
 s_add_u32 s45, s33, 1179648
 buffer_load_dwordx4 v11, s[16:19], s45 offen  lds
 ds_read_b64_tr_b16 a[4:5], v8 offset:16384
 ds_read_b64_tr_b16 a[6:7], v8 offset:17408
 ds_read_b64_tr_b16 a[76:77], v9 offset:16384
 ds_read_b64_tr_b16 a[78:79], v9 offset:17408
 ds_read_b64_tr_b16 a[148:149], v8 offset:24576
 ds_read_b64_tr_b16 a[150:151], v8 offset:25600
 ds_read_b64_tr_b16 a[220:221], v9 offset:24576
 ds_read_b64_tr_b16 a[222:223], v9 offset:25600
 s_waitcnt vmcnt(8) lgkmcnt(0)
 s_barrier
 s_add_u32 m0, s49, 90112
 s_add_u32 s45, s32, 1310720
 buffer_load_dwordx4 v11, s[12:15], s45 offen  lds
 s_add_u32 m0, s49, 94208
 s_add_u32 s45, s32, 1441792
 buffer_load_dwordx4 v11, s[12:15], s45 offen  lds
 s_add_u32 m0, s49, 98304
 s_add_u32 s45, s33, 1310720
 buffer_load_dwordx4 v11, s[16:19], s45 offen  lds
 s_add_u32 m0, s49, 102400
 s_add_u32 s45, s33, 1441792
 buffer_load_dwordx4 v11, s[16:19], s45 offen  lds
 ds_read_b64_tr_b16 a[8:9], v8 offset:32768
 ds_read_b64_tr_b16 a[10:11], v8 offset:33792
 ds_read_b64_tr_b16 a[80:81], v9 offset:32768
 ds_read_b64_tr_b16 a[82:83], v9 offset:33792
 ds_read_b64_tr_b16 a[152:153], v8 offset:40960
 ds_read_b64_tr_b16 a[154:155], v8 offset:41984
 ds_read_b64_tr_b16 a[224:225], v9 offset:40960
 ds_read_b64_tr_b16 a[226:227], v9 offset:41984
 s_waitcnt vmcnt(8) lgkmcnt(0)
 s_barrier
 s_add_u32 m0, s49, 106496
 s_add_u32 s45, s32, 1572864
 buffer_load_dwordx4 v11, s[12:15], s45 offen  lds
 s_add_u32 m0, s49, 110592
 s_add_u32 s45, s32, 1703936
 buffer_load_dwordx4 v11, s[12:15], s45 offen  lds
 s_add_u32 m0, s49, 114688
 s_add_u32 s45, s33, 1572864
 buffer_load_dwordx4 v11, s[16:19], s45 offen  lds
 s_add_u32 m0, s49, 118784
 s_add_u32 s45, s33, 1703936
 buffer_load_dwordx4 v11, s[16:19], s45 offen  lds
 ds_read_b64_tr_b16 a[12:13], v8 offset:49152
 ds_read_b64_tr_b16 a[14:15], v8 offset:50176
 ds_read_b64_tr_b16 a[84:85], v9 offset:49152
 ds_read_b64_tr_b16 a[86:87], v9 offset:50176
 ds_read_b64_tr_b16 a[156:157], v8 offset:57344
 ds_read_b64_tr_b16 a[158:159], v8 offset:58368
 ds_read_b64_tr_b16 a[228:229], v9 offset:57344
 ds_read_b64_tr_b16 a[230:231], v9 offset:58368
 s_waitcnt vmcnt(8) lgkmcnt(0)
 s_barrier
 s_add_u32 m0, s49, 122880
 s_add_u32 s45, s32, 1835008
 buffer_load_dwordx4 v11, s[12:15], s45 offen  lds
 s_add_u32 m0, s49, 126976
 s_add_u32 s45, s32, 1966080
 buffer_load_dwordx4 v11, s[12:15], s45 offen  lds
 s_add_u32 m0, s49, 131072
 s_add_u32 s45, s33, 1835008
 buffer_load_dwordx4 v11, s[16:19], s45 offen  lds
 s_add_u32 m0, s49, 135168
 s_add_u32 s45, s33, 1966080
 buffer_load_dwordx4 v11, s[16:19], s45 offen  lds
 ds_read_b64_tr_b16 a[16:17], v8 offset:0
 ds_read_b64_tr_b16 a[18:19], v8 offset:1024
 ds_read_b64_tr_b16 a[88:89], v9 offset:0
 ds_read_b64_tr_b16 a[90:91], v9 offset:1024
 ds_read_b64_tr_b16 a[160:161], v8 offset:8192
 ds_read_b64_tr_b16 a[162:163], v8 offset:9216
 ds_read_b64_tr_b16 a[232:233], v9 offset:8192
 ds_read_b64_tr_b16 a[234:235], v9 offset:9216
 s_waitcnt vmcnt(8) lgkmcnt(0)
 s_barrier
 s_add_u32 m0, s49, 73728
 s_add_u32 s45, s32, 2097152
 buffer_load_dwordx4 v11, s[12:15], s45 offen  lds
 s_add_u32 m0, s49, 77824
 s_add_u32 s45, s32, 2228224
 buffer_load_dwordx4 v11, s[12:15], s45 offen  lds
 s_add_u32 m0, s49, 81920
 s_add_u32 s45, s33, 2097152
 buffer_load_dwordx4 v11, s[16:19], s45 offen  lds
 s_add_u32 m0, s49, 86016
 s_add_u32 s45, s33, 2228224
 buffer_load_dwordx4 v11, s[16:19], s45 offen  lds
 ds_read_b64_tr_b16 a[20:21], v8 offset:16384
 ds_read_b64_tr_b16 a[22:23], v8 offset:17408
 ds_read_b64_tr_b16 a[92:93], v9 offset:16384
 ds_read_b64_tr_b16 a[94:95], v9 offset:17408
 ds_read_b64_tr_b16 a[164:165], v8 offset:24576
 ds_read_b64_tr_b16 a[166:167], v8 offset:25600
 ds_read_b64_tr_b16 a[236:237], v9 offset:24576
 ds_read_b64_tr_b16 a[238:239], v9 offset:25600
 s_waitcnt vmcnt(8) lgkmcnt(0)
 s_barrier
 s_add_u32 m0, s49, 90112
 s_add_u32 s45, s32, 2359296
 buffer_load_dwordx4 v11, s[12:15], s45 offen  lds
 s_add_u32 m0, s49, 94208
 s_add_u32 s45, s32, 2490368
 buffer_load_dwordx4 v11, s[12:15], s45 offen  lds
 s_add_u32 m0, s49, 98304
 s_add_u32 s45, s33, 2359296
 buffer_load_dwordx4 v11, s[16:19], s45 offen  lds
 s_add_u32 m0, s49, 102400
 s_add_u32 s45, s33, 2490368
 buffer_load_dwordx4 v11, s[16:19], s45 offen  lds
 ds_read_b64_tr_b16 a[24:25], v8 offset:32768
 ds_read_b64_tr_b16 a[26:27], v8 offset:33792
 ds_read_b64_tr_b16 a[96:97], v9 offset:32768
 ds_read_b64_tr_b16 a[98:99], v9 offset:33792
 ds_read_b64_tr_b16 a[168:169], v8 offset:40960
 ds_read_b64_tr_b16 a[170:171], v8 offset:41984
 ds_read_b64_tr_b16 a[240:241], v9 offset:40960
 ds_read_b64_tr_b16 a[242:243], v9 offset:41984
 s_waitcnt vmcnt(8) lgkmcnt(0)
 s_barrier
 s_add_u32 m0, s49, 106496
 s_add_u32 s45, s32, 2621440
 buffer_load_dwordx4 v11, s[12:15], s45 offen  lds
 s_add_u32 m0, s49, 110592
 s_add_u32 s45, s32, 2752512
 buffer_load_dwordx4 v11, s[12:15], s45 offen  lds
 s_add_u32 m0, s49, 114688
 s_add_u32 s45, s33, 2621440
 buffer_load_dwordx4 v11, s[16:19], s45 offen  lds
 s_add_u32 m0, s49, 118784
 s_add_u32 s45, s33, 2752512
 buffer_load_dwordx4 v11, s[16:19], s45 offen  lds
 ds_read_b64_tr_b16 a[28:29], v8 offset:49152
 ds_read_b64_tr_b16 a[30:31], v8 offset:50176
 ds_read_b64_tr_b16 a[100:101], v9 offset:49152
 ds_read_b64_tr_b16 a[102:103], v9 offset:50176
 ds_read_b64_tr_b16 a[172:173], v8 offset:57344
 ds_read_b64_tr_b16 a[174:175], v8 offset:58368
 ds_read_b64_tr_b16 a[244:245], v9 offset:57344
 ds_read_b64_tr_b16 a[246:247], v9 offset:58368
 s_waitcnt vmcnt(8) lgkmcnt(0)
 s_barrier
 s_add_u32 m0, s49, 122880
 s_add_u32 s45, s32, 2883584
 buffer_load_dwordx4 v11, s[12:15], s45 offen  lds
 s_add_u32 m0, s49, 126976
 s_add_u32 s45, s32, 3014656
 buffer_load_dwordx4 v11, s[12:15], s45 offen  lds
 s_add_u32 m0, s49, 131072
 s_add_u32 s45, s33, 2883584
 buffer_load_dwordx4 v11, s[16:19], s45 offen  lds
 s_add_u32 m0, s49, 135168
 s_add_u32 s45, s33, 3014656
 buffer_load_dwordx4 v11, s[16:19], s45 offen  lds
 ds_read_b64_tr_b16 a[32:33], v8 offset:0
 ds_read_b64_tr_b16 a[34:35], v8 offset:1024
 ds_read_b64_tr_b16 a[104:105], v9 offset:0
 ds_read_b64_tr_b16 a[106:107], v9 offset:1024
 ds_read_b64_tr_b16 a[176:177], v8 offset:8192
 ds_read_b64_tr_b16 a[178:179], v8 offset:9216
 ds_read_b64_tr_b16 a[248:249], v9 offset:8192
 ds_read_b64_tr_b16 a[250:251], v9 offset:9216
 s_waitcnt vmcnt(8) lgkmcnt(0)
 s_barrier
 s_add_u32 m0, s49, 73728
 s_add_u32 s45, s32, 3145728
 buffer_load_dwordx4 v11, s[12:15], s45 offen  lds
 s_add_u32 m0, s49, 77824
 s_add_u32 s45, s32, 3276800
 buffer_load_dwordx4 v11, s[12:15], s45 offen  lds
 s_add_u32 m0, s49, 81920
 s_add_u32 s45, s33, 3145728
 buffer_load_dwordx4 v11, s[16:19], s45 offen  lds
 s_add_u32 m0, s49, 86016
 s_add_u32 s45, s33, 3276800
 buffer_load_dwordx4 v11, s[16:19], s45 offen  lds
 ds_read_b64_tr_b16 a[36:37], v8 offset:16384
 ds_read_b64_tr_b16 a[38:39], v8 offset:17408
 ds_read_b64_tr_b16 a[108:109], v9 offset:16384
 ds_read_b64_tr_b16 a[110:111], v9 offset:17408
 ds_read_b64_tr_b16 a[180:181], v8 offset:24576
 ds_read_b64_tr_b16 a[182:183], v8 offset:25600
 ds_read_b64_tr_b16 a[252:253], v9 offset:24576
 ds_read_b64_tr_b16 a[254:255], v9 offset:25600
 s_waitcnt vmcnt(8) lgkmcnt(0)
 s_barrier
 s_add_u32 m0, s49, 90112
 s_add_u32 s45, s32, 3407872
 buffer_load_dwordx4 v11, s[12:15], s45 offen  lds
 s_add_u32 m0, s49, 94208
 s_add_u32 s45, s32, 3538944
 buffer_load_dwordx4 v11, s[12:15], s45 offen  lds
 s_add_u32 m0, s49, 98304
 s_add_u32 s45, s33, 3407872
 buffer_load_dwordx4 v11, s[16:19], s45 offen  lds
 s_add_u32 m0, s49, 102400
 s_add_u32 s45, s33, 3538944
 buffer_load_dwordx4 v11, s[16:19], s45 offen  lds
 ds_read_b64_tr_b16 a[40:41], v8 offset:32768
 ds_read_b64_tr_b16 a[42:43], v8 offset:33792
 ds_read_b64_tr_b16 a[112:113], v9 offset:32768
 ds_read_b64_tr_b16 a[114:115], v9 offset:33792
 ds_read_b64_tr_b16 a[184:185], v8 offset:40960
 ds_read_b64_tr_b16 a[186:187], v8 offset:41984
 ds_read_b64_tr_b16 v[224:225], v9 offset:40960
 ds_read_b64_tr_b16 v[226:227], v9 offset:41984
 s_waitcnt vmcnt(8) lgkmcnt(0)
 s_barrier
 s_add_u32 m0, s49, 106496
 s_add_u32 s45, s32, 3670016
 buffer_load_dwordx4 v11, s[12:15], s45 offen  lds
 s_add_u32 m0, s49, 110592
 s_add_u32 s45, s32, 3801088
 buffer_load_dwordx4 v11, s[12:15], s45 offen  lds
 s_add_u32 m0, s49, 114688
 s_add_u32 s45, s33, 3670016
 buffer_load_dwordx4 v11, s[16:19], s45 offen  lds
 s_add_u32 m0, s49, 118784
 s_add_u32 s45, s33, 3801088
 buffer_load_dwordx4 v11, s[16:19], s45 offen  lds
 ds_read_b64_tr_b16 a[44:45], v8 offset:49152
 ds_read_b64_tr_b16 a[46:47], v8 offset:50176
 ds_read_b64_tr_b16 a[116:117], v9 offset:49152
 ds_read_b64_tr_b16 a[118:119], v9 offset:50176
 ds_read_b64_tr_b16 a[188:189], v8 offset:57344
 ds_read_b64_tr_b16 a[190:191], v8 offset:58368
 ds_read_b64_tr_b16 v[228:229], v9 offset:57344
 ds_read_b64_tr_b16 v[230:231], v9 offset:58368
 s_waitcnt vmcnt(8) lgkmcnt(0)
 s_barrier
 s_add_u32 m0, s49, 122880
 s_add_u32 s45, s32, 3932160
 buffer_load_dwordx4 v11, s[12:15], s45 offen  lds
 s_add_u32 m0, s49, 126976
 s_add_u32 s45, s32, 4063232
 buffer_load_dwordx4 v11, s[12:15], s45 offen  lds
 s_add_u32 m0, s49, 131072
 s_add_u32 s45, s33, 3932160
 buffer_load_dwordx4 v11, s[16:19], s45 offen  lds
 s_add_u32 m0, s49, 135168
 s_add_u32 s45, s33, 4063232
 buffer_load_dwordx4 v11, s[16:19], s45 offen  lds
 ds_read_b64_tr_b16 a[48:49], v8 offset:0
 ds_read_b64_tr_b16 a[50:51], v8 offset:1024
 ds_read_b64_tr_b16 a[120:121], v9 offset:0
 ds_read_b64_tr_b16 a[122:123], v9 offset:1024
 ds_read_b64_tr_b16 a[192:193], v8 offset:8192
 ds_read_b64_tr_b16 a[194:195], v8 offset:9216
 ds_read_b64_tr_b16 v[232:233], v9 offset:8192
 ds_read_b64_tr_b16 v[234:235], v9 offset:9216
 s_waitcnt vmcnt(8) lgkmcnt(0)
 s_barrier
 s_add_u32 m0, s49, 73728
 s_add_u32 s45, s32, 4194304
 buffer_load_dwordx4 v11, s[12:15], s45 offen  lds
 s_add_u32 m0, s49, 77824
 s_add_u32 s45, s32, 4325376
 buffer_load_dwordx4 v11, s[12:15], s45 offen  lds
 s_add_u32 m0, s49, 81920
 s_add_u32 s45, s33, 4194304
 buffer_load_dwordx4 v11, s[16:19], s45 offen  lds
 s_add_u32 m0, s49, 86016
 s_add_u32 s45, s33, 4325376
 buffer_load_dwordx4 v11, s[16:19], s45 offen  lds
 ds_read_b64_tr_b16 a[52:53], v8 offset:16384
 ds_read_b64_tr_b16 a[54:55], v8 offset:17408
 ds_read_b64_tr_b16 a[124:125], v9 offset:16384
 ds_read_b64_tr_b16 a[126:127], v9 offset:17408
 ds_read_b64_tr_b16 a[196:197], v8 offset:24576
 ds_read_b64_tr_b16 a[198:199], v8 offset:25600
 ds_read_b64_tr_b16 v[236:237], v9 offset:24576
 ds_read_b64_tr_b16 v[238:239], v9 offset:25600
 s_waitcnt vmcnt(8) lgkmcnt(0)
 s_barrier
 s_add_u32 m0, s49, 90112
 s_add_u32 s45, s32, 4456448
 buffer_load_dwordx4 v11, s[12:15], s45 offen  lds
 s_add_u32 m0, s49, 94208
 s_add_u32 s45, s32, 4587520
 buffer_load_dwordx4 v11, s[12:15], s45 offen  lds
 s_add_u32 m0, s49, 98304
 s_add_u32 s45, s33, 4456448
 buffer_load_dwordx4 v11, s[16:19], s45 offen  lds
 s_add_u32 m0, s49, 102400
 s_add_u32 s45, s33, 4587520
 buffer_load_dwordx4 v11, s[16:19], s45 offen  lds
 ds_read_b64_tr_b16 a[56:57], v8 offset:32768
 ds_read_b64_tr_b16 a[58:59], v8 offset:33792
 ds_read_b64_tr_b16 a[128:129], v9 offset:32768
 ds_read_b64_tr_b16 a[130:131], v9 offset:33792
 ds_read_b64_tr_b16 a[200:201], v8 offset:40960
 ds_read_b64_tr_b16 a[202:203], v8 offset:41984
 ds_read_b64_tr_b16 v[240:241], v9 offset:40960
 ds_read_b64_tr_b16 v[242:243], v9 offset:41984
 s_waitcnt vmcnt(8) lgkmcnt(0)
 s_barrier
 ds_read_b64_tr_b16 a[60:61], v8 offset:49152
 ds_read_b64_tr_b16 a[62:63], v8 offset:50176
 ds_read_b64_tr_b16 a[132:133], v9 offset:49152
 ds_read_b64_tr_b16 a[134:135], v9 offset:50176
 ds_read_b64_tr_b16 a[204:205], v8 offset:57344
 ds_read_b64_tr_b16 a[206:207], v8 offset:58368
 ds_read_b64_tr_b16 v[244:245], v9 offset:57344
 ds_read_b64_tr_b16 v[246:247], v9 offset:58368
 s_waitcnt vmcnt(4) lgkmcnt(0)
 s_barrier
 ds_read_b64_tr_b16 a[64:65], v8 offset:0
 ds_read_b64_tr_b16 a[66:67], v8 offset:1024
 ds_read_b64_tr_b16 a[136:137], v9 offset:0
 ds_read_b64_tr_b16 a[138:139], v9 offset:1024
 ds_read_b64_tr_b16 a[208:209], v8 offset:8192
 ds_read_b64_tr_b16 a[210:211], v8 offset:9216
 ds_read_b64_tr_b16 v[248:249], v9 offset:8192
 ds_read_b64_tr_b16 v[250:251], v9 offset:9216
 s_waitcnt vmcnt(0) lgkmcnt(0)
 s_barrier
 ds_read_b64_tr_b16 a[68:69], v8 offset:16384
 ds_read_b64_tr_b16 a[70:71], v8 offset:17408
 ds_read_b64_tr_b16 a[140:141], v9 offset:16384
 ds_read_b64_tr_b16 a[142:143], v9 offset:17408
 ds_read_b64_tr_b16 a[212:213], v8 offset:24576
 ds_read_b64_tr_b16 a[214:215], v8 offset:25600
 ds_read_b64_tr_b16 v[252:253], v9 offset:24576
 ds_read_b64_tr_b16 v[254:255], v9 offset:25600
 s_mov_b32 s50, 0x3e0293ee
 s_mov_b32 s42, 0
 s_mov_b32 s43, 0
 s_mov_b32 s44, 73728
 v_mov_b32 v6, v4
 v_mov_b32 v7, v5
 v_and_b32 v17, 63, v0
 v_lshlrev_b32 v1, 4, v17
 s_lshl_b32 s45, s4, 11
 s_add_u32 s45, s45, 147456
 v_add_u32 v2, s45, v1
 s_lshr_b32 s53, s4, 1
 s_and_b32 s54, s4, 1
 s_add_u32 s52, s52, s53
 s_lshl_b32 s53, s53, 13
 s_lshl_b32 s54, s54, 10
 s_add_u32 s45, s53, s54
 s_add_u32 s45, s45, 147456
 v_add_u32 v3, s45, v1
 s_lshl_b32 s63, s52, 13
 s_add_u32 s63, s63, s54
 s_add_u32 s63, s63, 0x7000000
 s_lshl_b32 s61, s52, 14
 s_add_u32 s61, s61, 0x3000000
 s_lshl_b32 s62, s52, 12
 s_add_u32 s62, s62, 0x400000
 s_lshl_b32 s57, s52, 7
 s_add_u32 s57, s57, 0x1000
 s_waitcnt lgkmcnt(0)
 v_min_u32 v8, 1, v0
 v_lshlrev_b32 v8, 28, v8
 s_mov_b32 s58, 0x40000
 v_mov_b32 v13, 0
 v_mov_b32 v14, 0
 v_min_u32 v15, 1, v17
 v_lshlrev_b32 v15, 28, v15
 v_bfe_u32 v18, v17, 3, 2
 v_and_b32 v19, 7, v17
 v_lshlrev_b32 v19, 7, v19
 v_lshl_add_u32 v18, v18, 11, v19
 v_lshrrev_b32 v19, 5, v17
 v_lshl_or_b32 v11, v19, 28, v18
 s_mov_b32 s56, s61
 v_mov_b32 v18, 0x44444444
 v_mov_b32 v19, 0xeeeeeeee
 v_and_b32 v20, 2, v17
 v_cmp_eq_u32 vcc, 0, v20
 s_nop 1
 v_cndmask_b32 v12, v19, v18, vcc
 v_mov_b32 v217, 0
 v_mov_b32 v218, 0
 v_mov_b32 v220, 0x3f803f80
 v_mov_b32 v221, 0x3f803f80
 v_mov_b32 v222, 0x3f803f80
 v_mov_b32 v223, 0x3f803f80
 v_and_b32 v18, 15, v17
 v_lshrrev_b32 v19, 4, v17
 v_lshlrev_b32 v19, 2, v19
 v_sub_u32 v18, v18, v19
 s_lshr_b32 s45, s54, 6
 v_add_u32 v18, s45, v18
 v_mov_b32 v19, 0xff800000
 v_cmp_le_i32 vcc, 0, v18
 s_nop 1
 v_cndmask_b32 v208, v19, v13, vcc
 v_cmp_le_i32 vcc, 1, v18
 s_nop 1
 v_cndmask_b32 v209, v19, v13, vcc
 v_cmp_le_i32 vcc, 2, v18
 s_nop 1
 v_cndmask_b32 v210, v19, v13, vcc
 v_cmp_le_i32 vcc, 3, v18
 s_nop 1
 v_cndmask_b32 v211, v19, v13, vcc
 v_cmp_le_i32 vcc, 16, v18
 s_nop 1
 v_cndmask_b32 v212, v19, v13, vcc
 v_cmp_le_i32 vcc, 17, v18
 s_nop 1
 v_cndmask_b32 v213, v19, v13, vcc
 v_cmp_le_i32 vcc, 18, v18
 s_nop 1
 v_cndmask_b32 v214, v19, v13, vcc
 v_cmp_le_i32 vcc, 19, v18
 s_nop 1
 v_cndmask_b32 v215, v19, v13, vcc
 s_sub_u32 s53, s57, 4096
 s_add_u32 s60, s39, 1
Lqs_38:
 buffer_load_dword v16, v15, s[20:23], s53 offen sc1
 s_waitcnt vmcnt(0)
 v_cmp_le_u32 vcc, s60, v16
 s_cbranch_vccnz Lqsk_39
 s_sleep 2
 s_sub_u32 s58, s58, 1
 s_cbranch_scc0 Lqs_38
 s_endpgm
Lqsk_39:
 s_waitcnt vmcnt(0) lgkmcnt(0)
 s_barrier
 ds_read_b128 v[32:35], v6 offset:0
 ds_read_b128 v[36:39], v6 offset:2048
 ds_read_b128 v[40:43], v7 offset:0
 ds_read_b128 v[44:47], v7 offset:2048
 s_waitcnt lgkmcnt(2)
Lqb_loop_40:
 v_mfma_f32_16x16x32_bf16 v[64:67], a[0:3], v[32:35], 0
 ds_read_b128 v[48:51], v6 offset:4096
 v_mfma_f32_16x16x32_bf16 v[72:75], a[72:75], v[32:35], 0
 ds_read_b128 v[52:55], v6 offset:6144
 v_mfma_f32_16x16x32_bf16 v[80:83], a[144:147], v[32:35], 0
 s_add_u32 s41, s40, 2
 v_mfma_f32_16x16x32_bf16 v[88:91], a[216:219], v[32:35], 0
 s_add_u32 s45, s42, 2
 s_mul_i32 s46, s41, 36864
 v_mfma_f32_16x16x32_bf16 v[68:71], a[0:3], v[36:39], 0
 s_cmp_lt_u32 s45, s36
 s_cselect_b32 s46, s46, 0
 v_mfma_f32_16x16x32_bf16 v[76:79], a[72:75], v[36:39], 0
 s_lshl_b32 s49, s4, 10
 s_add_u32 s49, s49, s44
 v_mfma_f32_16x16x32_bf16 v[84:87], a[144:147], v[36:39], 0
 s_lshl_b32 s53, s39, 19
 s_add_u32 s53, s53, s61
 v_mfma_f32_16x16x32_bf16 v[92:95], a[216:219], v[36:39], 0
 s_waitcnt lgkmcnt(2)
 v_mfma_f32_16x16x32_bf16 v[64:67], a[4:7], v[40:43], v[64:67]
 ds_read_b128 v[56:59], v7 offset:4096
 v_mfma_f32_16x16x32_bf16 v[72:75], a[76:79], v[40:43], v[72:75]
 ds_read_b128 v[60:63], v7 offset:6144
 v_mfma_f32_16x16x32_bf16 v[80:83], a[148:151], v[40:43], v[80:83]
 s_add_u32 m0, s49, 0
 v_mfma_f32_16x16x32_bf16 v[88:91], a[220:223], v[40:43], v[88:91]
 buffer_load_dwordx4 v10, s[8:11], s46 offen offset:0  lds
 v_mfma_f32_16x16x32_bf16 v[68:71], a[4:7], v[44:47], v[68:71]
 s_add_u32 m0, s49, 3968
 v_mfma_f32_16x16x32_bf16 v[76:79], a[76:79], v[44:47], v[76:79]
 buffer_load_dwordx4 v10, s[8:11], s46 offen offset:128  lds
 v_mfma_f32_16x16x32_bf16 v[84:87], a[148:151], v[44:47], v[84:87]
 s_lshl_b32 s55, s39, 17
 s_add_u32 s55, s55, s62
 v_mfma_f32_16x16x32_bf16 v[92:95], a[220:223], v[44:47], v[92:95]
 s_waitcnt lgkmcnt(2)
 v_mfma_f32_16x16x32_bf16 v[64:67], a[8:11], v[48:51], v[64:67]
 ds_read_b128 v[32:35], v6 offset:8192
 v_mfma_f32_16x16x32_bf16 v[72:75], a[80:83], v[48:51], v[72:75]
 ds_read_b128 v[36:39], v6 offset:10240
 v_mfma_f32_16x16x32_bf16 v[80:83], a[152:155], v[48:51], v[80:83]
 s_add_u32 m0, s49, 7936
 v_mfma_f32_16x16x32_bf16 v[88:91], a[224:227], v[48:51], v[88:91]
 buffer_load_dwordx4 v10, s[8:11], s46 offen offset:256  lds
 v_mfma_f32_16x16x32_bf16 v[68:71], a[8:11], v[52:55], v[68:71]
 s_add_u32 m0, s49, 11904
 v_mfma_f32_16x16x32_bf16 v[76:79], a[80:83], v[52:55], v[76:79]
 buffer_load_dwordx4 v10, s[8:11], s46 offen offset:384  lds
 v_mfma_f32_16x16x32_bf16 v[84:87], a[152:155], v[52:55], v[84:87]
 v_mfma_f32_16x16x32_bf16 v[92:95], a[224:227], v[52:55], v[92:95]
 s_waitcnt lgkmcnt(2)
 v_mfma_f32_16x16x32_bf16 v[64:67], a[12:15], v[56:59], v[64:67]
 ds_read_b128 v[40:43], v7 offset:8192
 v_mfma_f32_16x16x32_bf16 v[72:75], a[84:87], v[56:59], v[72:75]
 ds_read_b128 v[44:47], v7 offset:10240
 v_mfma_f32_16x16x32_bf16 v[80:83], a[156:159], v[56:59], v[80:83]
 s_add_u32 m0, s49, 15872
 v_mfma_f32_16x16x32_bf16 v[88:91], a[228:231], v[56:59], v[88:91]
 buffer_load_dwordx4 v10, s[8:11], s46 offen offset:512  lds
 v_mfma_f32_16x16x32_bf16 v[68:71], a[12:15], v[60:63], v[68:71]
 s_add_u32 m0, s49, 19840
 v_mfma_f32_16x16x32_bf16 v[76:79], a[84:87], v[60:63], v[76:79]
 buffer_load_dwordx4 v10, s[8:11], s46 offen offset:640  lds
 v_mfma_f32_16x16x32_bf16 v[84:87], a[156:159], v[60:63], v[84:87]
 s_add_u32 s60, s39, 1
 v_mfma_f32_16x16x32_bf16 v[92:95], a[228:231], v[60:63], v[92:95]
 s_waitcnt lgkmcnt(2)
 v_mfma_f32_16x16x32_bf16 v[64:67], a[16:19], v[32:35], v[64:67]
 ds_read_b128 v[48:51], v6 offset:12288
 v_mfma_f32_16x16x32_bf16 v[72:75], a[88:91], v[32:35], v[72:75]
 ds_read_b128 v[52:55], v6 offset:14336
 v_mfma_f32_16x16x32_bf16 v[80:83], a[160:163], v[32:35], v[80:83]
 s_add_u32 m0, s49, 23808
 v_mfma_f32_16x16x32_bf16 v[88:91], a[232:235], v[32:35], v[88:91]
 buffer_load_dwordx4 v10, s[8:11], s46 offen offset:768  lds
 v_mfma_f32_16x16x32_bf16 v[68:71], a[16:19], v[36:39], v[68:71]
 s_add_u32 m0, s49, 27776
 v_mfma_f32_16x16x32_bf16 v[76:79], a[88:91], v[36:39], v[76:79]
 buffer_load_dwordx4 v10, s[8:11], s46 offen offset:896  lds
 v_mfma_f32_16x16x32_bf16 v[84:87], a[160:163], v[36:39], v[84:87]
 v_mfma_f32_16x16x32_bf16 v[92:95], a[232:235], v[36:39], v[92:95]
 s_waitcnt lgkmcnt(2)
 v_mfma_f32_16x16x32_bf16 v[64:67], a[20:23], v[40:43], v[64:67]
 ds_read_b128 v[56:59], v7 offset:12288
 v_mfma_f32_16x16x32_bf16 v[72:75], a[92:95], v[40:43], v[72:75]
 ds_read_b128 v[60:63], v7 offset:14336
 v_mfma_f32_16x16x32_bf16 v[80:83], a[164:167], v[40:43], v[80:83]
 s_add_u32 m0, s49, 31744
 v_mfma_f32_16x16x32_bf16 v[88:91], a[236:239], v[40:43], v[88:91]
 buffer_load_dwordx4 v10, s[8:11], s46 offen offset:1024  lds
 v_mfma_f32_16x16x32_bf16 v[68:71], a[20:23], v[44:47], v[68:71]
 v_mfma_f32_16x16x32_bf16 v[76:79], a[92:95], v[44:47], v[76:79]
 v_mfma_f32_16x16x32_bf16 v[84:87], a[164:167], v[44:47], v[84:87]
 v_mfma_f32_16x16x32_bf16 v[92:95], a[236:239], v[44:47], v[92:95]
 s_waitcnt lgkmcnt(2)
 v_mfma_f32_16x16x32_bf16 v[64:67], a[24:27], v[48:51], v[64:67]
 ds_read_b128 v[32:35], v6 offset:16384
 v_mfma_f32_16x16x32_bf16 v[72:75], a[96:99], v[48:51], v[72:75]
 ds_read_b128 v[36:39], v6 offset:18432
 v_mfma_f32_16x16x32_bf16 v[80:83], a[168:171], v[48:51], v[80:83]
 s_waitcnt vmcnt(9)
 buffer_load_dword v17, v11, s[20:23], s56 offen sc1
 v_mfma_f32_16x16x32_bf16 v[88:91], a[240:243], v[48:51], v[88:91]
 s_barrier
 buffer_store_dword v14, v8, s[20:23], s59 offen sc1
 v_mfma_f32_16x16x32_bf16 v[68:71], a[24:27], v[52:55], v[68:71]
 buffer_load_dword v16, v15, s[20:23], s57 offen sc1
 v_mfma_f32_16x16x32_bf16 v[76:79], a[96:99], v[52:55], v[76:79]
 v_mfma_f32_16x16x32_bf16 v[84:87], a[168:171], v[52:55], v[84:87]
 s_lshl_b32 s56, s39, 18
 s_add_u32 s56, s56, s63
 v_mfma_f32_16x16x32_bf16 v[92:95], a[240:243], v[52:55], v[92:95]
 s_waitcnt lgkmcnt(2)
 v_mfma_f32_16x16x32_bf16 v[64:67], a[28:31], v[56:59], v[64:67]
 ds_read_b128 v[40:43], v7 offset:16384
 v_mfma_f32_16x16x32_bf16 v[72:75], a[100:103], v[56:59], v[72:75]
 ds_read_b128 v[44:47], v7 offset:18432
 v_mfma_f32_16x16x32_bf16 v[80:83], a[172:175], v[56:59], v[80:83]
 buffer_load_dwordx4 v[128:131], v1, s[20:23], s53 offen offset:0 sc1
 v_mfma_f32_16x16x32_bf16 v[88:91], a[244:247], v[56:59], v[88:91]
 v_mfma_f32_16x16x32_bf16 v[68:71], a[28:31], v[60:63], v[68:71]
 buffer_load_dwordx4 v[132:135], v1, s[20:23], s53 offen offset:1024 sc1
 v_mfma_f32_16x16x32_bf16 v[76:79], a[100:103], v[60:63], v[76:79]
 v_mfma_f32_16x16x32_bf16 v[84:87], a[172:175], v[60:63], v[84:87]
 v_mfma_f32_16x16x32_bf16 v[92:95], a[244:247], v[60:63], v[92:95]
 s_waitcnt lgkmcnt(2)
 v_mfma_f32_16x16x32_bf16 v[64:67], a[32:35], v[32:35], v[64:67]
 ds_read_b128 v[48:51], v6 offset:20480
 v_mfma_f32_16x16x32_bf16 v[72:75], a[104:107], v[32:35], v[72:75]
 ds_read_b128 v[52:55], v6 offset:22528
 v_mfma_f32_16x16x32_bf16 v[80:83], a[176:179], v[32:35], v[80:83]
 buffer_load_dwordx4 v[136:139], v1, s[20:23], s53 offen offset:2048 sc1
 v_mfma_f32_16x16x32_bf16 v[88:91], a[248:251], v[32:35], v[88:91]
 v_mfma_f32_16x16x32_bf16 v[68:71], a[32:35], v[36:39], v[68:71]
 buffer_load_dwordx4 v[140:143], v1, s[20:23], s53 offen offset:3072 sc1
 v_mfma_f32_16x16x32_bf16 v[76:79], a[104:107], v[36:39], v[76:79]
 v_mfma_f32_16x16x32_bf16 v[84:87], a[176:179], v[36:39], v[84:87]
 s_add_u32 s53, s53, 4096
 v_mfma_f32_16x16x32_bf16 v[92:95], a[248:251], v[36:39], v[92:95]
 s_waitcnt lgkmcnt(2)
 v_mfma_f32_16x16x32_bf16 v[64:67], a[36:39], v[40:43], v[64:67]
 ds_read_b128 v[56:59], v7 offset:20480
 v_mfma_f32_16x16x32_bf16 v[72:75], a[108:111], v[40:43], v[72:75]
 ds_read_b128 v[60:63], v7 offset:22528
 v_mfma_f32_16x16x32_bf16 v[80:83], a[180:183], v[40:43], v[80:83]
 buffer_load_dwordx4 v[144:147], v1, s[20:23], s53 offen offset:0 sc1
 v_mfma_f32_16x16x32_bf16 v[88:91], a[252:255], v[40:43], v[88:91]
 v_mfma_f32_16x16x32_bf16 v[68:71], a[36:39], v[44:47], v[68:71]
 buffer_load_dwordx4 v[148:151], v1, s[20:23], s53 offen offset:1024 sc1
 v_mfma_f32_16x16x32_bf16 v[76:79], a[108:111], v[44:47], v[76:79]
 v_mfma_f32_16x16x32_bf16 v[84:87], a[180:183], v[44:47], v[84:87]
 v_mfma_f32_16x16x32_bf16 v[92:95], a[252:255], v[44:47], v[92:95]
 s_waitcnt lgkmcnt(2)
 v_mfma_f32_16x16x32_bf16 v[64:67], a[40:43], v[48:51], v[64:67]
 ds_read_b128 v[32:35], v6 offset:24576
 v_mfma_f32_16x16x32_bf16 v[72:75], a[112:115], v[48:51], v[72:75]
 ds_read_b128 v[36:39], v6 offset:26624
 v_mfma_f32_16x16x32_bf16 v[80:83], a[184:187], v[48:51], v[80:83]
 buffer_load_dwordx4 v[152:155], v1, s[20:23], s53 offen offset:2048 sc1
 v_mfma_f32_16x16x32_bf16 v[88:91], v[224:227], v[48:51], v[88:91]
 v_mfma_f32_16x16x32_bf16 v[68:71], a[40:43], v[52:55], v[68:71]
 buffer_load_dwordx4 v[156:159], v1, s[20:23], s53 offen offset:3072 sc1
 v_mfma_f32_16x16x32_bf16 v[76:79], a[112:115], v[52:55], v[76:79]
 v_mfma_f32_16x16x32_bf16 v[84:87], a[184:187], v[52:55], v[84:87]
 s_add_u32 s53, s53, 4096
 v_mfma_f32_16x16x32_bf16 v[92:95], v[224:227], v[52:55], v[92:95]
 s_waitcnt lgkmcnt(2)
 v_mfma_f32_16x16x32_bf16 v[64:67], a[44:47], v[56:59], v[64:67]
 ds_read_b128 v[40:43], v7 offset:24576
 v_mfma_f32_16x16x32_bf16 v[72:75], a[116:119], v[56:59], v[72:75]
 ds_read_b128 v[44:47], v7 offset:26624
 v_mfma_f32_16x16x32_bf16 v[80:83], a[188:191], v[56:59], v[80:83]
 buffer_load_dwordx4 v[160:163], v1, s[20:23], s53 offen offset:0 sc1
 v_mfma_f32_16x16x32_bf16 v[88:91], v[228:231], v[56:59], v[88:91]
 v_mfma_f32_16x16x32_bf16 v[68:71], a[44:47], v[60:63], v[68:71]
 buffer_load_dwordx4 v[164:167], v1, s[20:23], s53 offen offset:1024 sc1
 v_mfma_f32_16x16x32_bf16 v[76:79], a[116:119], v[60:63], v[76:79]
 v_mfma_f32_16x16x32_bf16 v[84:87], a[188:191], v[60:63], v[84:87]
 v_mfma_f32_16x16x32_bf16 v[92:95], v[228:231], v[60:63], v[92:95]
 s_waitcnt lgkmcnt(2)
 v_mfma_f32_16x16x32_bf16 v[64:67], a[48:51], v[32:35], v[64:67]
 ds_read_b128 v[48:51], v6 offset:28672
 v_mfma_f32_16x16x32_bf16 v[72:75], a[120:123], v[32:35], v[72:75]
 ds_read_b128 v[52:55], v6 offset:30720
 v_mfma_f32_16x16x32_bf16 v[80:83], a[192:195], v[32:35], v[80:83]
 buffer_load_dwordx4 v[168:171], v1, s[20:23], s53 offen offset:2048 sc1
 v_mfma_f32_16x16x32_bf16 v[88:91], v[232:235], v[32:35], v[88:91]
 v_mfma_f32_16x16x32_bf16 v[68:71], a[48:51], v[36:39], v[68:71]
 buffer_load_dwordx4 v[172:175], v1, s[20:23], s53 offen offset:3072 sc1
 v_mfma_f32_16x16x32_bf16 v[76:79], a[120:123], v[36:39], v[76:79]
 v_mfma_f32_16x16x32_bf16 v[84:87], a[192:195], v[36:39], v[84:87]
 s_add_u32 s53, s53, 4096
 v_mfma_f32_16x16x32_bf16 v[92:95], v[232:235], v[36:39], v[92:95]
 s_waitcnt lgkmcnt(2)
 v_mfma_f32_16x16x32_bf16 v[64:67], a[52:55], v[40:43], v[64:67]
 ds_read_b128 v[56:59], v7 offset:28672
 v_mfma_f32_16x16x32_bf16 v[72:75], a[124:127], v[40:43], v[72:75]
 ds_read_b128 v[60:63], v7 offset:30720
 v_mfma_f32_16x16x32_bf16 v[80:83], a[196:199], v[40:43], v[80:83]
 s_add_u32 s43, s43, 36864
 s_cmp_eq_u32 s43, 147456
 buffer_load_dwordx4 v[176:179], v1, s[20:23], s53 offen offset:0 sc1
 v_mfma_f32_16x16x32_bf16 v[88:91], v[236:239], v[40:43], v[88:91]
 s_cselect_b32 s43, 0, s43
 s_add_u32 s44, s44, 36864
 v_mfma_f32_16x16x32_bf16 v[68:71], a[52:55], v[44:47], v[68:71]
 s_cmp_eq_u32 s44, 147456
 s_cselect_b32 s44, 0, s44
 buffer_load_dwordx4 v[180:183], v1, s[20:23], s53 offen offset:1024 sc1
 v_mfma_f32_16x16x32_bf16 v[76:79], a[124:127], v[44:47], v[76:79]
 v_mfma_f32_16x16x32_bf16 v[84:87], a[196:199], v[44:47], v[84:87]
 v_mfma_f32_16x16x32_bf16 v[92:95], v[236:239], v[44:47], v[92:95]
 s_waitcnt lgkmcnt(2)
 v_mfma_f32_16x16x32_bf16 v[64:67], a[56:59], v[48:51], v[64:67]
 ds_read_b128 v[32:35], v6 offset:32768
 v_mfma_f32_16x16x32_bf16 v[72:75], a[128:131], v[48:51], v[72:75]
 ds_read_b128 v[36:39], v6 offset:34816
 v_mfma_f32_16x16x32_bf16 v[80:83], a[200:203], v[48:51], v[80:83]
 v_add_u32 v6, s43, v4
 buffer_load_dwordx4 v[184:187], v1, s[20:23], s53 offen offset:2048 sc1
 v_mfma_f32_16x16x32_bf16 v[88:91], v[240:243], v[48:51], v[88:91]
 v_mfma_f32_16x16x32_bf16 v[68:71], a[56:59], v[52:55], v[68:71]
 buffer_load_dwordx4 v[188:191], v1, s[20:23], s53 offen offset:3072 sc1
 v_mfma_f32_16x16x32_bf16 v[76:79], a[128:131], v[52:55], v[76:79]
 v_mfma_f32_16x16x32_bf16 v[84:87], a[200:203], v[52:55], v[84:87]
 v_mfma_f32_16x16x32_bf16 v[92:95], v[240:243], v[52:55], v[92:95]
 s_waitcnt lgkmcnt(2)
 v_mfma_f32_16x16x32_bf16 v[64:67], a[60:63], v[56:59], v[64:67]
 ds_read_b128 v[40:43], v7 offset:32768
 v_mfma_f32_16x16x32_bf16 v[72:75], a[132:135], v[56:59], v[72:75]
 ds_read_b128 v[44:47], v7 offset:34816
 v_mfma_f32_16x16x32_bf16 v[80:83], a[204:207], v[56:59], v[80:83]
 v_add_u32 v7, s43, v5
 v_mfma_f32_16x16x32_bf16 v[88:91], v[244:247], v[56:59], v[88:91]
 v_mfma_f32_16x16x32_bf16 v[68:71], a[60:63], v[60:63], v[68:71]
 v_mfma_f32_16x16x32_bf16 v[76:79], a[132:135], v[60:63], v[76:79]
 v_mfma_f32_16x16x32_bf16 v[84:87], a[204:207], v[60:63], v[84:87]
 v_mfma_f32_16x16x32_bf16 v[92:95], v[244:247], v[60:63], v[92:95]
 s_waitcnt lgkmcnt(2)
 v_mfma_f32_16x16x32_bf16 v[64:67], a[64:67], v[32:35], v[64:67]
 s_waitcnt vmcnt(28)
 s_barrier
 ds_read_b128 v[48:51], v6 offset:0
 v_mfma_f32_16x16x32_bf16 v[72:75], a[136:139], v[32:35], v[72:75]
 ds_read_b128 v[52:55], v6 offset:2048
 v_mfma_f32_16x16x32_bf16 v[80:83], a[208:211], v[32:35], v[80:83]
 v_mfma_f32_16x16x32_bf16 v[88:91], v[248:251], v[32:35], v[88:91]
 s_waitcnt vmcnt(16)
 v_cmp_le_u32 vcc, s60, v16
 v_mfma_f32_16x16x32_bf16 v[68:71], a[64:67], v[36:39], v[68:71]
 v_mfma_f32_16x16x32_bf16 v[76:79], a[136:139], v[36:39], v[76:79]
 s_and_b32 s64, vcc_lo, 1
 s_cbranch_scc0 Lqsk_42
 buffer_load_dwordx4 v[192:195], v1, s[20:23], s55 offen offset:0 sc1
 buffer_load_dwordx4 v[196:199], v1, s[20:23], s55 offen offset:1024 sc1
 buffer_load_dwordx4 v[200:203], v1, s[20:23], s55 offen offset:2048 sc1
 buffer_load_dwordx4 v[204:207], v1, s[20:23], s55 offen offset:3072 sc1
Lqsk_42:
 v_mfma_f32_16x16x32_bf16 v[84:87], a[208:211], v[36:39], v[84:87]
 v_mfma_f32_16x16x32_bf16 v[92:95], v[248:251], v[36:39], v[92:95]
 s_waitcnt lgkmcnt(2)
 v_mfma_f32_16x16x32_bf16 v[64:67], a[68:71], v[40:43], v[64:67]
 ds_read_b128 v[56:59], v7 offset:0
 v_mfma_f32_16x16x32_bf16 v[72:75], a[140:143], v[40:43], v[72:75]
 ds_read_b128 v[60:63], v7 offset:2048
 v_mfma_f32_16x16x32_bf16 v[80:83], a[212:215], v[40:43], v[80:83]
 v_mfma_f32_16x16x32_bf16 v[88:91], v[252:255], v[40:43], v[88:91]
 s_mov_b32 s39, s40
 s_mov_b32 s40, s41
 v_mfma_f32_16x16x32_bf16 v[68:71], a[68:71], v[44:47], v[68:71]
 s_add_u32 s42, s42, 1
 v_mov_b32 v14, s42
 v_mfma_f32_16x16x32_bf16 v[76:79], a[140:143], v[44:47], v[76:79]
 v_mfma_f32_16x16x32_bf16 v[84:87], a[212:215], v[44:47], v[84:87]
 v_mfma_f32_16x16x32_bf16 v[92:95], v[252:255], v[44:47], v[92:95]
 s_waitcnt lgkmcnt(2)
 s_nop 7
 v_cvt_pk_bf16_f32 v16, v64, v72
 v_cvt_pk_bf16_f32 v17, v65, v73
 v_cvt_pk_bf16_f32 v18, v66, v74
 v_cvt_pk_bf16_f32 v19, v67, v75
 ds_write_b128 v2, v[16:19] offset:0
 v_cvt_pk_bf16_f32 v20, v68, v76
 v_cvt_pk_bf16_f32 v21, v69, v77
 v_cvt_pk_bf16_f32 v22, v70, v78
 v_cvt_pk_bf16_f32 v23, v71, v79
 ds_write_b128 v2, v[20:23] offset:1024
 v_cvt_pk_bf16_f32 v24, v80, v88
 v_cvt_pk_bf16_f32 v25, v81, v89
 v_cvt_pk_bf16_f32 v26, v82, v90
 v_cvt_pk_bf16_f32 v27, v83, v91
 ds_write_b128 v2, v[24:27] offset:8192
 v_cvt_pk_bf16_f32 v28, v84, v92
 v_cvt_pk_bf16_f32 v29, v85, v93
 v_cvt_pk_bf16_f32 v30, v86, v94
 v_cvt_pk_bf16_f32 v31, v87, v95
 ds_write_b128 v2, v[28:31] offset:9216
 v_mov_b64 v[120:121], 0
 v_mov_b64 v[122:123], 0
 s_waitcnt lgkmcnt(0)
 s_barrier
 ds_read_b128 v[96:99], v3 offset:0
 ds_read_b128 v[100:103], v3 offset:2048
 ds_read_b128 v[104:107], v3 offset:4096
 ds_read_b128 v[108:111], v3 offset:6144
 s_cmp_lg_u32 s64, 0
 s_cbranch_scc1 Lqpre_43
Lqs_44:
 buffer_load_dword v16, v15, s[20:23], s57 offen sc1
 s_waitcnt vmcnt(0)
 v_cmp_le_u32 vcc, s60, v16
 s_cbranch_vccnz Lqsk_45
 s_sleep 2
 s_sub_u32 s58, s58, 1
 s_cbranch_scc0 Lqs_44
 s_endpgm
Lqsk_45:
 buffer_load_dwordx4 v[192:195], v1, s[20:23], s55 offen offset:0 sc1
 buffer_load_dwordx4 v[196:199], v1, s[20:23], s55 offen offset:1024 sc1
 buffer_load_dwordx4 v[200:203], v1, s[20:23], s55 offen offset:2048 sc1
 buffer_load_dwordx4 v[204:207], v1, s[20:23], s55 offen offset:3072 sc1
Lqpre_43:
 s_waitcnt vmcnt(4) lgkmcnt(0)
 v_mfma_f32_16x16x32_bf16 v[112:115], v[128:131], v[96:99], v[208:211]
 v_mfma_f32_16x16x32_bf16 v[116:119], v[132:135], v[96:99], v[212:215]
 v_mfma_f32_16x16x32_bf16 v[112:115], v[136:139], v[100:103], v[112:115]
 v_mfma_f32_16x16x32_bf16 v[116:119], v[140:143], v[100:103], v[116:119]
 v_mfma_f32_16x16x32_bf16 v[112:115], v[144:147], v[104:107], v[112:115]
 v_mfma_f32_16x16x32_bf16 v[116:119], v[148:151], v[104:107], v[116:119]
 v_mfma_f32_16x16x32_bf16 v[112:115], v[152:155], v[108:111], v[112:115]
 v_mfma_f32_16x16x32_bf16 v[116:119], v[156:159], v[108:111], v[116:119]
 s_nop 7
 v_max3_f32 v24, v112, v113, v114
 v_max3_f32 v24, v24, v115, v116
 v_max3_f32 v24, v24, v117, v118
 v_max_f32 v24, v24, v119
 s_waitcnt vmcnt(2)
 v_mov_b64 v[16:17], v[192:193]
 v_mov_b64 v[18:19], v[196:197]
 s_nop 1
 v_smfmac_f32_16x16x64_bf16 v[120:123], v[16:19], v[96:103], v12
 s_waitcnt vmcnt(0)
 v_mov_b64 v[20:21], v[200:201]
 v_mov_b64 v[22:23], v[204:205]
 s_nop 1
 v_smfmac_f32_16x16x64_bf16 v[120:123], v[20:23], v[104:111], v12
 s_nop 7
 v_add_f32 v120, v120, v122
 v_add_f32 v121, v121, v123
 v_mul_f32 v120, s50, v120
 v_mul_f32 v121, s50, v121
 v_max3_f32 v24, v24, v120, v121
 v_mov_b32 v25, v24
 s_nop 1
 v_permlane16_swap_b32 v24, v25
 v_max_f32 v24, v24, v25
 v_mov_b32 v25, v24
 s_nop 1
 v_permlane32_swap_b32 v24, v25
 v_max_f32 v24, v24, v25
 v_sub_f32 v112, v112, v24
 v_sub_f32 v113, v113, v24
 v_sub_f32 v114, v114, v24
 v_sub_f32 v115, v115, v24
 v_sub_f32 v116, v116, v24
 v_sub_f32 v117, v117, v24
 v_sub_f32 v118, v118, v24
 v_sub_f32 v119, v119, v24
 v_sub_f32 v120, v120, v24
 v_sub_f32 v121, v121, v24
 v_exp_f32 v120, v120
 v_exp_f32 v121, v121
 v_exp_f32 v112, v112
 v_exp_f32 v113, v113
 v_exp_f32 v114, v114
 v_exp_f32 v115, v115
 v_exp_f32 v116, v116
 v_exp_f32 v117, v117
 v_exp_f32 v118, v118
 v_exp_f32 v119, v119
 v_cvt_pk_bf16_f32 v216, v120, v121
 v_cvt_pk_bf16_f32 v219, v120, v121
 v_cvt_pk_bf16_f32 v28, v112, v113
 v_cvt_pk_bf16_f32 v29, v116, v117
 v_cvt_pk_bf16_f32 v30, v114, v115
 v_cvt_pk_bf16_f32 v31, v118, v119
 v_mfma_f32_16x16x16_bf16 v[124:127], v[220:221], v[216:217], 0
 v_mfma_f32_16x16x16_bf16 v[64:67], v[194:195], v[216:217], 0
 v_mfma_f32_16x16x16_bf16 v[68:71], v[194:195], v[218:219], 0
 v_mfma_f32_16x16x16_bf16 v[72:75], v[198:199], v[216:217], 0
 v_mfma_f32_16x16x16_bf16 v[76:79], v[198:199], v[218:219], 0
 v_mfma_f32_16x16x16_bf16 v[80:83], v[202:203], v[216:217], 0
 v_mfma_f32_16x16x16_bf16 v[84:87], v[202:203], v[218:219], 0
 v_mfma_f32_16x16x16_bf16 v[88:91], v[206:207], v[216:217], 0
 v_mfma_f32_16x16x16_bf16 v[92:95], v[206:207], v[218:219], 0
 v_mfma_f32_16x16x32_bf16 v[124:127], v[220:223], v[28:31], v[124:127]
 v_mfma_f32_16x16x32_bf16 v[64:67], v[160:163], v[28:31], v[64:67]
 v_mfma_f32_16x16x32_bf16 v[68:71], v[164:167], v[28:31], v[68:71]
 v_mfma_f32_16x16x32_bf16 v[72:75], v[168:171], v[28:31], v[72:75]
 v_mfma_f32_16x16x32_bf16 v[76:79], v[172:175], v[28:31], v[76:79]
 v_mfma_f32_16x16x32_bf16 v[80:83], v[176:179], v[28:31], v[80:83]
 v_mfma_f32_16x16x32_bf16 v[84:87], v[180:183], v[28:31], v[84:87]
 v_mfma_f32_16x16x32_bf16 v[88:91], v[184:187], v[28:31], v[88:91]
 v_mfma_f32_16x16x32_bf16 v[92:95], v[188:191], v[28:31], v[92:95]
 v_rcp_f32 v124, v124
 s_add_u32 s45, s56, 4096
 v_mul_f32 v64, v64, v124
 v_mul_f32 v65, v65, v124
 v_mul_f32 v66, v66, v124
 v_mul_f32 v67, v67, v124
 v_mul_f32 v68, v68, v124
 v_mul_f32 v69, v69, v124
 v_mul_f32 v70, v70, v124
 v_mul_f32 v71, v71, v124
 v_cvt_pk_bf16_f32 v96, v64, v65
 v_cvt_pk_bf16_f32 v97, v68, v69
 v_cvt_pk_bf16_f32 v98, v66, v67
 v_cvt_pk_bf16_f32 v99, v70, v71
 buffer_store_dwordx4 v[96:99], v1, s[20:23], s56 offen offset:0 sc1
 v_mul_f32 v72, v72, v124
 v_mul_f32 v73, v73, v124
 v_mul_f32 v74, v74, v124
 v_mul_f32 v75, v75, v124
 v_mul_f32 v76, v76, v124
 v_mul_f32 v77, v77, v124
 v_mul_f32 v78, v78, v124
 v_mul_f32 v79, v79, v124
 v_cvt_pk_bf16_f32 v100, v72, v73
 v_cvt_pk_bf16_f32 v101, v76, v77
 v_cvt_pk_bf16_f32 v102, v74, v75
 v_cvt_pk_bf16_f32 v103, v78, v79
 buffer_store_dwordx4 v[100:103], v1, s[20:23], s56 offen offset:2048 sc1
 v_mul_f32 v80, v80, v124
 v_mul_f32 v81, v81, v124
 v_mul_f32 v82, v82, v124
 v_mul_f32 v83, v83, v124
 v_mul_f32 v84, v84, v124
 v_mul_f32 v85, v85, v124
 v_mul_f32 v86, v86, v124
 v_mul_f32 v87, v87, v124
 v_cvt_pk_bf16_f32 v104, v80, v81
 v_cvt_pk_bf16_f32 v105, v84, v85
 v_cvt_pk_bf16_f32 v106, v82, v83
 v_cvt_pk_bf16_f32 v107, v86, v87
 buffer_store_dwordx4 v[104:107], v1, s[20:23], s45 offen offset:0 sc1
 v_mul_f32 v88, v88, v124
 v_mul_f32 v89, v89, v124
 v_mul_f32 v90, v90, v124
 v_mul_f32 v91, v91, v124
 v_mul_f32 v92, v92, v124
 v_mul_f32 v93, v93, v124
 v_mul_f32 v94, v94, v124
 v_mul_f32 v95, v95, v124
 v_cvt_pk_bf16_f32 v108, v88, v89
 v_cvt_pk_bf16_f32 v109, v92, v93
 v_cvt_pk_bf16_f32 v110, v90, v91
 v_cvt_pk_bf16_f32 v111, v94, v95
 buffer_store_dwordx4 v[108:111], v1, s[20:23], s45 offen offset:2048 sc1
 s_cmp_lt_u32 s42, s36
 s_cbranch_scc0 Lqb_out_41
 v_mfma_f32_16x16x32_bf16 v[64:67], a[0:3], v[48:51], 0
 ds_read_b128 v[32:35], v6 offset:4096
 v_mfma_f32_16x16x32_bf16 v[72:75], a[72:75], v[48:51], 0
 ds_read_b128 v[36:39], v6 offset:6144
 v_mfma_f32_16x16x32_bf16 v[80:83], a[144:147], v[48:51], 0
 s_add_u32 s41, s40, 2
 v_mfma_f32_16x16x32_bf16 v[88:91], a[216:219], v[48:51], 0
 s_add_u32 s45, s42, 2
 s_mul_i32 s46, s41, 36864
 v_mfma_f32_16x16x32_bf16 v[68:71], a[0:3], v[52:55], 0
 s_cmp_lt_u32 s45, s36
 s_cselect_b32 s46, s46, 0
 v_mfma_f32_16x16x32_bf16 v[76:79], a[72:75], v[52:55], 0
 s_lshl_b32 s49, s4, 10
 s_add_u32 s49, s49, s44
 v_mfma_f32_16x16x32_bf16 v[84:87], a[144:147], v[52:55], 0
 s_lshl_b32 s53, s39, 19
 s_add_u32 s53, s53, s61
 v_mfma_f32_16x16x32_bf16 v[92:95], a[216:219], v[52:55], 0
 s_waitcnt lgkmcnt(2)
 v_mfma_f32_16x16x32_bf16 v[64:67], a[4:7], v[56:59], v[64:67]
 ds_read_b128 v[40:43], v7 offset:4096
 v_mfma_f32_16x16x32_bf16 v[72:75], a[76:79], v[56:59], v[72:75]
 ds_read_b128 v[44:47], v7 offset:6144
 v_mfma_f32_16x16x32_bf16 v[80:83], a[148:151], v[56:59], v[80:83]
 s_add_u32 m0, s49, 0
 v_mfma_f32_16x16x32_bf16 v[88:91], a[220:223], v[56:59], v[88:91]
 buffer_load_dwordx4 v10, s[8:11], s46 offen offset:0  lds
 v_mfma_f32_16x16x32_bf16 v[68:71], a[4:7], v[60:63], v[68:71]
 s_add_u32 m0, s49, 3968
 v_mfma_f32_16x16x32_bf16 v[76:79], a[76:79], v[60:63], v[76:79]
 buffer_load_dwordx4 v10, s[8:11], s46 offen offset:128  lds
 v_mfma_f32_16x16x32_bf16 v[84:87], a[148:151], v[60:63], v[84:87]
 s_lshl_b32 s55, s39, 17
 s_add_u32 s55, s55, s62
 v_mfma_f32_16x16x32_bf16 v[92:95], a[220:223], v[60:63], v[92:95]
 s_waitcnt lgkmcnt(2)
 v_mfma_f32_16x16x32_bf16 v[64:67], a[8:11], v[32:35], v[64:67]
 ds_read_b128 v[48:51], v6 offset:8192
 v_mfma_f32_16x16x32_bf16 v[72:75], a[80:83], v[32:35], v[72:75]
 ds_read_b128 v[52:55], v6 offset:10240
 v_mfma_f32_16x16x32_bf16 v[80:83], a[152:155], v[32:35], v[80:83]
 s_add_u32 m0, s49, 7936
 v_mfma_f32_16x16x32_bf16 v[88:91], a[224:227], v[32:35], v[88:91]
 buffer_load_dwordx4 v10, s[8:11], s46 offen offset:256  lds
 v_mfma_f32_16x16x32_bf16 v[68:71], a[8:11], v[36:39], v[68:71]
 s_add_u32 m0, s49, 11904
 v_mfma_f32_16x16x32_bf16 v[76:79], a[80:83], v[36:39], v[76:79]
 buffer_load_dwordx4 v10, s[8:11], s46 offen offset:384  lds
 v_mfma_f32_16x16x32_bf16 v[84:87], a[152:155], v[36:39], v[84:87]
 v_mfma_f32_16x16x32_bf16 v[92:95], a[224:227], v[36:39], v[92:95]
 s_waitcnt lgkmcnt(2)
 v_mfma_f32_16x16x32_bf16 v[64:67], a[12:15], v[40:43], v[64:67]
 ds_read_b128 v[56:59], v7 offset:8192
 v_mfma_f32_16x16x32_bf16 v[72:75], a[84:87], v[40:43], v[72:75]
 ds_read_b128 v[60:63], v7 offset:10240
 v_mfma_f32_16x16x32_bf16 v[80:83], a[156:159], v[40:43], v[80:83]
 s_add_u32 m0, s49, 15872
 v_mfma_f32_16x16x32_bf16 v[88:91], a[228:231], v[40:43], v[88:91]
 buffer_load_dwordx4 v10, s[8:11], s46 offen offset:512  lds
 v_mfma_f32_16x16x32_bf16 v[68:71], a[12:15], v[44:47], v[68:71]
 s_add_u32 m0, s49, 19840
 v_mfma_f32_16x16x32_bf16 v[76:79], a[84:87], v[44:47], v[76:79]
 buffer_load_dwordx4 v10, s[8:11], s46 offen offset:640  lds
 v_mfma_f32_16x16x32_bf16 v[84:87], a[156:159], v[44:47], v[84:87]
 s_add_u32 s60, s39, 1
 v_mfma_f32_16x16x32_bf16 v[92:95], a[228:231], v[44:47], v[92:95]
 s_waitcnt lgkmcnt(2)
 v_mfma_f32_16x16x32_bf16 v[64:67], a[16:19], v[48:51], v[64:67]
 ds_read_b128 v[32:35], v6 offset:12288
 v_mfma_f32_16x16x32_bf16 v[72:75], a[88:91], v[48:51], v[72:75]
 ds_read_b128 v[36:39], v6 offset:14336
 v_mfma_f32_16x16x32_bf16 v[80:83], a[160:163], v[48:51], v[80:83]
 s_add_u32 m0, s49, 23808
 v_mfma_f32_16x16x32_bf16 v[88:91], a[232:235], v[48:51], v[88:91]
 buffer_load_dwordx4 v10, s[8:11], s46 offen offset:768  lds
 v_mfma_f32_16x16x32_bf16 v[68:71], a[16:19], v[52:55], v[68:71]
 s_add_u32 m0, s49, 27776
 v_mfma_f32_16x16x32_bf16 v[76:79], a[88:91], v[52:55], v[76:79]
 buffer_load_dwordx4 v10, s[8:11], s46 offen offset:896  lds
 v_mfma_f32_16x16x32_bf16 v[84:87], a[160:163], v[52:55], v[84:87]
 v_mfma_f32_16x16x32_bf16 v[92:95], a[232:235], v[52:55], v[92:95]
 s_waitcnt lgkmcnt(2)
 v_mfma_f32_16x16x32_bf16 v[64:67], a[20:23], v[56:59], v[64:67]
 ds_read_b128 v[40:43], v7 offset:12288
 v_mfma_f32_16x16x32_bf16 v[72:75], a[92:95], v[56:59], v[72:75]
 ds_read_b128 v[44:47], v7 offset:14336
 v_mfma_f32_16x16x32_bf16 v[80:83], a[164:167], v[56:59], v[80:83]
 s_add_u32 m0, s49, 31744
 v_mfma_f32_16x16x32_bf16 v[88:91], a[236:239], v[56:59], v[88:91]
 buffer_load_dwordx4 v10, s[8:11], s46 offen offset:1024  lds
 v_mfma_f32_16x16x32_bf16 v[68:71], a[20:23], v[60:63], v[68:71]
 v_mfma_f32_16x16x32_bf16 v[76:79], a[92:95], v[60:63], v[76:79]
 v_mfma_f32_16x16x32_bf16 v[84:87], a[164:167], v[60:63], v[84:87]
 v_mfma_f32_16x16x32_bf16 v[92:95], a[236:239], v[60:63], v[92:95]
 s_waitcnt lgkmcnt(2)
 v_mfma_f32_16x16x32_bf16 v[64:67], a[24:27], v[32:35], v[64:67]
 ds_read_b128 v[48:51], v6 offset:16384
 v_mfma_f32_16x16x32_bf16 v[72:75], a[96:99], v[32:35], v[72:75]
 ds_read_b128 v[52:55], v6 offset:18432
 v_mfma_f32_16x16x32_bf16 v[80:83], a[168:171], v[32:35], v[80:83]
 s_waitcnt vmcnt(9)
 buffer_load_dword v17, v11, s[20:23], s56 offen sc1
 v_mfma_f32_16x16x32_bf16 v[88:91], a[240:243], v[32:35], v[88:91]
 s_barrier
 buffer_store_dword v14, v8, s[20:23], s59 offen sc1
 v_mfma_f32_16x16x32_bf16 v[68:71], a[24:27], v[36:39], v[68:71]
 buffer_load_dword v16, v15, s[20:23], s57 offen sc1
 v_mfma_f32_16x16x32_bf16 v[76:79], a[96:99], v[36:39], v[76:79]
 v_mfma_f32_16x16x32_bf16 v[84:87], a[168:171], v[36:39], v[84:87]
 s_lshl_b32 s56, s39, 18
 s_add_u32 s56, s56, s63
 v_mfma_f32_16x16x32_bf16 v[92:95], a[240:243], v[36:39], v[92:95]
 s_waitcnt lgkmcnt(2)
 v_mfma_f32_16x16x32_bf16 v[64:67], a[28:31], v[40:43], v[64:67]
 ds_read_b128 v[56:59], v7 offset:16384
 v_mfma_f32_16x16x32_bf16 v[72:75], a[100:103], v[40:43], v[72:75]
 ds_read_b128 v[60:63], v7 offset:18432
 v_mfma_f32_16x16x32_bf16 v[80:83], a[172:175], v[40:43], v[80:83]
 buffer_load_dwordx4 v[128:131], v1, s[20:23], s53 offen offset:0 sc1
 v_mfma_f32_16x16x32_bf16 v[88:91], a[244:247], v[40:43], v[88:91]
 v_mfma_f32_16x16x32_bf16 v[68:71], a[28:31], v[44:47], v[68:71]
 buffer_load_dwordx4 v[132:135], v1, s[20:23], s53 offen offset:1024 sc1
 v_mfma_f32_16x16x32_bf16 v[76:79], a[100:103], v[44:47], v[76:79]
 v_mfma_f32_16x16x32_bf16 v[84:87], a[172:175], v[44:47], v[84:87]
 v_mfma_f32_16x16x32_bf16 v[92:95], a[244:247], v[44:47], v[92:95]
 s_waitcnt lgkmcnt(2)
 v_mfma_f32_16x16x32_bf16 v[64:67], a[32:35], v[48:51], v[64:67]
 ds_read_b128 v[32:35], v6 offset:20480
 v_mfma_f32_16x16x32_bf16 v[72:75], a[104:107], v[48:51], v[72:75]
 ds_read_b128 v[36:39], v6 offset:22528
 v_mfma_f32_16x16x32_bf16 v[80:83], a[176:179], v[48:51], v[80:83]
 buffer_load_dwordx4 v[136:139], v1, s[20:23], s53 offen offset:2048 sc1
 v_mfma_f32_16x16x32_bf16 v[88:91], a[248:251], v[48:51], v[88:91]
 v_mfma_f32_16x16x32_bf16 v[68:71], a[32:35], v[52:55], v[68:71]
 buffer_load_dwordx4 v[140:143], v1, s[20:23], s53 offen offset:3072 sc1
 v_mfma_f32_16x16x32_bf16 v[76:79], a[104:107], v[52:55], v[76:79]
 v_mfma_f32_16x16x32_bf16 v[84:87], a[176:179], v[52:55], v[84:87]
 s_add_u32 s53, s53, 4096
 v_mfma_f32_16x16x32_bf16 v[92:95], a[248:251], v[52:55], v[92:95]
 s_waitcnt lgkmcnt(2)
 v_mfma_f32_16x16x32_bf16 v[64:67], a[36:39], v[56:59], v[64:67]
 ds_read_b128 v[40:43], v7 offset:20480
 v_mfma_f32_16x16x32_bf16 v[72:75], a[108:111], v[56:59], v[72:75]
 ds_read_b128 v[44:47], v7 offset:22528
 v_mfma_f32_16x16x32_bf16 v[80:83], a[180:183], v[56:59], v[80:83]
 buffer_load_dwordx4 v[144:147], v1, s[20:23], s53 offen offset:0 sc1
 v_mfma_f32_16x16x32_bf16 v[88:91], a[252:255], v[56:59], v[88:91]
 v_mfma_f32_16x16x32_bf16 v[68:71], a[36:39], v[60:63], v[68:71]
 buffer_load_dwordx4 v[148:151], v1, s[20:23], s53 offen offset:1024 sc1
 v_mfma_f32_16x16x32_bf16 v[76:79], a[108:111], v[60:63], v[76:79]
 v_mfma_f32_16x16x32_bf16 v[84:87], a[180:183], v[60:63], v[84:87]
 v_mfma_f32_16x16x32_bf16 v[92:95], a[252:255], v[60:63], v[92:95]
 s_waitcnt lgkmcnt(2)
 v_mfma_f32_16x16x32_bf16 v[64:67], a[40:43], v[32:35], v[64:67]
 ds_read_b128 v[48:51], v6 offset:24576
 v_mfma_f32_16x16x32_bf16 v[72:75], a[112:115], v[32:35], v[72:75]
 ds_read_b128 v[52:55], v6 offset:26624
 v_mfma_f32_16x16x32_bf16 v[80:83], a[184:187], v[32:35], v[80:83]
 buffer_load_dwordx4 v[152:155], v1, s[20:23], s53 offen offset:2048 sc1
 v_mfma_f32_16x16x32_bf16 v[88:91], v[224:227], v[32:35], v[88:91]
 v_mfma_f32_16x16x32_bf16 v[68:71], a[40:43], v[36:39], v[68:71]
 buffer_load_dwordx4 v[156:159], v1, s[20:23], s53 offen offset:3072 sc1
 v_mfma_f32_16x16x32_bf16 v[76:79], a[112:115], v[36:39], v[76:79]
 v_mfma_f32_16x16x32_bf16 v[84:87], a[184:187], v[36:39], v[84:87]
 s_add_u32 s53, s53, 4096
 v_mfma_f32_16x16x32_bf16 v[92:95], v[224:227], v[36:39], v[92:95]
 s_waitcnt lgkmcnt(2)
 v_mfma_f32_16x16x32_bf16 v[64:67], a[44:47], v[40:43], v[64:67]
 ds_read_b128 v[56:59], v7 offset:24576
 v_mfma_f32_16x16x32_bf16 v[72:75], a[116:119], v[40:43], v[72:75]
 ds_read_b128 v[60:63], v7 offset:26624
 v_mfma_f32_16x16x32_bf16 v[80:83], a[188:191], v[40:43], v[80:83]
 buffer_load_dwordx4 v[160:163], v1, s[20:23], s53 offen offset:0 sc1
 v_mfma_f32_16x16x32_bf16 v[88:91], v[228:231], v[40:43], v[88:91]
 v_mfma_f32_16x16x32_bf16 v[68:71], a[44:47], v[44:47], v[68:71]
 buffer_load_dwordx4 v[164:167], v1, s[20:23], s53 offen offset:1024 sc1
 v_mfma_f32_16x16x32_bf16 v[76:79], a[116:119], v[44:47], v[76:79]
 v_mfma_f32_16x16x32_bf16 v[84:87], a[188:191], v[44:47], v[84:87]
 v_mfma_f32_16x16x32_bf16 v[92:95], v[228:231], v[44:47], v[92:95]
 s_waitcnt lgkmcnt(2)
 v_mfma_f32_16x16x32_bf16 v[64:67], a[48:51], v[48:51], v[64:67]
 ds_read_b128 v[32:35], v6 offset:28672
 v_mfma_f32_16x16x32_bf16 v[72:75], a[120:123], v[48:51], v[72:75]
 ds_read_b128 v[36:39], v6 offset:30720
 v_mfma_f32_16x16x32_bf16 v[80:83], a[192:195], v[48:51], v[80:83]
 buffer_load_dwordx4 v[168:171], v1, s[20:23], s53 offen offset:2048 sc1
 v_mfma_f32_16x16x32_bf16 v[88:91], v[232:235], v[48:51], v[88:91]
 v_mfma_f32_16x16x32_bf16 v[68:71], a[48:51], v[52:55], v[68:71]
 buffer_load_dwordx4 v[172:175], v1, s[20:23], s53 offen offset:3072 sc1
 v_mfma_f32_16x16x32_bf16 v[76:79], a[120:123], v[52:55], v[76:79]
 v_mfma_f32_16x16x32_bf16 v[84:87], a[192:195], v[52:55], v[84:87]
 s_add_u32 s53, s53, 4096
 v_mfma_f32_16x16x32_bf16 v[92:95], v[232:235], v[52:55], v[92:95]
 s_waitcnt lgkmcnt(2)
 v_mfma_f32_16x16x32_bf16 v[64:67], a[52:55], v[56:59], v[64:67]
 ds_read_b128 v[40:43], v7 offset:28672
 v_mfma_f32_16x16x32_bf16 v[72:75], a[124:127], v[56:59], v[72:75]
 ds_read_b128 v[44:47], v7 offset:30720
 v_mfma_f32_16x16x32_bf16 v[80:83], a[196:199], v[56:59], v[80:83]
 s_add_u32 s43, s43, 36864
 s_cmp_eq_u32 s43, 147456
 buffer_load_dwordx4 v[176:179], v1, s[20:23], s53 offen offset:0 sc1
 v_mfma_f32_16x16x32_bf16 v[88:91], v[236:239], v[56:59], v[88:91]
 s_cselect_b32 s43, 0, s43
 s_add_u32 s44, s44, 36864
 v_mfma_f32_16x16x32_bf16 v[68:71], a[52:55], v[60:63], v[68:71]
 s_cmp_eq_u32 s44, 147456
 s_cselect_b32 s44, 0, s44
 buffer_load_dwordx4 v[180:183], v1, s[20:23], s53 offen offset:1024 sc1
 v_mfma_f32_16x16x32_bf16 v[76:79], a[124:127], v[60:63], v[76:79]
 v_mfma_f32_16x16x32_bf16 v[84:87], a[196:199], v[60:63], v[84:87]
 v_mfma_f32_16x16x32_bf16 v[92:95], v[236:239], v[60:63], v[92:95]
 s_waitcnt lgkmcnt(2)
 v_mfma_f32_16x16x32_bf16 v[64:67], a[56:59], v[32:35], v[64:67]
 ds_read_b128 v[48:51], v6 offset:32768
 v_mfma_f32_16x16x32_bf16 v[72:75], a[128:131], v[32:35], v[72:75]
 ds_read_b128 v[52:55], v6 offset:34816
 v_mfma_f32_16x16x32_bf16 v[80:83], a[200:203], v[32:35], v[80:83]
 v_add_u32 v6, s43, v4
 buffer_load_dwordx4 v[184:187], v1, s[20:23], s53 offen offset:2048 sc1
 v_mfma_f32_16x16x32_bf16 v[88:91], v[240:243], v[32:35], v[88:91]
 v_mfma_f32_16x16x32_bf16 v[68:71], a[56:59], v[36:39], v[68:71]
 buffer_load_dwordx4 v[188:191], v1, s[20:23], s53 offen offset:3072 sc1
 v_mfma_f32_16x16x32_bf16 v[76:79], a[128:131], v[36:39], v[76:79]
 v_mfma_f32_16x16x32_bf16 v[84:87], a[200:203], v[36:39], v[84:87]
 v_mfma_f32_16x16x32_bf16 v[92:95], v[240:243], v[36:39], v[92:95]
 s_waitcnt lgkmcnt(2)
 v_mfma_f32_16x16x32_bf16 v[64:67], a[60:63], v[40:43], v[64:67]
 ds_read_b128 v[56:59], v7 offset:32768
 v_mfma_f32_16x16x32_bf16 v[72:75], a[132:135], v[40:43], v[72:75]
 ds_read_b128 v[60:63], v7 offset:34816
 v_mfma_f32_16x16x32_bf16 v[80:83], a[204:207], v[40:43], v[80:83]
 v_add_u32 v7, s43, v5
 v_mfma_f32_16x16x32_bf16 v[88:91], v[244:247], v[40:43], v[88:91]
 v_mfma_f32_16x16x32_bf16 v[68:71], a[60:63], v[44:47], v[68:71]
 v_mfma_f32_16x16x32_bf16 v[76:79], a[132:135], v[44:47], v[76:79]
 v_mfma_f32_16x16x32_bf16 v[84:87], a[204:207], v[44:47], v[84:87]
 v_mfma_f32_16x16x32_bf16 v[92:95], v[244:247], v[44:47], v[92:95]
 s_waitcnt lgkmcnt(2)
 v_mfma_f32_16x16x32_bf16 v[64:67], a[64:67], v[48:51], v[64:67]
 s_waitcnt vmcnt(28)
 s_barrier
 ds_read_b128 v[32:35], v6 offset:0
 v_mfma_f32_16x16x32_bf16 v[72:75], a[136:139], v[48:51], v[72:75]
 ds_read_b128 v[36:39], v6 offset:2048
 v_mfma_f32_16x16x32_bf16 v[80:83], a[208:211], v[48:51], v[80:83]
 v_mfma_f32_16x16x32_bf16 v[88:91], v[248:251], v[48:51], v[88:91]
 s_waitcnt vmcnt(16)
 v_cmp_le_u32 vcc, s60, v16
 v_mfma_f32_16x16x32_bf16 v[68:71], a[64:67], v[52:55], v[68:71]
 v_mfma_f32_16x16x32_bf16 v[76:79], a[136:139], v[52:55], v[76:79]
 s_and_b32 s64, vcc_lo, 1
 s_cbranch_scc0 Lqsk_46
 buffer_load_dwordx4 v[192:195], v1, s[20:23], s55 offen offset:0 sc1
 buffer_load_dwordx4 v[196:199], v1, s[20:23], s55 offen offset:1024 sc1
 buffer_load_dwordx4 v[200:203], v1, s[20:23], s55 offen offset:2048 sc1
 buffer_load_dwordx4 v[204:207], v1, s[20:23], s55 offen offset:3072 sc1
Lqsk_46:
 v_mfma_f32_16x16x32_bf16 v[84:87], a[208:211], v[52:55], v[84:87]
 v_mfma_f32_16x16x32_bf16 v[92:95], v[248:251], v[52:55], v[92:95]
 s_waitcnt lgkmcnt(2)
 v_mfma_f32_16x16x32_bf16 v[64:67], a[68:71], v[56:59], v[64:67]
 ds_read_b128 v[40:43], v7 offset:0
 v_mfma_f32_16x16x32_bf16 v[72:75], a[140:143], v[56:59], v[72:75]
 ds_read_b128 v[44:47], v7 offset:2048
 v_mfma_f32_16x16x32_bf16 v[80:83], a[212:215], v[56:59], v[80:83]
 v_mfma_f32_16x16x32_bf16 v[88:91], v[252:255], v[56:59], v[88:91]
 s_mov_b32 s39, s40
 s_mov_b32 s40, s41
 v_mfma_f32_16x16x32_bf16 v[68:71], a[68:71], v[60:63], v[68:71]
 s_add_u32 s42, s42, 1
 v_mov_b32 v14, s42
 v_mfma_f32_16x16x32_bf16 v[76:79], a[140:143], v[60:63], v[76:79]
 v_mfma_f32_16x16x32_bf16 v[84:87], a[212:215], v[60:63], v[84:87]
 v_mfma_f32_16x16x32_bf16 v[92:95], v[252:255], v[60:63], v[92:95]
 s_waitcnt lgkmcnt(2)
 s_nop 7
 v_cvt_pk_bf16_f32 v16, v64, v72
 v_cvt_pk_bf16_f32 v17, v65, v73
 v_cvt_pk_bf16_f32 v18, v66, v74
 v_cvt_pk_bf16_f32 v19, v67, v75
 ds_write_b128 v2, v[16:19] offset:0
 v_cvt_pk_bf16_f32 v20, v68, v76
 v_cvt_pk_bf16_f32 v21, v69, v77
 v_cvt_pk_bf16_f32 v22, v70, v78
 v_cvt_pk_bf16_f32 v23, v71, v79
 ds_write_b128 v2, v[20:23] offset:1024
 v_cvt_pk_bf16_f32 v24, v80, v88
 v_cvt_pk_bf16_f32 v25, v81, v89
 v_cvt_pk_bf16_f32 v26, v82, v90
 v_cvt_pk_bf16_f32 v27, v83, v91
 ds_write_b128 v2, v[24:27] offset:8192
 v_cvt_pk_bf16_f32 v28, v84, v92
 v_cvt_pk_bf16_f32 v29, v85, v93
 v_cvt_pk_bf16_f32 v30, v86, v94
 v_cvt_pk_bf16_f32 v31, v87, v95
 ds_write_b128 v2, v[28:31] offset:9216
 v_mov_b64 v[120:121], 0
 v_mov_b64 v[122:123], 0
 s_waitcnt lgkmcnt(0)
 s_barrier
 ds_read_b128 v[96:99], v3 offset:0
 ds_read_b128 v[100:103], v3 offset:2048
 ds_read_b128 v[104:107], v3 offset:4096
 ds_read_b128 v[108:111], v3 offset:6144
 s_cmp_lg_u32 s64, 0
 s_cbranch_scc1 Lqpre_47
Lqs_48:
 buffer_load_dword v16, v15, s[20:23], s57 offen sc1
 s_waitcnt vmcnt(0)
 v_cmp_le_u32 vcc, s60, v16
 s_cbranch_vccnz Lqsk_49
 s_sleep 2
 s_sub_u32 s58, s58, 1
 s_cbranch_scc0 Lqs_48
 s_endpgm
Lqsk_49:
 buffer_load_dwordx4 v[192:195], v1, s[20:23], s55 offen offset:0 sc1
 buffer_load_dwordx4 v[196:199], v1, s[20:23], s55 offen offset:1024 sc1
 buffer_load_dwordx4 v[200:203], v1, s[20:23], s55 offen offset:2048 sc1
 buffer_load_dwordx4 v[204:207], v1, s[20:23], s55 offen offset:3072 sc1
Lqpre_47:
 s_waitcnt vmcnt(4) lgkmcnt(0)
 v_mfma_f32_16x16x32_bf16 v[112:115], v[128:131], v[96:99], v[208:211]
 v_mfma_f32_16x16x32_bf16 v[116:119], v[132:135], v[96:99], v[212:215]
 v_mfma_f32_16x16x32_bf16 v[112:115], v[136:139], v[100:103], v[112:115]
 v_mfma_f32_16x16x32_bf16 v[116:119], v[140:143], v[100:103], v[116:119]
 v_mfma_f32_16x16x32_bf16 v[112:115], v[144:147], v[104:107], v[112:115]
 v_mfma_f32_16x16x32_bf16 v[116:119], v[148:151], v[104:107], v[116:119]
 v_mfma_f32_16x16x32_bf16 v[112:115], v[152:155], v[108:111], v[112:115]
 v_mfma_f32_16x16x32_bf16 v[116:119], v[156:159], v[108:111], v[116:119]
 s_nop 7
 v_max3_f32 v24, v112, v113, v114
 v_max3_f32 v24, v24, v115, v116
 v_max3_f32 v24, v24, v117, v118
 v_max_f32 v24, v24, v119
 s_waitcnt vmcnt(2)
 v_mov_b64 v[16:17], v[192:193]
 v_mov_b64 v[18:19], v[196:197]
 s_nop 1
 v_smfmac_f32_16x16x64_bf16 v[120:123], v[16:19], v[96:103], v12
 s_waitcnt vmcnt(0)
 v_mov_b64 v[20:21], v[200:201]
 v_mov_b64 v[22:23], v[204:205]
 s_nop 1
 v_smfmac_f32_16x16x64_bf16 v[120:123], v[20:23], v[104:111], v12
 s_nop 7
 v_add_f32 v120, v120, v122
 v_add_f32 v121, v121, v123
 v_mul_f32 v120, s50, v120
 v_mul_f32 v121, s50, v121
 v_max3_f32 v24, v24, v120, v121
 v_mov_b32 v25, v24
 s_nop 1
 v_permlane16_swap_b32 v24, v25
 v_max_f32 v24, v24, v25
 v_mov_b32 v25, v24
 s_nop 1
 v_permlane32_swap_b32 v24, v25
 v_max_f32 v24, v24, v25
 v_sub_f32 v112, v112, v24
 v_sub_f32 v113, v113, v24
 v_sub_f32 v114, v114, v24
 v_sub_f32 v115, v115, v24
 v_sub_f32 v116, v116, v24
 v_sub_f32 v117, v117, v24
 v_sub_f32 v118, v118, v24
 v_sub_f32 v119, v119, v24
 v_sub_f32 v120, v120, v24
 v_sub_f32 v121, v121, v24
 v_exp_f32 v120, v120
 v_exp_f32 v121, v121
 v_exp_f32 v112, v112
 v_exp_f32 v113, v113
 v_exp_f32 v114, v114
 v_exp_f32 v115, v115
 v_exp_f32 v116, v116
 v_exp_f32 v117, v117
 v_exp_f32 v118, v118
 v_exp_f32 v119, v119
 v_cvt_pk_bf16_f32 v216, v120, v121
 v_cvt_pk_bf16_f32 v219, v120, v121
 v_cvt_pk_bf16_f32 v28, v112, v113
 v_cvt_pk_bf16_f32 v29, v116, v117
 v_cvt_pk_bf16_f32 v30, v114, v115
 v_cvt_pk_bf16_f32 v31, v118, v119
 v_mfma_f32_16x16x16_bf16 v[124:127], v[220:221], v[216:217], 0
 v_mfma_f32_16x16x16_bf16 v[64:67], v[194:195], v[216:217], 0
 v_mfma_f32_16x16x16_bf16 v[68:71], v[194:195], v[218:219], 0
 v_mfma_f32_16x16x16_bf16 v[72:75], v[198:199], v[216:217], 0
 v_mfma_f32_16x16x16_bf16 v[76:79], v[198:199], v[218:219], 0
 v_mfma_f32_16x16x16_bf16 v[80:83], v[202:203], v[216:217], 0
 v_mfma_f32_16x16x16_bf16 v[84:87], v[202:203], v[218:219], 0
 v_mfma_f32_16x16x16_bf16 v[88:91], v[206:207], v[216:217], 0
 v_mfma_f32_16x16x16_bf16 v[92:95], v[206:207], v[218:219], 0
 v_mfma_f32_16x16x32_bf16 v[124:127], v[220:223], v[28:31], v[124:127]
 v_mfma_f32_16x16x32_bf16 v[64:67], v[160:163], v[28:31], v[64:67]
 v_mfma_f32_16x16x32_bf16 v[68:71], v[164:167], v[28:31], v[68:71]
 v_mfma_f32_16x16x32_bf16 v[72:75], v[168:171], v[28:31], v[72:75]
 v_mfma_f32_16x16x32_bf16 v[76:79], v[172:175], v[28:31], v[76:79]
 v_mfma_f32_16x16x32_bf16 v[80:83], v[176:179], v[28:31], v[80:83]
 v_mfma_f32_16x16x32_bf16 v[84:87], v[180:183], v[28:31], v[84:87]
 v_mfma_f32_16x16x32_bf16 v[88:91], v[184:187], v[28:31], v[88:91]
 v_mfma_f32_16x16x32_bf16 v[92:95], v[188:191], v[28:31], v[92:95]
 v_rcp_f32 v124, v124
 s_add_u32 s45, s56, 4096
 v_mul_f32 v64, v64, v124
 v_mul_f32 v65, v65, v124
 v_mul_f32 v66, v66, v124
 v_mul_f32 v67, v67, v124
 v_mul_f32 v68, v68, v124
 v_mul_f32 v69, v69, v124
 v_mul_f32 v70, v70, v124
 v_mul_f32 v71, v71, v124
 v_cvt_pk_bf16_f32 v96, v64, v65
 v_cvt_pk_bf16_f32 v97, v68, v69
 v_cvt_pk_bf16_f32 v98, v66, v67
 v_cvt_pk_bf16_f32 v99, v70, v71
 buffer_store_dwordx4 v[96:99], v1, s[20:23], s56 offen offset:0 sc1
 v_mul_f32 v72, v72, v124
 v_mul_f32 v73, v73, v124
 v_mul_f32 v74, v74, v124
 v_mul_f32 v75, v75, v124
 v_mul_f32 v76, v76, v124
 v_mul_f32 v77, v77, v124
 v_mul_f32 v78, v78, v124
 v_mul_f32 v79, v79, v124
 v_cvt_pk_bf16_f32 v100, v72, v73
 v_cvt_pk_bf16_f32 v101, v76, v77
 v_cvt_pk_bf16_f32 v102, v74, v75
 v_cvt_pk_bf16_f32 v103, v78, v79
 buffer_store_dwordx4 v[100:103], v1, s[20:23], s56 offen offset:2048 sc1
 v_mul_f32 v80, v80, v124
 v_mul_f32 v81, v81, v124
 v_mul_f32 v82, v82, v124
 v_mul_f32 v83, v83, v124
 v_mul_f32 v84, v84, v124
 v_mul_f32 v85, v85, v124
 v_mul_f32 v86, v86, v124
 v_mul_f32 v87, v87, v124
 v_cvt_pk_bf16_f32 v104, v80, v81
 v_cvt_pk_bf16_f32 v105, v84, v85
 v_cvt_pk_bf16_f32 v106, v82, v83
 v_cvt_pk_bf16_f32 v107, v86, v87
 buffer_store_dwordx4 v[104:107], v1, s[20:23], s45 offen offset:0 sc1
 v_mul_f32 v88, v88, v124
 v_mul_f32 v89, v89, v124
 v_mul_f32 v90, v90, v124
 v_mul_f32 v91, v91, v124
 v_mul_f32 v92, v92, v124
 v_mul_f32 v93, v93, v124
 v_mul_f32 v94, v94, v124
 v_mul_f32 v95, v95, v124
 v_cvt_pk_bf16_f32 v108, v88, v89
 v_cvt_pk_bf16_f32 v109, v92, v93
 v_cvt_pk_bf16_f32 v110, v90, v91
 v_cvt_pk_bf16_f32 v111, v94, v95
 buffer_store_dwordx4 v[108:111], v1, s[20:23], s45 offen offset:2048 sc1
 s_cmp_lt_u32 s42, s36
 s_cbranch_scc1 Lqb_loop_40
Lqb_out_41:
 s_waitcnt vmcnt(0)
 buffer_load_dword v17, v11, s[20:23], s56 offen sc1
 s_barrier
 buffer_store_dword v14, v8, s[20:23], s59 offen sc1
 s_branch Lfin
Lob:
 s_load_dwordx2 s[8:9], s[0:1], 88
 s_mov_b32 s10, 0x480000
 s_mov_b32 s11, 0x20000
 s_sub_u32 s32, s6, 16
 s_mul_i32 s7, s3, 5
 s_add_u32 s7, s7, s6
 s_sub_u32 s7, s7, 25
 s_sub_u32 s33, 2, s3
 s_lshl_b32 s34, 2, s3
 s_cmp_lt_u32 s6, 25
 s_cselect_b32 s32, s32, s7
 s_cselect_b32 s33, s33, 0
 s_cselect_b32 s34, s34, 3
 s_cselect_b32 s39, 6, 0
 s_cselect_b32 s40, 0, 4
 s_cmp_eq_u32 s3, 2
 s_cselect_b32 s33, 63, s33
 s_cselect_b32 s35, 1, 21
 s_cselect_b32 s90, 31, 1
 s_cselect_b32 s91, 10, 9
 s_mov_b32 s36, 0x7000000
 s_mov_b32 s37, 1152
 s_lshl_b32 s7, s4, 7
 s_add_u32 s38, s7, 0x3800
 s_mov_b32 s93, 1
 s_mov_b32 s92, 3
Los:
 s_load_dwordx2 s[24:25], s[0:1], 104
 s_mov_b32 s26, 0x480000
 s_mov_b32 s27, 0x20000
 s_waitcnt lgkmcnt(0)
 v_and_b32 v15, 63, v0
 v_lshlrev_b32 v1, 4, v15
 v_and_b32 v3, s92, v15
 v_lshlrev_b32 v3, 2, v3
 v_lshrrev_b32 v14, 4, v15
 v_min_u32 v14, 1, v14
 v_lshl_or_b32 v3, v14, 28, v3
 s_add_u32 s44, s32, s40
 s_and_b32 s44, s44, 7
 s_mov_b32 s50, 0x40000
 s_mul_i32 s49, s4, 40960
 v_add_u32 v5, s49, v1
 v_bfe_u32 v14, v15, 5, 1
 v_bfe_u32 v16, v15, 3, 1
 v_lshl_add_u32 v14, v14, 1, v16
 v_bfe_u32 v16, v15, 4, 1
 v_lshl_add_u32 v14, v16, 6, v14
 v_mul_u32_u24 v14, 1152, v14
 v_bfe_u32 v17, v15, 1, 2
 v_xor_b32 v17, v17, v16
 v_lshlrev_b32 v17, 5, v17
 v_and_b32 v16, 1, v15
 v_lshl_add_u32 v17, v16, 4, v17
 v_add_u32 v8, v14, v17
 v_xor_b32 v17, 64, v17
 v_add_u32 v9, v14, v17
 v_lshrrev_b32 v14, 4, v15
 v_bfe_u32 v16, v15, 2, 2
 v_lshl_add_u32 v14, v14, 3, v16
 v_lshlrev_b32 v14, 7, v14
 v_bfe_u32 v16, v15, 3, 2
 v_lshl_add_u32 v14, v16, 5, v14
 v_and_b32 v16, 3, v15
 v_lshl_add_u32 v14, v16, 3, v14
 v_xor_b32 v16, 0, v14
 v_add_u32 v10, s49, v16
 v_xor_b32 v16, 32, v14
 v_add_u32 v11, s49, v16
 v_xor_b32 v16, 64, v14
 v_add_u32 v12, s49, v16
 v_xor_b32 v16, 96, v14
 v_add_u32 v13, s49, v16
 s_lshl_b32 s47, s32, 7
 s_add_u32 s46, s44, 0
 s_and_b32 s46, s46, 7
 s_lshl_b32 s45, s4, 3
 s_add_u32 s46, s46, s45
 s_mul_i32 s46, s46, 147456
 s_add_u32 s46, s46, s47
 s_add_u32 m0, s49, 8192
 s_add_u32 s45, s46, 0
 buffer_load_dwordx4 v8, s[8:11], s45 offen  lds
 s_add_u32 m0, s49, 9216
 s_add_u32 s45, s46, 4608
 buffer_load_dwordx4 v9, s[8:11], s45 offen  lds
 s_add_u32 m0, s49, 10240
 s_add_u32 s45, s46, 9216
 buffer_load_dwordx4 v8, s[8:11], s45 offen  lds
 s_add_u32 m0, s49, 11264
 s_add_u32 s45, s46, 13824
 buffer_load_dwordx4 v9, s[8:11], s45 offen  lds
 s_waitcnt vmcnt(0) lgkmcnt(0)
 s_add_u32 m0, s49, 12288
 s_add_u32 s45, s46, 18432
 buffer_load_dwordx4 v8, s[8:11], s45 offen  lds
 s_add_u32 m0, s49, 13312
 s_add_u32 s45, s46, 23040
 buffer_load_dwordx4 v9, s[8:11], s45 offen  lds
 s_add_u32 m0, s49, 14336
 s_add_u32 s45, s46, 27648
 buffer_load_dwordx4 v8, s[8:11], s45 offen  lds
 s_add_u32 m0, s49, 15360
 s_add_u32 s45, s46, 32256
 buffer_load_dwordx4 v9, s[8:11], s45 offen  lds
 ds_read_b64_tr_b16 a[0:1], v10 offset:8192
 ds_read_b64_tr_b16 a[2:3], v10 offset:8704
 ds_read_b64_tr_b16 a[4:5], v11 offset:8192
 ds_read_b64_tr_b16 a[6:7], v11 offset:8704
 ds_read_b64_tr_b16 a[8:9], v12 offset:8192
 ds_read_b64_tr_b16 a[10:11], v12 offset:8704
 ds_read_b64_tr_b16 v[16:17], v13 offset:8192
 ds_read_b64_tr_b16 v[18:19], v13 offset:8704
 s_waitcnt vmcnt(0) lgkmcnt(0)
 s_add_u32 m0, s49, 16384
 s_add_u32 s45, s46, 36864
 buffer_load_dwordx4 v8, s[8:11], s45 offen  lds
 s_add_u32 m0, s49, 17408
 s_add_u32 s45, s46, 41472
 buffer_load_dwordx4 v9, s[8:11], s45 offen  lds
 s_add_u32 m0, s49, 18432
 s_add_u32 s45, s46, 46080
 buffer_load_dwordx4 v8, s[8:11], s45 offen  lds
 s_add_u32 m0, s49, 19456
 s_add_u32 s45, s46, 50688
 buffer_load_dwordx4 v9, s[8:11], s45 offen  lds
 ds_write_b128 v5, v[16:19] offset:0
 ds_read_b64_tr_b16 a[12:13], v10 offset:12288
 ds_read_b64_tr_b16 a[14:15], v10 offset:12800
 ds_read_b64_tr_b16 a[16:17], v11 offset:12288
 ds_read_b64_tr_b16 a[18:19], v11 offset:12800
 ds_read_b64_tr_b16 a[20:21], v12 offset:12288
 ds_read_b64_tr_b16 a[22:23], v12 offset:12800
 ds_read_b64_tr_b16 v[20:21], v13 offset:12288
 ds_read_b64_tr_b16 v[22:23], v13 offset:12800
 s_waitcnt vmcnt(0) lgkmcnt(0)
 s_add_u32 m0, s49, 20480
 s_add_u32 s45, s46, 55296
 buffer_load_dwordx4 v8, s[8:11], s45 offen  lds
 s_add_u32 m0, s49, 21504
 s_add_u32 s45, s46, 59904
 buffer_load_dwordx4 v9, s[8:11], s45 offen  lds
 s_add_u32 m0, s49, 22528
 s_add_u32 s45, s46, 64512
 buffer_load_dwordx4 v8, s[8:11], s45 offen  lds
 s_add_u32 m0, s49, 23552
 s_add_u32 s45, s46, 69120
 buffer_load_dwordx4 v9, s[8:11], s45 offen  lds
 ds_write_b128 v5, v[20:23] offset:1024
 ds_read_b64_tr_b16 a[24:25], v10 offset:16384
 ds_read_b64_tr_b16 a[26:27], v10 offset:16896
 ds_read_b64_tr_b16 a[28:29], v11 offset:16384
 ds_read_b64_tr_b16 a[30:31], v11 offset:16896
 ds_read_b64_tr_b16 a[32:33], v12 offset:16384
 ds_read_b64_tr_b16 a[34:35], v12 offset:16896
 ds_read_b64_tr_b16 v[16:17], v13 offset:16384
 ds_read_b64_tr_b16 v[18:19], v13 offset:16896
 s_waitcnt vmcnt(0) lgkmcnt(0)
 s_add_u32 s46, s44, 1
 s_and_b32 s46, s46, 7
 s_lshl_b32 s45, s4, 3
 s_add_u32 s46, s46, s45
 s_mul_i32 s46, s46, 147456
 s_add_u32 s46, s46, s47
 s_add_u32 m0, s49, 24576
 s_add_u32 s45, s46, 0
 buffer_load_dwordx4 v8, s[8:11], s45 offen  lds
 s_add_u32 m0, s49, 25600
 s_add_u32 s45, s46, 4608
 buffer_load_dwordx4 v9, s[8:11], s45 offen  lds
 s_add_u32 m0, s49, 26624
 s_add_u32 s45, s46, 9216
 buffer_load_dwordx4 v8, s[8:11], s45 offen  lds
 s_add_u32 m0, s49, 27648
 s_add_u32 s45, s46, 13824
 buffer_load_dwordx4 v9, s[8:11], s45 offen  lds
 ds_write_b128 v5, v[16:19] offset:2048
 ds_read_b64_tr_b16 a[36:37], v10 offset:20480
 ds_read_b64_tr_b16 a[38:39], v10 offset:20992
 ds_read_b64_tr_b16 a[40:41], v11 offset:20480
 ds_read_b64_tr_b16 a[42:43], v11 offset:20992
 ds_read_b64_tr_b16 a[44:45], v12 offset:20480
 ds_read_b64_tr_b16 a[46:47], v12 offset:20992
 ds_read_b64_tr_b16 v[20:21], v13 offset:20480
 ds_read_b64_tr_b16 v[22:23], v13 offset:20992
 s_waitcnt vmcnt(0) lgkmcnt(0)
 s_add_u32 m0, s49, 28672
 s_add_u32 s45, s46, 18432
 buffer_load_dwordx4 v8, s[8:11], s45 offen  lds
 s_add_u32 m0, s49, 29696
 s_add_u32 s45, s46, 23040
 buffer_load_dwordx4 v9, s[8:11], s45 offen  lds
 s_add_u32 m0, s49, 30720
 s_add_u32 s45, s46, 27648
 buffer_load_dwordx4 v8, s[8:11], s45 offen  lds
 s_add_u32 m0, s49, 31744
 s_add_u32 s45, s46, 32256
 buffer_load_dwordx4 v9, s[8:11], s45 offen  lds
 ds_write_b128 v5, v[20:23] offset:3072
 ds_read_b64_tr_b16 a[48:49], v10 offset:24576
 ds_read_b64_tr_b16 a[50:51], v10 offset:25088
 ds_read_b64_tr_b16 a[52:53], v11 offset:24576
 ds_read_b64_tr_b16 a[54:55], v11 offset:25088
 ds_read_b64_tr_b16 a[56:57], v12 offset:24576
 ds_read_b64_tr_b16 a[58:59], v12 offset:25088
 ds_read_b64_tr_b16 v[16:17], v13 offset:24576
 ds_read_b64_tr_b16 v[18:19], v13 offset:25088
 s_waitcnt vmcnt(0) lgkmcnt(0)
 s_add_u32 m0, s49, 32768
 s_add_u32 s45, s46, 36864
 buffer_load_dwordx4 v8, s[8:11], s45 offen  lds
 s_add_u32 m0, s49, 33792
 s_add_u32 s45, s46, 41472
 buffer_load_dwordx4 v9, s[8:11], s45 offen  lds
 s_add_u32 m0, s49, 34816
 s_add_u32 s45, s46, 46080
 buffer_load_dwordx4 v8, s[8:11], s45 offen  lds
 s_add_u32 m0, s49, 35840
 s_add_u32 s45, s46, 50688
 buffer_load_dwordx4 v9, s[8:11], s45 offen  lds
 ds_write_b128 v5, v[16:19] offset:4096
 ds_read_b64_tr_b16 a[60:61], v10 offset:28672
 ds_read_b64_tr_b16 a[62:63], v10 offset:29184
 ds_read_b64_tr_b16 a[64:65], v11 offset:28672
 ds_read_b64_tr_b16 a[66:67], v11 offset:29184
 ds_read_b64_tr_b16 a[68:69], v12 offset:28672
 ds_read_b64_tr_b16 a[70:71], v12 offset:29184
 ds_read_b64_tr_b16 v[20:21], v13 offset:28672
 ds_read_b64_tr_b16 v[22:23], v13 offset:29184
 s_waitcnt vmcnt(0) lgkmcnt(0)
 s_add_u32 m0, s49, 36864
 s_add_u32 s45, s46, 55296
 buffer_load_dwordx4 v8, s[8:11], s45 offen  lds
 s_add_u32 m0, s49, 37888
 s_add_u32 s45, s46, 59904
 buffer_load_dwordx4 v9, s[8:11], s45 offen  lds
 s_add_u32 m0, s49, 38912
 s_add_u32 s45, s46, 64512
 buffer_load_dwordx4 v8, s[8:11], s45 offen  lds
 s_add_u32 m0, s49, 39936
 s_add_u32 s45, s46, 69120
 buffer_load_dwordx4 v9, s[8:11], s45 offen  lds
 ds_write_b128 v5, v[20:23] offset:5120
 ds_read_b64_tr_b16 a[72:73], v10 offset:32768
 ds_read_b64_tr_b16 a[74:75], v10 offset:33280
 ds_read_b64_tr_b16 a[76:77], v11 offset:32768
 ds_read_b64_tr_b16 a[78:79], v11 offset:33280
 ds_read_b64_tr_b16 a[80:81], v12 offset:32768
 ds_read_b64_tr_b16 a[82:83], v12 offset:33280
 ds_read_b64_tr_b16 v[16:17], v13 offset:32768
 ds_read_b64_tr_b16 v[18:19], v13 offset:33280
 s_waitcnt vmcnt(0) lgkmcnt(0)
 s_add_u32 s46, s44, 2
 s_and_b32 s46, s46, 7
 s_lshl_b32 s45, s4, 3
 s_add_u32 s46, s46, s45
 s_mul_i32 s46, s46, 147456
 s_add_u32 s46, s46, s47
 s_add_u32 m0, s49, 8192
 s_add_u32 s45, s46, 0
 buffer_load_dwordx4 v8, s[8:11], s45 offen  lds
 s_add_u32 m0, s49, 9216
 s_add_u32 s45, s46, 4608
 buffer_load_dwordx4 v9, s[8:11], s45 offen  lds
 s_add_u32 m0, s49, 10240
 s_add_u32 s45, s46, 9216
 buffer_load_dwordx4 v8, s[8:11], s45 offen  lds
 s_add_u32 m0, s49, 11264
 s_add_u32 s45, s46, 13824
 buffer_load_dwordx4 v9, s[8:11], s45 offen  lds
 ds_write_b128 v5, v[16:19] offset:6144
 ds_read_b64_tr_b16 a[84:85], v10 offset:36864
 ds_read_b64_tr_b16 a[86:87], v10 offset:37376
 ds_read_b64_tr_b16 a[88:89], v11 offset:36864
 ds_read_b64_tr_b16 a[90:91], v11 offset:37376
 ds_read_b64_tr_b16 a[92:93], v12 offset:36864
 ds_read_b64_tr_b16 a[94:95], v12 offset:37376
 ds_read_b64_tr_b16 v[20:21], v13 offset:36864
 ds_read_b64_tr_b16 v[22:23], v13 offset:37376
 s_waitcnt vmcnt(0) lgkmcnt(0)
 s_add_u32 m0, s49, 12288
 s_add_u32 s45, s46, 18432
 buffer_load_dwordx4 v8, s[8:11], s45 offen  lds
 s_add_u32 m0, s49, 13312
 s_add_u32 s45, s46, 23040
 buffer_load_dwordx4 v9, s[8:11], s45 offen  lds
 s_add_u32 m0, s49, 14336
 s_add_u32 s45, s46, 27648
 buffer_load_dwordx4 v8, s[8:11], s45 offen  lds
 s_add_u32 m0, s49, 15360
 s_add_u32 s45, s46, 32256
 buffer_load_dwordx4 v9, s[8:11], s45 offen  lds
 ds_write_b128 v5, v[20:23] offset:7168
 ds_read_b64_tr_b16 a[96:97], v10 offset:8192
 ds_read_b64_tr_b16 a[98:99], v10 offset:8704
 ds_read_b64_tr_b16 a[100:101], v11 offset:8192
 ds_read_b64_tr_b16 a[102:103], v11 offset:8704
 ds_read_b64_tr_b16 a[104:105], v12 offset:8192
 ds_read_b64_tr_b16 a[106:107], v12 offset:8704
 ds_read_b64_tr_b16 v[32:33], v13 offset:8192
 ds_read_b64_tr_b16 v[34:35], v13 offset:8704
 s_waitcnt vmcnt(0) lgkmcnt(0)
 s_add_u32 m0, s49, 16384
 s_add_u32 s45, s46, 36864
 buffer_load_dwordx4 v8, s[8:11], s45 offen  lds
 s_add_u32 m0, s49, 17408
 s_add_u32 s45, s46, 41472
 buffer_load_dwordx4 v9, s[8:11], s45 offen  lds
 s_add_u32 m0, s49, 18432
 s_add_u32 s45, s46, 46080
 buffer_load_dwordx4 v8, s[8:11], s45 offen  lds
 s_add_u32 m0, s49, 19456
 s_add_u32 s45, s46, 50688
 buffer_load_dwordx4 v9, s[8:11], s45 offen  lds
 ds_read_b64_tr_b16 a[108:109], v10 offset:12288
 ds_read_b64_tr_b16 a[110:111], v10 offset:12800
 ds_read_b64_tr_b16 a[112:113], v11 offset:12288
 ds_read_b64_tr_b16 a[114:115], v11 offset:12800
 ds_read_b64_tr_b16 a[116:117], v12 offset:12288
 ds_read_b64_tr_b16 a[118:119], v12 offset:12800
 ds_read_b64_tr_b16 v[36:37], v13 offset:12288
 ds_read_b64_tr_b16 v[38:39], v13 offset:12800
 s_waitcnt vmcnt(0) lgkmcnt(0)
 s_add_u32 m0, s49, 20480
 s_add_u32 s45, s46, 55296
 buffer_load_dwordx4 v8, s[8:11], s45 offen  lds
 s_add_u32 m0, s49, 21504
 s_add_u32 s45, s46, 59904
 buffer_load_dwordx4 v9, s[8:11], s45 offen  lds
 s_add_u32 m0, s49, 22528
 s_add_u32 s45, s46, 64512
 buffer_load_dwordx4 v8, s[8:11], s45 offen  lds
 s_add_u32 m0, s49, 23552
 s_add_u32 s45, s46, 69120
 buffer_load_dwordx4 v9, s[8:11], s45 offen  lds
 ds_read_b64_tr_b16 a[120:121], v10 offset:16384
 ds_read_b64_tr_b16 a[122:123], v10 offset:16896
 ds_read_b64_tr_b16 a[124:125], v11 offset:16384
 ds_read_b64_tr_b16 a[126:127], v11 offset:16896
 ds_read_b64_tr_b16 a[128:129], v12 offset:16384
 ds_read_b64_tr_b16 a[130:131], v12 offset:16896
 ds_read_b64_tr_b16 v[40:41], v13 offset:16384
 ds_read_b64_tr_b16 v[42:43], v13 offset:16896
 s_waitcnt vmcnt(0) lgkmcnt(0)
 s_add_u32 s46, s44, 3
 s_and_b32 s46, s46, 7
 s_lshl_b32 s45, s4, 3
 s_add_u32 s46, s46, s45
 s_mul_i32 s46, s46, 147456
 s_add_u32 s46, s46, s47
 s_add_u32 m0, s49, 24576
 s_add_u32 s45, s46, 0
 buffer_load_dwordx4 v8, s[8:11], s45 offen  lds
 s_add_u32 m0, s49, 25600
 s_add_u32 s45, s46, 4608
 buffer_load_dwordx4 v9, s[8:11], s45 offen  lds
 s_add_u32 m0, s49, 26624
 s_add_u32 s45, s46, 9216
 buffer_load_dwordx4 v8, s[8:11], s45 offen  lds
 s_add_u32 m0, s49, 27648
 s_add_u32 s45, s46, 13824
 buffer_load_dwordx4 v9, s[8:11], s45 offen  lds
 ds_read_b64_tr_b16 a[132:133], v10 offset:20480
 ds_read_b64_tr_b16 a[134:135], v10 offset:20992
 ds_read_b64_tr_b16 a[136:137], v11 offset:20480
 ds_read_b64_tr_b16 a[138:139], v11 offset:20992
 ds_read_b64_tr_b16 a[140:141], v12 offset:20480
 ds_read_b64_tr_b16 a[142:143], v12 offset:20992
 ds_read_b64_tr_b16 v[44:45], v13 offset:20480
 ds_read_b64_tr_b16 v[46:47], v13 offset:20992
 s_waitcnt vmcnt(0) lgkmcnt(0)
 s_add_u32 m0, s49, 28672
 s_add_u32 s45, s46, 18432
 buffer_load_dwordx4 v8, s[8:11], s45 offen  lds
 s_add_u32 m0, s49, 29696
 s_add_u32 s45, s46, 23040
 buffer_load_dwordx4 v9, s[8:11], s45 offen  lds
 s_add_u32 m0, s49, 30720
 s_add_u32 s45, s46, 27648
 buffer_load_dwordx4 v8, s[8:11], s45 offen  lds
 s_add_u32 m0, s49, 31744
 s_add_u32 s45, s46, 32256
 buffer_load_dwordx4 v9, s[8:11], s45 offen  lds
 ds_read_b64_tr_b16 a[144:145], v10 offset:24576
 ds_read_b64_tr_b16 a[146:147], v10 offset:25088
 ds_read_b64_tr_b16 a[148:149], v11 offset:24576
 ds_read_b64_tr_b16 a[150:151], v11 offset:25088
 ds_read_b64_tr_b16 a[152:153], v12 offset:24576
 ds_read_b64_tr_b16 a[154:155], v12 offset:25088
 ds_read_b64_tr_b16 v[48:49], v13 offset:24576
 ds_read_b64_tr_b16 v[50:51], v13 offset:25088
 s_waitcnt vmcnt(0) lgkmcnt(0)
 s_add_u32 m0, s49, 32768
 s_add_u32 s45, s46, 36864
 buffer_load_dwordx4 v8, s[8:11], s45 offen  lds
 s_add_u32 m0, s49, 33792
 s_add_u32 s45, s46, 41472
 buffer_load_dwordx4 v9, s[8:11], s45 offen  lds
 s_add_u32 m0, s49, 34816
 s_add_u32 s45, s46, 46080
 buffer_load_dwordx4 v8, s[8:11], s45 offen  lds
 s_add_u32 m0, s49, 35840
 s_add_u32 s45, s46, 50688
 buffer_load_dwordx4 v9, s[8:11], s45 offen  lds
 ds_read_b64_tr_b16 a[156:157], v10 offset:28672
 ds_read_b64_tr_b16 a[158:159], v10 offset:29184
 ds_read_b64_tr_b16 a[160:161], v11 offset:28672
 ds_read_b64_tr_b16 a[162:163], v11 offset:29184
 ds_read_b64_tr_b16 a[164:165], v12 offset:28672
 ds_read_b64_tr_b16 a[166:167], v12 offset:29184
 ds_read_b64_tr_b16 v[52:53], v13 offset:28672
 ds_read_b64_tr_b16 v[54:55], v13 offset:29184
 s_waitcnt vmcnt(0) lgkmcnt(0)
 s_add_u32 m0, s49, 36864
 s_add_u32 s45, s46, 55296
 buffer_load_dwordx4 v8, s[8:11], s45 offen  lds
 s_add_u32 m0, s49, 37888
 s_add_u32 s45, s46, 59904
 buffer_load_dwordx4 v9, s[8:11], s45 offen  lds
 s_add_u32 m0, s49, 38912
 s_add_u32 s45, s46, 64512
 buffer_load_dwordx4 v8, s[8:11], s45 offen  lds
 s_add_u32 m0, s49, 39936
 s_add_u32 s45, s46, 69120
 buffer_load_dwordx4 v9, s[8:11], s45 offen  lds
 ds_read_b64_tr_b16 a[168:169], v10 offset:32768
 ds_read_b64_tr_b16 a[170:171], v10 offset:33280
 ds_read_b64_tr_b16 a[172:173], v11 offset:32768
 ds_read_b64_tr_b16 a[174:175], v11 offset:33280
 ds_read_b64_tr_b16 a[176:177], v12 offset:32768
 ds_read_b64_tr_b16 a[178:179], v12 offset:33280
 ds_read_b64_tr_b16 v[56:57], v13 offset:32768
 ds_read_b64_tr_b16 v[58:59], v13 offset:33280
 s_waitcnt vmcnt(0) lgkmcnt(0)
 s_add_u32 s46, s44, 4
 s_and_b32 s46, s46, 7
 s_lshl_b32 s45, s4, 3
 s_add_u32 s46, s46, s45
 s_mul_i32 s46, s46, 147456
 s_add_u32 s46, s46, s47
 s_add_u32 m0, s49, 8192
 s_add_u32 s45, s46, 0
 buffer_load_dwordx4 v8, s[8:11], s45 offen  lds
 s_add_u32 m0, s49, 9216
 s_add_u32 s45, s46, 4608
 buffer_load_dwordx4 v9, s[8:11], s45 offen  lds
 s_add_u32 m0, s49, 10240
 s_add_u32 s45, s46, 9216
 buffer_load_dwordx4 v8, s[8:11], s45 offen  lds
 s_add_u32 m0, s49, 11264
 s_add_u32 s45, s46, 13824
 buffer_load_dwordx4 v9, s[8:11], s45 offen  lds
 ds_read_b64_tr_b16 a[180:181], v10 offset:36864
 ds_read_b64_tr_b16 a[182:183], v10 offset:37376
 ds_read_b64_tr_b16 a[184:185], v11 offset:36864
 ds_read_b64_tr_b16 a[186:187], v11 offset:37376
 ds_read_b64_tr_b16 a[188:189], v12 offset:36864
 ds_read_b64_tr_b16 a[190:191], v12 offset:37376
 ds_read_b64_tr_b16 v[60:61], v13 offset:36864
 ds_read_b64_tr_b16 v[62:63], v13 offset:37376
 s_waitcnt vmcnt(0) lgkmcnt(0)
 s_add_u32 m0, s49, 12288
 s_add_u32 s45, s46, 18432
 buffer_load_dwordx4 v8, s[8:11], s45 offen  lds
 s_add_u32 m0, s49, 13312
 s_add_u32 s45, s46, 23040
 buffer_load_dwordx4 v9, s[8:11], s45 offen  lds
 s_add_u32 m0, s49, 14336
 s_add_u32 s45, s46, 27648
 buffer_load_dwordx4 v8, s[8:11], s45 offen  lds
 s_add_u32 m0, s49, 15360
 s_add_u32 s45, s46, 32256
 buffer_load_dwordx4 v9, s[8:11], s45 offen  lds
 ds_read_b64_tr_b16 a[192:193], v10 offset:8192
 ds_read_b64_tr_b16 a[194:195], v10 offset:8704
 ds_read_b64_tr_b16 a[196:197], v11 offset:8192
 ds_read_b64_tr_b16 a[198:199], v11 offset:8704
 ds_read_b64_tr_b16 a[200:201], v12 offset:8192
 ds_read_b64_tr_b16 a[202:203], v12 offset:8704
 ds_read_b64_tr_b16 v[64:65], v13 offset:8192
 ds_read_b64_tr_b16 v[66:67], v13 offset:8704
 s_waitcnt vmcnt(0) lgkmcnt(0)
 s_add_u32 m0, s49, 16384
 s_add_u32 s45, s46, 36864
 buffer_load_dwordx4 v8, s[8:11], s45 offen  lds
 s_add_u32 m0, s49, 17408
 s_add_u32 s45, s46, 41472
 buffer_load_dwordx4 v9, s[8:11], s45 offen  lds
 s_add_u32 m0, s49, 18432
 s_add_u32 s45, s46, 46080
 buffer_load_dwordx4 v8, s[8:11], s45 offen  lds
 s_add_u32 m0, s49, 19456
 s_add_u32 s45, s46, 50688
 buffer_load_dwordx4 v9, s[8:11], s45 offen  lds
 ds_read_b64_tr_b16 a[204:205], v10 offset:12288
 ds_read_b64_tr_b16 a[206:207], v10 offset:12800
 ds_read_b64_tr_b16 a[208:209], v11 offset:12288
 ds_read_b64_tr_b16 a[210:211], v11 offset:12800
 ds_read_b64_tr_b16 a[212:213], v12 offset:12288
 ds_read_b64_tr_b16 a[214:215], v12 offset:12800
 ds_read_b64_tr_b16 v[68:69], v13 offset:12288
 ds_read_b64_tr_b16 v[70:71], v13 offset:12800
 s_waitcnt vmcnt(0) lgkmcnt(0)
 s_add_u32 m0, s49, 20480
 s_add_u32 s45, s46, 55296
 buffer_load_dwordx4 v8, s[8:11], s45 offen  lds
 s_add_u32 m0, s49, 21504
 s_add_u32 s45, s46, 59904
 buffer_load_dwordx4 v9, s[8:11], s45 offen  lds
 s_add_u32 m0, s49, 22528
 s_add_u32 s45, s46, 64512
 buffer_load_dwordx4 v8, s[8:11], s45 offen  lds
 s_add_u32 m0, s49, 23552
 s_add_u32 s45, s46, 69120
 buffer_load_dwordx4 v9, s[8:11], s45 offen  lds
 ds_read_b64_tr_b16 a[216:217], v10 offset:16384
 ds_read_b64_tr_b16 a[218:219], v10 offset:16896
 ds_read_b64_tr_b16 a[220:221], v11 offset:16384
 ds_read_b64_tr_b16 a[222:223], v11 offset:16896
 ds_read_b64_tr_b16 a[224:225], v12 offset:16384
 ds_read_b64_tr_b16 a[226:227], v12 offset:16896
 ds_read_b64_tr_b16 v[72:73], v13 offset:16384
 ds_read_b64_tr_b16 v[74:75], v13 offset:16896
 s_waitcnt vmcnt(0) lgkmcnt(0)
 s_add_u32 s46, s44, 5
 s_and_b32 s46, s46, 7
 s_lshl_b32 s45, s4, 3
 s_add_u32 s46, s46, s45
 s_mul_i32 s46, s46, 147456
 s_add_u32 s46, s46, s47
 s_add_u32 m0, s49, 24576
 s_add_u32 s45, s46, 0
 buffer_load_dwordx4 v8, s[8:11], s45 offen  lds
 s_add_u32 m0, s49, 25600
 s_add_u32 s45, s46, 4608
 buffer_load_dwordx4 v9, s[8:11], s45 offen  lds
 s_add_u32 m0, s49, 26624
 s_add_u32 s45, s46, 9216
 buffer_load_dwordx4 v8, s[8:11], s45 offen  lds
 s_add_u32 m0, s49, 27648
 s_add_u32 s45, s46, 13824
 buffer_load_dwordx4 v9, s[8:11], s45 offen  lds
 ds_read_b64_tr_b16 a[228:229], v10 offset:20480
 ds_read_b64_tr_b16 a[230:231], v10 offset:20992
 ds_read_b64_tr_b16 a[232:233], v11 offset:20480
 ds_read_b64_tr_b16 a[234:235], v11 offset:20992
 ds_read_b64_tr_b16 a[236:237], v12 offset:20480
 ds_read_b64_tr_b16 a[238:239], v12 offset:20992
 ds_read_b64_tr_b16 v[76:77], v13 offset:20480
 ds_read_b64_tr_b16 v[78:79], v13 offset:20992
 s_waitcnt vmcnt(0) lgkmcnt(0)
 s_add_u32 m0, s49, 28672
 s_add_u32 s45, s46, 18432
 buffer_load_dwordx4 v8, s[8:11], s45 offen  lds
 s_add_u32 m0, s49, 29696
 s_add_u32 s45, s46, 23040
 buffer_load_dwordx4 v9, s[8:11], s45 offen  lds
 s_add_u32 m0, s49, 30720
 s_add_u32 s45, s46, 27648
 buffer_load_dwordx4 v8, s[8:11], s45 offen  lds
 s_add_u32 m0, s49, 31744
 s_add_u32 s45, s46, 32256
 buffer_load_dwordx4 v9, s[8:11], s45 offen  lds
 ds_read_b64_tr_b16 a[240:241], v10 offset:24576
 ds_read_b64_tr_b16 a[242:243], v10 offset:25088
 ds_read_b64_tr_b16 a[244:245], v11 offset:24576
 ds_read_b64_tr_b16 a[246:247], v11 offset:25088
 ds_read_b64_tr_b16 a[248:249], v12 offset:24576
 ds_read_b64_tr_b16 a[250:251], v12 offset:25088
 ds_read_b64_tr_b16 v[80:81], v13 offset:24576
 ds_read_b64_tr_b16 v[82:83], v13 offset:25088
 s_waitcnt vmcnt(0) lgkmcnt(0)
 s_add_u32 m0, s49, 32768
 s_add_u32 s45, s46, 36864
 buffer_load_dwordx4 v8, s[8:11], s45 offen  lds
 s_add_u32 m0, s49, 33792
 s_add_u32 s45, s46, 41472
 buffer_load_dwordx4 v9, s[8:11], s45 offen  lds
 s_add_u32 m0, s49, 34816
 s_add_u32 s45, s46, 46080
 buffer_load_dwordx4 v8, s[8:11], s45 offen  lds
 s_add_u32 m0, s49, 35840
 s_add_u32 s45, s46, 50688
 buffer_load_dwordx4 v9, s[8:11], s45 offen  lds
 ds_read_b64_tr_b16 a[252:253], v10 offset:28672
 ds_read_b64_tr_b16 a[254:255], v10 offset:29184
 ds_read_b64_tr_b16 v[128:129], v11 offset:28672
 ds_read_b64_tr_b16 v[130:131], v11 offset:29184
 ds_read_b64_tr_b16 v[132:133], v12 offset:28672
 ds_read_b64_tr_b16 v[134:135], v12 offset:29184
 ds_read_b64_tr_b16 v[84:85], v13 offset:28672
 ds_read_b64_tr_b16 v[86:87], v13 offset:29184
 s_waitcnt vmcnt(0) lgkmcnt(0)
 s_add_u32 m0, s49, 36864
 s_add_u32 s45, s46, 55296
 buffer_load_dwordx4 v8, s[8:11], s45 offen  lds
 s_add_u32 m0, s49, 37888
 s_add_u32 s45, s46, 59904
 buffer_load_dwordx4 v9, s[8:11], s45 offen  lds
 s_add_u32 m0, s49, 38912
 s_add_u32 s45, s46, 64512
 buffer_load_dwordx4 v8, s[8:11], s45 offen  lds
 s_add_u32 m0, s49, 39936
 s_add_u32 s45, s46, 69120
 buffer_load_dwordx4 v9, s[8:11], s45 offen  lds
 ds_read_b64_tr_b16 v[136:137], v10 offset:32768
 ds_read_b64_tr_b16 v[138:139], v10 offset:33280
 ds_read_b64_tr_b16 v[140:141], v11 offset:32768
 ds_read_b64_tr_b16 v[142:143], v11 offset:33280
 ds_read_b64_tr_b16 v[144:145], v12 offset:32768
 ds_read_b64_tr_b16 v[146:147], v12 offset:33280
 ds_read_b64_tr_b16 v[88:89], v13 offset:32768
 ds_read_b64_tr_b16 v[90:91], v13 offset:33280
 s_waitcnt vmcnt(0) lgkmcnt(0)
 s_add_u32 s46, s44, 6
 s_and_b32 s46, s46, 7
 s_lshl_b32 s45, s4, 3
 s_add_u32 s46, s46, s45
 s_mul_i32 s46, s46, 147456
 s_add_u32 s46, s46, s47
 s_add_u32 m0, s49, 8192
 s_add_u32 s45, s46, 0
 buffer_load_dwordx4 v8, s[8:11], s45 offen  lds
 s_add_u32 m0, s49, 9216
 s_add_u32 s45, s46, 4608
 buffer_load_dwordx4 v9, s[8:11], s45 offen  lds
 s_add_u32 m0, s49, 10240
 s_add_u32 s45, s46, 9216
 buffer_load_dwordx4 v8, s[8:11], s45 offen  lds
 s_add_u32 m0, s49, 11264
 s_add_u32 s45, s46, 13824
 buffer_load_dwordx4 v9, s[8:11], s45 offen  lds
 ds_read_b64_tr_b16 v[148:149], v10 offset:36864
 ds_read_b64_tr_b16 v[150:151], v10 offset:37376
 ds_read_b64_tr_b16 v[152:153], v11 offset:36864
 ds_read_b64_tr_b16 v[154:155], v11 offset:37376
 ds_read_b64_tr_b16 v[156:157], v12 offset:36864
 ds_read_b64_tr_b16 v[158:159], v12 offset:37376
 ds_read_b64_tr_b16 v[92:93], v13 offset:36864
 ds_read_b64_tr_b16 v[94:95], v13 offset:37376
 s_waitcnt vmcnt(0) lgkmcnt(0)
 s_add_u32 m0, s49, 12288
 s_add_u32 s45, s46, 18432
 buffer_load_dwordx4 v8, s[8:11], s45 offen  lds
 s_add_u32 m0, s49, 13312
 s_add_u32 s45, s46, 23040
 buffer_load_dwordx4 v9, s[8:11], s45 offen  lds
 s_add_u32 m0, s49, 14336
 s_add_u32 s45, s46, 27648
 buffer_load_dwordx4 v8, s[8:11], s45 offen  lds
 s_add_u32 m0, s49, 15360
 s_add_u32 s45, s46, 32256
 buffer_load_dwordx4 v9, s[8:11], s45 offen  lds
 ds_read_b64_tr_b16 v[160:161], v10 offset:8192
 ds_read_b64_tr_b16 v[162:163], v10 offset:8704
 ds_read_b64_tr_b16 v[164:165], v11 offset:8192
 ds_read_b64_tr_b16 v[166:167], v11 offset:8704
 ds_read_b64_tr_b16 v[168:169], v12 offset:8192
 ds_read_b64_tr_b16 v[170:171], v12 offset:8704
 ds_read_b64_tr_b16 v[96:97], v13 offset:8192
 ds_read_b64_tr_b16 v[98:99], v13 offset:8704
 s_waitcnt vmcnt(0) lgkmcnt(0)
 s_add_u32 m0, s49, 16384
 s_add_u32 s45, s46, 36864
 buffer_load_dwordx4 v8, s[8:11], s45 offen  lds
 s_add_u32 m0, s49, 17408
 s_add_u32 s45, s46, 41472
 buffer_load_dwordx4 v9, s[8:11], s45 offen  lds
 s_add_u32 m0, s49, 18432
 s_add_u32 s45, s46, 46080
 buffer_load_dwordx4 v8, s[8:11], s45 offen  lds
 s_add_u32 m0, s49, 19456
 s_add_u32 s45, s46, 50688
 buffer_load_dwordx4 v9, s[8:11], s45 offen  lds
 ds_read_b64_tr_b16 v[172:173], v10 offset:12288
 ds_read_b64_tr_b16 v[174:175], v10 offset:12800
 ds_read_b64_tr_b16 v[176:177], v11 offset:12288
 ds_read_b64_tr_b16 v[178:179], v11 offset:12800
 ds_read_b64_tr_b16 v[180:181], v12 offset:12288
 ds_read_b64_tr_b16 v[182:183], v12 offset:12800
 ds_read_b64_tr_b16 v[100:101], v13 offset:12288
 ds_read_b64_tr_b16 v[102:103], v13 offset:12800
 s_waitcnt vmcnt(0) lgkmcnt(0)
 s_add_u32 m0, s49, 20480
 s_add_u32 s45, s46, 55296
 buffer_load_dwordx4 v8, s[8:11], s45 offen  lds
 s_add_u32 m0, s49, 21504
 s_add_u32 s45, s46, 59904
 buffer_load_dwordx4 v9, s[8:11], s45 offen  lds
 s_add_u32 m0, s49, 22528
 s_add_u32 s45, s46, 64512
 buffer_load_dwordx4 v8, s[8:11], s45 offen  lds
 s_add_u32 m0, s49, 23552
 s_add_u32 s45, s46, 69120
 buffer_load_dwordx4 v9, s[8:11], s45 offen  lds
 ds_read_b64_tr_b16 v[184:185], v10 offset:16384
 ds_read_b64_tr_b16 v[186:187], v10 offset:16896
 ds_read_b64_tr_b16 v[188:189], v11 offset:16384
 ds_read_b64_tr_b16 v[190:191], v11 offset:16896
 ds_read_b64_tr_b16 v[192:193], v12 offset:16384
 ds_read_b64_tr_b16 v[194:195], v12 offset:16896
 ds_read_b64_tr_b16 v[104:105], v13 offset:16384
 ds_read_b64_tr_b16 v[106:107], v13 offset:16896
 s_waitcnt vmcnt(0) lgkmcnt(0)
 s_add_u32 s46, s44, 7
 s_and_b32 s46, s46, 7
 s_lshl_b32 s45, s4, 3
 s_add_u32 s46, s46, s45
 s_mul_i32 s46, s46, 147456
 s_add_u32 s46, s46, s47
 s_add_u32 m0, s49, 24576
 s_add_u32 s45, s46, 0
 buffer_load_dwordx4 v8, s[8:11], s45 offen  lds
 s_add_u32 m0, s49, 25600
 s_add_u32 s45, s46, 4608
 buffer_load_dwordx4 v9, s[8:11], s45 offen  lds
 s_add_u32 m0, s49, 26624
 s_add_u32 s45, s46, 9216
 buffer_load_dwordx4 v8, s[8:11], s45 offen  lds
 s_add_u32 m0, s49, 27648
 s_add_u32 s45, s46, 13824
 buffer_load_dwordx4 v9, s[8:11], s45 offen  lds
 ds_read_b64_tr_b16 v[196:197], v10 offset:20480
 ds_read_b64_tr_b16 v[198:199], v10 offset:20992
 ds_read_b64_tr_b16 v[200:201], v11 offset:20480
 ds_read_b64_tr_b16 v[202:203], v11 offset:20992
 ds_read_b64_tr_b16 v[204:205], v12 offset:20480
 ds_read_b64_tr_b16 v[206:207], v12 offset:20992
 ds_read_b64_tr_b16 v[108:109], v13 offset:20480
 ds_read_b64_tr_b16 v[110:111], v13 offset:20992
 s_waitcnt vmcnt(0) lgkmcnt(0)
 s_add_u32 m0, s49, 28672
 s_add_u32 s45, s46, 18432
 buffer_load_dwordx4 v8, s[8:11], s45 offen  lds
 s_add_u32 m0, s49, 29696
 s_add_u32 s45, s46, 23040
 buffer_load_dwordx4 v9, s[8:11], s45 offen  lds
 s_add_u32 m0, s49, 30720
 s_add_u32 s45, s46, 27648
 buffer_load_dwordx4 v8, s[8:11], s45 offen  lds
 s_add_u32 m0, s49, 31744
 s_add_u32 s45, s46, 32256
 buffer_load_dwordx4 v9, s[8:11], s45 offen  lds
 ds_read_b64_tr_b16 v[208:209], v10 offset:24576
 ds_read_b64_tr_b16 v[210:211], v10 offset:25088
 ds_read_b64_tr_b16 v[212:213], v11 offset:24576
 ds_read_b64_tr_b16 v[214:215], v11 offset:25088
 ds_read_b64_tr_b16 v[216:217], v12 offset:24576
 ds_read_b64_tr_b16 v[218:219], v12 offset:25088
 ds_read_b64_tr_b16 v[112:113], v13 offset:24576
 ds_read_b64_tr_b16 v[114:115], v13 offset:25088
 s_waitcnt vmcnt(0) lgkmcnt(0)
 s_add_u32 m0, s49, 32768
 s_add_u32 s45, s46, 36864
 buffer_load_dwordx4 v8, s[8:11], s45 offen  lds
 s_add_u32 m0, s49, 33792
 s_add_u32 s45, s46, 41472
 buffer_load_dwordx4 v9, s[8:11], s45 offen  lds
 s_add_u32 m0, s49, 34816
 s_add_u32 s45, s46, 46080
 buffer_load_dwordx4 v8, s[8:11], s45 offen  lds
 s_add_u32 m0, s49, 35840
 s_add_u32 s45, s46, 50688
 buffer_load_dwordx4 v9, s[8:11], s45 offen  lds
 ds_read_b64_tr_b16 v[220:221], v10 offset:28672
 ds_read_b64_tr_b16 v[222:223], v10 offset:29184
 ds_read_b64_tr_b16 v[224:225], v11 offset:28672
 ds_read_b64_tr_b16 v[226:227], v11 offset:29184
 ds_read_b64_tr_b16 v[228:229], v12 offset:28672
 ds_read_b64_tr_b16 v[230:231], v12 offset:29184
 ds_read_b64_tr_b16 v[116:117], v13 offset:28672
 ds_read_b64_tr_b16 v[118:119], v13 offset:29184
 s_waitcnt vmcnt(0) lgkmcnt(0)
 s_add_u32 m0, s49, 36864
 s_add_u32 s45, s46, 55296
 buffer_load_dwordx4 v8, s[8:11], s45 offen  lds
 s_add_u32 m0, s49, 37888
 s_add_u32 s45, s46, 59904
 buffer_load_dwordx4 v9, s[8:11], s45 offen  lds
 s_add_u32 m0, s49, 38912
 s_add_u32 s45, s46, 64512
 buffer_load_dwordx4 v8, s[8:11], s45 offen  lds
 s_add_u32 m0, s49, 39936
 s_add_u32 s45, s46, 69120
 buffer_load_dwordx4 v9, s[8:11], s45 offen  lds
 ds_read_b64_tr_b16 v[232:233], v10 offset:32768
 ds_read_b64_tr_b16 v[234:235], v10 offset:33280
 ds_read_b64_tr_b16 v[236:237], v11 offset:32768
 ds_read_b64_tr_b16 v[238:239], v11 offset:33280
 ds_read_b64_tr_b16 v[240:241], v12 offset:32768
 ds_read_b64_tr_b16 v[242:243], v12 offset:33280
 ds_read_b64_tr_b16 v[120:121], v13 offset:32768
 ds_read_b64_tr_b16 v[122:123], v13 offset:33280
 s_waitcnt vmcnt(0) lgkmcnt(0)
 ds_read_b64_tr_b16 v[244:245], v10 offset:36864
 ds_read_b64_tr_b16 v[246:247], v10 offset:37376
 ds_read_b64_tr_b16 v[248:249], v11 offset:36864
 ds_read_b64_tr_b16 v[250:251], v11 offset:37376
 ds_read_b64_tr_b16 v[252:253], v12 offset:36864
 ds_read_b64_tr_b16 v[254:255], v12 offset:37376
 ds_read_b64_tr_b16 v[124:125], v13 offset:36864
 ds_read_b64_tr_b16 v[126:127], v13 offset:37376
 s_waitcnt lgkmcnt(0)
 ds_write_b128 v5, v[32:35] offset:8192
 ds_write_b128 v5, v[36:39] offset:9216
 ds_write_b128 v5, v[40:43] offset:10240
 ds_write_b128 v5, v[44:47] offset:11264
 ds_write_b128 v5, v[48:51] offset:12288
 ds_write_b128 v5, v[52:55] offset:13312
 ds_write_b128 v5, v[56:59] offset:14336
 ds_write_b128 v5, v[60:63] offset:15360
 ds_write_b128 v5, v[64:67] offset:16384
 ds_write_b128 v5, v[68:71] offset:17408
 ds_write_b128 v5, v[72:75] offset:18432
 ds_write_b128 v5, v[76:79] offset:19456
 ds_write_b128 v5, v[80:83] offset:20480
 ds_write_b128 v5, v[84:87] offset:21504
 ds_write_b128 v5, v[88:91] offset:22528
 ds_write_b128 v5, v[92:95] offset:23552
 ds_write_b128 v5, v[96:99] offset:24576
 ds_write_b128 v5, v[100:103] offset:25600
 ds_write_b128 v5, v[104:107] offset:26624
 ds_write_b128 v5, v[108:111] offset:27648
 ds_write_b128 v5, v[112:115] offset:28672
 ds_write_b128 v5, v[116:119] offset:29696
 ds_write_b128 v5, v[120:123] offset:30720
 ds_write_b128 v5, v[124:127] offset:31744
 s_waitcnt lgkmcnt(0)
 v_lshrrev_b32 v13, 2, v15
 v_and_b32 v14, 3, v15
 s_lshr_b32 s45, s4, 1
 s_mul_i32 s45, s45, 36864
 s_and_b32 s46, s4, 1
 s_lshl_b32 s46, s46, 6
 s_add_u32 s45, s45, s46
 s_add_u32 s37, s37, s45
 v_mul_u32_u24 v6, 2304, v13
 v_lshl_add_u32 v6, v14, 4, v6
 v_lshl_add_u32 v13, v14, 2, v13
 v_and_b32 v13, 15, v13
 v_lshlrev_b32 v13, 4, v13
 s_lshl_b32 s45, s4, 11
 v_lshl_add_u32 v12, v14, 9, v13
 v_add_u32 v12, s45, v12
 v_lshrrev_b32 v13, 5, v15
 v_lshl_add_u32 v13, v13, 2, v15
 v_and_b32 v13, 15, v13
 v_and_or_b32 v13, v15, 48, v13
 v_lshlrev_b32 v13, 4, v13
 v_xor_b32 v14, 0x80, v13
 v_add_u32 v15, s49, v14
 v_add_u32 v14, s49, v13
 v_add_u32 v4, 32768, v12
 v_add_u32 v7, 114688, v12
 s_lshl_b32 s45, s32, 7
 s_add_u32 s37, s37, s45
 s_lshl_b32 s45, s4, 16
 s_add_u32 s36, s36, s45
 s_mov_b32 s42, s33
 s_mov_b32 s43, 0
 s_and_b32 s53, s42, s93
 s_lshl_b32 s53, s53, s91
 s_add_u32 s53, s53, s38
 s_lshr_b32 s51, s42, s90
 s_add_u32 s51, s51, 1
 ds_read_b128 v[16:19], v5 offset:0
 ds_read_b128 v[20:23], v5 offset:1024
Los0_50:
 buffer_load_dword v2, v3, s[20:23], s53 offen sc1
 s_waitcnt vmcnt(0)
 v_cmp_gt_u32 vcc, s51, v2
 s_and_b32 s52, vcc_lo, 0xffff
 s_cbranch_scc0 Los0k_51
 s_sleep 4
 s_sub_u32 s50, s50, 1
 s_cbranch_scc0 Los0_50
 s_endpgm
Los0k_51:
 s_lshl_b32 s48, s42, 18
 s_add_u32 s48, s48, s36
 s_add_u32 s52, s44, 0
 s_and_b32 s52, s52, 7
 s_lshl_b32 s52, s52, 13
 s_add_u32 s46, s48, s52
 s_add_u32 s47, s46, 4096
 buffer_load_dwordx4 v[32:35], v1, s[20:23], s46 offen offset:0 sc1
 buffer_load_dwordx4 v[36:39], v1, s[20:23], s46 offen offset:1024 sc1
 buffer_load_dwordx4 v[40:43], v1, s[20:23], s46 offen offset:2048 sc1
 buffer_load_dwordx4 v[44:47], v1, s[20:23], s46 offen offset:3072 sc1
 buffer_load_dwordx4 v[48:51], v1, s[20:23], s47 offen offset:0 sc1
 buffer_load_dwordx4 v[52:55], v1, s[20:23], s47 offen offset:1024 sc1
 buffer_load_dwordx4 v[56:59], v1, s[20:23], s47 offen offset:2048 sc1
 buffer_load_dwordx4 v[60:63], v1, s[20:23], s47 offen offset:3072 sc1
 s_add_u32 s52, s44, 1
 s_and_b32 s52, s52, 7
 s_lshl_b32 s52, s52, 13
 s_add_u32 s46, s48, s52
 s_add_u32 s47, s46, 4096
 buffer_load_dwordx4 v[64:67], v1, s[20:23], s46 offen offset:0 sc1
 buffer_load_dwordx4 v[68:71], v1, s[20:23], s46 offen offset:1024 sc1
 buffer_load_dwordx4 v[72:75], v1, s[20:23], s46 offen offset:2048 sc1
 buffer_load_dwordx4 v[76:79], v1, s[20:23], s46 offen offset:3072 sc1
 buffer_load_dwordx4 v[80:83], v1, s[20:23], s47 offen offset:0 sc1
 buffer_load_dwordx4 v[84:87], v1, s[20:23], s47 offen offset:1024 sc1
 buffer_load_dwordx4 v[88:91], v1, s[20:23], s47 offen offset:2048 sc1
 buffer_load_dwordx4 v[92:95], v1, s[20:23], s47 offen offset:3072 sc1
 .p2align 3
Losl_52:
 s_waitcnt vmcnt(14) lgkmcnt(1)
 v_mfma_f32_16x16x32_bf16 v[96:99], a[0:3], v[32:35], 0
 s_add_u32 s52, s44, 2
 s_and_b32 s52, s52, 7
 v_mfma_f32_16x16x32_bf16 v[100:103], a[4:7], v[32:35], 0
 s_lshl_b32 s52, s52, 13
 s_add_u32 s46, s48, s52
 v_mfma_f32_16x16x32_bf16 v[104:107], a[8:11], v[32:35], 0
 s_add_u32 s47, s46, 4096
 v_mfma_f32_16x16x32_bf16 v[108:111], v[16:19], v[32:35], 0
 buffer_load_dwordx4 v[32:35], v1, s[20:23], s46 offen offset:0 sc1
 v_mfma_f32_16x16x32_bf16 v[112:115], a[0:3], v[36:39], 0
 ds_read_b128 v[24:27], v5 offset:2048
 v_mfma_f32_16x16x32_bf16 v[116:119], a[4:7], v[36:39], 0
 v_mfma_f32_16x16x32_bf16 v[120:123], a[8:11], v[36:39], 0
 v_mfma_f32_16x16x32_bf16 v[124:127], v[16:19], v[36:39], 0
 buffer_load_dwordx4 v[36:39], v1, s[20:23], s46 offen offset:1024 sc1
 s_waitcnt vmcnt(14) lgkmcnt(1)
 v_mfma_f32_16x16x32_bf16 v[96:99], a[12:15], v[40:43], v[96:99]
 s_mov_b32 s41, s42
 s_add_u32 s43, s43, 1
 v_mfma_f32_16x16x32_bf16 v[100:103], a[16:19], v[40:43], v[100:103]
 s_cmp_lt_u32 s43, s35
 s_cselect_b32 s45, s34, 0
 v_mfma_f32_16x16x32_bf16 v[104:107], a[20:23], v[40:43], v[104:107]
 s_xor_b32 s34, s34, s39
 s_add_u32 s42, s42, s45
 v_mfma_f32_16x16x32_bf16 v[108:111], v[20:23], v[40:43], v[108:111]
 buffer_load_dwordx4 v[40:43], v1, s[20:23], s46 offen offset:2048 sc1
 v_mfma_f32_16x16x32_bf16 v[112:115], a[12:15], v[44:47], v[112:115]
 ds_read_b128 v[28:31], v5 offset:3072
 v_mfma_f32_16x16x32_bf16 v[116:119], a[16:19], v[44:47], v[116:119]
 v_mfma_f32_16x16x32_bf16 v[120:123], a[20:23], v[44:47], v[120:123]
 v_mfma_f32_16x16x32_bf16 v[124:127], v[20:23], v[44:47], v[124:127]
 buffer_load_dwordx4 v[44:47], v1, s[20:23], s46 offen offset:3072 sc1
 s_waitcnt vmcnt(14) lgkmcnt(1)
 v_mfma_f32_16x16x32_bf16 v[96:99], a[24:27], v[48:51], v[96:99]
 s_and_b32 s53, s42, s93
 s_lshl_b32 s53, s53, s91
 v_mfma_f32_16x16x32_bf16 v[100:103], a[28:31], v[48:51], v[100:103]
 s_add_u32 s53, s53, s38
 s_lshr_b32 s51, s42, s90
 v_mfma_f32_16x16x32_bf16 v[104:107], a[32:35], v[48:51], v[104:107]
 s_add_u32 s51, s51, 1
 v_mfma_f32_16x16x32_bf16 v[108:111], v[24:27], v[48:51], v[108:111]
 buffer_load_dwordx4 v[48:51], v1, s[20:23], s47 offen offset:0 sc1
 v_mfma_f32_16x16x32_bf16 v[112:115], a[24:27], v[52:55], v[112:115]
 ds_read_b128 v[16:19], v5 offset:4096
 v_mfma_f32_16x16x32_bf16 v[116:119], a[28:31], v[52:55], v[116:119]
 v_mfma_f32_16x16x32_bf16 v[120:123], a[32:35], v[52:55], v[120:123]
 v_mfma_f32_16x16x32_bf16 v[124:127], v[24:27], v[52:55], v[124:127]
 buffer_load_dwordx4 v[52:55], v1, s[20:23], s47 offen offset:1024 sc1
 s_waitcnt vmcnt(14) lgkmcnt(1)
 v_mfma_f32_16x16x32_bf16 v[96:99], a[36:39], v[56:59], v[96:99]
 s_mul_i32 s54, s41, 73728
 s_add_u32 s54, s54, s37
 v_mfma_f32_16x16x32_bf16 v[100:103], a[40:43], v[56:59], v[100:103]
 s_cmp_lt_u32 s43, s35
 s_cselect_b32 s51, s51, -1
 v_mfma_f32_16x16x32_bf16 v[104:107], a[44:47], v[56:59], v[104:107]
 v_mfma_f32_16x16x32_bf16 v[108:111], v[28:31], v[56:59], v[108:111]
 buffer_load_dwordx4 v[56:59], v1, s[20:23], s47 offen offset:2048 sc1
 v_mfma_f32_16x16x32_bf16 v[112:115], a[36:39], v[60:63], v[112:115]
 ds_read_b128 v[20:23], v5 offset:5120
 v_mfma_f32_16x16x32_bf16 v[116:119], a[40:43], v[60:63], v[116:119]
 v_mfma_f32_16x16x32_bf16 v[120:123], a[44:47], v[60:63], v[120:123]
 v_mfma_f32_16x16x32_bf16 v[124:127], v[28:31], v[60:63], v[124:127]
 buffer_load_dwordx4 v[60:63], v1, s[20:23], s47 offen offset:3072 sc1
 s_waitcnt vmcnt(14) lgkmcnt(1)
 v_mfma_f32_16x16x32_bf16 v[96:99], a[48:51], v[64:67], v[96:99]
 s_add_u32 s52, s44, 3
 s_and_b32 s52, s52, 7
 v_mfma_f32_16x16x32_bf16 v[100:103], a[52:55], v[64:67], v[100:103]
 s_lshl_b32 s52, s52, 13
 s_add_u32 s46, s48, s52
 v_mfma_f32_16x16x32_bf16 v[104:107], a[56:59], v[64:67], v[104:107]
 s_add_u32 s47, s46, 4096
 v_mfma_f32_16x16x32_bf16 v[108:111], v[16:19], v[64:67], v[108:111]
 buffer_load_dwordx4 v[64:67], v1, s[20:23], s46 offen offset:0 sc1
 v_mfma_f32_16x16x32_bf16 v[112:115], a[48:51], v[68:71], v[112:115]
 ds_read_b128 v[24:27], v5 offset:6144
 v_mfma_f32_16x16x32_bf16 v[116:119], a[52:55], v[68:71], v[116:119]
 v_mfma_f32_16x16x32_bf16 v[120:123], a[56:59], v[68:71], v[120:123]
 v_mfma_f32_16x16x32_bf16 v[124:127], v[16:19], v[68:71], v[124:127]
 buffer_load_dwordx4 v[68:71], v1, s[20:23], s46 offen offset:1024 sc1
 s_waitcnt vmcnt(14) lgkmcnt(1)
 v_mfma_f32_16x16x32_bf16 v[96:99], a[60:63], v[72:75], v[96:99]
 v_mfma_f32_16x16x32_bf16 v[100:103], a[64:67], v[72:75], v[100:103]
 v_mfma_f32_16x16x32_bf16 v[104:107], a[68:71], v[72:75], v[104:107]
 v_mfma_f32_16x16x32_bf16 v[108:111], v[20:23], v[72:75], v[108:111]
 buffer_load_dwordx4 v[72:75], v1, s[20:23], s46 offen offset:2048 sc1
 v_mfma_f32_16x16x32_bf16 v[112:115], a[60:63], v[76:79], v[112:115]
 ds_read_b128 v[28:31], v5 offset:7168
 v_mfma_f32_16x16x32_bf16 v[116:119], a[64:67], v[76:79], v[116:119]
 v_mfma_f32_16x16x32_bf16 v[120:123], a[68:71], v[76:79], v[120:123]
 v_mfma_f32_16x16x32_bf16 v[124:127], v[20:23], v[76:79], v[124:127]
 buffer_load_dwordx4 v[76:79], v1, s[20:23], s46 offen offset:3072 sc1
 s_waitcnt vmcnt(14) lgkmcnt(1)
 v_mfma_f32_16x16x32_bf16 v[96:99], a[72:75], v[80:83], v[96:99]
 v_mfma_f32_16x16x32_bf16 v[100:103], a[76:79], v[80:83], v[100:103]
 v_mfma_f32_16x16x32_bf16 v[104:107], a[80:83], v[80:83], v[104:107]
 v_mfma_f32_16x16x32_bf16 v[108:111], v[24:27], v[80:83], v[108:111]
 buffer_load_dwordx4 v[80:83], v1, s[20:23], s47 offen offset:0 sc1
 v_mfma_f32_16x16x32_bf16 v[112:115], a[72:75], v[84:87], v[112:115]
 ds_read_b128 v[16:19], v5 offset:8192
 v_mfma_f32_16x16x32_bf16 v[116:119], a[76:79], v[84:87], v[116:119]
 v_mfma_f32_16x16x32_bf16 v[120:123], a[80:83], v[84:87], v[120:123]
 v_mfma_f32_16x16x32_bf16 v[124:127], v[24:27], v[84:87], v[124:127]
 buffer_load_dwordx4 v[84:87], v1, s[20:23], s47 offen offset:1024 sc1
 s_waitcnt vmcnt(14) lgkmcnt(1)
 v_mfma_f32_16x16x32_bf16 v[96:99], a[84:87], v[88:91], v[96:99]
 v_mfma_f32_16x16x32_bf16 v[100:103], a[88:91], v[88:91], v[100:103]
 v_mfma_f32_16x16x32_bf16 v[104:107], a[92:95], v[88:91], v[104:107]
 v_mfma_f32_16x16x32_bf16 v[108:111], v[28:31], v[88:91], v[108:111]
 buffer_load_dwordx4 v[88:91], v1, s[20:23], s47 offen offset:2048 sc1
 v_mfma_f32_16x16x32_bf16 v[112:115], a[84:87], v[92:95], v[112:115]
 ds_read_b128 v[20:23], v5 offset:9216
 v_mfma_f32_16x16x32_bf16 v[116:119], a[88:91], v[92:95], v[116:119]
 v_mfma_f32_16x16x32_bf16 v[120:123], a[92:95], v[92:95], v[120:123]
 v_mfma_f32_16x16x32_bf16 v[124:127], v[28:31], v[92:95], v[124:127]
 buffer_load_dwordx4 v[92:95], v1, s[20:23], s47 offen offset:3072 sc1
 s_waitcnt vmcnt(14) lgkmcnt(1)
 v_mfma_f32_16x16x32_bf16 v[96:99], a[96:99], v[32:35], v[96:99]
 s_add_u32 s52, s44, 4
 s_and_b32 s52, s52, 7
 v_mfma_f32_16x16x32_bf16 v[100:103], a[100:103], v[32:35], v[100:103]
 s_lshl_b32 s52, s52, 13
 s_add_u32 s46, s48, s52
 v_mfma_f32_16x16x32_bf16 v[104:107], a[104:107], v[32:35], v[104:107]
 s_add_u32 s47, s46, 4096
 v_mfma_f32_16x16x32_bf16 v[108:111], v[16:19], v[32:35], v[108:111]
 buffer_load_dwordx4 v[32:35], v1, s[20:23], s46 offen offset:0 sc1
 v_mfma_f32_16x16x32_bf16 v[112:115], a[96:99], v[36:39], v[112:115]
 ds_read_b128 v[24:27], v5 offset:10240
 v_mfma_f32_16x16x32_bf16 v[116:119], a[100:103], v[36:39], v[116:119]
 v_mfma_f32_16x16x32_bf16 v[120:123], a[104:107], v[36:39], v[120:123]
 v_mfma_f32_16x16x32_bf16 v[124:127], v[16:19], v[36:39], v[124:127]
 buffer_load_dwordx4 v[36:39], v1, s[20:23], s46 offen offset:1024 sc1
 s_waitcnt vmcnt(14) lgkmcnt(1)
 v_mfma_f32_16x16x32_bf16 v[96:99], a[108:111], v[40:43], v[96:99]
 v_mfma_f32_16x16x32_bf16 v[100:103], a[112:115], v[40:43], v[100:103]
 v_mfma_f32_16x16x32_bf16 v[104:107], a[116:119], v[40:43], v[104:107]
 v_mfma_f32_16x16x32_bf16 v[108:111], v[20:23], v[40:43], v[108:111]
 buffer_load_dwordx4 v[40:43], v1, s[20:23], s46 offen offset:2048 sc1
 v_mfma_f32_16x16x32_bf16 v[112:115], a[108:111], v[44:47], v[112:115]
 ds_read_b128 v[28:31], v5 offset:11264
 v_mfma_f32_16x16x32_bf16 v[116:119], a[112:115], v[44:47], v[116:119]
 v_mfma_f32_16x16x32_bf16 v[120:123], a[116:119], v[44:47], v[120:123]
 v_mfma_f32_16x16x32_bf16 v[124:127], v[20:23], v[44:47], v[124:127]
 buffer_load_dwordx4 v[44:47], v1, s[20:23], s46 offen offset:3072 sc1
 s_waitcnt vmcnt(14) lgkmcnt(1)
 v_mfma_f32_16x16x32_bf16 v[96:99], a[120:123], v[48:51], v[96:99]
 s_barrier
 v_mfma_f32_16x16x32_bf16 v[100:103], a[124:127], v[48:51], v[100:103]
 v_mfma_f32_16x16x32_bf16 v[104:107], a[128:131], v[48:51], v[104:107]
 v_mfma_f32_16x16x32_bf16 v[108:111], v[24:27], v[48:51], v[108:111]
 buffer_load_dwordx4 v[48:51], v1, s[20:23], s47 offen offset:0 sc1
 v_mfma_f32_16x16x32_bf16 v[112:115], a[120:123], v[52:55], v[112:115]
 ds_read_b128 v[16:19], v5 offset:12288
 v_mfma_f32_16x16x32_bf16 v[116:119], a[124:127], v[52:55], v[116:119]
 v_mfma_f32_16x16x32_bf16 v[120:123], a[128:131], v[52:55], v[120:123]
 v_mfma_f32_16x16x32_bf16 v[124:127], v[24:27], v[52:55], v[124:127]
 buffer_load_dwordx4 v[52:55], v1, s[20:23], s47 offen offset:1024 sc1
 s_waitcnt vmcnt(14) lgkmcnt(1)
 v_mfma_f32_16x16x32_bf16 v[96:99], a[132:135], v[56:59], v[96:99]
 v_mfma_f32_16x16x32_bf16 v[100:103], a[136:139], v[56:59], v[100:103]
 v_mfma_f32_16x16x32_bf16 v[104:107], a[140:143], v[56:59], v[104:107]
 v_mfma_f32_16x16x32_bf16 v[108:111], v[28:31], v[56:59], v[108:111]
 buffer_load_dwordx4 v[56:59], v1, s[20:23], s47 offen offset:2048 sc1
 v_mfma_f32_16x16x32_bf16 v[112:115], a[132:135], v[60:63], v[112:115]
 ds_read_b128 v[20:23], v5 offset:13312
 v_mfma_f32_16x16x32_bf16 v[116:119], a[136:139], v[60:63], v[116:119]
 v_mfma_f32_16x16x32_bf16 v[120:123], a[140:143], v[60:63], v[120:123]
 v_mfma_f32_16x16x32_bf16 v[124:127], v[28:31], v[60:63], v[124:127]
 buffer_load_dwordx4 v[60:63], v1, s[20:23], s47 offen offset:3072 sc1
 s_waitcnt vmcnt(14) lgkmcnt(1)
 v_mfma_f32_16x16x32_bf16 v[96:99], a[144:147], v[64:67], v[96:99]
 s_add_u32 s52, s44, 5
 s_and_b32 s52, s52, 7
 v_mfma_f32_16x16x32_bf16 v[100:103], a[148:151], v[64:67], v[100:103]
 s_lshl_b32 s52, s52, 13
 s_add_u32 s46, s48, s52
 v_mfma_f32_16x16x32_bf16 v[104:107], a[152:155], v[64:67], v[104:107]
 s_add_u32 s47, s46, 4096
 v_mfma_f32_16x16x32_bf16 v[108:111], v[16:19], v[64:67], v[108:111]
 buffer_load_dwordx4 v[64:67], v1, s[20:23], s46 offen offset:0 sc1
 v_mfma_f32_16x16x32_bf16 v[112:115], a[144:147], v[68:71], v[112:115]
 ds_read_b128 v[24:27], v5 offset:14336
 v_mfma_f32_16x16x32_bf16 v[116:119], a[148:151], v[68:71], v[116:119]
 v_mfma_f32_16x16x32_bf16 v[120:123], a[152:155], v[68:71], v[120:123]
 v_mfma_f32_16x16x32_bf16 v[124:127], v[16:19], v[68:71], v[124:127]
 buffer_load_dwordx4 v[68:71], v1, s[20:23], s46 offen offset:1024 sc1
 s_waitcnt vmcnt(14) lgkmcnt(1)
 v_mfma_f32_16x16x32_bf16 v[96:99], a[156:159], v[72:75], v[96:99]
 buffer_load_dword v2, v3, s[20:23], s53 offen sc1
 v_mfma_f32_16x16x32_bf16 v[100:103], a[160:163], v[72:75], v[100:103]
 v_mfma_f32_16x16x32_bf16 v[104:107], a[164:167], v[72:75], v[104:107]
 v_mfma_f32_16x16x32_bf16 v[108:111], v[20:23], v[72:75], v[108:111]
 buffer_load_dwordx4 v[72:75], v1, s[20:23], s46 offen offset:2048 sc1
 v_mfma_f32_16x16x32_bf16 v[112:115], a[156:159], v[76:79], v[112:115]
 ds_read_b128 v[28:31], v5 offset:15360
 v_mfma_f32_16x16x32_bf16 v[116:119], a[160:163], v[76:79], v[116:119]
 v_mfma_f32_16x16x32_bf16 v[120:123], a[164:167], v[76:79], v[120:123]
 v_mfma_f32_16x16x32_bf16 v[124:127], v[20:23], v[76:79], v[124:127]
 buffer_load_dwordx4 v[76:79], v1, s[20:23], s46 offen offset:3072 sc1
 s_waitcnt vmcnt(14) lgkmcnt(1)
 v_mfma_f32_16x16x32_bf16 v[96:99], a[168:171], v[80:83], v[96:99]
 v_mfma_f32_16x16x32_bf16 v[100:103], a[172:175], v[80:83], v[100:103]
 v_mfma_f32_16x16x32_bf16 v[104:107], a[176:179], v[80:83], v[104:107]
 v_mfma_f32_16x16x32_bf16 v[108:111], v[24:27], v[80:83], v[108:111]
 buffer_load_dwordx4 v[80:83], v1, s[20:23], s47 offen offset:0 sc1
 v_mfma_f32_16x16x32_bf16 v[112:115], a[168:171], v[84:87], v[112:115]
 ds_read_b128 v[16:19], v5 offset:16384
 v_mfma_f32_16x16x32_bf16 v[116:119], a[172:175], v[84:87], v[116:119]
 v_mfma_f32_16x16x32_bf16 v[120:123], a[176:179], v[84:87], v[120:123]
 v_mfma_f32_16x16x32_bf16 v[124:127], v[24:27], v[84:87], v[124:127]
 buffer_load_dwordx4 v[84:87], v1, s[20:23], s47 offen offset:1024 sc1
 s_waitcnt vmcnt(14) lgkmcnt(1)
 v_mfma_f32_16x16x32_bf16 v[96:99], a[180:183], v[88:91], v[96:99]
 v_mfma_f32_16x16x32_bf16 v[100:103], a[184:187], v[88:91], v[100:103]
 v_mfma_f32_16x16x32_bf16 v[104:107], a[188:191], v[88:91], v[104:107]
 v_mfma_f32_16x16x32_bf16 v[108:111], v[28:31], v[88:91], v[108:111]
 buffer_load_dwordx4 v[88:91], v1, s[20:23], s47 offen offset:2048 sc1
 v_mfma_f32_16x16x32_bf16 v[112:115], a[180:183], v[92:95], v[112:115]
 ds_read_b128 v[20:23], v5 offset:17408
 v_mfma_f32_16x16x32_bf16 v[116:119], a[184:187], v[92:95], v[116:119]
 v_mfma_f32_16x16x32_bf16 v[120:123], a[188:191], v[92:95], v[120:123]
 v_mfma_f32_16x16x32_bf16 v[124:127], v[28:31], v[92:95], v[124:127]
 buffer_load_dwordx4 v[92:95], v1, s[20:23], s47 offen offset:3072 sc1
 s_waitcnt vmcnt(14) lgkmcnt(1)
 v_mfma_f32_16x16x32_bf16 v[96:99], a[192:195], v[32:35], v[96:99]
 s_add_u32 s52, s44, 6
 s_and_b32 s52, s52, 7
 v_mfma_f32_16x16x32_bf16 v[100:103], a[196:199], v[32:35], v[100:103]
 s_lshl_b32 s52, s52, 13
 s_add_u32 s46, s48, s52
 v_mfma_f32_16x16x32_bf16 v[104:107], a[200:203], v[32:35], v[104:107]
 s_add_u32 s47, s46, 4096
 v_mfma_f32_16x16x32_bf16 v[108:111], v[16:19], v[32:35], v[108:111]
 buffer_load_dwordx4 v[32:35], v1, s[20:23], s46 offen offset:0 sc1
 v_mfma_f32_16x16x32_bf16 v[112:115], a[192:195], v[36:39], v[112:115]
 ds_read_b128 v[24:27], v5 offset:18432
 v_mfma_f32_16x16x32_bf16 v[116:119], a[196:199], v[36:39], v[116:119]
 v_mfma_f32_16x16x32_bf16 v[120:123], a[200:203], v[36:39], v[120:123]
 v_mfma_f32_16x16x32_bf16 v[124:127], v[16:19], v[36:39], v[124:127]
 buffer_load_dwordx4 v[36:39], v1, s[20:23], s46 offen offset:1024 sc1
 s_waitcnt vmcnt(14) lgkmcnt(1)
 v_mfma_f32_16x16x32_bf16 v[96:99], a[204:207], v[40:43], v[96:99]
 v_mfma_f32_16x16x32_bf16 v[100:103], a[208:211], v[40:43], v[100:103]
 v_mfma_f32_16x16x32_bf16 v[104:107], a[212:215], v[40:43], v[104:107]
 v_mfma_f32_16x16x32_bf16 v[108:111], v[20:23], v[40:43], v[108:111]
 buffer_load_dwordx4 v[40:43], v1, s[20:23], s46 offen offset:2048 sc1
 v_mfma_f32_16x16x32_bf16 v[112:115], a[204:207], v[44:47], v[112:115]
 ds_read_b128 v[28:31], v5 offset:19456
 v_mfma_f32_16x16x32_bf16 v[116:119], a[208:211], v[44:47], v[116:119]
 v_mfma_f32_16x16x32_bf16 v[120:123], a[212:215], v[44:47], v[120:123]
 v_mfma_f32_16x16x32_bf16 v[124:127], v[20:23], v[44:47], v[124:127]
 buffer_load_dwordx4 v[44:47], v1, s[20:23], s46 offen offset:3072 sc1
 s_waitcnt vmcnt(14) lgkmcnt(1)
 v_mfma_f32_16x16x32_bf16 v[96:99], a[216:219], v[48:51], v[96:99]
 v_mfma_f32_16x16x32_bf16 v[100:103], a[220:223], v[48:51], v[100:103]
 v_mfma_f32_16x16x32_bf16 v[104:107], a[224:227], v[48:51], v[104:107]
 v_mfma_f32_16x16x32_bf16 v[108:111], v[24:27], v[48:51], v[108:111]
 buffer_load_dwordx4 v[48:51], v1, s[20:23], s47 offen offset:0 sc1
 v_mfma_f32_16x16x32_bf16 v[112:115], a[216:219], v[52:55], v[112:115]
 ds_read_b128 v[16:19], v5 offset:20480
 v_mfma_f32_16x16x32_bf16 v[116:119], a[220:223], v[52:55], v[116:119]
 v_mfma_f32_16x16x32_bf16 v[120:123], a[224:227], v[52:55], v[120:123]
 v_mfma_f32_16x16x32_bf16 v[124:127], v[24:27], v[52:55], v[124:127]
 buffer_load_dwordx4 v[52:55], v1, s[20:23], s47 offen offset:1024 sc1
 s_waitcnt vmcnt(14) lgkmcnt(1)
 v_mfma_f32_16x16x32_bf16 v[96:99], a[228:231], v[56:59], v[96:99]
 v_mfma_f32_16x16x32_bf16 v[100:103], a[232:235], v[56:59], v[100:103]
 v_mfma_f32_16x16x32_bf16 v[104:107], a[236:239], v[56:59], v[104:107]
 v_mfma_f32_16x16x32_bf16 v[108:111], v[28:31], v[56:59], v[108:111]
 buffer_load_dwordx4 v[56:59], v1, s[20:23], s47 offen offset:2048 sc1
 v_mfma_f32_16x16x32_bf16 v[112:115], a[228:231], v[60:63], v[112:115]
 ds_read_b128 v[20:23], v5 offset:21504
 v_mfma_f32_16x16x32_bf16 v[116:119], a[232:235], v[60:63], v[116:119]
 v_mfma_f32_16x16x32_bf16 v[120:123], a[236:239], v[60:63], v[120:123]
 v_mfma_f32_16x16x32_bf16 v[124:127], v[28:31], v[60:63], v[124:127]
 buffer_load_dwordx4 v[60:63], v1, s[20:23], s47 offen offset:3072 sc1
 s_waitcnt vmcnt(14) lgkmcnt(1)
 v_mfma_f32_16x16x32_bf16 v[96:99], a[240:243], v[64:67], v[96:99]
 s_add_u32 s52, s44, 7
 s_and_b32 s52, s52, 7
 v_mfma_f32_16x16x32_bf16 v[100:103], a[244:247], v[64:67], v[100:103]
 s_lshl_b32 s52, s52, 13
 s_add_u32 s46, s48, s52
 v_mfma_f32_16x16x32_bf16 v[104:107], a[248:251], v[64:67], v[104:107]
 s_add_u32 s47, s46, 4096
 v_mfma_f32_16x16x32_bf16 v[108:111], v[16:19], v[64:67], v[108:111]
 buffer_load_dwordx4 v[64:67], v1, s[20:23], s46 offen offset:0 sc1
 v_mfma_f32_16x16x32_bf16 v[112:115], a[240:243], v[68:71], v[112:115]
 ds_read_b128 v[24:27], v5 offset:22528
 v_mfma_f32_16x16x32_bf16 v[116:119], a[244:247], v[68:71], v[116:119]
 v_mfma_f32_16x16x32_bf16 v[120:123], a[248:251], v[68:71], v[120:123]
 v_mfma_f32_16x16x32_bf16 v[124:127], v[16:19], v[68:71], v[124:127]
 buffer_load_dwordx4 v[68:71], v1, s[20:23], s46 offen offset:1024 sc1
 s_waitcnt vmcnt(14) lgkmcnt(1)
 v_mfma_f32_16x16x32_bf16 v[96:99], a[252:255], v[72:75], v[96:99]
 v_mfma_f32_16x16x32_bf16 v[100:103], v[128:131], v[72:75], v[100:103]
 v_mfma_f32_16x16x32_bf16 v[104:107], v[132:135], v[72:75], v[104:107]
 v_mfma_f32_16x16x32_bf16 v[108:111], v[20:23], v[72:75], v[108:111]
 buffer_load_dwordx4 v[72:75], v1, s[20:23], s46 offen offset:2048 sc1
 v_mfma_f32_16x16x32_bf16 v[112:115], a[252:255], v[76:79], v[112:115]
 ds_read_b128 v[28:31], v5 offset:23552
 v_mfma_f32_16x16x32_bf16 v[116:119], v[128:131], v[76:79], v[116:119]
 v_mfma_f32_16x16x32_bf16 v[120:123], v[132:135], v[76:79], v[120:123]
 v_mfma_f32_16x16x32_bf16 v[124:127], v[20:23], v[76:79], v[124:127]
 buffer_load_dwordx4 v[76:79], v1, s[20:23], s46 offen offset:3072 sc1
 s_waitcnt vmcnt(14) lgkmcnt(1)
 v_mfma_f32_16x16x32_bf16 v[96:99], v[136:139], v[80:83], v[96:99]
 v_cmp_gt_u32 vcc, s51, v2
 v_mfma_f32_16x16x32_bf16 v[100:103], v[140:143], v[80:83], v[100:103]
 v_mfma_f32_16x16x32_bf16 v[104:107], v[144:147], v[80:83], v[104:107]
 v_mfma_f32_16x16x32_bf16 v[108:111], v[24:27], v[80:83], v[108:111]
 buffer_load_dwordx4 v[80:83], v1, s[20:23], s47 offen offset:0 sc1
 v_mfma_f32_16x16x32_bf16 v[112:115], v[136:139], v[84:87], v[112:115]
 ds_read_b128 v[16:19], v5 offset:24576
 v_mfma_f32_16x16x32_bf16 v[116:119], v[140:143], v[84:87], v[116:119]
 v_mfma_f32_16x16x32_bf16 v[120:123], v[144:147], v[84:87], v[120:123]
 v_mfma_f32_16x16x32_bf16 v[124:127], v[24:27], v[84:87], v[124:127]
 buffer_load_dwordx4 v[84:87], v1, s[20:23], s47 offen offset:1024 sc1
 s_waitcnt vmcnt(14) lgkmcnt(1)
 v_mfma_f32_16x16x32_bf16 v[96:99], v[148:151], v[88:91], v[96:99]
 s_lshl_b32 s48, s42, 18
 s_add_u32 s48, s48, s36
 v_mfma_f32_16x16x32_bf16 v[100:103], v[152:155], v[88:91], v[100:103]
 s_and_b32 s52, vcc_lo, 0xffff
 v_mfma_f32_16x16x32_bf16 v[104:107], v[156:159], v[88:91], v[104:107]
 v_mfma_f32_16x16x32_bf16 v[108:111], v[28:31], v[88:91], v[108:111]
 buffer_load_dwordx4 v[88:91], v1, s[20:23], s47 offen offset:2048 sc1
 v_mfma_f32_16x16x32_bf16 v[112:115], v[148:151], v[92:95], v[112:115]
 ds_read_b128 v[20:23], v5 offset:25600
 v_mfma_f32_16x16x32_bf16 v[116:119], v[152:155], v[92:95], v[116:119]
 v_mfma_f32_16x16x32_bf16 v[120:123], v[156:159], v[92:95], v[120:123]
 v_mfma_f32_16x16x32_bf16 v[124:127], v[28:31], v[92:95], v[124:127]
 buffer_load_dwordx4 v[92:95], v1, s[20:23], s47 offen offset:3072 sc1
 s_cbranch_scc1 Losw_53
 s_waitcnt vmcnt(14) lgkmcnt(1)
 v_mfma_f32_16x16x32_bf16 v[96:99], v[160:163], v[32:35], v[96:99]
 s_add_u32 s52, s44, 0
 s_and_b32 s52, s52, 7
 v_mfma_f32_16x16x32_bf16 v[100:103], v[164:167], v[32:35], v[100:103]
 s_lshl_b32 s52, s52, 13
 s_add_u32 s46, s48, s52
 v_mfma_f32_16x16x32_bf16 v[104:107], v[168:171], v[32:35], v[104:107]
 s_add_u32 s47, s46, 4096
 v_mfma_f32_16x16x32_bf16 v[108:111], v[16:19], v[32:35], v[108:111]
 buffer_load_dwordx4 v[32:35], v1, s[20:23], s46 offen offset:0 sc1
 v_mfma_f32_16x16x32_bf16 v[112:115], v[160:163], v[36:39], v[112:115]
 ds_read_b128 v[24:27], v5 offset:26624
 v_mfma_f32_16x16x32_bf16 v[116:119], v[164:167], v[36:39], v[116:119]
 v_mfma_f32_16x16x32_bf16 v[120:123], v[168:171], v[36:39], v[120:123]
 v_mfma_f32_16x16x32_bf16 v[124:127], v[16:19], v[36:39], v[124:127]
 buffer_load_dwordx4 v[36:39], v1, s[20:23], s46 offen offset:1024 sc1
 s_waitcnt vmcnt(14) lgkmcnt(1)
 v_mfma_f32_16x16x32_bf16 v[96:99], v[172:175], v[40:43], v[96:99]
 v_mfma_f32_16x16x32_bf16 v[100:103], v[176:179], v[40:43], v[100:103]
 v_mfma_f32_16x16x32_bf16 v[104:107], v[180:183], v[40:43], v[104:107]
 v_mfma_f32_16x16x32_bf16 v[108:111], v[20:23], v[40:43], v[108:111]
 buffer_load_dwordx4 v[40:43], v1, s[20:23], s46 offen offset:2048 sc1
 v_mfma_f32_16x16x32_bf16 v[112:115], v[172:175], v[44:47], v[112:115]
 ds_read_b128 v[28:31], v5 offset:27648
 v_mfma_f32_16x16x32_bf16 v[116:119], v[176:179], v[44:47], v[116:119]
 v_mfma_f32_16x16x32_bf16 v[120:123], v[180:183], v[44:47], v[120:123]
 v_mfma_f32_16x16x32_bf16 v[124:127], v[20:23], v[44:47], v[124:127]
 buffer_load_dwordx4 v[44:47], v1, s[20:23], s46 offen offset:3072 sc1
 s_waitcnt vmcnt(14) lgkmcnt(1)
 v_mfma_f32_16x16x32_bf16 v[96:99], v[184:187], v[48:51], v[96:99]
 v_mfma_f32_16x16x32_bf16 v[100:103], v[188:191], v[48:51], v[100:103]
 v_mfma_f32_16x16x32_bf16 v[104:107], v[192:195], v[48:51], v[104:107]
 v_mfma_f32_16x16x32_bf16 v[108:111], v[24:27], v[48:51], v[108:111]
 buffer_load_dwordx4 v[48:51], v1, s[20:23], s47 offen offset:0 sc1
 v_mfma_f32_16x16x32_bf16 v[112:115], v[184:187], v[52:55], v[112:115]
 ds_read_b128 v[16:19], v5 offset:28672
 v_mfma_f32_16x16x32_bf16 v[116:119], v[188:191], v[52:55], v[116:119]
 v_mfma_f32_16x16x32_bf16 v[120:123], v[192:195], v[52:55], v[120:123]
 v_mfma_f32_16x16x32_bf16 v[124:127], v[24:27], v[52:55], v[124:127]
 buffer_load_dwordx4 v[52:55], v1, s[20:23], s47 offen offset:1024 sc1
 s_waitcnt vmcnt(14) lgkmcnt(1)
 v_mfma_f32_16x16x32_bf16 v[96:99], v[196:199], v[56:59], v[96:99]
 v_mfma_f32_16x16x32_bf16 v[100:103], v[200:203], v[56:59], v[100:103]
 v_mfma_f32_16x16x32_bf16 v[104:107], v[204:207], v[56:59], v[104:107]
 v_mfma_f32_16x16x32_bf16 v[108:111], v[28:31], v[56:59], v[108:111]
 buffer_load_dwordx4 v[56:59], v1, s[20:23], s47 offen offset:2048 sc1
 v_mfma_f32_16x16x32_bf16 v[112:115], v[196:199], v[60:63], v[112:115]
 ds_read_b128 v[20:23], v5 offset:29696
 v_mfma_f32_16x16x32_bf16 v[116:119], v[200:203], v[60:63], v[116:119]
 v_mfma_f32_16x16x32_bf16 v[120:123], v[204:207], v[60:63], v[120:123]
 v_mfma_f32_16x16x32_bf16 v[124:127], v[28:31], v[60:63], v[124:127]
 buffer_load_dwordx4 v[60:63], v1, s[20:23], s47 offen offset:3072 sc1
 s_waitcnt vmcnt(14) lgkmcnt(1)
 v_mfma_f32_16x16x32_bf16 v[96:99], v[208:211], v[64:67], v[96:99]
 s_add_u32 s52, s44, 1
 s_and_b32 s52, s52, 7
 v_mfma_f32_16x16x32_bf16 v[100:103], v[212:215], v[64:67], v[100:103]
 s_lshl_b32 s52, s52, 13
 s_add_u32 s46, s48, s52
 v_mfma_f32_16x16x32_bf16 v[104:107], v[216:219], v[64:67], v[104:107]
 s_add_u32 s47, s46, 4096
 v_mfma_f32_16x16x32_bf16 v[108:111], v[16:19], v[64:67], v[108:111]
 buffer_load_dwordx4 v[64:67], v1, s[20:23], s46 offen offset:0 sc1
 v_mfma_f32_16x16x32_bf16 v[112:115], v[208:211], v[68:71], v[112:115]
 ds_read_b128 v[24:27], v5 offset:30720
 v_mfma_f32_16x16x32_bf16 v[116:119], v[212:215], v[68:71], v[116:119]
 v_mfma_f32_16x16x32_bf16 v[120:123], v[216:219], v[68:71], v[120:123]
 v_mfma_f32_16x16x32_bf16 v[124:127], v[16:19], v[68:71], v[124:127]
 buffer_load_dwordx4 v[68:71], v1, s[20:23], s46 offen offset:1024 sc1
 s_waitcnt vmcnt(14) lgkmcnt(1)
 v_mfma_f32_16x16x32_bf16 v[96:99], v[220:223], v[72:75], v[96:99]
 v_mfma_f32_16x16x32_bf16 v[100:103], v[224:227], v[72:75], v[100:103]
 v_mfma_f32_16x16x32_bf16 v[104:107], v[228:231], v[72:75], v[104:107]
 v_mfma_f32_16x16x32_bf16 v[108:111], v[20:23], v[72:75], v[108:111]
 buffer_load_dwordx4 v[72:75], v1, s[20:23], s46 offen offset:2048 sc1
 v_mfma_f32_16x16x32_bf16 v[112:115], v[220:223], v[76:79], v[112:115]
 ds_read_b128 v[28:31], v5 offset:31744
 v_mfma_f32_16x16x32_bf16 v[116:119], v[224:227], v[76:79], v[116:119]
 v_mfma_f32_16x16x32_bf16 v[120:123], v[228:231], v[76:79], v[120:123]
 v_mfma_f32_16x16x32_bf16 v[124:127], v[20:23], v[76:79], v[124:127]
 buffer_load_dwordx4 v[76:79], v1, s[20:23], s46 offen offset:3072 sc1
 s_waitcnt vmcnt(14) lgkmcnt(1)
 v_mfma_f32_16x16x32_bf16 v[96:99], v[232:235], v[80:83], v[96:99]
 v_mfma_f32_16x16x32_bf16 v[100:103], v[236:239], v[80:83], v[100:103]
 v_mfma_f32_16x16x32_bf16 v[104:107], v[240:243], v[80:83], v[104:107]
 v_mfma_f32_16x16x32_bf16 v[108:111], v[24:27], v[80:83], v[108:111]
 buffer_load_dwordx4 v[80:83], v1, s[20:23], s47 offen offset:0 sc1
 v_mfma_f32_16x16x32_bf16 v[112:115], v[232:235], v[84:87], v[112:115]
 ds_read_b128 v[16:19], v5 offset:0
 v_mfma_f32_16x16x32_bf16 v[116:119], v[236:239], v[84:87], v[116:119]
 v_mfma_f32_16x16x32_bf16 v[120:123], v[240:243], v[84:87], v[120:123]
 v_mfma_f32_16x16x32_bf16 v[124:127], v[24:27], v[84:87], v[124:127]
 buffer_load_dwordx4 v[84:87], v1, s[20:23], s47 offen offset:1024 sc1
 s_waitcnt vmcnt(14) lgkmcnt(1)
 v_mfma_f32_16x16x32_bf16 v[96:99], v[244:247], v[88:91], v[96:99]
 v_mfma_f32_16x16x32_bf16 v[100:103], v[248:251], v[88:91], v[100:103]
 v_mfma_f32_16x16x32_bf16 v[104:107], v[252:255], v[88:91], v[104:107]
 v_mfma_f32_16x16x32_bf16 v[108:111], v[28:31], v[88:91], v[108:111]
 buffer_load_dwordx4 v[88:91], v1, s[20:23], s47 offen offset:2048 sc1
 v_mfma_f32_16x16x32_bf16 v[112:115], v[244:247], v[92:95], v[112:115]
 ds_read_b128 v[20:23], v5 offset:1024
 v_mfma_f32_16x16x32_bf16 v[116:119], v[248:251], v[92:95], v[116:119]
 v_mfma_f32_16x16x32_bf16 v[120:123], v[252:255], v[92:95], v[120:123]
 v_mfma_f32_16x16x32_bf16 v[124:127], v[28:31], v[92:95], v[124:127]
 buffer_load_dwordx4 v[92:95], v1, s[20:23], s47 offen offset:3072 sc1
 s_nop 0
 ds_write_b128 v14, v[96:99] offset:32768
 ds_write_b128 v15, v[100:103] offset:33792
 ds_write_b128 v14, v[104:107] offset:34816
 ds_write_b128 v15, v[108:111] offset:35840
 ds_write_b128 v14, v[112:115] offset:36864
 ds_write_b128 v15, v[116:119] offset:37888
 ds_write_b128 v14, v[120:123] offset:38912
 ds_write_b128 v15, v[124:127] offset:39936
 s_waitcnt lgkmcnt(0)
 s_barrier
 ds_read_b128 v[96:99], v4 offset:0
 ds_read_b128 v[100:103], v4 offset:256
 ds_read_b128 v[104:107], v4 offset:40960
 ds_read_b128 v[108:111], v4 offset:41216
 ds_read_b128 v[112:115], v7 offset:0
 ds_read_b128 v[116:119], v7 offset:256
 ds_read_b128 v[120:123], v7 offset:40960
 ds_read_b128 v[124:127], v7 offset:41216
 s_waitcnt lgkmcnt(4)
 v_pk_add_f32 v[96:97], v[96:97], v[104:105]
 v_pk_add_f32 v[98:99], v[98:99], v[106:107]
 v_pk_add_f32 v[100:101], v[100:101], v[108:109]
 v_pk_add_f32 v[102:103], v[102:103], v[110:111]
 s_waitcnt lgkmcnt(2)
 v_pk_add_f32 v[96:97], v[96:97], v[112:113]
 v_pk_add_f32 v[98:99], v[98:99], v[114:115]
 v_pk_add_f32 v[100:101], v[100:101], v[116:117]
 v_pk_add_f32 v[102:103], v[102:103], v[118:119]
 s_waitcnt lgkmcnt(0)
 v_pk_add_f32 v[96:97], v[96:97], v[120:121]
 v_pk_add_f32 v[98:99], v[98:99], v[122:123]
 v_pk_add_f32 v[100:101], v[100:101], v[124:125]
 v_pk_add_f32 v[102:103], v[102:103], v[126:127]
 v_cvt_pk_bf16_f32 v8, v96, v97
 v_cvt_pk_bf16_f32 v9, v98, v99
 v_cvt_pk_bf16_f32 v10, v100, v101
 v_cvt_pk_bf16_f32 v11, v102, v103
 buffer_store_dwordx4 v[8:11], v6, s[24:27], s54 offen
 s_branch Losl_52
Losw_53:
 s_waitcnt vmcnt(14) lgkmcnt(1)
 v_mfma_f32_16x16x32_bf16 v[96:99], v[160:163], v[32:35], v[96:99]
 v_mfma_f32_16x16x32_bf16 v[100:103], v[164:167], v[32:35], v[100:103]
 v_mfma_f32_16x16x32_bf16 v[104:107], v[168:171], v[32:35], v[104:107]
 v_mfma_f32_16x16x32_bf16 v[108:111], v[16:19], v[32:35], v[108:111]
 v_mfma_f32_16x16x32_bf16 v[112:115], v[160:163], v[36:39], v[112:115]
 ds_read_b128 v[24:27], v5 offset:26624
 v_mfma_f32_16x16x32_bf16 v[116:119], v[164:167], v[36:39], v[116:119]
 v_mfma_f32_16x16x32_bf16 v[120:123], v[168:171], v[36:39], v[120:123]
 v_mfma_f32_16x16x32_bf16 v[124:127], v[16:19], v[36:39], v[124:127]
 s_waitcnt vmcnt(12) lgkmcnt(1)
 v_mfma_f32_16x16x32_bf16 v[96:99], v[172:175], v[40:43], v[96:99]
 v_mfma_f32_16x16x32_bf16 v[100:103], v[176:179], v[40:43], v[100:103]
 v_mfma_f32_16x16x32_bf16 v[104:107], v[180:183], v[40:43], v[104:107]
 v_mfma_f32_16x16x32_bf16 v[108:111], v[20:23], v[40:43], v[108:111]
 v_mfma_f32_16x16x32_bf16 v[112:115], v[172:175], v[44:47], v[112:115]
 ds_read_b128 v[28:31], v5 offset:27648
 v_mfma_f32_16x16x32_bf16 v[116:119], v[176:179], v[44:47], v[116:119]
 v_mfma_f32_16x16x32_bf16 v[120:123], v[180:183], v[44:47], v[120:123]
 v_mfma_f32_16x16x32_bf16 v[124:127], v[20:23], v[44:47], v[124:127]
 s_waitcnt vmcnt(10) lgkmcnt(1)
 v_mfma_f32_16x16x32_bf16 v[96:99], v[184:187], v[48:51], v[96:99]
 v_mfma_f32_16x16x32_bf16 v[100:103], v[188:191], v[48:51], v[100:103]
 v_mfma_f32_16x16x32_bf16 v[104:107], v[192:195], v[48:51], v[104:107]
 v_mfma_f32_16x16x32_bf16 v[108:111], v[24:27], v[48:51], v[108:111]
 v_mfma_f32_16x16x32_bf16 v[112:115], v[184:187], v[52:55], v[112:115]
 ds_read_b128 v[16:19], v5 offset:28672
 v_mfma_f32_16x16x32_bf16 v[116:119], v[188:191], v[52:55], v[116:119]
 v_mfma_f32_16x16x32_bf16 v[120:123], v[192:195], v[52:55], v[120:123]
 v_mfma_f32_16x16x32_bf16 v[124:127], v[24:27], v[52:55], v[124:127]
 s_waitcnt vmcnt(8) lgkmcnt(1)
 v_mfma_f32_16x16x32_bf16 v[96:99], v[196:199], v[56:59], v[96:99]
 v_mfma_f32_16x16x32_bf16 v[100:103], v[200:203], v[56:59], v[100:103]
 v_mfma_f32_16x16x32_bf16 v[104:107], v[204:207], v[56:59], v[104:107]
 v_mfma_f32_16x16x32_bf16 v[108:111], v[28:31], v[56:59], v[108:111]
 v_mfma_f32_16x16x32_bf16 v[112:115], v[196:199], v[60:63], v[112:115]
 ds_read_b128 v[20:23], v5 offset:29696
 v_mfma_f32_16x16x32_bf16 v[116:119], v[200:203], v[60:63], v[116:119]
 v_mfma_f32_16x16x32_bf16 v[120:123], v[204:207], v[60:63], v[120:123]
 v_mfma_f32_16x16x32_bf16 v[124:127], v[28:31], v[60:63], v[124:127]
 s_waitcnt vmcnt(6) lgkmcnt(1)
 v_mfma_f32_16x16x32_bf16 v[96:99], v[208:211], v[64:67], v[96:99]
 v_mfma_f32_16x16x32_bf16 v[100:103], v[212:215], v[64:67], v[100:103]
 v_mfma_f32_16x16x32_bf16 v[104:107], v[216:219], v[64:67], v[104:107]
 v_mfma_f32_16x16x32_bf16 v[108:111], v[16:19], v[64:67], v[108:111]
 v_mfma_f32_16x16x32_bf16 v[112:115], v[208:211], v[68:71], v[112:115]
 ds_read_b128 v[24:27], v5 offset:30720
 v_mfma_f32_16x16x32_bf16 v[116:119], v[212:215], v[68:71], v[116:119]
 v_mfma_f32_16x16x32_bf16 v[120:123], v[216:219], v[68:71], v[120:123]
 v_mfma_f32_16x16x32_bf16 v[124:127], v[16:19], v[68:71], v[124:127]
 s_waitcnt vmcnt(4) lgkmcnt(1)
 v_mfma_f32_16x16x32_bf16 v[96:99], v[220:223], v[72:75], v[96:99]
 v_mfma_f32_16x16x32_bf16 v[100:103], v[224:227], v[72:75], v[100:103]
 v_mfma_f32_16x16x32_bf16 v[104:107], v[228:231], v[72:75], v[104:107]
 v_mfma_f32_16x16x32_bf16 v[108:111], v[20:23], v[72:75], v[108:111]
 v_mfma_f32_16x16x32_bf16 v[112:115], v[220:223], v[76:79], v[112:115]
 ds_read_b128 v[28:31], v5 offset:31744
 v_mfma_f32_16x16x32_bf16 v[116:119], v[224:227], v[76:79], v[116:119]
 v_mfma_f32_16x16x32_bf16 v[120:123], v[228:231], v[76:79], v[120:123]
 v_mfma_f32_16x16x32_bf16 v[124:127], v[20:23], v[76:79], v[124:127]
 s_waitcnt vmcnt(2) lgkmcnt(1)
 v_mfma_f32_16x16x32_bf16 v[96:99], v[232:235], v[80:83], v[96:99]
 v_mfma_f32_16x16x32_bf16 v[100:103], v[236:239], v[80:83], v[100:103]
 v_mfma_f32_16x16x32_bf16 v[104:107], v[240:243], v[80:83], v[104:107]
 v_mfma_f32_16x16x32_bf16 v[108:111], v[24:27], v[80:83], v[108:111]
 v_mfma_f32_16x16x32_bf16 v[112:115], v[232:235], v[84:87], v[112:115]
 ds_read_b128 v[16:19], v5 offset:0
 v_mfma_f32_16x16x32_bf16 v[116:119], v[236:239], v[84:87], v[116:119]
 v_mfma_f32_16x16x32_bf16 v[120:123], v[240:243], v[84:87], v[120:123]
 v_mfma_f32_16x16x32_bf16 v[124:127], v[24:27], v[84:87], v[124:127]
 s_waitcnt vmcnt(0) lgkmcnt(1)
 v_mfma_f32_16x16x32_bf16 v[96:99], v[244:247], v[88:91], v[96:99]
 v_mfma_f32_16x16x32_bf16 v[100:103], v[248:251], v[88:91], v[100:103]
 v_mfma_f32_16x16x32_bf16 v[104:107], v[252:255], v[88:91], v[104:107]
 v_mfma_f32_16x16x32_bf16 v[108:111], v[28:31], v[88:91], v[108:111]
 v_mfma_f32_16x16x32_bf16 v[112:115], v[244:247], v[92:95], v[112:115]
 ds_read_b128 v[20:23], v5 offset:1024
 v_mfma_f32_16x16x32_bf16 v[116:119], v[248:251], v[92:95], v[116:119]
 v_mfma_f32_16x16x32_bf16 v[120:123], v[252:255], v[92:95], v[120:123]
 v_mfma_f32_16x16x32_bf16 v[124:127], v[28:31], v[92:95], v[124:127]
 s_cmp_lt_u32 s43, s35
 ds_write_b128 v14, v[96:99] offset:32768
 ds_write_b128 v15, v[100:103] offset:33792
 ds_write_b128 v14, v[104:107] offset:34816
 ds_write_b128 v15, v[108:111] offset:35840
 ds_write_b128 v14, v[112:115] offset:36864
 ds_write_b128 v15, v[116:119] offset:37888
 ds_write_b128 v14, v[120:123] offset:38912
 ds_write_b128 v15, v[124:127] offset:39936
 s_waitcnt lgkmcnt(0)
 s_barrier
 ds_read_b128 v[96:99], v4 offset:0
 ds_read_b128 v[100:103], v4 offset:256
 ds_read_b128 v[104:107], v4 offset:40960
 ds_read_b128 v[108:111], v4 offset:41216
 ds_read_b128 v[112:115], v7 offset:0
 ds_read_b128 v[116:119], v7 offset:256
 ds_read_b128 v[120:123], v7 offset:40960
 ds_read_b128 v[124:127], v7 offset:41216
 s_waitcnt lgkmcnt(4)
 v_pk_add_f32 v[96:97], v[96:97], v[104:105]
 v_pk_add_f32 v[98:99], v[98:99], v[106:107]
 v_pk_add_f32 v[100:101], v[100:101], v[108:109]
 v_pk_add_f32 v[102:103], v[102:103], v[110:111]
 s_waitcnt lgkmcnt(2)
 v_pk_add_f32 v[96:97], v[96:97], v[112:113]
 v_pk_add_f32 v[98:99], v[98:99], v[114:115]
 v_pk_add_f32 v[100:101], v[100:101], v[116:117]
 v_pk_add_f32 v[102:103], v[102:103], v[118:119]
 s_waitcnt lgkmcnt(0)
 v_pk_add_f32 v[96:97], v[96:97], v[120:121]
 v_pk_add_f32 v[98:99], v[98:99], v[122:123]
 v_pk_add_f32 v[100:101], v[100:101], v[124:125]
 v_pk_add_f32 v[102:103], v[102:103], v[126:127]
 v_cvt_pk_bf16_f32 v8, v96, v97
 v_cvt_pk_bf16_f32 v9, v98, v99
 v_cvt_pk_bf16_f32 v10, v100, v101
 v_cvt_pk_bf16_f32 v11, v102, v103
 buffer_store_dwordx4 v[8:11], v6, s[24:27], s54 offen
 s_cbranch_scc1 Los0_50
 s_branch Lfin
Lchain:
 s_load_dwordx2 s[8:9], s[0:1], 64
 s_mov_b32 s10, 0x480000
 s_mov_b32 s11, 0x20000
 s_load_dwordx2 s[12:13], s[0:1], 72
 s_mov_b32 s14, 0x480000
 s_mov_b32 s15, 0x20000
 s_load_dwordx2 s[16:17], s[0:1], 80
 s_mov_b32 s18, 0x480000
 s_mov_b32 s19, 0x20000
 s_load_dwordx2 s[24:25], s[0:1], 88
 s_mov_b32 s26, 0x480000
 s_mov_b32 s27, 0x20000
 s_load_dwordx2 s[28:29], s[0:1], 112
 s_mov_b32 s30, 0x100
 s_mov_b32 s31, 0x20000
 s_load_dwordx2 s[32:33], s[0:1], 56
 s_mov_b32 s34, 0x2400
 s_mov_b32 s35, 0x20000
 v_and_b32 v30, 63, v0
 v_bfe_u32 v31, v30, 1, 2
 v_lshrrev_b32 v32, 5, v30
 v_xor_b32 v31, v31, v32
 v_lshlrev_b32 v31, 5, v31
 v_and_b32 v32, 1, v30
 v_lshl_add_u32 v31, v32, 4, v31
 v_xor_b32 v33, 64, v31
 v_lshrrev_b32 v32, 3, v30
 s_lshl_b32 s47, s4, 4
 v_and_b32 v34, 3, v32
 v_lshrrev_b32 v35, 2, v32
 v_lshl_add_u32 v34, v34, 1, v35
 v_add_u32 v34, s47, v34
 v_lshl_add_u32 v12, v34, 13, v31
 v_add_u32 v34, 8, v34
 v_lshl_add_u32 v13, v34, 13, v33
 v_and_b32 v34, 1, v32
 v_lshlrev_b32 v34, 6, v34
 v_and_b32 v35, 6, v32
 s_lshl_b32 s47, s4, 3
 v_add3_u32 v34, v34, v35, s47
 v_lshl_add_u32 v56, v34, 13, v31
 v_mul_u32_u24 v35, 1152, v34
 v_add_u32 v14, v35, v31
 v_add_u32 v34, 1, v34
 v_lshl_add_u32 v57, v34, 13, v33
 v_mul_u32_u24 v35, 1152, v34
 v_add_u32 v15, v35, v33
 v_bfe_u32 v31, v30, 4, 1
 v_bfe_u32 v32, v30, 3, 1
 v_lshl_add_u32 v33, v32, 1, v31
 v_xor_b32 v33, s4, v33
 v_lshlrev_b32 v33, 5, v33
 v_lshl_add_u32 v33, v31, 9, v33
 v_lshl_add_u32 v33, v32, 10, v33
 v_bfe_u32 v31, v30, 2, 1
 v_lshl_add_u32 v33, v31, 7, v33
 v_lshrrev_b32 v31, 5, v30
 v_lshl_add_u32 v33, v31, 11, v33
 v_and_b32 v31, 3, v30
 v_lshl_add_u32 v16, v31, 3, v33
 v_add_u32 v17, 0x10000, v16
 v_add_u32 v18, 0x20000, v16
 v_lshlrev_b32 v60, 4, v0
 v_add_u32 v61, 0x10000, v60
 v_add_u32 v62, 0x20000, v60
 s_lshl_b32 s70, s6, 8
 s_mul_i32 s71, s6, 147456
 s_lshl_b32 s72, s4, 11
 s_lshl_b32 s47, s4, 4
 v_add_u32 v31, s47, v30
 s_lshr_b32 s47, s4, 1
 s_lshl_b32 s47, s47, 5
 v_add_u32 v32, s47, v31
 v_lshrrev_b32 v33, 4, v30
 v_lshlrev_b32 v33, 28, v33
 v_lshl_or_b32 v58, v31, 13, v33
 v_lshl_or_b32 v19, v32, 13, v33
 v_mul_u32_u24 v32, 1152, v32
 v_or_b32 v59, v32, v33
 s_waitcnt lgkmcnt(0)
 s_add_u32 m0, s72, 24576
 s_add_u32 s47, s70, 0
 buffer_load_dwordx4 v56, s[8:11], s47 offen  lds
 s_add_u32 m0, s72, 25600
 s_nop 0
 buffer_load_dwordx4 v57, s[8:11], s47 offen  lds
 s_add_u32 m0, s72, 32768
 s_add_u32 s47, s70, 128
 buffer_load_dwordx4 v56, s[8:11], s47 offen  lds
 s_add_u32 m0, s72, 33792
 s_nop 0
 buffer_load_dwordx4 v57, s[8:11], s47 offen  lds
 s_add_u32 m0, s72, 40960
 s_add_u32 s47, s70, 0
 buffer_load_dwordx4 v56, s[12:15], s47 offen  lds
 s_add_u32 m0, s72, 41984
 s_nop 0
 buffer_load_dwordx4 v57, s[12:15], s47 offen  lds
 s_add_u32 m0, s72, 49152
 s_add_u32 s47, s70, 0
 buffer_load_dwordx4 v56, s[16:19], s47 offen  lds
 s_add_u32 m0, s72, 50176
 s_nop 0
 buffer_load_dwordx4 v57, s[16:19], s47 offen  lds
 s_add_u32 m0, s72, 57344
 s_add_u32 s47, s70, 128
 buffer_load_dwordx4 v56, s[16:19], s47 offen  lds
 s_add_u32 m0, s72, 58368
 s_nop 0
 buffer_load_dwordx4 v57, s[16:19], s47 offen  lds
 v_and_b32 v20, 63, v0
 v_lshlrev_b32 v3, 4, v20
 v_mov_b32 v7, 0
 s_mov_b32 s48, 0xcccccccc
 s_mov_b32 s49, 0xcccccccc
 v_mov_b32 v21, 0x44444444
 v_mov_b32 v22, 0xeeeeeeee
 v_cndmask_b32 v5, v21, v22, s[48:49]
 s_lshl_b32 s47, s4, 10
 s_add_u32 s47, s47, 19456
 v_and_b32 v21, 48, v20
 v_lshl_add_u32 v21, v21, 3, s47
 v_and_b32 v22, 8, v20
 v_lshl_add_u32 v21, v22, 2, v21
 v_and_b32 v22, 1, v20
 v_lshl_add_u32 v21, v22, 4, v21
 v_and_b32 v22, 6, v20
 v_lshl_add_u32 v8, v22, 1, v21
 v_and_b32 v21, 32, v20
 v_lshlrev_b32 v21, 5, v21
 v_and_b32 v22, 12, v20
 v_lshl_add_u32 v21, v22, 5, v21
 v_and_b32 v22, 1, v20
 v_lshl_add_u32 v21, v22, 6, v21
 v_and_b32 v22, 16, v20
 v_lshl_add_u32 v21, v22, 1, v21
 v_and_b32 v22, 2, v20
 v_lshl_add_u32 v9, v22, 3, v21
 v_lshrrev_b32 v21, 4, v0
 v_lshlrev_b32 v21, 7, v21
 v_and_b32 v22, 15, v20
 v_lshl_add_u32 v21, v22, 2, v21
 v_add_u32 v10, 17408, v21
 v_and_b32 v22, 1, v20
 v_and_b32 v21, 12, v20
 v_lshlrev_b32 v21, 5, v21
 v_lshl_add_u32 v21, v22, 6, v21
 v_and_b32 v22, 48, v20
 v_add_u32 v11, v21, v22
 s_mov_b32 s55, 0x3e0293ee
 s_mov_b32 s54, 0x40000
 s_lshl_b32 s47, s6, 6
 s_add_u32 s60, s47, 0x100000
 s_add_u32 s61, s47, 0x101000
 s_add_u32 s62, s47, 0x102000
 s_lshl_b32 s47, s6, 7
 s_add_u32 s56, s47, 0x0
 s_add_u32 s57, s47, 0x1000
 s_mul_i32 s47, s6, 10496
 s_add_u32 s40, s47, 0x102000
 s_lshl_b32 s58, s4, 11
 s_add_u32 s47, s47, s58
 s_add_u32 s39, s47, 0x100000
 s_lshl_b32 s42, s4, 11
 s_add_u32 s41, s42, 0x1e0000
 s_mov_b32 s43, 0x1e2000
 s_lshr_b32 s69, s4, 1
 s_lshl_b32 s69, s69, 11
 s_and_b32 s47, s4, 1
 s_lshl_b32 s47, s47, 3
 s_add_u32 s69, s69, s47
 s_lshl_b32 s47, s6, 5
 s_add_u32 s65, s47, 0x1e2000
 s_add_u32 s66, s47, 0x162000
 s_lshr_b32 s47, s6, 3
 s_lshl_b32 s47, s47, 9
 s_and_b32 s58, s6, 1
 s_lshl_b32 s58, s58, 8
 s_add_u32 s47, s47, s58
 s_and_b32 s58, s6, 6
 s_lshl_b32 s58, s58, 5
 s_add_u32 s47, s47, s58
 s_lshl_b32 s58, s4, 11
 s_add_u32 s47, s47, s58
 s_add_u32 s44, s47, 0x1e0000
 s_add_u32 s45, s47, 0x160000
 s_lshl_b32 s47, s6, 14
 s_add_u32 s37, s47, 0x3000000
 s_add_u32 s67, s37, s58
 s_add_u32 s59, s67, 8192
 s_lshl_b32 s47, s6, 12
 s_add_u32 s38, s47, 0x3e0000
 s_mov_b32 s36, 0
 s_mov_b32 s46, 0
 s_mov_b32 s50, 0
 s_waitcnt vmcnt(8)
 s_waitcnt lgkmcnt(0)
 s_barrier
 s_add_u32 m0, s72, 65536
 s_add_u32 s47, s70, 262144
 buffer_load_dwordx4 v56, s[8:11], s47 offen  lds
 s_add_u32 m0, s72, 66560
 s_nop 0
 buffer_load_dwordx4 v57, s[8:11], s47 offen  lds
 v_mbcnt_lo_u32_b32 v69, -1, 0
 v_min_u32 v69, 1, v69
 v_lshlrev_b32 v69, 28, v69
 buffer_load_dword v68, v69, s[28:31], 0 offen offset:4 sc1
 ds_read_b64_tr_b16 v[72:73], v16 offset:24576
 ds_read_b64_tr_b16 v[74:75], v16 offset:24832
 ds_read_b64_tr_b16 v[76:77], v16 offset:28672
 ds_read_b64_tr_b16 v[78:79], v16 offset:28928
 s_waitcnt vmcnt(9)
 s_waitcnt lgkmcnt(0)
 s_barrier
 s_add_u32 m0, s72, 73728
 s_add_u32 s47, s70, 262272
 buffer_load_dwordx4 v56, s[8:11], s47 offen  lds
 s_add_u32 m0, s72, 74752
 s_nop 0
 buffer_load_dwordx4 v57, s[8:11], s47 offen  lds
 ds_read_b64_tr_b16 v[80:81], v16 offset:32768
 ds_read_b64_tr_b16 v[82:83], v16 offset:33024
 ds_read_b64_tr_b16 v[84:85], v16 offset:36864
 ds_read_b64_tr_b16 v[86:87], v16 offset:37120
 s_waitcnt vmcnt(9)
 s_waitcnt lgkmcnt(0)
 s_barrier
 s_add_u32 m0, s72, 81920
 s_add_u32 s47, s70, 262144
 buffer_load_dwordx4 v56, s[12:15], s47 offen  lds
 s_add_u32 m0, s72, 82944
 s_nop 0
 buffer_load_dwordx4 v57, s[12:15], s47 offen  lds
 ds_read_b64_tr_b16 v[88:89], v16 offset:40960
 ds_read_b64_tr_b16 v[90:91], v16 offset:41216
 ds_read_b64_tr_b16 v[92:93], v16 offset:45056
 ds_read_b64_tr_b16 v[94:95], v16 offset:45312
 s_waitcnt vmcnt(9)
 s_waitcnt lgkmcnt(0)
 s_barrier
 s_add_u32 m0, s72, 90112
 s_add_u32 s47, s70, 262144
 buffer_load_dwordx4 v56, s[16:19], s47 offen  lds
 s_add_u32 m0, s72, 91136
 s_nop 0
 buffer_load_dwordx4 v57, s[16:19], s47 offen  lds
 ds_read_b64_tr_b16 v[96:97], v16 offset:49152
 ds_read_b64_tr_b16 v[98:99], v16 offset:49408
 ds_read_b64_tr_b16 v[100:101], v16 offset:53248
 ds_read_b64_tr_b16 v[102:103], v16 offset:53504
 s_waitcnt vmcnt(9)
 s_waitcnt lgkmcnt(0)
 s_barrier
 s_add_u32 m0, s72, 98304
 s_add_u32 s47, s70, 262272
 buffer_load_dwordx4 v56, s[16:19], s47 offen  lds
 s_add_u32 m0, s72, 99328
 s_nop 0
 buffer_load_dwordx4 v57, s[16:19], s47 offen  lds
 ds_read_b64_tr_b16 v[104:105], v16 offset:57344
 ds_read_b64_tr_b16 v[106:107], v16 offset:57600
 ds_read_b64_tr_b16 v[108:109], v16 offset:61440
 ds_read_b64_tr_b16 v[110:111], v16 offset:61696
 s_waitcnt vmcnt(9)
 s_waitcnt lgkmcnt(0)
 s_barrier
 s_add_u32 m0, s72, 106496
 s_add_u32 s47, s70, 1048576
 buffer_load_dwordx4 v56, s[8:11], s47 offen  lds
 s_add_u32 m0, s72, 107520
 s_nop 0
 buffer_load_dwordx4 v57, s[8:11], s47 offen  lds
 ds_read_b64_tr_b16 v[112:113], v17 offset:0
 ds_read_b64_tr_b16 v[114:115], v17 offset:256
 ds_read_b64_tr_b16 v[116:117], v17 offset:4096
 ds_read_b64_tr_b16 v[118:119], v17 offset:4352
 s_waitcnt vmcnt(8)
 s_waitcnt lgkmcnt(0)
 s_barrier
 s_add_u32 m0, s72, 114688
 s_add_u32 s47, s70, 1048704
 buffer_load_dwordx4 v56, s[8:11], s47 offen  lds
 s_add_u32 m0, s72, 115712
 s_nop 0
 buffer_load_dwordx4 v57, s[8:11], s47 offen  lds
 ds_read_b64_tr_b16 v[120:121], v17 offset:8192
 ds_read_b64_tr_b16 v[122:123], v17 offset:8448
 ds_read_b64_tr_b16 v[124:125], v17 offset:12288
 ds_read_b64_tr_b16 v[126:127], v17 offset:12544
 s_waitcnt vmcnt(8)
 s_waitcnt lgkmcnt(0)
 s_barrier
 s_add_u32 m0, s72, 122880
 s_add_u32 s47, s70, 1048576
 buffer_load_dwordx4 v56, s[12:15], s47 offen  lds
 s_add_u32 m0, s72, 123904
 s_nop 0
 buffer_load_dwordx4 v57, s[12:15], s47 offen  lds
 ds_read_b64_tr_b16 v[128:129], v17 offset:16384
 ds_read_b64_tr_b16 v[130:131], v17 offset:16640
 ds_read_b64_tr_b16 v[132:133], v17 offset:20480
 ds_read_b64_tr_b16 v[134:135], v17 offset:20736
 s_waitcnt vmcnt(8)
 s_waitcnt lgkmcnt(0)
 s_barrier
 s_add_u32 m0, s72, 131072
 s_add_u32 s47, s70, 1048576
 buffer_load_dwordx4 v56, s[16:19], s47 offen  lds
 s_add_u32 m0, s72, 132096
 s_nop 0
 buffer_load_dwordx4 v57, s[16:19], s47 offen  lds
 ds_read_b64_tr_b16 v[136:137], v17 offset:24576
 ds_read_b64_tr_b16 v[138:139], v17 offset:24832
 ds_read_b64_tr_b16 v[140:141], v17 offset:28672
 ds_read_b64_tr_b16 v[142:143], v17 offset:28928
 s_waitcnt vmcnt(8)
 s_waitcnt lgkmcnt(0)
 s_barrier
 s_add_u32 m0, s72, 139264
 s_add_u32 s47, s70, 1048704
 buffer_load_dwordx4 v56, s[16:19], s47 offen  lds
 s_add_u32 m0, s72, 140288
 s_nop 0
 buffer_load_dwordx4 v57, s[16:19], s47 offen  lds
 s_branch Lrhc_56
Lrh_55:
 v_mbcnt_lo_u32_b32 v69, -1, 0
 v_min_u32 v69, 1, v69
 v_lshlrev_b32 v69, 28, v69
 buffer_load_dword v68, v69, s[28:31], 0 offen offset:4 sc1
 s_waitcnt vmcnt(0)
Lrhc_56:
 v_readfirstlane_b32 s89, v68
 s_cmp_eq_u32 s89, s88
 s_cbranch_scc1 Lrhk_57
 s_cmp_lg_u32 s89, 0
 s_cbranch_scc1 Lredo
 s_sub_u32 s95, s95, 1
 s_cbranch_scc0 Lrh_55
 s_endpgm
Lrhk_57:
 v_mov_b32 v20, 0
 v_mov_b32 v21, 0
 v_mov_b32 v22, 0
 v_mov_b32 v23, 0
 v_mov_b32 v27, -1
 v_bfe_u32 v24, v3, 8, 1
 v_bfe_u32 v25, v3, 9, 1
 v_lshl_or_b32 v24, v24, 1, v25
 v_bfe_u32 v25, v3, 5, 1
 v_lshl_or_b32 v24, v24, 1, v25
 v_and_b32 v25, 0xd0, v3
 v_lshlrev_b32 v25, 24, v25
 v_lshl_or_b32 v24, v24, 2, v25
 v_bfe_u32 v26, v3, 8, 2
 v_bfe_u32 v25, v3, 2, 4
 v_lshl_or_b32 v26, v26, 4, v25
 v_and_b32 v25, 0xc0, v3
 v_lshl_or_b32 v26, v25, 24, v26
 buffer_store_dwordx4 v[20:23], v3, s[20:23], s39 offen offset:0 sc1
 buffer_store_dwordx4 v[20:23], v3, s[20:23], s39 offen offset:1024 sc1
 buffer_store_dwordx4 v[20:23], v3, s[20:23], s40 offen offset:0 sc1
 buffer_store_dwordx4 v[20:23], v3, s[20:23], s40 offen offset:1024 sc1
 buffer_store_dword v27, v26, s[20:23], s44 offen sc1
 buffer_store_dword v27, v26, s[20:23], s45 offen sc1
 buffer_store_dword v27, v24, s[20:23], s65 offen sc1
 buffer_store_dword v27, v24, s[20:23], s66 offen sc1
 ds_read_b64_tr_b16 v[144:145], v17 offset:32768
 ds_read_b64_tr_b16 v[146:147], v17 offset:33024
 ds_read_b64_tr_b16 v[148:149], v17 offset:36864
 ds_read_b64_tr_b16 v[150:151], v17 offset:37120
 s_waitcnt vmcnt(16)
 s_waitcnt lgkmcnt(0)
 s_barrier
 s_add_u32 m0, s72, 147456
 s_add_u32 s47, s70, 1310720
 buffer_load_dwordx4 v56, s[8:11], s47 offen  lds
 s_add_u32 m0, s72, 148480
 s_nop 0
 buffer_load_dwordx4 v57, s[8:11], s47 offen  lds
 ds_read_b64_tr_b16 v[152:153], v17 offset:40960
 ds_read_b64_tr_b16 v[154:155], v17 offset:41216
 ds_read_b64_tr_b16 v[156:157], v17 offset:45056
 ds_read_b64_tr_b16 v[158:159], v17 offset:45312
 s_waitcnt vmcnt(16)
 s_waitcnt lgkmcnt(0)
 s_barrier
 s_add_u32 m0, s72, 155648
 s_add_u32 s47, s70, 1310848
 buffer_load_dwordx4 v56, s[8:11], s47 offen  lds
 s_add_u32 m0, s72, 156672
 s_nop 0
 buffer_load_dwordx4 v57, s[8:11], s47 offen  lds
 v_lshrrev_b32 v68, 4, v3
 v_bfe_u32 v69, v68, 2, 2
 v_and_b32 v70, 1, v68
 v_lshl_add_u32 v69, v69, 1, v70
 v_mul_u32_u24 v69, 1152, v69
 v_and_b32 v70, 48, v68
 v_and_b32 v71, 2, v68
 v_lshl_add_u32 v71, v71, 2, v70
 v_lshl_add_u32 v71, v71, 1, v69
 v_add_u32 v69, v70, v69
 s_lshr_b32 s47, s4, 1
 s_lshl_b32 s47, s47, 8
 s_and_b32 s58, s4, 1
 s_lshl_b32 s58, s58, 6
 s_add_u32 s47, s47, s58
 buffer_load_dwordx4 v[20:23], v69, s[32:35], s47 offen offset:0
 buffer_load_dwordx4 v[24:27], v69, s[32:35], s47 offen offset:128
 buffer_load_dwordx4 v[28:31], v69, s[32:35], s47 offen offset:512
 buffer_load_dwordx4 v[32:35], v69, s[32:35], s47 offen offset:640
 buffer_load_dwordx4 v[36:39], v71, s[32:35], 0 offen offset:1024
 ds_read_b64_tr_b16 v[160:161], v17 offset:49152
 ds_read_b64_tr_b16 v[162:163], v17 offset:49408
 ds_read_b64_tr_b16 v[164:165], v17 offset:53248
 ds_read_b64_tr_b16 v[166:167], v17 offset:53504
 s_waitcnt vmcnt(21)
 s_waitcnt lgkmcnt(0)
 s_barrier
 s_add_u32 m0, s72, 24576
 s_add_u32 s47, s70, 1310720
 buffer_load_dwordx4 v56, s[12:15], s47 offen  lds
 s_add_u32 m0, s72, 25600
 s_nop 0
 buffer_load_dwordx4 v57, s[12:15], s47 offen  lds
 ds_read_b64_tr_b16 v[168:169], v17 offset:57344
 ds_read_b64_tr_b16 v[170:171], v17 offset:57600
 ds_read_b64_tr_b16 v[172:173], v17 offset:61440
 ds_read_b64_tr_b16 v[174:175], v17 offset:61696
 s_waitcnt vmcnt(21)
 s_waitcnt lgkmcnt(0)
 s_barrier
 s_add_u32 m0, s72, 32768
 s_add_u32 s47, s70, 1310720
 buffer_load_dwordx4 v56, s[16:19], s47 offen  lds
 s_add_u32 m0, s72, 33792
 s_nop 0
 buffer_load_dwordx4 v57, s[16:19], s47 offen  lds
 ds_read_b64_tr_b16 v[176:177], v18 offset:0
 ds_read_b64_tr_b16 v[178:179], v18 offset:256
 ds_read_b64_tr_b16 v[180:181], v18 offset:4096
 ds_read_b64_tr_b16 v[182:183], v18 offset:4352
 s_waitcnt vmcnt(21)
 s_waitcnt lgkmcnt(0)
 s_barrier
 s_add_u32 m0, s72, 40960
 s_add_u32 s47, s70, 1310848
 buffer_load_dwordx4 v56, s[16:19], s47 offen  lds
 s_add_u32 m0, s72, 41984
 s_nop 0
 buffer_load_dwordx4 v57, s[16:19], s47 offen  lds
 ds_read_b64_tr_b16 v[184:185], v18 offset:8192
 ds_read_b64_tr_b16 v[186:187], v18 offset:8448
 ds_read_b64_tr_b16 v[188:189], v18 offset:12288
 ds_read_b64_tr_b16 v[190:191], v18 offset:12544
 s_waitcnt vmcnt(13)
 s_waitcnt lgkmcnt(0)
 s_barrier
 s_add_u32 m0, s72, 49152
 s_add_u32 s47, s70, 2097152
 buffer_load_dwordx4 v56, s[8:11], s47 offen  lds
 s_add_u32 m0, s72, 50176
 s_nop 0
 buffer_load_dwordx4 v57, s[8:11], s47 offen  lds
 ds_read_b64_tr_b16 v[192:193], v18 offset:16384
 ds_read_b64_tr_b16 v[194:195], v18 offset:16640
 ds_read_b64_tr_b16 v[196:197], v18 offset:20480
 ds_read_b64_tr_b16 v[198:199], v18 offset:20736
 s_waitcnt vmcnt(13)
 s_waitcnt lgkmcnt(0)
 s_barrier
 s_add_u32 m0, s72, 57344
 s_add_u32 s47, s70, 2097280
 buffer_load_dwordx4 v56, s[8:11], s47 offen  lds
 s_add_u32 m0, s72, 58368
 s_nop 0
 buffer_load_dwordx4 v57, s[8:11], s47 offen  lds
 ds_read_b64_tr_b16 v[200:201], v18 offset:24576
 ds_read_b64_tr_b16 v[202:203], v18 offset:24832
 ds_read_b64_tr_b16 v[204:205], v18 offset:28672
 ds_read_b64_tr_b16 v[206:207], v18 offset:28928
 s_waitcnt vmcnt(8)
 s_waitcnt lgkmcnt(0)
 s_barrier
 s_add_u32 m0, s72, 65536
 s_add_u32 s47, s70, 2097152
 buffer_load_dwordx4 v56, s[12:15], s47 offen  lds
 s_add_u32 m0, s72, 66560
 s_nop 0
 buffer_load_dwordx4 v57, s[12:15], s47 offen  lds
 ds_read_b64_tr_b16 v[208:209], v16 offset:24576
 ds_read_b64_tr_b16 v[210:211], v16 offset:24832
 ds_read_b64_tr_b16 v[212:213], v16 offset:28672
 ds_read_b64_tr_b16 v[214:215], v16 offset:28928
 s_waitcnt vmcnt(8)
 s_waitcnt lgkmcnt(0)
 s_barrier
 s_add_u32 m0, s72, 73728
 s_add_u32 s47, s70, 2097152
 buffer_load_dwordx4 v56, s[16:19], s47 offen  lds
 s_add_u32 m0, s72, 74752
 s_nop 0
 buffer_load_dwordx4 v57, s[16:19], s47 offen  lds
 ds_read_b64_tr_b16 v[216:217], v16 offset:32768
 ds_read_b64_tr_b16 v[218:219], v16 offset:33024
 ds_read_b64_tr_b16 v[220:221], v16 offset:36864
 ds_read_b64_tr_b16 v[222:223], v16 offset:37120
 s_waitcnt vmcnt(8)
 s_waitcnt lgkmcnt(0)
 s_barrier
 s_add_u32 m0, s72, 81920
 s_add_u32 s47, s70, 2097280
 buffer_load_dwordx4 v56, s[16:19], s47 offen  lds
 s_add_u32 m0, s72, 82944
 s_nop 0
 buffer_load_dwordx4 v57, s[16:19], s47 offen  lds
 ds_read_b64_tr_b16 v[224:225], v16 offset:40960
 ds_read_b64_tr_b16 v[226:227], v16 offset:41216
 ds_read_b64_tr_b16 v[228:229], v16 offset:45056
 ds_read_b64_tr_b16 v[230:231], v16 offset:45312
 s_waitcnt vmcnt(8)
 s_waitcnt lgkmcnt(0)
 s_barrier
 s_add_u32 m0, s72, 90112
 s_add_u32 s47, s70, 2359296
 buffer_load_dwordx4 v56, s[8:11], s47 offen  lds
 s_add_u32 m0, s72, 91136
 s_nop 0
 buffer_load_dwordx4 v57, s[8:11], s47 offen  lds
 s_getreg_b32 s73, hwreg(HW_REG_XCC_ID, 0, 3)
 s_lshl_b32 s73, s73, 3
 s_lshl_b64 s[74:75], 1, s73
 v_mov_b32 v64, s74
 v_mov_b32 v65, s75
 v_mov_b32 v66, 0x7ff00000
 v_cmp_eq_u32 vcc, 0, v0
 s_nop 1
 v_cndmask_b32 v66, v66, v7, vcc
 buffer_atomic_add_x2 v[64:65], v66, s[28:31], 0 offen offset:8
 ds_read_b64_tr_b16 v[232:233], v16 offset:49152
 ds_read_b64_tr_b16 v[234:235], v16 offset:49408
 ds_read_b64_tr_b16 v[236:237], v16 offset:53248
 ds_read_b64_tr_b16 v[238:239], v16 offset:53504
 s_waitcnt vmcnt(9)
 s_waitcnt lgkmcnt(0)
 s_barrier
 s_add_u32 m0, s72, 98304
 s_add_u32 s47, s70, 2359424
 buffer_load_dwordx4 v56, s[8:11], s47 offen  lds
 s_add_u32 m0, s72, 99328
 s_nop 0
 buffer_load_dwordx4 v57, s[8:11], s47 offen  lds
 v_mov_b32 v68, 0x05040100
 v_mov_b32 v69, 0x07060302
 v_cndmask_b32 v70, v68, v69, s[48:49]
 v_perm_b32 v20, v24, v20, v70
 v_perm_b32 v21, v25, v21, v70
 v_perm_b32 v22, v26, v22, v70
 v_perm_b32 v23, v27, v23, v70
 v_perm_b32 v28, v32, v28, v70
 v_perm_b32 v29, v33, v29, v70
 v_perm_b32 v30, v34, v30, v70
 v_perm_b32 v31, v35, v31, v70
 v_perm_b32 v24, v37, v36, v68
 v_perm_b32 v25, v39, v38, v68
 v_perm_b32 v26, v37, v36, v69
 v_perm_b32 v27, v39, v38, v69
 v_min_u32 v20, -2, v20
 v_min_u32 v21, -2, v21
 v_min_u32 v22, -2, v22
 v_min_u32 v23, -2, v23
 v_min_u32 v24, -2, v24
 v_min_u32 v25, -2, v25
 v_min_u32 v26, -2, v26
 v_min_u32 v27, -2, v27
 v_min_u32 v28, -2, v28
 v_min_u32 v29, -2, v29
 v_min_u32 v30, -2, v30
 v_min_u32 v31, -2, v31
 ds_write_b128 v60, v[20:23]
 ds_write_b128 v60, v[28:31] offset:4096
 ds_write_b128 v3, v[24:27] offset:8192
 ds_read_b64_tr_b16 v[240:241], v16 offset:57344
 ds_read_b64_tr_b16 v[242:243], v16 offset:57600
 ds_read_b64_tr_b16 v[244:245], v16 offset:61440
 ds_read_b64_tr_b16 v[246:247], v16 offset:61696
 s_waitcnt vmcnt(9)
 s_waitcnt lgkmcnt(0)
 s_barrier
 s_add_u32 m0, s72, 106496
 s_add_u32 s47, s70, 2359296
 buffer_load_dwordx4 v56, s[12:15], s47 offen  lds
 s_add_u32 m0, s72, 107520
 s_nop 0
 buffer_load_dwordx4 v57, s[12:15], s47 offen  lds
 ds_read_b64_tr_b16 v[248:249], v17 offset:0
 ds_read_b64_tr_b16 v[250:251], v17 offset:256
 ds_read_b64_tr_b16 v[252:253], v17 offset:4096
 ds_read_b64_tr_b16 v[254:255], v17 offset:4352
 s_waitcnt vmcnt(9)
 s_waitcnt lgkmcnt(0)
 s_barrier
 s_add_u32 m0, s72, 114688
 s_add_u32 s47, s70, 2359296
 buffer_load_dwordx4 v56, s[16:19], s47 offen  lds
 s_add_u32 m0, s72, 115712
 s_nop 0
 buffer_load_dwordx4 v57, s[16:19], s47 offen  lds
 ds_read_b64_tr_b16 a[0:1], v17 offset:8192
 ds_read_b64_tr_b16 a[2:3], v17 offset:8448
 ds_read_b64_tr_b16 a[4:5], v17 offset:12288
 ds_read_b64_tr_b16 a[6:7], v17 offset:12544
 s_waitcnt vmcnt(9)
 s_waitcnt lgkmcnt(0)
 s_barrier
 s_add_u32 m0, s72, 122880
 s_add_u32 s47, s70, 2359424
 buffer_load_dwordx4 v56, s[16:19], s47 offen  lds
 s_add_u32 m0, s72, 123904
 s_nop 0
 buffer_load_dwordx4 v57, s[16:19], s47 offen  lds
 ds_read_b64_tr_b16 a[8:9], v17 offset:16384
 ds_read_b64_tr_b16 a[10:11], v17 offset:16640
 ds_read_b64_tr_b16 a[12:13], v17 offset:20480
 ds_read_b64_tr_b16 a[14:15], v17 offset:20736
 s_waitcnt vmcnt(9)
 s_waitcnt lgkmcnt(0)
 s_barrier
 s_add_u32 m0, s72, 131072
 s_add_u32 s47, s70, 3145728
 buffer_load_dwordx4 v56, s[8:11], s47 offen  lds
 s_add_u32 m0, s72, 132096
 s_nop 0
 buffer_load_dwordx4 v57, s[8:11], s47 offen  lds
 ds_read_b64_tr_b16 a[16:17], v17 offset:24576
 ds_read_b64_tr_b16 a[18:19], v17 offset:24832
 ds_read_b64_tr_b16 a[20:21], v17 offset:28672
 ds_read_b64_tr_b16 a[22:23], v17 offset:28928
 s_waitcnt vmcnt(8)
 s_waitcnt lgkmcnt(0)
 s_barrier
 s_add_u32 m0, s72, 139264
 s_add_u32 s47, s70, 3145856
 buffer_load_dwordx4 v56, s[8:11], s47 offen  lds
 s_add_u32 m0, s72, 140288
 s_nop 0
 buffer_load_dwordx4 v57, s[8:11], s47 offen  lds
 ds_read_b64_tr_b16 a[24:25], v17 offset:32768
 ds_read_b64_tr_b16 a[26:27], v17 offset:33024
 ds_read_b64_tr_b16 a[28:29], v17 offset:36864
 ds_read_b64_tr_b16 a[30:31], v17 offset:37120
 s_waitcnt vmcnt(8)
 s_waitcnt lgkmcnt(0)
 s_barrier
 s_add_u32 m0, s72, 147456
 s_add_u32 s47, s70, 3145728
 buffer_load_dwordx4 v56, s[12:15], s47 offen  lds
 s_add_u32 m0, s72, 148480
 s_nop 0
 buffer_load_dwordx4 v57, s[12:15], s47 offen  lds
 ds_read_b64_tr_b16 a[32:33], v17 offset:40960
 ds_read_b64_tr_b16 a[34:35], v17 offset:41216
 ds_read_b64_tr_b16 a[36:37], v17 offset:45056
 ds_read_b64_tr_b16 a[38:39], v17 offset:45312
 s_waitcnt vmcnt(8)
 s_waitcnt lgkmcnt(0)
 s_barrier
 s_add_u32 m0, s72, 155648
 s_add_u32 s47, s70, 3145728
 buffer_load_dwordx4 v56, s[16:19], s47 offen  lds
 s_add_u32 m0, s72, 156672
 s_nop 0
 buffer_load_dwordx4 v57, s[16:19], s47 offen  lds
 ds_read_b64_tr_b16 a[40:41], v17 offset:49152
 ds_read_b64_tr_b16 a[42:43], v17 offset:49408
 ds_read_b64_tr_b16 a[44:45], v17 offset:53248
 ds_read_b64_tr_b16 a[46:47], v17 offset:53504
 s_waitcnt vmcnt(8)
 s_waitcnt lgkmcnt(0)
 s_barrier
 s_add_u32 m0, s72, 24576
 s_add_u32 s47, s70, 3145856
 buffer_load_dwordx4 v56, s[16:19], s47 offen  lds
 s_add_u32 m0, s72, 25600
 s_nop 0
 buffer_load_dwordx4 v57, s[16:19], s47 offen  lds
 ds_read_b64_tr_b16 a[48:49], v17 offset:57344
 ds_read_b64_tr_b16 a[50:51], v17 offset:57600
 ds_read_b64_tr_b16 a[52:53], v17 offset:61440
 ds_read_b64_tr_b16 a[54:55], v17 offset:61696
 s_waitcnt vmcnt(8)
 s_waitcnt lgkmcnt(0)
 s_barrier
 s_add_u32 m0, s72, 32768
 s_add_u32 s47, s70, 3407872
 buffer_load_dwordx4 v56, s[8:11], s47 offen  lds
 s_add_u32 m0, s72, 33792
 s_nop 0
 buffer_load_dwordx4 v57, s[8:11], s47 offen  lds
 ds_read_b64_tr_b16 a[56:57], v18 offset:0
 ds_read_b64_tr_b16 a[58:59], v18 offset:256
 ds_read_b64_tr_b16 a[60:61], v18 offset:4096
 ds_read_b64_tr_b16 a[62:63], v18 offset:4352
 s_waitcnt vmcnt(8)
 s_waitcnt lgkmcnt(0)
 s_barrier
 s_add_u32 m0, s72, 40960
 s_add_u32 s47, s70, 3408000
 buffer_load_dwordx4 v56, s[8:11], s47 offen  lds
 s_add_u32 m0, s72, 41984
 s_nop 0
 buffer_load_dwordx4 v57, s[8:11], s47 offen  lds
 ds_read_b64_tr_b16 a[64:65], v18 offset:8192
 ds_read_b64_tr_b16 a[66:67], v18 offset:8448
 ds_read_b64_tr_b16 a[68:69], v18 offset:12288
 ds_read_b64_tr_b16 a[70:71], v18 offset:12544
 s_waitcnt vmcnt(8)
 s_waitcnt lgkmcnt(0)
 s_barrier
 s_add_u32 m0, s72, 49152
 s_add_u32 s47, s70, 3407872
 buffer_load_dwordx4 v56, s[12:15], s47 offen  lds
 s_add_u32 m0, s72, 50176
 s_nop 0
 buffer_load_dwordx4 v57, s[12:15], s47 offen  lds
 ds_read_b64_tr_b16 a[72:73], v18 offset:16384
 ds_read_b64_tr_b16 a[74:75], v18 offset:16640
 ds_read_b64_tr_b16 a[76:77], v18 offset:20480
 ds_read_b64_tr_b16 a[78:79], v18 offset:20736
 s_waitcnt vmcnt(8)
 s_waitcnt lgkmcnt(0)
 s_barrier
 s_add_u32 m0, s72, 57344
 s_add_u32 s47, s70, 3407872
 buffer_load_dwordx4 v56, s[16:19], s47 offen  lds
 s_add_u32 m0, s72, 58368
 s_nop 0
 buffer_load_dwordx4 v57, s[16:19], s47 offen  lds
 ds_read_b64_tr_b16 a[80:81], v18 offset:24576
 ds_read_b64_tr_b16 a[82:83], v18 offset:24832
 ds_read_b64_tr_b16 a[84:85], v18 offset:28672
 ds_read_b64_tr_b16 a[86:87], v18 offset:28928
 s_waitcnt vmcnt(8)
 s_waitcnt lgkmcnt(0)
 s_barrier
 s_add_u32 m0, s72, 65536
 s_add_u32 s47, s70, 3408000
 buffer_load_dwordx4 v56, s[16:19], s47 offen  lds
 s_add_u32 m0, s72, 66560
 s_nop 0
 buffer_load_dwordx4 v57, s[16:19], s47 offen  lds
 v_min_u32 v65, 16, v3
 v_lshlrev_b32 v65, 24, v65
 buffer_load_dwordx4 v[68:71], v65, s[28:31], 0 offen sc1
 ds_read_b64_tr_b16 a[88:89], v16 offset:24576
 ds_read_b64_tr_b16 a[90:91], v16 offset:24832
 ds_read_b64_tr_b16 a[92:93], v16 offset:28672
 ds_read_b64_tr_b16 a[94:95], v16 offset:28928
 s_waitcnt vmcnt(9)
 s_waitcnt lgkmcnt(0)
 s_barrier
 s_add_u32 m0, s72, 73728
 s_add_u32 s47, s70, 4194304
 buffer_load_dwordx4 v12, s[8:11], s47 offen  lds
 s_add_u32 m0, s72, 74752
 s_nop 0
 buffer_load_dwordx4 v13, s[8:11], s47 offen  lds
 ds_read_b64_tr_b16 a[96:97], v16 offset:32768
 ds_read_b64_tr_b16 a[98:99], v16 offset:33024
 ds_read_b64_tr_b16 a[100:101], v16 offset:36864
 ds_read_b64_tr_b16 a[102:103], v16 offset:37120
 s_waitcnt vmcnt(9)
 s_waitcnt lgkmcnt(0)
 s_barrier
 s_add_u32 m0, s72, 81920
 s_add_u32 s47, s70, 4194432
 buffer_load_dwordx4 v12, s[8:11], s47 offen  lds
 s_add_u32 m0, s72, 82944
 s_nop 0
 buffer_load_dwordx4 v13, s[8:11], s47 offen  lds
 ds_read_b64_tr_b16 a[104:105], v16 offset:40960
 ds_read_b64_tr_b16 a[106:107], v16 offset:41216
 ds_read_b64_tr_b16 a[108:109], v16 offset:45056
 ds_read_b64_tr_b16 a[110:111], v16 offset:45312
 s_waitcnt vmcnt(9)
 s_waitcnt lgkmcnt(0)
 s_barrier
 s_add_u32 m0, s72, 90112
 s_add_u32 s47, s70, 4194304
 buffer_load_dwordx4 v12, s[12:15], s47 offen  lds
 s_add_u32 m0, s72, 91136
 s_nop 0
 buffer_load_dwordx4 v13, s[12:15], s47 offen  lds
 ds_read_b64_tr_b16 a[112:113], v16 offset:49152
 ds_read_b64_tr_b16 a[114:115], v16 offset:49408
 ds_read_b64_tr_b16 a[116:117], v16 offset:53248
 ds_read_b64_tr_b16 a[118:119], v16 offset:53504
 s_waitcnt vmcnt(9)
 s_waitcnt lgkmcnt(0)
 s_barrier
 s_add_u32 m0, s72, 98304
 s_add_u32 s47, s70, 4194304
 buffer_load_dwordx4 v12, s[16:19], s47 offen  lds
 s_add_u32 m0, s72, 99328
 s_nop 0
 buffer_load_dwordx4 v13, s[16:19], s47 offen  lds
 ds_read_b64_tr_b16 a[120:121], v16 offset:57344
 ds_read_b64_tr_b16 a[122:123], v16 offset:57600
 ds_read_b64_tr_b16 a[124:125], v16 offset:61440
 ds_read_b64_tr_b16 a[126:127], v16 offset:61696
 s_waitcnt vmcnt(9)
 s_waitcnt lgkmcnt(0)
 s_barrier
 s_add_u32 m0, s72, 106496
 s_add_u32 s47, s70, 4194432
 buffer_load_dwordx4 v12, s[16:19], s47 offen  lds
 s_add_u32 m0, s72, 107520
 s_nop 0
 buffer_load_dwordx4 v13, s[16:19], s47 offen  lds
 ds_read_b64_tr_b16 a[128:129], v17 offset:0
 ds_read_b64_tr_b16 a[130:131], v17 offset:256
 ds_read_b64_tr_b16 a[132:133], v17 offset:4096
 ds_read_b64_tr_b16 a[134:135], v17 offset:4352
 s_waitcnt vmcnt(8)
 s_waitcnt lgkmcnt(0)
 s_barrier
 s_add_u32 m0, s72, 114688
 s_add_u32 s47, s71, 0
 buffer_load_dwordx4 v14, s[24:27], s47 offen  lds
 s_add_u32 m0, s72, 115712
 s_nop 0
 buffer_load_dwordx4 v15, s[24:27], s47 offen  lds
 ds_read_b64_tr_b16 a[136:137], v17 offset:8192
 ds_read_b64_tr_b16 a[138:139], v17 offset:8448
 ds_read_b64_tr_b16 a[140:141], v17 offset:12288
 ds_read_b64_tr_b16 a[142:143], v17 offset:12544
 s_waitcnt vmcnt(8)
 s_waitcnt lgkmcnt(0)
 s_barrier
 s_add_u32 m0, s72, 122880
 s_add_u32 s47, s71, 128
 buffer_load_dwordx4 v14, s[24:27], s47 offen  lds
 s_add_u32 m0, s72, 123904
 s_nop 0
 buffer_load_dwordx4 v15, s[24:27], s47 offen  lds
 ds_read_b64_tr_b16 a[144:145], v17 offset:16384
 ds_read_b64_tr_b16 a[146:147], v17 offset:16640
 ds_read_b64_tr_b16 a[148:149], v17 offset:20480
 ds_read_b64_tr_b16 a[150:151], v17 offset:20736
 s_waitcnt vmcnt(8)
 s_waitcnt lgkmcnt(0)
 s_barrier
 s_add_u32 m0, s72, 131072
 s_add_u32 s47, s71, 256
 buffer_load_dwordx4 v14, s[24:27], s47 offen  lds
 s_add_u32 m0, s72, 132096
 s_nop 0
 buffer_load_dwordx4 v15, s[24:27], s47 offen  lds
 ds_read_b64_tr_b16 a[152:153], v17 offset:24576
 ds_read_b64_tr_b16 a[154:155], v17 offset:24832
 ds_read_b64_tr_b16 a[156:157], v17 offset:28672
 ds_read_b64_tr_b16 a[158:159], v17 offset:28928
 s_waitcnt vmcnt(8)
 s_waitcnt lgkmcnt(0)
 s_barrier
 s_add_u32 m0, s72, 139264
 s_add_u32 s47, s71, 384
 buffer_load_dwordx4 v14, s[24:27], s47 offen  lds
 s_add_u32 m0, s72, 140288
 s_nop 0
 buffer_load_dwordx4 v15, s[24:27], s47 offen  lds
 ds_read_b64_tr_b16 a[160:161], v17 offset:32768
 ds_read_b64_tr_b16 a[162:163], v17 offset:33024
 ds_read_b64_tr_b16 a[164:165], v17 offset:36864
 ds_read_b64_tr_b16 a[166:167], v17 offset:37120
 s_waitcnt vmcnt(8)
 s_waitcnt lgkmcnt(0)
 s_barrier
 s_add_u32 m0, s72, 147456
 s_add_u32 s47, s71, 512
 buffer_load_dwordx4 v14, s[24:27], s47 offen  lds
 s_add_u32 m0, s72, 148480
 s_nop 0
 buffer_load_dwordx4 v15, s[24:27], s47 offen  lds
 s_branch Lhsc_60
Lhs_59:
 buffer_load_dwordx4 v[68:71], v65, s[28:31], 0 offen sc1
 s_waitcnt vmcnt(0)
Lhsc_60:
 v_sad_u8 v69, v70, 0, 0
 v_sad_u8 v69, v71, 0, v69
 v_lshrrev_b32 v69, 5, v69
 v_min_u32 v68, v68, v69
 v_cmp_ne_u32 vcc, 0, v68
 s_cbranch_vccnz Lhsok_61
 s_sub_u32 s54, s54, 1
 s_cbranch_scc0 Lhs_59
 s_endpgm
Lhsok_61:
 v_readfirstlane_b32 s74, v70
 v_readfirstlane_b32 s75, v71
 buffer_load_dwordx4 v[20:23], v3, s[20:23], s39 offen offset:0 sc1
 buffer_load_dwordx4 v[20:23], v3, s[20:23], s39 offen offset:1024 sc1
 buffer_load_dwordx4 v[20:23], v3, s[20:23], s40 offen offset:0 sc1
 buffer_load_dwordx4 v[20:23], v3, s[20:23], s40 offen offset:1024 sc1
 v_min_u32 v67, 3, v0
 v_add_u32 v68, 1, v67
 v_and_b32 v68, 4, v68
 v_lshlrev_b32 v68, 26, v68
 v_lshl_or_b32 v68, v67, 7, v68
 s_mul_i32 s47, s6, 384
 s_add_u32 s47, s47, 0x160000
 buffer_load_dword v20, v68, s[20:23], s47 offen sc1
 s_mul_i32 s47, s6, 384
 s_add_u32 s47, s47, 0x1e0000
 buffer_load_dword v20, v68, s[20:23], s47 offen sc1
 v_lshlrev_b32 v67, 6, v0
 ds_read_b64_tr_b16 a[168:169], v17 offset:40960
 ds_read_b64_tr_b16 a[170:171], v17 offset:41216
 ds_read_b64_tr_b16 a[172:173], v17 offset:45056
 ds_read_b64_tr_b16 a[174:175], v17 offset:45312
 s_waitcnt vmcnt(14)
 s_waitcnt lgkmcnt(0)
 s_barrier
 s_add_u32 m0, s72, 155648
 s_add_u32 s47, s71, 640
 buffer_load_dwordx4 v14, s[24:27], s47 offen  lds
 s_add_u32 m0, s72, 156672
 s_nop 0
 buffer_load_dwordx4 v15, s[24:27], s47 offen  lds
 ds_read_b64_tr_b16 a[176:177], v17 offset:49152
 ds_read_b64_tr_b16 a[178:179], v17 offset:49408
 ds_read_b64_tr_b16 a[180:181], v17 offset:53248
 ds_read_b64_tr_b16 a[182:183], v17 offset:53504
 s_waitcnt vmcnt(14)
 s_waitcnt lgkmcnt(0)
 s_barrier
 s_add_u32 m0, s72, 24576
 s_add_u32 s47, s71, 768
 buffer_load_dwordx4 v14, s[24:27], s47 offen  lds
 s_add_u32 m0, s72, 25600
 s_nop 0
 buffer_load_dwordx4 v15, s[24:27], s47 offen  lds
 ds_read_b64_tr_b16 a[184:185], v17 offset:57344
 ds_read_b64_tr_b16 a[186:187], v17 offset:57600
 ds_read_b64_tr_b16 a[188:189], v17 offset:61440
 ds_read_b64_tr_b16 a[190:191], v17 offset:61696
 s_waitcnt vmcnt(14)
 s_waitcnt lgkmcnt(0)
 s_barrier
 s_add_u32 m0, s72, 32768
 s_add_u32 s47, s71, 896
 buffer_load_dwordx4 v14, s[24:27], s47 offen  lds
 s_add_u32 m0, s72, 33792
 s_nop 0
 buffer_load_dwordx4 v15, s[24:27], s47 offen  lds
 ds_read_b64_tr_b16 a[192:193], v18 offset:0
 ds_read_b64_tr_b16 a[194:195], v18 offset:256
 ds_read_b64_tr_b16 a[196:197], v18 offset:4096
 ds_read_b64_tr_b16 a[198:199], v18 offset:4352
 s_waitcnt vmcnt(14)
 s_waitcnt lgkmcnt(0)
 s_barrier
 s_add_u32 m0, s72, 40960
 s_add_u32 s47, s71, 37760
 buffer_load_dwordx4 v14, s[24:27], s47 offen  lds
 s_add_u32 m0, s72, 41984
 s_nop 0
 buffer_load_dwordx4 v15, s[24:27], s47 offen  lds
 ds_read_b64_tr_b16 a[200:201], v18 offset:8192
 ds_read_b64_tr_b16 a[202:203], v18 offset:8448
 ds_read_b64_tr_b16 a[204:205], v18 offset:12288
 ds_read_b64_tr_b16 a[206:207], v18 offset:12544
 s_waitcnt vmcnt(14)
 s_waitcnt lgkmcnt(0)
 s_barrier
 s_add_u32 m0, s72, 49152
 s_add_u32 s47, s71, 1024
 buffer_load_dwordx4 v14, s[24:27], s47 offen  lds
 s_add_u32 m0, s72, 50176
 s_nop 0
 buffer_load_dwordx4 v15, s[24:27], s47 offen  lds
 ds_read_b64_tr_b16 a[208:209], v18 offset:16384
 ds_read_b64_tr_b16 a[210:211], v18 offset:16640
 ds_read_b64_tr_b16 a[212:213], v18 offset:20480
 ds_read_b64_tr_b16 a[214:215], v18 offset:20736
 s_waitcnt vmcnt(8)
 s_waitcnt lgkmcnt(0)
 s_barrier
 s_add_u32 m0, s72, 57344
 s_add_u32 s47, s70, 1310848
 buffer_load_dwordx4 v56, s[12:15], s47 offen  lds
 s_add_u32 m0, s72, 58368
 s_nop 0
 buffer_load_dwordx4 v57, s[12:15], s47 offen  lds
 s_lshl_b32 s47, s6, 2
 s_add_u32 s47, s47, 0x4400
 v_mov_b32 v64, 1
 buffer_store_dword v64, v66, s[20:23], s47 offen
 ds_read_b64_tr_b16 a[216:217], v18 offset:24576
 ds_read_b64_tr_b16 a[218:219], v18 offset:24832
 ds_read_b64_tr_b16 a[220:221], v18 offset:28672
 ds_read_b64_tr_b16 a[222:223], v18 offset:28928
 s_waitcnt vmcnt(9)
 s_waitcnt lgkmcnt(0)
 s_barrier
 s_add_u32 m0, s72, 65536
 s_add_u32 s47, s70, 2097280
 buffer_load_dwordx4 v56, s[12:15], s47 offen  lds
 s_add_u32 m0, s72, 66560
 s_nop 0
 buffer_load_dwordx4 v57, s[12:15], s47 offen  lds
 ds_read_b64_tr_b16 a[224:225], v16 offset:24576
 ds_read_b64_tr_b16 a[226:227], v16 offset:24832
 ds_read_b64_tr_b16 a[228:229], v16 offset:28672
 ds_read_b64_tr_b16 a[230:231], v16 offset:28928
 s_waitcnt vmcnt(9)
 s_waitcnt lgkmcnt(0)
 s_barrier
 s_add_u32 m0, s72, 73728
 s_add_u32 s47, s70, 2359424
 buffer_load_dwordx4 v56, s[12:15], s47 offen  lds
 s_add_u32 m0, s72, 74752
 s_nop 0
 buffer_load_dwordx4 v57, s[12:15], s47 offen  lds
 s_and_b32 s47, s6, 29
 s_cbranch_scc1 Lgt_62
 buffer_store_dword v64, v66, s[28:31], 0 offen offset:128 sc1
Lgt_62:
 ds_read_b64_tr_b16 a[232:233], v16 offset:32768
 ds_read_b64_tr_b16 a[234:235], v16 offset:33024
 ds_read_b64_tr_b16 a[236:237], v16 offset:36864
 ds_read_b64_tr_b16 a[238:239], v16 offset:37120
 s_waitcnt vmcnt(9)
 s_waitcnt lgkmcnt(0)
 s_barrier
 s_add_u32 m0, s72, 81920
 s_add_u32 s47, s70, 3145856
 buffer_load_dwordx4 v56, s[12:15], s47 offen  lds
 s_add_u32 m0, s72, 82944
 s_nop 0
 buffer_load_dwordx4 v57, s[12:15], s47 offen  lds
 ds_read_b64_tr_b16 a[240:241], v16 offset:40960
 ds_read_b64_tr_b16 a[242:243], v16 offset:41216
 ds_read_b64_tr_b16 a[244:245], v16 offset:45056
 ds_read_b64_tr_b16 a[246:247], v16 offset:45312
 s_waitcnt vmcnt(9)
 s_waitcnt lgkmcnt(0)
 s_barrier
 s_add_u32 m0, s72, 90112
 s_add_u32 s47, s70, 3408000
 buffer_load_dwordx4 v56, s[12:15], s47 offen  lds
 s_add_u32 m0, s72, 91136
 s_nop 0
 buffer_load_dwordx4 v57, s[12:15], s47 offen  lds
 ds_read_b64_tr_b16 a[248:249], v16 offset:49152
 ds_read_b64_tr_b16 a[250:251], v16 offset:49408
 ds_read_b64_tr_b16 a[252:253], v16 offset:53248
 ds_read_b64_tr_b16 a[254:255], v16 offset:53504
 s_waitcnt vmcnt(9)
 s_waitcnt lgkmcnt(0)
 s_barrier
 s_add_u32 m0, s72, 98304
 s_add_u32 s47, s71, 37888
 buffer_load_dwordx4 v14, s[24:27], s47 offen  lds
 s_add_u32 m0, s72, 99328
 s_nop 0
 buffer_load_dwordx4 v15, s[24:27], s47 offen  lds
 ds_read_b64_tr_b16 v[48:49], v16 offset:57344
 ds_read_b64_tr_b16 v[50:51], v16 offset:57600
 ds_read_b64_tr_b16 v[52:53], v16 offset:61440
 ds_read_b64_tr_b16 v[54:55], v16 offset:61696
 s_waitcnt vmcnt(8)
 s_waitcnt lgkmcnt(0)
 s_barrier
 s_add_u32 m0, s72, 106496
 s_add_u32 s47, s71, 36864
 buffer_load_dwordx4 v14, s[24:27], s47 offen  lds
 s_add_u32 m0, s72, 107520
 s_nop 0
 buffer_load_dwordx4 v15, s[24:27], s47 offen  lds
 v_lshrrev_b32 v68, 2, v3
 s_mov_b32 s47, 0x4400
 buffer_load_dword v68, v68, s[20:23], s47 offen sc1
 ds_write_b128 v60, v[48:51] offset:57344
 ds_write_b128 v60, v[52:55] offset:61440
 ds_read_b64_tr_b16 v[40:41], v17 offset:0
 ds_read_b64_tr_b16 v[42:43], v17 offset:256
 ds_read_b64_tr_b16 v[44:45], v17 offset:4096
 ds_read_b64_tr_b16 v[46:47], v17 offset:4352
 s_waitcnt vmcnt(9)
 s_waitcnt lgkmcnt(0)
 s_barrier
 s_add_u32 m0, s72, 114688
 s_add_u32 s47, s71, 36992
 buffer_load_dwordx4 v14, s[24:27], s47 offen  lds
 s_add_u32 m0, s72, 115712
 s_nop 0
 buffer_load_dwordx4 v15, s[24:27], s47 offen  lds
 ds_write_b128 v61, v[40:43] offset:0
 ds_write_b128 v61, v[44:47] offset:4096
 ds_read_b64_tr_b16 v[48:49], v17 offset:8192
 ds_read_b64_tr_b16 v[50:51], v17 offset:8448
 ds_read_b64_tr_b16 v[52:53], v17 offset:12288
 ds_read_b64_tr_b16 v[54:55], v17 offset:12544
 s_waitcnt vmcnt(9)
 s_waitcnt lgkmcnt(0)
 s_barrier
 s_add_u32 m0, s72, 122880
 s_add_u32 s47, s71, 37120
 buffer_load_dwordx4 v14, s[24:27], s47 offen  lds
 s_add_u32 m0, s72, 123904
 s_nop 0
 buffer_load_dwordx4 v15, s[24:27], s47 offen  lds
 ds_write_b128 v61, v[48:51] offset:8192
 ds_write_b128 v61, v[52:55] offset:12288
 ds_read_b64_tr_b16 v[40:41], v17 offset:16384
 ds_read_b64_tr_b16 v[42:43], v17 offset:16640
 ds_read_b64_tr_b16 v[44:45], v17 offset:20480
 ds_read_b64_tr_b16 v[46:47], v17 offset:20736
 s_waitcnt vmcnt(9)
 s_waitcnt lgkmcnt(0)
 s_barrier
 s_add_u32 m0, s72, 131072
 s_add_u32 s47, s71, 37248
 buffer_load_dwordx4 v14, s[24:27], s47 offen  lds
 s_add_u32 m0, s72, 132096
 s_nop 0
 buffer_load_dwordx4 v15, s[24:27], s47 offen  lds
 ds_write_b128 v61, v[40:43] offset:16384
 ds_write_b128 v61, v[44:47] offset:20480
 ds_read_b64_tr_b16 v[48:49], v17 offset:24576
 ds_read_b64_tr_b16 v[50:51], v17 offset:24832
 ds_read_b64_tr_b16 v[52:53], v17 offset:28672
 ds_read_b64_tr_b16 v[54:55], v17 offset:28928
 s_waitcnt vmcnt(9)
 s_waitcnt lgkmcnt(0)
 s_barrier
 s_add_u32 m0, s72, 139264
 s_add_u32 s47, s71, 37376
 buffer_load_dwordx4 v14, s[24:27], s47 offen  lds
 s_add_u32 m0, s72, 140288
 s_nop 0
 buffer_load_dwordx4 v15, s[24:27], s47 offen  lds
 ds_write_b128 v61, v[48:51] offset:24576
 ds_write_b128 v61, v[52:55] offset:28672
 ds_read_b64_tr_b16 v[40:41], v17 offset:32768
 ds_read_b64_tr_b16 v[42:43], v17 offset:33024
 ds_read_b64_tr_b16 v[44:45], v17 offset:36864
 ds_read_b64_tr_b16 v[46:47], v17 offset:37120
 s_waitcnt vmcnt(9)
 s_waitcnt lgkmcnt(0)
 s_barrier
 s_add_u32 m0, s72, 147456
 s_add_u32 s47, s71, 37504
 buffer_load_dwordx4 v14, s[24:27], s47 offen  lds
 s_add_u32 m0, s72, 148480
 s_nop 0
 buffer_load_dwordx4 v15, s[24:27], s47 offen  lds
 ds_write_b128 v61, v[40:43] offset:32768
 ds_write_b128 v61, v[44:47] offset:36864
 ds_read_b64_tr_b16 v[48:49], v17 offset:40960
 ds_read_b64_tr_b16 v[50:51], v17 offset:41216
 ds_read_b64_tr_b16 v[52:53], v17 offset:45056
 ds_read_b64_tr_b16 v[54:55], v17 offset:45312
 s_waitcnt vmcnt(8)
 s_waitcnt lgkmcnt(0)
 s_barrier
 s_add_u32 m0, s72, 155648
 s_add_u32 s47, s71, 37632
 buffer_load_dwordx4 v14, s[24:27], s47 offen  lds
 s_add_u32 m0, s72, 156672
 s_nop 0
 buffer_load_dwordx4 v15, s[24:27], s47 offen  lds
 v_cmp_ne_u32 vcc, 0, v68
 s_mov_b32 s77, vcc_lo
 s_add_u32 s58, s6, 1
 s_and_b32 s58, s58, 31
 s_bitcmp1_b32 s77, s58
 s_cbranch_scc1 Lhlp_63
 s_lshl_b32 s76, s58, 8
 s_mul_i32 s80, s58, 147456
 s_add_u32 s47, s76, 2359424
 buffer_load_dword v63, v19, s[12:15], s47 offen
 s_add_u32 s47, s80, 37888
 buffer_load_dword v63, v59, s[24:27], s47 offen
 s_add_u32 s47, s80, 37120
 buffer_load_dword v63, v59, s[24:27], s47 offen
 s_add_u32 s47, s80, 37504
 buffer_load_dword v63, v59, s[24:27], s47 offen
 s_add_u32 s47, s76, 128
 buffer_load_dword v63, v19, s[12:15], s47 offen
Lhlp_63:
 s_add_u32 s58, s6, 2
 s_and_b32 s58, s58, 31
 s_bitcmp1_b32 s77, s58
 s_cbranch_scc1 Lhlp_64
 s_lshl_b32 s76, s58, 8
 s_mul_i32 s80, s58, 147456
 s_add_u32 s47, s76, 3145856
 buffer_load_dword v63, v19, s[12:15], s47 offen
 s_add_u32 s47, s80, 36864
 buffer_load_dword v63, v59, s[24:27], s47 offen
 s_add_u32 s47, s80, 37248
 buffer_load_dword v63, v59, s[24:27], s47 offen
 s_add_u32 s47, s80, 37632
 buffer_load_dword v63, v59, s[24:27], s47 offen
 s_add_u32 s47, s76, 262272
 buffer_load_dword v63, v19, s[12:15], s47 offen
Lhlp_64:
 s_add_u32 s58, s6, 3
 s_and_b32 s58, s58, 31
 s_bitcmp1_b32 s77, s58
 s_cbranch_scc1 Lhlp_65
 s_lshl_b32 s76, s58, 8
 s_mul_i32 s80, s58, 147456
 s_add_u32 s47, s76, 3408000
 buffer_load_dword v63, v19, s[12:15], s47 offen
 s_add_u32 s47, s80, 36992
 buffer_load_dword v63, v59, s[24:27], s47 offen
 s_add_u32 s47, s80, 37376
 buffer_load_dword v63, v59, s[24:27], s47 offen
 s_add_u32 s47, s76, 4194432
 buffer_load_dword v63, v58, s[12:15], s47 offen
 s_add_u32 s47, s76, 1048704
 buffer_load_dword v63, v19, s[12:15], s47 offen
Lhlp_65:
 ds_write_b128 v61, v[48:51] offset:40960
 ds_write_b128 v61, v[52:55] offset:45056
 ds_read_b64_tr_b16 v[40:41], v17 offset:49152
 ds_read_b64_tr_b16 v[42:43], v17 offset:49408
 ds_read_b64_tr_b16 v[44:45], v17 offset:53248
 ds_read_b64_tr_b16 v[46:47], v17 offset:53504
 s_waitcnt vmcnt(8)
 s_waitcnt lgkmcnt(0)
 s_barrier
 s_add_u32 m0, s72, 24576
 s_add_u32 s47, s70, 4194432
 buffer_load_dwordx4 v12, s[12:15], s47 offen  lds
 s_add_u32 m0, s72, 25600
 s_nop 0
 buffer_load_dwordx4 v13, s[12:15], s47 offen  lds
 ds_write_b128 v61, v[40:43] offset:49152
 ds_write_b128 v61, v[44:47] offset:53248
 ds_read_b64_tr_b16 v[48:49], v17 offset:57344
 ds_read_b64_tr_b16 v[50:51], v17 offset:57600
 ds_read_b64_tr_b16 v[52:53], v17 offset:61440
 ds_read_b64_tr_b16 v[54:55], v17 offset:61696
 s_waitcnt vmcnt(8)
 s_waitcnt lgkmcnt(0)
 s_barrier
 s_add_u32 m0, s72, 32768
 s_add_u32 s47, s70, 128
 buffer_load_dwordx4 v56, s[12:15], s47 offen  lds
 s_add_u32 m0, s72, 33792
 s_nop 0
 buffer_load_dwordx4 v57, s[12:15], s47 offen  lds
 ds_write_b128 v61, v[48:51] offset:57344
 ds_write_b128 v61, v[52:55] offset:61440
 ds_read_b64_tr_b16 v[40:41], v18 offset:0
 ds_read_b64_tr_b16 v[42:43], v18 offset:256
 ds_read_b64_tr_b16 v[44:45], v18 offset:4096
 ds_read_b64_tr_b16 v[46:47], v18 offset:4352
 s_waitcnt vmcnt(8)
 s_waitcnt lgkmcnt(0)
 s_barrier
 s_add_u32 m0, s72, 40960
 s_add_u32 s47, s70, 262272
 buffer_load_dwordx4 v56, s[12:15], s47 offen  lds
 s_add_u32 m0, s72, 41984
 s_nop 0
 buffer_load_dwordx4 v57, s[12:15], s47 offen  lds
 ds_write_b128 v62, v[40:43] offset:0
 ds_write_b128 v62, v[44:47] offset:4096
 ds_read_b64_tr_b16 v[48:49], v18 offset:8192
 ds_read_b64_tr_b16 v[50:51], v18 offset:8448
 ds_read_b64_tr_b16 v[52:53], v18 offset:12288
 ds_read_b64_tr_b16 v[54:55], v18 offset:12544
 s_waitcnt vmcnt(8)
 s_waitcnt lgkmcnt(0)
 s_barrier
 s_add_u32 m0, s72, 49152
 s_add_u32 s47, s70, 1048704
 buffer_load_dwordx4 v56, s[12:15], s47 offen  lds
 s_add_u32 m0, s72, 50176
 s_nop 0
 buffer_load_dwordx4 v57, s[12:15], s47 offen  lds
 buffer_load_dword v1, v65, s[20:23], s56 offen sc1
 ds_write_b128 v62, v[48:51] offset:8192
 ds_write_b128 v62, v[52:55] offset:12288
 ds_read_b64_tr_b16 v[40:41], v18 offset:16384
 ds_read_b64_tr_b16 v[42:43], v18 offset:16640
 ds_read_b64_tr_b16 v[44:45], v18 offset:20480
 ds_read_b64_tr_b16 v[46:47], v18 offset:20736
 s_waitcnt vmcnt(9)
 s_waitcnt lgkmcnt(0)
 s_barrier
 ds_write_b128 v62, v[40:43] offset:16384
 ds_write_b128 v62, v[44:47] offset:20480
 ds_read_b64_tr_b16 v[48:49], v18 offset:24576
 ds_read_b64_tr_b16 v[50:51], v18 offset:24832
 ds_read_b64_tr_b16 v[52:53], v18 offset:28672
 ds_read_b64_tr_b16 v[54:55], v18 offset:28928
 s_waitcnt vmcnt(7)
 s_waitcnt lgkmcnt(0)
 s_barrier
 ds_write_b128 v62, v[48:51] offset:24576
 ds_write_b128 v62, v[52:55] offset:28672
 ds_read_b64_tr_b16 v[40:41], v16 offset:24576
 ds_read_b64_tr_b16 v[42:43], v16 offset:24832
 ds_read_b64_tr_b16 v[44:45], v16 offset:28672
 ds_read_b64_tr_b16 v[46:47], v16 offset:28928
 s_waitcnt vmcnt(5)
 s_waitcnt lgkmcnt(0)
 s_barrier
 ds_write_b128 v60, v[40:43] offset:24576
 ds_write_b128 v60, v[44:47] offset:28672
 ds_read_b64_tr_b16 v[48:49], v16 offset:32768
 ds_read_b64_tr_b16 v[50:51], v16 offset:33024
 ds_read_b64_tr_b16 v[52:53], v16 offset:36864
 ds_read_b64_tr_b16 v[54:55], v16 offset:37120
 s_waitcnt vmcnt(3)
 s_waitcnt lgkmcnt(0)
 s_barrier
 ds_write_b128 v60, v[48:51] offset:32768
 ds_write_b128 v60, v[52:55] offset:36864
 ds_read_b64_tr_b16 v[40:41], v16 offset:40960
 ds_read_b64_tr_b16 v[42:43], v16 offset:41216
 ds_read_b64_tr_b16 v[44:45], v16 offset:45056
 ds_read_b64_tr_b16 v[46:47], v16 offset:45312
 s_waitcnt vmcnt(1)
 s_waitcnt lgkmcnt(0)
 s_barrier
 ds_write_b128 v60, v[40:43] offset:40960
 ds_write_b128 v60, v[44:47] offset:45056
 ds_read_b64_tr_b16 v[48:49], v16 offset:49152
 ds_read_b64_tr_b16 v[50:51], v16 offset:49408
 ds_read_b64_tr_b16 v[52:53], v16 offset:53248
 ds_read_b64_tr_b16 v[54:55], v16 offset:53504
 s_waitcnt lgkmcnt(0)
 s_barrier
 ds_write_b128 v60, v[48:51] offset:49152
 ds_write_b128 v60, v[52:55] offset:53248
 v_lshlrev_b32 v0, 4, v0
 s_waitcnt vmcnt(0)
 v_cmp_le_u32 vcc, 2, v1
 s_cbranch_vccnz Lpbk_66
Lpb0_67:
 buffer_load_dword v1, v7, s[20:23], s56 offen sc1
 s_waitcnt vmcnt(0)
 v_cmp_le_u32 vcc, 2, v1
 s_cbranch_vccnz Lpb0ok_68
 s_sub_u32 s54, s54, 1
 s_cbranch_scc0 Lpb0_67
 s_endpgm
Lpb0ok_68:
Lpbk_66:
 s_lshl_b32 s47, s4, 11
 s_add_u32 m0, s47, 9216
 s_add_u32 s68, s37, 0x80000
 buffer_load_dwordx4 v3, s[20:23], s67 offen offset:0 sc1 lds
 buffer_load_dwordx4 v3, s[20:23], s67 offen offset:1024 sc1 lds
 buffer_load_dword v12, v67, s[20:23], s37 offen sc1
 v_mov_b64 v[68:69], 0
 v_mov_b64 v[70:71], 0
 s_mov_b32 s24, 0xf000f
 s_mov_b32 s25, 0xf000f
 s_mov_b32 s26, 0xf000f0
 s_mov_b32 s27, 0xf000f0
 s_mov_b32 s28, 0xf000f00
 s_mov_b32 s29, 0xf000f00
 s_mov_b32 s30, 0xf000f000
 s_mov_b32 s31, 0xf000f000
 s_mov_b32 s32, 0xaaaaaaaa
 s_mov_b32 s33, 0xaaaaaaaa
 s_mov_b32 s34, 0x3f803f80
 s_mov_b32 s35, 0x3f803f80
 s_mov_b32 s70, -1
 s_mov_b32 s71, 0
 s_lshl_b32 s47, s4, 12
 s_add_u32 s68, s68, s47
 v_mov_b32 v2, 0
 v_mov_b32 v4, 0
 s_waitcnt lgkmcnt(0)
 ds_read_b128 v[20:23], v0 offset:24576
 ds_read_b128 v[24:27], v0 offset:28672
 ds_read_b128 v[28:31], v0 offset:32768
 ds_read_b128 v[32:35], v0 offset:36864
 v_mov_b64 v[36:37], 0
 v_mov_b64 v[38:39], 0
 v_mov_b64 v[40:41], 0
 v_mov_b64 v[42:43], 0
 v_mov_b64 v[44:45], 0
 v_mov_b64 v[46:47], 0
 v_mov_b64 v[48:49], 0
 v_mov_b64 v[50:51], 0
 v_lshl_add_u32 v1, v3, 3, s68
 v_mov_b32 v6, s56
 v_cndmask_b32 v1, v6, v1, s[70:71]
 v_min_u32 v6, 16, v0
 v_lshlrev_b32 v6, 24, v6
 s_max_u32 s47, s36, 1
 v_add_u32 v2, -1, s47
 s_xor_b32 s44, s44, 0x80000
 s_xor_b32 s45, s45, 0x80000
 s_xor_b32 s65, s65, 0x80000
 s_xor_b32 s66, s66, 0x80000
 s_xor_b32 s41, s41, 0x80000
 s_xor_b32 s43, s43, 0x80000
 s_lshr_b64 s[74:75], s[74:75], s73
 s_and_b32 s74, s74, 0xff
 s_cmp_eq_u32 s74, 32
 s_waitcnt vmcnt(1)
 s_cbranch_scc0 Lslow_69
 s_branch Lstep_71
 .p2align 3
LstepB_73:
 s_mov_b64 exec, -1
 s_cmp_lg_u32 s50, 0
 s_cbranch_scc1 Lsure_74
Lsureb_75:
 buffer_load_dwordx4 v3, s[20:23], s41 offen offset:0 sc1 lds
 buffer_load_dwordx4 v3, s[20:23], s41 offen offset:1024 sc1 lds
Lstep_71:
 s_mov_b64 exec, -1
 s_waitcnt lgkmcnt(0)
 buffer_load_dwordx4 v[12:15], v3, s[20:23], s59 offen offset:0 sc1
 buffer_load_dwordx4 v[16:19], v3, s[20:23], s59 offen offset:1024 sc1
 s_barrier
 ds_read_b128 v[52:55], v3 offset:8192
 ds_read_b128 v[56:59], v3 offset:0
 ds_read_b128 v[60:63], v3 offset:1024
 buffer_store_dwordx4 v[64:67], v0, s[20:23], s38 offen sc1
 s_waitcnt lgkmcnt(2)
 v_smfmac_f32_16x16x64_bf16 v[36:39], v[52:55], a[136:143], v5
 v_smfmac_f32_16x16x64_bf16 v[40:43], v[52:55], a[144:151], v5
 buffer_store_dword v2, v6, s[20:23], s57 offen sc1
 v_smfmac_f32_16x16x64_bf16 v[44:47], v[52:55], a[152:159], v5
 s_waitcnt lgkmcnt(1)
 v_smfmac_f32_16x16x64_bf16 v[48:51], v[52:55], v[20:27], v5
 buffer_load_dword v1, v1, s[20:23], 0 offen sc1
 v_smfmac_f32_16x16x64_bf16 v[36:39], v[56:59], v[72:79], v5
 ds_read_b128 v[20:23], v0 offset:40960
 v_mov_b64 v[64:65], 0
 v_smfmac_f32_16x16x64_bf16 v[40:43], v[56:59], v[80:87], v5
 ds_read_b128 v[24:27], v0 offset:45056
 v_mov_b64 v[66:67], 0
 v_smfmac_f32_16x16x64_bf16 v[44:47], v[56:59], v[88:95], v5
 ds_read_b128 v[52:55], v3 offset:2048
 s_waitcnt lgkmcnt(3)
 v_smfmac_f32_16x16x64_bf16 v[48:51], v[56:59], v[28:35], v5
 v_smfmac_f32_16x16x64_bf16 v[36:39], v[60:63], v[112:119], v5
 ds_read_b128 v[28:31], v0 offset:49152
 v_smfmac_f32_16x16x64_bf16 v[40:43], v[60:63], v[120:127], v5
 ds_read_b128 v[32:35], v0 offset:53248
 v_smfmac_f32_16x16x64_bf16 v[44:47], v[60:63], v[128:135], v5
 ds_read_b128 v[56:59], v3 offset:3072
 v_smfmac_f32_16x16x64_bf16 v[64:67], v[60:63], v[136:143], v5
 s_waitcnt vmcnt(5)
 v_smfmac_f32_16x16x64_bf16 v[68:71], v[60:63], v[144:151], v5
 s_waitcnt lgkmcnt(3)
 v_smfmac_f32_16x16x64_bf16 v[48:51], v[60:63], v[20:27], v5
 s_barrier
 v_smfmac_f32_16x16x64_bf16 v[36:39], v[52:55], v[152:159], v5
 ds_read_b128 v[20:23], v0 offset:57344
 v_smfmac_f32_16x16x64_bf16 v[40:43], v[52:55], v[160:167], v5
 ds_read_b128 v[24:27], v0 offset:61440
 v_smfmac_f32_16x16x64_bf16 v[44:47], v[52:55], v[168:175], v5
 ds_read_b128 v[60:63], v3 offset:4096
 v_smfmac_f32_16x16x64_bf16 v[64:67], v[52:55], v[176:183], v5
 v_smfmac_f32_16x16x64_bf16 v[68:71], v[52:55], v[184:191], v5
 s_waitcnt lgkmcnt(3)
 v_add_u32 v0, 0x10000, v0
 v_smfmac_f32_16x16x64_bf16 v[48:51], v[52:55], v[28:35], v5
 ds_read_b128 v[52:55], v3 offset:5120
 v_smfmac_f32_16x16x64_bf16 v[36:39], v[56:59], v[192:199], v5
 ds_read_b128 v[28:31], v0 offset:0
 v_smfmac_f32_16x16x64_bf16 v[40:43], v[56:59], v[200:207], v5
 ds_read_b128 v[32:35], v0 offset:4096
 v_smfmac_f32_16x16x64_bf16 v[44:47], v[56:59], v[208:215], v5
 v_smfmac_f32_16x16x64_bf16 v[64:67], v[56:59], v[216:223], v5
 s_waitcnt lgkmcnt(2)
 v_max_u32 v4, v63, v55
 v_cmp_eq_u32 vcc, -1, v4
 v_smfmac_f32_16x16x64_bf16 v[68:71], v[56:59], v[224:231], v5
 v_smfmac_f32_16x16x64_bf16 v[48:51], v[56:59], v[20:27], v5
 ds_read_b128 v[56:59], v3 offset:6144
 s_cbranch_vccnz Lfx_76
Lfxb_77:
 v_smfmac_f32_16x16x64_bf16 v[36:39], v[60:63], v[232:239], v5
 ds_read_b128 v[20:23], v0 offset:8192
 v_smfmac_f32_16x16x64_bf16 v[40:43], v[60:63], v[240:247], v5
 ds_read_b128 v[24:27], v0 offset:12288
 v_smfmac_f32_16x16x64_bf16 v[44:47], v[60:63], v[248:255], v5
 s_waitcnt lgkmcnt(3)
 v_smfmac_f32_16x16x64_bf16 v[48:51], v[60:63], v[28:35], v5
 ds_read_b128 v[60:63], v3 offset:7168
 v_smfmac_f32_16x16x64_bf16 v[36:39], v[52:55], a[16:23], v5
 ds_read_b128 v[28:31], v0 offset:16384
 v_smfmac_f32_16x16x64_bf16 v[40:43], v[52:55], a[24:31], v5
 ds_read_b128 v[32:35], v0 offset:20480
 v_smfmac_f32_16x16x64_bf16 v[44:47], v[52:55], a[32:39], v5
 s_waitcnt lgkmcnt(3)
 v_smfmac_f32_16x16x64_bf16 v[48:51], v[52:55], v[20:27], v5
 s_waitcnt lgkmcnt(2)
 v_max_u32 v4, v59, v63
 v_cmp_eq_u32 vcc, -1, v4
 v_smfmac_f32_16x16x64_bf16 v[64:67], v[52:55], a[40:47], v5
 ds_read_b128 v[20:23], v0 offset:24576
 v_smfmac_f32_16x16x64_bf16 v[68:71], v[52:55], a[48:55], v5
 s_cbranch_vccnz Lfx_78
Lfxb_79:
 v_smfmac_f32_16x16x64_bf16 v[36:39], v[56:59], a[56:63], v5
 ds_read_b128 v[24:27], v0 offset:28672
 v_smfmac_f32_16x16x64_bf16 v[40:43], v[56:59], a[64:71], v5
 ds_read_b128 v[52:55], v3 offset:8192
 v_smfmac_f32_16x16x64_bf16 v[36:39], v[60:63], a[96:103], v5
 v_smfmac_f32_16x16x64_bf16 v[40:43], v[60:63], a[104:111], v5
 v_smfmac_f32_16x16x64_bf16 v[44:47], v[56:59], a[72:79], v5
 s_waitcnt lgkmcnt(1)
 v_add_f32 v36, v36, v38
 v_add_f32 v37, v37, v39
 v_smfmac_f32_16x16x64_bf16 v[48:51], v[56:59], v[28:35], v5
 ds_read_b128 v[32:35], v3 offset:11264
 v_add_f32 v40, v40, v42
 v_add_f32 v41, v41, v43
 v_smfmac_f32_16x16x64_bf16 v[44:47], v[60:63], a[112:119], v5
 v_cvt_pk_bf16_f32 v36, v36, v40
 v_cvt_pk_bf16_f32 v37, v37, v41
 v_smfmac_f32_16x16x64_bf16 v[48:51], v[60:63], v[20:27], v5
 ds_write2_b32 v10, v36, v37 offset0:0 offset1:16
 v_smfmac_f32_16x16x64_bf16 v[64:67], v[56:59], a[80:87], v5
 ds_read_b128 v[20:23], v3 offset:9216
 v_add_f32 v44, v44, v46
 v_add_f32 v45, v45, v47
 v_smfmac_f32_16x16x64_bf16 v[68:71], v[56:59], a[88:95], v5
 s_waitcnt lgkmcnt(3)
 v_add_f32 v48, v48, v50
 v_add_f32 v49, v49, v51
 v_cvt_pk_bf16_f32 v44, v44, v48
 v_cvt_pk_bf16_f32 v45, v45, v49
 ds_write2_b32 v8, v44, v45 offset0:0 offset1:16
 v_smfmac_f32_16x16x64_bf16 v[64:67], v[52:55], a[160:167], v5
 ds_read_b128 v[56:59], v3 offset:0
 v_mov_b64 v[28:29], 0
 v_smfmac_f32_16x16x64_bf16 v[68:71], v[52:55], a[168:175], v5
 ds_read_b128 v[52:55], v3 offset:4096
 v_mov_b64 v[30:31], 0
 v_smfmac_f32_16x16x64_bf16 v[64:67], v[60:63], a[120:127], v5
 ds_read_b128 v[24:27], v3 offset:10240
 v_smfmac_f32_16x16x64_bf16 v[68:71], v[60:63], a[128:135], v5
 s_waitcnt lgkmcnt(3)
 s_barrier
 ds_read_b128 v[36:39], v11 offset:17408
 s_waitcnt lgkmcnt(3)
 v_smfmac_f32_16x16x64_bf16 v[64:67], v[56:59], v[96:103], v5
 ds_read_b128 v[40:43], v11 offset:17920
 s_waitcnt lgkmcnt(3)
 v_smfmac_f32_16x16x64_bf16 v[68:71], v[56:59], v[104:111], v5
 ds_read_b128 v[60:63], v9 offset:19456
 ds_read_b128 v[44:47], v11 offset:18432
 v_smfmac_f32_16x16x64_bf16 v[64:67], v[52:55], a[0:7], v5
 ds_read_b128 v[48:51], v11 offset:18944
 v_smfmac_f32_16x16x64_bf16 v[68:71], v[52:55], a[8:15], v5
 ds_read_b128 v[52:55], v3 offset:12288
 s_waitcnt lgkmcnt(5)
 v_mfma_f32_16x16x32_bf16 v[20:23], v[20:23], v[36:39], 0
 ds_read_b128 v[56:59], v9 offset:21504
 v_mfma_f32_16x16x32_bf16 v[24:27], v[24:27], v[36:39], 0
 v_add_f32 v64, v64, v66
 v_add_f32 v65, v65, v67
 s_waitcnt lgkmcnt(5)
 v_mfma_f32_16x16x32_bf16 v[20:23], v[32:35], v[40:43], v[20:23]
 ds_read_b128 v[32:35], v3 offset:13312
 v_cvt_pk_bf16_f32 v2, v64, v65
 v_add_f32 v68, v68, v70
 s_waitcnt lgkmcnt(5)
 v_smfmac_f32_16x16x64_bf16 v[28:31], v[60:63], v[36:43], v5
 ds_read_b128 v[60:63], v3 offset:14336
 ds_read_b128 v[36:39], v3 offset:15360
 v_add_f32 v69, v69, v71
 s_waitcnt lgkmcnt(4)
 v_mfma_f32_16x16x32_bf16 v[24:27], v[52:55], v[40:43], v[24:27]
 ds_read_b128 v[52:55], v3 offset:16384
 v_cvt_pk_bf16_f32 v4, v68, v69
 s_waitcnt lgkmcnt(4)
 v_smfmac_f32_16x16x64_bf16 v[28:31], v[56:59], v[44:51], v5
 ds_read_b128 v[40:43], v0 offset:36864
 s_waitcnt lgkmcnt(4)
 v_mfma_f32_16x16x32_bf16 v[20:23], v[32:35], v[44:47], v[20:23]
 v_mov_b64 v[32:33], s[34:35]
 v_mov_b64 v[34:35], s[34:35]
 s_waitcnt lgkmcnt(3)
 v_mfma_f32_16x16x32_bf16 v[24:27], v[60:63], v[44:47], v[24:27]
 ds_read_b128 v[44:47], v0 offset:40960
 v_add_f32 v28, v28, v30
 v_add_f32 v29, v29, v31
 s_waitcnt lgkmcnt(3)
 v_mfma_f32_16x16x32_bf16 v[20:23], v[36:39], v[48:51], v[20:23]
 ds_read_b128 v[36:39], v0 offset:32768
 v_cndmask_b32 v28, v28, v29, s[48:49]
 v_mul_f32 v28, s55, v28
 s_waitcnt lgkmcnt(3)
 v_mfma_f32_16x16x32_bf16 v[24:27], v[52:55], v[48:51], v[24:27]
 ds_read_b128 v[48:51], v0 offset:45056
 v_exp_f32 v28, v28
 v_mov_b64 v[64:65], 0
 v_cndmask_b32 v29, 0, v28, s[48:49]
 v_cndmask_b32 v28, v28, 0, s[48:49]
 v_cvt_pk_bf16_f32 v6, v28, v29
 v_mov_b64 v[66:67], 0
 v_mov_b64 v[68:69], 0
 v_cndmask_b32 v20, v20, v24, s[48:49]
 v_cndmask_b32 v21, v21, v25, s[48:49]
 v_cndmask_b32 v22, v22, v26, s[48:49]
 v_cndmask_b32 v23, v23, v27, s[48:49]
 v_mfma_f32_16x16x16_bf16 v[60:63], v[6:7], v[32:33], 0
 s_waitcnt vmcnt(3)
 v_exp_f32 v20, v20
 v_mfma_f32_16x16x16_bf16 v[52:55], v[6:7], v[2:3], 0
 s_cmp_eq_u32 s36, 63
 v_exp_f32 v21, v21
 v_mfma_f32_16x16x16_bf16 v[56:59], v[6:7], v[4:5], 0
 v_exp_f32 v22, v22
 v_exp_f32 v23, v23
 v_cvt_pk_bf16_f32 v30, v20, v21
 v_cvt_pk_bf16_f32 v31, v22, v23
 v_mov_b64 v[70:71], 0
 v_mov_b64 v[20:21], 0
 v_smfmac_f32_16x16x32_bf16 v[60:63], v[30:31], v[32:35], v5
 v_mov_b64 v[22:23], 0
 v_mov_b64 v[24:25], 0
 v_smfmac_f32_16x16x32_bf16 v[52:55], v[30:31], v[12:15], v5
 v_mov_b64 v[26:27], 0
 v_smfmac_f32_16x16x32_bf16 v[56:59], v[30:31], v[16:19], v5
 s_nop 0
 v_add_f32 v60, v60, v62
 v_add_f32 v61, v61, v63
 v_rcp_f32 v60, v60
 v_rcp_f32 v61, v61
 v_add_f32 v52, v52, v54
 v_add_f32 v53, v53, v55
 v_mul_f32 v52, v52, v60
 v_mul_f32 v53, v53, v61
 v_add_f32 v56, v56, v58
 v_add_f32 v57, v57, v59
 v_mul_f32 v56, v56, v60
 v_mul_f32 v57, v57, v61
 v_cvt_pk_bf16_f32 v52, v52, v56
 v_cvt_pk_bf16_f32 v53, v53, v57
 ds_write2_b32 v8, v52, v53 offset0:128 offset1:144
 v_subrev_u32 v60, 0x21800000, v60
 v_subrev_u32 v61, 0x21800000, v61
 v_max_u32 v60, v60, v61
 v_cmp_lt_u32 vcc, 0x3c000000, v60
 s_cbranch_scc1 Lchexit_70
 v_mov_b64 v[28:29], 0
 v_mov_b64 v[30:31], 0
 v_mov_b64 v[32:33], 0
 v_mov_b64 v[34:35], 0
 s_cbranch_vccnz Lmx_80
Lmxb_81:
 s_waitcnt lgkmcnt(0)
 v_bfe_u32 v6, v0, 7, 5
 s_barrier
 ds_read_b128 v[52:55], v9 offset:19968
 v_mul_u32_u24 v6, 10496, v6
 ds_read_b128 v[56:59], v9 offset:22016
 ds_read_b128 v[12:15], v0 offset:49152
 v_bfe_u32 v60, v3, 4, 3
 ds_read_b128 v[16:19], v0 offset:53248
 s_add_u32 s67, s67, 0x80000
 v_lshl_add_u32 v6, v60, 3, v6
 s_add_u32 m0, s42, 9216
 s_xor_b32 s46, s46, 0x1
 v_mov_b64 v[60:61], 0
 s_add_u32 s59, s59, 0x80000
 v_mov_b64 v[62:63], 0
 s_waitcnt lgkmcnt(3)
 v_smfmac_f32_16x16x64_bf16 v[64:67], v[52:55], a[248:255], v5
 buffer_load_dwordx4 v3, s[20:23], s67 offen offset:0 sc1 lds
 v_smfmac_f32_16x16x64_bf16 v[68:71], v[52:55], a[176:183], v5
 s_waitcnt lgkmcnt(2)
 s_add_u32 s38, s38, 0x20000
 v_smfmac_f32_16x16x64_bf16 v[64:67], v[56:59], v[36:43], v5
 ds_read_b128 v[36:39], v0 offset:57344
 buffer_load_dwordx4 v3, s[20:23], s67 offen offset:1024 sc1 lds
 v_smfmac_f32_16x16x64_bf16 v[20:23], v[52:55], a[184:191], v5
 ds_read_b128 v[40:43], v0 offset:61440
 s_cmp_lt_u32 s36, 62
 v_add_u32 v0, 0x10000, v0
 v_smfmac_f32_16x16x64_bf16 v[68:71], v[56:59], v[44:51], v5
 ds_read_b128 v[44:47], v0 offset:0
 s_cselect_b32 s47, 0x80000, 0
 v_add_f32 v64, v64, v66
 v_add_f32 v65, v65, v67
 v_cvt_pk_bf16_f32 v65, v65, v65
 v_smfmac_f32_16x16x64_bf16 v[24:27], v[52:55], a[192:199], v5
 ds_read_b128 v[48:51], v0 offset:4096
 s_waitcnt lgkmcnt(4)
 v_cvt_pk_bf16_f32 v64, v64, v64
 v_and_or_b32 v65, v65, -2, s46
 v_smfmac_f32_16x16x64_bf16 v[20:23], v[56:59], v[12:19], v5
 ds_read_b128 v[12:15], v0 offset:8192
 buffer_store_dwordx2 v[64:65], v6, s[20:23], s62 offen
 v_add_f32 v68, v68, v70
 v_add_f32 v69, v69, v71
 v_smfmac_f32_16x16x64_bf16 v[28:31], v[52:55], a[200:207], v5
 ds_read_b128 v[16:19], v0 offset:12288
 s_waitcnt lgkmcnt(4)
 v_mov_b64 v[64:65], 0
 v_mov_b64 v[66:67], 0
 v_smfmac_f32_16x16x64_bf16 v[24:27], v[56:59], v[36:43], v5
 ds_read_b128 v[36:39], v0 offset:16384
 s_add_u32 s68, s68, s47
 v_add_f32 v20, v20, v22
 v_add_f32 v21, v21, v23
 v_cvt_pk_bf16_f32 v69, v69, v21
 v_smfmac_f32_16x16x64_bf16 v[32:35], v[52:55], a[208:215], v5
 ds_read_b128 v[40:43], v0 offset:20480
 s_waitcnt lgkmcnt(4)
 v_cvt_pk_bf16_f32 v68, v68, v20
 v_and_or_b32 v69, v69, -2, s46
 v_smfmac_f32_16x16x64_bf16 v[28:31], v[56:59], v[44:51], v5
 ds_read_b128 v[44:47], v0 offset:24576
 buffer_store_dwordx2 v[68:69], v6, s[20:23], s60 offen offset:0
 v_add_f32 v24, v24, v26
 v_add_f32 v25, v25, v27
 v_smfmac_f32_16x16x64_bf16 v[60:63], v[52:55], a[216:223], v5
 ds_read_b128 v[48:51], v0 offset:28672
 s_waitcnt lgkmcnt(4)
 v_mov_b64 v[20:21], 0
 v_mov_b64 v[22:23], 0
 v_smfmac_f32_16x16x64_bf16 v[32:35], v[56:59], v[12:19], v5
 s_add_u32 s36, s36, 1
 s_add_u32 s58, s36, 2
 v_add_f32 v28, v28, v30
 v_add_f32 v29, v29, v31
 v_cvt_pk_bf16_f32 v25, v25, v29
 v_smfmac_f32_16x16x64_bf16 v[64:67], v[52:55], a[224:231], v5
 s_waitcnt lgkmcnt(2)
 s_min_u32 s58, s58, 64
 v_cvt_pk_bf16_f32 v24, v24, v28
 v_and_or_b32 v25, v25, -2, s46
 v_smfmac_f32_16x16x64_bf16 v[60:63], v[56:59], v[36:43], v5
 buffer_store_dwordx2 v[24:25], v6, s[20:23], s60 offen offset:2048
 v_add_f32 v32, v32, v34
 v_smfmac_f32_16x16x64_bf16 v[20:23], v[52:55], a[232:239], v5
 s_waitcnt lgkmcnt(0)
 s_xor_b32 s44, s44, 0x80000
 v_add_f32 v33, v33, v35
 v_smfmac_f32_16x16x64_bf16 v[64:67], v[56:59], v[44:51], v5
 s_xor_b32 s45, s45, 0x80000
 s_xor_b32 s65, s65, 0x80000
 v_add_f32 v60, v60, v62
 v_add_f32 v61, v61, v63
 v_smfmac_f32_16x16x64_bf16 v[20:23], v[56:59], a[240:247], v5
 s_cmp_eq_u32 s4, 0
 v_cvt_pk_bf16_f32 v33, v33, v61
 v_cvt_pk_bf16_f32 v32, v32, v60
 v_and_or_b32 v33, v33, -2, s46
 buffer_store_dwordx2 v[32:33], v6, s[20:23], s61 offen offset:0
 v_add_f32 v64, v64, v66
 v_add_f32 v65, v65, v67
 s_nop 0
 v_add_f32 v20, v20, v22
 v_add_f32 v21, v21, v23
 v_cvt_pk_bf16_f32 v65, v65, v21
 v_cvt_pk_bf16_f32 v64, v64, v20
 v_and_or_b32 v65, v65, -2, s46
 buffer_store_dwordx2 v[64:65], v6, s[20:23], s61 offen offset:2048
 s_cbranch_scc1 LwH_82
 s_cmp_eq_u32 s4, 1
 s_cbranch_scc1 Lw_83
 s_cmp_eq_u32 s4, 2
 s_cbranch_scc1 Lw_84
 s_xor_b32 s66, s66, 0x80000
 s_xor_b32 s41, s41, 0x80000
 s_xor_b32 s43, s43, 0x80000
 v_mov_b32 v47, 0x3f80
 v_cndmask_b32 v47, v47, 1.0, s[32:33]
 v_cndmask_b32 v44, 0, v47, s[24:25]
 v_cndmask_b32 v45, 0, v47, s[26:27]
 v_cndmask_b32 v46, 0, v47, s[28:29]
 v_cndmask_b32 v47, 0, v47, s[30:31]
 v_bfe_u32 v52, v3, 8, 2
 v_bfe_u32 v58, v3, 2, 4
 v_lshl_or_b32 v52, v52, 4, v58
 v_and_b32 v58, 0xc0, v3
 v_lshl_or_b32 v52, v58, 24, v52
 v_subrev_u32 v0, 0x20000, v0
 v_mov_b32 v59, -1
 v_add_u32 v54, s42, v3
 v_add_u32 v58, s69, v9
 ds_read_b64 v[64:65], v58 offset:19456
 v_mov_b32 v66, v2
 v_mov_b32 v67, v4
 v_mov_b64 v[68:69], 0
 v_mov_b64 v[70:71], 0
 ds_read_b128 v[20:23], v0 offset:24576
 ds_read_b128 v[24:27], v0 offset:28672
 ds_read_b128 v[28:31], v0 offset:32768
 ds_read_b128 v[32:35], v0 offset:36864
 s_waitcnt vmcnt(0)
 buffer_load_dwordx4 v[36:39], v3, s[20:23], s39 offen offset:0 sc1
 buffer_load_dwordx4 v[40:43], v3, s[20:23], s39 offen offset:1024 sc1
 s_nop 15
 s_nop 10
 buffer_load_dwordx4 v[12:15], v3, s[20:23], s39 offen offset:0 sc1
 buffer_load_dwordx4 v[16:19], v3, s[20:23], s39 offen offset:1024 sc1
 s_waitcnt vmcnt(3)
 v_mfma_f32_16x16x32_bf16 v[48:51], v[44:47], v[36:39], 0
 s_waitcnt vmcnt(2)
 v_mfma_f32_16x16x32_bf16 v[48:51], v[44:47], v[40:43], v[48:51]
 v_bitop3_b32 v55, v37, v39, s46 bitop3:0x7e
 v_bitop3_b32 v56, v41, v43, s46 bitop3:0x7e
 v_bitop3_b32 v55, v55, 1, v56 bitop3:0xc8
 v_cmp_ne_u32 vcc, 0, v55
 s_nop 3
 v_add_f32_dpp v48, v48, v48 row_ror:4 row_mask:0xf bank_mask:0xf
 v_add_f32_dpp v49, v49, v49 row_ror:4 row_mask:0xf bank_mask:0xf
 s_cbranch_vccnz Lr2_86
 v_add_f32_dpp v48, v48, v48 row_ror:8 row_mask:0xf bank_mask:0xf
 v_add_f32_dpp v49, v49, v49 row_ror:8 row_mask:0xf bank_mask:0xf
 v_cvt_pk_bf16_f32 v48, v48, v49
 buffer_store_dword v48, v52, s[20:23], s44 offen
Lb1_87:
 buffer_store_dword v59, v52, s[20:23], s45 offen
 v_cmp_gt_u32 vcc, s58, v1
 v_mov_b64 v[36:37], 0
 v_mov_b64 v[38:39], 0
 v_mov_b64 v[40:41], 0
 v_mov_b64 v[42:43], 0
 v_mov_b64 v[44:45], 0
 v_mov_b64 v[46:47], 0
 v_mov_b64 v[48:49], 0
 v_mov_b64 v[50:51], 0
 s_cmp_lg_u32 vcc_hi, 0
 s_cbranch_scc1 Lfw_89
Lfok_88:
 v_lshl_add_u32 v1, v3, 3, s68
 v_mov_b32 v6, s56
 v_cndmask_b32 v1, v6, v1, s[70:71]
 v_min_u32 v6, 16, v0
 v_lshlrev_b32 v6, 24, v6
 s_max_u32 s47, s36, 1
 v_add_u32 v2, -1, s47
 s_add_u32 m0, s42, 0
 s_waitcnt vmcnt(0)
 s_cmp_lg_u32 s50, 0
 s_cbranch_scc1 Lsure_74
 s_nop 15
 s_nop 15
 s_nop 7
 s_branch LstepB_73
Lw_84:
 s_xor_b32 s66, s66, 0x80000
 s_xor_b32 s41, s41, 0x80000
 s_xor_b32 s43, s43, 0x80000
 v_mov_b32 v47, 0x3f80
 v_cndmask_b32 v47, v47, 1.0, s[32:33]
 v_cndmask_b32 v44, 0, v47, s[24:25]
 v_cndmask_b32 v45, 0, v47, s[26:27]
 v_cndmask_b32 v46, 0, v47, s[28:29]
 v_cndmask_b32 v47, 0, v47, s[30:31]
 v_bfe_u32 v52, v3, 8, 2
 v_bfe_u32 v58, v3, 2, 4
 v_lshl_or_b32 v52, v52, 4, v58
 v_and_b32 v58, 0xc0, v3
 v_lshl_or_b32 v52, v58, 24, v52
 v_subrev_u32 v0, 0x20000, v0
 v_mov_b32 v59, -1
 v_add_u32 v54, s42, v3
 v_add_u32 v58, s69, v9
 ds_read_b64 v[64:65], v58 offset:19456
 v_mov_b32 v66, v2
 v_mov_b32 v67, v4
 v_mov_b64 v[68:69], 0
 v_mov_b64 v[70:71], 0
 ds_read_b128 v[20:23], v0 offset:24576
 ds_read_b128 v[24:27], v0 offset:28672
 ds_read_b128 v[28:31], v0 offset:32768
 ds_read_b128 v[32:35], v0 offset:36864
 s_waitcnt vmcnt(1)
 buffer_load_dwordx4 v[36:39], v3, s[20:23], s39 offen offset:0 sc1
 buffer_load_dwordx4 v[40:43], v3, s[20:23], s39 offen offset:1024 sc1
 s_nop 15
 s_nop 10
 buffer_load_dwordx4 v[12:15], v3, s[20:23], s39 offen offset:0 sc1
 buffer_load_dwordx4 v[16:19], v3, s[20:23], s39 offen offset:1024 sc1
 s_waitcnt vmcnt(3)
 v_mfma_f32_16x16x32_bf16 v[48:51], v[44:47], v[36:39], 0
 s_waitcnt vmcnt(2)
 v_mfma_f32_16x16x32_bf16 v[48:51], v[44:47], v[40:43], v[48:51]
 v_bitop3_b32 v55, v37, v39, s46 bitop3:0x7e
 v_bitop3_b32 v56, v41, v43, s46 bitop3:0x7e
 v_bitop3_b32 v55, v55, 1, v56 bitop3:0xc8
 v_cmp_ne_u32 vcc, 0, v55
 s_nop 3
 v_add_f32_dpp v48, v48, v48 row_ror:4 row_mask:0xf bank_mask:0xf
 v_add_f32_dpp v49, v49, v49 row_ror:4 row_mask:0xf bank_mask:0xf
 s_cbranch_vccnz Lr2_92
 v_add_f32_dpp v48, v48, v48 row_ror:8 row_mask:0xf bank_mask:0xf
 v_add_f32_dpp v49, v49, v49 row_ror:8 row_mask:0xf bank_mask:0xf
 v_cvt_pk_bf16_f32 v48, v48, v49
 buffer_store_dword v48, v52, s[20:23], s44 offen
Lb1_93:
 buffer_store_dword v59, v52, s[20:23], s45 offen
 v_cmp_gt_u32 vcc, s58, v1
 v_mov_b64 v[36:37], 0
 v_mov_b64 v[38:39], 0
 v_mov_b64 v[40:41], 0
 v_mov_b64 v[42:43], 0
 v_mov_b64 v[44:45], 0
 v_mov_b64 v[46:47], 0
 v_mov_b64 v[48:49], 0
 v_mov_b64 v[50:51], 0
 s_cmp_lg_u32 vcc_hi, 0
 s_cbranch_scc1 Lfw_95
Lfok_94:
 v_lshl_add_u32 v1, v3, 3, s68
 v_mov_b32 v6, s56
 v_cndmask_b32 v1, v6, v1, s[70:71]
 v_min_u32 v6, 16, v0
 v_lshlrev_b32 v6, 24, v6
 s_max_u32 s47, s36, 1
 v_add_u32 v2, -1, s47
 s_add_u32 m0, s42, 0
 s_nop 4
 buffer_load_dwordx4 v[12:15], v3, s[20:23], s43 offen offset:0 sc1
 s_nop 15
 s_nop 7
Lp2_96:
 buffer_load_dwordx4 v[12:15], v3, s[20:23], s43 offen offset:0 sc1
 s_waitcnt vmcnt(1)
 v_max3_u32 v55, v12, v13, v14
 v_max_u32 v55, v55, v15
 ds_write_b128 v3, v[12:15] offset:8192
 v_cmpx_eq_u32 vcc, -1, v55
 s_cbranch_execz LstepB_73
 buffer_load_dwordx4 v[12:15], v3, s[20:23], s43 offen offset:0 sc1
 s_waitcnt vmcnt(1)
 v_max3_u32 v55, v12, v13, v14
 v_max_u32 v55, v55, v15
 ds_write_b128 v3, v[12:15] offset:8192
 v_cmpx_eq_u32 vcc, -1, v55
 s_cbranch_execz LstepB_73
 buffer_load_dwordx4 v[12:15], v3, s[20:23], s43 offen offset:0 sc1
 s_waitcnt vmcnt(1)
 v_max3_u32 v55, v12, v13, v14
 v_max_u32 v55, v55, v15
 ds_write_b128 v3, v[12:15] offset:8192
 v_cmpx_eq_u32 vcc, -1, v55
 s_cbranch_execz LstepB_73
 s_sub_u32 s54, s54, 1
 s_cbranch_scc0 Lp2_96
 s_endpgm
Lw_83:
 s_waitcnt vmcnt(2)
 buffer_load_dwordx4 v[36:39], v3, s[20:23], s39 offen offset:0 sc1
 buffer_load_dwordx4 v[40:43], v3, s[20:23], s39 offen offset:1024 sc1
 s_xor_b32 s66, s66, 0x80000
 s_xor_b32 s41, s41, 0x80000
 s_xor_b32 s43, s43, 0x80000
 v_mov_b32 v47, 0x3f80
 v_cndmask_b32 v47, v47, 1.0, s[32:33]
 v_cndmask_b32 v44, 0, v47, s[24:25]
 v_cndmask_b32 v45, 0, v47, s[26:27]
 v_cndmask_b32 v46, 0, v47, s[28:29]
 v_cndmask_b32 v47, 0, v47, s[30:31]
 v_bfe_u32 v52, v3, 8, 2
 v_bfe_u32 v58, v3, 2, 4
 v_lshl_or_b32 v52, v52, 4, v58
 v_and_b32 v58, 0xc0, v3
 v_lshl_or_b32 v52, v58, 24, v52
 v_subrev_u32 v0, 0x20000, v0
 v_mov_b32 v59, -1
 v_add_u32 v54, s42, v3
 v_add_u32 v58, s69, v9
 ds_read_b64 v[64:65], v58 offset:19456
 v_mov_b32 v66, v2
 v_mov_b32 v67, v4
 v_mov_b64 v[68:69], 0
 v_mov_b64 v[70:71], 0
 ds_read_b128 v[20:23], v0 offset:24576
 ds_read_b128 v[24:27], v0 offset:28672
 ds_read_b128 v[28:31], v0 offset:32768
 ds_read_b128 v[32:35], v0 offset:36864
 s_nop 3
 buffer_load_dwordx4 v[12:15], v3, s[20:23], s39 offen offset:0 sc1
 buffer_load_dwordx4 v[16:19], v3, s[20:23], s39 offen offset:1024 sc1
 s_waitcnt vmcnt(3)
 v_mfma_f32_16x16x32_bf16 v[48:51], v[44:47], v[36:39], 0
 s_waitcnt vmcnt(2)
 v_mfma_f32_16x16x32_bf16 v[48:51], v[44:47], v[40:43], v[48:51]
 v_bitop3_b32 v55, v37, v39, s46 bitop3:0x7e
 v_bitop3_b32 v56, v41, v43, s46 bitop3:0x7e
 v_bitop3_b32 v55, v55, 1, v56 bitop3:0xc8
 v_cmp_ne_u32 vcc, 0, v55
 s_nop 3
 v_add_f32_dpp v48, v48, v48 row_ror:4 row_mask:0xf bank_mask:0xf
 v_add_f32_dpp v49, v49, v49 row_ror:4 row_mask:0xf bank_mask:0xf
 s_cbranch_vccnz Lr2_98
 v_add_f32_dpp v48, v48, v48 row_ror:8 row_mask:0xf bank_mask:0xf
 v_add_f32_dpp v49, v49, v49 row_ror:8 row_mask:0xf bank_mask:0xf
 v_cvt_pk_bf16_f32 v48, v48, v49
 buffer_store_dword v48, v52, s[20:23], s44 offen
Lb1_99:
 buffer_store_dword v59, v52, s[20:23], s45 offen
 v_cmp_gt_u32 vcc, s58, v1
 v_mov_b64 v[36:37], 0
 v_mov_b64 v[38:39], 0
 v_mov_b64 v[40:41], 0
 v_mov_b64 v[42:43], 0
 v_mov_b64 v[44:45], 0
 v_mov_b64 v[46:47], 0
 v_mov_b64 v[48:49], 0
 v_mov_b64 v[50:51], 0
 s_cmp_lg_u32 vcc_hi, 0
 s_cbranch_scc1 Lfw_101
Lfok_100:
 v_lshl_add_u32 v1, v3, 3, s68
 v_mov_b32 v6, s56
 v_cndmask_b32 v1, v6, v1, s[70:71]
 v_min_u32 v6, 16, v0
 v_lshlrev_b32 v6, 24, v6
 s_max_u32 s47, s36, 1
 v_add_u32 v2, -1, s47
 s_nop 15
 s_nop 0
 buffer_load_dwordx4 v[12:15], v3, s[20:23], s41 offen offset:0 sc1
 buffer_load_dwordx4 v[16:19], v3, s[20:23], s41 offen offset:1024 sc1
 s_nop 15
 s_nop 7
Lp2_102:
 buffer_load_dwordx4 v[12:15], v3, s[20:23], s41 offen offset:0 sc1
 buffer_load_dwordx4 v[16:19], v3, s[20:23], s41 offen offset:1024 sc1
 s_waitcnt vmcnt(2)
 v_max3_u32 v55, v12, v13, v14
 v_max3_u32 v55, v55, v15, v16
 v_max3_u32 v55, v55, v17, v18
 v_max_u32 v55, v55, v19
 ds_write_b128 v54, v[12:15] offset:0
 ds_write_b128 v54, v[16:19] offset:1024
 v_cmpx_eq_u32 vcc, -1, v55
 s_cbranch_execz Lstep_71
 buffer_load_dwordx4 v[12:15], v3, s[20:23], s41 offen offset:0 sc1
 buffer_load_dwordx4 v[16:19], v3, s[20:23], s41 offen offset:1024 sc1
 s_waitcnt vmcnt(2)
 v_max3_u32 v55, v12, v13, v14
 v_max3_u32 v55, v55, v15, v16
 v_max3_u32 v55, v55, v17, v18
 v_max_u32 v55, v55, v19
 ds_write_b128 v54, v[12:15] offset:0
 ds_write_b128 v54, v[16:19] offset:1024
 v_cmpx_eq_u32 vcc, -1, v55
 s_cbranch_execz Lstep_71
 buffer_load_dwordx4 v[12:15], v3, s[20:23], s41 offen offset:0 sc1
 buffer_load_dwordx4 v[16:19], v3, s[20:23], s41 offen offset:1024 sc1
 s_waitcnt vmcnt(2)
 v_max3_u32 v55, v12, v13, v14
 v_max3_u32 v55, v55, v15, v16
 v_max3_u32 v55, v55, v17, v18
 v_max_u32 v55, v55, v19
 ds_write_b128 v54, v[12:15] offset:0
 ds_write_b128 v54, v[16:19] offset:1024
 v_cmpx_eq_u32 vcc, -1, v55
 s_cbranch_execz Lstep_71
 s_sub_u32 s54, s54, 1
 s_cbranch_scc0 Lp2_102
 s_endpgm
LwH_82:
 v_bfe_u32 v53, v3, 8, 1
 v_bfe_u32 v58, v3, 9, 1
 v_lshl_or_b32 v53, v53, 1, v58
 v_bfe_u32 v58, v3, 5, 1
 v_lshl_or_b32 v53, v53, 1, v58
 v_and_b32 v58, 0xd0, v3
 v_lshlrev_b32 v58, 24, v58
 v_lshl_or_b32 v53, v53, 2, v58
 s_waitcnt vmcnt(3)
 s_nop 7
 buffer_load_dwordx4 v[20:23], v3, s[20:23], s40 offen offset:0 sc1
 buffer_load_dwordx4 v[24:27], v3, s[20:23], s40 offen offset:1024 sc1
 buffer_load_dwordx4 v[36:39], v3, s[20:23], s39 offen offset:0 sc1
 buffer_load_dwordx4 v[40:43], v3, s[20:23], s39 offen offset:1024 sc1
 s_xor_b32 s66, s66, 0x80000
 s_xor_b32 s41, s41, 0x80000
 s_xor_b32 s43, s43, 0x80000
 v_mov_b32 v47, 0x3f80
 v_cndmask_b32 v47, v47, 1.0, s[32:33]
 v_cndmask_b32 v44, 0, v47, s[24:25]
 v_cndmask_b32 v45, 0, v47, s[26:27]
 v_cndmask_b32 v46, 0, v47, s[28:29]
 v_cndmask_b32 v47, 0, v47, s[30:31]
 v_bfe_u32 v52, v3, 8, 2
 v_bfe_u32 v58, v3, 2, 4
 v_lshl_or_b32 v52, v52, 4, v58
 v_and_b32 v58, 0xc0, v3
 v_lshl_or_b32 v52, v58, 24, v52
 v_subrev_u32 v0, 0x20000, v0
 v_mov_b32 v59, -1
 v_add_u32 v54, s42, v3
 v_add_u32 v58, s69, v9
 ds_read_b64 v[64:65], v58 offset:19456
 v_mov_b32 v66, v2
 v_mov_b32 v67, v4
 v_mov_b64 v[68:69], 0
 v_mov_b64 v[70:71], 0
 s_waitcnt vmcnt(2)
 v_mfma_f32_16x16x32_bf16 v[28:31], v[44:47], v[20:23], 0
 v_mfma_f32_16x16x32_bf16 v[28:31], v[44:47], v[24:27], v[28:31]
 s_waitcnt vmcnt(1)
 v_mfma_f32_16x16x32_bf16 v[48:51], v[44:47], v[36:39], 0
 s_waitcnt vmcnt(0)
 v_mfma_f32_16x16x32_bf16 v[48:51], v[44:47], v[40:43], v[48:51]
 v_bitop3_b32 v55, v37, v39, s46 bitop3:0x7e
 v_bitop3_b32 v56, v41, v43, s46 bitop3:0x7e
 v_bitop3_b32 v57, v21, v23, s46 bitop3:0x7e
 v_or3_b32 v55, v55, v56, v57
 v_bitop3_b32 v56, v25, v27, s46 bitop3:0x7e
 v_bitop3_b32 v55, v55, 1, v56 bitop3:0xc8
 v_cmp_ne_u32 vcc, 0, v55
 v_add_f32_dpp v29, v29, v29 row_ror:4 row_mask:0xf bank_mask:0xf
 v_add_f32_dpp v48, v48, v48 row_ror:4 row_mask:0xf bank_mask:0xf
 v_add_f32_dpp v49, v49, v49 row_ror:4 row_mask:0xf bank_mask:0xf
 v_add_f32_dpp v29, v29, v29 row_ror:8 row_mask:0xf bank_mask:0xf
 v_add_f32_dpp v48, v48, v48 row_ror:8 row_mask:0xf bank_mask:0xf
 v_add_f32_dpp v49, v49, v49 row_ror:8 row_mask:0xf bank_mask:0xf
 s_cbranch_vccnz Lr1_103
 v_cvt_pk_bf16_f32 v48, v48, v49
 buffer_store_dword v48, v52, s[20:23], s44 offen
 v_mov_b32_dpp v30, v29 quad_perm:[1,0,3,2] row_mask:0xf bank_mask:0xf
 v_cvt_pk_bf16_f32 v29, v29, v30
 buffer_store_dword v29, v53, s[20:23], s65 offen
Lb1_104:
 buffer_store_dword v59, v52, s[20:23], s45 offen
 buffer_store_dword v59, v53, s[20:23], s66 offen
 v_cmp_gt_u32 vcc, s58, v1
 ds_read_b128 v[20:23], v0 offset:24576
 ds_read_b128 v[24:27], v0 offset:28672
 ds_read_b128 v[28:31], v0 offset:32768
 ds_read_b128 v[32:35], v0 offset:36864
 v_mov_b64 v[36:37], 0
 v_mov_b64 v[38:39], 0
 v_mov_b64 v[40:41], 0
 v_mov_b64 v[42:43], 0
 v_mov_b64 v[44:45], 0
 v_mov_b64 v[46:47], 0
 v_mov_b64 v[48:49], 0
 v_mov_b64 v[50:51], 0
 s_cmp_lg_u32 vcc_hi, 0
 s_cbranch_scc1 Lfw_106
Lfok_105:
 v_lshl_add_u32 v1, v3, 3, s68
 v_mov_b32 v6, s56
 v_cndmask_b32 v1, v6, v1, s[70:71]
 v_min_u32 v6, 16, v0
 v_lshlrev_b32 v6, 24, v6
 s_max_u32 s47, s36, 1
 v_add_u32 v2, -1, s47
 s_nop 10
 buffer_load_dwordx4 v[12:15], v3, s[20:23], s41 offen offset:0 sc1
 buffer_load_dwordx4 v[16:19], v3, s[20:23], s41 offen offset:1024 sc1
 s_nop 15
 s_nop 7
Lp2_107:
 buffer_load_dwordx4 v[12:15], v3, s[20:23], s41 offen offset:0 sc1
 buffer_load_dwordx4 v[16:19], v3, s[20:23], s41 offen offset:1024 sc1
 s_waitcnt vmcnt(2)
 v_max3_u32 v55, v12, v13, v14
 v_max3_u32 v55, v55, v15, v16
 v_max3_u32 v55, v55, v17, v18
 v_max_u32 v55, v55, v19
 ds_write_b128 v54, v[12:15] offset:0
 ds_write_b128 v54, v[16:19] offset:1024
 v_cmpx_eq_u32 vcc, -1, v55
 s_cbranch_execz Lstep_71
 buffer_load_dwordx4 v[12:15], v3, s[20:23], s41 offen offset:0 sc1
 buffer_load_dwordx4 v[16:19], v3, s[20:23], s41 offen offset:1024 sc1
 s_waitcnt vmcnt(2)
 v_max3_u32 v55, v12, v13, v14
 v_max3_u32 v55, v55, v15, v16
 v_max3_u32 v55, v55, v17, v18
 v_max_u32 v55, v55, v19
 ds_write_b128 v54, v[12:15] offset:0
 ds_write_b128 v54, v[16:19] offset:1024
 v_cmpx_eq_u32 vcc, -1, v55
 s_cbranch_execz Lstep_71
 buffer_load_dwordx4 v[12:15], v3, s[20:23], s41 offen offset:0 sc1
 buffer_load_dwordx4 v[16:19], v3, s[20:23], s41 offen offset:1024 sc1
 s_waitcnt vmcnt(2)
 v_max3_u32 v55, v12, v13, v14
 v_max3_u32 v55, v55, v15, v16
 v_max3_u32 v55, v55, v17, v18
 v_max_u32 v55, v55, v19
 ds_write_b128 v54, v[12:15] offset:0
 ds_write_b128 v54, v[16:19] offset:1024
 v_cmpx_eq_u32 vcc, -1, v55
 s_cbranch_execz Lstep_71
 s_sub_u32 s54, s54, 1
 s_cbranch_scc0 Lp2_107
 s_endpgm
Lr1_103:
 s_mov_b64 exec, vcc
Lrt_108:
 buffer_load_dwordx4 v[20:23], v3, s[20:23], s40 offen offset:0 sc1
 buffer_load_dwordx4 v[24:27], v3, s[20:23], s40 offen offset:1024 sc1
 buffer_load_dwordx4 v[36:39], v3, s[20:23], s39 offen offset:0 sc1
 buffer_load_dwordx4 v[40:43], v3, s[20:23], s39 offen offset:1024 sc1
 s_waitcnt vmcnt(4)
 v_bitop3_b32 v55, v37, v39, s46 bitop3:0x7e
 v_bitop3_b32 v56, v41, v43, s46 bitop3:0x7e
 v_bitop3_b32 v57, v21, v23, s46 bitop3:0x7e
 v_or3_b32 v55, v55, v56, v57
 v_bitop3_b32 v56, v25, v27, s46 bitop3:0x7e
 v_bitop3_b32 v55, v55, 1, v56 bitop3:0xc8
 v_cmpx_ne_u32 vcc, 0, v55
 s_cbranch_execz Lrte_109
 buffer_load_dwordx4 v[20:23], v3, s[20:23], s40 offen offset:0 sc1
 buffer_load_dwordx4 v[24:27], v3, s[20:23], s40 offen offset:1024 sc1
 buffer_load_dwordx4 v[36:39], v3, s[20:23], s39 offen offset:0 sc1
 buffer_load_dwordx4 v[40:43], v3, s[20:23], s39 offen offset:1024 sc1
 s_waitcnt vmcnt(4)
 v_bitop3_b32 v55, v37, v39, s46 bitop3:0x7e
 v_bitop3_b32 v56, v41, v43, s46 bitop3:0x7e
 v_bitop3_b32 v57, v21, v23, s46 bitop3:0x7e
 v_or3_b32 v55, v55, v56, v57
 v_bitop3_b32 v56, v25, v27, s46 bitop3:0x7e
 v_bitop3_b32 v55, v55, 1, v56 bitop3:0xc8
 v_cmpx_ne_u32 vcc, 0, v55
 s_cbranch_execz Lrte_109
 buffer_load_dwordx4 v[20:23], v3, s[20:23], s40 offen offset:0 sc1
 buffer_load_dwordx4 v[24:27], v3, s[20:23], s40 offen offset:1024 sc1
 buffer_load_dwordx4 v[36:39], v3, s[20:23], s39 offen offset:0 sc1
 buffer_load_dwordx4 v[40:43], v3, s[20:23], s39 offen offset:1024 sc1
 s_waitcnt vmcnt(4)
 v_bitop3_b32 v55, v37, v39, s46 bitop3:0x7e
 v_bitop3_b32 v56, v41, v43, s46 bitop3:0x7e
 v_bitop3_b32 v57, v21, v23, s46 bitop3:0x7e
 v_or3_b32 v55, v55, v56, v57
 v_bitop3_b32 v56, v25, v27, s46 bitop3:0x7e
 v_bitop3_b32 v55, v55, 1, v56 bitop3:0xc8
 v_cmpx_ne_u32 vcc, 0, v55
 s_cbranch_execz Lrte_109
 s_sub_u32 s54, s54, 1
 s_cbranch_scc0 Lrt_108
 s_endpgm
Lrte_109:
 s_mov_b64 exec, -1
 s_nop 2
 v_mfma_f32_16x16x32_bf16 v[28:31], v[44:47], v[20:23], 0
 v_mfma_f32_16x16x32_bf16 v[28:31], v[44:47], v[24:27], v[28:31]
 v_mfma_f32_16x16x32_bf16 v[48:51], v[44:47], v[36:39], 0
 v_mfma_f32_16x16x32_bf16 v[48:51], v[44:47], v[40:43], v[48:51]
 s_nop 6
 v_add_f32_dpp v29, v29, v29 row_ror:4 row_mask:0xf bank_mask:0xf
 v_add_f32_dpp v48, v48, v48 row_ror:4 row_mask:0xf bank_mask:0xf
 v_add_f32_dpp v49, v49, v49 row_ror:4 row_mask:0xf bank_mask:0xf
 v_add_f32_dpp v29, v29, v29 row_ror:8 row_mask:0xf bank_mask:0xf
 v_add_f32_dpp v48, v48, v48 row_ror:8 row_mask:0xf bank_mask:0xf
 v_add_f32_dpp v49, v49, v49 row_ror:8 row_mask:0xf bank_mask:0xf
 v_cvt_pk_bf16_f32 v48, v48, v49
 buffer_store_dword v48, v52, s[20:23], s44 offen
 v_mov_b32_dpp v30, v29 quad_perm:[1,0,3,2] row_mask:0xf bank_mask:0xf
 v_cvt_pk_bf16_f32 v29, v29, v30
 buffer_store_dword v29, v53, s[20:23], s65 offen
 s_waitcnt vmcnt(2)
 s_branch Lb1_104
Lsure_74:
 s_mov_b32 s50, 0
 s_waitcnt lgkmcnt(0)
 buffer_load_dwordx4 v[12:15], v3, s[20:23], s41 offen offset:0 sc1
 buffer_load_dwordx4 v[16:19], v3, s[20:23], s41 offen offset:1024 sc1
 s_sub_u32 s54, s54, 1
 s_cbranch_scc1 Lfail_72
 s_waitcnt vmcnt(0)
 v_max3_u32 v4, v12, v13, v14
 v_max3_u32 v4, v4, v15, v16
 v_max3_u32 v4, v4, v17, v18
 v_max_u32 v4, v4, v19
 v_cmp_eq_u32 vcc, -1, v4
 s_cbranch_vccnz Lsure_74
 s_branch Lsureb_75
Lfx_76:
 s_add_u32 s47, s43, -4096
 buffer_load_dwordx4 v[60:63], v3, s[20:23], s47 offen offset:0 sc1
 buffer_load_dwordx4 v[52:55], v3, s[20:23], s47 offen offset:1024 sc1
 s_sub_u32 s54, s54, 1
 s_cbranch_scc1 Lfail_72
 s_waitcnt vmcnt(0)
 v_max3_u32 v4, v60, v61, v62
 v_max3_u32 v4, v4, v63, v52
 v_max3_u32 v4, v4, v53, v54
 v_max_u32 v4, v4, v55
 v_cmp_eq_u32 vcc, -1, v4
 s_cbranch_vccnz Lfx_76
 ds_write_b128 v3, v[60:63] offset:4096
 s_waitcnt lgkmcnt(0)
 s_branch Lfxb_77
Lfx_78:
 s_add_u32 s47, s43, -2048
 buffer_load_dwordx4 v[56:59], v3, s[20:23], s47 offen offset:0 sc1
 buffer_load_dwordx4 v[60:63], v3, s[20:23], s47 offen offset:1024 sc1
 s_sub_u32 s54, s54, 1
 s_cbranch_scc1 Lfail_72
 s_waitcnt vmcnt(0)
 v_max3_u32 v4, v56, v57, v58
 v_max3_u32 v4, v4, v59, v60
 v_max3_u32 v4, v4, v61, v62
 v_max_u32 v4, v4, v63
 v_cmp_eq_u32 vcc, -1, v4
 s_cbranch_vccnz Lfx_78
 ds_write_b128 v3, v[56:59] offset:6144
 s_waitcnt lgkmcnt(0)
 s_branch Lfxb_79
Lmx_80:
 s_waitcnt lgkmcnt(0)
 ds_read_b128 v[36:39], v11 offset:17408
 ds_read_b128 v[40:43], v11 offset:17920
 ds_read_b128 v[44:47], v11 offset:18432
 ds_read_b128 v[48:51], v11 offset:18944
 v_mov_b64 v[28:29], 0
 v_mov_b64 v[30:31], 0
 ds_read_b128 v[52:55], v3 offset:9216
 ds_read_b128 v[56:59], v3 offset:10240
 s_waitcnt lgkmcnt(0)
 v_mfma_f32_16x16x32_bf16 v[20:23], v[52:55], v[36:39], 0
 v_mfma_f32_16x16x32_bf16 v[24:27], v[56:59], v[36:39], 0
 ds_read_b128 v[52:55], v3 offset:11264
 ds_read_b128 v[56:59], v3 offset:12288
 s_waitcnt lgkmcnt(0)
 v_mfma_f32_16x16x32_bf16 v[20:23], v[52:55], v[40:43], v[20:23]
 v_mfma_f32_16x16x32_bf16 v[24:27], v[56:59], v[40:43], v[24:27]
 ds_read_b128 v[52:55], v3 offset:13312
 ds_read_b128 v[56:59], v3 offset:14336
 s_waitcnt lgkmcnt(0)
 v_mfma_f32_16x16x32_bf16 v[20:23], v[52:55], v[44:47], v[20:23]
 v_mfma_f32_16x16x32_bf16 v[24:27], v[56:59], v[44:47], v[24:27]
 ds_read_b128 v[52:55], v3 offset:15360
 ds_read_b128 v[56:59], v3 offset:16384
 s_waitcnt lgkmcnt(0)
 v_mfma_f32_16x16x32_bf16 v[20:23], v[52:55], v[48:51], v[20:23]
 v_mfma_f32_16x16x32_bf16 v[24:27], v[56:59], v[48:51], v[24:27]
 ds_read_b128 v[52:55], v9 offset:19456
 ds_read_b128 v[56:59], v9 offset:21504
 s_waitcnt lgkmcnt(0)
 v_smfmac_f32_16x16x64_bf16 v[28:31], v[52:55], v[36:43], v5
 v_smfmac_f32_16x16x64_bf16 v[28:31], v[56:59], v[44:51], v5
 ds_read_b128 v[36:39], v0 offset:32768
 ds_read_b128 v[40:43], v0 offset:36864
 ds_read_b128 v[44:47], v0 offset:40960
 ds_read_b128 v[48:51], v0 offset:45056
 v_mov_b64 v[32:33], s[34:35]
 v_mov_b64 v[34:35], s[34:35]
 s_nop 1
 v_add_f32 v28, v28, v30
 v_add_f32 v29, v29, v31
 v_mul_f32 v28, s55, v28
 v_mul_f32 v29, s55, v29
 v_max_f32 v30, v28, v29
 v_cndmask_b32 v28, v28, v29, s[48:49]
 v_max3_f32 v30, v30, v20, v21
 v_max3_f32 v30, v30, v22, v23
 v_max3_f32 v30, v30, v24, v25
 v_max3_f32 v31, v30, v26, v27
 v_max3_f32 v29, v30, v26, v27
 v_cndmask_b32 v20, v20, v24, s[48:49]
 v_cndmask_b32 v21, v21, v25, s[48:49]
 v_permlane16_swap_b32 v31, v29
 v_max_f32 v30, v31, v29
 v_max_f32 v6, v31, v29
 v_cndmask_b32 v22, v22, v26, s[48:49]
 v_cndmask_b32 v23, v23, v27, s[48:49]
 v_permlane32_swap_b32 v30, v6
 v_max_f32 v30, v30, v6
 v_sub_f32 v28, v28, v30
 v_sub_f32 v20, v20, v30
 v_sub_f32 v21, v21, v30
 v_sub_f32 v22, v22, v30
 v_sub_f32 v23, v23, v30
 v_exp_f32 v28, v28
 v_exp_f32 v20, v20
 v_exp_f32 v21, v21
 v_exp_f32 v22, v22
 v_exp_f32 v23, v23
 v_cndmask_b32 v29, 0, v28, s[48:49]
 v_cndmask_b32 v28, v28, 0, s[48:49]
 v_cvt_pk_bf16_f32 v6, v28, v29
 v_cvt_pk_bf16_f32 v30, v20, v21
 v_cvt_pk_bf16_f32 v31, v22, v23
 v_mfma_f32_16x16x16_bf16 v[60:63], v[6:7], v[32:33], 0
 v_mfma_f32_16x16x16_bf16 v[52:55], v[6:7], v[2:3], 0
 v_mfma_f32_16x16x16_bf16 v[56:59], v[6:7], v[4:5], 0
 v_smfmac_f32_16x16x32_bf16 v[60:63], v[30:31], v[32:35], v5
 v_smfmac_f32_16x16x32_bf16 v[52:55], v[30:31], v[12:15], v5
 v_smfmac_f32_16x16x32_bf16 v[56:59], v[30:31], v[16:19], v5
 s_nop 0
 v_add_f32 v60, v60, v62
 v_add_f32 v61, v61, v63
 v_rcp_f32 v60, v60
 v_rcp_f32 v61, v61
 v_add_f32 v52, v52, v54
 v_add_f32 v53, v53, v55
 v_mul_f32 v52, v52, v60
 v_mul_f32 v53, v53, v61
 v_add_f32 v56, v56, v58
 v_add_f32 v57, v57, v59
 v_mul_f32 v56, v56, v60
 v_mul_f32 v57, v57, v61
 v_cvt_pk_bf16_f32 v52, v52, v56
 v_cvt_pk_bf16_f32 v53, v53, v57
 ds_write2_b32 v8, v52, v53 offset0:128 offset1:144
 v_mov_b64 v[20:21], 0
 v_mov_b64 v[22:23], 0
 v_mov_b64 v[24:25], 0
 v_mov_b64 v[26:27], 0
 v_mov_b64 v[28:29], 0
 v_mov_b64 v[30:31], 0
 v_mov_b64 v[32:33], 0
 v_mov_b64 v[34:35], 0
 s_waitcnt lgkmcnt(0)
 s_branch Lmxb_81
Lr2_86:
 s_waitcnt vmcnt(1)
 v_mfma_f32_16x16x32_bf16 v[48:51], v[44:47], v[12:15], 0
 s_waitcnt vmcnt(0)
 v_mfma_f32_16x16x32_bf16 v[48:51], v[44:47], v[16:19], v[48:51]
 v_bitop3_b32 v55, v13, v15, s46 bitop3:0x7e
 v_bitop3_b32 v56, v17, v19, s46 bitop3:0x7e
 v_bitop3_b32 v55, v55, 1, v56 bitop3:0xc8
 v_cmp_ne_u32 vcc, 0, v55
 s_nop 3
 v_add_f32_dpp v48, v48, v48 row_ror:4 row_mask:0xf bank_mask:0xf
 v_add_f32_dpp v49, v49, v49 row_ror:4 row_mask:0xf bank_mask:0xf
 s_cbranch_vccnz Lr1_85
 v_add_f32_dpp v48, v48, v48 row_ror:8 row_mask:0xf bank_mask:0xf
 v_add_f32_dpp v49, v49, v49 row_ror:8 row_mask:0xf bank_mask:0xf
 v_cvt_pk_bf16_f32 v48, v48, v49
 buffer_store_dword v48, v52, s[20:23], s44 offen
 s_branch Lb1_87
Lr1_85:
 s_mov_b64 exec, vcc
Lrt_110:
 buffer_load_dwordx4 v[12:15], v3, s[20:23], s39 offen offset:0 sc1
 buffer_load_dwordx4 v[16:19], v3, s[20:23], s39 offen offset:1024 sc1
 s_waitcnt vmcnt(2)
 v_bitop3_b32 v55, v13, v15, s46 bitop3:0x7e
 v_bitop3_b32 v56, v17, v19, s46 bitop3:0x7e
 v_bitop3_b32 v55, v55, 1, v56 bitop3:0xc8
 v_cmpx_ne_u32 vcc, 0, v55
 s_cbranch_execz Lrte_111
 buffer_load_dwordx4 v[12:15], v3, s[20:23], s39 offen offset:0 sc1
 buffer_load_dwordx4 v[16:19], v3, s[20:23], s39 offen offset:1024 sc1
 s_waitcnt vmcnt(2)
 v_bitop3_b32 v55, v13, v15, s46 bitop3:0x7e
 v_bitop3_b32 v56, v17, v19, s46 bitop3:0x7e
 v_bitop3_b32 v55, v55, 1, v56 bitop3:0xc8
 v_cmpx_ne_u32 vcc, 0, v55
 s_cbranch_execz Lrte_111
 buffer_load_dwordx4 v[12:15], v3, s[20:23], s39 offen offset:0 sc1
 buffer_load_dwordx4 v[16:19], v3, s[20:23], s39 offen offset:1024 sc1
 s_waitcnt vmcnt(2)
 v_bitop3_b32 v55, v13, v15, s46 bitop3:0x7e
 v_bitop3_b32 v56, v17, v19, s46 bitop3:0x7e
 v_bitop3_b32 v55, v55, 1, v56 bitop3:0xc8
 v_cmpx_ne_u32 vcc, 0, v55
 s_cbranch_execz Lrte_111
 s_sub_u32 s54, s54, 1
 s_cbranch_scc0 Lrt_110
 s_endpgm
Lrte_111:
 s_mov_b64 exec, -1
 s_mov_b32 s50, 0
 s_nop 1
 v_mfma_f32_16x16x32_bf16 v[48:51], v[44:47], v[12:15], 0
 v_mfma_f32_16x16x32_bf16 v[48:51], v[44:47], v[16:19], v[48:51]
 s_nop 7
 v_add_f32_dpp v48, v48, v48 row_ror:4 row_mask:0xf bank_mask:0xf
 v_add_f32_dpp v49, v49, v49 row_ror:4 row_mask:0xf bank_mask:0xf
 s_nop 0
 v_add_f32_dpp v48, v48, v48 row_ror:8 row_mask:0xf bank_mask:0xf
 v_add_f32_dpp v49, v49, v49 row_ror:8 row_mask:0xf bank_mask:0xf
 v_cvt_pk_bf16_f32 v48, v48, v49
 buffer_store_dword v48, v52, s[20:23], s44 offen
 s_branch Lb1_87
Lr2_92:
 s_waitcnt vmcnt(1)
 v_mfma_f32_16x16x32_bf16 v[48:51], v[44:47], v[12:15], 0
 s_waitcnt vmcnt(0)
 v_mfma_f32_16x16x32_bf16 v[48:51], v[44:47], v[16:19], v[48:51]
 v_bitop3_b32 v55, v13, v15, s46 bitop3:0x7e
 v_bitop3_b32 v56, v17, v19, s46 bitop3:0x7e
 v_bitop3_b32 v55, v55, 1, v56 bitop3:0xc8
 v_cmp_ne_u32 vcc, 0, v55
 s_nop 3
 v_add_f32_dpp v48, v48, v48 row_ror:4 row_mask:0xf bank_mask:0xf
 v_add_f32_dpp v49, v49, v49 row_ror:4 row_mask:0xf bank_mask:0xf
 s_cbranch_vccnz Lr1_91
 v_add_f32_dpp v48, v48, v48 row_ror:8 row_mask:0xf bank_mask:0xf
 v_add_f32_dpp v49, v49, v49 row_ror:8 row_mask:0xf bank_mask:0xf
 v_cvt_pk_bf16_f32 v48, v48, v49
 buffer_store_dword v48, v52, s[20:23], s44 offen
 s_branch Lb1_93
Lr1_91:
 s_mov_b64 exec, vcc
Lrt_112:
 buffer_load_dwordx4 v[12:15], v3, s[20:23], s39 offen offset:0 sc1
 buffer_load_dwordx4 v[16:19], v3, s[20:23], s39 offen offset:1024 sc1
 s_waitcnt vmcnt(2)
 v_bitop3_b32 v55, v13, v15, s46 bitop3:0x7e
 v_bitop3_b32 v56, v17, v19, s46 bitop3:0x7e
 v_bitop3_b32 v55, v55, 1, v56 bitop3:0xc8
 v_cmpx_ne_u32 vcc, 0, v55
 s_cbranch_execz Lrte_113
 buffer_load_dwordx4 v[12:15], v3, s[20:23], s39 offen offset:0 sc1
 buffer_load_dwordx4 v[16:19], v3, s[20:23], s39 offen offset:1024 sc1
 s_waitcnt vmcnt(2)
 v_bitop3_b32 v55, v13, v15, s46 bitop3:0x7e
 v_bitop3_b32 v56, v17, v19, s46 bitop3:0x7e
 v_bitop3_b32 v55, v55, 1, v56 bitop3:0xc8
 v_cmpx_ne_u32 vcc, 0, v55
 s_cbranch_execz Lrte_113
 buffer_load_dwordx4 v[12:15], v3, s[20:23], s39 offen offset:0 sc1
 buffer_load_dwordx4 v[16:19], v3, s[20:23], s39 offen offset:1024 sc1
 s_waitcnt vmcnt(2)
 v_bitop3_b32 v55, v13, v15, s46 bitop3:0x7e
 v_bitop3_b32 v56, v17, v19, s46 bitop3:0x7e
 v_bitop3_b32 v55, v55, 1, v56 bitop3:0xc8
 v_cmpx_ne_u32 vcc, 0, v55
 s_cbranch_execz Lrte_113
 s_sub_u32 s54, s54, 1
 s_cbranch_scc0 Lrt_112
 s_endpgm
Lrte_113:
 s_mov_b64 exec, -1
 s_mov_b32 s50, 0
 s_nop 1
 v_mfma_f32_16x16x32_bf16 v[48:51], v[44:47], v[12:15], 0
 v_mfma_f32_16x16x32_bf16 v[48:51], v[44:47], v[16:19], v[48:51]
 s_nop 7
 v_add_f32_dpp v48, v48, v48 row_ror:4 row_mask:0xf bank_mask:0xf
 v_add_f32_dpp v49, v49, v49 row_ror:4 row_mask:0xf bank_mask:0xf
 s_nop 0
 v_add_f32_dpp v48, v48, v48 row_ror:8 row_mask:0xf bank_mask:0xf
 v_add_f32_dpp v49, v49, v49 row_ror:8 row_mask:0xf bank_mask:0xf
 v_cvt_pk_bf16_f32 v48, v48, v49
 buffer_store_dword v48, v52, s[20:23], s44 offen
 s_branch Lb1_93
Lr2_98:
 s_waitcnt vmcnt(1)
 v_mfma_f32_16x16x32_bf16 v[48:51], v[44:47], v[12:15], 0
 s_waitcnt vmcnt(0)
 v_mfma_f32_16x16x32_bf16 v[48:51], v[44:47], v[16:19], v[48:51]
 v_bitop3_b32 v55, v13, v15, s46 bitop3:0x7e
 v_bitop3_b32 v56, v17, v19, s46 bitop3:0x7e
 v_bitop3_b32 v55, v55, 1, v56 bitop3:0xc8
 v_cmp_ne_u32 vcc, 0, v55
 s_nop 3
 v_add_f32_dpp v48, v48, v48 row_ror:4 row_mask:0xf bank_mask:0xf
 v_add_f32_dpp v49, v49, v49 row_ror:4 row_mask:0xf bank_mask:0xf
 s_cbranch_vccnz Lr1_97
 v_add_f32_dpp v48, v48, v48 row_ror:8 row_mask:0xf bank_mask:0xf
 v_add_f32_dpp v49, v49, v49 row_ror:8 row_mask:0xf bank_mask:0xf
 v_cvt_pk_bf16_f32 v48, v48, v49
 buffer_store_dword v48, v52, s[20:23], s44 offen
 s_branch Lb1_99
Lr1_97:
 s_mov_b64 exec, vcc
Lrt_114:
 buffer_load_dwordx4 v[12:15], v3, s[20:23], s39 offen offset:0 sc1
 buffer_load_dwordx4 v[16:19], v3, s[20:23], s39 offen offset:1024 sc1
 s_waitcnt vmcnt(2)
 v_bitop3_b32 v55, v13, v15, s46 bitop3:0x7e
 v_bitop3_b32 v56, v17, v19, s46 bitop3:0x7e
 v_bitop3_b32 v55, v55, 1, v56 bitop3:0xc8
 v_cmpx_ne_u32 vcc, 0, v55
 s_cbranch_execz Lrte_115
 buffer_load_dwordx4 v[12:15], v3, s[20:23], s39 offen offset:0 sc1
 buffer_load_dwordx4 v[16:19], v3, s[20:23], s39 offen offset:1024 sc1
 s_waitcnt vmcnt(2)
 v_bitop3_b32 v55, v13, v15, s46 bitop3:0x7e
 v_bitop3_b32 v56, v17, v19, s46 bitop3:0x7e
 v_bitop3_b32 v55, v55, 1, v56 bitop3:0xc8
 v_cmpx_ne_u32 vcc, 0, v55
 s_cbranch_execz Lrte_115
 buffer_load_dwordx4 v[12:15], v3, s[20:23], s39 offen offset:0 sc1
 buffer_load_dwordx4 v[16:19], v3, s[20:23], s39 offen offset:1024 sc1
 s_waitcnt vmcnt(2)
 v_bitop3_b32 v55, v13, v15, s46 bitop3:0x7e
 v_bitop3_b32 v56, v17, v19, s46 bitop3:0x7e
 v_bitop3_b32 v55, v55, 1, v56 bitop3:0xc8
 v_cmpx_ne_u32 vcc, 0, v55
 s_cbranch_execz Lrte_115
 s_sub_u32 s54, s54, 1
 s_cbranch_scc0 Lrt_114
 s_endpgm
Lrte_115:
 s_mov_b64 exec, -1
 s_mov_b32 s50, 0
 s_nop 1
 v_mfma_f32_16x16x32_bf16 v[48:51], v[44:47], v[12:15], 0
 v_mfma_f32_16x16x32_bf16 v[48:51], v[44:47], v[16:19], v[48:51]
 s_nop 7
 v_add_f32_dpp v48, v48, v48 row_ror:4 row_mask:0xf bank_mask:0xf
 v_add_f32_dpp v49, v49, v49 row_ror:4 row_mask:0xf bank_mask:0xf
 s_nop 0
 v_add_f32_dpp v48, v48, v48 row_ror:8 row_mask:0xf bank_mask:0xf
 v_add_f32_dpp v49, v49, v49 row_ror:8 row_mask:0xf bank_mask:0xf
 v_cvt_pk_bf16_f32 v48, v48, v49
 buffer_store_dword v48, v52, s[20:23], s44 offen
 s_branch Lb1_99
Lfw_89:
Lpb_116:
 buffer_load_dword v1, v7, s[20:23], s56 offen sc1
 s_waitcnt vmcnt(0)
 v_cmp_le_u32 vcc, s58, v1
 s_cbranch_vccnz Lpbok_117
 s_sub_u32 s54, s54, 1
 s_cbranch_scc0 Lpb_116
 s_endpgm
Lpbok_117:
 s_branch Lfok_88
Lfw_95:
Lpb_118:
 buffer_load_dword v1, v7, s[20:23], s56 offen sc1
 s_waitcnt vmcnt(0)
 v_cmp_le_u32 vcc, s58, v1
 s_cbranch_vccnz Lpbok_119
 s_sub_u32 s54, s54, 1
 s_cbranch_scc0 Lpb_118
 s_endpgm
Lpbok_119:
 s_branch Lfok_94
Lfw_101:
Lpb_120:
 buffer_load_dword v1, v7, s[20:23], s56 offen sc1
 s_waitcnt vmcnt(0)
 v_cmp_le_u32 vcc, s58, v1
 s_cbranch_vccnz Lpbok_121
 s_sub_u32 s54, s54, 1
 s_cbranch_scc0 Lpb_120
 s_endpgm
Lpbok_121:
 s_branch Lfok_100
Lfw_106:
Lpb_122:
 buffer_load_dword v1, v7, s[20:23], s56 offen sc1
 s_waitcnt vmcnt(0)
 v_cmp_le_u32 vcc, s58, v1
 s_cbranch_vccnz Lpbok_123
 s_sub_u32 s54, s54, 1
 s_cbranch_scc0 Lpb_122
 s_endpgm
Lpbok_123:
 s_branch Lfok_105
Lfail_72:
 s_endpgm
Lslow_69:
 s_branch Lstep_124
 .p2align 3
LstepB_126:
 s_mov_b64 exec, -1
 s_cmp_lg_u32 s50, 0
 s_cbranch_scc1 Lsure_127
Lsureb_128:
 buffer_load_dwordx4 v3, s[20:23], s41 offen offset:0 sc1 lds
 buffer_load_dwordx4 v3, s[20:23], s41 offen offset:1024 sc1 lds
Lstep_124:
 s_mov_b64 exec, -1
 s_waitcnt lgkmcnt(0)
 buffer_load_dwordx4 v[12:15], v3, s[20:23], s59 offen offset:0 sc1
 buffer_load_dwordx4 v[16:19], v3, s[20:23], s59 offen offset:1024 sc1
 s_barrier
 ds_read_b128 v[52:55], v3 offset:8192
 ds_read_b128 v[56:59], v3 offset:0
 ds_read_b128 v[60:63], v3 offset:1024
 buffer_store_dwordx4 v[64:67], v0, s[20:23], s38 offen sc1
 s_waitcnt lgkmcnt(2)
 v_smfmac_f32_16x16x64_bf16 v[36:39], v[52:55], a[136:143], v5
 v_smfmac_f32_16x16x64_bf16 v[40:43], v[52:55], a[144:151], v5
 buffer_store_dword v2, v6, s[20:23], s57 offen sc1
 v_smfmac_f32_16x16x64_bf16 v[44:47], v[52:55], a[152:159], v5
 s_waitcnt lgkmcnt(1)
 v_smfmac_f32_16x16x64_bf16 v[48:51], v[52:55], v[20:27], v5
 buffer_load_dword v1, v1, s[20:23], 0 offen sc1
 v_smfmac_f32_16x16x64_bf16 v[36:39], v[56:59], v[72:79], v5
 ds_read_b128 v[20:23], v0 offset:40960
 v_mov_b64 v[64:65], 0
 v_smfmac_f32_16x16x64_bf16 v[40:43], v[56:59], v[80:87], v5
 ds_read_b128 v[24:27], v0 offset:45056
 v_mov_b64 v[66:67], 0
 v_smfmac_f32_16x16x64_bf16 v[44:47], v[56:59], v[88:95], v5
 ds_read_b128 v[52:55], v3 offset:2048
 s_waitcnt lgkmcnt(3)
 v_smfmac_f32_16x16x64_bf16 v[48:51], v[56:59], v[28:35], v5
 v_smfmac_f32_16x16x64_bf16 v[36:39], v[60:63], v[112:119], v5
 ds_read_b128 v[28:31], v0 offset:49152
 v_smfmac_f32_16x16x64_bf16 v[40:43], v[60:63], v[120:127], v5
 ds_read_b128 v[32:35], v0 offset:53248
 v_smfmac_f32_16x16x64_bf16 v[44:47], v[60:63], v[128:135], v5
 ds_read_b128 v[56:59], v3 offset:3072
 v_smfmac_f32_16x16x64_bf16 v[64:67], v[60:63], v[136:143], v5
 s_waitcnt vmcnt(5)
 v_smfmac_f32_16x16x64_bf16 v[68:71], v[60:63], v[144:151], v5
 s_waitcnt lgkmcnt(3)
 v_smfmac_f32_16x16x64_bf16 v[48:51], v[60:63], v[20:27], v5
 s_barrier
 v_smfmac_f32_16x16x64_bf16 v[36:39], v[52:55], v[152:159], v5
 ds_read_b128 v[20:23], v0 offset:57344
 v_smfmac_f32_16x16x64_bf16 v[40:43], v[52:55], v[160:167], v5
 ds_read_b128 v[24:27], v0 offset:61440
 v_smfmac_f32_16x16x64_bf16 v[44:47], v[52:55], v[168:175], v5
 ds_read_b128 v[60:63], v3 offset:4096
 v_smfmac_f32_16x16x64_bf16 v[64:67], v[52:55], v[176:183], v5
 v_smfmac_f32_16x16x64_bf16 v[68:71], v[52:55], v[184:191], v5
 s_waitcnt lgkmcnt(3)
 v_add_u32 v0, 0x10000, v0
 v_smfmac_f32_16x16x64_bf16 v[48:51], v[52:55], v[28:35], v5
 ds_read_b128 v[52:55], v3 offset:5120
 v_smfmac_f32_16x16x64_bf16 v[36:39], v[56:59], v[192:199], v5
 ds_read_b128 v[28:31], v0 offset:0
 v_smfmac_f32_16x16x64_bf16 v[40:43], v[56:59], v[200:207], v5
 ds_read_b128 v[32:35], v0 offset:4096
 v_smfmac_f32_16x16x64_bf16 v[44:47], v[56:59], v[208:215], v5
 v_smfmac_f32_16x16x64_bf16 v[64:67], v[56:59], v[216:223], v5
 s_waitcnt lgkmcnt(2)
 v_max3_u32 v4, v60, v61, v62
 v_max3_u32 v4, v4, v63, v52
 v_max3_u32 v4, v4, v53, v54
 v_max_u32 v4, v4, v55
 v_cmp_eq_u32 vcc, -1, v4
 v_smfmac_f32_16x16x64_bf16 v[68:71], v[56:59], v[224:231], v5
 v_smfmac_f32_16x16x64_bf16 v[48:51], v[56:59], v[20:27], v5
 ds_read_b128 v[56:59], v3 offset:6144
 s_cbranch_vccnz Lfx_129
Lfxb_130:
 v_smfmac_f32_16x16x64_bf16 v[36:39], v[60:63], v[232:239], v5
 ds_read_b128 v[20:23], v0 offset:8192
 v_smfmac_f32_16x16x64_bf16 v[40:43], v[60:63], v[240:247], v5
 ds_read_b128 v[24:27], v0 offset:12288
 v_smfmac_f32_16x16x64_bf16 v[44:47], v[60:63], v[248:255], v5
 s_waitcnt lgkmcnt(3)
 v_smfmac_f32_16x16x64_bf16 v[48:51], v[60:63], v[28:35], v5
 ds_read_b128 v[60:63], v3 offset:7168
 v_smfmac_f32_16x16x64_bf16 v[36:39], v[52:55], a[16:23], v5
 ds_read_b128 v[28:31], v0 offset:16384
 v_smfmac_f32_16x16x64_bf16 v[40:43], v[52:55], a[24:31], v5
 ds_read_b128 v[32:35], v0 offset:20480
 v_smfmac_f32_16x16x64_bf16 v[44:47], v[52:55], a[32:39], v5
 s_waitcnt lgkmcnt(3)
 v_smfmac_f32_16x16x64_bf16 v[48:51], v[52:55], v[20:27], v5
 s_waitcnt lgkmcnt(2)
 v_max3_u32 v4, v56, v57, v58
 v_max3_u32 v4, v4, v59, v60
 v_max3_u32 v4, v4, v61, v62
 v_max_u32 v4, v4, v63
 v_cmp_eq_u32 vcc, -1, v4
 v_smfmac_f32_16x16x64_bf16 v[64:67], v[52:55], a[40:47], v5
 ds_read_b128 v[20:23], v0 offset:24576
 v_smfmac_f32_16x16x64_bf16 v[68:71], v[52:55], a[48:55], v5
 s_cbranch_vccnz Lfx_131
Lfxb_132:
 v_smfmac_f32_16x16x64_bf16 v[36:39], v[56:59], a[56:63], v5
 ds_read_b128 v[24:27], v0 offset:28672
 v_smfmac_f32_16x16x64_bf16 v[40:43], v[56:59], a[64:71], v5
 ds_read_b128 v[52:55], v3 offset:8192
 v_smfmac_f32_16x16x64_bf16 v[36:39], v[60:63], a[96:103], v5
 v_smfmac_f32_16x16x64_bf16 v[40:43], v[60:63], a[104:111], v5
 v_smfmac_f32_16x16x64_bf16 v[44:47], v[56:59], a[72:79], v5
 s_waitcnt lgkmcnt(1)
 v_add_f32 v36, v36, v38
 v_add_f32 v37, v37, v39
 v_smfmac_f32_16x16x64_bf16 v[48:51], v[56:59], v[28:35], v5
 ds_read_b128 v[32:35], v3 offset:11264
 v_add_f32 v40, v40, v42
 v_add_f32 v41, v41, v43
 v_smfmac_f32_16x16x64_bf16 v[44:47], v[60:63], a[112:119], v5
 v_cvt_pk_bf16_f32 v36, v36, v40
 v_cvt_pk_bf16_f32 v37, v37, v41
 v_smfmac_f32_16x16x64_bf16 v[48:51], v[60:63], v[20:27], v5
 ds_write2_b32 v10, v36, v37 offset0:0 offset1:16
 v_smfmac_f32_16x16x64_bf16 v[64:67], v[56:59], a[80:87], v5
 ds_read_b128 v[20:23], v3 offset:9216
 v_add_f32 v44, v44, v46
 v_add_f32 v45, v45, v47
 v_smfmac_f32_16x16x64_bf16 v[68:71], v[56:59], a[88:95], v5
 s_waitcnt lgkmcnt(3)
 v_add_f32 v48, v48, v50
 v_add_f32 v49, v49, v51
 v_cvt_pk_bf16_f32 v44, v44, v48
 v_cvt_pk_bf16_f32 v45, v45, v49
 ds_write2_b32 v8, v44, v45 offset0:0 offset1:16
 v_smfmac_f32_16x16x64_bf16 v[64:67], v[52:55], a[160:167], v5
 ds_read_b128 v[56:59], v3 offset:0
 v_mov_b64 v[28:29], 0
 v_smfmac_f32_16x16x64_bf16 v[68:71], v[52:55], a[168:175], v5
 ds_read_b128 v[52:55], v3 offset:4096
 v_mov_b64 v[30:31], 0
 v_smfmac_f32_16x16x64_bf16 v[64:67], v[60:63], a[120:127], v5
 ds_read_b128 v[24:27], v3 offset:10240
 v_smfmac_f32_16x16x64_bf16 v[68:71], v[60:63], a[128:135], v5
 s_waitcnt lgkmcnt(3)
 s_barrier
 ds_read_b128 v[36:39], v11 offset:17408
 s_waitcnt lgkmcnt(3)
 v_smfmac_f32_16x16x64_bf16 v[64:67], v[56:59], v[96:103], v5
 ds_read_b128 v[40:43], v11 offset:17920
 s_waitcnt lgkmcnt(3)
 v_smfmac_f32_16x16x64_bf16 v[68:71], v[56:59], v[104:111], v5
 ds_read_b128 v[60:63], v9 offset:19456
 ds_read_b128 v[44:47], v11 offset:18432
 v_smfmac_f32_16x16x64_bf16 v[64:67], v[52:55], a[0:7], v5
 ds_read_b128 v[48:51], v11 offset:18944
 v_smfmac_f32_16x16x64_bf16 v[68:71], v[52:55], a[8:15], v5
 ds_read_b128 v[52:55], v3 offset:12288
 s_waitcnt lgkmcnt(5)
 v_mfma_f32_16x16x32_bf16 v[20:23], v[20:23], v[36:39], 0
 ds_read_b128 v[56:59], v9 offset:21504
 v_mfma_f32_16x16x32_bf16 v[24:27], v[24:27], v[36:39], 0
 v_add_f32 v64, v64, v66
 v_add_f32 v65, v65, v67
 s_waitcnt lgkmcnt(5)
 v_mfma_f32_16x16x32_bf16 v[20:23], v[32:35], v[40:43], v[20:23]
 ds_read_b128 v[32:35], v3 offset:13312
 v_cvt_pk_bf16_f32 v2, v64, v65
 v_add_f32 v68, v68, v70
 s_waitcnt lgkmcnt(5)
 v_smfmac_f32_16x16x64_bf16 v[28:31], v[60:63], v[36:43], v5
 ds_read_b128 v[60:63], v3 offset:14336
 ds_read_b128 v[36:39], v3 offset:15360
 v_add_f32 v69, v69, v71
 s_waitcnt lgkmcnt(4)
 v_mfma_f32_16x16x32_bf16 v[24:27], v[52:55], v[40:43], v[24:27]
 ds_read_b128 v[52:55], v3 offset:16384
 v_cvt_pk_bf16_f32 v4, v68, v69
 s_waitcnt lgkmcnt(4)
 v_smfmac_f32_16x16x64_bf16 v[28:31], v[56:59], v[44:51], v5
 ds_read_b128 v[40:43], v0 offset:36864
 s_waitcnt lgkmcnt(4)
 v_mfma_f32_16x16x32_bf16 v[20:23], v[32:35], v[44:47], v[20:23]
 v_mov_b64 v[32:33], s[34:35]
 v_mov_b64 v[34:35], s[34:35]
 s_waitcnt lgkmcnt(3)
 v_mfma_f32_16x16x32_bf16 v[24:27], v[60:63], v[44:47], v[24:27]
 ds_read_b128 v[44:47], v0 offset:40960
 v_add_f32 v28, v28, v30
 v_add_f32 v29, v29, v31
 s_waitcnt lgkmcnt(3)
 v_mfma_f32_16x16x32_bf16 v[20:23], v[36:39], v[48:51], v[20:23]
 ds_read_b128 v[36:39], v0 offset:32768
 v_cndmask_b32 v28, v28, v29, s[48:49]
 v_mul_f32 v28, s55, v28
 s_waitcnt lgkmcnt(3)
 v_mfma_f32_16x16x32_bf16 v[24:27], v[52:55], v[48:51], v[24:27]
 ds_read_b128 v[48:51], v0 offset:45056
 v_exp_f32 v28, v28
 v_mov_b64 v[64:65], 0
 v_cndmask_b32 v29, 0, v28, s[48:49]
 v_cndmask_b32 v28, v28, 0, s[48:49]
 v_cvt_pk_bf16_f32 v6, v28, v29
 v_mov_b64 v[66:67], 0
 v_mov_b64 v[68:69], 0
 v_cndmask_b32 v20, v20, v24, s[48:49]
 v_cndmask_b32 v21, v21, v25, s[48:49]
 v_cndmask_b32 v22, v22, v26, s[48:49]
 v_cndmask_b32 v23, v23, v27, s[48:49]
 v_mfma_f32_16x16x16_bf16 v[60:63], v[6:7], v[32:33], 0
 s_waitcnt vmcnt(3)
 v_exp_f32 v20, v20
 v_mfma_f32_16x16x16_bf16 v[52:55], v[6:7], v[2:3], 0
 s_cmp_eq_u32 s36, 63
 v_exp_f32 v21, v21
 v_mfma_f32_16x16x16_bf16 v[56:59], v[6:7], v[4:5], 0
 v_exp_f32 v22, v22
 v_exp_f32 v23, v23
 v_cvt_pk_bf16_f32 v30, v20, v21
 v_cvt_pk_bf16_f32 v31, v22, v23
 v_mov_b64 v[70:71], 0
 v_mov_b64 v[20:21], 0
 v_smfmac_f32_16x16x32_bf16 v[60:63], v[30:31], v[32:35], v5
 v_mov_b64 v[22:23], 0
 v_mov_b64 v[24:25], 0
 v_smfmac_f32_16x16x32_bf16 v[52:55], v[30:31], v[12:15], v5
 v_mov_b64 v[26:27], 0
 v_smfmac_f32_16x16x32_bf16 v[56:59], v[30:31], v[16:19], v5
 s_nop 0
 v_add_f32 v60, v60, v62
 v_add_f32 v61, v61, v63
 v_rcp_f32 v60, v60
 v_rcp_f32 v61, v61
 v_add_f32 v52, v52, v54
 v_add_f32 v53, v53, v55
 v_mul_f32 v52, v52, v60
 v_mul_f32 v53, v53, v61
 v_add_f32 v56, v56, v58
 v_add_f32 v57, v57, v59
 v_mul_f32 v56, v56, v60
 v_mul_f32 v57, v57, v61
 v_cvt_pk_bf16_f32 v52, v52, v56
 v_cvt_pk_bf16_f32 v53, v53, v57
 ds_write2_b32 v8, v52, v53 offset0:128 offset1:144
 v_subrev_u32 v60, 0x21800000, v60
 v_subrev_u32 v61, 0x21800000, v61
 v_max_u32 v60, v60, v61
 v_cmp_lt_u32 vcc, 0x3c000000, v60
 s_cbranch_scc1 Lchexit_70
 v_mov_b64 v[28:29], 0
 v_mov_b64 v[30:31], 0
 v_mov_b64 v[32:33], 0
 v_mov_b64 v[34:35], 0
 s_cbranch_vccnz Lmx_133
Lmxb_134:
 s_waitcnt lgkmcnt(0)
 v_bfe_u32 v6, v0, 7, 5
 s_barrier
 ds_read_b128 v[52:55], v9 offset:19968
 v_mul_u32_u24 v6, 10496, v6
 ds_read_b128 v[56:59], v9 offset:22016
 ds_read_b128 v[12:15], v0 offset:49152
 v_bfe_u32 v60, v3, 4, 3
 ds_read_b128 v[16:19], v0 offset:53248
 s_add_u32 s67, s67, 0x80000
 v_lshl_add_u32 v6, v60, 3, v6
 s_add_u32 m0, s42, 9216
 s_xor_b32 s46, s46, 0x1
 v_mov_b64 v[60:61], 0
 s_add_u32 s59, s59, 0x80000
 v_mov_b64 v[62:63], 0
 s_waitcnt lgkmcnt(3)
 v_smfmac_f32_16x16x64_bf16 v[64:67], v[52:55], a[248:255], v5
 buffer_load_dwordx4 v3, s[20:23], s67 offen offset:0 sc1 lds
 v_smfmac_f32_16x16x64_bf16 v[68:71], v[52:55], a[176:183], v5
 s_waitcnt lgkmcnt(2)
 s_add_u32 s38, s38, 0x20000
 v_smfmac_f32_16x16x64_bf16 v[64:67], v[56:59], v[36:43], v5
 ds_read_b128 v[36:39], v0 offset:57344
 buffer_load_dwordx4 v3, s[20:23], s67 offen offset:1024 sc1 lds
 v_smfmac_f32_16x16x64_bf16 v[20:23], v[52:55], a[184:191], v5
 ds_read_b128 v[40:43], v0 offset:61440
 s_cmp_lt_u32 s36, 62
 v_add_u32 v0, 0x10000, v0
 v_smfmac_f32_16x16x64_bf16 v[68:71], v[56:59], v[44:51], v5
 ds_read_b128 v[44:47], v0 offset:0
 s_cselect_b32 s47, 0x80000, 0
 v_add_f32 v64, v64, v66
 v_add_f32 v65, v65, v67
 v_cvt_pk_bf16_f32 v65, v65, v65
 v_smfmac_f32_16x16x64_bf16 v[24:27], v[52:55], a[192:199], v5
 ds_read_b128 v[48:51], v0 offset:4096
 s_waitcnt lgkmcnt(4)
 v_cvt_pk_bf16_f32 v64, v64, v64
 v_and_or_b32 v65, v65, -2, s46
 v_smfmac_f32_16x16x64_bf16 v[20:23], v[56:59], v[12:19], v5
 ds_read_b128 v[12:15], v0 offset:8192
 buffer_store_dwordx2 v[64:65], v6, s[20:23], s62 offen sc1
 v_add_f32 v68, v68, v70
 v_add_f32 v69, v69, v71
 v_smfmac_f32_16x16x64_bf16 v[28:31], v[52:55], a[200:207], v5
 ds_read_b128 v[16:19], v0 offset:12288
 s_waitcnt lgkmcnt(4)
 v_mov_b64 v[64:65], 0
 v_mov_b64 v[66:67], 0
 v_smfmac_f32_16x16x64_bf16 v[24:27], v[56:59], v[36:43], v5
 ds_read_b128 v[36:39], v0 offset:16384
 s_add_u32 s68, s68, s47
 v_add_f32 v20, v20, v22
 v_add_f32 v21, v21, v23
 v_cvt_pk_bf16_f32 v69, v69, v21
 v_smfmac_f32_16x16x64_bf16 v[32:35], v[52:55], a[208:215], v5
 ds_read_b128 v[40:43], v0 offset:20480
 s_waitcnt lgkmcnt(4)
 v_cvt_pk_bf16_f32 v68, v68, v20
 v_and_or_b32 v69, v69, -2, s46
 v_smfmac_f32_16x16x64_bf16 v[28:31], v[56:59], v[44:51], v5
 ds_read_b128 v[44:47], v0 offset:24576
 buffer_store_dwordx2 v[68:69], v6, s[20:23], s60 offen offset:0 sc1
 v_add_f32 v24, v24, v26
 v_add_f32 v25, v25, v27
 v_smfmac_f32_16x16x64_bf16 v[60:63], v[52:55], a[216:223], v5
 ds_read_b128 v[48:51], v0 offset:28672
 s_waitcnt lgkmcnt(4)
 v_mov_b64 v[20:21], 0
 v_mov_b64 v[22:23], 0
 v_smfmac_f32_16x16x64_bf16 v[32:35], v[56:59], v[12:19], v5
 s_add_u32 s36, s36, 1
 s_add_u32 s58, s36, 2
 v_add_f32 v28, v28, v30
 v_add_f32 v29, v29, v31
 v_cvt_pk_bf16_f32 v25, v25, v29
 v_smfmac_f32_16x16x64_bf16 v[64:67], v[52:55], a[224:231], v5
 s_waitcnt lgkmcnt(2)
 s_min_u32 s58, s58, 64
 v_cvt_pk_bf16_f32 v24, v24, v28
 v_and_or_b32 v25, v25, -2, s46
 v_smfmac_f32_16x16x64_bf16 v[60:63], v[56:59], v[36:43], v5
 buffer_store_dwordx2 v[24:25], v6, s[20:23], s60 offen offset:2048 sc1
 v_add_f32 v32, v32, v34
 v_smfmac_f32_16x16x64_bf16 v[20:23], v[52:55], a[232:239], v5
 s_waitcnt lgkmcnt(0)
 s_xor_b32 s44, s44, 0x80000
 v_add_f32 v33, v33, v35
 v_smfmac_f32_16x16x64_bf16 v[64:67], v[56:59], v[44:51], v5
 s_xor_b32 s45, s45, 0x80000
 s_xor_b32 s65, s65, 0x80000
 v_add_f32 v60, v60, v62
 v_add_f32 v61, v61, v63
 v_smfmac_f32_16x16x64_bf16 v[20:23], v[56:59], a[240:247], v5
 s_cmp_eq_u32 s4, 0
 v_cvt_pk_bf16_f32 v33, v33, v61
 v_cvt_pk_bf16_f32 v32, v32, v60
 v_and_or_b32 v33, v33, -2, s46
 buffer_store_dwordx2 v[32:33], v6, s[20:23], s61 offen offset:0 sc1
 v_add_f32 v64, v64, v66
 v_add_f32 v65, v65, v67
 s_nop 0
 v_add_f32 v20, v20, v22
 v_add_f32 v21, v21, v23
 v_cvt_pk_bf16_f32 v65, v65, v21
 v_cvt_pk_bf16_f32 v64, v64, v20
 v_and_or_b32 v65, v65, -2, s46
 buffer_store_dwordx2 v[64:65], v6, s[20:23], s61 offen offset:2048 sc1
 s_cbranch_scc1 LwH_135
 s_cmp_eq_u32 s4, 1
 s_cbranch_scc1 Lw_136
 s_cmp_eq_u32 s4, 2
 s_cbranch_scc1 Lw_137
 s_xor_b32 s66, s66, 0x80000
 s_xor_b32 s41, s41, 0x80000
 s_xor_b32 s43, s43, 0x80000
 v_mov_b32 v47, 0x3f80
 v_cndmask_b32 v47, v47, 1.0, s[32:33]
 v_cndmask_b32 v44, 0, v47, s[24:25]
 v_cndmask_b32 v45, 0, v47, s[26:27]
 v_cndmask_b32 v46, 0, v47, s[28:29]
 v_cndmask_b32 v47, 0, v47, s[30:31]
 v_bfe_u32 v52, v3, 8, 2
 v_bfe_u32 v58, v3, 2, 4
 v_lshl_or_b32 v52, v52, 4, v58
 v_and_b32 v58, 0xc0, v3
 v_lshl_or_b32 v52, v58, 24, v52
 v_subrev_u32 v0, 0x20000, v0
 v_mov_b32 v59, -1
 v_add_u32 v54, s42, v3
 v_add_u32 v58, s69, v9
 ds_read_b64 v[64:65], v58 offset:19456
 v_mov_b32 v66, v2
 v_mov_b32 v67, v4
 v_mov_b64 v[68:69], 0
 v_mov_b64 v[70:71], 0
 ds_read_b128 v[20:23], v0 offset:24576
 ds_read_b128 v[24:27], v0 offset:28672
 ds_read_b128 v[28:31], v0 offset:32768
 ds_read_b128 v[32:35], v0 offset:36864
 s_waitcnt vmcnt(0)
 buffer_load_dwordx4 v[36:39], v3, s[20:23], s39 offen offset:0 sc1
 buffer_load_dwordx4 v[40:43], v3, s[20:23], s39 offen offset:1024 sc1
 s_nop 15
 s_nop 10
 buffer_load_dwordx4 v[12:15], v3, s[20:23], s39 offen offset:0 sc1
 buffer_load_dwordx4 v[16:19], v3, s[20:23], s39 offen offset:1024 sc1
 s_waitcnt vmcnt(3)
 v_mfma_f32_16x16x32_bf16 v[48:51], v[44:47], v[36:39], 0
 s_waitcnt vmcnt(2)
 v_mfma_f32_16x16x32_bf16 v[48:51], v[44:47], v[40:43], v[48:51]
 v_bitop3_b32 v55, v37, v39, s46 bitop3:0x7e
 v_bitop3_b32 v56, v41, v43, s46 bitop3:0x7e
 v_bitop3_b32 v55, v55, 1, v56 bitop3:0xc8
 v_cmp_ne_u32 vcc, 0, v55
 s_nop 3
 v_add_f32_dpp v48, v48, v48 row_ror:4 row_mask:0xf bank_mask:0xf
 v_add_f32_dpp v49, v49, v49 row_ror:4 row_mask:0xf bank_mask:0xf
 s_cbranch_vccnz Lr2_139
 v_add_f32_dpp v48, v48, v48 row_ror:8 row_mask:0xf bank_mask:0xf
 v_add_f32_dpp v49, v49, v49 row_ror:8 row_mask:0xf bank_mask:0xf
 v_cvt_pk_bf16_f32 v48, v48, v49
 buffer_store_dword v48, v52, s[20:23], s44 offen sc1
Lb1_140:
 buffer_store_dword v59, v52, s[20:23], s45 offen sc1
 v_cmp_gt_u32 vcc, s58, v1
 v_mov_b64 v[36:37], 0
 v_mov_b64 v[38:39], 0
 v_mov_b64 v[40:41], 0
 v_mov_b64 v[42:43], 0
 v_mov_b64 v[44:45], 0
 v_mov_b64 v[46:47], 0
 v_mov_b64 v[48:49], 0
 v_mov_b64 v[50:51], 0
 s_cmp_lg_u32 vcc_hi, 0
 s_cbranch_scc1 Lfw_142
Lfok_141:
 v_lshl_add_u32 v1, v3, 3, s68
 v_mov_b32 v6, s56
 v_cndmask_b32 v1, v6, v1, s[70:71]
 v_min_u32 v6, 16, v0
 v_lshlrev_b32 v6, 24, v6
 s_max_u32 s47, s36, 1
 v_add_u32 v2, -1, s47
 s_add_u32 m0, s42, 0
 s_waitcnt vmcnt(0)
 s_cmp_lg_u32 s50, 0
 s_cbranch_scc1 Lsure_127
 s_nop 15
 s_nop 15
 s_nop 7
 s_branch LstepB_126
Lw_137:
 s_xor_b32 s66, s66, 0x80000
 s_xor_b32 s41, s41, 0x80000
 s_xor_b32 s43, s43, 0x80000
 v_mov_b32 v47, 0x3f80
 v_cndmask_b32 v47, v47, 1.0, s[32:33]
 v_cndmask_b32 v44, 0, v47, s[24:25]
 v_cndmask_b32 v45, 0, v47, s[26:27]
 v_cndmask_b32 v46, 0, v47, s[28:29]
 v_cndmask_b32 v47, 0, v47, s[30:31]
 v_bfe_u32 v52, v3, 8, 2
 v_bfe_u32 v58, v3, 2, 4
 v_lshl_or_b32 v52, v52, 4, v58
 v_and_b32 v58, 0xc0, v3
 v_lshl_or_b32 v52, v58, 24, v52
 v_subrev_u32 v0, 0x20000, v0
 v_mov_b32 v59, -1
 v_add_u32 v54, s42, v3
 v_add_u32 v58, s69, v9
 ds_read_b64 v[64:65], v58 offset:19456
 v_mov_b32 v66, v2
 v_mov_b32 v67, v4
 v_mov_b64 v[68:69], 0
 v_mov_b64 v[70:71], 0
 ds_read_b128 v[20:23], v0 offset:24576
 ds_read_b128 v[24:27], v0 offset:28672
 ds_read_b128 v[28:31], v0 offset:32768
 ds_read_b128 v[32:35], v0 offset:36864
 s_waitcnt vmcnt(1)
 buffer_load_dwordx4 v[36:39], v3, s[20:23], s39 offen offset:0 sc1
 buffer_load_dwordx4 v[40:43], v3, s[20:23], s39 offen offset:1024 sc1
 s_nop 15
 s_nop 10
 buffer_load_dwordx4 v[12:15], v3, s[20:23], s39 offen offset:0 sc1
 buffer_load_dwordx4 v[16:19], v3, s[20:23], s39 offen offset:1024 sc1
 s_waitcnt vmcnt(3)
 v_mfma_f32_16x16x32_bf16 v[48:51], v[44:47], v[36:39], 0
 s_waitcnt vmcnt(2)
 v_mfma_f32_16x16x32_bf16 v[48:51], v[44:47], v[40:43], v[48:51]
 v_bitop3_b32 v55, v37, v39, s46 bitop3:0x7e
 v_bitop3_b32 v56, v41, v43, s46 bitop3:0x7e
 v_bitop3_b32 v55, v55, 1, v56 bitop3:0xc8
 v_cmp_ne_u32 vcc, 0, v55
 s_nop 3
 v_add_f32_dpp v48, v48, v48 row_ror:4 row_mask:0xf bank_mask:0xf
 v_add_f32_dpp v49, v49, v49 row_ror:4 row_mask:0xf bank_mask:0xf
 s_cbranch_vccnz Lr2_145
 v_add_f32_dpp v48, v48, v48 row_ror:8 row_mask:0xf bank_mask:0xf
 v_add_f32_dpp v49, v49, v49 row_ror:8 row_mask:0xf bank_mask:0xf
 v_cvt_pk_bf16_f32 v48, v48, v49
 buffer_store_dword v48, v52, s[20:23], s44 offen sc1
Lb1_146:
 buffer_store_dword v59, v52, s[20:23], s45 offen sc1
 v_cmp_gt_u32 vcc, s58, v1
 v_mov_b64 v[36:37], 0
 v_mov_b64 v[38:39], 0
 v_mov_b64 v[40:41], 0
 v_mov_b64 v[42:43], 0
 v_mov_b64 v[44:45], 0
 v_mov_b64 v[46:47], 0
 v_mov_b64 v[48:49], 0
 v_mov_b64 v[50:51], 0
 s_cmp_lg_u32 vcc_hi, 0
 s_cbranch_scc1 Lfw_148
Lfok_147:
 v_lshl_add_u32 v1, v3, 3, s68
 v_mov_b32 v6, s56
 v_cndmask_b32 v1, v6, v1, s[70:71]
 v_min_u32 v6, 16, v0
 v_lshlrev_b32 v6, 24, v6
 s_max_u32 s47, s36, 1
 v_add_u32 v2, -1, s47
 s_add_u32 m0, s42, 0
 s_nop 4
 buffer_load_dwordx4 v[12:15], v3, s[20:23], s43 offen offset:0 sc1
 s_nop 15
 s_nop 7
Lp2_149:
 buffer_load_dwordx4 v[12:15], v3, s[20:23], s43 offen offset:0 sc1
 s_waitcnt vmcnt(1)
 v_max3_u32 v55, v12, v13, v14
 v_max_u32 v55, v55, v15
 ds_write_b128 v3, v[12:15] offset:8192
 v_cmpx_eq_u32 vcc, -1, v55
 s_cbranch_execz LstepB_126
 buffer_load_dwordx4 v[12:15], v3, s[20:23], s43 offen offset:0 sc1
 s_waitcnt vmcnt(1)
 v_max3_u32 v55, v12, v13, v14
 v_max_u32 v55, v55, v15
 ds_write_b128 v3, v[12:15] offset:8192
 v_cmpx_eq_u32 vcc, -1, v55
 s_cbranch_execz LstepB_126
 buffer_load_dwordx4 v[12:15], v3, s[20:23], s43 offen offset:0 sc1
 s_waitcnt vmcnt(1)
 v_max3_u32 v55, v12, v13, v14
 v_max_u32 v55, v55, v15
 ds_write_b128 v3, v[12:15] offset:8192
 v_cmpx_eq_u32 vcc, -1, v55
 s_cbranch_execz LstepB_126
 s_sub_u32 s54, s54, 1
 s_cbranch_scc0 Lp2_149
 s_endpgm
Lw_136:
 s_waitcnt vmcnt(2)
 buffer_load_dwordx4 v[36:39], v3, s[20:23], s39 offen offset:0 sc1
 buffer_load_dwordx4 v[40:43], v3, s[20:23], s39 offen offset:1024 sc1
 s_xor_b32 s66, s66, 0x80000
 s_xor_b32 s41, s41, 0x80000
 s_xor_b32 s43, s43, 0x80000
 v_mov_b32 v47, 0x3f80
 v_cndmask_b32 v47, v47, 1.0, s[32:33]
 v_cndmask_b32 v44, 0, v47, s[24:25]
 v_cndmask_b32 v45, 0, v47, s[26:27]
 v_cndmask_b32 v46, 0, v47, s[28:29]
 v_cndmask_b32 v47, 0, v47, s[30:31]
 v_bfe_u32 v52, v3, 8, 2
 v_bfe_u32 v58, v3, 2, 4
 v_lshl_or_b32 v52, v52, 4, v58
 v_and_b32 v58, 0xc0, v3
 v_lshl_or_b32 v52, v58, 24, v52
 v_subrev_u32 v0, 0x20000, v0
 v_mov_b32 v59, -1
 v_add_u32 v54, s42, v3
 v_add_u32 v58, s69, v9
 ds_read_b64 v[64:65], v58 offset:19456
 v_mov_b32 v66, v2
 v_mov_b32 v67, v4
 v_mov_b64 v[68:69], 0
 v_mov_b64 v[70:71], 0
 ds_read_b128 v[20:23], v0 offset:24576
 ds_read_b128 v[24:27], v0 offset:28672
 ds_read_b128 v[28:31], v0 offset:32768
 ds_read_b128 v[32:35], v0 offset:36864
 s_nop 3
 buffer_load_dwordx4 v[12:15], v3, s[20:23], s39 offen offset:0 sc1
 buffer_load_dwordx4 v[16:19], v3, s[20:23], s39 offen offset:1024 sc1
 s_waitcnt vmcnt(3)
 v_mfma_f32_16x16x32_bf16 v[48:51], v[44:47], v[36:39], 0
 s_waitcnt vmcnt(2)
 v_mfma_f32_16x16x32_bf16 v[48:51], v[44:47], v[40:43], v[48:51]
 v_bitop3_b32 v55, v37, v39, s46 bitop3:0x7e
 v_bitop3_b32 v56, v41, v43, s46 bitop3:0x7e
 v_bitop3_b32 v55, v55, 1, v56 bitop3:0xc8
 v_cmp_ne_u32 vcc, 0, v55
 s_nop 3
 v_add_f32_dpp v48, v48, v48 row_ror:4 row_mask:0xf bank_mask:0xf
 v_add_f32_dpp v49, v49, v49 row_ror:4 row_mask:0xf bank_mask:0xf
 s_cbranch_vccnz Lr2_151
 v_add_f32_dpp v48, v48, v48 row_ror:8 row_mask:0xf bank_mask:0xf
 v_add_f32_dpp v49, v49, v49 row_ror:8 row_mask:0xf bank_mask:0xf
 v_cvt_pk_bf16_f32 v48, v48, v49
 buffer_store_dword v48, v52, s[20:23], s44 offen sc1
Lb1_152:
 buffer_store_dword v59, v52, s[20:23], s45 offen sc1
 v_cmp_gt_u32 vcc, s58, v1
 v_mov_b64 v[36:37], 0
 v_mov_b64 v[38:39], 0
 v_mov_b64 v[40:41], 0
 v_mov_b64 v[42:43], 0
 v_mov_b64 v[44:45], 0
 v_mov_b64 v[46:47], 0
 v_mov_b64 v[48:49], 0
 v_mov_b64 v[50:51], 0
 s_cmp_lg_u32 vcc_hi, 0
 s_cbranch_scc1 Lfw_154
Lfok_153:
 v_lshl_add_u32 v1, v3, 3, s68
 v_mov_b32 v6, s56
 v_cndmask_b32 v1, v6, v1, s[70:71]
 v_min_u32 v6, 16, v0
 v_lshlrev_b32 v6, 24, v6
 s_max_u32 s47, s36, 1
 v_add_u32 v2, -1, s47
 s_nop 15
 s_nop 0
 buffer_load_dwordx4 v[12:15], v3, s[20:23], s41 offen offset:0 sc1
 buffer_load_dwordx4 v[16:19], v3, s[20:23], s41 offen offset:1024 sc1
 s_nop 15
 s_nop 7
Lp2_155:
 buffer_load_dwordx4 v[12:15], v3, s[20:23], s41 offen offset:0 sc1
 buffer_load_dwordx4 v[16:19], v3, s[20:23], s41 offen offset:1024 sc1
 s_waitcnt vmcnt(2)
 v_max3_u32 v55, v12, v13, v14
 v_max3_u32 v55, v55, v15, v16
 v_max3_u32 v55, v55, v17, v18
 v_max_u32 v55, v55, v19
 ds_write_b128 v54, v[12:15] offset:0
 ds_write_b128 v54, v[16:19] offset:1024
 v_cmpx_eq_u32 vcc, -1, v55
 s_cbranch_execz Lstep_124
 buffer_load_dwordx4 v[12:15], v3, s[20:23], s41 offen offset:0 sc1
 buffer_load_dwordx4 v[16:19], v3, s[20:23], s41 offen offset:1024 sc1
 s_waitcnt vmcnt(2)
 v_max3_u32 v55, v12, v13, v14
 v_max3_u32 v55, v55, v15, v16
 v_max3_u32 v55, v55, v17, v18
 v_max_u32 v55, v55, v19
 ds_write_b128 v54, v[12:15] offset:0
 ds_write_b128 v54, v[16:19] offset:1024
 v_cmpx_eq_u32 vcc, -1, v55
 s_cbranch_execz Lstep_124
 buffer_load_dwordx4 v[12:15], v3, s[20:23], s41 offen offset:0 sc1
 buffer_load_dwordx4 v[16:19], v3, s[20:23], s41 offen offset:1024 sc1
 s_waitcnt vmcnt(2)
 v_max3_u32 v55, v12, v13, v14
 v_max3_u32 v55, v55, v15, v16
 v_max3_u32 v55, v55, v17, v18
 v_max_u32 v55, v55, v19
 ds_write_b128 v54, v[12:15] offset:0
 ds_write_b128 v54, v[16:19] offset:1024
 v_cmpx_eq_u32 vcc, -1, v55
 s_cbranch_execz Lstep_124
 s_sub_u32 s54, s54, 1
 s_cbranch_scc0 Lp2_155
 s_endpgm
LwH_135:
 v_bfe_u32 v53, v3, 8, 1
 v_bfe_u32 v58, v3, 9, 1
 v_lshl_or_b32 v53, v53, 1, v58
 v_bfe_u32 v58, v3, 5, 1
 v_lshl_or_b32 v53, v53, 1, v58
 v_and_b32 v58, 0xd0, v3
 v_lshlrev_b32 v58, 24, v58
 v_lshl_or_b32 v53, v53, 2, v58
 s_waitcnt vmcnt(3)
 s_nop 7
 buffer_load_dwordx4 v[20:23], v3, s[20:23], s40 offen offset:0 sc1
 buffer_load_dwordx4 v[24:27], v3, s[20:23], s40 offen offset:1024 sc1
 buffer_load_dwordx4 v[36:39], v3, s[20:23], s39 offen offset:0 sc1
 buffer_load_dwordx4 v[40:43], v3, s[20:23], s39 offen offset:1024 sc1
 s_xor_b32 s66, s66, 0x80000
 s_xor_b32 s41, s41, 0x80000
 s_xor_b32 s43, s43, 0x80000
 v_mov_b32 v47, 0x3f80
 v_cndmask_b32 v47, v47, 1.0, s[32:33]
 v_cndmask_b32 v44, 0, v47, s[24:25]
 v_cndmask_b32 v45, 0, v47, s[26:27]
 v_cndmask_b32 v46, 0, v47, s[28:29]
 v_cndmask_b32 v47, 0, v47, s[30:31]
 v_bfe_u32 v52, v3, 8, 2
 v_bfe_u32 v58, v3, 2, 4
 v_lshl_or_b32 v52, v52, 4, v58
 v_and_b32 v58, 0xc0, v3
 v_lshl_or_b32 v52, v58, 24, v52
 v_subrev_u32 v0, 0x20000, v0
 v_mov_b32 v59, -1
 v_add_u32 v54, s42, v3
 v_add_u32 v58, s69, v9
 ds_read_b64 v[64:65], v58 offset:19456
 v_mov_b32 v66, v2
 v_mov_b32 v67, v4
 v_mov_b64 v[68:69], 0
 v_mov_b64 v[70:71], 0
 s_waitcnt vmcnt(2)
 v_mfma_f32_16x16x32_bf16 v[28:31], v[44:47], v[20:23], 0
 v_mfma_f32_16x16x32_bf16 v[28:31], v[44:47], v[24:27], v[28:31]
 s_waitcnt vmcnt(1)
 v_mfma_f32_16x16x32_bf16 v[48:51], v[44:47], v[36:39], 0
 s_waitcnt vmcnt(0)
 v_mfma_f32_16x16x32_bf16 v[48:51], v[44:47], v[40:43], v[48:51]
 v_bitop3_b32 v55, v37, v39, s46 bitop3:0x7e
 v_bitop3_b32 v56, v41, v43, s46 bitop3:0x7e
 v_bitop3_b32 v57, v21, v23, s46 bitop3:0x7e
 v_or3_b32 v55, v55, v56, v57
 v_bitop3_b32 v56, v25, v27, s46 bitop3:0x7e
 v_bitop3_b32 v55, v55, 1, v56 bitop3:0xc8
 v_cmp_ne_u32 vcc, 0, v55
 v_add_f32_dpp v29, v29, v29 row_ror:4 row_mask:0xf bank_mask:0xf
 v_add_f32_dpp v48, v48, v48 row_ror:4 row_mask:0xf bank_mask:0xf
 v_add_f32_dpp v49, v49, v49 row_ror:4 row_mask:0xf bank_mask:0xf
 v_add_f32_dpp v29, v29, v29 row_ror:8 row_mask:0xf bank_mask:0xf
 v_add_f32_dpp v48, v48, v48 row_ror:8 row_mask:0xf bank_mask:0xf
 v_add_f32_dpp v49, v49, v49 row_ror:8 row_mask:0xf bank_mask:0xf
 s_cbranch_vccnz Lr1_156
 v_cvt_pk_bf16_f32 v48, v48, v49
 buffer_store_dword v48, v52, s[20:23], s44 offen sc1
 v_mov_b32_dpp v30, v29 quad_perm:[1,0,3,2] row_mask:0xf bank_mask:0xf
 v_cvt_pk_bf16_f32 v29, v29, v30
 buffer_store_dword v29, v53, s[20:23], s65 offen sc1
Lb1_157:
 buffer_store_dword v59, v52, s[20:23], s45 offen sc1
 buffer_store_dword v59, v53, s[20:23], s66 offen sc1
 v_cmp_gt_u32 vcc, s58, v1
 ds_read_b128 v[20:23], v0 offset:24576
 ds_read_b128 v[24:27], v0 offset:28672
 ds_read_b128 v[28:31], v0 offset:32768
 ds_read_b128 v[32:35], v0 offset:36864
 v_mov_b64 v[36:37], 0
 v_mov_b64 v[38:39], 0
 v_mov_b64 v[40:41], 0
 v_mov_b64 v[42:43], 0
 v_mov_b64 v[44:45], 0
 v_mov_b64 v[46:47], 0
 v_mov_b64 v[48:49], 0
 v_mov_b64 v[50:51], 0
 s_cmp_lg_u32 vcc_hi, 0
 s_cbranch_scc1 Lfw_159
Lfok_158:
 v_lshl_add_u32 v1, v3, 3, s68
 v_mov_b32 v6, s56
 v_cndmask_b32 v1, v6, v1, s[70:71]
 v_min_u32 v6, 16, v0
 v_lshlrev_b32 v6, 24, v6
 s_max_u32 s47, s36, 1
 v_add_u32 v2, -1, s47
 s_nop 10
 buffer_load_dwordx4 v[12:15], v3, s[20:23], s41 offen offset:0 sc1
 buffer_load_dwordx4 v[16:19], v3, s[20:23], s41 offen offset:1024 sc1
 s_nop 15
 s_nop 7
Lp2_160:
 buffer_load_dwordx4 v[12:15], v3, s[20:23], s41 offen offset:0 sc1
 buffer_load_dwordx4 v[16:19], v3, s[20:23], s41 offen offset:1024 sc1
 s_waitcnt vmcnt(2)
 v_max3_u32 v55, v12, v13, v14
 v_max3_u32 v55, v55, v15, v16
 v_max3_u32 v55, v55, v17, v18
 v_max_u32 v55, v55, v19
 ds_write_b128 v54, v[12:15] offset:0
 ds_write_b128 v54, v[16:19] offset:1024
 v_cmpx_eq_u32 vcc, -1, v55
 s_cbranch_execz Lstep_124
 buffer_load_dwordx4 v[12:15], v3, s[20:23], s41 offen offset:0 sc1
 buffer_load_dwordx4 v[16:19], v3, s[20:23], s41 offen offset:1024 sc1
 s_waitcnt vmcnt(2)
 v_max3_u32 v55, v12, v13, v14
 v_max3_u32 v55, v55, v15, v16
 v_max3_u32 v55, v55, v17, v18
 v_max_u32 v55, v55, v19
 ds_write_b128 v54, v[12:15] offset:0
 ds_write_b128 v54, v[16:19] offset:1024
 v_cmpx_eq_u32 vcc, -1, v55
 s_cbranch_execz Lstep_124
 buffer_load_dwordx4 v[12:15], v3, s[20:23], s41 offen offset:0 sc1
 buffer_load_dwordx4 v[16:19], v3, s[20:23], s41 offen offset:1024 sc1
 s_waitcnt vmcnt(2)
 v_max3_u32 v55, v12, v13, v14
 v_max3_u32 v55, v55, v15, v16
 v_max3_u32 v55, v55, v17, v18
 v_max_u32 v55, v55, v19
 ds_write_b128 v54, v[12:15] offset:0
 ds_write_b128 v54, v[16:19] offset:1024
 v_cmpx_eq_u32 vcc, -1, v55
 s_cbranch_execz Lstep_124
 s_sub_u32 s54, s54, 1
 s_cbranch_scc0 Lp2_160
 s_endpgm
Lr1_156:
 s_mov_b64 exec, vcc
Lrt_161:
 buffer_load_dwordx4 v[20:23], v3, s[20:23], s40 offen offset:0 sc1
 buffer_load_dwordx4 v[24:27], v3, s[20:23], s40 offen offset:1024 sc1
 buffer_load_dwordx4 v[36:39], v3, s[20:23], s39 offen offset:0 sc1
 buffer_load_dwordx4 v[40:43], v3, s[20:23], s39 offen offset:1024 sc1
 s_waitcnt vmcnt(4)
 v_bitop3_b32 v55, v37, v39, s46 bitop3:0x7e
 v_bitop3_b32 v56, v41, v43, s46 bitop3:0x7e
 v_bitop3_b32 v57, v21, v23, s46 bitop3:0x7e
 v_or3_b32 v55, v55, v56, v57
 v_bitop3_b32 v56, v25, v27, s46 bitop3:0x7e
 v_bitop3_b32 v55, v55, 1, v56 bitop3:0xc8
 v_cmpx_ne_u32 vcc, 0, v55
 s_cbranch_execz Lrte_162
 buffer_load_dwordx4 v[20:23], v3, s[20:23], s40 offen offset:0 sc1
 buffer_load_dwordx4 v[24:27], v3, s[20:23], s40 offen offset:1024 sc1
 buffer_load_dwordx4 v[36:39], v3, s[20:23], s39 offen offset:0 sc1
 buffer_load_dwordx4 v[40:43], v3, s[20:23], s39 offen offset:1024 sc1
 s_waitcnt vmcnt(4)
 v_bitop3_b32 v55, v37, v39, s46 bitop3:0x7e
 v_bitop3_b32 v56, v41, v43, s46 bitop3:0x7e
 v_bitop3_b32 v57, v21, v23, s46 bitop3:0x7e
 v_or3_b32 v55, v55, v56, v57
 v_bitop3_b32 v56, v25, v27, s46 bitop3:0x7e
 v_bitop3_b32 v55, v55, 1, v56 bitop3:0xc8
 v_cmpx_ne_u32 vcc, 0, v55
 s_cbranch_execz Lrte_162
 buffer_load_dwordx4 v[20:23], v3, s[20:23], s40 offen offset:0 sc1
 buffer_load_dwordx4 v[24:27], v3, s[20:23], s40 offen offset:1024 sc1
 buffer_load_dwordx4 v[36:39], v3, s[20:23], s39 offen offset:0 sc1
 buffer_load_dwordx4 v[40:43], v3, s[20:23], s39 offen offset:1024 sc1
 s_waitcnt vmcnt(4)
 v_bitop3_b32 v55, v37, v39, s46 bitop3:0x7e
 v_bitop3_b32 v56, v41, v43, s46 bitop3:0x7e
 v_bitop3_b32 v57, v21, v23, s46 bitop3:0x7e
 v_or3_b32 v55, v55, v56, v57
 v_bitop3_b32 v56, v25, v27, s46 bitop3:0x7e
 v_bitop3_b32 v55, v55, 1, v56 bitop3:0xc8
 v_cmpx_ne_u32 vcc, 0, v55
 s_cbranch_execz Lrte_162
 s_sub_u32 s54, s54, 1
 s_cbranch_scc0 Lrt_161
 s_endpgm
Lrte_162:
 s_mov_b64 exec, -1
 s_nop 2
 v_mfma_f32_16x16x32_bf16 v[28:31], v[44:47], v[20:23], 0
 v_mfma_f32_16x16x32_bf16 v[28:31], v[44:47], v[24:27], v[28:31]
 v_mfma_f32_16x16x32_bf16 v[48:51], v[44:47], v[36:39], 0
 v_mfma_f32_16x16x32_bf16 v[48:51], v[44:47], v[40:43], v[48:51]
 s_nop 6
 v_add_f32_dpp v29, v29, v29 row_ror:4 row_mask:0xf bank_mask:0xf
 v_add_f32_dpp v48, v48, v48 row_ror:4 row_mask:0xf bank_mask:0xf
 v_add_f32_dpp v49, v49, v49 row_ror:4 row_mask:0xf bank_mask:0xf
 v_add_f32_dpp v29, v29, v29 row_ror:8 row_mask:0xf bank_mask:0xf
 v_add_f32_dpp v48, v48, v48 row_ror:8 row_mask:0xf bank_mask:0xf
 v_add_f32_dpp v49, v49, v49 row_ror:8 row_mask:0xf bank_mask:0xf
 v_cvt_pk_bf16_f32 v48, v48, v49
 buffer_store_dword v48, v52, s[20:23], s44 offen sc1
 v_mov_b32_dpp v30, v29 quad_perm:[1,0,3,2] row_mask:0xf bank_mask:0xf
 v_cvt_pk_bf16_f32 v29, v29, v30
 buffer_store_dword v29, v53, s[20:23], s65 offen sc1
 s_waitcnt vmcnt(2)
 s_branch Lb1_157
Lsure_127:
 s_mov_b32 s50, 0
 s_waitcnt lgkmcnt(0)
 buffer_load_dwordx4 v[12:15], v3, s[20:23], s41 offen offset:0 sc1
 buffer_load_dwordx4 v[16:19], v3, s[20:23], s41 offen offset:1024 sc1
 s_sub_u32 s54, s54, 1
 s_cbranch_scc1 Lfail_125
 s_waitcnt vmcnt(0)
 v_max3_u32 v4, v12, v13, v14
 v_max3_u32 v4, v4, v15, v16
 v_max3_u32 v4, v4, v17, v18
 v_max_u32 v4, v4, v19
 v_cmp_eq_u32 vcc, -1, v4
 s_cbranch_vccnz Lsure_127
 s_branch Lsureb_128
Lfx_129:
 s_add_u32 s47, s43, -4096
 buffer_load_dwordx4 v[60:63], v3, s[20:23], s47 offen offset:0 sc1
 buffer_load_dwordx4 v[52:55], v3, s[20:23], s47 offen offset:1024 sc1
 s_sub_u32 s54, s54, 1
 s_cbranch_scc1 Lfail_125
 s_waitcnt vmcnt(0)
 v_max3_u32 v4, v60, v61, v62
 v_max3_u32 v4, v4, v63, v52
 v_max3_u32 v4, v4, v53, v54
 v_max_u32 v4, v4, v55
 v_cmp_eq_u32 vcc, -1, v4
 s_cbranch_vccnz Lfx_129
 ds_write_b128 v3, v[60:63] offset:4096
 s_waitcnt lgkmcnt(0)
 s_branch Lfxb_130
Lfx_131:
 s_add_u32 s47, s43, -2048
 buffer_load_dwordx4 v[56:59], v3, s[20:23], s47 offen offset:0 sc1
 buffer_load_dwordx4 v[60:63], v3, s[20:23], s47 offen offset:1024 sc1
 s_sub_u32 s54, s54, 1
 s_cbranch_scc1 Lfail_125
 s_waitcnt vmcnt(0)
 v_max3_u32 v4, v56, v57, v58
 v_max3_u32 v4, v4, v59, v60
 v_max3_u32 v4, v4, v61, v62
 v_max_u32 v4, v4, v63
 v_cmp_eq_u32 vcc, -1, v4
 s_cbranch_vccnz Lfx_131
 ds_write_b128 v3, v[56:59] offset:6144
 s_waitcnt lgkmcnt(0)
 s_branch Lfxb_132
Lmx_133:
 s_waitcnt lgkmcnt(0)
 ds_read_b128 v[36:39], v11 offset:17408
 ds_read_b128 v[40:43], v11 offset:17920
 ds_read_b128 v[44:47], v11 offset:18432
 ds_read_b128 v[48:51], v11 offset:18944
 v_mov_b64 v[28:29], 0
 v_mov_b64 v[30:31], 0
 ds_read_b128 v[52:55], v3 offset:9216
 ds_read_b128 v[56:59], v3 offset:10240
 s_waitcnt lgkmcnt(0)
 v_mfma_f32_16x16x32_bf16 v[20:23], v[52:55], v[36:39], 0
 v_mfma_f32_16x16x32_bf16 v[24:27], v[56:59], v[36:39], 0
 ds_read_b128 v[52:55], v3 offset:11264
 ds_read_b128 v[56:59], v3 offset:12288
 s_waitcnt lgkmcnt(0)
 v_mfma_f32_16x16x32_bf16 v[20:23], v[52:55], v[40:43], v[20:23]
 v_mfma_f32_16x16x32_bf16 v[24:27], v[56:59], v[40:43], v[24:27]
 ds_read_b128 v[52:55], v3 offset:13312
 ds_read_b128 v[56:59], v3 offset:14336
 s_waitcnt lgkmcnt(0)
 v_mfma_f32_16x16x32_bf16 v[20:23], v[52:55], v[44:47], v[20:23]
 v_mfma_f32_16x16x32_bf16 v[24:27], v[56:59], v[44:47], v[24:27]
 ds_read_b128 v[52:55], v3 offset:15360
 ds_read_b128 v[56:59], v3 offset:16384
 s_waitcnt lgkmcnt(0)
 v_mfma_f32_16x16x32_bf16 v[20:23], v[52:55], v[48:51], v[20:23]
 v_mfma_f32_16x16x32_bf16 v[24:27], v[56:59], v[48:51], v[24:27]
 ds_read_b128 v[52:55], v9 offset:19456
 ds_read_b128 v[56:59], v9 offset:21504
 s_waitcnt lgkmcnt(0)
 v_smfmac_f32_16x16x64_bf16 v[28:31], v[52:55], v[36:43], v5
 v_smfmac_f32_16x16x64_bf16 v[28:31], v[56:59], v[44:51], v5
 ds_read_b128 v[36:39], v0 offset:32768
 ds_read_b128 v[40:43], v0 offset:36864
 ds_read_b128 v[44:47], v0 offset:40960
 ds_read_b128 v[48:51], v0 offset:45056
 v_mov_b64 v[32:33], s[34:35]
 v_mov_b64 v[34:35], s[34:35]
 s_nop 1
 v_add_f32 v28, v28, v30
 v_add_f32 v29, v29, v31
 v_mul_f32 v28, s55, v28
 v_mul_f32 v29, s55, v29
 v_max_f32 v30, v28, v29
 v_cndmask_b32 v28, v28, v29, s[48:49]
 v_max3_f32 v30, v30, v20, v21
 v_max3_f32 v30, v30, v22, v23
 v_max3_f32 v30, v30, v24, v25
 v_max3_f32 v31, v30, v26, v27
 v_max3_f32 v29, v30, v26, v27
 v_cndmask_b32 v20, v20, v24, s[48:49]
 v_cndmask_b32 v21, v21, v25, s[48:49]
 v_permlane16_swap_b32 v31, v29
 v_max_f32 v30, v31, v29
 v_max_f32 v6, v31, v29
 v_cndmask_b32 v22, v22, v26, s[48:49]
 v_cndmask_b32 v23, v23, v27, s[48:49]
 v_permlane32_swap_b32 v30, v6
 v_max_f32 v30, v30, v6
 v_sub_f32 v28, v28, v30
 v_sub_f32 v20, v20, v30
 v_sub_f32 v21, v21, v30
 v_sub_f32 v22, v22, v30
 v_sub_f32 v23, v23, v30
 v_exp_f32 v28, v28
 v_exp_f32 v20, v20
 v_exp_f32 v21, v21
 v_exp_f32 v22, v22
 v_exp_f32 v23, v23
 v_cndmask_b32 v29, 0, v28, s[48:49]
 v_cndmask_b32 v28, v28, 0, s[48:49]
 v_cvt_pk_bf16_f32 v6, v28, v29
 v_cvt_pk_bf16_f32 v30, v20, v21
 v_cvt_pk_bf16_f32 v31, v22, v23
 v_mfma_f32_16x16x16_bf16 v[60:63], v[6:7], v[32:33], 0
 v_mfma_f32_16x16x16_bf16 v[52:55], v[6:7], v[2:3], 0
 v_mfma_f32_16x16x16_bf16 v[56:59], v[6:7], v[4:5], 0
 v_smfmac_f32_16x16x32_bf16 v[60:63], v[30:31], v[32:35], v5
 v_smfmac_f32_16x16x32_bf16 v[52:55], v[30:31], v[12:15], v5
 v_smfmac_f32_16x16x32_bf16 v[56:59], v[30:31], v[16:19], v5
 s_nop 0
 v_add_f32 v60, v60, v62
 v_add_f32 v61, v61, v63
 v_rcp_f32 v60, v60
 v_rcp_f32 v61, v61
 v_add_f32 v52, v52, v54
 v_add_f32 v53, v53, v55
 v_mul_f32 v52, v52, v60
 v_mul_f32 v53, v53, v61
 v_add_f32 v56, v56, v58
 v_add_f32 v57, v57, v59
 v_mul_f32 v56, v56, v60
 v_mul_f32 v57, v57, v61
 v_cvt_pk_bf16_f32 v52, v52, v56
 v_cvt_pk_bf16_f32 v53, v53, v57
 ds_write2_b32 v8, v52, v53 offset0:128 offset1:144
 v_mov_b64 v[20:21], 0
 v_mov_b64 v[22:23], 0
 v_mov_b64 v[24:25], 0
 v_mov_b64 v[26:27], 0
 v_mov_b64 v[28:29], 0
 v_mov_b64 v[30:31], 0
 v_mov_b64 v[32:33], 0
 v_mov_b64 v[34:35], 0
 s_waitcnt lgkmcnt(0)
 s_branch Lmxb_134
Lr2_139:
 s_waitcnt vmcnt(1)
 v_mfma_f32_16x16x32_bf16 v[48:51], v[44:47], v[12:15], 0
 s_waitcnt vmcnt(0)
 v_mfma_f32_16x16x32_bf16 v[48:51], v[44:47], v[16:19], v[48:51]
 v_bitop3_b32 v55, v13, v15, s46 bitop3:0x7e
 v_bitop3_b32 v56, v17, v19, s46 bitop3:0x7e
 v_bitop3_b32 v55, v55, 1, v56 bitop3:0xc8
 v_cmp_ne_u32 vcc, 0, v55
 s_nop 3
 v_add_f32_dpp v48, v48, v48 row_ror:4 row_mask:0xf bank_mask:0xf
 v_add_f32_dpp v49, v49, v49 row_ror:4 row_mask:0xf bank_mask:0xf
 s_cbranch_vccnz Lr1_138
 v_add_f32_dpp v48, v48, v48 row_ror:8 row_mask:0xf bank_mask:0xf
 v_add_f32_dpp v49, v49, v49 row_ror:8 row_mask:0xf bank_mask:0xf
 v_cvt_pk_bf16_f32 v48, v48, v49
 buffer_store_dword v48, v52, s[20:23], s44 offen sc1
 s_branch Lb1_140
Lr1_138:
 s_mov_b64 exec, vcc
Lrt_163:
 buffer_load_dwordx4 v[12:15], v3, s[20:23], s39 offen offset:0 sc1
 buffer_load_dwordx4 v[16:19], v3, s[20:23], s39 offen offset:1024 sc1
 s_waitcnt vmcnt(2)
 v_bitop3_b32 v55, v13, v15, s46 bitop3:0x7e
 v_bitop3_b32 v56, v17, v19, s46 bitop3:0x7e
 v_bitop3_b32 v55, v55, 1, v56 bitop3:0xc8
 v_cmpx_ne_u32 vcc, 0, v55
 s_cbranch_execz Lrte_164
 buffer_load_dwordx4 v[12:15], v3, s[20:23], s39 offen offset:0 sc1
 buffer_load_dwordx4 v[16:19], v3, s[20:23], s39 offen offset:1024 sc1
 s_waitcnt vmcnt(2)
 v_bitop3_b32 v55, v13, v15, s46 bitop3:0x7e
 v_bitop3_b32 v56, v17, v19, s46 bitop3:0x7e
 v_bitop3_b32 v55, v55, 1, v56 bitop3:0xc8
 v_cmpx_ne_u32 vcc, 0, v55
 s_cbranch_execz Lrte_164
 buffer_load_dwordx4 v[12:15], v3, s[20:23], s39 offen offset:0 sc1
 buffer_load_dwordx4 v[16:19], v3, s[20:23], s39 offen offset:1024 sc1
 s_waitcnt vmcnt(2)
 v_bitop3_b32 v55, v13, v15, s46 bitop3:0x7e
 v_bitop3_b32 v56, v17, v19, s46 bitop3:0x7e
 v_bitop3_b32 v55, v55, 1, v56 bitop3:0xc8
 v_cmpx_ne_u32 vcc, 0, v55
 s_cbranch_execz Lrte_164
 s_sub_u32 s54, s54, 1
 s_cbranch_scc0 Lrt_163
 s_endpgm
Lrte_164:
 s_mov_b64 exec, -1
 s_mov_b32 s50, 0
 s_nop 1
 v_mfma_f32_16x16x32_bf16 v[48:51], v[44:47], v[12:15], 0
 v_mfma_f32_16x16x32_bf16 v[48:51], v[44:47], v[16:19], v[48:51]
 s_nop 7
 v_add_f32_dpp v48, v48, v48 row_ror:4 row_mask:0xf bank_mask:0xf
 v_add_f32_dpp v49, v49, v49 row_ror:4 row_mask:0xf bank_mask:0xf
 s_nop 0
 v_add_f32_dpp v48, v48, v48 row_ror:8 row_mask:0xf bank_mask:0xf
 v_add_f32_dpp v49, v49, v49 row_ror:8 row_mask:0xf bank_mask:0xf
 v_cvt_pk_bf16_f32 v48, v48, v49
 buffer_store_dword v48, v52, s[20:23], s44 offen sc1
 s_branch Lb1_140
Lr2_145:
 s_waitcnt vmcnt(1)
 v_mfma_f32_16x16x32_bf16 v[48:51], v[44:47], v[12:15], 0
 s_waitcnt vmcnt(0)
 v_mfma_f32_16x16x32_bf16 v[48:51], v[44:47], v[16:19], v[48:51]
 v_bitop3_b32 v55, v13, v15, s46 bitop3:0x7e
 v_bitop3_b32 v56, v17, v19, s46 bitop3:0x7e
 v_bitop3_b32 v55, v55, 1, v56 bitop3:0xc8
 v_cmp_ne_u32 vcc, 0, v55
 s_nop 3
 v_add_f32_dpp v48, v48, v48 row_ror:4 row_mask:0xf bank_mask:0xf
 v_add_f32_dpp v49, v49, v49 row_ror:4 row_mask:0xf bank_mask:0xf
 s_cbranch_vccnz Lr1_144
 v_add_f32_dpp v48, v48, v48 row_ror:8 row_mask:0xf bank_mask:0xf
 v_add_f32_dpp v49, v49, v49 row_ror:8 row_mask:0xf bank_mask:0xf
 v_cvt_pk_bf16_f32 v48, v48, v49
 buffer_store_dword v48, v52, s[20:23], s44 offen sc1
 s_branch Lb1_146
Lr1_144:
 s_mov_b64 exec, vcc
Lrt_165:
 buffer_load_dwordx4 v[12:15], v3, s[20:23], s39 offen offset:0 sc1
 buffer_load_dwordx4 v[16:19], v3, s[20:23], s39 offen offset:1024 sc1
 s_waitcnt vmcnt(2)
 v_bitop3_b32 v55, v13, v15, s46 bitop3:0x7e
 v_bitop3_b32 v56, v17, v19, s46 bitop3:0x7e
 v_bitop3_b32 v55, v55, 1, v56 bitop3:0xc8
 v_cmpx_ne_u32 vcc, 0, v55
 s_cbranch_execz Lrte_166
 buffer_load_dwordx4 v[12:15], v3, s[20:23], s39 offen offset:0 sc1
 buffer_load_dwordx4 v[16:19], v3, s[20:23], s39 offen offset:1024 sc1
 s_waitcnt vmcnt(2)
 v_bitop3_b32 v55, v13, v15, s46 bitop3:0x7e
 v_bitop3_b32 v56, v17, v19, s46 bitop3:0x7e
 v_bitop3_b32 v55, v55, 1, v56 bitop3:0xc8
 v_cmpx_ne_u32 vcc, 0, v55
 s_cbranch_execz Lrte_166
 buffer_load_dwordx4 v[12:15], v3, s[20:23], s39 offen offset:0 sc1
 buffer_load_dwordx4 v[16:19], v3, s[20:23], s39 offen offset:1024 sc1
 s_waitcnt vmcnt(2)
 v_bitop3_b32 v55, v13, v15, s46 bitop3:0x7e
 v_bitop3_b32 v56, v17, v19, s46 bitop3:0x7e
 v_bitop3_b32 v55, v55, 1, v56 bitop3:0xc8
 v_cmpx_ne_u32 vcc, 0, v55
 s_cbranch_execz Lrte_166
 s_sub_u32 s54, s54, 1
 s_cbranch_scc0 Lrt_165
 s_endpgm
Lrte_166:
 s_mov_b64 exec, -1
 s_mov_b32 s50, 0
 s_nop 1
 v_mfma_f32_16x16x32_bf16 v[48:51], v[44:47], v[12:15], 0
 v_mfma_f32_16x16x32_bf16 v[48:51], v[44:47], v[16:19], v[48:51]
 s_nop 7
 v_add_f32_dpp v48, v48, v48 row_ror:4 row_mask:0xf bank_mask:0xf
 v_add_f32_dpp v49, v49, v49 row_ror:4 row_mask:0xf bank_mask:0xf
 s_nop 0
 v_add_f32_dpp v48, v48, v48 row_ror:8 row_mask:0xf bank_mask:0xf
 v_add_f32_dpp v49, v49, v49 row_ror:8 row_mask:0xf bank_mask:0xf
 v_cvt_pk_bf16_f32 v48, v48, v49
 buffer_store_dword v48, v52, s[20:23], s44 offen sc1
 s_branch Lb1_146
Lr2_151:
 s_waitcnt vmcnt(1)
 v_mfma_f32_16x16x32_bf16 v[48:51], v[44:47], v[12:15], 0
 s_waitcnt vmcnt(0)
 v_mfma_f32_16x16x32_bf16 v[48:51], v[44:47], v[16:19], v[48:51]
 v_bitop3_b32 v55, v13, v15, s46 bitop3:0x7e
 v_bitop3_b32 v56, v17, v19, s46 bitop3:0x7e
 v_bitop3_b32 v55, v55, 1, v56 bitop3:0xc8
 v_cmp_ne_u32 vcc, 0, v55
 s_nop 3
 v_add_f32_dpp v48, v48, v48 row_ror:4 row_mask:0xf bank_mask:0xf
 v_add_f32_dpp v49, v49, v49 row_ror:4 row_mask:0xf bank_mask:0xf
 s_cbranch_vccnz Lr1_150
 v_add_f32_dpp v48, v48, v48 row_ror:8 row_mask:0xf bank_mask:0xf
 v_add_f32_dpp v49, v49, v49 row_ror:8 row_mask:0xf bank_mask:0xf
 v_cvt_pk_bf16_f32 v48, v48, v49
 buffer_store_dword v48, v52, s[20:23], s44 offen sc1
 s_branch Lb1_152
Lr1_150:
 s_mov_b64 exec, vcc
Lrt_167:
 buffer_load_dwordx4 v[12:15], v3, s[20:23], s39 offen offset:0 sc1
 buffer_load_dwordx4 v[16:19], v3, s[20:23], s39 offen offset:1024 sc1
 s_waitcnt vmcnt(2)
 v_bitop3_b32 v55, v13, v15, s46 bitop3:0x7e
 v_bitop3_b32 v56, v17, v19, s46 bitop3:0x7e
 v_bitop3_b32 v55, v55, 1, v56 bitop3:0xc8
 v_cmpx_ne_u32 vcc, 0, v55
 s_cbranch_execz Lrte_168
 buffer_load_dwordx4 v[12:15], v3, s[20:23], s39 offen offset:0 sc1
 buffer_load_dwordx4 v[16:19], v3, s[20:23], s39 offen offset:1024 sc1
 s_waitcnt vmcnt(2)
 v_bitop3_b32 v55, v13, v15, s46 bitop3:0x7e
 v_bitop3_b32 v56, v17, v19, s46 bitop3:0x7e
 v_bitop3_b32 v55, v55, 1, v56 bitop3:0xc8
 v_cmpx_ne_u32 vcc, 0, v55
 s_cbranch_execz Lrte_168
 buffer_load_dwordx4 v[12:15], v3, s[20:23], s39 offen offset:0 sc1
 buffer_load_dwordx4 v[16:19], v3, s[20:23], s39 offen offset:1024 sc1
 s_waitcnt vmcnt(2)
 v_bitop3_b32 v55, v13, v15, s46 bitop3:0x7e
 v_bitop3_b32 v56, v17, v19, s46 bitop3:0x7e
 v_bitop3_b32 v55, v55, 1, v56 bitop3:0xc8
 v_cmpx_ne_u32 vcc, 0, v55
 s_cbranch_execz Lrte_168
 s_sub_u32 s54, s54, 1
 s_cbranch_scc0 Lrt_167
 s_endpgm
Lrte_168:
 s_mov_b64 exec, -1
 s_mov_b32 s50, 0
 s_nop 1
 v_mfma_f32_16x16x32_bf16 v[48:51], v[44:47], v[12:15], 0
 v_mfma_f32_16x16x32_bf16 v[48:51], v[44:47], v[16:19], v[48:51]
 s_nop 7
 v_add_f32_dpp v48, v48, v48 row_ror:4 row_mask:0xf bank_mask:0xf
 v_add_f32_dpp v49, v49, v49 row_ror:4 row_mask:0xf bank_mask:0xf
 s_nop 0
 v_add_f32_dpp v48, v48, v48 row_ror:8 row_mask:0xf bank_mask:0xf
 v_add_f32_dpp v49, v49, v49 row_ror:8 row_mask:0xf bank_mask:0xf
 v_cvt_pk_bf16_f32 v48, v48, v49
 buffer_store_dword v48, v52, s[20:23], s44 offen sc1
 s_branch Lb1_152
Lfw_142:
Lpb_169:
 buffer_load_dword v1, v7, s[20:23], s56 offen sc1
 s_waitcnt vmcnt(0)
 v_cmp_le_u32 vcc, s58, v1
 s_cbranch_vccnz Lpbok_170
 s_sub_u32 s54, s54, 1
 s_cbranch_scc0 Lpb_169
 s_endpgm
Lpbok_170:
 s_branch Lfok_141
Lfw_148:
Lpb_171:
 buffer_load_dword v1, v7, s[20:23], s56 offen sc1
 s_waitcnt vmcnt(0)
 v_cmp_le_u32 vcc, s58, v1
 s_cbranch_vccnz Lpbok_172
 s_sub_u32 s54, s54, 1
 s_cbranch_scc0 Lpb_171
 s_endpgm
Lpbok_172:
 s_branch Lfok_147
Lfw_154:
Lpb_173:
 buffer_load_dword v1, v7, s[20:23], s56 offen sc1
 s_waitcnt vmcnt(0)
 v_cmp_le_u32 vcc, s58, v1
 s_cbranch_vccnz Lpbok_174
 s_sub_u32 s54, s54, 1
 s_cbranch_scc0 Lpb_173
 s_endpgm
Lpbok_174:
 s_branch Lfok_153
Lfw_159:
Lpb_175:
 buffer_load_dword v1, v7, s[20:23], s56 offen sc1
 s_waitcnt vmcnt(0)
 v_cmp_le_u32 vcc, s58, v1
 s_cbranch_vccnz Lpbok_176
 s_sub_u32 s54, s54, 1
 s_cbranch_scc0 Lpb_175
 s_endpgm
Lpbok_176:
 s_branch Lfok_158
Lfail_125:
 s_endpgm
Lchexit_70:
 s_add_u32 s38, s38, 0x10000
 v_add_u32 v6, s69, v9
 ds_read_b64 v[64:65], v6 offset:19456
 v_mov_b32 v66, v2
 v_mov_b32 v67, v4
 s_waitcnt lgkmcnt(0)
 buffer_store_dwordx4 v[64:67], v0, s[20:23], s38 offen sc1
 s_waitcnt vmcnt(0) lgkmcnt(0)
 s_barrier
 v_subrev_u32 v0, 0x10000, v0
 v_min_u32 v0, 16, v0
 v_lshlrev_b32 v0, 24, v0
 v_mov_b32 v6, 64
 buffer_store_dword v6, v0, s[20:23], s57 offen sc1
Lfin:
Lend:
 s_endpgm
Lredo:
 s_mov_b32 s88, s89
 s_waitcnt vmcnt(0) lgkmcnt(0)
 s_barrier
 s_branch Lrole
.section .rodata,"a"
.p2align 6
.amdhsa_kernel concat_heads__compressed_kv_cla__memory_aug_recurrent_mem_tr__prompt_kernel
  .amdhsa_next_free_vgpr 512
  .amdhsa_next_free_sgpr 102
  .amdhsa_accum_offset 256
  .amdhsa_group_segment_fixed_size 0
  .amdhsa_kernarg_size 128
  .amdhsa_user_sgpr_count 2
  .amdhsa_user_sgpr_kernarg_segment_ptr 1
  .amdhsa_system_sgpr_workgroup_id_x 1
  .amdhsa_float_denorm_mode_32 3
.end_amdhsa_kernel
```

```asm
; @launch grid=(256,1,1) block=(256,1,1) lds=163840
.amdgcn_target "amdgcn-amd-amdhsa--gfx950"
.text
.globl concat_heads__compressed_kv_cla__memory_aug_recurrent_mem_tr__prompt_kernel
.p2align 8
.type concat_heads__compressed_kv_cla__memory_aug_recurrent_mem_tr__prompt_kernel,@function
concat_heads__compressed_kv_cla__memory_aug_recurrent_mem_tr__prompt_kernel:
 s_cmp_ge_u32 s2, 256
 s_cbranch_scc1 Lend
 s_load_dwordx2 s[20:21], s[0:1], 120
 s_mov_b32 s22, 0x10000000
 s_mov_b32 s23, 0x20000
 s_load_dwordx2 s[28:29], s[0:1], 112
 s_mov_b32 s30, 0x100
 s_mov_b32 s31, 0x20000
 v_lshrrev_b32 v1, 6, v0
 s_lshr_b32 s6, s2, 3
 s_lshr_b32 s86, s2, 5
 v_readfirstlane_b32 s4, v1
 s_getreg_b32 s73, hwreg(HW_REG_XCC_ID, 0, 3)
 s_sub_u32 s88, s73, s2
 s_and_b32 s88, s88, 7
 s_add_u32 s88, s88, 1
 s_mov_b32 s95, 0x40000
 s_waitcnt lgkmcnt(0)
 s_cmp_eq_u32 s2, 0
 s_cbranch_scc0 Lrole
 v_min_u32 v1, 1, v0
 v_lshlrev_b32 v1, 28, v1
 v_mov_b32 v2, s88
 buffer_store_dword v2, v1, s[28:31], 0 offen offset:4 sc1
Lrole:
 s_add_u32 s5, s2, s88
 s_sub_u32 s5, s5, 1
 s_and_b32 s5, s5, 7
 s_lshl_b32 s5, s5, 2
 s_lshr_b32 s5, 0x76532041, s5
 s_and_b32 s5, s5, 7
 s_getpc_b64 s[8:9]
Lpc:
 s_lshl_b32 s7, s6, 13
 s_cmp_le_u32 s7, Lend - Lpc
 s_cselect_b32 s3, s4, 1
 s_cmp_eq_u32 s3, 0
 s_cbranch_scc0 Lcpf
 v_lshl_add_u32 v1, v0, 7, s7
 v_min_u32 v1, Lend - Lpc, v1
 global_load_dword v255, v1, s[8:9]
Lcpf:
 s_cmp_eq_u32 s5, 0
 s_cbranch_scc1 Lchain
 s_cmp_eq_u32 s5, 1
 s_cbranch_scc1 Lpb
 s_cmp_lt_u32 s5, 4
 s_cbranch_scc1 Lqa
 s_load_dwordx2 s[8:9], s[0:1], 8
 s_mov_b32 s10, 0x200000
 s_mov_b32 s11, 0x20000
 s_load_dwordx2 s[12:13], s[0:1], 24
 s_mov_b32 s14, 0x400000
 s_mov_b32 s15, 0x20000
 s_load_dwordx2 s[16:17], s[0:1], 32
 s_mov_b32 s18, 0x400000
 s_mov_b32 s19, 0x20000
 s_sub_u32 s3, s5, 4
 s_lshl_b32 s3, s3, 3
 s_lshr_b32 s7, s6, 2
 s_add_u32 s3, s3, s7
 s_lshl_b32 s32, s3, 8
 s_mov_b32 s33, s32
 s_lshl_b32 s34, s3, 14
 s_add_u32 s34, s34, 0x1000000
 s_add_u32 s35, s34, 8192
 s_mov_b32 s36, 16
 s_and_b32 s37, s6, 3
 s_lshl_b32 s7, s3, 5
 s_add_u32 s7, s7, s37
 s_lshl_b32 s7, s7, 2
 s_add_u32 s7, s7, 0x2000
 v_min_u32 v1, 1, v0
 v_lshlrev_b32 v1, 28, v1
 v_add_u32 v13, s7, v1
 s_waitcnt lgkmcnt(0)
 v_and_b32 v1, 63, v0
 v_lshrrev_b32 v2, 3, v0
 v_mul_u32_u24 v10, 1024, v2
 v_lshrrev_b32 v2, 4, v0
 v_xor_b32 v2, v2, v0
 v_and_b32 v2, 7, v2
 v_lshl_add_u32 v10, v2, 4, v10
 v_lshrrev_b32 v2, 4, v1
 v_bfe_u32 v3, v1, 1, 3
 v_xor_b32 v2, v2, v3
 v_and_b32 v3, 15, v1
 v_lshlrev_b32 v3, 7, v3
 v_lshl_add_u32 v4, v2, 4, v3
 v_xor_b32 v5, 64, v4
 v_lshrrev_b32 v2, 4, v0
 v_lshlrev_b32 v11, 13, v2
 v_lshrrev_b32 v2, 7, v0
 v_lshrrev_b32 v3, 4, v1
 v_lshl_add_u32 v3, v2, 2, v3
 v_bfe_u32 v2, v1, 1, 3
 v_xor_b32 v2, v2, v3
 v_lshl_add_u32 v11, v2, 5, v11
 v_and_b32 v2, 1, v1
 v_lshl_add_u32 v11, v2, 4, v11
 v_bfe_u32 v2, v1, 2, 3
 v_xor_b32 v3, s4, v2
 v_lshlrev_b32 v3, 5, v3
 v_and_b32 v2, 3, v2
 v_lshl_add_u32 v3, v2, 8, v3
 v_lshrrev_b32 v2, 4, v1
 v_lshl_add_u32 v3, v2, 11, v3
 v_and_b32 v2, 3, v1
 v_lshl_add_u32 v3, v2, 3, v3
 v_add_u32 v8, 65536, v3
 v_xor_b32 v3, 0x80, v3
 v_add_u32 v9, 65536, v3
 s_lshl_b32 s45, s4, 11
 v_lshl_add_u32 v12, v1, 4, s45
 s_mov_b32 s39, s37
 s_add_u32 s40, s39, 4
 s_min_u32 s40, s40, 63
 s_lshl_b32 s49, s4, 10
 s_mul_i32 s46, s39, 32768
 s_add_u32 m0, s49, 0
 s_nop 0
 buffer_load_dwordx4 v10, s[8:11], s46 offen offset:0  lds
 s_add_u32 m0, s49, 3968
 s_nop 0
 buffer_load_dwordx4 v10, s[8:11], s46 offen offset:128  lds
 s_add_u32 m0, s49, 7936
 s_nop 0
 buffer_load_dwordx4 v10, s[8:11], s46 offen offset:256  lds
 s_add_u32 m0, s49, 11904
 s_nop 0
 buffer_load_dwordx4 v10, s[8:11], s46 offen offset:384  lds
 s_add_u32 m0, s49, 15872
 s_nop 0
 buffer_load_dwordx4 v10, s[8:11], s46 offen offset:512  lds
 s_add_u32 m0, s49, 19840
 s_nop 0
 buffer_load_dwordx4 v10, s[8:11], s46 offen offset:640  lds
 s_add_u32 m0, s49, 23808
 s_nop 0
 buffer_load_dwordx4 v10, s[8:11], s46 offen offset:768  lds
 s_add_u32 m0, s49, 27776
 s_nop 0
 buffer_load_dwordx4 v10, s[8:11], s46 offen offset:896  lds
 s_lshl_b32 s49, s4, 10
 s_add_u32 s49, s49, 32768
 s_mul_i32 s46, s40, 32768
 s_add_u32 m0, s49, 0
 s_nop 0
 buffer_load_dwordx4 v10, s[8:11], s46 offen offset:0  lds
 s_add_u32 m0, s49, 3968
 s_nop 0
 buffer_load_dwordx4 v10, s[8:11], s46 offen offset:128  lds
 s_add_u32 m0, s49, 7936
 s_nop 0
 buffer_load_dwordx4 v10, s[8:11], s46 offen offset:256  lds
 s_add_u32 m0, s49, 11904
 s_nop 0
 buffer_load_dwordx4 v10, s[8:11], s46 offen offset:384  lds
 s_add_u32 m0, s49, 15872
 s_nop 0
 buffer_load_dwordx4 v10, s[8:11], s46 offen offset:512  lds
 s_add_u32 m0, s49, 19840
 s_nop 0
 buffer_load_dwordx4 v10, s[8:11], s46 offen offset:640  lds
 s_add_u32 m0, s49, 23808
 s_nop 0
 buffer_load_dwordx4 v10, s[8:11], s46 offen offset:768  lds
 s_add_u32 m0, s49, 27776
 s_nop 0
 buffer_load_dwordx4 v10, s[8:11], s46 offen offset:896  lds
 s_lshl_b32 s49, s4, 10
 s_add_u32 m0, s49, 65536
 s_add_u32 s45, s32, 0
 buffer_load_dwordx4 v11, s[12:15], s45 offen  lds
 s_add_u32 m0, s49, 69632
 s_add_u32 s45, s32, 131072
 buffer_load_dwordx4 v11, s[12:15], s45 offen  lds
 s_add_u32 m0, s49, 73728
 s_add_u32 s45, s33, 0
 buffer_load_dwordx4 v11, s[16:19], s45 offen  lds
 s_add_u32 m0, s49, 77824
 s_add_u32 s45, s33, 131072
 buffer_load_dwordx4 v11, s[16:19], s45 offen  lds
 s_add_u32 m0, s49, 81920
 s_add_u32 s45, s32, 262144
 buffer_load_dwordx4 v11, s[12:15], s45 offen  lds
 s_add_u32 m0, s49, 86016
 s_add_u32 s45, s32, 393216
 buffer_load_dwordx4 v11, s[12:15], s45 offen  lds
 s_add_u32 m0, s49, 90112
 s_add_u32 s45, s33, 262144
 buffer_load_dwordx4 v11, s[16:19], s45 offen  lds
 s_add_u32 m0, s49, 94208
 s_add_u32 s45, s33, 393216
 buffer_load_dwordx4 v11, s[16:19], s45 offen  lds
 s_add_u32 m0, s49, 98304
 s_add_u32 s45, s32, 524288
 buffer_load_dwordx4 v11, s[12:15], s45 offen  lds
 s_add_u32 m0, s49, 102400
 s_add_u32 s45, s32, 655360
 buffer_load_dwordx4 v11, s[12:15], s45 offen  lds
 s_add_u32 m0, s49, 106496
 s_add_u32 s45, s33, 524288
 buffer_load_dwordx4 v11, s[16:19], s45 offen  lds
 s_add_u32 m0, s49, 110592
 s_add_u32 s45, s33, 655360
 buffer_load_dwordx4 v11, s[16:19], s45 offen  lds
 s_waitcnt vmcnt(8) lgkmcnt(0)
 s_barrier
 s_add_u32 m0, s49, 114688
 s_add_u32 s45, s32, 786432
 buffer_load_dwordx4 v11, s[12:15], s45 offen  lds
 s_add_u32 m0, s49, 118784
 s_add_u32 s45, s32, 917504
 buffer_load_dwordx4 v11, s[12:15], s45 offen  lds
 s_add_u32 m0, s49, 122880
 s_add_u32 s45, s33, 786432
 buffer_load_dwordx4 v11, s[16:19], s45 offen  lds
 s_add_u32 m0, s49, 126976
 s_add_u32 s45, s33, 917504
 buffer_load_dwordx4 v11, s[16:19], s45 offen  lds
 ds_read_b64_tr_b16 a[0:1], v8 offset:0
 ds_read_b64_tr_b16 a[2:3], v8 offset:1024
 ds_read_b64_tr_b16 a[64:65], v9 offset:0
 ds_read_b64_tr_b16 a[66:67], v9 offset:1024
 ds_read_b64_tr_b16 a[128:129], v8 offset:8192
 ds_read_b64_tr_b16 a[130:131], v8 offset:9216
 ds_read_b64_tr_b16 a[192:193], v9 offset:8192
 ds_read_b64_tr_b16 a[194:195], v9 offset:9216
 s_waitcnt vmcnt(8) lgkmcnt(0)
 s_barrier
 s_add_u32 m0, s49, 65536
 s_add_u32 s45, s32, 1048576
 buffer_load_dwordx4 v11, s[12:15], s45 offen  lds
 s_add_u32 m0, s49, 69632
 s_add_u32 s45, s32, 1179648
 buffer_load_dwordx4 v11, s[12:15], s45 offen  lds
 s_add_u32 m0, s49, 73728
 s_add_u32 s45, s33, 1048576
 buffer_load_dwordx4 v11, s[16:19], s45 offen  lds
 s_add_u32 m0, s49, 77824
 s_add_u32 s45, s33, 1179648
 buffer_load_dwordx4 v11, s[16:19], s45 offen  lds
 ds_read_b64_tr_b16 a[4:5], v8 offset:16384
 ds_read_b64_tr_b16 a[6:7], v8 offset:17408
 ds_read_b64_tr_b16 a[68:69], v9 offset:16384
 ds_read_b64_tr_b16 a[70:71], v9 offset:17408
 ds_read_b64_tr_b16 a[132:133], v8 offset:24576
 ds_read_b64_tr_b16 a[134:135], v8 offset:25600
 ds_read_b64_tr_b16 a[196:197], v9 offset:24576
 ds_read_b64_tr_b16 a[198:199], v9 offset:25600
 s_waitcnt vmcnt(8) lgkmcnt(0)
 s_barrier
 s_add_u32 m0, s49, 81920
 s_add_u32 s45, s32, 1310720
 buffer_load_dwordx4 v11, s[12:15], s45 offen  lds
 s_add_u32 m0, s49, 86016
 s_add_u32 s45, s32, 1441792
 buffer_load_dwordx4 v11, s[12:15], s45 offen  lds
 s_add_u32 m0, s49, 90112
 s_add_u32 s45, s33, 1310720
 buffer_load_dwordx4 v11, s[16:19], s45 offen  lds
 s_add_u32 m0, s49, 94208
 s_add_u32 s45, s33, 1441792
 buffer_load_dwordx4 v11, s[16:19], s45 offen  lds
 ds_read_b64_tr_b16 a[8:9], v8 offset:32768
 ds_read_b64_tr_b16 a[10:11], v8 offset:33792
 ds_read_b64_tr_b16 a[72:73], v9 offset:32768
 ds_read_b64_tr_b16 a[74:75], v9 offset:33792
 ds_read_b64_tr_b16 a[136:137], v8 offset:40960
 ds_read_b64_tr_b16 a[138:139], v8 offset:41984
 ds_read_b64_tr_b16 a[200:201], v9 offset:40960
 ds_read_b64_tr_b16 a[202:203], v9 offset:41984
 s_waitcnt vmcnt(8) lgkmcnt(0)
 s_barrier
 s_add_u32 m0, s49, 98304
 s_add_u32 s45, s32, 1572864
 buffer_load_dwordx4 v11, s[12:15], s45 offen  lds
 s_add_u32 m0, s49, 102400
 s_add_u32 s45, s32, 1703936
 buffer_load_dwordx4 v11, s[12:15], s45 offen  lds
 s_add_u32 m0, s49, 106496
 s_add_u32 s45, s33, 1572864
 buffer_load_dwordx4 v11, s[16:19], s45 offen  lds
 s_add_u32 m0, s49, 110592
 s_add_u32 s45, s33, 1703936
 buffer_load_dwordx4 v11, s[16:19], s45 offen  lds
 ds_read_b64_tr_b16 a[12:13], v8 offset:49152
 ds_read_b64_tr_b16 a[14:15], v8 offset:50176
 ds_read_b64_tr_b16 a[76:77], v9 offset:49152
 ds_read_b64_tr_b16 a[78:79], v9 offset:50176
 ds_read_b64_tr_b16 a[140:141], v8 offset:57344
 ds_read_b64_tr_b16 a[142:143], v8 offset:58368
 ds_read_b64_tr_b16 a[204:205], v9 offset:57344
 ds_read_b64_tr_b16 a[206:207], v9 offset:58368
 s_waitcnt vmcnt(8) lgkmcnt(0)
 s_barrier
 s_add_u32 m0, s49, 114688
 s_add_u32 s45, s32, 1835008
 buffer_load_dwordx4 v11, s[12:15], s45 offen  lds
 s_add_u32 m0, s49, 118784
 s_add_u32 s45, s32, 1966080
 buffer_load_dwordx4 v11, s[12:15], s45 offen  lds
 s_add_u32 m0, s49, 122880
 s_add_u32 s45, s33, 1835008
 buffer_load_dwordx4 v11, s[16:19], s45 offen  lds
 s_add_u32 m0, s49, 126976
 s_add_u32 s45, s33, 1966080
 buffer_load_dwordx4 v11, s[16:19], s45 offen  lds
 ds_read_b64_tr_b16 a[16:17], v8 offset:0
 ds_read_b64_tr_b16 a[18:19], v8 offset:1024
 ds_read_b64_tr_b16 a[80:81], v9 offset:0
 ds_read_b64_tr_b16 a[82:83], v9 offset:1024
 ds_read_b64_tr_b16 a[144:145], v8 offset:8192
 ds_read_b64_tr_b16 a[146:147], v8 offset:9216
 ds_read_b64_tr_b16 a[208:209], v9 offset:8192
 ds_read_b64_tr_b16 a[210:211], v9 offset:9216
 s_waitcnt vmcnt(8) lgkmcnt(0)
 s_barrier
 s_add_u32 m0, s49, 65536
 s_add_u32 s45, s32, 2097152
 buffer_load_dwordx4 v11, s[12:15], s45 offen  lds
 s_add_u32 m0, s49, 69632
 s_add_u32 s45, s32, 2228224
 buffer_load_dwordx4 v11, s[12:15], s45 offen  lds
 s_add_u32 m0, s49, 73728
 s_add_u32 s45, s33, 2097152
 buffer_load_dwordx4 v11, s[16:19], s45 offen  lds
 s_add_u32 m0, s49, 77824
 s_add_u32 s45, s33, 2228224
 buffer_load_dwordx4 v11, s[16:19], s45 offen  lds
 ds_read_b64_tr_b16 a[20:21], v8 offset:16384
 ds_read_b64_tr_b16 a[22:23], v8 offset:17408
 ds_read_b64_tr_b16 a[84:85], v9 offset:16384
 ds_read_b64_tr_b16 a[86:87], v9 offset:17408
 ds_read_b64_tr_b16 a[148:149], v8 offset:24576
 ds_read_b64_tr_b16 a[150:151], v8 offset:25600
 ds_read_b64_tr_b16 a[212:213], v9 offset:24576
 ds_read_b64_tr_b16 a[214:215], v9 offset:25600
 s_waitcnt vmcnt(8) lgkmcnt(0)
 s_barrier
 s_add_u32 m0, s49, 81920
 s_add_u32 s45, s32, 2359296
 buffer_load_dwordx4 v11, s[12:15], s45 offen  lds
 s_add_u32 m0, s49, 86016
 s_add_u32 s45, s32, 2490368
 buffer_load_dwordx4 v11, s[12:15], s45 offen  lds
 s_add_u32 m0, s49, 90112
 s_add_u32 s45, s33, 2359296
 buffer_load_dwordx4 v11, s[16:19], s45 offen  lds
 s_add_u32 m0, s49, 94208
 s_add_u32 s45, s33, 2490368
 buffer_load_dwordx4 v11, s[16:19], s45 offen  lds
 ds_read_b64_tr_b16 a[24:25], v8 offset:32768
 ds_read_b64_tr_b16 a[26:27], v8 offset:33792
 ds_read_b64_tr_b16 a[88:89], v9 offset:32768
 ds_read_b64_tr_b16 a[90:91], v9 offset:33792
 ds_read_b64_tr_b16 a[152:153], v8 offset:40960
 ds_read_b64_tr_b16 a[154:155], v8 offset:41984
 ds_read_b64_tr_b16 a[216:217], v9 offset:40960
 ds_read_b64_tr_b16 a[218:219], v9 offset:41984
 s_waitcnt vmcnt(8) lgkmcnt(0)
 s_barrier
 s_add_u32 m0, s49, 98304
 s_add_u32 s45, s32, 2621440
 buffer_load_dwordx4 v11, s[12:15], s45 offen  lds
 s_add_u32 m0, s49, 102400
 s_add_u32 s45, s32, 2752512
 buffer_load_dwordx4 v11, s[12:15], s45 offen  lds
 s_add_u32 m0, s49, 106496
 s_add_u32 s45, s33, 2621440
 buffer_load_dwordx4 v11, s[16:19], s45 offen  lds
 s_add_u32 m0, s49, 110592
 s_add_u32 s45, s33, 2752512
 buffer_load_dwordx4 v11, s[16:19], s45 offen  lds
 ds_read_b64_tr_b16 a[28:29], v8 offset:49152
 ds_read_b64_tr_b16 a[30:31], v8 offset:50176
 ds_read_b64_tr_b16 a[92:93], v9 offset:49152
 ds_read_b64_tr_b16 a[94:95], v9 offset:50176
 ds_read_b64_tr_b16 a[156:157], v8 offset:57344
 ds_read_b64_tr_b16 a[158:159], v8 offset:58368
 ds_read_b64_tr_b16 a[220:221], v9 offset:57344
 ds_read_b64_tr_b16 a[222:223], v9 offset:58368
 s_waitcnt vmcnt(8) lgkmcnt(0)
 s_barrier
 s_add_u32 m0, s49, 114688
 s_add_u32 s45, s32, 2883584
 buffer_load_dwordx4 v11, s[12:15], s45 offen  lds
 s_add_u32 m0, s49, 118784
 s_add_u32 s45, s32, 3014656
 buffer_load_dwordx4 v11, s[12:15], s45 offen  lds
 s_add_u32 m0, s49, 122880
 s_add_u32 s45, s33, 2883584
 buffer_load_dwordx4 v11, s[16:19], s45 offen  lds
 s_add_u32 m0, s49, 126976
 s_add_u32 s45, s33, 3014656
 buffer_load_dwordx4 v11, s[16:19], s45 offen  lds
 ds_read_b64_tr_b16 a[32:33], v8 offset:0
 ds_read_b64_tr_b16 a[34:35], v8 offset:1024
 ds_read_b64_tr_b16 a[96:97], v9 offset:0
 ds_read_b64_tr_b16 a[98:99], v9 offset:1024
 ds_read_b64_tr_b16 a[160:161], v8 offset:8192
 ds_read_b64_tr_b16 a[162:163], v8 offset:9216
 ds_read_b64_tr_b16 a[224:225], v9 offset:8192
 ds_read_b64_tr_b16 a[226:227], v9 offset:9216
 s_waitcnt vmcnt(8) lgkmcnt(0)
 s_barrier
 s_add_u32 m0, s49, 65536
 s_add_u32 s45, s32, 3145728
 buffer_load_dwordx4 v11, s[12:15], s45 offen  lds
 s_add_u32 m0, s49, 69632
 s_add_u32 s45, s32, 3276800
 buffer_load_dwordx4 v11, s[12:15], s45 offen  lds
 s_add_u32 m0, s49, 73728
 s_add_u32 s45, s33, 3145728
 buffer_load_dwordx4 v11, s[16:19], s45 offen  lds
 s_add_u32 m0, s49, 77824
 s_add_u32 s45, s33, 3276800
 buffer_load_dwordx4 v11, s[16:19], s45 offen  lds
 ds_read_b64_tr_b16 a[36:37], v8 offset:16384
 ds_read_b64_tr_b16 a[38:39], v8 offset:17408
 ds_read_b64_tr_b16 a[100:101], v9 offset:16384
 ds_read_b64_tr_b16 a[102:103], v9 offset:17408
 ds_read_b64_tr_b16 a[164:165], v8 offset:24576
 ds_read_b64_tr_b16 a[166:167], v8 offset:25600
 ds_read_b64_tr_b16 a[228:229], v9 offset:24576
 ds_read_b64_tr_b16 a[230:231], v9 offset:25600
 s_waitcnt vmcnt(8) lgkmcnt(0)
 s_barrier
 s_add_u32 m0, s49, 81920
 s_add_u32 s45, s32, 3407872
 buffer_load_dwordx4 v11, s[12:15], s45 offen  lds
 s_add_u32 m0, s49, 86016
 s_add_u32 s45, s32, 3538944
 buffer_load_dwordx4 v11, s[12:15], s45 offen  lds
 s_add_u32 m0, s49, 90112
 s_add_u32 s45, s33, 3407872
 buffer_load_dwordx4 v11, s[16:19], s45 offen  lds
 s_add_u32 m0, s49, 94208
 s_add_u32 s45, s33, 3538944
 buffer_load_dwordx4 v11, s[16:19], s45 offen  lds
 ds_read_b64_tr_b16 a[40:41], v8 offset:32768
 ds_read_b64_tr_b16 a[42:43], v8 offset:33792
 ds_read_b64_tr_b16 a[104:105], v9 offset:32768
 ds_read_b64_tr_b16 a[106:107], v9 offset:33792
 ds_read_b64_tr_b16 a[168:169], v8 offset:40960
 ds_read_b64_tr_b16 a[170:171], v8 offset:41984
 ds_read_b64_tr_b16 a[232:233], v9 offset:40960
 ds_read_b64_tr_b16 a[234:235], v9 offset:41984
 s_waitcnt vmcnt(8) lgkmcnt(0)
 s_barrier
 s_add_u32 m0, s49, 98304
 s_add_u32 s45, s32, 3670016
 buffer_load_dwordx4 v11, s[12:15], s45 offen  lds
 s_add_u32 m0, s49, 102400
 s_add_u32 s45, s32, 3801088
 buffer_load_dwordx4 v11, s[12:15], s45 offen  lds
 s_add_u32 m0, s49, 106496
 s_add_u32 s45, s33, 3670016
 buffer_load_dwordx4 v11, s[16:19], s45 offen  lds
 s_add_u32 m0, s49, 110592
 s_add_u32 s45, s33, 3801088
 buffer_load_dwordx4 v11, s[16:19], s45 offen  lds
 ds_read_b64_tr_b16 a[44:45], v8 offset:49152
 ds_read_b64_tr_b16 a[46:47], v8 offset:50176
 ds_read_b64_tr_b16 a[108:109], v9 offset:49152
 ds_read_b64_tr_b16 a[110:111], v9 offset:50176
 ds_read_b64_tr_b16 a[172:173], v8 offset:57344
 ds_read_b64_tr_b16 a[174:175], v8 offset:58368
 ds_read_b64_tr_b16 a[236:237], v9 offset:57344
 ds_read_b64_tr_b16 a[238:239], v9 offset:58368
 s_waitcnt vmcnt(8) lgkmcnt(0)
 s_barrier
 s_add_u32 m0, s49, 114688
 s_add_u32 s45, s32, 3932160
 buffer_load_dwordx4 v11, s[12:15], s45 offen  lds
 s_add_u32 m0, s49, 118784
 s_add_u32 s45, s32, 4063232
 buffer_load_dwordx4 v11, s[12:15], s45 offen  lds
 s_add_u32 m0, s49, 122880
 s_add_u32 s45, s33, 3932160
 buffer_load_dwordx4 v11, s[16:19], s45 offen  lds
 s_add_u32 m0, s49, 126976
 s_add_u32 s45, s33, 4063232
 buffer_load_dwordx4 v11, s[16:19], s45 offen  lds
 ds_read_b64_tr_b16 a[48:49], v8 offset:0
 ds_read_b64_tr_b16 a[50:51], v8 offset:1024
 ds_read_b64_tr_b16 a[112:113], v9 offset:0
 ds_read_b64_tr_b16 a[114:115], v9 offset:1024
 ds_read_b64_tr_b16 a[176:177], v8 offset:8192
 ds_read_b64_tr_b16 a[178:179], v8 offset:9216
 ds_read_b64_tr_b16 a[240:241], v9 offset:8192
 ds_read_b64_tr_b16 a[242:243], v9 offset:9216
 s_waitcnt vmcnt(8) lgkmcnt(0)
 s_barrier
 ds_read_b64_tr_b16 a[52:53], v8 offset:16384
 ds_read_b64_tr_b16 a[54:55], v8 offset:17408
 ds_read_b64_tr_b16 a[116:117], v9 offset:16384
 ds_read_b64_tr_b16 a[118:119], v9 offset:17408
 ds_read_b64_tr_b16 a[180:181], v8 offset:24576
 ds_read_b64_tr_b16 a[182:183], v8 offset:25600
 ds_read_b64_tr_b16 a[244:245], v9 offset:24576
 ds_read_b64_tr_b16 a[246:247], v9 offset:25600
 s_waitcnt vmcnt(4) lgkmcnt(0)
 s_barrier
 ds_read_b64_tr_b16 a[56:57], v8 offset:32768
 ds_read_b64_tr_b16 a[58:59], v8 offset:33792
 ds_read_b64_tr_b16 a[120:121], v9 offset:32768
 ds_read_b64_tr_b16 a[122:123], v9 offset:33792
 ds_read_b64_tr_b16 a[184:185], v8 offset:40960
 ds_read_b64_tr_b16 a[186:187], v8 offset:41984
 ds_read_b64_tr_b16 a[248:249], v9 offset:40960
 ds_read_b64_tr_b16 a[250:251], v9 offset:41984
 s_waitcnt vmcnt(0) lgkmcnt(0)
 s_barrier
 ds_read_b64_tr_b16 a[60:61], v8 offset:49152
 ds_read_b64_tr_b16 a[62:63], v8 offset:50176
 ds_read_b64_tr_b16 a[124:125], v9 offset:49152
 ds_read_b64_tr_b16 a[126:127], v9 offset:50176
 ds_read_b64_tr_b16 a[188:189], v8 offset:57344
 ds_read_b64_tr_b16 a[190:191], v8 offset:58368
 ds_read_b64_tr_b16 a[252:253], v9 offset:57344
 ds_read_b64_tr_b16 a[254:255], v9 offset:58368
 s_mov_b32 s50, 0x3e0293ee
 s_mov_b32 s42, 0
 s_mov_b32 s43, 0
 s_mov_b32 s44, 65536
 v_mov_b32 v6, v4
 v_mov_b32 v7, v5
Lrh_3:
 v_mbcnt_lo_u32_b32 v21, -1, 0
 v_min_u32 v21, 1, v21
 v_lshlrev_b32 v21, 28, v21
 buffer_load_dword v20, v21, s[28:31], 0 offen offset:4 sc1
 s_waitcnt vmcnt(0)
Lrhc_4:
 v_readfirstlane_b32 s89, v20
 s_cmp_eq_u32 s89, s88
 s_cbranch_scc1 Lrhk_5
 s_cmp_lg_u32 s89, 0
 s_cbranch_scc1 Lredo
 s_sub_u32 s95, s95, 1
 s_cbranch_scc0 Lrh_3
 s_endpgm
Lrhk_5:
 s_cmp_lg_u32 s4, 0
 s_cbranch_scc1 Lfrk_2
 v_min_u32 v21, 1, v0
 v_lshlrev_b32 v21, 28, v21
Lfr_1:
 buffer_load_dword v20, v21, s[28:31], 0 offen offset:0 sc1
 s_waitcnt vmcnt(0)
 v_cmp_eq_u32 vcc, 1, v20
 s_cbranch_vccnz Lfrk_2
 s_sub_u32 s95, s95, 1
 s_cbranch_scc0 Lfr_1
 s_endpgm
Lfrk_2:
 s_lshl_b32 s47, s2, 13
 s_add_u32 s47, s47, 0x8000000
 s_mov_b32 s48, s47
 v_mov_b32 v14, 0
 s_waitcnt vmcnt(0) lgkmcnt(0)
 s_barrier
 ds_read_b128 v[32:35], v6 offset:0
 ds_read_b128 v[36:39], v6 offset:2048
 ds_read_b128 v[40:43], v7 offset:0
 ds_read_b128 v[44:47], v7 offset:2048
 s_mul_i32 s45, s86, 4096
 v_lshl_add_u32 v1, v0, 7, s45
 v_add_u32 v1, 262144, v1
 v_mov_b32 v2, 0x7ff00000
 v_cmp_gt_u32 vcc, 32, v0
 s_nop 1
 v_cndmask_b32 v1, v2, v1, vcc
 s_waitcnt lgkmcnt(2)
Lps_loop_6:
 v_mfma_f32_16x16x32_bf16 v[64:67], a[0:3], v[32:35], 0
 ds_read_b128 v[48:51], v6 offset:4096
 v_mfma_f32_16x16x32_bf16 v[72:75], a[64:67], v[32:35], 0
 ds_read_b128 v[52:55], v6 offset:6144
 v_mfma_f32_16x16x32_bf16 v[80:83], v[32:35], a[128:131], 0
 s_add_u32 s41, s40, 4
 v_mfma_f32_16x16x32_bf16 v[88:91], v[32:35], a[192:195], 0
 s_add_u32 s45, s42, 2
 s_mul_i32 s46, s41, 32768
 v_mfma_f32_16x16x32_bf16 v[68:71], a[0:3], v[36:39], 0
 s_cmp_lt_u32 s45, s36
 s_cselect_b32 s46, s46, 0
 v_mfma_f32_16x16x32_bf16 v[76:79], a[64:67], v[36:39], 0
 s_lshl_b32 s49, s4, 10
 s_add_u32 s49, s49, s44
 v_mfma_f32_16x16x32_bf16 v[84:87], v[36:39], a[128:131], 0
 v_mfma_f32_16x16x32_bf16 v[92:95], v[36:39], a[192:195], 0
 s_waitcnt lgkmcnt(2)
 v_mfma_f32_16x16x32_bf16 v[64:67], a[4:7], v[40:43], v[64:67]
 ds_read_b128 v[56:59], v7 offset:4096
 v_mfma_f32_16x16x32_bf16 v[72:75], a[68:71], v[40:43], v[72:75]
 ds_read_b128 v[60:63], v7 offset:6144
 v_mfma_f32_16x16x32_bf16 v[80:83], v[40:43], a[132:135], v[80:83]
 s_add_u32 m0, s49, 0
 v_mfma_f32_16x16x32_bf16 v[88:91], v[40:43], a[196:199], v[88:91]
 buffer_load_dwordx4 v10, s[8:11], s46 offen offset:0  lds
 v_mfma_f32_16x16x32_bf16 v[68:71], a[4:7], v[44:47], v[68:71]
 s_add_u32 m0, s49, 3968
 v_mfma_f32_16x16x32_bf16 v[76:79], a[68:71], v[44:47], v[76:79]
 buffer_load_dwordx4 v10, s[8:11], s46 offen offset:128  lds
 v_mfma_f32_16x16x32_bf16 v[84:87], v[44:47], a[132:135], v[84:87]
 v_mfma_f32_16x16x32_bf16 v[92:95], v[44:47], a[196:199], v[92:95]
 s_waitcnt lgkmcnt(2)
 v_mfma_f32_16x16x32_bf16 v[64:67], a[8:11], v[48:51], v[64:67]
 ds_read_b128 v[32:35], v6 offset:8192
 v_mfma_f32_16x16x32_bf16 v[72:75], a[72:75], v[48:51], v[72:75]
 ds_read_b128 v[36:39], v6 offset:10240
 v_mfma_f32_16x16x32_bf16 v[80:83], v[48:51], a[136:139], v[80:83]
 s_add_u32 m0, s49, 7936
 v_mfma_f32_16x16x32_bf16 v[88:91], v[48:51], a[200:203], v[88:91]
 buffer_load_dwordx4 v10, s[8:11], s46 offen offset:256  lds
 v_mfma_f32_16x16x32_bf16 v[68:71], a[8:11], v[52:55], v[68:71]
 s_add_u32 m0, s49, 11904
 v_mfma_f32_16x16x32_bf16 v[76:79], a[72:75], v[52:55], v[76:79]
 buffer_load_dwordx4 v10, s[8:11], s46 offen offset:384  lds
 v_mfma_f32_16x16x32_bf16 v[84:87], v[52:55], a[136:139], v[84:87]
 v_mfma_f32_16x16x32_bf16 v[92:95], v[52:55], a[200:203], v[92:95]
 s_waitcnt lgkmcnt(2)
 v_mfma_f32_16x16x32_bf16 v[64:67], a[12:15], v[56:59], v[64:67]
 ds_read_b128 v[40:43], v7 offset:8192
 v_mfma_f32_16x16x32_bf16 v[72:75], a[76:79], v[56:59], v[72:75]
 ds_read_b128 v[44:47], v7 offset:10240
 v_mfma_f32_16x16x32_bf16 v[80:83], v[56:59], a[140:143], v[80:83]
 s_add_u32 m0, s49, 15872
 v_mfma_f32_16x16x32_bf16 v[88:91], v[56:59], a[204:207], v[88:91]
 buffer_load_dwordx4 v10, s[8:11], s46 offen offset:512  lds
 v_mfma_f32_16x16x32_bf16 v[68:71], a[12:15], v[60:63], v[68:71]
 s_add_u32 m0, s49, 19840
 v_mfma_f32_16x16x32_bf16 v[76:79], a[76:79], v[60:63], v[76:79]
 buffer_load_dwordx4 v10, s[8:11], s46 offen offset:640  lds
 v_mfma_f32_16x16x32_bf16 v[84:87], v[60:63], a[140:143], v[84:87]
 v_mfma_f32_16x16x32_bf16 v[92:95], v[60:63], a[204:207], v[92:95]
 s_waitcnt lgkmcnt(2)
 v_mfma_f32_16x16x32_bf16 v[64:67], a[16:19], v[32:35], v[64:67]
 ds_read_b128 v[48:51], v6 offset:12288
 v_mfma_f32_16x16x32_bf16 v[72:75], a[80:83], v[32:35], v[72:75]
 ds_read_b128 v[52:55], v6 offset:14336
 v_mfma_f32_16x16x32_bf16 v[80:83], v[32:35], a[144:147], v[80:83]
 s_add_u32 m0, s49, 23808
 v_mfma_f32_16x16x32_bf16 v[88:91], v[32:35], a[208:211], v[88:91]
 buffer_load_dwordx4 v10, s[8:11], s46 offen offset:768  lds
 v_mfma_f32_16x16x32_bf16 v[68:71], a[16:19], v[36:39], v[68:71]
 s_add_u32 m0, s49, 27776
 v_mfma_f32_16x16x32_bf16 v[76:79], a[80:83], v[36:39], v[76:79]
 buffer_load_dwordx4 v10, s[8:11], s46 offen offset:896  lds
 v_mfma_f32_16x16x32_bf16 v[84:87], v[36:39], a[144:147], v[84:87]
 v_mfma_f32_16x16x32_bf16 v[92:95], v[36:39], a[208:211], v[92:95]
 s_waitcnt lgkmcnt(2)
 v_mfma_f32_16x16x32_bf16 v[64:67], a[20:23], v[40:43], v[64:67]
 ds_read_b128 v[56:59], v7 offset:12288
 v_mfma_f32_16x16x32_bf16 v[72:75], a[84:87], v[40:43], v[72:75]
 ds_read_b128 v[60:63], v7 offset:14336
 v_mfma_f32_16x16x32_bf16 v[80:83], v[40:43], a[148:151], v[80:83]
 v_mfma_f32_16x16x32_bf16 v[88:91], v[40:43], a[212:215], v[88:91]
 v_mfma_f32_16x16x32_bf16 v[68:71], a[20:23], v[44:47], v[68:71]
 v_add_u32 v2, s46, v1
 v_mfma_f32_16x16x32_bf16 v[76:79], a[84:87], v[44:47], v[76:79]
 buffer_load_dword v15, v2, s[8:11], 0 offen
 v_mfma_f32_16x16x32_bf16 v[84:87], v[44:47], a[148:151], v[84:87]
 v_mfma_f32_16x16x32_bf16 v[92:95], v[44:47], a[212:215], v[92:95]
 s_waitcnt lgkmcnt(2)
 v_mfma_f32_16x16x32_bf16 v[64:67], a[24:27], v[48:51], v[64:67]
 ds_read_b128 v[32:35], v6 offset:16384
 v_mfma_f32_16x16x32_bf16 v[72:75], a[88:91], v[48:51], v[72:75]
 ds_read_b128 v[36:39], v6 offset:18432
 v_mfma_f32_16x16x32_bf16 v[80:83], v[48:51], a[152:155], v[80:83]
 v_cvt_pk_bf16_f32 v16, v96, v97
 v_mfma_f32_16x16x32_bf16 v[88:91], v[48:51], a[216:219], v[88:91]
 v_cvt_pk_bf16_f32 v17, v104, v105
 v_mfma_f32_16x16x32_bf16 v[68:71], a[24:27], v[52:55], v[68:71]
 v_mfma_f32_16x16x32_bf16 v[76:79], a[88:91], v[52:55], v[76:79]
 v_cvt_pk_bf16_f32 v18, v98, v99
 v_mfma_f32_16x16x32_bf16 v[84:87], v[52:55], a[152:155], v[84:87]
 v_mfma_f32_16x16x32_bf16 v[92:95], v[52:55], a[216:219], v[92:95]
 s_waitcnt lgkmcnt(2)
 v_mfma_f32_16x16x32_bf16 v[64:67], a[28:31], v[56:59], v[64:67]
 ds_read_b128 v[40:43], v7 offset:16384
 v_mfma_f32_16x16x32_bf16 v[72:75], a[92:95], v[56:59], v[72:75]
 ds_read_b128 v[44:47], v7 offset:18432
 v_mfma_f32_16x16x32_bf16 v[80:83], v[56:59], a[156:159], v[80:83]
 v_cvt_pk_bf16_f32 v19, v106, v107
 v_mfma_f32_16x16x32_bf16 v[88:91], v[56:59], a[220:223], v[88:91]
 v_mfma_f32_16x16x32_bf16 v[68:71], a[28:31], v[60:63], v[68:71]
 buffer_store_dwordx4 v[16:19], v12, s[20:23], s47 offen offset:0 sc1
 v_mfma_f32_16x16x32_bf16 v[76:79], a[92:95], v[60:63], v[76:79]
 v_cvt_pk_bf16_f32 v20, v100, v101
 v_mfma_f32_16x16x32_bf16 v[84:87], v[60:63], a[156:159], v[84:87]
 v_mfma_f32_16x16x32_bf16 v[92:95], v[60:63], a[220:223], v[92:95]
 s_waitcnt lgkmcnt(2)
 v_mfma_f32_16x16x32_bf16 v[64:67], a[32:35], v[32:35], v[64:67]
 ds_read_b128 v[48:51], v6 offset:20480
 v_mfma_f32_16x16x32_bf16 v[72:75], a[96:99], v[32:35], v[72:75]
 ds_read_b128 v[52:55], v6 offset:22528
 v_mfma_f32_16x16x32_bf16 v[80:83], v[32:35], a[160:163], v[80:83]
 v_cvt_pk_bf16_f32 v21, v108, v109
 v_mfma_f32_16x16x32_bf16 v[88:91], v[32:35], a[224:227], v[88:91]
 v_mfma_f32_16x16x32_bf16 v[68:71], a[32:35], v[36:39], v[68:71]
 v_cvt_pk_bf16_f32 v22, v102, v103
 v_mfma_f32_16x16x32_bf16 v[76:79], a[96:99], v[36:39], v[76:79]
 v_mfma_f32_16x16x32_bf16 v[84:87], v[36:39], a[160:163], v[84:87]
 v_cvt_pk_bf16_f32 v23, v110, v111
 v_mfma_f32_16x16x32_bf16 v[92:95], v[36:39], a[224:227], v[92:95]
 s_waitcnt lgkmcnt(2)
 v_mfma_f32_16x16x32_bf16 v[64:67], a[36:39], v[40:43], v[64:67]
 ds_read_b128 v[56:59], v7 offset:20480
 v_mfma_f32_16x16x32_bf16 v[72:75], a[100:103], v[40:43], v[72:75]
 ds_read_b128 v[60:63], v7 offset:22528
 v_mfma_f32_16x16x32_bf16 v[80:83], v[40:43], a[164:167], v[80:83]
 buffer_store_dwordx4 v[20:23], v12, s[20:23], s47 offen offset:1024 sc1
 v_mfma_f32_16x16x32_bf16 v[88:91], v[40:43], a[228:231], v[88:91]
 v_mfma_f32_16x16x32_bf16 v[68:71], a[36:39], v[44:47], v[68:71]
 v_cvt_pk_bf16_f32 v24, v112, v113
 v_mfma_f32_16x16x32_bf16 v[76:79], a[100:103], v[44:47], v[76:79]
 v_mfma_f32_16x16x32_bf16 v[84:87], v[44:47], a[164:167], v[84:87]
 v_cvt_pk_bf16_f32 v25, v116, v117
 v_mfma_f32_16x16x32_bf16 v[92:95], v[44:47], a[228:231], v[92:95]
 s_waitcnt lgkmcnt(2)
 v_mfma_f32_16x16x32_bf16 v[64:67], a[40:43], v[48:51], v[64:67]
 ds_read_b128 v[32:35], v6 offset:24576
 v_mfma_f32_16x16x32_bf16 v[72:75], a[104:107], v[48:51], v[72:75]
 ds_read_b128 v[36:39], v6 offset:26624
 v_mfma_f32_16x16x32_bf16 v[80:83], v[48:51], a[168:171], v[80:83]
 v_mfma_f32_16x16x32_bf16 v[88:91], v[48:51], a[232:235], v[88:91]
 v_cvt_pk_bf16_f32 v26, v114, v115
 v_mfma_f32_16x16x32_bf16 v[68:71], a[40:43], v[52:55], v[68:71]
 v_cvt_pk_bf16_f32 v27, v118, v119
 v_mfma_f32_16x16x32_bf16 v[76:79], a[104:107], v[52:55], v[76:79]
 v_mfma_f32_16x16x32_bf16 v[84:87], v[52:55], a[168:171], v[84:87]
 buffer_store_dwordx4 v[24:27], v12, s[20:23], s48 offen offset:0 sc1
 v_mfma_f32_16x16x32_bf16 v[92:95], v[52:55], a[232:235], v[92:95]
 s_waitcnt lgkmcnt(2)
 v_mfma_f32_16x16x32_bf16 v[64:67], a[44:47], v[56:59], v[64:67]
 ds_read_b128 v[40:43], v7 offset:24576
 v_mfma_f32_16x16x32_bf16 v[72:75], a[108:111], v[56:59], v[72:75]
 ds_read_b128 v[44:47], v7 offset:26624
 v_mfma_f32_16x16x32_bf16 v[80:83], v[56:59], a[172:175], v[80:83]
 s_add_u32 s43, s43, 32768
 s_cmp_eq_u32 s43, 131072
 v_mfma_f32_16x16x32_bf16 v[88:91], v[56:59], a[236:239], v[88:91]
 s_cselect_b32 s43, 0, s43
 s_add_u32 s44, s44, 32768
 v_mfma_f32_16x16x32_bf16 v[68:71], a[44:47], v[60:63], v[68:71]
 s_cmp_eq_u32 s44, 131072
 s_cselect_b32 s44, 0, s44
 v_mfma_f32_16x16x32_bf16 v[76:79], a[108:111], v[60:63], v[76:79]
 v_mfma_f32_16x16x32_bf16 v[84:87], v[60:63], a[172:175], v[84:87]
 v_cvt_pk_bf16_f32 v28, v120, v121
 v_mfma_f32_16x16x32_bf16 v[92:95], v[60:63], a[236:239], v[92:95]
 s_waitcnt lgkmcnt(2)
 v_mfma_f32_16x16x32_bf16 v[64:67], a[48:51], v[32:35], v[64:67]
 ds_read_b128 v[48:51], v6 offset:28672
 v_mfma_f32_16x16x32_bf16 v[72:75], a[112:115], v[32:35], v[72:75]
 ds_read_b128 v[52:55], v6 offset:30720
 v_mfma_f32_16x16x32_bf16 v[80:83], v[32:35], a[176:179], v[80:83]
 v_add_u32 v6, s43, v4
 v_mfma_f32_16x16x32_bf16 v[88:91], v[32:35], a[240:243], v[88:91]
 v_mfma_f32_16x16x32_bf16 v[68:71], a[48:51], v[36:39], v[68:71]
 v_cvt_pk_bf16_f32 v29, v124, v125
 v_mfma_f32_16x16x32_bf16 v[76:79], a[112:115], v[36:39], v[76:79]
 v_cvt_pk_bf16_f32 v30, v122, v123
 v_mfma_f32_16x16x32_bf16 v[84:87], v[36:39], a[176:179], v[84:87]
 v_mfma_f32_16x16x32_bf16 v[92:95], v[36:39], a[240:243], v[92:95]
 s_waitcnt lgkmcnt(2)
 v_mfma_f32_16x16x32_bf16 v[64:67], a[52:55], v[40:43], v[64:67]
 ds_read_b128 v[56:59], v7 offset:28672
 v_mfma_f32_16x16x32_bf16 v[72:75], a[116:119], v[40:43], v[72:75]
 ds_read_b128 v[60:63], v7 offset:30720
 v_mfma_f32_16x16x32_bf16 v[80:83], v[40:43], a[180:183], v[80:83]
 v_add_u32 v7, s43, v5
 v_mfma_f32_16x16x32_bf16 v[88:91], v[40:43], a[244:247], v[88:91]
 v_cvt_pk_bf16_f32 v31, v126, v127
 v_mfma_f32_16x16x32_bf16 v[68:71], a[52:55], v[44:47], v[68:71]
 v_mfma_f32_16x16x32_bf16 v[76:79], a[116:119], v[44:47], v[76:79]
 buffer_store_dwordx4 v[28:31], v12, s[20:23], s48 offen offset:1024 sc1
 v_mfma_f32_16x16x32_bf16 v[84:87], v[44:47], a[180:183], v[84:87]
 v_mfma_f32_16x16x32_bf16 v[92:95], v[44:47], a[244:247], v[92:95]
 s_waitcnt lgkmcnt(2)
 v_mfma_f32_16x16x32_bf16 v[64:67], a[56:59], v[48:51], v[64:67]
 s_waitcnt vmcnt(13)
 s_barrier
 ds_read_b128 v[32:35], v6 offset:0
 v_mfma_f32_16x16x32_bf16 v[72:75], a[120:123], v[48:51], v[72:75]
 ds_read_b128 v[36:39], v6 offset:2048
 v_mfma_f32_16x16x32_bf16 v[80:83], v[48:51], a[184:187], v[80:83]
 v_mfma_f32_16x16x32_bf16 v[88:91], v[48:51], a[248:251], v[88:91]
 v_mfma_f32_16x16x32_bf16 v[68:71], a[56:59], v[52:55], v[68:71]
 v_mfma_f32_16x16x32_bf16 v[76:79], a[120:123], v[52:55], v[76:79]
 v_mfma_f32_16x16x32_bf16 v[84:87], v[52:55], a[184:187], v[84:87]
 v_mfma_f32_16x16x32_bf16 v[92:95], v[52:55], a[248:251], v[92:95]
 s_waitcnt lgkmcnt(2)
 v_mfma_f32_16x16x32_bf16 v[64:67], a[60:63], v[56:59], v[64:67]
 ds_read_b128 v[40:43], v7 offset:0
 v_mfma_f32_16x16x32_bf16 v[72:75], a[124:127], v[56:59], v[72:75]
 ds_read_b128 v[44:47], v7 offset:2048
 v_mfma_f32_16x16x32_bf16 v[80:83], v[56:59], a[188:191], v[80:83]
 s_mul_i32 s45, s39, 524288
 s_add_u32 s47, s34, s45
 v_mfma_f32_16x16x32_bf16 v[88:91], v[56:59], a[252:255], v[88:91]
 s_add_u32 s48, s35, s45
 v_mov_b32 v14, s42
 v_mfma_f32_16x16x32_bf16 v[68:71], a[60:63], v[60:63], v[68:71]
 s_mov_b32 s39, s40
 s_mov_b32 s40, s41
 v_mfma_f32_16x16x32_bf16 v[76:79], a[124:127], v[60:63], v[76:79]
 s_add_u32 s42, s42, 1
 v_mfma_f32_16x16x32_bf16 v[84:87], v[60:63], a[188:191], v[84:87]
 v_mfma_f32_16x16x32_bf16 v[92:95], v[60:63], a[252:255], v[92:95]
 s_waitcnt lgkmcnt(2)
 v_mfma_f32_16x16x32_bf16 v[96:99], a[0:3], v[32:35], 0
 ds_read_b128 v[48:51], v6 offset:4096
 v_mfma_f32_16x16x32_bf16 v[104:107], a[64:67], v[32:35], 0
 ds_read_b128 v[52:55], v6 offset:6144
 v_mfma_f32_16x16x32_bf16 v[112:115], v[32:35], a[128:131], 0
 s_add_u32 s41, s40, 4
 v_mfma_f32_16x16x32_bf16 v[120:123], v[32:35], a[192:195], 0
 s_add_u32 s45, s42, 2
 s_mul_i32 s46, s41, 32768
 v_mfma_f32_16x16x32_bf16 v[100:103], a[0:3], v[36:39], 0
 s_cmp_lt_u32 s45, s36
 s_cselect_b32 s46, s46, 0
 v_mfma_f32_16x16x32_bf16 v[108:111], a[64:67], v[36:39], 0
 s_lshl_b32 s49, s4, 10
 s_add_u32 s49, s49, s44
 v_mfma_f32_16x16x32_bf16 v[116:119], v[36:39], a[128:131], 0
 v_mfma_f32_16x16x32_bf16 v[124:127], v[36:39], a[192:195], 0
 s_waitcnt lgkmcnt(2)
 v_mfma_f32_16x16x32_bf16 v[96:99], a[4:7], v[40:43], v[96:99]
 ds_read_b128 v[56:59], v7 offset:4096
 v_mfma_f32_16x16x32_bf16 v[104:107], a[68:71], v[40:43], v[104:107]
 ds_read_b128 v[60:63], v7 offset:6144
 v_mfma_f32_16x16x32_bf16 v[112:115], v[40:43], a[132:135], v[112:115]
 s_add_u32 m0, s49, 0
 v_mfma_f32_16x16x32_bf16 v[120:123], v[40:43], a[196:199], v[120:123]
 buffer_load_dwordx4 v10, s[8:11], s46 offen offset:0  lds
 v_mfma_f32_16x16x32_bf16 v[100:103], a[4:7], v[44:47], v[100:103]
 s_add_u32 m0, s49, 3968
 v_mfma_f32_16x16x32_bf16 v[108:111], a[68:71], v[44:47], v[108:111]
 buffer_load_dwordx4 v10, s[8:11], s46 offen offset:128  lds
 v_mfma_f32_16x16x32_bf16 v[116:119], v[44:47], a[132:135], v[116:119]
 v_mfma_f32_16x16x32_bf16 v[124:127], v[44:47], a[196:199], v[124:127]
 s_waitcnt lgkmcnt(2)
 v_mfma_f32_16x16x32_bf16 v[96:99], a[8:11], v[48:51], v[96:99]
 ds_read_b128 v[32:35], v6 offset:8192
 v_mfma_f32_16x16x32_bf16 v[104:107], a[72:75], v[48:51], v[104:107]
 ds_read_b128 v[36:39], v6 offset:10240
 v_mfma_f32_16x16x32_bf16 v[112:115], v[48:51], a[136:139], v[112:115]
 s_add_u32 m0, s49, 7936
 v_mfma_f32_16x16x32_bf16 v[120:123], v[48:51], a[200:203], v[120:123]
 buffer_load_dwordx4 v10, s[8:11], s46 offen offset:256  lds
 v_mfma_f32_16x16x32_bf16 v[100:103], a[8:11], v[52:55], v[100:103]
 s_add_u32 m0, s49, 11904
 v_mfma_f32_16x16x32_bf16 v[108:111], a[72:75], v[52:55], v[108:111]
 buffer_load_dwordx4 v10, s[8:11], s46 offen offset:384  lds
 v_mfma_f32_16x16x32_bf16 v[116:119], v[52:55], a[136:139], v[116:119]
 v_mfma_f32_16x16x32_bf16 v[124:127], v[52:55], a[200:203], v[124:127]
 s_waitcnt lgkmcnt(2)
 v_mfma_f32_16x16x32_bf16 v[96:99], a[12:15], v[56:59], v[96:99]
 ds_read_b128 v[40:43], v7 offset:8192
 v_mfma_f32_16x16x32_bf16 v[104:107], a[76:79], v[56:59], v[104:107]
 ds_read_b128 v[44:47], v7 offset:10240
 v_mfma_f32_16x16x32_bf16 v[112:115], v[56:59], a[140:143], v[112:115]
 s_add_u32 m0, s49, 15872
 v_mfma_f32_16x16x32_bf16 v[120:123], v[56:59], a[204:207], v[120:123]
 buffer_load_dwordx4 v10, s[8:11], s46 offen offset:512  lds
 v_mfma_f32_16x16x32_bf16 v[100:103], a[12:15], v[60:63], v[100:103]
 s_add_u32 m0, s49, 19840
 v_mfma_f32_16x16x32_bf16 v[108:111], a[76:79], v[60:63], v[108:111]
 buffer_load_dwordx4 v10, s[8:11], s46 offen offset:640  lds
 v_mfma_f32_16x16x32_bf16 v[116:119], v[60:63], a[140:143], v[116:119]
 v_mfma_f32_16x16x32_bf16 v[124:127], v[60:63], a[204:207], v[124:127]
 s_waitcnt lgkmcnt(2)
 v_mfma_f32_16x16x32_bf16 v[96:99], a[16:19], v[32:35], v[96:99]
 ds_read_b128 v[48:51], v6 offset:12288
 v_mfma_f32_16x16x32_bf16 v[104:107], a[80:83], v[32:35], v[104:107]
 ds_read_b128 v[52:55], v6 offset:14336
 v_mfma_f32_16x16x32_bf16 v[112:115], v[32:35], a[144:147], v[112:115]
 s_add_u32 m0, s49, 23808
 v_mfma_f32_16x16x32_bf16 v[120:123], v[32:35], a[208:211], v[120:123]
 buffer_load_dwordx4 v10, s[8:11], s46 offen offset:768  lds
 v_mfma_f32_16x16x32_bf16 v[100:103], a[16:19], v[36:39], v[100:103]
 s_add_u32 m0, s49, 27776
 v_mfma_f32_16x16x32_bf16 v[108:111], a[80:83], v[36:39], v[108:111]
 buffer_load_dwordx4 v10, s[8:11], s46 offen offset:896  lds
 v_mfma_f32_16x16x32_bf16 v[116:119], v[36:39], a[144:147], v[116:119]
 v_mfma_f32_16x16x32_bf16 v[124:127], v[36:39], a[208:211], v[124:127]
 s_waitcnt lgkmcnt(2)
 v_mfma_f32_16x16x32_bf16 v[96:99], a[20:23], v[40:43], v[96:99]
 ds_read_b128 v[56:59], v7 offset:12288
 v_mfma_f32_16x16x32_bf16 v[104:107], a[84:87], v[40:43], v[104:107]
 ds_read_b128 v[60:63], v7 offset:14336
 v_mfma_f32_16x16x32_bf16 v[112:115], v[40:43], a[148:151], v[112:115]
 v_mfma_f32_16x16x32_bf16 v[120:123], v[40:43], a[212:215], v[120:123]
 v_mfma_f32_16x16x32_bf16 v[100:103], a[20:23], v[44:47], v[100:103]
 v_add_u32 v2, s46, v1
 v_mfma_f32_16x16x32_bf16 v[108:111], a[84:87], v[44:47], v[108:111]
 buffer_load_dword v15, v2, s[8:11], 0 offen
 v_mfma_f32_16x16x32_bf16 v[116:119], v[44:47], a[148:151], v[116:119]
 v_mfma_f32_16x16x32_bf16 v[124:127], v[44:47], a[212:215], v[124:127]
 s_waitcnt lgkmcnt(2)
 v_mfma_f32_16x16x32_bf16 v[96:99], a[24:27], v[48:51], v[96:99]
 ds_read_b128 v[32:35], v6 offset:16384
 v_mfma_f32_16x16x32_bf16 v[104:107], a[88:91], v[48:51], v[104:107]
 ds_read_b128 v[36:39], v6 offset:18432
 v_mfma_f32_16x16x32_bf16 v[112:115], v[48:51], a[152:155], v[112:115]
 v_cvt_pk_bf16_f32 v16, v64, v65
 v_mfma_f32_16x16x32_bf16 v[120:123], v[48:51], a[216:219], v[120:123]
 v_cvt_pk_bf16_f32 v17, v72, v73
 v_mfma_f32_16x16x32_bf16 v[100:103], a[24:27], v[52:55], v[100:103]
 v_mfma_f32_16x16x32_bf16 v[108:111], a[88:91], v[52:55], v[108:111]
 v_cvt_pk_bf16_f32 v18, v66, v67
 v_mfma_f32_16x16x32_bf16 v[116:119], v[52:55], a[152:155], v[116:119]
 v_mfma_f32_16x16x32_bf16 v[124:127], v[52:55], a[216:219], v[124:127]
 s_waitcnt lgkmcnt(2)
 v_mfma_f32_16x16x32_bf16 v[96:99], a[28:31], v[56:59], v[96:99]
 ds_read_b128 v[40:43], v7 offset:16384
 v_mfma_f32_16x16x32_bf16 v[104:107], a[92:95], v[56:59], v[104:107]
 ds_read_b128 v[44:47], v7 offset:18432
 v_mfma_f32_16x16x32_bf16 v[112:115], v[56:59], a[156:159], v[112:115]
 v_cvt_pk_bf16_f32 v19, v74, v75
 v_mfma_f32_16x16x32_bf16 v[120:123], v[56:59], a[220:223], v[120:123]
 v_mfma_f32_16x16x32_bf16 v[100:103], a[28:31], v[60:63], v[100:103]
 buffer_store_dwordx4 v[16:19], v12, s[20:23], s47 offen offset:0 sc1
 v_mfma_f32_16x16x32_bf16 v[108:111], a[92:95], v[60:63], v[108:111]
 v_cvt_pk_bf16_f32 v20, v68, v69
 v_mfma_f32_16x16x32_bf16 v[116:119], v[60:63], a[156:159], v[116:119]
 v_mfma_f32_16x16x32_bf16 v[124:127], v[60:63], a[220:223], v[124:127]
 s_waitcnt lgkmcnt(2)
 v_mfma_f32_16x16x32_bf16 v[96:99], a[32:35], v[32:35], v[96:99]
 ds_read_b128 v[48:51], v6 offset:20480
 v_mfma_f32_16x16x32_bf16 v[104:107], a[96:99], v[32:35], v[104:107]
 ds_read_b128 v[52:55], v6 offset:22528
 v_mfma_f32_16x16x32_bf16 v[112:115], v[32:35], a[160:163], v[112:115]
 v_cvt_pk_bf16_f32 v21, v76, v77
 v_mfma_f32_16x16x32_bf16 v[120:123], v[32:35], a[224:227], v[120:123]
 v_mfma_f32_16x16x32_bf16 v[100:103], a[32:35], v[36:39], v[100:103]
 v_cvt_pk_bf16_f32 v22, v70, v71
 v_mfma_f32_16x16x32_bf16 v[108:111], a[96:99], v[36:39], v[108:111]
 v_mfma_f32_16x16x32_bf16 v[116:119], v[36:39], a[160:163], v[116:119]
 v_cvt_pk_bf16_f32 v23, v78, v79
 v_mfma_f32_16x16x32_bf16 v[124:127], v[36:39], a[224:227], v[124:127]
 s_waitcnt lgkmcnt(2)
 v_mfma_f32_16x16x32_bf16 v[96:99], a[36:39], v[40:43], v[96:99]
 ds_read_b128 v[56:59], v7 offset:20480
 v_mfma_f32_16x16x32_bf16 v[104:107], a[100:103], v[40:43], v[104:107]
 ds_read_b128 v[60:63], v7 offset:22528
 v_mfma_f32_16x16x32_bf16 v[112:115], v[40:43], a[164:167], v[112:115]
 buffer_store_dwordx4 v[20:23], v12, s[20:23], s47 offen offset:1024 sc1
 v_mfma_f32_16x16x32_bf16 v[120:123], v[40:43], a[228:231], v[120:123]
 v_mfma_f32_16x16x32_bf16 v[100:103], a[36:39], v[44:47], v[100:103]
 v_cvt_pk_bf16_f32 v24, v80, v81
 v_mfma_f32_16x16x32_bf16 v[108:111], a[100:103], v[44:47], v[108:111]
 v_mfma_f32_16x16x32_bf16 v[116:119], v[44:47], a[164:167], v[116:119]
 v_cvt_pk_bf16_f32 v25, v84, v85
 v_mfma_f32_16x16x32_bf16 v[124:127], v[44:47], a[228:231], v[124:127]
 s_waitcnt lgkmcnt(2)
 v_mfma_f32_16x16x32_bf16 v[96:99], a[40:43], v[48:51], v[96:99]
 ds_read_b128 v[32:35], v6 offset:24576
 v_mfma_f32_16x16x32_bf16 v[104:107], a[104:107], v[48:51], v[104:107]
 ds_read_b128 v[36:39], v6 offset:26624
 v_mfma_f32_16x16x32_bf16 v[112:115], v[48:51], a[168:171], v[112:115]
 v_mfma_f32_16x16x32_bf16 v[120:123], v[48:51], a[232:235], v[120:123]
 v_cvt_pk_bf16_f32 v26, v82, v83
 v_mfma_f32_16x16x32_bf16 v[100:103], a[40:43], v[52:55], v[100:103]
 v_cvt_pk_bf16_f32 v27, v86, v87
 v_mfma_f32_16x16x32_bf16 v[108:111], a[104:107], v[52:55], v[108:111]
 v_mfma_f32_16x16x32_bf16 v[116:119], v[52:55], a[168:171], v[116:119]
 buffer_store_dwordx4 v[24:27], v12, s[20:23], s48 offen offset:0 sc1
 v_mfma_f32_16x16x32_bf16 v[124:127], v[52:55], a[232:235], v[124:127]
 s_waitcnt lgkmcnt(2)
 v_mfma_f32_16x16x32_bf16 v[96:99], a[44:47], v[56:59], v[96:99]
 ds_read_b128 v[40:43], v7 offset:24576
 v_mfma_f32_16x16x32_bf16 v[104:107], a[108:111], v[56:59], v[104:107]
 ds_read_b128 v[44:47], v7 offset:26624
 v_mfma_f32_16x16x32_bf16 v[112:115], v[56:59], a[172:175], v[112:115]
 s_add_u32 s43, s43, 32768
 s_cmp_eq_u32 s43, 131072
 v_mfma_f32_16x16x32_bf16 v[120:123], v[56:59], a[236:239], v[120:123]
 s_cselect_b32 s43, 0, s43
 s_add_u32 s44, s44, 32768
 v_mfma_f32_16x16x32_bf16 v[100:103], a[44:47], v[60:63], v[100:103]
 s_cmp_eq_u32 s44, 131072
 s_cselect_b32 s44, 0, s44
 v_mfma_f32_16x16x32_bf16 v[108:111], a[108:111], v[60:63], v[108:111]
 v_mfma_f32_16x16x32_bf16 v[116:119], v[60:63], a[172:175], v[116:119]
 v_cvt_pk_bf16_f32 v28, v88, v89
 v_mfma_f32_16x16x32_bf16 v[124:127], v[60:63], a[236:239], v[124:127]
 s_waitcnt lgkmcnt(2)
 v_mfma_f32_16x16x32_bf16 v[96:99], a[48:51], v[32:35], v[96:99]
 ds_read_b128 v[48:51], v6 offset:28672
 v_mfma_f32_16x16x32_bf16 v[104:107], a[112:115], v[32:35], v[104:107]
 ds_read_b128 v[52:55], v6 offset:30720
 v_mfma_f32_16x16x32_bf16 v[112:115], v[32:35], a[176:179], v[112:115]
 v_add_u32 v6, s43, v4
 v_mfma_f32_16x16x32_bf16 v[120:123], v[32:35], a[240:243], v[120:123]
 v_mfma_f32_16x16x32_bf16 v[100:103], a[48:51], v[36:39], v[100:103]
 v_cvt_pk_bf16_f32 v29, v92, v93
 v_mfma_f32_16x16x32_bf16 v[108:111], a[112:115], v[36:39], v[108:111]
 v_cvt_pk_bf16_f32 v30, v90, v91
 v_mfma_f32_16x16x32_bf16 v[116:119], v[36:39], a[176:179], v[116:119]
 v_mfma_f32_16x16x32_bf16 v[124:127], v[36:39], a[240:243], v[124:127]
 s_waitcnt lgkmcnt(2)
 v_mfma_f32_16x16x32_bf16 v[96:99], a[52:55], v[40:43], v[96:99]
 ds_read_b128 v[56:59], v7 offset:28672
 v_mfma_f32_16x16x32_bf16 v[104:107], a[116:119], v[40:43], v[104:107]
 ds_read_b128 v[60:63], v7 offset:30720
 v_mfma_f32_16x16x32_bf16 v[112:115], v[40:43], a[180:183], v[112:115]
 v_add_u32 v7, s43, v5
 v_mfma_f32_16x16x32_bf16 v[120:123], v[40:43], a[244:247], v[120:123]
 v_cvt_pk_bf16_f32 v31, v94, v95
 v_mfma_f32_16x16x32_bf16 v[100:103], a[52:55], v[44:47], v[100:103]
 v_mfma_f32_16x16x32_bf16 v[108:111], a[116:119], v[44:47], v[108:111]
 buffer_store_dwordx4 v[28:31], v12, s[20:23], s48 offen offset:1024 sc1
 v_mfma_f32_16x16x32_bf16 v[116:119], v[44:47], a[180:183], v[116:119]
 v_mfma_f32_16x16x32_bf16 v[124:127], v[44:47], a[244:247], v[124:127]
 s_waitcnt lgkmcnt(2)
 v_mfma_f32_16x16x32_bf16 v[96:99], a[56:59], v[48:51], v[96:99]
 s_waitcnt vmcnt(13)
 s_barrier
 ds_read_b128 v[32:35], v6 offset:0
 v_mfma_f32_16x16x32_bf16 v[104:107], a[120:123], v[48:51], v[104:107]
 ds_read_b128 v[36:39], v6 offset:2048
 v_mfma_f32_16x16x32_bf16 v[112:115], v[48:51], a[184:187], v[112:115]
 v_mfma_f32_16x16x32_bf16 v[120:123], v[48:51], a[248:251], v[120:123]
 v_mfma_f32_16x16x32_bf16 v[100:103], a[56:59], v[52:55], v[100:103]
 v_mfma_f32_16x16x32_bf16 v[108:111], a[120:123], v[52:55], v[108:111]
 v_mfma_f32_16x16x32_bf16 v[116:119], v[52:55], a[184:187], v[116:119]
 v_mfma_f32_16x16x32_bf16 v[124:127], v[52:55], a[248:251], v[124:127]
 s_waitcnt lgkmcnt(2)
 v_mfma_f32_16x16x32_bf16 v[96:99], a[60:63], v[56:59], v[96:99]
 ds_read_b128 v[40:43], v7 offset:0
 v_mfma_f32_16x16x32_bf16 v[104:107], a[124:127], v[56:59], v[104:107]
 ds_read_b128 v[44:47], v7 offset:2048
 v_mfma_f32_16x16x32_bf16 v[112:115], v[56:59], a[188:191], v[112:115]
 s_mul_i32 s45, s39, 524288
 s_add_u32 s47, s34, s45
 v_mfma_f32_16x16x32_bf16 v[120:123], v[56:59], a[252:255], v[120:123]
 s_add_u32 s48, s35, s45
 v_mov_b32 v14, s42
 v_mfma_f32_16x16x32_bf16 v[100:103], a[60:63], v[60:63], v[100:103]
 s_mov_b32 s39, s40
 s_mov_b32 s40, s41
 v_mfma_f32_16x16x32_bf16 v[108:111], a[124:127], v[60:63], v[108:111]
 s_add_u32 s42, s42, 1
 s_cmp_lt_u32 s42, s36
 v_mfma_f32_16x16x32_bf16 v[116:119], v[60:63], a[188:191], v[116:119]
 v_mfma_f32_16x16x32_bf16 v[124:127], v[60:63], a[252:255], v[124:127]
 s_waitcnt lgkmcnt(2)
 s_cbranch_scc1 Lps_loop_6
 s_nop 7
 v_cvt_pk_bf16_f32 v16, v96, v97
 v_cvt_pk_bf16_f32 v17, v104, v105
 v_cvt_pk_bf16_f32 v18, v98, v99
 v_cvt_pk_bf16_f32 v19, v106, v107
 buffer_store_dwordx4 v[16:19], v12, s[20:23], s47 offen offset:0 sc1
 v_cvt_pk_bf16_f32 v20, v100, v101
 v_cvt_pk_bf16_f32 v21, v108, v109
 v_cvt_pk_bf16_f32 v22, v102, v103
 v_cvt_pk_bf16_f32 v23, v110, v111
 buffer_store_dwordx4 v[20:23], v12, s[20:23], s47 offen offset:1024 sc1
 v_cvt_pk_bf16_f32 v24, v112, v113
 v_cvt_pk_bf16_f32 v25, v116, v117
 v_cvt_pk_bf16_f32 v26, v114, v115
 v_cvt_pk_bf16_f32 v27, v118, v119
 buffer_store_dwordx4 v[24:27], v12, s[20:23], s48 offen offset:0 sc1
 v_cvt_pk_bf16_f32 v28, v120, v121
 v_cvt_pk_bf16_f32 v29, v124, v125
 v_cvt_pk_bf16_f32 v30, v122, v123
 v_cvt_pk_bf16_f32 v31, v126, v127
 buffer_store_dwordx4 v[28:31], v12, s[20:23], s48 offen offset:1024 sc1
 s_waitcnt vmcnt(0) lgkmcnt(0)
 s_barrier
 v_mov_b32 v14, s36
 buffer_store_dword v14, v13, s[20:23], 0 offen sc1
 s_mov_b32 s32, s3
 s_and_b32 s33, s6, 3
 s_sub_u32 s34, 7, s33
 v_and_b32 v1, 63, v0
 v_lshlrev_b32 v1, 4, v1
 v_mov_b32 v4, 0xff800000
 v_min_u32 v5, 1, v0
 v_lshlrev_b32 v5, 28, v5
 v_mov_b32 v6, 0x3f803f80
 v_accvgpr_write_b32 a192, v6
 v_accvgpr_write_b32 a193, v6
 v_accvgpr_write_b32 a194, v6
 v_accvgpr_write_b32 a195, v6
 s_mov_b32 s52, 0xfff0ffff
 s_mov_b32 s53, 0xf000ff00
 s_mov_b32 s54, 0xffe0fffe
 s_mov_b32 s55, 0xe000fe00
 s_mov_b32 s56, 0xffc0fffc
 s_mov_b32 s57, 0xc000fc00
 s_mov_b32 s58, 0xff80fff8
 s_mov_b32 s59, 0x8000f800
 s_mov_b32 s73, 0x53800000
 s_mov_b32 s74, 0x21800000
 s_lshl_b32 s50, s4, 12
 s_lshl_b32 s45, s32, 14
 s_add_u32 s45, s45, s50
 s_add_u32 s45, s45, 0x1000000
 s_lshl_b32 s36, s33, 3
 s_add_u32 s36, s36, 8
 s_lshl_b32 s47, s34, 3
 s_add_u32 s47, s47, 8
 s_mov_b32 s35, 0
 s_mov_b32 s38, 0
 s_mov_b32 s46, 0
 s_lshl_b32 s7, s3, 7
 s_add_u32 s7, s7, 0x2000
 s_lshr_b32 s94, s3, 1
 s_lshl_b32 s94, s94, 7
 s_add_u32 s94, s94, 0x3000
 v_min_u32 v10, 16, v1
 v_lshlrev_b32 v10, 24, v10
Law_7:
 buffer_load_dwordx4 v[240:243], v10, s[20:23], s94 offen sc1
 buffer_load_dwordx4 v[244:247], v10, s[20:23], s7 offen sc1
 s_waitcnt vmcnt(0)
 v_min3_u32 v240, v240, v241, v242
 v_min_u32 v240, v240, v243
 v_lshlrev_b32 v240, 1, v240
 v_min3_u32 v240, v240, v244, v245
 v_min3_u32 v240, v240, v246, v247
 v_cmp_le_u32 vcc, 16, v240
 s_cbranch_vccnz Lawk_8
 s_sleep 2
 s_sub_u32 s95, s95, 1
 s_cbranch_scc0 Law_7
 s_endpgm
Lawk_8:
 s_lshl_b32 s37, s35, 19
 s_add_u32 m0, s38, s50
 s_add_u32 s37, s37, s45
 buffer_load_dwordx4 v1, s[20:23], s37 offen offset:0 sc1 lds
 buffer_load_dwordx4 v1, s[20:23], s37 offen offset:1024 sc1 lds
 buffer_load_dwordx4 v1, s[20:23], s37 offen offset:2048 sc1 lds
 buffer_load_dwordx4 v1, s[20:23], s37 offen offset:3072 sc1 lds
 s_add_u32 s38, s38, 0x4000
 s_and_b32 s38, s38, 0x1ffff
 s_add_u32 s35, s35, 1
 s_cmp_eq_u32 s35, s36
 s_cselect_b32 s36, s47, s36
 s_cselect_b32 s35, 0, s35
 s_lshl_b32 s44, s33, 3
 s_add_u32 s44, s44, s4
 s_lshl_b32 s44, s44, 5
 s_add_u32 s44, s44, s32
 s_lshl_b32 s44, s44, 13
 s_add_u32 s44, s44, 0x5000000
 buffer_load_dwordx4 a[0:3], v1, s[20:23], s44 offen offset:0 sc1
 buffer_load_dwordx4 a[16:19], v1, s[20:23], s44 offen offset:1024 sc1
 buffer_load_dwordx4 a[4:7], v1, s[20:23], s44 offen offset:2048 sc1
 buffer_load_dwordx4 a[20:23], v1, s[20:23], s44 offen offset:3072 sc1
 s_add_u32 s44, s44, 4096
 buffer_load_dwordx4 a[8:11], v1, s[20:23], s44 offen offset:0 sc1
 buffer_load_dwordx4 a[24:27], v1, s[20:23], s44 offen offset:1024 sc1
 buffer_load_dwordx4 a[12:15], v1, s[20:23], s44 offen offset:2048 sc1
 buffer_load_dwordx4 a[28:31], v1, s[20:23], s44 offen offset:3072 sc1
 s_lshl_b32 s44, s33, 3
 s_add_u32 s44, s44, 7
 s_sub_u32 s44, s44, s4
 s_lshl_b32 s44, s44, 5
 s_add_u32 s44, s44, s32
 s_lshl_b32 s44, s44, 13
 s_add_u32 s44, s44, 0x5000000
 buffer_load_dwordx4 a[32:35], v1, s[20:23], s44 offen offset:0 sc1
 buffer_load_dwordx4 a[48:51], v1, s[20:23], s44 offen offset:1024 sc1
 buffer_load_dwordx4 a[36:39], v1, s[20:23], s44 offen offset:2048 sc1
 buffer_load_dwordx4 a[52:55], v1, s[20:23], s44 offen offset:3072 sc1
 s_add_u32 s44, s44, 4096
 buffer_load_dwordx4 a[40:43], v1, s[20:23], s44 offen offset:0 sc1
 buffer_load_dwordx4 a[56:59], v1, s[20:23], s44 offen offset:1024 sc1
 buffer_load_dwordx4 a[44:47], v1, s[20:23], s44 offen offset:2048 sc1
 buffer_load_dwordx4 a[60:63], v1, s[20:23], s44 offen offset:3072 sc1
 s_lshl_b32 s37, s35, 19
 s_add_u32 m0, s38, s50
 s_add_u32 s37, s37, s45
 buffer_load_dwordx4 v1, s[20:23], s37 offen offset:0 sc1 lds
 buffer_load_dwordx4 v1, s[20:23], s37 offen offset:1024 sc1 lds
 buffer_load_dwordx4 v1, s[20:23], s37 offen offset:2048 sc1 lds
 buffer_load_dwordx4 v1, s[20:23], s37 offen offset:3072 sc1 lds
 s_add_u32 s38, s38, 0x4000
 s_and_b32 s38, s38, 0x1ffff
 s_add_u32 s35, s35, 1
 s_cmp_eq_u32 s35, s36
 s_cselect_b32 s36, s47, s36
 s_cselect_b32 s35, 0, s35
 s_lshl_b32 s37, s35, 19
 s_add_u32 m0, s38, s50
 s_add_u32 s37, s37, s45
 buffer_load_dwordx4 v1, s[20:23], s37 offen offset:0 sc1 lds
 buffer_load_dwordx4 v1, s[20:23], s37 offen offset:1024 sc1 lds
 buffer_load_dwordx4 v1, s[20:23], s37 offen offset:2048 sc1 lds
 buffer_load_dwordx4 v1, s[20:23], s37 offen offset:3072 sc1 lds
 s_add_u32 s38, s38, 0x4000
 s_and_b32 s38, s38, 0x1ffff
 s_add_u32 s35, s35, 1
 s_cmp_eq_u32 s35, s36
 s_cselect_b32 s36, s47, s36
 s_cselect_b32 s35, 0, s35
 s_waitcnt vmcnt(8)
 s_barrier
 v_mov_b32 v2, v1
 ds_read_b128 a[128:131], v2 offset:0
 ds_read_b128 a[132:135], v2 offset:1024
 ds_read_b128 a[136:139], v2 offset:2048
 ds_read_b128 a[140:143], v2 offset:3072
 ds_read_b128 a[144:147], v2 offset:4096
 ds_read_b128 a[148:151], v2 offset:5120
 ds_read_b128 a[152:155], v2 offset:6144
 ds_read_b128 a[156:159], v2 offset:7168
 s_mov_b32 s39, 0
 s_add_u32 s39, s39, 0x4000
 s_and_b32 s39, s39, 0x1ffff
 v_mov_b32 v3, v2
 v_add_u32 v2, s39, v1
Lablk_9:
 s_lshl_b32 s43, s33, 3
 s_add_u32 s41, s43, s4
 s_add_u32 s42, s43, 7
 s_sub_u32 s42, s42, s4
 s_mov_b32 s49, 0
 s_waitcnt lgkmcnt(0)
 v_mfma_f32_16x16x32_bf16 v[48:51], a[128:131], a[0:3], 0
 s_cmp_lt_u32 s49, s41
 v_mov_b64 v[176:177], 0
 v_mov_b64 v[178:179], 0
 v_mfma_f32_16x16x32_bf16 v[56:59], a[128:131], a[16:19], 0
 s_cselect_b64 s[68:69], -1, 0
 v_mov_b64 v[180:181], 0
 v_mov_b64 v[182:183], 0
 v_mfma_f32_16x16x32_bf16 v[64:67], a[128:131], a[32:35], 0
 v_mfma_f32_16x16x32_bf16 v[72:75], a[128:131], a[48:51], 0
 s_cmp_le_u32 s49, s41
 v_mov_b64 v[184:185], 0
 v_mov_b64 v[186:187], 0
 v_mfma_f32_16x16x32_bf16 v[48:51], a[136:139], a[4:7], v[48:51]
 v_mfma_f32_16x16x32_bf16 v[56:59], a[136:139], a[20:23], v[56:59]
 s_cselect_b64 s[70:71], -1, 0
 v_mov_b64 v[188:189], 0
 v_mov_b64 v[190:191], 0
 v_mfma_f32_16x16x32_bf16 v[64:67], a[136:139], a[36:39], v[64:67]
 v_mfma_f32_16x16x32_bf16 v[72:75], a[136:139], a[52:55], v[72:75]
 s_cmp_eq_u32 s49, s41
 v_mov_b64 v[192:193], 0
 v_mov_b64 v[194:195], 0
 v_mfma_f32_16x16x32_bf16 v[48:51], a[144:147], a[8:11], v[48:51]
 s_cselect_b64 s[60:61], s[52:53], s[68:69]
 v_mfma_f32_16x16x32_bf16 v[56:59], a[144:147], a[24:27], v[56:59]
 v_mov_b64 v[196:197], 0
 v_mov_b64 v[198:199], 0
 v_mfma_f32_16x16x32_bf16 v[64:67], a[144:147], a[40:43], v[64:67]
 s_cselect_b64 s[62:63], s[54:55], s[68:69]
 v_mfma_f32_16x16x32_bf16 v[72:75], a[144:147], a[56:59], v[72:75]
 v_mov_b64 v[200:201], 0
 v_mov_b64 v[202:203], 0
 v_mfma_f32_16x16x32_bf16 v[48:51], a[152:155], a[12:15], v[48:51]
 s_cselect_b64 s[64:65], s[56:57], s[68:69]
 v_mfma_f32_16x16x32_bf16 v[56:59], a[152:155], a[28:31], v[56:59]
 v_mov_b64 v[204:205], 0
 v_mov_b64 v[206:207], 0
 v_mfma_f32_16x16x32_bf16 v[64:67], a[152:155], a[44:47], v[64:67]
 s_cselect_b64 s[66:67], s[58:59], s[68:69]
 v_mfma_f32_16x16x32_bf16 v[72:75], a[152:155], a[60:63], v[72:75]
 s_nop 4
 v_max3_f32 v12, v48, v49, v50
 v_max3_f32 v13, v56, v57, v58
 v_max3_f32 v14, v64, v65, v66
 v_max3_f32 v15, v72, v73, v74
 v_max_f32 v12, v12, v51
 v_max_f32 v13, v13, v59
 v_max_f32 v14, v14, v67
 v_max_f32 v15, v15, v75
 v_mov_b32 v6, v12
 v_mov_b32 v7, v13
 v_mov_b32 v8, v14
 v_mov_b32 v9, v15
 v_permlane16_swap_b32 v12, v6
 v_permlane16_swap_b32 v13, v7
 v_permlane16_swap_b32 v14, v8
 v_permlane16_swap_b32 v15, v9
 v_max_f32 v12, v12, v6
 v_max_f32 v13, v13, v7
 v_max_f32 v14, v14, v8
 v_max_f32 v15, v15, v9
 v_mov_b32 v6, v12
 v_mov_b32 v7, v13
 v_mov_b32 v8, v14
 v_mov_b32 v9, v15
 v_permlane32_swap_b32 v12, v6
 v_permlane32_swap_b32 v13, v7
 v_permlane32_swap_b32 v14, v8
 v_permlane32_swap_b32 v15, v9
 v_max_f32 v12, v12, v6
 v_max_f32 v13, v13, v7
 v_max_f32 v14, v14, v8
 v_max_f32 v15, v15, v9
 v_sub_f32 v12, 0, v12
 v_sub_f32 v13, 0, v13
 v_sub_f32 v14, 0, v14
 v_sub_f32 v15, 0, v15
 v_cndmask_b32 v80, v4, v12, s[60:61]
 v_cndmask_b32 v81, v4, v12, s[62:63]
 v_cndmask_b32 v82, v4, v12, s[64:65]
 v_cndmask_b32 v83, v4, v12, s[66:67]
 v_cndmask_b32 v84, v4, v12, s[68:69]
 v_cndmask_b32 v85, v4, v12, s[68:69]
 v_cndmask_b32 v86, v4, v12, s[68:69]
 v_cndmask_b32 v87, v4, v12, s[68:69]
 v_cndmask_b32 v88, v4, v13, s[70:71]
 v_cndmask_b32 v89, v4, v13, s[70:71]
 v_cndmask_b32 v90, v4, v13, s[70:71]
 v_cndmask_b32 v91, v4, v13, s[70:71]
 v_cndmask_b32 v92, v4, v13, s[60:61]
 v_cndmask_b32 v93, v4, v13, s[62:63]
 v_cndmask_b32 v94, v4, v13, s[64:65]
 v_cndmask_b32 v95, v4, v13, s[66:67]
 v_mov_b32 v96, v14
 v_mov_b32 v97, v14
 v_mov_b32 v98, v14
 v_mov_b32 v99, v14
 v_mov_b32 v100, v14
 v_mov_b32 v101, v14
 v_mov_b32 v102, v14
 v_mov_b32 v103, v14
 v_mov_b32 v104, v15
 v_mov_b32 v105, v15
 v_mov_b32 v106, v15
 v_mov_b32 v107, v15
 v_mov_b32 v108, v15
 v_mov_b32 v109, v15
 v_mov_b32 v110, v15
 v_mov_b32 v111, v15
 s_waitcnt lgkmcnt(0)
 v_mfma_f32_16x16x32_bf16 v[48:51], a[128:131], a[0:3], v[80:83]
 ds_read_b128 a[160:163], v3 offset:8192
 v_mov_b64 v[208:209], 0
 v_mov_b64 v[210:211], 0
 v_mfma_f32_16x16x32_bf16 v[56:59], a[128:131], a[16:19], v[88:91]
 v_mov_b64 v[212:213], 0
 v_mov_b64 v[214:215], 0
 v_mfma_f32_16x16x32_bf16 v[52:55], a[132:135], a[0:3], v[84:87]
 ds_read_b128 a[164:167], v3 offset:9216
 v_mfma_f32_16x16x32_bf16 v[60:63], a[132:135], a[16:19], v[92:95]
 v_mov_b64 v[216:217], 0
 v_mov_b64 v[218:219], 0
 v_mfma_f32_16x16x32_bf16 v[48:51], a[136:139], a[4:7], v[48:51]
 ds_read_b128 a[168:171], v3 offset:10240
 v_mov_b64 v[220:221], 0
 v_mov_b64 v[222:223], 0
 v_mfma_f32_16x16x32_bf16 v[56:59], a[136:139], a[20:23], v[56:59]
 v_mfma_f32_16x16x32_bf16 v[52:55], a[140:143], a[4:7], v[52:55]
 ds_read_b128 a[172:175], v3 offset:11264
 v_mov_b64 v[224:225], 0
 v_mov_b64 v[226:227], 0
 v_mfma_f32_16x16x32_bf16 v[60:63], a[140:143], a[20:23], v[60:63]
 v_mov_b64 v[228:229], 0
 v_mov_b64 v[230:231], 0
 v_mfma_f32_16x16x32_bf16 v[48:51], a[144:147], a[8:11], v[48:51]
 ds_read_b128 a[176:179], v3 offset:12288
 v_mfma_f32_16x16x32_bf16 v[56:59], a[144:147], a[24:27], v[56:59]
 v_mov_b64 v[232:233], 0
 v_mov_b64 v[234:235], 0
 v_mfma_f32_16x16x32_bf16 v[52:55], a[148:151], a[8:11], v[52:55]
 ds_read_b128 a[180:183], v3 offset:13312
 v_mov_b64 v[236:237], 0
 v_mov_b64 v[238:239], 0
 v_mfma_f32_16x16x32_bf16 v[60:63], a[148:151], a[24:27], v[60:63]
 v_mfma_f32_16x16x32_bf16 v[48:51], a[152:155], a[12:15], v[48:51]
 ds_read_b128 a[184:187], v3 offset:14336
 v_mov_b64 v[40:41], 0
 v_mov_b64 v[42:43], 0
 v_mfma_f32_16x16x32_bf16 v[56:59], a[152:155], a[28:31], v[56:59]
 v_mov_b64 v[44:45], 0
 v_mov_b64 v[46:47], 0
 v_mfma_f32_16x16x32_bf16 v[52:55], a[156:159], a[12:15], v[52:55]
 ds_read_b128 a[188:191], v3 offset:15360
 v_mfma_f32_16x16x32_bf16 v[60:63], a[156:159], a[28:31], v[60:63]
 v_mfma_f32_16x16x32_bf16 v[64:67], a[128:131], a[32:35], v[96:99]
 s_waitcnt vmcnt(4)
 s_barrier
 v_mfma_f32_16x16x32_bf16 v[72:75], a[128:131], a[48:51], v[104:107]
 ds_read_b128 a[128:131], v2 offset:0
 v_mfma_f32_16x16x32_bf16 v[68:71], a[132:135], a[32:35], v[100:103]
 s_add_u32 s49, s49, 1
 v_mfma_f32_16x16x32_bf16 v[76:79], a[132:135], a[48:51], v[108:111]
 ds_read_b128 a[132:135], v2 offset:1024
 v_exp_f32 v48, v48
 v_exp_f32 v49, v49
 v_mfma_f32_16x16x32_bf16 v[64:67], a[136:139], a[36:39], v[64:67]
 s_cmp_lt_u32 s49, s41
 v_exp_f32 v52, v52
 v_exp_f32 v53, v53
 v_mfma_f32_16x16x32_bf16 v[72:75], a[136:139], a[52:55], v[72:75]
 ds_read_b128 a[136:139], v2 offset:2048
 v_exp_f32 v50, v50
 v_mfma_f32_16x16x32_bf16 v[68:71], a[140:143], a[36:39], v[68:71]
 s_cselect_b64 s[68:69], -1, 0
 v_cvt_pk_bf16_f32 v16, v48, v49
 v_cvt_pk_bf16_f32 v17, v52, v53
 v_exp_f32 v51, v51
 v_mfma_f32_16x16x32_bf16 v[76:79], a[140:143], a[52:55], v[76:79]
 ds_read_b128 a[140:143], v2 offset:3072
 v_exp_f32 v54, v54
 v_exp_f32 v55, v55
 v_mfma_f32_16x16x32_bf16 v[64:67], a[144:147], a[40:43], v[64:67]
 v_cvt_pk_bf16_f32 v18, v50, v51
 v_cvt_pk_bf16_f32 v19, v54, v55
 v_mfma_f32_16x16x32_bf16 v[72:75], a[144:147], a[56:59], v[72:75]
 ds_read_b128 a[144:147], v2 offset:4096
 v_exp_f32 v56, v56
 v_exp_f32 v57, v57
 v_mfma_f32_16x16x32_bf16 v[68:71], a[148:151], a[40:43], v[68:71]
 s_cmp_le_u32 s49, s41
 v_exp_f32 v60, v60
 v_exp_f32 v61, v61
 v_mfma_f32_16x16x32_bf16 v[76:79], a[148:151], a[56:59], v[76:79]
 ds_read_b128 a[148:151], v2 offset:5120
 v_exp_f32 v58, v58
 v_mfma_f32_16x16x32_bf16 v[64:67], a[152:155], a[44:47], v[64:67]
 s_cselect_b64 s[70:71], -1, 0
 v_cvt_pk_bf16_f32 v20, v56, v57
 v_cvt_pk_bf16_f32 v21, v60, v61
 v_exp_f32 v59, v59
 v_mfma_f32_16x16x32_bf16 v[72:75], a[152:155], a[60:63], v[72:75]
 ds_read_b128 a[152:155], v2 offset:6144
 v_exp_f32 v62, v62
 v_exp_f32 v63, v63
 v_mfma_f32_16x16x32_bf16 v[68:71], a[156:159], a[44:47], v[68:71]
 v_cvt_pk_bf16_f32 v22, v58, v59
 v_cvt_pk_bf16_f32 v23, v62, v63
 v_mfma_f32_16x16x32_bf16 v[76:79], a[156:159], a[60:63], v[76:79]
 ds_read_b128 a[156:159], v2 offset:7168
 s_waitcnt lgkmcnt(8)
 v_mfma_f32_16x16x32_bf16 v[112:115], a[160:163], v[16:19], 0
 s_add_u32 s39, s39, 0x4000
 s_and_b32 s39, s39, 0x1ffff
 v_mfma_f32_16x16x32_bf16 v[144:147], a[160:163], v[20:23], 0
 s_cmp_eq_u32 s49, s41
 v_mfma_f32_16x16x32_bf16 v[116:119], a[164:167], v[16:19], 0
 s_cselect_b64 s[60:61], s[52:53], s[68:69]
 v_mfma_f32_16x16x32_bf16 v[148:151], a[164:167], v[20:23], 0
 s_cselect_b64 s[62:63], s[54:55], s[68:69]
 v_mov_b32 v3, v2
 v_add_u32 v2, s39, v1
 v_exp_f32 v64, v64
 v_mfma_f32_16x16x32_bf16 v[120:123], a[168:171], v[16:19], 0
 s_cselect_b64 s[64:65], s[56:57], s[68:69]
 v_exp_f32 v65, v65
 v_mfma_f32_16x16x32_bf16 v[152:155], a[168:171], v[20:23], 0
 s_cselect_b64 s[66:67], s[58:59], s[68:69]
 v_exp_f32 v68, v68
 v_mfma_f32_16x16x32_bf16 v[124:127], a[172:175], v[16:19], 0
 s_lshl_b32 s37, s35, 19
 v_exp_f32 v69, v69
 v_exp_f32 v66, v66
 v_mfma_f32_16x16x32_bf16 v[156:159], a[172:175], v[20:23], 0
 s_add_u32 m0, s38, s50
 v_cvt_pk_bf16_f32 v24, v64, v65
 v_cvt_pk_bf16_f32 v25, v68, v69
 v_mfma_f32_16x16x32_bf16 v[128:131], a[176:179], v[16:19], 0
 s_add_u32 s37, s37, s45
 v_exp_f32 v67, v67
 v_mfma_f32_16x16x32_bf16 v[160:163], a[176:179], v[20:23], 0
 buffer_load_dwordx4 v1, s[20:23], s37 offen offset:0 sc1 lds
 buffer_load_dwordx4 v1, s[20:23], s37 offen offset:1024 sc1 lds
 v_exp_f32 v70, v70
 v_mfma_f32_16x16x32_bf16 v[132:135], a[180:183], v[16:19], 0
 buffer_load_dwordx4 v1, s[20:23], s37 offen offset:2048 sc1 lds
 v_exp_f32 v71, v71
 v_cvt_pk_bf16_f32 v26, v66, v67
 v_cvt_pk_bf16_f32 v27, v70, v71
 v_mfma_f32_16x16x32_bf16 v[164:167], a[180:183], v[20:23], 0
 buffer_load_dwordx4 v1, s[20:23], s37 offen offset:3072 sc1 lds
 v_cndmask_b32 v80, v4, v12, s[60:61]
 v_cndmask_b32 v81, v4, v12, s[62:63]
 v_mfma_f32_16x16x32_bf16 v[136:139], a[184:187], v[16:19], 0
 s_add_u32 s38, s38, 0x4000
 v_cndmask_b32 v82, v4, v12, s[64:65]
 v_cndmask_b32 v83, v4, v12, s[66:67]
 v_mfma_f32_16x16x32_bf16 v[168:171], a[184:187], v[20:23], 0
 s_and_b32 s38, s38, 0x1ffff
 v_cndmask_b32 v84, v4, v12, s[68:69]
 v_cndmask_b32 v85, v4, v12, s[68:69]
 v_mfma_f32_16x16x32_bf16 v[140:143], a[188:191], v[16:19], 0
 s_add_u32 s35, s35, 1
 v_cndmask_b32 v86, v4, v12, s[68:69]
 v_cndmask_b32 v87, v4, v12, s[68:69]
 v_cndmask_b32 v88, v4, v13, s[70:71]
 v_cndmask_b32 v89, v4, v13, s[70:71]
 v_mfma_f32_16x16x32_bf16 v[172:175], a[188:191], v[20:23], 0
 s_cmp_eq_u32 s35, s36
 v_cndmask_b32 v90, v4, v13, s[70:71]
 v_cndmask_b32 v91, v4, v13, s[70:71]
 v_mfma_f32_16x16x32_bf16 v[32:35], a[192:195], v[16:19], 0
 s_cselect_b32 s36, s47, s36
 v_cndmask_b32 v92, v4, v13, s[60:61]
 v_cndmask_b32 v93, v4, v13, s[62:63]
 v_mfma_f32_16x16x32_bf16 v[36:39], a[192:195], v[20:23], 0
 s_cselect_b32 s35, 0, s35
 v_cndmask_b32 v94, v4, v13, s[64:65]
 v_cndmask_b32 v95, v4, v13, s[66:67]
 s_cmp_eq_u32 s43, 0
 s_cbranch_scc1 Lamk_14
 s_sub_u32 s40, s43, 1
 .p2align 3
Lapl_13:
 s_waitcnt lgkmcnt(0)
 v_mfma_f32_16x16x32_bf16 v[48:51], a[128:131], a[0:3], v[80:83]
 v_exp_f32 v72, v72
 v_mfma_f32_16x16x32_bf16 v[56:59], a[128:131], a[16:19], v[88:91]
 v_exp_f32 v73, v73
 v_mfma_f32_16x16x32_bf16 v[52:55], a[132:135], a[0:3], v[84:87]
 v_mfma_f32_16x16x32_bf16 v[60:63], a[132:135], a[16:19], v[92:95]
 v_exp_f32 v76, v76
 v_mfma_f32_16x16x32_bf16 v[48:51], a[136:139], a[4:7], v[48:51]
 v_exp_f32 v77, v77
 v_mfma_f32_16x16x32_bf16 v[56:59], a[136:139], a[20:23], v[56:59]
 v_mfma_f32_16x16x32_bf16 v[52:55], a[140:143], a[4:7], v[52:55]
 v_exp_f32 v74, v74
 v_mfma_f32_16x16x32_bf16 v[60:63], a[140:143], a[20:23], v[60:63]
 v_cvt_pk_bf16_f32 v28, v72, v73
 v_cvt_pk_bf16_f32 v29, v76, v77
 v_mfma_f32_16x16x32_bf16 v[48:51], a[144:147], a[8:11], v[48:51]
 v_mfma_f32_16x16x32_bf16 v[56:59], a[144:147], a[24:27], v[56:59]
 v_exp_f32 v75, v75
 v_mfma_f32_16x16x32_bf16 v[52:55], a[148:151], a[8:11], v[52:55]
 v_exp_f32 v78, v78
 v_mfma_f32_16x16x32_bf16 v[60:63], a[148:151], a[24:27], v[60:63]
 v_mfma_f32_16x16x32_bf16 v[48:51], a[152:155], a[12:15], v[48:51]
 v_exp_f32 v79, v79
 v_mfma_f32_16x16x32_bf16 v[56:59], a[152:155], a[28:31], v[56:59]
 v_cvt_pk_bf16_f32 v30, v74, v75
 v_cvt_pk_bf16_f32 v31, v78, v79
 v_mfma_f32_16x16x32_bf16 v[52:55], a[156:159], a[12:15], v[52:55]
 v_mfma_f32_16x16x32_bf16 v[60:63], a[156:159], a[28:31], v[60:63]
 v_mfma_f32_16x16x32_bf16 v[176:179], a[160:163], v[24:27], v[176:179]
 v_mfma_f32_16x16x32_bf16 v[208:211], a[160:163], v[28:31], v[208:211]
 ds_read_b128 a[160:163], v3 offset:8192
 v_mfma_f32_16x16x32_bf16 v[180:183], a[164:167], v[24:27], v[180:183]
 v_mfma_f32_16x16x32_bf16 v[212:215], a[164:167], v[28:31], v[212:215]
 ds_read_b128 a[164:167], v3 offset:9216
 v_exp_f32 v48, v48
 v_mfma_f32_16x16x32_bf16 v[184:187], a[168:171], v[24:27], v[184:187]
 v_exp_f32 v49, v49
 v_mfma_f32_16x16x32_bf16 v[216:219], a[168:171], v[28:31], v[216:219]
 ds_read_b128 a[168:171], v3 offset:10240
 v_exp_f32 v52, v52
 v_mfma_f32_16x16x32_bf16 v[188:191], a[172:175], v[24:27], v[188:191]
 v_mfma_f32_16x16x32_bf16 v[220:223], a[172:175], v[28:31], v[220:223]
 ds_read_b128 a[172:175], v3 offset:11264
 v_exp_f32 v53, v53
 v_mfma_f32_16x16x32_bf16 v[192:195], a[176:179], v[24:27], v[192:195]
 v_exp_f32 v50, v50
 v_mfma_f32_16x16x32_bf16 v[224:227], a[176:179], v[28:31], v[224:227]
 ds_read_b128 a[176:179], v3 offset:12288
 v_mfma_f32_16x16x32_bf16 v[196:199], a[180:183], v[24:27], v[196:199]
 v_cvt_pk_bf16_f32 v16, v48, v49
 v_cvt_pk_bf16_f32 v17, v52, v53
 v_mfma_f32_16x16x32_bf16 v[228:231], a[180:183], v[28:31], v[228:231]
 ds_read_b128 a[180:183], v3 offset:13312
 v_exp_f32 v51, v51
 v_mfma_f32_16x16x32_bf16 v[200:203], a[184:187], v[24:27], v[200:203]
 v_exp_f32 v54, v54
 v_mfma_f32_16x16x32_bf16 v[232:235], a[184:187], v[28:31], v[232:235]
 ds_read_b128 a[184:187], v3 offset:14336
 v_mfma_f32_16x16x32_bf16 v[204:207], a[188:191], v[24:27], v[204:207]
 v_exp_f32 v55, v55
 v_mfma_f32_16x16x32_bf16 v[236:239], a[188:191], v[28:31], v[236:239]
 ds_read_b128 a[188:191], v3 offset:15360
 v_cvt_pk_bf16_f32 v18, v50, v51
 v_cvt_pk_bf16_f32 v19, v54, v55
 v_mfma_f32_16x16x32_bf16 v[40:43], a[192:195], v[24:27], v[40:43]
 v_mfma_f32_16x16x32_bf16 v[44:47], a[192:195], v[28:31], v[44:47]
 v_mfma_f32_16x16x32_bf16 v[64:67], a[128:131], a[32:35], v[96:99]
 s_waitcnt vmcnt(4)
 s_barrier
 v_exp_f32 v56, v56
 v_mfma_f32_16x16x32_bf16 v[72:75], a[128:131], a[48:51], v[104:107]
 ds_read_b128 a[128:131], v2 offset:0
 v_exp_f32 v57, v57
 v_mfma_f32_16x16x32_bf16 v[68:71], a[132:135], a[32:35], v[100:103]
 s_add_u32 s39, s39, 0x4000
 v_mfma_f32_16x16x32_bf16 v[76:79], a[132:135], a[48:51], v[108:111]
 ds_read_b128 a[132:135], v2 offset:1024
 v_exp_f32 v60, v60
 v_mfma_f32_16x16x32_bf16 v[64:67], a[136:139], a[36:39], v[64:67]
 v_exp_f32 v61, v61
 v_mfma_f32_16x16x32_bf16 v[72:75], a[136:139], a[52:55], v[72:75]
 ds_read_b128 a[136:139], v2 offset:2048
 v_mfma_f32_16x16x32_bf16 v[68:71], a[140:143], a[36:39], v[68:71]
 v_exp_f32 v58, v58
 v_mfma_f32_16x16x32_bf16 v[76:79], a[140:143], a[52:55], v[76:79]
 ds_read_b128 a[140:143], v2 offset:3072
 v_cvt_pk_bf16_f32 v20, v56, v57
 v_cvt_pk_bf16_f32 v21, v60, v61
 v_mfma_f32_16x16x32_bf16 v[64:67], a[144:147], a[40:43], v[64:67]
 s_and_b32 s39, s39, 0x1ffff
 v_mfma_f32_16x16x32_bf16 v[72:75], a[144:147], a[56:59], v[72:75]
 ds_read_b128 a[144:147], v2 offset:4096
 v_exp_f32 v59, v59
 v_mfma_f32_16x16x32_bf16 v[68:71], a[148:151], a[40:43], v[68:71]
 v_exp_f32 v62, v62
 v_mfma_f32_16x16x32_bf16 v[76:79], a[148:151], a[56:59], v[76:79]
 ds_read_b128 a[148:151], v2 offset:5120
 v_mfma_f32_16x16x32_bf16 v[64:67], a[152:155], a[44:47], v[64:67]
 v_exp_f32 v63, v63
 v_mfma_f32_16x16x32_bf16 v[72:75], a[152:155], a[60:63], v[72:75]
 ds_read_b128 a[152:155], v2 offset:6144
 v_cvt_pk_bf16_f32 v22, v58, v59
 v_cvt_pk_bf16_f32 v23, v62, v63
 v_mfma_f32_16x16x32_bf16 v[68:71], a[156:159], a[44:47], v[68:71]
 v_mfma_f32_16x16x32_bf16 v[76:79], a[156:159], a[60:63], v[76:79]
 ds_read_b128 a[156:159], v2 offset:7168
 s_waitcnt lgkmcnt(8)
 v_mfma_f32_16x16x32_bf16 v[112:115], a[160:163], v[16:19], v[112:115]
 s_lshl_b32 s37, s35, 19
 v_mov_b32 v3, v2
 v_add_u32 v2, s39, v1
 v_mfma_f32_16x16x32_bf16 v[144:147], a[160:163], v[20:23], v[144:147]
 s_add_u32 m0, s38, s50
 v_mfma_f32_16x16x32_bf16 v[116:119], a[164:167], v[16:19], v[116:119]
 s_add_u32 s37, s37, s45
 v_mfma_f32_16x16x32_bf16 v[148:151], a[164:167], v[20:23], v[148:151]
 buffer_load_dwordx4 v1, s[20:23], s37 offen offset:0 sc1 lds
 v_exp_f32 v64, v64
 v_mfma_f32_16x16x32_bf16 v[120:123], a[168:171], v[16:19], v[120:123]
 buffer_load_dwordx4 v1, s[20:23], s37 offen offset:1024 sc1 lds
 v_mfma_f32_16x16x32_bf16 v[152:155], a[168:171], v[20:23], v[152:155]
 v_exp_f32 v65, v65
 v_mfma_f32_16x16x32_bf16 v[124:127], a[172:175], v[16:19], v[124:127]
 buffer_load_dwordx4 v1, s[20:23], s37 offen offset:2048 sc1 lds
 v_exp_f32 v68, v68
 v_mfma_f32_16x16x32_bf16 v[156:159], a[172:175], v[20:23], v[156:159]
 buffer_load_dwordx4 v1, s[20:23], s37 offen offset:3072 sc1 lds
 v_exp_f32 v69, v69
 v_mfma_f32_16x16x32_bf16 v[128:131], a[176:179], v[16:19], v[128:131]
 s_add_u32 s38, s38, 0x4000
 v_mfma_f32_16x16x32_bf16 v[160:163], a[176:179], v[20:23], v[160:163]
 s_and_b32 s38, s38, 0x1ffff
 v_exp_f32 v66, v66
 v_mfma_f32_16x16x32_bf16 v[132:135], a[180:183], v[16:19], v[132:135]
 s_add_u32 s35, s35, 1
 v_cvt_pk_bf16_f32 v24, v64, v65
 v_cvt_pk_bf16_f32 v25, v68, v69
 v_mfma_f32_16x16x32_bf16 v[164:167], a[180:183], v[20:23], v[164:167]
 v_exp_f32 v67, v67
 v_mfma_f32_16x16x32_bf16 v[136:139], a[184:187], v[16:19], v[136:139]
 s_cmp_eq_u32 s35, s36
 v_mfma_f32_16x16x32_bf16 v[168:171], a[184:187], v[20:23], v[168:171]
 s_cselect_b32 s36, s47, s36
 v_exp_f32 v70, v70
 v_mfma_f32_16x16x32_bf16 v[140:143], a[188:191], v[16:19], v[140:143]
 s_cselect_b32 s35, 0, s35
 v_exp_f32 v71, v71
 v_mfma_f32_16x16x32_bf16 v[172:175], a[188:191], v[20:23], v[172:175]
 s_add_u32 s49, s49, 1
 v_cvt_pk_bf16_f32 v26, v66, v67
 v_cvt_pk_bf16_f32 v27, v70, v71
 v_mfma_f32_16x16x32_bf16 v[32:35], a[192:195], v[16:19], v[32:35]
 s_cmp_lt_u32 s49, s40
 v_mfma_f32_16x16x32_bf16 v[36:39], a[192:195], v[20:23], v[36:39]
 s_cbranch_scc1 Lapl_13
Lamk_14:
 s_add_u32 s40, s43, 4
 .p2align 3
Lamk_16:
 s_waitcnt lgkmcnt(0)
 v_mfma_f32_16x16x32_bf16 v[48:51], a[128:131], a[0:3], v[80:83]
 s_add_u32 s49, s49, 1
 v_exp_f32 v72, v72
 v_mfma_f32_16x16x32_bf16 v[56:59], a[128:131], a[16:19], v[88:91]
 s_cmp_lt_u32 s49, s41
 v_exp_f32 v73, v73
 v_mfma_f32_16x16x32_bf16 v[52:55], a[132:135], a[0:3], v[84:87]
 v_mfma_f32_16x16x32_bf16 v[60:63], a[132:135], a[16:19], v[92:95]
 s_cselect_b64 s[68:69], -1, 0
 v_exp_f32 v76, v76
 v_mfma_f32_16x16x32_bf16 v[48:51], a[136:139], a[4:7], v[48:51]
 s_cmp_le_u32 s49, s41
 v_exp_f32 v77, v77
 v_mfma_f32_16x16x32_bf16 v[56:59], a[136:139], a[20:23], v[56:59]
 v_mfma_f32_16x16x32_bf16 v[52:55], a[140:143], a[4:7], v[52:55]
 s_cselect_b64 s[70:71], -1, 0
 v_exp_f32 v74, v74
 v_mfma_f32_16x16x32_bf16 v[60:63], a[140:143], a[20:23], v[60:63]
 v_cvt_pk_bf16_f32 v28, v72, v73
 v_cvt_pk_bf16_f32 v29, v76, v77
 v_mfma_f32_16x16x32_bf16 v[48:51], a[144:147], a[8:11], v[48:51]
 s_cmp_eq_u32 s49, s41
 v_mfma_f32_16x16x32_bf16 v[56:59], a[144:147], a[24:27], v[56:59]
 s_cselect_b64 s[60:61], s[52:53], s[68:69]
 v_exp_f32 v75, v75
 v_mfma_f32_16x16x32_bf16 v[52:55], a[148:151], a[8:11], v[52:55]
 v_exp_f32 v78, v78
 v_mfma_f32_16x16x32_bf16 v[60:63], a[148:151], a[24:27], v[60:63]
 s_cselect_b64 s[62:63], s[54:55], s[68:69]
 v_mfma_f32_16x16x32_bf16 v[48:51], a[152:155], a[12:15], v[48:51]
 s_cselect_b64 s[64:65], s[56:57], s[68:69]
 v_exp_f32 v79, v79
 v_mfma_f32_16x16x32_bf16 v[56:59], a[152:155], a[28:31], v[56:59]
 v_cvt_pk_bf16_f32 v30, v74, v75
 v_cvt_pk_bf16_f32 v31, v78, v79
 v_mfma_f32_16x16x32_bf16 v[52:55], a[156:159], a[12:15], v[52:55]
 s_cselect_b64 s[66:67], s[58:59], s[68:69]
 v_mfma_f32_16x16x32_bf16 v[60:63], a[156:159], a[28:31], v[60:63]
 v_mfma_f32_16x16x32_bf16 v[176:179], a[160:163], v[24:27], v[176:179]
 v_mfma_f32_16x16x32_bf16 v[208:211], a[160:163], v[28:31], v[208:211]
 ds_read_b128 a[160:163], v3 offset:8192
 v_mfma_f32_16x16x32_bf16 v[180:183], a[164:167], v[24:27], v[180:183]
 v_mfma_f32_16x16x32_bf16 v[212:215], a[164:167], v[28:31], v[212:215]
 ds_read_b128 a[164:167], v3 offset:9216
 v_exp_f32 v48, v48
 v_mfma_f32_16x16x32_bf16 v[184:187], a[168:171], v[24:27], v[184:187]
 v_exp_f32 v49, v49
 v_mfma_f32_16x16x32_bf16 v[216:219], a[168:171], v[28:31], v[216:219]
 ds_read_b128 a[168:171], v3 offset:10240
 v_exp_f32 v52, v52
 v_mfma_f32_16x16x32_bf16 v[188:191], a[172:175], v[24:27], v[188:191]
 v_exp_f32 v53, v53
 v_mfma_f32_16x16x32_bf16 v[220:223], a[172:175], v[28:31], v[220:223]
 ds_read_b128 a[172:175], v3 offset:11264
 v_exp_f32 v50, v50
 v_mfma_f32_16x16x32_bf16 v[192:195], a[176:179], v[24:27], v[192:195]
 v_cvt_pk_bf16_f32 v16, v48, v49
 v_cvt_pk_bf16_f32 v17, v52, v53
 v_mfma_f32_16x16x32_bf16 v[224:227], a[176:179], v[28:31], v[224:227]
 ds_read_b128 a[176:179], v3 offset:12288
 v_exp_f32 v51, v51
 v_mfma_f32_16x16x32_bf16 v[196:199], a[180:183], v[24:27], v[196:199]
 v_exp_f32 v54, v54
 v_mfma_f32_16x16x32_bf16 v[228:231], a[180:183], v[28:31], v[228:231]
 ds_read_b128 a[180:183], v3 offset:13312
 v_exp_f32 v55, v55
 v_mfma_f32_16x16x32_bf16 v[200:203], a[184:187], v[24:27], v[200:203]
 v_cvt_pk_bf16_f32 v18, v50, v51
 v_cvt_pk_bf16_f32 v19, v54, v55
 v_mfma_f32_16x16x32_bf16 v[232:235], a[184:187], v[28:31], v[232:235]
 ds_read_b128 a[184:187], v3 offset:14336
 v_cndmask_b32 v80, v4, v12, s[60:61]
 v_cndmask_b32 v81, v4, v12, s[62:63]
 v_mfma_f32_16x16x32_bf16 v[204:207], a[188:191], v[24:27], v[204:207]
 v_cndmask_b32 v82, v4, v12, s[64:65]
 v_cndmask_b32 v83, v4, v12, s[66:67]
 v_mfma_f32_16x16x32_bf16 v[236:239], a[188:191], v[28:31], v[236:239]
 ds_read_b128 a[188:191], v3 offset:15360
 v_cndmask_b32 v84, v4, v12, s[68:69]
 v_cndmask_b32 v85, v4, v12, s[68:69]
 v_mfma_f32_16x16x32_bf16 v[40:43], a[192:195], v[24:27], v[40:43]
 v_cndmask_b32 v86, v4, v12, s[68:69]
 v_cndmask_b32 v87, v4, v12, s[68:69]
 v_mfma_f32_16x16x32_bf16 v[44:47], a[192:195], v[28:31], v[44:47]
 v_mfma_f32_16x16x32_bf16 v[64:67], a[128:131], a[32:35], v[96:99]
 s_waitcnt vmcnt(4)
 s_barrier
 v_exp_f32 v56, v56
 v_mfma_f32_16x16x32_bf16 v[72:75], a[128:131], a[48:51], v[104:107]
 ds_read_b128 a[128:131], v2 offset:0
 v_exp_f32 v57, v57
 v_mfma_f32_16x16x32_bf16 v[68:71], a[132:135], a[32:35], v[100:103]
 s_add_u32 s39, s39, 0x4000
 v_exp_f32 v60, v60
 v_mfma_f32_16x16x32_bf16 v[76:79], a[132:135], a[48:51], v[108:111]
 ds_read_b128 a[132:135], v2 offset:1024
 v_exp_f32 v61, v61
 v_mfma_f32_16x16x32_bf16 v[64:67], a[136:139], a[36:39], v[64:67]
 v_exp_f32 v58, v58
 v_mfma_f32_16x16x32_bf16 v[72:75], a[136:139], a[52:55], v[72:75]
 ds_read_b128 a[136:139], v2 offset:2048
 v_cvt_pk_bf16_f32 v20, v56, v57
 v_cvt_pk_bf16_f32 v21, v60, v61
 v_mfma_f32_16x16x32_bf16 v[68:71], a[140:143], a[36:39], v[68:71]
 v_exp_f32 v59, v59
 v_mfma_f32_16x16x32_bf16 v[76:79], a[140:143], a[52:55], v[76:79]
 ds_read_b128 a[140:143], v2 offset:3072
 v_exp_f32 v62, v62
 v_mfma_f32_16x16x32_bf16 v[64:67], a[144:147], a[40:43], v[64:67]
 s_and_b32 s39, s39, 0x1ffff
 v_exp_f32 v63, v63
 v_mfma_f32_16x16x32_bf16 v[72:75], a[144:147], a[56:59], v[72:75]
 ds_read_b128 a[144:147], v2 offset:4096
 v_cvt_pk_bf16_f32 v22, v58, v59
 v_cvt_pk_bf16_f32 v23, v62, v63
 v_mfma_f32_16x16x32_bf16 v[68:71], a[148:151], a[40:43], v[68:71]
 v_cndmask_b32 v88, v4, v13, s[70:71]
 v_cndmask_b32 v89, v4, v13, s[70:71]
 v_mfma_f32_16x16x32_bf16 v[76:79], a[148:151], a[56:59], v[76:79]
 ds_read_b128 a[148:151], v2 offset:5120
 v_cndmask_b32 v90, v4, v13, s[70:71]
 v_cndmask_b32 v91, v4, v13, s[70:71]
 v_mfma_f32_16x16x32_bf16 v[64:67], a[152:155], a[44:47], v[64:67]
 v_cndmask_b32 v92, v4, v13, s[60:61]
 v_cndmask_b32 v93, v4, v13, s[62:63]
 v_mfma_f32_16x16x32_bf16 v[72:75], a[152:155], a[60:63], v[72:75]
 ds_read_b128 a[152:155], v2 offset:6144
 v_cndmask_b32 v94, v4, v13, s[64:65]
 v_cndmask_b32 v95, v4, v13, s[66:67]
 v_mfma_f32_16x16x32_bf16 v[68:71], a[156:159], a[44:47], v[68:71]
 v_mfma_f32_16x16x32_bf16 v[76:79], a[156:159], a[60:63], v[76:79]
 ds_read_b128 a[156:159], v2 offset:7168
 s_waitcnt lgkmcnt(8)
 v_mfma_f32_16x16x32_bf16 v[112:115], a[160:163], v[16:19], v[112:115]
 s_lshl_b32 s37, s35, 19
 v_mov_b32 v3, v2
 v_add_u32 v2, s39, v1
 v_mfma_f32_16x16x32_bf16 v[144:147], a[160:163], v[20:23], v[144:147]
 s_add_u32 m0, s38, s50
 v_mfma_f32_16x16x32_bf16 v[116:119], a[164:167], v[16:19], v[116:119]
 s_add_u32 s37, s37, s45
 v_mfma_f32_16x16x32_bf16 v[148:151], a[164:167], v[20:23], v[148:151]
 buffer_load_dwordx4 v1, s[20:23], s37 offen offset:0 sc1 lds
 v_exp_f32 v64, v64
 v_mfma_f32_16x16x32_bf16 v[120:123], a[168:171], v[16:19], v[120:123]
 v_mfma_f32_16x16x32_bf16 v[152:155], a[168:171], v[20:23], v[152:155]
 buffer_load_dwordx4 v1, s[20:23], s37 offen offset:1024 sc1 lds
 v_exp_f32 v65, v65
 v_mfma_f32_16x16x32_bf16 v[124:127], a[172:175], v[16:19], v[124:127]
 buffer_load_dwordx4 v1, s[20:23], s37 offen offset:2048 sc1 lds
 v_exp_f32 v68, v68
 v_mfma_f32_16x16x32_bf16 v[156:159], a[172:175], v[20:23], v[156:159]
 buffer_load_dwordx4 v1, s[20:23], s37 offen offset:3072 sc1 lds
 v_exp_f32 v69, v69
 v_mfma_f32_16x16x32_bf16 v[128:131], a[176:179], v[16:19], v[128:131]
 v_mfma_f32_16x16x32_bf16 v[160:163], a[176:179], v[20:23], v[160:163]
 s_add_u32 s38, s38, 0x4000
 v_exp_f32 v66, v66
 v_mfma_f32_16x16x32_bf16 v[132:135], a[180:183], v[16:19], v[132:135]
 s_and_b32 s38, s38, 0x1ffff
 v_cvt_pk_bf16_f32 v24, v64, v65
 v_cvt_pk_bf16_f32 v25, v68, v69
 v_mfma_f32_16x16x32_bf16 v[164:167], a[180:183], v[20:23], v[164:167]
 s_add_u32 s35, s35, 1
 v_exp_f32 v67, v67
 v_mfma_f32_16x16x32_bf16 v[136:139], a[184:187], v[16:19], v[136:139]
 s_cmp_eq_u32 s35, s36
 v_mfma_f32_16x16x32_bf16 v[168:171], a[184:187], v[20:23], v[168:171]
 v_exp_f32 v70, v70
 v_mfma_f32_16x16x32_bf16 v[140:143], a[188:191], v[16:19], v[140:143]
 s_cselect_b32 s36, s47, s36
 v_exp_f32 v71, v71
 v_mfma_f32_16x16x32_bf16 v[172:175], a[188:191], v[20:23], v[172:175]
 s_cselect_b32 s35, 0, s35
 v_cvt_pk_bf16_f32 v26, v66, v67
 v_cvt_pk_bf16_f32 v27, v70, v71
 v_mfma_f32_16x16x32_bf16 v[32:35], a[192:195], v[16:19], v[32:35]
 s_cmp_lt_u32 s49, s40
 v_mfma_f32_16x16x32_bf16 v[36:39], a[192:195], v[20:23], v[36:39]
 s_cbranch_scc1 Lamk_16
 s_add_u32 s40, s43, 8
 s_cmp_eq_u32 s46, 0
 s_cbranch_scc0 Laq2_17
 v_min_u32 v10, 16, v1
 v_lshlrev_b32 v10, 24, v10
Law_19:
 buffer_load_dwordx4 v[240:243], v10, s[20:23], s94 offen sc1
 s_waitcnt vmcnt(0)
 v_min3_u32 v240, v240, v241, v242
 v_min_u32 v240, v240, v243
 v_cmp_le_u32 vcc, 16, v240
 s_cbranch_vccnz Lawk_20
 s_sleep 2
 s_sub_u32 s95, s95, 1
 s_cbranch_scc0 Law_19
 s_endpgm
Lawk_20:
 s_lshl_b32 s44, s34, 3
 s_add_u32 s44, s44, s4
 s_lshl_b32 s44, s44, 5
 s_add_u32 s44, s44, s32
 s_lshl_b32 s44, s44, 13
 s_add_u32 s44, s44, 0x5000000
 buffer_load_dwordx4 a[64:67], v1, s[20:23], s44 offen offset:0 sc1
 buffer_load_dwordx4 a[80:83], v1, s[20:23], s44 offen offset:1024 sc1
 buffer_load_dwordx4 a[68:71], v1, s[20:23], s44 offen offset:2048 sc1
 buffer_load_dwordx4 a[84:87], v1, s[20:23], s44 offen offset:3072 sc1
 s_add_u32 s44, s44, 4096
 buffer_load_dwordx4 a[72:75], v1, s[20:23], s44 offen offset:0 sc1
 buffer_load_dwordx4 a[88:91], v1, s[20:23], s44 offen offset:1024 sc1
 buffer_load_dwordx4 a[76:79], v1, s[20:23], s44 offen offset:2048 sc1
 buffer_load_dwordx4 a[92:95], v1, s[20:23], s44 offen offset:3072 sc1
 s_lshl_b32 s44, s34, 3
 s_add_u32 s44, s44, 7
 s_sub_u32 s44, s44, s4
 s_lshl_b32 s44, s44, 5
 s_add_u32 s44, s44, s32
 s_lshl_b32 s44, s44, 13
 s_add_u32 s44, s44, 0x5000000
 buffer_load_dwordx4 a[96:99], v1, s[20:23], s44 offen offset:0 sc1
 buffer_load_dwordx4 a[112:115], v1, s[20:23], s44 offen offset:1024 sc1
 buffer_load_dwordx4 a[100:103], v1, s[20:23], s44 offen offset:2048 sc1
 buffer_load_dwordx4 a[116:119], v1, s[20:23], s44 offen offset:3072 sc1
 s_add_u32 s44, s44, 4096
 buffer_load_dwordx4 a[104:107], v1, s[20:23], s44 offen offset:0 sc1
 buffer_load_dwordx4 a[120:123], v1, s[20:23], s44 offen offset:1024 sc1
 buffer_load_dwordx4 a[108:111], v1, s[20:23], s44 offen offset:2048 sc1
 buffer_load_dwordx4 a[124:127], v1, s[20:23], s44 offen offset:3072 sc1
 s_branch Laq2_18
Laq2_17:
 v_mov_b32 v6, 1
 buffer_store_dword v6, v5, s[20:23], s72 offen sc1
Laq2_18:
 s_cmp_lt_u32 s49, s42
 s_cselect_b64 s[68:69], -1, 0
 s_cmp_le_u32 s49, s42
 s_cselect_b64 s[70:71], -1, 0
 s_cmp_eq_u32 s49, s42
 s_cselect_b64 s[60:61], s[52:53], s[68:69]
 s_cselect_b64 s[62:63], s[54:55], s[68:69]
 s_cselect_b64 s[64:65], s[56:57], s[68:69]
 s_cselect_b64 s[66:67], s[58:59], s[68:69]
 v_mfma_f32_16x16x32_bf16 v[176:179], a[160:163], v[24:27], v[176:179]
 v_cndmask_b32 v96, v4, v14, s[60:61]
 v_cndmask_b32 v97, v4, v14, s[62:63]
 v_mfma_f32_16x16x32_bf16 v[180:183], a[164:167], v[24:27], v[180:183]
 v_cndmask_b32 v98, v4, v14, s[64:65]
 v_cndmask_b32 v99, v4, v14, s[66:67]
 v_mfma_f32_16x16x32_bf16 v[184:187], a[168:171], v[24:27], v[184:187]
 v_cndmask_b32 v100, v4, v14, s[68:69]
 v_cndmask_b32 v101, v4, v14, s[68:69]
 v_mfma_f32_16x16x32_bf16 v[188:191], a[172:175], v[24:27], v[188:191]
 v_exp_f32 v72, v72
 v_mfma_f32_16x16x32_bf16 v[192:195], a[176:179], v[24:27], v[192:195]
 v_exp_f32 v73, v73
 v_mfma_f32_16x16x32_bf16 v[196:199], a[180:183], v[24:27], v[196:199]
 v_exp_f32 v76, v76
 v_mfma_f32_16x16x32_bf16 v[200:203], a[184:187], v[24:27], v[200:203]
 v_exp_f32 v77, v77
 v_mfma_f32_16x16x32_bf16 v[204:207], a[188:191], v[24:27], v[204:207]
 v_exp_f32 v74, v74
 v_mfma_f32_16x16x32_bf16 v[40:43], a[192:195], v[24:27], v[40:43]
 v_cndmask_b32 v102, v4, v14, s[68:69]
 v_cndmask_b32 v103, v4, v14, s[68:69]
 s_nop 0
 .p2align 3
Lam1_15:
 s_waitcnt lgkmcnt(0)
 v_mfma_f32_16x16x32_bf16 v[64:67], a[128:131], a[32:35], v[96:99]
 v_cvt_pk_bf16_f32 v28, v72, v73
 v_cvt_pk_bf16_f32 v29, v76, v77
 v_mfma_f32_16x16x32_bf16 v[68:71], a[132:135], a[32:35], v[100:103]
 v_exp_f32 v75, v75
 v_mfma_f32_16x16x32_bf16 v[64:67], a[136:139], a[36:39], v[64:67]
 v_exp_f32 v78, v78
 v_mfma_f32_16x16x32_bf16 v[68:71], a[140:143], a[36:39], v[68:71]
 v_exp_f32 v79, v79
 v_mfma_f32_16x16x32_bf16 v[64:67], a[144:147], a[40:43], v[64:67]
 v_cvt_pk_bf16_f32 v30, v74, v75
 v_cvt_pk_bf16_f32 v31, v78, v79
 v_mfma_f32_16x16x32_bf16 v[68:71], a[148:151], a[40:43], v[68:71]
 v_cndmask_b32 v104, v4, v15, s[70:71]
 v_cndmask_b32 v105, v4, v15, s[70:71]
 v_mfma_f32_16x16x32_bf16 v[64:67], a[152:155], a[44:47], v[64:67]
 v_mfma_f32_16x16x32_bf16 v[68:71], a[156:159], a[44:47], v[68:71]
 v_mfma_f32_16x16x32_bf16 v[208:211], a[160:163], v[28:31], v[208:211]
 ds_read_b128 a[160:163], v3 offset:8192
 v_cndmask_b32 v106, v4, v15, s[70:71]
 v_cndmask_b32 v107, v4, v15, s[70:71]
 v_mfma_f32_16x16x32_bf16 v[212:215], a[164:167], v[28:31], v[212:215]
 ds_read_b128 a[164:167], v3 offset:9216
 v_cndmask_b32 v108, v4, v15, s[60:61]
 v_cndmask_b32 v109, v4, v15, s[62:63]
 v_mfma_f32_16x16x32_bf16 v[216:219], a[168:171], v[28:31], v[216:219]
 ds_read_b128 a[168:171], v3 offset:10240
 v_cndmask_b32 v110, v4, v15, s[64:65]
 v_cndmask_b32 v111, v4, v15, s[66:67]
 v_mfma_f32_16x16x32_bf16 v[220:223], a[172:175], v[28:31], v[220:223]
 ds_read_b128 a[172:175], v3 offset:11264
 v_exp_f32 v64, v64
 v_mfma_f32_16x16x32_bf16 v[224:227], a[176:179], v[28:31], v[224:227]
 ds_read_b128 a[176:179], v3 offset:12288
 v_exp_f32 v65, v65
 v_mfma_f32_16x16x32_bf16 v[228:231], a[180:183], v[28:31], v[228:231]
 ds_read_b128 a[180:183], v3 offset:13312
 v_exp_f32 v68, v68
 v_mfma_f32_16x16x32_bf16 v[232:235], a[184:187], v[28:31], v[232:235]
 ds_read_b128 a[184:187], v3 offset:14336
 v_exp_f32 v69, v69
 v_mfma_f32_16x16x32_bf16 v[236:239], a[188:191], v[28:31], v[236:239]
 ds_read_b128 a[188:191], v3 offset:15360
 v_exp_f32 v66, v66
 v_mfma_f32_16x16x32_bf16 v[44:47], a[192:195], v[28:31], v[44:47]
 v_mfma_f32_16x16x32_bf16 v[72:75], a[128:131], a[48:51], v[104:107]
 s_waitcnt vmcnt(4)
 s_barrier
 ds_read_b128 a[128:131], v2 offset:0
 s_add_u32 s39, s39, 0x4000
 v_cvt_pk_bf16_f32 v24, v64, v65
 v_cvt_pk_bf16_f32 v25, v68, v69
 v_mfma_f32_16x16x32_bf16 v[76:79], a[132:135], a[48:51], v[108:111]
 ds_read_b128 a[132:135], v2 offset:1024
 v_exp_f32 v67, v67
 v_mfma_f32_16x16x32_bf16 v[72:75], a[136:139], a[52:55], v[72:75]
 ds_read_b128 a[136:139], v2 offset:2048
 v_exp_f32 v70, v70
 v_mfma_f32_16x16x32_bf16 v[76:79], a[140:143], a[52:55], v[76:79]
 ds_read_b128 a[140:143], v2 offset:3072
 v_mfma_f32_16x16x32_bf16 v[72:75], a[144:147], a[56:59], v[72:75]
 ds_read_b128 a[144:147], v2 offset:4096
 s_and_b32 s39, s39, 0x1ffff
 v_exp_f32 v71, v71
 v_mfma_f32_16x16x32_bf16 v[76:79], a[148:151], a[56:59], v[76:79]
 ds_read_b128 a[148:151], v2 offset:5120
 v_cvt_pk_bf16_f32 v26, v66, v67
 v_cvt_pk_bf16_f32 v27, v70, v71
 v_mfma_f32_16x16x32_bf16 v[72:75], a[152:155], a[60:63], v[72:75]
 ds_read_b128 a[152:155], v2 offset:6144
 v_mfma_f32_16x16x32_bf16 v[76:79], a[156:159], a[60:63], v[76:79]
 ds_read_b128 a[156:159], v2 offset:7168
 s_waitcnt lgkmcnt(8)
 s_add_u32 s49, s49, 1
 s_cmp_lt_u32 s49, s42
 s_cselect_b64 s[68:69], -1, 0
 s_cmp_le_u32 s49, s42
 s_cselect_b64 s[70:71], -1, 0
 s_cmp_eq_u32 s49, s42
 s_cselect_b64 s[60:61], s[52:53], s[68:69]
 s_cselect_b64 s[62:63], s[54:55], s[68:69]
 s_cselect_b64 s[64:65], s[56:57], s[68:69]
 s_cselect_b64 s[66:67], s[58:59], s[68:69]
 v_mfma_f32_16x16x32_bf16 v[176:179], a[160:163], v[24:27], v[176:179]
 s_lshl_b32 s37, s35, 19
 s_add_u32 m0, s38, s50
 v_mov_b32 v3, v2
 v_add_u32 v2, s39, v1
 v_cndmask_b32 v96, v4, v14, s[60:61]
 v_cndmask_b32 v97, v4, v14, s[62:63]
 v_mfma_f32_16x16x32_bf16 v[180:183], a[164:167], v[24:27], v[180:183]
 s_add_u32 s37, s37, s45
 buffer_load_dwordx4 v1, s[20:23], s37 offen offset:0 sc1 lds
 v_cndmask_b32 v98, v4, v14, s[64:65]
 v_cndmask_b32 v99, v4, v14, s[66:67]
 v_mfma_f32_16x16x32_bf16 v[184:187], a[168:171], v[24:27], v[184:187]
 buffer_load_dwordx4 v1, s[20:23], s37 offen offset:1024 sc1 lds
 v_exp_f32 v72, v72
 v_mfma_f32_16x16x32_bf16 v[188:191], a[172:175], v[24:27], v[188:191]
 buffer_load_dwordx4 v1, s[20:23], s37 offen offset:2048 sc1 lds
 buffer_load_dwordx4 v1, s[20:23], s37 offen offset:3072 sc1 lds
 v_exp_f32 v73, v73
 v_mfma_f32_16x16x32_bf16 v[192:195], a[176:179], v[24:27], v[192:195]
 s_add_u32 s38, s38, 0x4000
 v_exp_f32 v76, v76
 v_mfma_f32_16x16x32_bf16 v[196:199], a[180:183], v[24:27], v[196:199]
 s_and_b32 s38, s38, 0x1ffff
 s_add_u32 s35, s35, 1
 v_exp_f32 v77, v77
 v_mfma_f32_16x16x32_bf16 v[200:203], a[184:187], v[24:27], v[200:203]
 s_cmp_eq_u32 s35, s36
 v_exp_f32 v74, v74
 v_mfma_f32_16x16x32_bf16 v[204:207], a[188:191], v[24:27], v[204:207]
 s_cselect_b32 s36, s47, s36
 s_cselect_b32 s35, 0, s35
 v_cndmask_b32 v100, v4, v14, s[68:69]
 v_cndmask_b32 v101, v4, v14, s[68:69]
 v_mfma_f32_16x16x32_bf16 v[40:43], a[192:195], v[24:27], v[40:43]
 s_cmp_lt_u32 s49, s40
 v_cndmask_b32 v102, v4, v14, s[68:69]
 v_cndmask_b32 v103, v4, v14, s[68:69]
 s_cbranch_scc1 Lam1_15
 v_cvt_pk_bf16_f32 v28, v72, v73
 v_cvt_pk_bf16_f32 v29, v76, v77
 v_exp_f32 v75, v75
 v_exp_f32 v78, v78
 v_exp_f32 v79, v79
 v_cvt_pk_bf16_f32 v30, v74, v75
 v_cvt_pk_bf16_f32 v31, v78, v79
 s_nop 1
 v_mfma_f32_16x16x32_bf16 v[44:47], a[192:195], v[28:31], v[44:47]
 v_mfma_f32_16x16x32_bf16 v[208:211], a[160:163], v[28:31], v[208:211]
 v_mfma_f32_16x16x32_bf16 v[212:215], a[164:167], v[28:31], v[212:215]
 v_mfma_f32_16x16x32_bf16 v[216:219], a[168:171], v[28:31], v[216:219]
 v_mfma_f32_16x16x32_bf16 v[220:223], a[172:175], v[28:31], v[220:223]
 v_mfma_f32_16x16x32_bf16 v[224:227], a[176:179], v[28:31], v[224:227]
 v_mfma_f32_16x16x32_bf16 v[228:231], a[180:183], v[28:31], v[228:231]
 v_mfma_f32_16x16x32_bf16 v[232:235], a[184:187], v[28:31], v[232:235]
 v_mfma_f32_16x16x32_bf16 v[236:239], a[188:191], v[28:31], v[236:239]
 v_cmp_ngt_f32 s[60:61], s73, v32
 v_cmp_nlt_f32 vcc, s74, v32
 s_or_b64 s[60:61], s[60:61], vcc
 v_cmp_ngt_f32 s[62:63], s73, v36
 v_cmp_nlt_f32 vcc, s74, v36
 s_or_b64 s[62:63], s[62:63], vcc
 v_cmp_ngt_f32 s[64:65], s73, v40
 v_cmp_nlt_f32 vcc, s74, v40
 s_or_b64 s[64:65], s[64:65], vcc
 v_cmp_ngt_f32 s[66:67], s73, v44
 v_cmp_nlt_f32 vcc, s74, v44
 s_or_b64 s[66:67], s[66:67], vcc
 s_or_b64 s[60:61], s[60:61], s[62:63]
 s_or_b64 s[64:65], s[64:65], s[66:67]
 s_or_b64 s[60:61], s[60:61], s[64:65]
 s_cbranch_scc1 Laslow_10
Laback_11:
 v_rcp_f32 v32, v32
 v_rcp_f32 v36, v36
 v_rcp_f32 v40, v40
 v_rcp_f32 v44, v44
 s_lshl_b32 s40, s41, 5
 s_add_u32 s40, s40, s32
 s_lshl_b32 s40, s40, 13
 s_add_u32 s40, s40, 0x6000000
 s_add_u32 s44, s40, 4096
 v_pk_mul_f32 v[112:113], v[112:113], v[32:33] op_sel_hi:[1,0]
 v_pk_mul_f32 v[114:115], v[114:115], v[32:33] op_sel_hi:[1,0]
 v_pk_mul_f32 v[116:117], v[116:117], v[32:33] op_sel_hi:[1,0]
 v_pk_mul_f32 v[118:119], v[118:119], v[32:33] op_sel_hi:[1,0]
 v_cvt_pk_bf16_f32 v240, v112, v113
 v_cvt_pk_bf16_f32 v241, v116, v117
 v_cvt_pk_bf16_f32 v242, v114, v115
 v_cvt_pk_bf16_f32 v243, v118, v119
 buffer_store_dwordx4 v[240:243], v1, s[20:23], s40 offen offset:0 sc1
 v_pk_mul_f32 v[120:121], v[120:121], v[32:33] op_sel_hi:[1,0]
 v_pk_mul_f32 v[122:123], v[122:123], v[32:33] op_sel_hi:[1,0]
 v_pk_mul_f32 v[124:125], v[124:125], v[32:33] op_sel_hi:[1,0]
 v_pk_mul_f32 v[126:127], v[126:127], v[32:33] op_sel_hi:[1,0]
 v_cvt_pk_bf16_f32 v244, v120, v121
 v_cvt_pk_bf16_f32 v245, v124, v125
 v_cvt_pk_bf16_f32 v246, v122, v123
 v_cvt_pk_bf16_f32 v247, v126, v127
 buffer_store_dwordx4 v[244:247], v1, s[20:23], s40 offen offset:2048 sc1
 v_pk_mul_f32 v[128:129], v[128:129], v[32:33] op_sel_hi:[1,0]
 v_pk_mul_f32 v[130:131], v[130:131], v[32:33] op_sel_hi:[1,0]
 v_pk_mul_f32 v[132:133], v[132:133], v[32:33] op_sel_hi:[1,0]
 v_pk_mul_f32 v[134:135], v[134:135], v[32:33] op_sel_hi:[1,0]
 v_cvt_pk_bf16_f32 v248, v128, v129
 v_cvt_pk_bf16_f32 v249, v132, v133
 v_cvt_pk_bf16_f32 v250, v130, v131
 v_cvt_pk_bf16_f32 v251, v134, v135
 buffer_store_dwordx4 v[248:251], v1, s[20:23], s44 offen offset:0 sc1
 v_pk_mul_f32 v[136:137], v[136:137], v[32:33] op_sel_hi:[1,0]
 v_pk_mul_f32 v[138:139], v[138:139], v[32:33] op_sel_hi:[1,0]
 v_pk_mul_f32 v[140:141], v[140:141], v[32:33] op_sel_hi:[1,0]
 v_pk_mul_f32 v[142:143], v[142:143], v[32:33] op_sel_hi:[1,0]
 v_cvt_pk_bf16_f32 v252, v136, v137
 v_cvt_pk_bf16_f32 v253, v140, v141
 v_cvt_pk_bf16_f32 v254, v138, v139
 v_cvt_pk_bf16_f32 v255, v142, v143
 buffer_store_dwordx4 v[252:255], v1, s[20:23], s44 offen offset:2048 sc1
 v_pk_mul_f32 v[144:145], v[144:145], v[36:37] op_sel_hi:[1,0]
 v_pk_mul_f32 v[146:147], v[146:147], v[36:37] op_sel_hi:[1,0]
 v_pk_mul_f32 v[148:149], v[148:149], v[36:37] op_sel_hi:[1,0]
 v_pk_mul_f32 v[150:151], v[150:151], v[36:37] op_sel_hi:[1,0]
 v_cvt_pk_bf16_f32 v240, v144, v145
 v_cvt_pk_bf16_f32 v241, v148, v149
 v_cvt_pk_bf16_f32 v242, v146, v147
 v_cvt_pk_bf16_f32 v243, v150, v151
 buffer_store_dwordx4 v[240:243], v1, s[20:23], s40 offen offset:1024 sc1
 v_pk_mul_f32 v[152:153], v[152:153], v[36:37] op_sel_hi:[1,0]
 v_pk_mul_f32 v[154:155], v[154:155], v[36:37] op_sel_hi:[1,0]
 v_pk_mul_f32 v[156:157], v[156:157], v[36:37] op_sel_hi:[1,0]
 v_pk_mul_f32 v[158:159], v[158:159], v[36:37] op_sel_hi:[1,0]
 v_cvt_pk_bf16_f32 v244, v152, v153
 v_cvt_pk_bf16_f32 v245, v156, v157
 v_cvt_pk_bf16_f32 v246, v154, v155
 v_cvt_pk_bf16_f32 v247, v158, v159
 buffer_store_dwordx4 v[244:247], v1, s[20:23], s40 offen offset:3072 sc1
 v_pk_mul_f32 v[160:161], v[160:161], v[36:37] op_sel_hi:[1,0]
 v_pk_mul_f32 v[162:163], v[162:163], v[36:37] op_sel_hi:[1,0]
 v_pk_mul_f32 v[164:165], v[164:165], v[36:37] op_sel_hi:[1,0]
 v_pk_mul_f32 v[166:167], v[166:167], v[36:37] op_sel_hi:[1,0]
 v_cvt_pk_bf16_f32 v248, v160, v161
 v_cvt_pk_bf16_f32 v249, v164, v165
 v_cvt_pk_bf16_f32 v250, v162, v163
 v_cvt_pk_bf16_f32 v251, v166, v167
 buffer_store_dwordx4 v[248:251], v1, s[20:23], s44 offen offset:1024 sc1
 v_pk_mul_f32 v[168:169], v[168:169], v[36:37] op_sel_hi:[1,0]
 v_pk_mul_f32 v[170:171], v[170:171], v[36:37] op_sel_hi:[1,0]
 v_pk_mul_f32 v[172:173], v[172:173], v[36:37] op_sel_hi:[1,0]
 v_pk_mul_f32 v[174:175], v[174:175], v[36:37] op_sel_hi:[1,0]
 v_cvt_pk_bf16_f32 v252, v168, v169
 v_cvt_pk_bf16_f32 v253, v172, v173
 v_cvt_pk_bf16_f32 v254, v170, v171
 v_cvt_pk_bf16_f32 v255, v174, v175
 buffer_store_dwordx4 v[252:255], v1, s[20:23], s44 offen offset:3072 sc1
 s_lshl_b32 s40, s42, 5
 s_add_u32 s40, s40, s32
 s_lshl_b32 s40, s40, 13
 s_add_u32 s40, s40, 0x6000000
 s_add_u32 s44, s40, 4096
 v_pk_mul_f32 v[176:177], v[176:177], v[40:41] op_sel_hi:[1,0]
 v_pk_mul_f32 v[178:179], v[178:179], v[40:41] op_sel_hi:[1,0]
 v_pk_mul_f32 v[180:181], v[180:181], v[40:41] op_sel_hi:[1,0]
 v_pk_mul_f32 v[182:183], v[182:183], v[40:41] op_sel_hi:[1,0]
 v_cvt_pk_bf16_f32 v240, v176, v177
 v_cvt_pk_bf16_f32 v241, v180, v181
 v_cvt_pk_bf16_f32 v242, v178, v179
 v_cvt_pk_bf16_f32 v243, v182, v183
 buffer_store_dwordx4 v[240:243], v1, s[20:23], s40 offen offset:0 sc1
 v_pk_mul_f32 v[184:185], v[184:185], v[40:41] op_sel_hi:[1,0]
 v_pk_mul_f32 v[186:187], v[186:187], v[40:41] op_sel_hi:[1,0]
 v_pk_mul_f32 v[188:189], v[188:189], v[40:41] op_sel_hi:[1,0]
 v_pk_mul_f32 v[190:191], v[190:191], v[40:41] op_sel_hi:[1,0]
 v_cvt_pk_bf16_f32 v244, v184, v185
 v_cvt_pk_bf16_f32 v245, v188, v189
 v_cvt_pk_bf16_f32 v246, v186, v187
 v_cvt_pk_bf16_f32 v247, v190, v191
 buffer_store_dwordx4 v[244:247], v1, s[20:23], s40 offen offset:2048 sc1
 v_pk_mul_f32 v[192:193], v[192:193], v[40:41] op_sel_hi:[1,0]
 v_pk_mul_f32 v[194:195], v[194:195], v[40:41] op_sel_hi:[1,0]
 v_pk_mul_f32 v[196:197], v[196:197], v[40:41] op_sel_hi:[1,0]
 v_pk_mul_f32 v[198:199], v[198:199], v[40:41] op_sel_hi:[1,0]
 v_cvt_pk_bf16_f32 v248, v192, v193
 v_cvt_pk_bf16_f32 v249, v196, v197
 v_cvt_pk_bf16_f32 v250, v194, v195
 v_cvt_pk_bf16_f32 v251, v198, v199
 buffer_store_dwordx4 v[248:251], v1, s[20:23], s44 offen offset:0 sc1
 v_pk_mul_f32 v[200:201], v[200:201], v[40:41] op_sel_hi:[1,0]
 v_pk_mul_f32 v[202:203], v[202:203], v[40:41] op_sel_hi:[1,0]
 v_pk_mul_f32 v[204:205], v[204:205], v[40:41] op_sel_hi:[1,0]
 v_pk_mul_f32 v[206:207], v[206:207], v[40:41] op_sel_hi:[1,0]
 v_cvt_pk_bf16_f32 v252, v200, v201
 v_cvt_pk_bf16_f32 v253, v204, v205
 v_cvt_pk_bf16_f32 v254, v202, v203
 v_cvt_pk_bf16_f32 v255, v206, v207
 buffer_store_dwordx4 v[252:255], v1, s[20:23], s44 offen offset:2048 sc1
 v_pk_mul_f32 v[208:209], v[208:209], v[44:45] op_sel_hi:[1,0]
 v_pk_mul_f32 v[210:211], v[210:211], v[44:45] op_sel_hi:[1,0]
 v_pk_mul_f32 v[212:213], v[212:213], v[44:45] op_sel_hi:[1,0]
 v_pk_mul_f32 v[214:215], v[214:215], v[44:45] op_sel_hi:[1,0]
 v_cvt_pk_bf16_f32 v240, v208, v209
 v_cvt_pk_bf16_f32 v241, v212, v213
 v_cvt_pk_bf16_f32 v242, v210, v211
 v_cvt_pk_bf16_f32 v243, v214, v215
 buffer_store_dwordx4 v[240:243], v1, s[20:23], s40 offen offset:1024 sc1
 v_pk_mul_f32 v[216:217], v[216:217], v[44:45] op_sel_hi:[1,0]
 v_pk_mul_f32 v[218:219], v[218:219], v[44:45] op_sel_hi:[1,0]
 v_pk_mul_f32 v[220:221], v[220:221], v[44:45] op_sel_hi:[1,0]
 v_pk_mul_f32 v[222:223], v[222:223], v[44:45] op_sel_hi:[1,0]
 v_cvt_pk_bf16_f32 v244, v216, v217
 v_cvt_pk_bf16_f32 v245, v220, v221
 v_cvt_pk_bf16_f32 v246, v218, v219
 v_cvt_pk_bf16_f32 v247, v222, v223
 buffer_store_dwordx4 v[244:247], v1, s[20:23], s40 offen offset:3072 sc1
 v_pk_mul_f32 v[224:225], v[224:225], v[44:45] op_sel_hi:[1,0]
 v_pk_mul_f32 v[226:227], v[226:227], v[44:45] op_sel_hi:[1,0]
 v_pk_mul_f32 v[228:229], v[228:229], v[44:45] op_sel_hi:[1,0]
 v_pk_mul_f32 v[230:231], v[230:231], v[44:45] op_sel_hi:[1,0]
 v_cvt_pk_bf16_f32 v248, v224, v225
 v_cvt_pk_bf16_f32 v249, v228, v229
 v_cvt_pk_bf16_f32 v250, v226, v227
 v_cvt_pk_bf16_f32 v251, v230, v231
 buffer_store_dwordx4 v[248:251], v1, s[20:23], s44 offen offset:1024 sc1
 v_pk_mul_f32 v[232:233], v[232:233], v[44:45] op_sel_hi:[1,0]
 v_pk_mul_f32 v[234:235], v[234:235], v[44:45] op_sel_hi:[1,0]
 v_pk_mul_f32 v[236:237], v[236:237], v[44:45] op_sel_hi:[1,0]
 v_pk_mul_f32 v[238:239], v[238:239], v[44:45] op_sel_hi:[1,0]
 v_cvt_pk_bf16_f32 v252, v232, v233
 v_cvt_pk_bf16_f32 v253, v236, v237
 v_cvt_pk_bf16_f32 v254, v234, v235
 v_cvt_pk_bf16_f32 v255, v238, v239
 buffer_store_dwordx4 v[252:255], v1, s[20:23], s44 offen offset:3072 sc1
 s_lshl_b32 s72, s33, 5
 s_add_u32 s72, s72, s32
 s_lshl_b32 s72, s72, 2
 s_add_u32 s72, s72, 0x4000
 s_cmp_eq_u32 s46, 1
 s_cbranch_scc1 Ladone_12
 s_mov_b32 s46, 1
 s_mov_b32 s33, s34
 s_waitcnt vmcnt(16)
 v_accvgpr_mov_b32 a0, a64
 v_accvgpr_mov_b32 a1, a65
 v_accvgpr_mov_b32 a2, a66
 v_accvgpr_mov_b32 a3, a67
 v_accvgpr_mov_b32 a4, a68
 v_accvgpr_mov_b32 a5, a69
 v_accvgpr_mov_b32 a6, a70
 v_accvgpr_mov_b32 a7, a71
 v_accvgpr_mov_b32 a8, a72
 v_accvgpr_mov_b32 a9, a73
 v_accvgpr_mov_b32 a10, a74
 v_accvgpr_mov_b32 a11, a75
 v_accvgpr_mov_b32 a12, a76
 v_accvgpr_mov_b32 a13, a77
 v_accvgpr_mov_b32 a14, a78
 v_accvgpr_mov_b32 a15, a79
 v_accvgpr_mov_b32 a16, a80
 v_accvgpr_mov_b32 a17, a81
 v_accvgpr_mov_b32 a18, a82
 v_accvgpr_mov_b32 a19, a83
 v_accvgpr_mov_b32 a20, a84
 v_accvgpr_mov_b32 a21, a85
 v_accvgpr_mov_b32 a22, a86
 v_accvgpr_mov_b32 a23, a87
 v_accvgpr_mov_b32 a24, a88
 v_accvgpr_mov_b32 a25, a89
 v_accvgpr_mov_b32 a26, a90
 v_accvgpr_mov_b32 a27, a91
 v_accvgpr_mov_b32 a28, a92
 v_accvgpr_mov_b32 a29, a93
 v_accvgpr_mov_b32 a30, a94
 v_accvgpr_mov_b32 a31, a95
 v_accvgpr_mov_b32 a32, a96
 v_accvgpr_mov_b32 a33, a97
 v_accvgpr_mov_b32 a34, a98
 v_accvgpr_mov_b32 a35, a99
 v_accvgpr_mov_b32 a36, a100
 v_accvgpr_mov_b32 a37, a101
 v_accvgpr_mov_b32 a38, a102
 v_accvgpr_mov_b32 a39, a103
 v_accvgpr_mov_b32 a40, a104
 v_accvgpr_mov_b32 a41, a105
 v_accvgpr_mov_b32 a42, a106
 v_accvgpr_mov_b32 a43, a107
 v_accvgpr_mov_b32 a44, a108
 v_accvgpr_mov_b32 a45, a109
 v_accvgpr_mov_b32 a46, a110
 v_accvgpr_mov_b32 a47, a111
 v_accvgpr_mov_b32 a48, a112
 v_accvgpr_mov_b32 a49, a113
 v_accvgpr_mov_b32 a50, a114
 v_accvgpr_mov_b32 a51, a115
 v_accvgpr_mov_b32 a52, a116
 v_accvgpr_mov_b32 a53, a117
 v_accvgpr_mov_b32 a54, a118
 v_accvgpr_mov_b32 a55, a119
 v_accvgpr_mov_b32 a56, a120
 v_accvgpr_mov_b32 a57, a121
 v_accvgpr_mov_b32 a58, a122
 v_accvgpr_mov_b32 a59, a123
 v_accvgpr_mov_b32 a60, a124
 v_accvgpr_mov_b32 a61, a125
 v_accvgpr_mov_b32 a62, a126
 v_accvgpr_mov_b32 a63, a127
 s_branch Lablk_9
Laslow_10:
 s_waitcnt vmcnt(0) lgkmcnt(0)
 v_mov_b32 v12, 0
 v_mov_b32 v240, v4
 v_mov_b32 v13, 0
 v_mov_b32 v241, v4
 v_mov_b32 v14, 0
 v_mov_b32 v242, v4
 v_mov_b32 v15, 0
 v_mov_b32 v243, v4
 s_mov_b32 s49, 0
Lsl_21:
 s_lshl_b32 s37, s49, 19
 s_add_u32 s37, s37, s45
 s_sub_u32 s37, s37, s50
 s_add_u32 s44, s37, 0
 buffer_load_dwordx4 a[128:131], v1, s[20:23], s44 offen offset:0 sc1
 buffer_load_dwordx4 a[132:135], v1, s[20:23], s44 offen offset:1024 sc1
 buffer_load_dwordx4 a[136:139], v1, s[20:23], s44 offen offset:2048 sc1
 buffer_load_dwordx4 a[140:143], v1, s[20:23], s44 offen offset:3072 sc1
 s_add_u32 s44, s37, 4096
 buffer_load_dwordx4 a[144:147], v1, s[20:23], s44 offen offset:0 sc1
 buffer_load_dwordx4 a[148:151], v1, s[20:23], s44 offen offset:1024 sc1
 buffer_load_dwordx4 a[152:155], v1, s[20:23], s44 offen offset:2048 sc1
 buffer_load_dwordx4 a[156:159], v1, s[20:23], s44 offen offset:3072 sc1
 s_cmp_lt_u32 s49, s41
 s_cselect_b64 s[68:69], -1, 0
 s_cmp_le_u32 s49, s41
 s_cselect_b64 s[70:71], -1, 0
 s_cmp_eq_u32 s49, s41
 s_cselect_b64 s[60:61], s[52:53], s[68:69]
 s_cselect_b64 s[62:63], s[54:55], s[68:69]
 s_cselect_b64 s[64:65], s[56:57], s[68:69]
 s_cselect_b64 s[66:67], s[58:59], s[68:69]
 v_cndmask_b32 v80, v4, v12, s[60:61]
 v_cndmask_b32 v81, v4, v12, s[62:63]
 v_cndmask_b32 v82, v4, v12, s[64:65]
 v_cndmask_b32 v83, v4, v12, s[66:67]
 v_cndmask_b32 v84, v4, v12, s[68:69]
 v_cndmask_b32 v85, v4, v12, s[68:69]
 v_cndmask_b32 v86, v4, v12, s[68:69]
 v_cndmask_b32 v87, v4, v12, s[68:69]
 v_cndmask_b32 v88, v4, v13, s[70:71]
 v_cndmask_b32 v89, v4, v13, s[70:71]
 v_cndmask_b32 v90, v4, v13, s[70:71]
 v_cndmask_b32 v91, v4, v13, s[70:71]
 v_cndmask_b32 v92, v4, v13, s[60:61]
 v_cndmask_b32 v93, v4, v13, s[62:63]
 v_cndmask_b32 v94, v4, v13, s[64:65]
 v_cndmask_b32 v95, v4, v13, s[66:67]
 s_cmp_lt_u32 s49, s42
 s_cselect_b64 s[68:69], -1, 0
 s_cmp_le_u32 s49, s42
 s_cselect_b64 s[70:71], -1, 0
 s_cmp_eq_u32 s49, s42
 s_cselect_b64 s[60:61], s[52:53], s[68:69]
 s_cselect_b64 s[62:63], s[54:55], s[68:69]
 s_cselect_b64 s[64:65], s[56:57], s[68:69]
 s_cselect_b64 s[66:67], s[58:59], s[68:69]
 v_cndmask_b32 v96, v4, v14, s[60:61]
 v_cndmask_b32 v97, v4, v14, s[62:63]
 v_cndmask_b32 v98, v4, v14, s[64:65]
 v_cndmask_b32 v99, v4, v14, s[66:67]
 v_cndmask_b32 v100, v4, v14, s[68:69]
 v_cndmask_b32 v101, v4, v14, s[68:69]
 v_cndmask_b32 v102, v4, v14, s[68:69]
 v_cndmask_b32 v103, v4, v14, s[68:69]
 v_cndmask_b32 v104, v4, v15, s[70:71]
 v_cndmask_b32 v105, v4, v15, s[70:71]
 v_cndmask_b32 v106, v4, v15, s[70:71]
 v_cndmask_b32 v107, v4, v15, s[70:71]
 v_cndmask_b32 v108, v4, v15, s[60:61]
 v_cndmask_b32 v109, v4, v15, s[62:63]
 v_cndmask_b32 v110, v4, v15, s[64:65]
 v_cndmask_b32 v111, v4, v15, s[66:67]
 s_waitcnt vmcnt(0)
 s_nop 0
 v_mfma_f32_16x16x32_bf16 v[48:51], a[128:131], a[0:3], v[80:83]
 v_mfma_f32_16x16x32_bf16 v[56:59], a[128:131], a[16:19], v[88:91]
 v_mfma_f32_16x16x32_bf16 v[64:67], a[128:131], a[32:35], v[96:99]
 v_mfma_f32_16x16x32_bf16 v[72:75], a[128:131], a[48:51], v[104:107]
 v_mfma_f32_16x16x32_bf16 v[52:55], a[132:135], a[0:3], v[84:87]
 v_mfma_f32_16x16x32_bf16 v[60:63], a[132:135], a[16:19], v[92:95]
 v_mfma_f32_16x16x32_bf16 v[68:71], a[132:135], a[32:35], v[100:103]
 v_mfma_f32_16x16x32_bf16 v[76:79], a[132:135], a[48:51], v[108:111]
 v_mfma_f32_16x16x32_bf16 v[48:51], a[136:139], a[4:7], v[48:51]
 v_mfma_f32_16x16x32_bf16 v[56:59], a[136:139], a[20:23], v[56:59]
 v_mfma_f32_16x16x32_bf16 v[64:67], a[136:139], a[36:39], v[64:67]
 v_mfma_f32_16x16x32_bf16 v[72:75], a[136:139], a[52:55], v[72:75]
 v_mfma_f32_16x16x32_bf16 v[52:55], a[140:143], a[4:7], v[52:55]
 v_mfma_f32_16x16x32_bf16 v[60:63], a[140:143], a[20:23], v[60:63]
 v_mfma_f32_16x16x32_bf16 v[68:71], a[140:143], a[36:39], v[68:71]
 v_mfma_f32_16x16x32_bf16 v[76:79], a[140:143], a[52:55], v[76:79]
 v_mfma_f32_16x16x32_bf16 v[48:51], a[144:147], a[8:11], v[48:51]
 v_mfma_f32_16x16x32_bf16 v[56:59], a[144:147], a[24:27], v[56:59]
 v_mfma_f32_16x16x32_bf16 v[64:67], a[144:147], a[40:43], v[64:67]
 v_mfma_f32_16x16x32_bf16 v[72:75], a[144:147], a[56:59], v[72:75]
 v_mfma_f32_16x16x32_bf16 v[52:55], a[148:151], a[8:11], v[52:55]
 v_mfma_f32_16x16x32_bf16 v[60:63], a[148:151], a[24:27], v[60:63]
 v_mfma_f32_16x16x32_bf16 v[68:71], a[148:151], a[40:43], v[68:71]
 v_mfma_f32_16x16x32_bf16 v[76:79], a[148:151], a[56:59], v[76:79]
 v_mfma_f32_16x16x32_bf16 v[48:51], a[152:155], a[12:15], v[48:51]
 v_mfma_f32_16x16x32_bf16 v[56:59], a[152:155], a[28:31], v[56:59]
 v_mfma_f32_16x16x32_bf16 v[64:67], a[152:155], a[44:47], v[64:67]
 v_mfma_f32_16x16x32_bf16 v[72:75], a[152:155], a[60:63], v[72:75]
 v_mfma_f32_16x16x32_bf16 v[52:55], a[156:159], a[12:15], v[52:55]
 v_mfma_f32_16x16x32_bf16 v[60:63], a[156:159], a[28:31], v[60:63]
 v_mfma_f32_16x16x32_bf16 v[68:71], a[156:159], a[44:47], v[68:71]
 v_mfma_f32_16x16x32_bf16 v[76:79], a[156:159], a[60:63], v[76:79]
 s_nop 7
 v_max3_f32 v240, v240, v48, v49
 v_max3_f32 v240, v240, v50, v51
 v_max3_f32 v240, v240, v52, v53
 v_max3_f32 v240, v240, v54, v55
 v_max3_f32 v241, v241, v56, v57
 v_max3_f32 v241, v241, v58, v59
 v_max3_f32 v241, v241, v60, v61
 v_max3_f32 v241, v241, v62, v63
 v_max3_f32 v242, v242, v64, v65
 v_max3_f32 v242, v242, v66, v67
 v_max3_f32 v242, v242, v68, v69
 v_max3_f32 v242, v242, v70, v71
 v_max3_f32 v243, v243, v72, v73
 v_max3_f32 v243, v243, v74, v75
 v_max3_f32 v243, v243, v76, v77
 v_max3_f32 v243, v243, v78, v79
 s_add_u32 s49, s49, 1
 s_cmp_le_u32 s49, s42
 s_cbranch_scc1 Lsl_21
 v_mov_b32 v244, v240
 v_mov_b32 v245, v241
 v_mov_b32 v246, v242
 v_mov_b32 v247, v243
 v_permlane16_swap_b32 v240, v244
 v_permlane16_swap_b32 v241, v245
 v_permlane16_swap_b32 v242, v246
 v_permlane16_swap_b32 v243, v247
 v_max_f32 v240, v240, v244
 v_max_f32 v241, v241, v245
 v_max_f32 v242, v242, v246
 v_max_f32 v243, v243, v247
 v_mov_b32 v244, v240
 v_mov_b32 v245, v241
 v_mov_b32 v246, v242
 v_mov_b32 v247, v243
 v_permlane32_swap_b32 v240, v244
 v_permlane32_swap_b32 v241, v245
 v_permlane32_swap_b32 v242, v246
 v_permlane32_swap_b32 v243, v247
 v_max_f32 v240, v240, v244
 v_max_f32 v241, v241, v245
 v_max_f32 v242, v242, v246
 v_max_f32 v243, v243, v247
 v_sub_f32 v12, 0, v240
 v_sub_f32 v13, 0, v241
 v_sub_f32 v14, 0, v242
 v_sub_f32 v15, 0, v243
 v_mov_b64 v[112:113], 0
 v_mov_b64 v[114:115], 0
 v_mov_b64 v[116:117], 0
 v_mov_b64 v[118:119], 0
 v_mov_b64 v[120:121], 0
 v_mov_b64 v[122:123], 0
 v_mov_b64 v[124:125], 0
 v_mov_b64 v[126:127], 0
 v_mov_b64 v[128:129], 0
 v_mov_b64 v[130:131], 0
 v_mov_b64 v[132:133], 0
 v_mov_b64 v[134:135], 0
 v_mov_b64 v[136:137], 0
 v_mov_b64 v[138:139], 0
 v_mov_b64 v[140:141], 0
 v_mov_b64 v[142:143], 0
 v_mov_b64 v[144:145], 0
 v_mov_b64 v[146:147], 0
 v_mov_b64 v[148:149], 0
 v_mov_b64 v[150:151], 0
 v_mov_b64 v[152:153], 0
 v_mov_b64 v[154:155], 0
 v_mov_b64 v[156:157], 0
 v_mov_b64 v[158:159], 0
 v_mov_b64 v[160:161], 0
 v_mov_b64 v[162:163], 0
 v_mov_b64 v[164:165], 0
 v_mov_b64 v[166:167], 0
 v_mov_b64 v[168:169], 0
 v_mov_b64 v[170:171], 0
 v_mov_b64 v[172:173], 0
 v_mov_b64 v[174:175], 0
 v_mov_b64 v[176:177], 0
 v_mov_b64 v[178:179], 0
 v_mov_b64 v[180:181], 0
 v_mov_b64 v[182:183], 0
 v_mov_b64 v[184:185], 0
 v_mov_b64 v[186:187], 0
 v_mov_b64 v[188:189], 0
 v_mov_b64 v[190:191], 0
 v_mov_b64 v[192:193], 0
 v_mov_b64 v[194:195], 0
 v_mov_b64 v[196:197], 0
 v_mov_b64 v[198:199], 0
 v_mov_b64 v[200:201], 0
 v_mov_b64 v[202:203], 0
 v_mov_b64 v[204:205], 0
 v_mov_b64 v[206:207], 0
 v_mov_b64 v[208:209], 0
 v_mov_b64 v[210:211], 0
 v_mov_b64 v[212:213], 0
 v_mov_b64 v[214:215], 0
 v_mov_b64 v[216:217], 0
 v_mov_b64 v[218:219], 0
 v_mov_b64 v[220:221], 0
 v_mov_b64 v[222:223], 0
 v_mov_b64 v[224:225], 0
 v_mov_b64 v[226:227], 0
 v_mov_b64 v[228:229], 0
 v_mov_b64 v[230:231], 0
 v_mov_b64 v[232:233], 0
 v_mov_b64 v[234:235], 0
 v_mov_b64 v[236:237], 0
 v_mov_b64 v[238:239], 0
 v_mov_b64 v[32:33], 0
 v_mov_b64 v[34:35], 0
 v_mov_b64 v[36:37], 0
 v_mov_b64 v[38:39], 0
 v_mov_b64 v[40:41], 0
 v_mov_b64 v[42:43], 0
 v_mov_b64 v[44:45], 0
 v_mov_b64 v[46:47], 0
 s_mov_b32 s49, 0
Lsl_22:
 s_lshl_b32 s37, s49, 19
 s_add_u32 s37, s37, s45
 s_sub_u32 s37, s37, s50
 s_add_u32 s44, s37, 0
 buffer_load_dwordx4 a[128:131], v1, s[20:23], s44 offen offset:0 sc1
 buffer_load_dwordx4 a[132:135], v1, s[20:23], s44 offen offset:1024 sc1
 buffer_load_dwordx4 a[136:139], v1, s[20:23], s44 offen offset:2048 sc1
 buffer_load_dwordx4 a[140:143], v1, s[20:23], s44 offen offset:3072 sc1
 s_add_u32 s44, s37, 4096
 buffer_load_dwordx4 a[144:147], v1, s[20:23], s44 offen offset:0 sc1
 buffer_load_dwordx4 a[148:151], v1, s[20:23], s44 offen offset:1024 sc1
 buffer_load_dwordx4 a[152:155], v1, s[20:23], s44 offen offset:2048 sc1
 buffer_load_dwordx4 a[156:159], v1, s[20:23], s44 offen offset:3072 sc1
 s_add_u32 s44, s37, 8192
 buffer_load_dwordx4 a[160:163], v1, s[20:23], s44 offen offset:0 sc1
 buffer_load_dwordx4 a[164:167], v1, s[20:23], s44 offen offset:1024 sc1
 buffer_load_dwordx4 a[168:171], v1, s[20:23], s44 offen offset:2048 sc1
 buffer_load_dwordx4 a[172:175], v1, s[20:23], s44 offen offset:3072 sc1
 s_add_u32 s44, s37, 12288
 buffer_load_dwordx4 a[176:179], v1, s[20:23], s44 offen offset:0 sc1
 buffer_load_dwordx4 a[180:183], v1, s[20:23], s44 offen offset:1024 sc1
 buffer_load_dwordx4 a[184:187], v1, s[20:23], s44 offen offset:2048 sc1
 buffer_load_dwordx4 a[188:191], v1, s[20:23], s44 offen offset:3072 sc1
 s_cmp_lt_u32 s49, s41
 s_cselect_b64 s[68:69], -1, 0
 s_cmp_le_u32 s49, s41
 s_cselect_b64 s[70:71], -1, 0
 s_cmp_eq_u32 s49, s41
 s_cselect_b64 s[60:61], s[52:53], s[68:69]
 s_cselect_b64 s[62:63], s[54:55], s[68:69]
 s_cselect_b64 s[64:65], s[56:57], s[68:69]
 s_cselect_b64 s[66:67], s[58:59], s[68:69]
 v_cndmask_b32 v80, v4, v12, s[60:61]
 v_cndmask_b32 v81, v4, v12, s[62:63]
 v_cndmask_b32 v82, v4, v12, s[64:65]
 v_cndmask_b32 v83, v4, v12, s[66:67]
 v_cndmask_b32 v84, v4, v12, s[68:69]
 v_cndmask_b32 v85, v4, v12, s[68:69]
 v_cndmask_b32 v86, v4, v12, s[68:69]
 v_cndmask_b32 v87, v4, v12, s[68:69]
 v_cndmask_b32 v88, v4, v13, s[70:71]
 v_cndmask_b32 v89, v4, v13, s[70:71]
 v_cndmask_b32 v90, v4, v13, s[70:71]
 v_cndmask_b32 v91, v4, v13, s[70:71]
 v_cndmask_b32 v92, v4, v13, s[60:61]
 v_cndmask_b32 v93, v4, v13, s[62:63]
 v_cndmask_b32 v94, v4, v13, s[64:65]
 v_cndmask_b32 v95, v4, v13, s[66:67]
 s_cmp_lt_u32 s49, s42
 s_cselect_b64 s[68:69], -1, 0
 s_cmp_le_u32 s49, s42
 s_cselect_b64 s[70:71], -1, 0
 s_cmp_eq_u32 s49, s42
 s_cselect_b64 s[60:61], s[52:53], s[68:69]
 s_cselect_b64 s[62:63], s[54:55], s[68:69]
 s_cselect_b64 s[64:65], s[56:57], s[68:69]
 s_cselect_b64 s[66:67], s[58:59], s[68:69]
 v_cndmask_b32 v96, v4, v14, s[60:61]
 v_cndmask_b32 v97, v4, v14, s[62:63]
 v_cndmask_b32 v98, v4, v14, s[64:65]
 v_cndmask_b32 v99, v4, v14, s[66:67]
 v_cndmask_b32 v100, v4, v14, s[68:69]
 v_cndmask_b32 v101, v4, v14, s[68:69]
 v_cndmask_b32 v102, v4, v14, s[68:69]
 v_cndmask_b32 v103, v4, v14, s[68:69]
 v_cndmask_b32 v104, v4, v15, s[70:71]
 v_cndmask_b32 v105, v4, v15, s[70:71]
 v_cndmask_b32 v106, v4, v15, s[70:71]
 v_cndmask_b32 v107, v4, v15, s[70:71]
 v_cndmask_b32 v108, v4, v15, s[60:61]
 v_cndmask_b32 v109, v4, v15, s[62:63]
 v_cndmask_b32 v110, v4, v15, s[64:65]
 v_cndmask_b32 v111, v4, v15, s[66:67]
 s_waitcnt vmcnt(0)
 s_nop 0
 v_mfma_f32_16x16x32_bf16 v[48:51], a[128:131], a[0:3], v[80:83]
 v_mfma_f32_16x16x32_bf16 v[56:59], a[128:131], a[16:19], v[88:91]
 v_mfma_f32_16x16x32_bf16 v[64:67], a[128:131], a[32:35], v[96:99]
 v_mfma_f32_16x16x32_bf16 v[72:75], a[128:131], a[48:51], v[104:107]
 v_mfma_f32_16x16x32_bf16 v[52:55], a[132:135], a[0:3], v[84:87]
 v_mfma_f32_16x16x32_bf16 v[60:63], a[132:135], a[16:19], v[92:95]
 v_mfma_f32_16x16x32_bf16 v[68:71], a[132:135], a[32:35], v[100:103]
 v_mfma_f32_16x16x32_bf16 v[76:79], a[132:135], a[48:51], v[108:111]
 v_mfma_f32_16x16x32_bf16 v[48:51], a[136:139], a[4:7], v[48:51]
 v_mfma_f32_16x16x32_bf16 v[56:59], a[136:139], a[20:23], v[56:59]
 v_mfma_f32_16x16x32_bf16 v[64:67], a[136:139], a[36:39], v[64:67]
 v_mfma_f32_16x16x32_bf16 v[72:75], a[136:139], a[52:55], v[72:75]
 v_mfma_f32_16x16x32_bf16 v[52:55], a[140:143], a[4:7], v[52:55]
 v_mfma_f32_16x16x32_bf16 v[60:63], a[140:143], a[20:23], v[60:63]
 v_mfma_f32_16x16x32_bf16 v[68:71], a[140:143], a[36:39], v[68:71]
 v_mfma_f32_16x16x32_bf16 v[76:79], a[140:143], a[52:55], v[76:79]
 v_mfma_f32_16x16x32_bf16 v[48:51], a[144:147], a[8:11], v[48:51]
 v_mfma_f32_16x16x32_bf16 v[56:59], a[144:147], a[24:27], v[56:59]
 v_mfma_f32_16x16x32_bf16 v[64:67], a[144:147], a[40:43], v[64:67]
 v_mfma_f32_16x16x32_bf16 v[72:75], a[144:147], a[56:59], v[72:75]
 v_mfma_f32_16x16x32_bf16 v[52:55], a[148:151], a[8:11], v[52:55]
 v_mfma_f32_16x16x32_bf16 v[60:63], a[148:151], a[24:27], v[60:63]
 v_mfma_f32_16x16x32_bf16 v[68:71], a[148:151], a[40:43], v[68:71]
 v_mfma_f32_16x16x32_bf16 v[76:79], a[148:151], a[56:59], v[76:79]
 v_mfma_f32_16x16x32_bf16 v[48:51], a[152:155], a[12:15], v[48:51]
 v_mfma_f32_16x16x32_bf16 v[56:59], a[152:155], a[28:31], v[56:59]
 v_mfma_f32_16x16x32_bf16 v[64:67], a[152:155], a[44:47], v[64:67]
 v_mfma_f32_16x16x32_bf16 v[72:75], a[152:155], a[60:63], v[72:75]
 v_mfma_f32_16x16x32_bf16 v[52:55], a[156:159], a[12:15], v[52:55]
 v_mfma_f32_16x16x32_bf16 v[60:63], a[156:159], a[28:31], v[60:63]
 v_mfma_f32_16x16x32_bf16 v[68:71], a[156:159], a[44:47], v[68:71]
 v_mfma_f32_16x16x32_bf16 v[76:79], a[156:159], a[60:63], v[76:79]
 s_nop 7
 v_exp_f32 v48, v48
 v_exp_f32 v49, v49
 v_exp_f32 v52, v52
 v_exp_f32 v53, v53
 v_exp_f32 v50, v50
 v_cvt_pk_bf16_f32 v16, v48, v49
 v_cvt_pk_bf16_f32 v17, v52, v53
 v_exp_f32 v51, v51
 v_exp_f32 v54, v54
 v_exp_f32 v55, v55
 v_cvt_pk_bf16_f32 v18, v50, v51
 v_cvt_pk_bf16_f32 v19, v54, v55
 v_exp_f32 v56, v56
 v_exp_f32 v57, v57
 v_exp_f32 v60, v60
 v_exp_f32 v61, v61
 v_exp_f32 v58, v58
 v_cvt_pk_bf16_f32 v20, v56, v57
 v_cvt_pk_bf16_f32 v21, v60, v61
 v_exp_f32 v59, v59
 v_exp_f32 v62, v62
 v_exp_f32 v63, v63
 v_cvt_pk_bf16_f32 v22, v58, v59
 v_cvt_pk_bf16_f32 v23, v62, v63
 v_exp_f32 v64, v64
 v_exp_f32 v65, v65
 v_exp_f32 v68, v68
 v_exp_f32 v69, v69
 v_exp_f32 v66, v66
 v_cvt_pk_bf16_f32 v24, v64, v65
 v_cvt_pk_bf16_f32 v25, v68, v69
 v_exp_f32 v67, v67
 v_exp_f32 v70, v70
 v_exp_f32 v71, v71
 v_cvt_pk_bf16_f32 v26, v66, v67
 v_cvt_pk_bf16_f32 v27, v70, v71
 v_exp_f32 v72, v72
 v_exp_f32 v73, v73
 v_exp_f32 v76, v76
 v_exp_f32 v77, v77
 v_exp_f32 v74, v74
 v_cvt_pk_bf16_f32 v28, v72, v73
 v_cvt_pk_bf16_f32 v29, v76, v77
 v_exp_f32 v75, v75
 v_exp_f32 v78, v78
 v_exp_f32 v79, v79
 v_cvt_pk_bf16_f32 v30, v74, v75
 v_cvt_pk_bf16_f32 v31, v78, v79
 s_nop 1
 v_mfma_f32_16x16x32_bf16 v[112:115], a[160:163], v[16:19], v[112:115]
 v_mfma_f32_16x16x32_bf16 v[144:147], a[160:163], v[20:23], v[144:147]
 v_mfma_f32_16x16x32_bf16 v[176:179], a[160:163], v[24:27], v[176:179]
 v_mfma_f32_16x16x32_bf16 v[208:211], a[160:163], v[28:31], v[208:211]
 v_mfma_f32_16x16x32_bf16 v[116:119], a[164:167], v[16:19], v[116:119]
 v_mfma_f32_16x16x32_bf16 v[148:151], a[164:167], v[20:23], v[148:151]
 v_mfma_f32_16x16x32_bf16 v[180:183], a[164:167], v[24:27], v[180:183]
 v_mfma_f32_16x16x32_bf16 v[212:215], a[164:167], v[28:31], v[212:215]
 v_mfma_f32_16x16x32_bf16 v[120:123], a[168:171], v[16:19], v[120:123]
 v_mfma_f32_16x16x32_bf16 v[152:155], a[168:171], v[20:23], v[152:155]
 v_mfma_f32_16x16x32_bf16 v[184:187], a[168:171], v[24:27], v[184:187]
 v_mfma_f32_16x16x32_bf16 v[216:219], a[168:171], v[28:31], v[216:219]
 v_mfma_f32_16x16x32_bf16 v[124:127], a[172:175], v[16:19], v[124:127]
 v_mfma_f32_16x16x32_bf16 v[156:159], a[172:175], v[20:23], v[156:159]
 v_mfma_f32_16x16x32_bf16 v[188:191], a[172:175], v[24:27], v[188:191]
 v_mfma_f32_16x16x32_bf16 v[220:223], a[172:175], v[28:31], v[220:223]
 v_mfma_f32_16x16x32_bf16 v[128:131], a[176:179], v[16:19], v[128:131]
 v_mfma_f32_16x16x32_bf16 v[160:163], a[176:179], v[20:23], v[160:163]
 v_mfma_f32_16x16x32_bf16 v[192:195], a[176:179], v[24:27], v[192:195]
 v_mfma_f32_16x16x32_bf16 v[224:227], a[176:179], v[28:31], v[224:227]
 v_mfma_f32_16x16x32_bf16 v[132:135], a[180:183], v[16:19], v[132:135]
 v_mfma_f32_16x16x32_bf16 v[164:167], a[180:183], v[20:23], v[164:167]
 v_mfma_f32_16x16x32_bf16 v[196:199], a[180:183], v[24:27], v[196:199]
 v_mfma_f32_16x16x32_bf16 v[228:231], a[180:183], v[28:31], v[228:231]
 v_mfma_f32_16x16x32_bf16 v[136:139], a[184:187], v[16:19], v[136:139]
 v_mfma_f32_16x16x32_bf16 v[168:171], a[184:187], v[20:23], v[168:171]
 v_mfma_f32_16x16x32_bf16 v[200:203], a[184:187], v[24:27], v[200:203]
 v_mfma_f32_16x16x32_bf16 v[232:235], a[184:187], v[28:31], v[232:235]
 v_mfma_f32_16x16x32_bf16 v[140:143], a[188:191], v[16:19], v[140:143]
 v_mfma_f32_16x16x32_bf16 v[172:175], a[188:191], v[20:23], v[172:175]
 v_mfma_f32_16x16x32_bf16 v[204:207], a[188:191], v[24:27], v[204:207]
 v_mfma_f32_16x16x32_bf16 v[236:239], a[188:191], v[28:31], v[236:239]
 v_mfma_f32_16x16x32_bf16 v[32:35], a[192:195], v[16:19], v[32:35]
 v_mfma_f32_16x16x32_bf16 v[36:39], a[192:195], v[20:23], v[36:39]
 v_mfma_f32_16x16x32_bf16 v[40:43], a[192:195], v[24:27], v[40:43]
 v_mfma_f32_16x16x32_bf16 v[44:47], a[192:195], v[28:31], v[44:47]
 s_add_u32 s49, s49, 1
 s_cmp_le_u32 s49, s42
 s_cbranch_scc1 Lsl_22
 ds_read_b128 a[128:131], v3 offset:0
 ds_read_b128 a[132:135], v3 offset:1024
 ds_read_b128 a[136:139], v3 offset:2048
 ds_read_b128 a[140:143], v3 offset:3072
 ds_read_b128 a[144:147], v3 offset:4096
 ds_read_b128 a[148:151], v3 offset:5120
 ds_read_b128 a[152:155], v3 offset:6144
 ds_read_b128 a[156:159], v3 offset:7168
 s_branch Laback_11
Ladone_12:
 s_waitcnt vmcnt(0) lgkmcnt(0)
 s_barrier
 v_mov_b32 v6, 1
 buffer_store_dword v6, v5, s[20:23], s72 offen sc1
 s_cmp_ge_u32 s6, 27
 s_cbranch_scc1 Lfin
 s_load_dwordx2 s[8:9], s[0:1], 40
 s_mov_b32 s10, 0x480000
 s_mov_b32 s11, 0x20000
 s_mul_i32 s7, s6, 29
 s_lshr_b32 s7, s7, 8
 s_mul_i32 s94, s7, 9
 s_sub_u32 s32, s6, s94
 s_mul_i32 s40, s7, 3
 s_lshl_b32 s7, s7, 2
 s_add_u32 s7, s7, s5
 s_sub_u32 s33, s7, 4
 s_mov_b32 s34, 12
 s_cmp_lt_u32 s33, 4
 s_cselect_b32 s35, 6, 5
 s_mov_b32 s36, 0x6000000
 s_mov_b32 s37, 0
 s_lshl_b32 s38, s4, 5
 s_add_u32 s38, s38, 0x4000
 s_mov_b32 s39, 0
 s_mov_b32 s93, 0x38
 s_mov_b32 s92, 7
 s_mov_b32 s91, 4
 s_mov_b32 s90, 31
 s_branch Los
Lpb:
 s_load_dwordx2 s[8:9], s[0:1], 48
 s_mov_b32 s10, 0x240000
 s_mov_b32 s11, 0x20000
 s_load_dwordx2 s[12:13], s[0:1], 72
 s_mov_b32 s14, 0x480000
 s_mov_b32 s15, 0x20000
 s_load_dwordx2 s[16:17], s[0:1], 80
 s_mov_b32 s18, 0x480000
 s_mov_b32 s19, 0x20000
 s_lshl_b32 s32, s6, 8
 s_mov_b32 s33, s32
 s_lshl_b32 s34, s6, 14
 s_add_u32 s34, s34, 0x3000000
 s_add_u32 s35, s34, 8192
 s_mov_b32 s36, 64
 s_mov_b32 s37, 0
 s_lshl_b32 s52, s6, 12
 s_add_u32 s52, s52, 0x400000
 s_lshl_b32 s7, s6, 7
 s_add_u32 s7, s7, 0x0
 v_min_u32 v1, 1, v0
 v_lshlrev_b32 v1, 28, v1
 v_add_u32 v13, s7, v1
 s_waitcnt lgkmcnt(0)
 v_and_b32 v1, 63, v0
 v_lshrrev_b32 v2, 3, v0
 v_mul_u32_u24 v10, 1152, v2
 v_lshrrev_b32 v2, 4, v0
 v_xor_b32 v2, v2, v0
 v_and_b32 v2, 7, v2
 v_lshl_add_u32 v10, v2, 4, v10
 v_lshrrev_b32 v2, 4, v1
 v_bfe_u32 v3, v1, 1, 3
 v_xor_b32 v2, v2, v3
 v_and_b32 v3, 15, v1
 v_lshlrev_b32 v3, 7, v3
 v_lshl_add_u32 v4, v2, 4, v3
 v_xor_b32 v5, 64, v4
 v_lshrrev_b32 v2, 4, v0
 v_lshlrev_b32 v11, 13, v2
 v_lshrrev_b32 v2, 7, v0
 v_lshrrev_b32 v3, 4, v1
 v_lshl_add_u32 v3, v2, 2, v3
 v_bfe_u32 v2, v1, 1, 3
 v_xor_b32 v2, v2, v3
 v_lshl_add_u32 v11, v2, 5, v11
 v_and_b32 v2, 1, v1
 v_lshl_add_u32 v11, v2, 4, v11
 v_bfe_u32 v2, v1, 2, 3
 v_xor_b32 v3, s4, v2
 v_lshlrev_b32 v3, 5, v3
 v_and_b32 v2, 3, v2
 v_lshl_add_u32 v3, v2, 8, v3
 v_lshrrev_b32 v2, 4, v1
 v_lshl_add_u32 v3, v2, 11, v3
 v_and_b32 v2, 3, v1
 v_lshl_add_u32 v3, v2, 3, v3
 v_add_u32 v8, 73728, v3
 v_xor_b32 v3, 0x80, v3
 v_add_u32 v9, 73728, v3
 s_lshl_b32 s45, s4, 11
 v_lshl_add_u32 v12, v1, 4, s45
 s_mov_b32 s39, s37
 s_add_u32 s40, s39, 1
 s_min_u32 s40, s40, 63
 s_lshl_b32 s49, s4, 10
 s_mul_i32 s46, s39, 36864
 s_add_u32 m0, s49, 0
 s_nop 0
 buffer_load_dwordx4 v10, s[8:11], s46 offen offset:0  lds
 s_add_u32 m0, s49, 3968
 s_nop 0
 buffer_load_dwordx4 v10, s[8:11], s46 offen offset:128  lds
 s_add_u32 m0, s49, 7936
 s_nop 0
 buffer_load_dwordx4 v10, s[8:11], s46 offen offset:256  lds
 s_add_u32 m0, s49, 11904
 s_nop 0
 buffer_load_dwordx4 v10, s[8:11], s46 offen offset:384  lds
 s_add_u32 m0, s49, 15872
 s_nop 0
 buffer_load_dwordx4 v10, s[8:11], s46 offen offset:512  lds
 s_add_u32 m0, s49, 19840
 s_nop 0
 buffer_load_dwordx4 v10, s[8:11], s46 offen offset:640  lds
 s_add_u32 m0, s49, 23808
 s_nop 0
 buffer_load_dwordx4 v10, s[8:11], s46 offen offset:768  lds
 s_add_u32 m0, s49, 27776
 s_nop 0
 buffer_load_dwordx4 v10, s[8:11], s46 offen offset:896  lds
 s_add_u32 m0, s49, 31744
 s_nop 0
 buffer_load_dwordx4 v10, s[8:11], s46 offen offset:1024  lds
 s_lshl_b32 s49, s4, 10
 s_add_u32 s49, s49, 36864
 s_mul_i32 s46, s40, 36864
 s_add_u32 m0, s49, 0
 s_nop 0
 buffer_load_dwordx4 v10, s[8:11], s46 offen offset:0  lds
 s_add_u32 m0, s49, 3968
 s_nop 0
 buffer_load_dwordx4 v10, s[8:11], s46 offen offset:128  lds
 s_add_u32 m0, s49, 7936
 s_nop 0
 buffer_load_dwordx4 v10, s[8:11], s46 offen offset:256  lds
 s_add_u32 m0, s49, 11904
 s_nop 0
 buffer_load_dwordx4 v10, s[8:11], s46 offen offset:384  lds
 s_add_u32 m0, s49, 15872
 s_nop 0
 buffer_load_dwordx4 v10, s[8:11], s46 offen offset:512  lds
 s_add_u32 m0, s49, 19840
 s_nop 0
 buffer_load_dwordx4 v10, s[8:11], s46 offen offset:640  lds
 s_add_u32 m0, s49, 23808
 s_nop 0
 buffer_load_dwordx4 v10, s[8:11], s46 offen offset:768  lds
 s_add_u32 m0, s49, 27776
 s_nop 0
 buffer_load_dwordx4 v10, s[8:11], s46 offen offset:896  lds
 s_add_u32 m0, s49, 31744
 s_nop 0
 buffer_load_dwordx4 v10, s[8:11], s46 offen offset:1024  lds
 s_lshl_b32 s49, s4, 10
 s_add_u32 m0, s49, 73728
 s_add_u32 s45, s32, 0
 buffer_load_dwordx4 v11, s[12:15], s45 offen  lds
 s_add_u32 m0, s49, 77824
 s_add_u32 s45, s32, 131072
 buffer_load_dwordx4 v11, s[12:15], s45 offen  lds
 s_add_u32 m0, s49, 81920
 s_add_u32 s45, s33, 0
 buffer_load_dwordx4 v11, s[16:19], s45 offen  lds
 s_add_u32 m0, s49, 86016
 s_add_u32 s45, s33, 131072
 buffer_load_dwordx4 v11, s[16:19], s45 offen  lds
 s_add_u32 m0, s49, 90112
 s_add_u32 s45, s32, 262144
 buffer_load_dwordx4 v11, s[12:15], s45 offen  lds
 s_add_u32 m0, s49, 94208
 s_add_u32 s45, s32, 393216
 buffer_load_dwordx4 v11, s[12:15], s45 offen  lds
 s_add_u32 m0, s49, 98304
 s_add_u32 s45, s33, 262144
 buffer_load_dwordx4 v11, s[16:19], s45 offen  lds
 s_add_u32 m0, s49, 102400
 s_add_u32 s45, s33, 393216
 buffer_load_dwordx4 v11, s[16:19], s45 offen  lds
 s_add_u32 m0, s49, 106496
 s_add_u32 s45, s32, 524288
 buffer_load_dwordx4 v11, s[12:15], s45 offen  lds
 s_add_u32 m0, s49, 110592
 s_add_u32 s45, s32, 655360
 buffer_load_dwordx4 v11, s[12:15], s45 offen  lds
 s_add_u32 m0, s49, 114688
 s_add_u32 s45, s33, 524288
 buffer_load_dwordx4 v11, s[16:19], s45 offen  lds
 s_add_u32 m0, s49, 118784
 s_add_u32 s45, s33, 655360
 buffer_load_dwordx4 v11, s[16:19], s45 offen  lds
 s_waitcnt vmcnt(8) lgkmcnt(0)
 s_barrier
 s_add_u32 m0, s49, 122880
 s_add_u32 s45, s32, 786432
 buffer_load_dwordx4 v11, s[12:15], s45 offen  lds
 s_add_u32 m0, s49, 126976
 s_add_u32 s45, s32, 917504
 buffer_load_dwordx4 v11, s[12:15], s45 offen  lds
 s_add_u32 m0, s49, 131072
 s_add_u32 s45, s33, 786432
 buffer_load_dwordx4 v11, s[16:19], s45 offen  lds
 s_add_u32 m0, s49, 135168
 s_add_u32 s45, s33, 917504
 buffer_load_dwordx4 v11, s[16:19], s45 offen  lds
 ds_read_b64_tr_b16 a[0:1], v8 offset:0
 ds_read_b64_tr_b16 a[2:3], v8 offset:1024
 ds_read_b64_tr_b16 a[72:73], v9 offset:0
 ds_read_b64_tr_b16 a[74:75], v9 offset:1024
 ds_read_b64_tr_b16 a[144:145], v8 offset:8192
 ds_read_b64_tr_b16 a[146:147], v8 offset:9216
 ds_read_b64_tr_b16 a[216:217], v9 offset:8192
 ds_read_b64_tr_b16 a[218:219], v9 offset:9216
 s_waitcnt vmcnt(8) lgkmcnt(0)
 s_barrier
 s_add_u32 m0, s49, 73728
 s_add_u32 s45, s32, 1048576
 buffer_load_dwordx4 v11, s[12:15], s45 offen  lds
 s_add_u32 m0, s49, 77824
 s_add_u32 s45, s32, 1179648
 buffer_load_dwordx4 v11, s[12:15], s45 offen  lds
 s_add_u32 m0, s49, 81920
 s_add_u32 s45, s33, 1048576
 buffer_load_dwordx4 v11, s[16:19], s45 offen  lds
 s_add_u32 m0, s49, 86016
 s_add_u32 s45, s33, 1179648
 buffer_load_dwordx4 v11, s[16:19], s45 offen  lds
 ds_read_b64_tr_b16 a[4:5], v8 offset:16384
 ds_read_b64_tr_b16 a[6:7], v8 offset:17408
 ds_read_b64_tr_b16 a[76:77], v9 offset:16384
 ds_read_b64_tr_b16 a[78:79], v9 offset:17408
 ds_read_b64_tr_b16 a[148:149], v8 offset:24576
 ds_read_b64_tr_b16 a[150:151], v8 offset:25600
 ds_read_b64_tr_b16 a[220:221], v9 offset:24576
 ds_read_b64_tr_b16 a[222:223], v9 offset:25600
 s_waitcnt vmcnt(8) lgkmcnt(0)
 s_barrier
 s_add_u32 m0, s49, 90112
 s_add_u32 s45, s32, 1310720
 buffer_load_dwordx4 v11, s[12:15], s45 offen  lds
 s_add_u32 m0, s49, 94208
 s_add_u32 s45, s32, 1441792
 buffer_load_dwordx4 v11, s[12:15], s45 offen  lds
 s_add_u32 m0, s49, 98304
 s_add_u32 s45, s33, 1310720
 buffer_load_dwordx4 v11, s[16:19], s45 offen  lds
 s_add_u32 m0, s49, 102400
 s_add_u32 s45, s33, 1441792
 buffer_load_dwordx4 v11, s[16:19], s45 offen  lds
 ds_read_b64_tr_b16 a[8:9], v8 offset:32768
 ds_read_b64_tr_b16 a[10:11], v8 offset:33792
 ds_read_b64_tr_b16 a[80:81], v9 offset:32768
 ds_read_b64_tr_b16 a[82:83], v9 offset:33792
 ds_read_b64_tr_b16 a[152:153], v8 offset:40960
 ds_read_b64_tr_b16 a[154:155], v8 offset:41984
 ds_read_b64_tr_b16 a[224:225], v9 offset:40960
 ds_read_b64_tr_b16 a[226:227], v9 offset:41984
 s_waitcnt vmcnt(8) lgkmcnt(0)
 s_barrier
 s_add_u32 m0, s49, 106496
 s_add_u32 s45, s32, 1572864
 buffer_load_dwordx4 v11, s[12:15], s45 offen  lds
 s_add_u32 m0, s49, 110592
 s_add_u32 s45, s32, 1703936
 buffer_load_dwordx4 v11, s[12:15], s45 offen  lds
 s_add_u32 m0, s49, 114688
 s_add_u32 s45, s33, 1572864
 buffer_load_dwordx4 v11, s[16:19], s45 offen  lds
 s_add_u32 m0, s49, 118784
 s_add_u32 s45, s33, 1703936
 buffer_load_dwordx4 v11, s[16:19], s45 offen  lds
 ds_read_b64_tr_b16 a[12:13], v8 offset:49152
 ds_read_b64_tr_b16 a[14:15], v8 offset:50176
 ds_read_b64_tr_b16 a[84:85], v9 offset:49152
 ds_read_b64_tr_b16 a[86:87], v9 offset:50176
 ds_read_b64_tr_b16 a[156:157], v8 offset:57344
 ds_read_b64_tr_b16 a[158:159], v8 offset:58368
 ds_read_b64_tr_b16 a[228:229], v9 offset:57344
 ds_read_b64_tr_b16 a[230:231], v9 offset:58368
 s_waitcnt vmcnt(8) lgkmcnt(0)
 s_barrier
 s_add_u32 m0, s49, 122880
 s_add_u32 s45, s32, 1835008
 buffer_load_dwordx4 v11, s[12:15], s45 offen  lds
 s_add_u32 m0, s49, 126976
 s_add_u32 s45, s32, 1966080
 buffer_load_dwordx4 v11, s[12:15], s45 offen  lds
 s_add_u32 m0, s49, 131072
 s_add_u32 s45, s33, 1835008
 buffer_load_dwordx4 v11, s[16:19], s45 offen  lds
 s_add_u32 m0, s49, 135168
 s_add_u32 s45, s33, 1966080
 buffer_load_dwordx4 v11, s[16:19], s45 offen  lds
 ds_read_b64_tr_b16 a[16:17], v8 offset:0
 ds_read_b64_tr_b16 a[18:19], v8 offset:1024
 ds_read_b64_tr_b16 a[88:89], v9 offset:0
 ds_read_b64_tr_b16 a[90:91], v9 offset:1024
 ds_read_b64_tr_b16 a[160:161], v8 offset:8192
 ds_read_b64_tr_b16 a[162:163], v8 offset:9216
 ds_read_b64_tr_b16 a[232:233], v9 offset:8192
 ds_read_b64_tr_b16 a[234:235], v9 offset:9216
 s_waitcnt vmcnt(8) lgkmcnt(0)
 s_barrier
 s_add_u32 m0, s49, 73728
 s_add_u32 s45, s32, 2097152
 buffer_load_dwordx4 v11, s[12:15], s45 offen  lds
 s_add_u32 m0, s49, 77824
 s_add_u32 s45, s32, 2228224
 buffer_load_dwordx4 v11, s[12:15], s45 offen  lds
 s_add_u32 m0, s49, 81920
 s_add_u32 s45, s33, 2097152
 buffer_load_dwordx4 v11, s[16:19], s45 offen  lds
 s_add_u32 m0, s49, 86016
 s_add_u32 s45, s33, 2228224
 buffer_load_dwordx4 v11, s[16:19], s45 offen  lds
 ds_read_b64_tr_b16 a[20:21], v8 offset:16384
 ds_read_b64_tr_b16 a[22:23], v8 offset:17408
 ds_read_b64_tr_b16 a[92:93], v9 offset:16384
 ds_read_b64_tr_b16 a[94:95], v9 offset:17408
 ds_read_b64_tr_b16 a[164:165], v8 offset:24576
 ds_read_b64_tr_b16 a[166:167], v8 offset:25600
 ds_read_b64_tr_b16 a[236:237], v9 offset:24576
 ds_read_b64_tr_b16 a[238:239], v9 offset:25600
 s_waitcnt vmcnt(8) lgkmcnt(0)
 s_barrier
 s_add_u32 m0, s49, 90112
 s_add_u32 s45, s32, 2359296
 buffer_load_dwordx4 v11, s[12:15], s45 offen  lds
 s_add_u32 m0, s49, 94208
 s_add_u32 s45, s32, 2490368
 buffer_load_dwordx4 v11, s[12:15], s45 offen  lds
 s_add_u32 m0, s49, 98304
 s_add_u32 s45, s33, 2359296
 buffer_load_dwordx4 v11, s[16:19], s45 offen  lds
 s_add_u32 m0, s49, 102400
 s_add_u32 s45, s33, 2490368
 buffer_load_dwordx4 v11, s[16:19], s45 offen  lds
 ds_read_b64_tr_b16 a[24:25], v8 offset:32768
 ds_read_b64_tr_b16 a[26:27], v8 offset:33792
 ds_read_b64_tr_b16 a[96:97], v9 offset:32768
 ds_read_b64_tr_b16 a[98:99], v9 offset:33792
 ds_read_b64_tr_b16 a[168:169], v8 offset:40960
 ds_read_b64_tr_b16 a[170:171], v8 offset:41984
 ds_read_b64_tr_b16 a[240:241], v9 offset:40960
 ds_read_b64_tr_b16 a[242:243], v9 offset:41984
 s_waitcnt vmcnt(8) lgkmcnt(0)
 s_barrier
 s_add_u32 m0, s49, 106496
 s_add_u32 s45, s32, 2621440
 buffer_load_dwordx4 v11, s[12:15], s45 offen  lds
 s_add_u32 m0, s49, 110592
 s_add_u32 s45, s32, 2752512
 buffer_load_dwordx4 v11, s[12:15], s45 offen  lds
 s_add_u32 m0, s49, 114688
 s_add_u32 s45, s33, 2621440
 buffer_load_dwordx4 v11, s[16:19], s45 offen  lds
 s_add_u32 m0, s49, 118784
 s_add_u32 s45, s33, 2752512
 buffer_load_dwordx4 v11, s[16:19], s45 offen  lds
 ds_read_b64_tr_b16 a[28:29], v8 offset:49152
 ds_read_b64_tr_b16 a[30:31], v8 offset:50176
 ds_read_b64_tr_b16 a[100:101], v9 offset:49152
 ds_read_b64_tr_b16 a[102:103], v9 offset:50176
 ds_read_b64_tr_b16 a[172:173], v8 offset:57344
 ds_read_b64_tr_b16 a[174:175], v8 offset:58368
 ds_read_b64_tr_b16 a[244:245], v9 offset:57344
 ds_read_b64_tr_b16 a[246:247], v9 offset:58368
 s_waitcnt vmcnt(8) lgkmcnt(0)
 s_barrier
 s_add_u32 m0, s49, 122880
 s_add_u32 s45, s32, 2883584
 buffer_load_dwordx4 v11, s[12:15], s45 offen  lds
 s_add_u32 m0, s49, 126976
 s_add_u32 s45, s32, 3014656
 buffer_load_dwordx4 v11, s[12:15], s45 offen  lds
 s_add_u32 m0, s49, 131072
 s_add_u32 s45, s33, 2883584
 buffer_load_dwordx4 v11, s[16:19], s45 offen  lds
 s_add_u32 m0, s49, 135168
 s_add_u32 s45, s33, 3014656
 buffer_load_dwordx4 v11, s[16:19], s45 offen  lds
 ds_read_b64_tr_b16 a[32:33], v8 offset:0
 ds_read_b64_tr_b16 a[34:35], v8 offset:1024
 ds_read_b64_tr_b16 a[104:105], v9 offset:0
 ds_read_b64_tr_b16 a[106:107], v9 offset:1024
 ds_read_b64_tr_b16 a[176:177], v8 offset:8192
 ds_read_b64_tr_b16 a[178:179], v8 offset:9216
 ds_read_b64_tr_b16 a[248:249], v9 offset:8192
 ds_read_b64_tr_b16 a[250:251], v9 offset:9216
 s_waitcnt vmcnt(8) lgkmcnt(0)
 s_barrier
 s_add_u32 m0, s49, 73728
 s_add_u32 s45, s32, 3145728
 buffer_load_dwordx4 v11, s[12:15], s45 offen  lds
 s_add_u32 m0, s49, 77824
 s_add_u32 s45, s32, 3276800
 buffer_load_dwordx4 v11, s[12:15], s45 offen  lds
 s_add_u32 m0, s49, 81920
 s_add_u32 s45, s33, 3145728
 buffer_load_dwordx4 v11, s[16:19], s45 offen  lds
 s_add_u32 m0, s49, 86016
 s_add_u32 s45, s33, 3276800
 buffer_load_dwordx4 v11, s[16:19], s45 offen  lds
 ds_read_b64_tr_b16 a[36:37], v8 offset:16384
 ds_read_b64_tr_b16 a[38:39], v8 offset:17408
 ds_read_b64_tr_b16 a[108:109], v9 offset:16384
 ds_read_b64_tr_b16 a[110:111], v9 offset:17408
 ds_read_b64_tr_b16 a[180:181], v8 offset:24576
 ds_read_b64_tr_b16 a[182:183], v8 offset:25600
 ds_read_b64_tr_b16 a[252:253], v9 offset:24576
 ds_read_b64_tr_b16 a[254:255], v9 offset:25600
 s_waitcnt vmcnt(8) lgkmcnt(0)
 s_barrier
 s_add_u32 m0, s49, 90112
 s_add_u32 s45, s32, 3407872
 buffer_load_dwordx4 v11, s[12:15], s45 offen  lds
 s_add_u32 m0, s49, 94208
 s_add_u32 s45, s32, 3538944
 buffer_load_dwordx4 v11, s[12:15], s45 offen  lds
 s_add_u32 m0, s49, 98304
 s_add_u32 s45, s33, 3407872
 buffer_load_dwordx4 v11, s[16:19], s45 offen  lds
 s_add_u32 m0, s49, 102400
 s_add_u32 s45, s33, 3538944
 buffer_load_dwordx4 v11, s[16:19], s45 offen  lds
 ds_read_b64_tr_b16 a[40:41], v8 offset:32768
 ds_read_b64_tr_b16 a[42:43], v8 offset:33792
 ds_read_b64_tr_b16 a[112:113], v9 offset:32768
 ds_read_b64_tr_b16 a[114:115], v9 offset:33792
 ds_read_b64_tr_b16 a[184:185], v8 offset:40960
 ds_read_b64_tr_b16 a[186:187], v8 offset:41984
 ds_read_b64_tr_b16 v[224:225], v9 offset:40960
 ds_read_b64_tr_b16 v[226:227], v9 offset:41984
 s_waitcnt vmcnt(8) lgkmcnt(0)
 s_barrier
 s_add_u32 m0, s49, 106496
 s_add_u32 s45, s32, 3670016
 buffer_load_dwordx4 v11, s[12:15], s45 offen  lds
 s_add_u32 m0, s49, 110592
 s_add_u32 s45, s32, 3801088
 buffer_load_dwordx4 v11, s[12:15], s45 offen  lds
 s_add_u32 m0, s49, 114688
 s_add_u32 s45, s33, 3670016
 buffer_load_dwordx4 v11, s[16:19], s45 offen  lds
 s_add_u32 m0, s49, 118784
 s_add_u32 s45, s33, 3801088
 buffer_load_dwordx4 v11, s[16:19], s45 offen  lds
 ds_read_b64_tr_b16 a[44:45], v8 offset:49152
 ds_read_b64_tr_b16 a[46:47], v8 offset:50176
 ds_read_b64_tr_b16 a[116:117], v9 offset:49152
 ds_read_b64_tr_b16 a[118:119], v9 offset:50176
 ds_read_b64_tr_b16 a[188:189], v8 offset:57344
 ds_read_b64_tr_b16 a[190:191], v8 offset:58368
 ds_read_b64_tr_b16 v[228:229], v9 offset:57344
 ds_read_b64_tr_b16 v[230:231], v9 offset:58368
 s_waitcnt vmcnt(8) lgkmcnt(0)
 s_barrier
 s_add_u32 m0, s49, 122880
 s_add_u32 s45, s32, 3932160
 buffer_load_dwordx4 v11, s[12:15], s45 offen  lds
 s_add_u32 m0, s49, 126976
 s_add_u32 s45, s32, 4063232
 buffer_load_dwordx4 v11, s[12:15], s45 offen  lds
 s_add_u32 m0, s49, 131072
 s_add_u32 s45, s33, 3932160
 buffer_load_dwordx4 v11, s[16:19], s45 offen  lds
 s_add_u32 m0, s49, 135168
 s_add_u32 s45, s33, 4063232
 buffer_load_dwordx4 v11, s[16:19], s45 offen  lds
 ds_read_b64_tr_b16 a[48:49], v8 offset:0
 ds_read_b64_tr_b16 a[50:51], v8 offset:1024
 ds_read_b64_tr_b16 a[120:121], v9 offset:0
 ds_read_b64_tr_b16 a[122:123], v9 offset:1024
 ds_read_b64_tr_b16 a[192:193], v8 offset:8192
 ds_read_b64_tr_b16 a[194:195], v8 offset:9216
 ds_read_b64_tr_b16 v[232:233], v9 offset:8192
 ds_read_b64_tr_b16 v[234:235], v9 offset:9216
 s_waitcnt vmcnt(8) lgkmcnt(0)
 s_barrier
 s_add_u32 m0, s49, 73728
 s_add_u32 s45, s32, 4194304
 buffer_load_dwordx4 v11, s[12:15], s45 offen  lds
 s_add_u32 m0, s49, 77824
 s_add_u32 s45, s32, 4325376
 buffer_load_dwordx4 v11, s[12:15], s45 offen  lds
 s_add_u32 m0, s49, 81920
 s_add_u32 s45, s33, 4194304
 buffer_load_dwordx4 v11, s[16:19], s45 offen  lds
 s_add_u32 m0, s49, 86016
 s_add_u32 s45, s33, 4325376
 buffer_load_dwordx4 v11, s[16:19], s45 offen  lds
 ds_read_b64_tr_b16 a[52:53], v8 offset:16384
 ds_read_b64_tr_b16 a[54:55], v8 offset:17408
 ds_read_b64_tr_b16 a[124:125], v9 offset:16384
 ds_read_b64_tr_b16 a[126:127], v9 offset:17408
 ds_read_b64_tr_b16 a[196:197], v8 offset:24576
 ds_read_b64_tr_b16 a[198:199], v8 offset:25600
 ds_read_b64_tr_b16 v[236:237], v9 offset:24576
 ds_read_b64_tr_b16 v[238:239], v9 offset:25600
 s_waitcnt vmcnt(8) lgkmcnt(0)
 s_barrier
 s_add_u32 m0, s49, 90112
 s_add_u32 s45, s32, 4456448
 buffer_load_dwordx4 v11, s[12:15], s45 offen  lds
 s_add_u32 m0, s49, 94208
 s_add_u32 s45, s32, 4587520
 buffer_load_dwordx4 v11, s[12:15], s45 offen  lds
 s_add_u32 m0, s49, 98304
 s_add_u32 s45, s33, 4456448
 buffer_load_dwordx4 v11, s[16:19], s45 offen  lds
 s_add_u32 m0, s49, 102400
 s_add_u32 s45, s33, 4587520
 buffer_load_dwordx4 v11, s[16:19], s45 offen  lds
 ds_read_b64_tr_b16 a[56:57], v8 offset:32768
 ds_read_b64_tr_b16 a[58:59], v8 offset:33792
 ds_read_b64_tr_b16 a[128:129], v9 offset:32768
 ds_read_b64_tr_b16 a[130:131], v9 offset:33792
 ds_read_b64_tr_b16 a[200:201], v8 offset:40960
 ds_read_b64_tr_b16 a[202:203], v8 offset:41984
 ds_read_b64_tr_b16 v[240:241], v9 offset:40960
 ds_read_b64_tr_b16 v[242:243], v9 offset:41984
 s_waitcnt vmcnt(8) lgkmcnt(0)
 s_barrier
 ds_read_b64_tr_b16 a[60:61], v8 offset:49152
 ds_read_b64_tr_b16 a[62:63], v8 offset:50176
 ds_read_b64_tr_b16 a[132:133], v9 offset:49152
 ds_read_b64_tr_b16 a[134:135], v9 offset:50176
 ds_read_b64_tr_b16 a[204:205], v8 offset:57344
 ds_read_b64_tr_b16 a[206:207], v8 offset:58368
 ds_read_b64_tr_b16 v[244:245], v9 offset:57344
 ds_read_b64_tr_b16 v[246:247], v9 offset:58368
 s_waitcnt vmcnt(4) lgkmcnt(0)
 s_barrier
 ds_read_b64_tr_b16 a[64:65], v8 offset:0
 ds_read_b64_tr_b16 a[66:67], v8 offset:1024
 ds_read_b64_tr_b16 a[136:137], v9 offset:0
 ds_read_b64_tr_b16 a[138:139], v9 offset:1024
 ds_read_b64_tr_b16 a[208:209], v8 offset:8192
 ds_read_b64_tr_b16 a[210:211], v8 offset:9216
 ds_read_b64_tr_b16 v[248:249], v9 offset:8192
 ds_read_b64_tr_b16 v[250:251], v9 offset:9216
 s_waitcnt vmcnt(0) lgkmcnt(0)
 s_barrier
 ds_read_b64_tr_b16 a[68:69], v8 offset:16384
 ds_read_b64_tr_b16 a[70:71], v8 offset:17408
 ds_read_b64_tr_b16 a[140:141], v9 offset:16384
 ds_read_b64_tr_b16 a[142:143], v9 offset:17408
 ds_read_b64_tr_b16 a[212:213], v8 offset:24576
 ds_read_b64_tr_b16 a[214:215], v8 offset:25600
 ds_read_b64_tr_b16 v[252:253], v9 offset:24576
 ds_read_b64_tr_b16 v[254:255], v9 offset:25600
 s_mov_b32 s50, 0x3e0293ee
 s_mov_b32 s42, 0
 s_mov_b32 s43, 0
 s_mov_b32 s44, 73728
 v_mov_b32 v6, v4
 v_mov_b32 v7, v5
Lrh_25:
 v_mbcnt_lo_u32_b32 v21, -1, 0
 v_min_u32 v21, 1, v21
 v_lshlrev_b32 v21, 28, v21
 buffer_load_dword v20, v21, s[28:31], 0 offen offset:4 sc1
 s_waitcnt vmcnt(0)
Lrhc_26:
 v_readfirstlane_b32 s89, v20
 s_cmp_eq_u32 s89, s88
 s_cbranch_scc1 Lrhk_27
 s_cmp_lg_u32 s89, 0
 s_cbranch_scc1 Lredo
 s_sub_u32 s95, s95, 1
 s_cbranch_scc0 Lrh_25
 s_endpgm
Lrhk_27:
 s_cmp_lg_u32 s4, 0
 s_cbranch_scc1 Lfrk_24
 v_min_u32 v21, 1, v0
 v_lshlrev_b32 v21, 28, v21
Lfr_23:
 buffer_load_dword v20, v21, s[28:31], 0 offen offset:0 sc1
 s_waitcnt vmcnt(0)
 v_cmp_eq_u32 vcc, 1, v20
 s_cbranch_vccnz Lfrk_24
 s_sub_u32 s95, s95, 1
 s_cbranch_scc0 Lfr_23
 s_endpgm
Lfrk_24:
 s_lshl_b32 s47, s2, 13
 s_add_u32 s47, s47, 0x8000000
 s_mov_b32 s48, s47
 v_mov_b32 v14, 0
 s_waitcnt vmcnt(0) lgkmcnt(0)
 s_barrier
 ds_read_b128 v[32:35], v6 offset:0
 ds_read_b128 v[36:39], v6 offset:2048
 ds_read_b128 v[40:43], v7 offset:0
 ds_read_b128 v[44:47], v7 offset:2048
 s_mul_i32 s45, s6, 1152
 v_lshl_add_u32 v1, v0, 7, s45
 v_add_u32 v1, 110592, v1
 v_mov_b32 v2, 0x7ff00000
 v_cmp_gt_u32 vcc, 9, v0
 s_nop 1
 v_cndmask_b32 v1, v2, v1, vcc
 s_waitcnt lgkmcnt(2)
Lps_loop_28:
 v_mfma_f32_16x16x32_bf16 v[64:67], a[0:3], v[32:35], 0
 ds_read_b128 v[48:51], v6 offset:4096
 v_mfma_f32_16x16x32_bf16 v[72:75], a[72:75], v[32:35], 0
 ds_read_b128 v[52:55], v6 offset:6144
 v_mfma_f32_16x16x32_bf16 v[80:83], v[32:35], a[144:147], 0
 s_add_u32 s41, s40, 1
 v_mfma_f32_16x16x32_bf16 v[88:91], v[32:35], a[216:219], 0
 s_add_u32 s45, s42, 2
 s_mul_i32 s46, s41, 36864
 v_mfma_f32_16x16x32_bf16 v[68:71], a[0:3], v[36:39], 0
 s_cmp_lt_u32 s45, s36
 s_cselect_b32 s46, s46, 0
 v_mfma_f32_16x16x32_bf16 v[76:79], a[72:75], v[36:39], 0
 s_lshl_b32 s49, s4, 10
 s_add_u32 s49, s49, s44
 v_mfma_f32_16x16x32_bf16 v[84:87], v[36:39], a[144:147], 0
 v_mul_f32 v96, s50, v96
 v_mul_f32 v97, s50, v97
 v_mfma_f32_16x16x32_bf16 v[92:95], v[36:39], a[216:219], 0
 s_waitcnt lgkmcnt(2)
 v_mfma_f32_16x16x32_bf16 v[64:67], a[4:7], v[40:43], v[64:67]
 ds_read_b128 v[56:59], v7 offset:4096
 v_mul_f32 v98, s50, v98
 v_mfma_f32_16x16x32_bf16 v[72:75], a[76:79], v[40:43], v[72:75]
 ds_read_b128 v[60:63], v7 offset:6144
 v_mul_f32 v99, s50, v99
 v_mfma_f32_16x16x32_bf16 v[80:83], v[40:43], a[148:151], v[80:83]
 v_mul_f32 v104, s50, v104
 v_mfma_f32_16x16x32_bf16 v[88:91], v[40:43], a[220:223], v[88:91]
 v_mul_f32 v105, s50, v105
 v_mfma_f32_16x16x32_bf16 v[68:71], a[4:7], v[44:47], v[68:71]
 v_mul_f32 v106, s50, v106
 v_mul_f32 v107, s50, v107
 v_mfma_f32_16x16x32_bf16 v[76:79], a[76:79], v[44:47], v[76:79]
 v_cvt_pk_bf16_f32 v16, v96, v104
 v_mfma_f32_16x16x32_bf16 v[84:87], v[44:47], a[148:151], v[84:87]
 v_cvt_pk_bf16_f32 v17, v97, v105
 v_mfma_f32_16x16x32_bf16 v[92:95], v[44:47], a[220:223], v[92:95]
 s_waitcnt lgkmcnt(2)
 v_cvt_pk_bf16_f32 v18, v98, v106
 v_mfma_f32_16x16x32_bf16 v[64:67], a[8:11], v[48:51], v[64:67]
 ds_read_b128 v[32:35], v6 offset:8192
 v_cvt_pk_bf16_f32 v19, v99, v107
 v_mfma_f32_16x16x32_bf16 v[72:75], a[80:83], v[48:51], v[72:75]
 ds_read_b128 v[36:39], v6 offset:10240
 v_mfma_f32_16x16x32_bf16 v[80:83], v[48:51], a[152:155], v[80:83]
 buffer_store_dwordx4 v[16:19], v12, s[20:23], s47 offen offset:0 sc1
 v_mul_f32 v100, s50, v100
 v_mfma_f32_16x16x32_bf16 v[88:91], v[48:51], a[224:227], v[88:91]
 v_mul_f32 v101, s50, v101
 v_mfma_f32_16x16x32_bf16 v[68:71], a[8:11], v[52:55], v[68:71]
 v_mul_f32 v102, s50, v102
 v_mfma_f32_16x16x32_bf16 v[76:79], a[80:83], v[52:55], v[76:79]
 v_mul_f32 v103, s50, v103
 v_mul_f32 v108, s50, v108
 v_mfma_f32_16x16x32_bf16 v[84:87], v[52:55], a[152:155], v[84:87]
 v_mul_f32 v109, s50, v109
 v_mfma_f32_16x16x32_bf16 v[92:95], v[52:55], a[224:227], v[92:95]
 s_waitcnt lgkmcnt(2)
 v_mfma_f32_16x16x32_bf16 v[64:67], a[12:15], v[56:59], v[64:67]
 ds_read_b128 v[40:43], v7 offset:8192
 v_mul_f32 v110, s50, v110
 v_mfma_f32_16x16x32_bf16 v[72:75], a[84:87], v[56:59], v[72:75]
 ds_read_b128 v[44:47], v7 offset:10240
 v_mul_f32 v111, s50, v111
 v_mfma_f32_16x16x32_bf16 v[80:83], v[56:59], a[156:159], v[80:83]
 v_cvt_pk_bf16_f32 v20, v100, v108
 v_mfma_f32_16x16x32_bf16 v[88:91], v[56:59], a[228:231], v[88:91]
 v_cvt_pk_bf16_f32 v21, v101, v109
 v_mfma_f32_16x16x32_bf16 v[68:71], a[12:15], v[60:63], v[68:71]
 v_cvt_pk_bf16_f32 v22, v102, v110
 v_cvt_pk_bf16_f32 v23, v103, v111
 v_mfma_f32_16x16x32_bf16 v[76:79], a[84:87], v[60:63], v[76:79]
 buffer_store_dwordx4 v[20:23], v12, s[20:23], s47 offen offset:1024 sc1
 v_mfma_f32_16x16x32_bf16 v[84:87], v[60:63], a[156:159], v[84:87]
 v_cvt_pk_bf16_f32 v24, v112, v113
 v_mfma_f32_16x16x32_bf16 v[92:95], v[60:63], a[228:231], v[92:95]
 s_waitcnt lgkmcnt(2)
 v_cvt_pk_bf16_f32 v25, v116, v117
 v_mfma_f32_16x16x32_bf16 v[64:67], a[16:19], v[32:35], v[64:67]
 ds_read_b128 v[48:51], v6 offset:12288
 v_cvt_pk_bf16_f32 v26, v114, v115
 v_mfma_f32_16x16x32_bf16 v[72:75], a[88:91], v[32:35], v[72:75]
 ds_read_b128 v[52:55], v6 offset:14336
 v_mfma_f32_16x16x32_bf16 v[80:83], v[32:35], a[160:163], v[80:83]
 v_cvt_pk_bf16_f32 v27, v118, v119
 buffer_store_dwordx4 v[24:27], v12, s[20:23], s48 offen offset:0 sc1
 v_mfma_f32_16x16x32_bf16 v[88:91], v[32:35], a[232:235], v[88:91]
 v_cvt_pk_bf16_f32 v28, v120, v121
 v_mfma_f32_16x16x32_bf16 v[68:71], a[16:19], v[36:39], v[68:71]
 v_cvt_pk_bf16_f32 v29, v124, v125
 v_mfma_f32_16x16x32_bf16 v[76:79], a[88:91], v[36:39], v[76:79]
 v_cvt_pk_bf16_f32 v30, v122, v123
 v_cvt_pk_bf16_f32 v31, v126, v127
 v_mfma_f32_16x16x32_bf16 v[84:87], v[36:39], a[160:163], v[84:87]
 buffer_store_dwordx4 v[28:31], v12, s[20:23], s48 offen offset:1024 sc1
 v_mfma_f32_16x16x32_bf16 v[92:95], v[36:39], a[232:235], v[92:95]
 s_waitcnt lgkmcnt(2)
 v_mfma_f32_16x16x32_bf16 v[64:67], a[20:23], v[40:43], v[64:67]
 ds_read_b128 v[56:59], v7 offset:12288
 v_mfma_f32_16x16x32_bf16 v[72:75], a[92:95], v[40:43], v[72:75]
 ds_read_b128 v[60:63], v7 offset:14336
 v_mfma_f32_16x16x32_bf16 v[80:83], v[40:43], a[164:167], v[80:83]
 s_add_u32 m0, s49, 0
 v_mfma_f32_16x16x32_bf16 v[88:91], v[40:43], a[236:239], v[88:91]
 buffer_load_dwordx4 v10, s[8:11], s46 offen offset:0  lds
 v_mfma_f32_16x16x32_bf16 v[68:71], a[20:23], v[44:47], v[68:71]
 s_add_u32 m0, s49, 3968
 v_mfma_f32_16x16x32_bf16 v[76:79], a[92:95], v[44:47], v[76:79]
 buffer_load_dwordx4 v10, s[8:11], s46 offen offset:128  lds
 v_mfma_f32_16x16x32_bf16 v[84:87], v[44:47], a[164:167], v[84:87]
 v_mfma_f32_16x16x32_bf16 v[92:95], v[44:47], a[236:239], v[92:95]
 s_waitcnt lgkmcnt(2)
 v_mfma_f32_16x16x32_bf16 v[64:67], a[24:27], v[48:51], v[64:67]
 ds_read_b128 v[32:35], v6 offset:16384
 v_mfma_f32_16x16x32_bf16 v[72:75], a[96:99], v[48:51], v[72:75]
 ds_read_b128 v[36:39], v6 offset:18432
 v_mfma_f32_16x16x32_bf16 v[80:83], v[48:51], a[168:171], v[80:83]
 s_add_u32 m0, s49, 7936
 v_mfma_f32_16x16x32_bf16 v[88:91], v[48:51], a[240:243], v[88:91]
 buffer_load_dwordx4 v10, s[8:11], s46 offen offset:256  lds
 v_mfma_f32_16x16x32_bf16 v[68:71], a[24:27], v[52:55], v[68:71]
 s_add_u32 m0, s49, 11904
 v_mfma_f32_16x16x32_bf16 v[76:79], a[96:99], v[52:55], v[76:79]
 buffer_load_dwordx4 v10, s[8:11], s46 offen offset:384  lds
 v_mfma_f32_16x16x32_bf16 v[84:87], v[52:55], a[168:171], v[84:87]
 v_mfma_f32_16x16x32_bf16 v[92:95], v[52:55], a[240:243], v[92:95]
 s_waitcnt lgkmcnt(2)
 v_mfma_f32_16x16x32_bf16 v[64:67], a[28:31], v[56:59], v[64:67]
 ds_read_b128 v[40:43], v7 offset:16384
 v_mfma_f32_16x16x32_bf16 v[72:75], a[100:103], v[56:59], v[72:75]
 ds_read_b128 v[44:47], v7 offset:18432
 v_mfma_f32_16x16x32_bf16 v[80:83], v[56:59], a[172:175], v[80:83]
 s_add_u32 m0, s49, 15872
 v_mfma_f32_16x16x32_bf16 v[88:91], v[56:59], a[244:247], v[88:91]
 buffer_load_dwordx4 v10, s[8:11], s46 offen offset:512  lds
 v_mfma_f32_16x16x32_bf16 v[68:71], a[28:31], v[60:63], v[68:71]
 s_add_u32 m0, s49, 19840
 v_mfma_f32_16x16x32_bf16 v[76:79], a[100:103], v[60:63], v[76:79]
 buffer_load_dwordx4 v10, s[8:11], s46 offen offset:640  lds
 v_mfma_f32_16x16x32_bf16 v[84:87], v[60:63], a[172:175], v[84:87]
 v_mfma_f32_16x16x32_bf16 v[92:95], v[60:63], a[244:247], v[92:95]
 s_waitcnt lgkmcnt(2)
 v_mfma_f32_16x16x32_bf16 v[64:67], a[32:35], v[32:35], v[64:67]
 ds_read_b128 v[48:51], v6 offset:20480
 v_mfma_f32_16x16x32_bf16 v[72:75], a[104:107], v[32:35], v[72:75]
 ds_read_b128 v[52:55], v6 offset:22528
 v_mfma_f32_16x16x32_bf16 v[80:83], v[32:35], a[176:179], v[80:83]
 s_add_u32 m0, s49, 23808
 v_mfma_f32_16x16x32_bf16 v[88:91], v[32:35], a[248:251], v[88:91]
 buffer_load_dwordx4 v10, s[8:11], s46 offen offset:768  lds
 v_mfma_f32_16x16x32_bf16 v[68:71], a[32:35], v[36:39], v[68:71]
 s_add_u32 m0, s49, 27776
 v_mfma_f32_16x16x32_bf16 v[76:79], a[104:107], v[36:39], v[76:79]
 buffer_load_dwordx4 v10, s[8:11], s46 offen offset:896  lds
 v_mfma_f32_16x16x32_bf16 v[84:87], v[36:39], a[176:179], v[84:87]
 v_mfma_f32_16x16x32_bf16 v[92:95], v[36:39], a[248:251], v[92:95]
 s_waitcnt lgkmcnt(2)
 v_mfma_f32_16x16x32_bf16 v[64:67], a[36:39], v[40:43], v[64:67]
 ds_read_b128 v[56:59], v7 offset:20480
 v_mfma_f32_16x16x32_bf16 v[72:75], a[108:111], v[40:43], v[72:75]
 ds_read_b128 v[60:63], v7 offset:22528
 v_mfma_f32_16x16x32_bf16 v[80:83], v[40:43], a[180:183], v[80:83]
 s_add_u32 m0, s49, 31744
 v_mfma_f32_16x16x32_bf16 v[88:91], v[40:43], a[252:255], v[88:91]
 buffer_load_dwordx4 v10, s[8:11], s46 offen offset:1024  lds
 v_mfma_f32_16x16x32_bf16 v[68:71], a[36:39], v[44:47], v[68:71]
 v_add_u32 v2, s46, v1
 v_mfma_f32_16x16x32_bf16 v[76:79], a[108:111], v[44:47], v[76:79]
 buffer_load_dword v15, v2, s[8:11], 0 offen
 v_mfma_f32_16x16x32_bf16 v[84:87], v[44:47], a[180:183], v[84:87]
 v_mfma_f32_16x16x32_bf16 v[92:95], v[44:47], a[252:255], v[92:95]
 s_waitcnt lgkmcnt(2)
 v_mfma_f32_16x16x32_bf16 v[64:67], a[40:43], v[48:51], v[64:67]
 ds_read_b128 v[32:35], v6 offset:24576
 v_mfma_f32_16x16x32_bf16 v[72:75], a[112:115], v[48:51], v[72:75]
 ds_read_b128 v[36:39], v6 offset:26624
 v_mfma_f32_16x16x32_bf16 v[80:83], v[48:51], a[184:187], v[80:83]
 v_mfma_f32_16x16x32_bf16 v[88:91], v[48:51], v[224:227], v[88:91]
 v_mfma_f32_16x16x32_bf16 v[68:71], a[40:43], v[52:55], v[68:71]
 v_mfma_f32_16x16x32_bf16 v[76:79], a[112:115], v[52:55], v[76:79]
 v_mfma_f32_16x16x32_bf16 v[84:87], v[52:55], a[184:187], v[84:87]
 v_mfma_f32_16x16x32_bf16 v[92:95], v[52:55], v[224:227], v[92:95]
 s_waitcnt lgkmcnt(2)
 v_mfma_f32_16x16x32_bf16 v[64:67], a[44:47], v[56:59], v[64:67]
 ds_read_b128 v[40:43], v7 offset:24576
 v_mfma_f32_16x16x32_bf16 v[72:75], a[116:119], v[56:59], v[72:75]
 ds_read_b128 v[44:47], v7 offset:26624
 v_mfma_f32_16x16x32_bf16 v[80:83], v[56:59], a[188:191], v[80:83]
 v_mfma_f32_16x16x32_bf16 v[88:91], v[56:59], v[228:231], v[88:91]
 v_mfma_f32_16x16x32_bf16 v[68:71], a[44:47], v[60:63], v[68:71]
 v_mfma_f32_16x16x32_bf16 v[76:79], a[116:119], v[60:63], v[76:79]
 v_mfma_f32_16x16x32_bf16 v[84:87], v[60:63], a[188:191], v[84:87]
 v_mfma_f32_16x16x32_bf16 v[92:95], v[60:63], v[228:231], v[92:95]
 s_waitcnt lgkmcnt(2)
 v_mfma_f32_16x16x32_bf16 v[64:67], a[48:51], v[32:35], v[64:67]
 ds_read_b128 v[48:51], v6 offset:28672
 v_mfma_f32_16x16x32_bf16 v[72:75], a[120:123], v[32:35], v[72:75]
 ds_read_b128 v[52:55], v6 offset:30720
 v_mfma_f32_16x16x32_bf16 v[80:83], v[32:35], a[192:195], v[80:83]
 v_mfma_f32_16x16x32_bf16 v[88:91], v[32:35], v[232:235], v[88:91]
 v_mfma_f32_16x16x32_bf16 v[68:71], a[48:51], v[36:39], v[68:71]
 v_mfma_f32_16x16x32_bf16 v[76:79], a[120:123], v[36:39], v[76:79]
 v_mfma_f32_16x16x32_bf16 v[84:87], v[36:39], a[192:195], v[84:87]
 v_mfma_f32_16x16x32_bf16 v[92:95], v[36:39], v[232:235], v[92:95]
 s_waitcnt lgkmcnt(2)
 v_mfma_f32_16x16x32_bf16 v[64:67], a[52:55], v[40:43], v[64:67]
 ds_read_b128 v[56:59], v7 offset:28672
 v_mfma_f32_16x16x32_bf16 v[72:75], a[124:127], v[40:43], v[72:75]
 ds_read_b128 v[60:63], v7 offset:30720
 v_mfma_f32_16x16x32_bf16 v[80:83], v[40:43], a[196:199], v[80:83]
 s_add_u32 s43, s43, 36864
 s_cmp_eq_u32 s43, 147456
 v_mfma_f32_16x16x32_bf16 v[88:91], v[40:43], v[236:239], v[88:91]
 s_cselect_b32 s43, 0, s43
 s_add_u32 s44, s44, 36864
 v_mfma_f32_16x16x32_bf16 v[68:71], a[52:55], v[44:47], v[68:71]
 s_cmp_eq_u32 s44, 147456
 s_cselect_b32 s44, 0, s44
 v_mfma_f32_16x16x32_bf16 v[76:79], a[124:127], v[44:47], v[76:79]
 v_mfma_f32_16x16x32_bf16 v[84:87], v[44:47], a[196:199], v[84:87]
 v_mfma_f32_16x16x32_bf16 v[92:95], v[44:47], v[236:239], v[92:95]
 s_waitcnt lgkmcnt(2)
 v_mfma_f32_16x16x32_bf16 v[64:67], a[56:59], v[48:51], v[64:67]
 ds_read_b128 v[32:35], v6 offset:32768
 v_mfma_f32_16x16x32_bf16 v[72:75], a[128:131], v[48:51], v[72:75]
 ds_read_b128 v[36:39], v6 offset:34816
 v_mfma_f32_16x16x32_bf16 v[80:83], v[48:51], a[200:203], v[80:83]
 v_add_u32 v6, s43, v4
 v_mfma_f32_16x16x32_bf16 v[88:91], v[48:51], v[240:243], v[88:91]
 v_mfma_f32_16x16x32_bf16 v[68:71], a[56:59], v[52:55], v[68:71]
 v_mfma_f32_16x16x32_bf16 v[76:79], a[128:131], v[52:55], v[76:79]
 v_mfma_f32_16x16x32_bf16 v[84:87], v[52:55], a[200:203], v[84:87]
 v_mfma_f32_16x16x32_bf16 v[92:95], v[52:55], v[240:243], v[92:95]
 s_waitcnt lgkmcnt(2)
 v_mfma_f32_16x16x32_bf16 v[64:67], a[60:63], v[56:59], v[64:67]
 ds_read_b128 v[40:43], v7 offset:32768
 v_mfma_f32_16x16x32_bf16 v[72:75], a[132:135], v[56:59], v[72:75]
 ds_read_b128 v[44:47], v7 offset:34816
 v_mfma_f32_16x16x32_bf16 v[80:83], v[56:59], a[204:207], v[80:83]
 v_add_u32 v7, s43, v5
 v_mfma_f32_16x16x32_bf16 v[88:91], v[56:59], v[244:247], v[88:91]
 v_mfma_f32_16x16x32_bf16 v[68:71], a[60:63], v[60:63], v[68:71]
 v_mfma_f32_16x16x32_bf16 v[76:79], a[132:135], v[60:63], v[76:79]
 v_mfma_f32_16x16x32_bf16 v[84:87], v[60:63], a[204:207], v[84:87]
 v_mfma_f32_16x16x32_bf16 v[92:95], v[60:63], v[244:247], v[92:95]
 s_waitcnt lgkmcnt(2)
 v_mfma_f32_16x16x32_bf16 v[64:67], a[64:67], v[32:35], v[64:67]
 s_waitcnt vmcnt(10)
 s_barrier
 ds_read_b128 v[48:51], v6 offset:0
 v_mfma_f32_16x16x32_bf16 v[72:75], a[136:139], v[32:35], v[72:75]
 ds_read_b128 v[52:55], v6 offset:2048
 v_mfma_f32_16x16x32_bf16 v[80:83], v[32:35], a[208:211], v[80:83]
 buffer_store_dword v14, v13, s[20:23], 0 offen sc1
 v_mfma_f32_16x16x32_bf16 v[88:91], v[32:35], v[248:251], v[88:91]
 v_mfma_f32_16x16x32_bf16 v[68:71], a[64:67], v[36:39], v[68:71]
 v_mfma_f32_16x16x32_bf16 v[76:79], a[136:139], v[36:39], v[76:79]
 v_mfma_f32_16x16x32_bf16 v[84:87], v[36:39], a[208:211], v[84:87]
 v_mfma_f32_16x16x32_bf16 v[92:95], v[36:39], v[248:251], v[92:95]
 s_waitcnt lgkmcnt(2)
 v_mfma_f32_16x16x32_bf16 v[64:67], a[68:71], v[40:43], v[64:67]
 ds_read_b128 v[56:59], v7 offset:0
 v_mfma_f32_16x16x32_bf16 v[72:75], a[140:143], v[40:43], v[72:75]
 ds_read_b128 v[60:63], v7 offset:2048
 v_mfma_f32_16x16x32_bf16 v[80:83], v[40:43], a[212:215], v[80:83]
 s_mul_i32 s45, s39, 524288
 s_add_u32 s47, s34, s45
 v_mfma_f32_16x16x32_bf16 v[88:91], v[40:43], v[252:255], v[88:91]
 s_add_u32 s48, s35, s45
 v_add_u32 v14, 1, v14
 v_mfma_f32_16x16x32_bf16 v[68:71], a[68:71], v[44:47], v[68:71]
 s_mov_b32 s39, s40
 s_mov_b32 s40, s41
 v_mfma_f32_16x16x32_bf16 v[76:79], a[140:143], v[44:47], v[76:79]
 s_add_u32 s42, s42, 1
 v_mfma_f32_16x16x32_bf16 v[84:87], v[44:47], a[212:215], v[84:87]
 v_mfma_f32_16x16x32_bf16 v[92:95], v[44:47], v[252:255], v[92:95]
 s_waitcnt lgkmcnt(2)
 v_mfma_f32_16x16x32_bf16 v[96:99], a[0:3], v[48:51], 0
 ds_read_b128 v[32:35], v6 offset:4096
 v_mfma_f32_16x16x32_bf16 v[104:107], a[72:75], v[48:51], 0
 ds_read_b128 v[36:39], v6 offset:6144
 v_mfma_f32_16x16x32_bf16 v[112:115], v[48:51], a[144:147], 0
 s_add_u32 s41, s40, 1
 v_mfma_f32_16x16x32_bf16 v[120:123], v[48:51], a[216:219], 0
 s_add_u32 s45, s42, 2
 s_mul_i32 s46, s41, 36864
 v_mfma_f32_16x16x32_bf16 v[100:103], a[0:3], v[52:55], 0
 s_cmp_lt_u32 s45, s36
 s_cselect_b32 s46, s46, 0
 v_mfma_f32_16x16x32_bf16 v[108:111], a[72:75], v[52:55], 0
 s_lshl_b32 s49, s4, 10
 s_add_u32 s49, s49, s44
 v_mfma_f32_16x16x32_bf16 v[116:119], v[52:55], a[144:147], 0
 v_mul_f32 v64, s50, v64
 v_mul_f32 v65, s50, v65
 v_mfma_f32_16x16x32_bf16 v[124:127], v[52:55], a[216:219], 0
 s_waitcnt lgkmcnt(2)
 v_mfma_f32_16x16x32_bf16 v[96:99], a[4:7], v[56:59], v[96:99]
 ds_read_b128 v[40:43], v7 offset:4096
 v_mul_f32 v66, s50, v66
 v_mfma_f32_16x16x32_bf16 v[104:107], a[76:79], v[56:59], v[104:107]
 ds_read_b128 v[44:47], v7 offset:6144
 v_mul_f32 v67, s50, v67
 v_mfma_f32_16x16x32_bf16 v[112:115], v[56:59], a[148:151], v[112:115]
 v_mul_f32 v72, s50, v72
 v_mfma_f32_16x16x32_bf16 v[120:123], v[56:59], a[220:223], v[120:123]
 v_mul_f32 v73, s50, v73
 v_mfma_f32_16x16x32_bf16 v[100:103], a[4:7], v[60:63], v[100:103]
 v_mul_f32 v74, s50, v74
 v_mul_f32 v75, s50, v75
 v_mfma_f32_16x16x32_bf16 v[108:111], a[76:79], v[60:63], v[108:111]
 v_cvt_pk_bf16_f32 v16, v64, v72
 v_mfma_f32_16x16x32_bf16 v[116:119], v[60:63], a[148:151], v[116:119]
 v_cvt_pk_bf16_f32 v17, v65, v73
 v_mfma_f32_16x16x32_bf16 v[124:127], v[60:63], a[220:223], v[124:127]
 s_waitcnt lgkmcnt(2)
 v_cvt_pk_bf16_f32 v18, v66, v74
 v_mfma_f32_16x16x32_bf16 v[96:99], a[8:11], v[32:35], v[96:99]
 ds_read_b128 v[48:51], v6 offset:8192
 v_cvt_pk_bf16_f32 v19, v67, v75
 v_mfma_f32_16x16x32_bf16 v[104:107], a[80:83], v[32:35], v[104:107]
 ds_read_b128 v[52:55], v6 offset:10240
 v_mfma_f32_16x16x32_bf16 v[112:115], v[32:35], a[152:155], v[112:115]
 buffer_store_dwordx4 v[16:19], v12, s[20:23], s47 offen offset:0 sc1
 v_mul_f32 v68, s50, v68
 v_mfma_f32_16x16x32_bf16 v[120:123], v[32:35], a[224:227], v[120:123]
 v_mul_f32 v69, s50, v69
 v_mfma_f32_16x16x32_bf16 v[100:103], a[8:11], v[36:39], v[100:103]
 v_mul_f32 v70, s50, v70
 v_mfma_f32_16x16x32_bf16 v[108:111], a[80:83], v[36:39], v[108:111]
 v_mul_f32 v71, s50, v71
 v_mul_f32 v76, s50, v76
 v_mfma_f32_16x16x32_bf16 v[116:119], v[36:39], a[152:155], v[116:119]
 v_mul_f32 v77, s50, v77
 v_mfma_f32_16x16x32_bf16 v[124:127], v[36:39], a[224:227], v[124:127]
 s_waitcnt lgkmcnt(2)
 v_mfma_f32_16x16x32_bf16 v[96:99], a[12:15], v[40:43], v[96:99]
 ds_read_b128 v[56:59], v7 offset:8192
 v_mul_f32 v78, s50, v78
 v_mfma_f32_16x16x32_bf16 v[104:107], a[84:87], v[40:43], v[104:107]
 ds_read_b128 v[60:63], v7 offset:10240
 v_mul_f32 v79, s50, v79
 v_mfma_f32_16x16x32_bf16 v[112:115], v[40:43], a[156:159], v[112:115]
 v_cvt_pk_bf16_f32 v20, v68, v76
 v_mfma_f32_16x16x32_bf16 v[120:123], v[40:43], a[228:231], v[120:123]
 v_cvt_pk_bf16_f32 v21, v69, v77
 v_mfma_f32_16x16x32_bf16 v[100:103], a[12:15], v[44:47], v[100:103]
 v_cvt_pk_bf16_f32 v22, v70, v78
 v_cvt_pk_bf16_f32 v23, v71, v79
 v_mfma_f32_16x16x32_bf16 v[108:111], a[84:87], v[44:47], v[108:111]
 buffer_store_dwordx4 v[20:23], v12, s[20:23], s47 offen offset:1024 sc1
 v_mfma_f32_16x16x32_bf16 v[116:119], v[44:47], a[156:159], v[116:119]
 v_cvt_pk_bf16_f32 v24, v80, v81
 v_mfma_f32_16x16x32_bf16 v[124:127], v[44:47], a[228:231], v[124:127]
 s_waitcnt lgkmcnt(2)
 v_cvt_pk_bf16_f32 v25, v84, v85
 v_mfma_f32_16x16x32_bf16 v[96:99], a[16:19], v[48:51], v[96:99]
 ds_read_b128 v[32:35], v6 offset:12288
 v_cvt_pk_bf16_f32 v26, v82, v83
 v_mfma_f32_16x16x32_bf16 v[104:107], a[88:91], v[48:51], v[104:107]
 ds_read_b128 v[36:39], v6 offset:14336
 v_mfma_f32_16x16x32_bf16 v[112:115], v[48:51], a[160:163], v[112:115]
 v_cvt_pk_bf16_f32 v27, v86, v87
 buffer_store_dwordx4 v[24:27], v12, s[20:23], s48 offen offset:0 sc1
 v_mfma_f32_16x16x32_bf16 v[120:123], v[48:51], a[232:235], v[120:123]
 v_cvt_pk_bf16_f32 v28, v88, v89
 v_mfma_f32_16x16x32_bf16 v[100:103], a[16:19], v[52:55], v[100:103]
 v_cvt_pk_bf16_f32 v29, v92, v93
 v_mfma_f32_16x16x32_bf16 v[108:111], a[88:91], v[52:55], v[108:111]
 v_cvt_pk_bf16_f32 v30, v90, v91
 v_cvt_pk_bf16_f32 v31, v94, v95
 v_mfma_f32_16x16x32_bf16 v[116:119], v[52:55], a[160:163], v[116:119]
 buffer_store_dwordx4 v[28:31], v12, s[20:23], s48 offen offset:1024 sc1
 v_mfma_f32_16x16x32_bf16 v[124:127], v[52:55], a[232:235], v[124:127]
 s_waitcnt lgkmcnt(2)
 v_mfma_f32_16x16x32_bf16 v[96:99], a[20:23], v[56:59], v[96:99]
 ds_read_b128 v[40:43], v7 offset:12288
 v_mfma_f32_16x16x32_bf16 v[104:107], a[92:95], v[56:59], v[104:107]
 ds_read_b128 v[44:47], v7 offset:14336
 v_mfma_f32_16x16x32_bf16 v[112:115], v[56:59], a[164:167], v[112:115]
 s_add_u32 m0, s49, 0
 v_mfma_f32_16x16x32_bf16 v[120:123], v[56:59], a[236:239], v[120:123]
 buffer_load_dwordx4 v10, s[8:11], s46 offen offset:0  lds
 v_mfma_f32_16x16x32_bf16 v[100:103], a[20:23], v[60:63], v[100:103]
 s_add_u32 m0, s49, 3968
 v_mfma_f32_16x16x32_bf16 v[108:111], a[92:95], v[60:63], v[108:111]
 buffer_load_dwordx4 v10, s[8:11], s46 offen offset:128  lds
 v_mfma_f32_16x16x32_bf16 v[116:119], v[60:63], a[164:167], v[116:119]
 v_mfma_f32_16x16x32_bf16 v[124:127], v[60:63], a[236:239], v[124:127]
 s_waitcnt lgkmcnt(2)
 v_mfma_f32_16x16x32_bf16 v[96:99], a[24:27], v[32:35], v[96:99]
 ds_read_b128 v[48:51], v6 offset:16384
 v_mfma_f32_16x16x32_bf16 v[104:107], a[96:99], v[32:35], v[104:107]
 ds_read_b128 v[52:55], v6 offset:18432
 v_mfma_f32_16x16x32_bf16 v[112:115], v[32:35], a[168:171], v[112:115]
 s_add_u32 m0, s49, 7936
 v_mfma_f32_16x16x32_bf16 v[120:123], v[32:35], a[240:243], v[120:123]
 buffer_load_dwordx4 v10, s[8:11], s46 offen offset:256  lds
 v_mfma_f32_16x16x32_bf16 v[100:103], a[24:27], v[36:39], v[100:103]
 s_add_u32 m0, s49, 11904
 v_mfma_f32_16x16x32_bf16 v[108:111], a[96:99], v[36:39], v[108:111]
 buffer_load_dwordx4 v10, s[8:11], s46 offen offset:384  lds
 v_mfma_f32_16x16x32_bf16 v[116:119], v[36:39], a[168:171], v[116:119]
 v_mfma_f32_16x16x32_bf16 v[124:127], v[36:39], a[240:243], v[124:127]
 s_waitcnt lgkmcnt(2)
 v_mfma_f32_16x16x32_bf16 v[96:99], a[28:31], v[40:43], v[96:99]
 ds_read_b128 v[56:59], v7 offset:16384
 v_mfma_f32_16x16x32_bf16 v[104:107], a[100:103], v[40:43], v[104:107]
 ds_read_b128 v[60:63], v7 offset:18432
 v_mfma_f32_16x16x32_bf16 v[112:115], v[40:43], a[172:175], v[112:115]
 s_add_u32 m0, s49, 15872
 v_mfma_f32_16x16x32_bf16 v[120:123], v[40:43], a[244:247], v[120:123]
 buffer_load_dwordx4 v10, s[8:11], s46 offen offset:512  lds
 v_mfma_f32_16x16x32_bf16 v[100:103], a[28:31], v[44:47], v[100:103]
 s_add_u32 m0, s49, 19840
 v_mfma_f32_16x16x32_bf16 v[108:111], a[100:103], v[44:47], v[108:111]
 buffer_load_dwordx4 v10, s[8:11], s46 offen offset:640  lds
 v_mfma_f32_16x16x32_bf16 v[116:119], v[44:47], a[172:175], v[116:119]
 v_mfma_f32_16x16x32_bf16 v[124:127], v[44:47], a[244:247], v[124:127]
 s_waitcnt lgkmcnt(2)
 v_mfma_f32_16x16x32_bf16 v[96:99], a[32:35], v[48:51], v[96:99]
 ds_read_b128 v[32:35], v6 offset:20480
 v_mfma_f32_16x16x32_bf16 v[104:107], a[104:107], v[48:51], v[104:107]
 ds_read_b128 v[36:39], v6 offset:22528
 v_mfma_f32_16x16x32_bf16 v[112:115], v[48:51], a[176:179], v[112:115]
 s_add_u32 m0, s49, 23808
 v_mfma_f32_16x16x32_bf16 v[120:123], v[48:51], a[248:251], v[120:123]
 buffer_load_dwordx4 v10, s[8:11], s46 offen offset:768  lds
 v_mfma_f32_16x16x32_bf16 v[100:103], a[32:35], v[52:55], v[100:103]
 s_add_u32 m0, s49, 27776
 v_mfma_f32_16x16x32_bf16 v[108:111], a[104:107], v[52:55], v[108:111]
 buffer_load_dwordx4 v10, s[8:11], s46 offen offset:896  lds
 v_mfma_f32_16x16x32_bf16 v[116:119], v[52:55], a[176:179], v[116:119]
 v_mfma_f32_16x16x32_bf16 v[124:127], v[52:55], a[248:251], v[124:127]
 s_waitcnt lgkmcnt(2)
 v_mfma_f32_16x16x32_bf16 v[96:99], a[36:39], v[56:59], v[96:99]
 ds_read_b128 v[40:43], v7 offset:20480
 v_mfma_f32_16x16x32_bf16 v[104:107], a[108:111], v[56:59], v[104:107]
 ds_read_b128 v[44:47], v7 offset:22528
 v_mfma_f32_16x16x32_bf16 v[112:115], v[56:59], a[180:183], v[112:115]
 s_add_u32 m0, s49, 31744
 v_mfma_f32_16x16x32_bf16 v[120:123], v[56:59], a[252:255], v[120:123]
 buffer_load_dwordx4 v10, s[8:11], s46 offen offset:1024  lds
 v_mfma_f32_16x16x32_bf16 v[100:103], a[36:39], v[60:63], v[100:103]
 v_add_u32 v2, s46, v1
 v_mfma_f32_16x16x32_bf16 v[108:111], a[108:111], v[60:63], v[108:111]
 buffer_load_dword v15, v2, s[8:11], 0 offen
 v_mfma_f32_16x16x32_bf16 v[116:119], v[60:63], a[180:183], v[116:119]
 v_mfma_f32_16x16x32_bf16 v[124:127], v[60:63], a[252:255], v[124:127]
 s_waitcnt lgkmcnt(2)
 v_mfma_f32_16x16x32_bf16 v[96:99], a[40:43], v[32:35], v[96:99]
 ds_read_b128 v[48:51], v6 offset:24576
 v_mfma_f32_16x16x32_bf16 v[104:107], a[112:115], v[32:35], v[104:107]
 ds_read_b128 v[52:55], v6 offset:26624
 v_mfma_f32_16x16x32_bf16 v[112:115], v[32:35], a[184:187], v[112:115]
 v_mfma_f32_16x16x32_bf16 v[120:123], v[32:35], v[224:227], v[120:123]
 v_mfma_f32_16x16x32_bf16 v[100:103], a[40:43], v[36:39], v[100:103]
 v_mfma_f32_16x16x32_bf16 v[108:111], a[112:115], v[36:39], v[108:111]
 v_mfma_f32_16x16x32_bf16 v[116:119], v[36:39], a[184:187], v[116:119]
 v_mfma_f32_16x16x32_bf16 v[124:127], v[36:39], v[224:227], v[124:127]
 s_waitcnt lgkmcnt(2)
 v_mfma_f32_16x16x32_bf16 v[96:99], a[44:47], v[40:43], v[96:99]
 ds_read_b128 v[56:59], v7 offset:24576
 v_mfma_f32_16x16x32_bf16 v[104:107], a[116:119], v[40:43], v[104:107]
 ds_read_b128 v[60:63], v7 offset:26624
 v_mfma_f32_16x16x32_bf16 v[112:115], v[40:43], a[188:191], v[112:115]
 v_mfma_f32_16x16x32_bf16 v[120:123], v[40:43], v[228:231], v[120:123]
 v_mfma_f32_16x16x32_bf16 v[100:103], a[44:47], v[44:47], v[100:103]
 v_mfma_f32_16x16x32_bf16 v[108:111], a[116:119], v[44:47], v[108:111]
 v_mfma_f32_16x16x32_bf16 v[116:119], v[44:47], a[188:191], v[116:119]
 v_mfma_f32_16x16x32_bf16 v[124:127], v[44:47], v[228:231], v[124:127]
 s_waitcnt lgkmcnt(2)
 v_mfma_f32_16x16x32_bf16 v[96:99], a[48:51], v[48:51], v[96:99]
 ds_read_b128 v[32:35], v6 offset:28672
 v_mfma_f32_16x16x32_bf16 v[104:107], a[120:123], v[48:51], v[104:107]
 ds_read_b128 v[36:39], v6 offset:30720
 v_mfma_f32_16x16x32_bf16 v[112:115], v[48:51], a[192:195], v[112:115]
 v_mfma_f32_16x16x32_bf16 v[120:123], v[48:51], v[232:235], v[120:123]
 v_mfma_f32_16x16x32_bf16 v[100:103], a[48:51], v[52:55], v[100:103]
 v_mfma_f32_16x16x32_bf16 v[108:111], a[120:123], v[52:55], v[108:111]
 v_mfma_f32_16x16x32_bf16 v[116:119], v[52:55], a[192:195], v[116:119]
 v_mfma_f32_16x16x32_bf16 v[124:127], v[52:55], v[232:235], v[124:127]
 s_waitcnt lgkmcnt(2)
 v_mfma_f32_16x16x32_bf16 v[96:99], a[52:55], v[56:59], v[96:99]
 ds_read_b128 v[40:43], v7 offset:28672
 v_mfma_f32_16x16x32_bf16 v[104:107], a[124:127], v[56:59], v[104:107]
 ds_read_b128 v[44:47], v7 offset:30720
 v_mfma_f32_16x16x32_bf16 v[112:115], v[56:59], a[196:199], v[112:115]
 s_add_u32 s43, s43, 36864
 s_cmp_eq_u32 s43, 147456
 v_mfma_f32_16x16x32_bf16 v[120:123], v[56:59], v[236:239], v[120:123]
 s_cselect_b32 s43, 0, s43
 s_add_u32 s44, s44, 36864
 v_mfma_f32_16x16x32_bf16 v[100:103], a[52:55], v[60:63], v[100:103]
 s_cmp_eq_u32 s44, 147456
 s_cselect_b32 s44, 0, s44
 v_mfma_f32_16x16x32_bf16 v[108:111], a[124:127], v[60:63], v[108:111]
 v_mfma_f32_16x16x32_bf16 v[116:119], v[60:63], a[196:199], v[116:119]
 v_mfma_f32_16x16x32_bf16 v[124:127], v[60:63], v[236:239], v[124:127]
 s_waitcnt lgkmcnt(2)
 v_mfma_f32_16x16x32_bf16 v[96:99], a[56:59], v[32:35], v[96:99]
 ds_read_b128 v[48:51], v6 offset:32768
 v_mfma_f32_16x16x32_bf16 v[104:107], a[128:131], v[32:35], v[104:107]
 ds_read_b128 v[52:55], v6 offset:34816
 v_mfma_f32_16x16x32_bf16 v[112:115], v[32:35], a[200:203], v[112:115]
 v_add_u32 v6, s43, v4
 v_mfma_f32_16x16x32_bf16 v[120:123], v[32:35], v[240:243], v[120:123]
 v_mfma_f32_16x16x32_bf16 v[100:103], a[56:59], v[36:39], v[100:103]
 v_mfma_f32_16x16x32_bf16 v[108:111], a[128:131], v[36:39], v[108:111]
 v_mfma_f32_16x16x32_bf16 v[116:119], v[36:39], a[200:203], v[116:119]
 v_mfma_f32_16x16x32_bf16 v[124:127], v[36:39], v[240:243], v[124:127]
 s_waitcnt lgkmcnt(2)
 v_mfma_f32_16x16x32_bf16 v[96:99], a[60:63], v[40:43], v[96:99]
 ds_read_b128 v[56:59], v7 offset:32768
 v_mfma_f32_16x16x32_bf16 v[104:107], a[132:135], v[40:43], v[104:107]
 ds_read_b128 v[60:63], v7 offset:34816
 v_mfma_f32_16x16x32_bf16 v[112:115], v[40:43], a[204:207], v[112:115]
 v_add_u32 v7, s43, v5
 v_mfma_f32_16x16x32_bf16 v[120:123], v[40:43], v[244:247], v[120:123]
 v_mfma_f32_16x16x32_bf16 v[100:103], a[60:63], v[44:47], v[100:103]
 v_mfma_f32_16x16x32_bf16 v[108:111], a[132:135], v[44:47], v[108:111]
 v_mfma_f32_16x16x32_bf16 v[116:119], v[44:47], a[204:207], v[116:119]
 v_mfma_f32_16x16x32_bf16 v[124:127], v[44:47], v[244:247], v[124:127]
 s_waitcnt lgkmcnt(2)
 v_mfma_f32_16x16x32_bf16 v[96:99], a[64:67], v[48:51], v[96:99]
 s_waitcnt vmcnt(10)
 s_barrier
 ds_read_b128 v[32:35], v6 offset:0
 v_mfma_f32_16x16x32_bf16 v[104:107], a[136:139], v[48:51], v[104:107]
 ds_read_b128 v[36:39], v6 offset:2048
 v_mfma_f32_16x16x32_bf16 v[112:115], v[48:51], a[208:211], v[112:115]
 buffer_store_dword v14, v13, s[20:23], 0 offen sc1
 v_mfma_f32_16x16x32_bf16 v[120:123], v[48:51], v[248:251], v[120:123]
 v_mfma_f32_16x16x32_bf16 v[100:103], a[64:67], v[52:55], v[100:103]
 v_mfma_f32_16x16x32_bf16 v[108:111], a[136:139], v[52:55], v[108:111]
 v_mfma_f32_16x16x32_bf16 v[116:119], v[52:55], a[208:211], v[116:119]
 v_mfma_f32_16x16x32_bf16 v[124:127], v[52:55], v[248:251], v[124:127]
 s_waitcnt lgkmcnt(2)
 v_mfma_f32_16x16x32_bf16 v[96:99], a[68:71], v[56:59], v[96:99]
 ds_read_b128 v[40:43], v7 offset:0
 v_mfma_f32_16x16x32_bf16 v[104:107], a[140:143], v[56:59], v[104:107]
 ds_read_b128 v[44:47], v7 offset:2048
 v_mfma_f32_16x16x32_bf16 v[112:115], v[56:59], a[212:215], v[112:115]
 s_mul_i32 s45, s39, 524288
 s_add_u32 s47, s34, s45
 v_mfma_f32_16x16x32_bf16 v[120:123], v[56:59], v[252:255], v[120:123]
 s_add_u32 s48, s35, s45
 v_add_u32 v14, 1, v14
 v_mfma_f32_16x16x32_bf16 v[100:103], a[68:71], v[60:63], v[100:103]
 s_mov_b32 s39, s40
 s_mov_b32 s40, s41
 v_mfma_f32_16x16x32_bf16 v[108:111], a[140:143], v[60:63], v[108:111]
 s_add_u32 s42, s42, 1
 s_cmp_lt_u32 s42, s36
 v_mfma_f32_16x16x32_bf16 v[116:119], v[60:63], a[212:215], v[116:119]
 v_mfma_f32_16x16x32_bf16 v[124:127], v[60:63], v[252:255], v[124:127]
 s_waitcnt lgkmcnt(2)
 s_cbranch_scc1 Lps_loop_28
 s_nop 7
 v_mul_f32 v96, s50, v96
 v_mul_f32 v97, s50, v97
 v_mul_f32 v98, s50, v98
 v_mul_f32 v99, s50, v99
 v_mul_f32 v104, s50, v104
 v_mul_f32 v105, s50, v105
 v_mul_f32 v106, s50, v106
 v_mul_f32 v107, s50, v107
 v_cvt_pk_bf16_f32 v16, v96, v104
 v_cvt_pk_bf16_f32 v17, v97, v105
 v_cvt_pk_bf16_f32 v18, v98, v106
 v_cvt_pk_bf16_f32 v19, v99, v107
 buffer_store_dwordx4 v[16:19], v12, s[20:23], s47 offen offset:0 sc1
 v_mul_f32 v100, s50, v100
 v_mul_f32 v101, s50, v101
 v_mul_f32 v102, s50, v102
 v_mul_f32 v103, s50, v103
 v_mul_f32 v108, s50, v108
 v_mul_f32 v109, s50, v109
 v_mul_f32 v110, s50, v110
 v_mul_f32 v111, s50, v111
 v_cvt_pk_bf16_f32 v20, v100, v108
 v_cvt_pk_bf16_f32 v21, v101, v109
 v_cvt_pk_bf16_f32 v22, v102, v110
 v_cvt_pk_bf16_f32 v23, v103, v111
 buffer_store_dwordx4 v[20:23], v12, s[20:23], s47 offen offset:1024 sc1
 v_cvt_pk_bf16_f32 v24, v112, v113
 v_cvt_pk_bf16_f32 v25, v116, v117
 v_cvt_pk_bf16_f32 v26, v114, v115
 v_cvt_pk_bf16_f32 v27, v118, v119
 buffer_store_dwordx4 v[24:27], v12, s[20:23], s48 offen offset:0 sc1
 v_cvt_pk_bf16_f32 v28, v120, v121
 v_cvt_pk_bf16_f32 v29, v124, v125
 v_cvt_pk_bf16_f32 v30, v122, v123
 v_cvt_pk_bf16_f32 v31, v126, v127
 buffer_store_dwordx4 v[28:31], v12, s[20:23], s48 offen offset:1024 sc1
 s_waitcnt vmcnt(0) lgkmcnt(0)
 s_barrier
 v_mov_b32 v14, s36
 buffer_store_dword v14, v13, s[20:23], 0 offen sc1
 s_cmp_ge_u32 s6, 25
 s_cbranch_scc1 Lfin
 s_mov_b32 s3, 2
 s_branch Lqb
Lqa:
 s_load_dwordx2 s[8:9], s[0:1], 0
 s_mov_b32 s10, 0x240000
 s_mov_b32 s11, 0x20000
 s_load_dwordx2 s[12:13], s[0:1], 16
 s_mov_b32 s14, 0x480000
 s_mov_b32 s15, 0x20000
 s_load_dwordx2 s[16:17], s[0:1], 16
 s_mov_b32 s18, 0x480000
 s_mov_b32 s19, 0x20000
 s_lshl_b32 s7, s5, 5
 s_add_u32 s7, s7, s6
 s_cmp_eq_u32 s7, 127
 s_cbranch_scc0 Lqa1
Lrh_29:
 v_mbcnt_lo_u32_b32 v5, -1, 0
 v_min_u32 v5, 1, v5
 v_lshlrev_b32 v5, 28, v5
 buffer_load_dword v4, v5, s[28:31], 0 offen offset:4 sc1
 s_waitcnt vmcnt(0)
Lrhc_30:
 v_readfirstlane_b32 s89, v4
 s_cmp_eq_u32 s89, s88
 s_cbranch_scc1 Lrhk_31
 s_cmp_lg_u32 s89, 0
 s_cbranch_scc1 Lredo
 s_sub_u32 s95, s95, 1
 s_cbranch_scc0 Lrh_29
 s_endpgm
Lrhk_31:
 v_mov_b32 v4, 0
 v_mov_b32 v5, 0
 v_mov_b32 v6, 0
 v_mov_b32 v7, 0
 v_lshlrev_b32 v1, 4, v0
 s_mov_b32 s7, 0
 buffer_store_dwordx4 v[4:7], v1, s[20:23], s7 offen sc1
 s_mov_b32 s7, 4096
 buffer_store_dwordx4 v[4:7], v1, s[20:23], s7 offen sc1
 s_mov_b32 s7, 8192
 buffer_store_dwordx4 v[4:7], v1, s[20:23], s7 offen sc1
 s_mov_b32 s7, 12288
 buffer_store_dwordx4 v[4:7], v1, s[20:23], s7 offen sc1
 s_mov_b32 s7, 16384
 buffer_store_dwordx4 v[4:7], v1, s[20:23], s7 offen sc1
 v_min_u32 v1, 1, v0
 v_lshlrev_b32 v1, 28, v1
 v_mov_b32 v2, 1
 s_waitcnt vmcnt(0)
 s_barrier
 buffer_store_dword v2, v1, s[28:31], 0 offen sc1
Lqa1:
 s_sub_u32 s3, s5, 2
 s_lshl_b32 s3, s3, 3
 s_lshr_b32 s7, s6, 2
 s_add_u32 s3, s3, s7
 s_lshl_b32 s32, s3, 9
 s_add_u32 s33, s32, 256
 s_lshl_b32 s34, s3, 14
 s_add_u32 s34, s34, 0x5000000
 s_add_u32 s35, s34, 8192
 s_mov_b32 s36, 16
 s_and_b32 s37, s6, 3
 s_lshl_b32 s7, s3, 5
 s_add_u32 s7, s7, s37
 s_lshl_b32 s7, s7, 2
 s_add_u32 s7, s7, 0x3000
 v_min_u32 v1, 1, v0
 v_lshlrev_b32 v1, 28, v1
 v_add_u32 v13, s7, v1
 s_waitcnt lgkmcnt(0)
 v_and_b32 v1, 63, v0
 v_lshrrev_b32 v2, 3, v0
 v_mul_u32_u24 v10, 1152, v2
 v_lshrrev_b32 v2, 4, v0
 v_xor_b32 v2, v2, v0
 v_and_b32 v2, 7, v2
 v_lshl_add_u32 v10, v2, 4, v10
 v_lshrrev_b32 v2, 4, v1
 v_bfe_u32 v3, v1, 1, 3
 v_xor_b32 v2, v2, v3
 v_and_b32 v3, 15, v1
 v_lshlrev_b32 v3, 7, v3
 v_lshl_add_u32 v4, v2, 4, v3
 v_xor_b32 v5, 64, v4
 v_lshrrev_b32 v2, 4, v0
 v_lshlrev_b32 v11, 13, v2
 v_lshrrev_b32 v2, 7, v0
 v_lshrrev_b32 v3, 4, v1
 v_lshl_add_u32 v3, v2, 2, v3
 v_bfe_u32 v2, v1, 1, 3
 v_xor_b32 v2, v2, v3
 v_lshl_add_u32 v11, v2, 5, v11
 v_and_b32 v2, 1, v1
 v_lshl_add_u32 v11, v2, 4, v11
 v_bfe_u32 v2, v1, 2, 3
 v_xor_b32 v3, s4, v2
 v_lshlrev_b32 v3, 5, v3
 v_and_b32 v2, 3, v2
 v_lshl_add_u32 v3, v2, 8, v3
 v_lshrrev_b32 v2, 4, v1
 v_lshl_add_u32 v3, v2, 11, v3
 v_and_b32 v2, 3, v1
 v_lshl_add_u32 v3, v2, 3, v3
 v_add_u32 v8, 73728, v3
 v_xor_b32 v3, 0x80, v3
 v_add_u32 v9, 73728, v3
 s_lshl_b32 s45, s4, 11
 v_lshl_add_u32 v12, v1, 4, s45
 s_mov_b32 s39, s37
 s_add_u32 s40, s39, 4
 s_min_u32 s40, s40, 63
 s_lshl_b32 s49, s4, 10
 s_mul_i32 s46, s39, 36864
 s_add_u32 m0, s49, 0
 s_nop 0
 buffer_load_dwordx4 v10, s[8:11], s46 offen offset:0  lds
 s_add_u32 m0, s49, 3968
 s_nop 0
 buffer_load_dwordx4 v10, s[8:11], s46 offen offset:128  lds
 s_add_u32 m0, s49, 7936
 s_nop 0
 buffer_load_dwordx4 v10, s[8:11], s46 offen offset:256  lds
 s_add_u32 m0, s49, 11904
 s_nop 0
 buffer_load_dwordx4 v10, s[8:11], s46 offen offset:384  lds
 s_add_u32 m0, s49, 15872
 s_nop 0
 buffer_load_dwordx4 v10, s[8:11], s46 offen offset:512  lds
 s_add_u32 m0, s49, 19840
 s_nop 0
 buffer_load_dwordx4 v10, s[8:11], s46 offen offset:640  lds
 s_add_u32 m0, s49, 23808
 s_nop 0
 buffer_load_dwordx4 v10, s[8:11], s46 offen offset:768  lds
 s_add_u32 m0, s49, 27776
 s_nop 0
 buffer_load_dwordx4 v10, s[8:11], s46 offen offset:896  lds
 s_add_u32 m0, s49, 31744
 s_nop 0
 buffer_load_dwordx4 v10, s[8:11], s46 offen offset:1024  lds
 s_lshl_b32 s49, s4, 10
 s_add_u32 s49, s49, 36864
 s_mul_i32 s46, s40, 36864
 s_add_u32 m0, s49, 0
 s_nop 0
 buffer_load_dwordx4 v10, s[8:11], s46 offen offset:0  lds
 s_add_u32 m0, s49, 3968
 s_nop 0
 buffer_load_dwordx4 v10, s[8:11], s46 offen offset:128  lds
 s_add_u32 m0, s49, 7936
 s_nop 0
 buffer_load_dwordx4 v10, s[8:11], s46 offen offset:256  lds
 s_add_u32 m0, s49, 11904
 s_nop 0
 buffer_load_dwordx4 v10, s[8:11], s46 offen offset:384  lds
 s_add_u32 m0, s49, 15872
 s_nop 0
 buffer_load_dwordx4 v10, s[8:11], s46 offen offset:512  lds
 s_add_u32 m0, s49, 19840
 s_nop 0
 buffer_load_dwordx4 v10, s[8:11], s46 offen offset:640  lds
 s_add_u32 m0, s49, 23808
 s_nop 0
 buffer_load_dwordx4 v10, s[8:11], s46 offen offset:768  lds
 s_add_u32 m0, s49, 27776
 s_nop 0
 buffer_load_dwordx4 v10, s[8:11], s46 offen offset:896  lds
 s_add_u32 m0, s49, 31744
 s_nop 0
 buffer_load_dwordx4 v10, s[8:11], s46 offen offset:1024  lds
 s_lshl_b32 s49, s4, 10
 s_add_u32 m0, s49, 73728
 s_add_u32 s45, s32, 0
 buffer_load_dwordx4 v11, s[12:15], s45 offen  lds
 s_add_u32 m0, s49, 77824
 s_add_u32 s45, s32, 131072
 buffer_load_dwordx4 v11, s[12:15], s45 offen  lds
 s_add_u32 m0, s49, 81920
 s_add_u32 s45, s33, 0
 buffer_load_dwordx4 v11, s[16:19], s45 offen  lds
 s_add_u32 m0, s49, 86016
 s_add_u32 s45, s33, 131072
 buffer_load_dwordx4 v11, s[16:19], s45 offen  lds
 s_add_u32 m0, s49, 90112
 s_add_u32 s45, s32, 262144
 buffer_load_dwordx4 v11, s[12:15], s45 offen  lds
 s_add_u32 m0, s49, 94208
 s_add_u32 s45, s32, 393216
 buffer_load_dwordx4 v11, s[12:15], s45 offen  lds
 s_add_u32 m0, s49, 98304
 s_add_u32 s45, s33, 262144
 buffer_load_dwordx4 v11, s[16:19], s45 offen  lds
 s_add_u32 m0, s49, 102400
 s_add_u32 s45, s33, 393216
 buffer_load_dwordx4 v11, s[16:19], s45 offen  lds
 s_add_u32 m0, s49, 106496
 s_add_u32 s45, s32, 524288
 buffer_load_dwordx4 v11, s[12:15], s45 offen  lds
 s_add_u32 m0, s49, 110592
 s_add_u32 s45, s32, 655360
 buffer_load_dwordx4 v11, s[12:15], s45 offen  lds
 s_add_u32 m0, s49, 114688
 s_add_u32 s45, s33, 524288
 buffer_load_dwordx4 v11, s[16:19], s45 offen  lds
 s_add_u32 m0, s49, 118784
 s_add_u32 s45, s33, 655360
 buffer_load_dwordx4 v11, s[16:19], s45 offen  lds
 s_waitcnt vmcnt(8) lgkmcnt(0)
 s_barrier
 s_add_u32 m0, s49, 122880
 s_add_u32 s45, s32, 786432
 buffer_load_dwordx4 v11, s[12:15], s45 offen  lds
 s_add_u32 m0, s49, 126976
 s_add_u32 s45, s32, 917504
 buffer_load_dwordx4 v11, s[12:15], s45 offen  lds
 s_add_u32 m0, s49, 131072
 s_add_u32 s45, s33, 786432
 buffer_load_dwordx4 v11, s[16:19], s45 offen  lds
 s_add_u32 m0, s49, 135168
 s_add_u32 s45, s33, 917504
 buffer_load_dwordx4 v11, s[16:19], s45 offen  lds
 ds_read_b64_tr_b16 a[0:1], v8 offset:0
 ds_read_b64_tr_b16 a[2:3], v8 offset:1024
 ds_read_b64_tr_b16 a[72:73], v9 offset:0
 ds_read_b64_tr_b16 a[74:75], v9 offset:1024
 ds_read_b64_tr_b16 a[144:145], v8 offset:8192
 ds_read_b64_tr_b16 a[146:147], v8 offset:9216
 ds_read_b64_tr_b16 a[216:217], v9 offset:8192
 ds_read_b64_tr_b16 a[218:219], v9 offset:9216
 s_waitcnt vmcnt(8) lgkmcnt(0)
 s_barrier
 s_add_u32 m0, s49, 73728
 s_add_u32 s45, s32, 1048576
 buffer_load_dwordx4 v11, s[12:15], s45 offen  lds
 s_add_u32 m0, s49, 77824
 s_add_u32 s45, s32, 1179648
 buffer_load_dwordx4 v11, s[12:15], s45 offen  lds
 s_add_u32 m0, s49, 81920
 s_add_u32 s45, s33, 1048576
 buffer_load_dwordx4 v11, s[16:19], s45 offen  lds
 s_add_u32 m0, s49, 86016
 s_add_u32 s45, s33, 1179648
 buffer_load_dwordx4 v11, s[16:19], s45 offen  lds
 ds_read_b64_tr_b16 a[4:5], v8 offset:16384
 ds_read_b64_tr_b16 a[6:7], v8 offset:17408
 ds_read_b64_tr_b16 a[76:77], v9 offset:16384
 ds_read_b64_tr_b16 a[78:79], v9 offset:17408
 ds_read_b64_tr_b16 a[148:149], v8 offset:24576
 ds_read_b64_tr_b16 a[150:151], v8 offset:25600
 ds_read_b64_tr_b16 a[220:221], v9 offset:24576
 ds_read_b64_tr_b16 a[222:223], v9 offset:25600
 s_waitcnt vmcnt(8) lgkmcnt(0)
 s_barrier
 s_add_u32 m0, s49, 90112
 s_add_u32 s45, s32, 1310720
 buffer_load_dwordx4 v11, s[12:15], s45 offen  lds
 s_add_u32 m0, s49, 94208
 s_add_u32 s45, s32, 1441792
 buffer_load_dwordx4 v11, s[12:15], s45 offen  lds
 s_add_u32 m0, s49, 98304
 s_add_u32 s45, s33, 1310720
 buffer_load_dwordx4 v11, s[16:19], s45 offen  lds
 s_add_u32 m0, s49, 102400
 s_add_u32 s45, s33, 1441792
 buffer_load_dwordx4 v11, s[16:19], s45 offen  lds
 ds_read_b64_tr_b16 a[8:9], v8 offset:32768
 ds_read_b64_tr_b16 a[10:11], v8 offset:33792
 ds_read_b64_tr_b16 a[80:81], v9 offset:32768
 ds_read_b64_tr_b16 a[82:83], v9 offset:33792
 ds_read_b64_tr_b16 a[152:153], v8 offset:40960
 ds_read_b64_tr_b16 a[154:155], v8 offset:41984
 ds_read_b64_tr_b16 a[224:225], v9 offset:40960
 ds_read_b64_tr_b16 a[226:227], v9 offset:41984
 s_waitcnt vmcnt(8) lgkmcnt(0)
 s_barrier
 s_add_u32 m0, s49, 106496
 s_add_u32 s45, s32, 1572864
 buffer_load_dwordx4 v11, s[12:15], s45 offen  lds
 s_add_u32 m0, s49, 110592
 s_add_u32 s45, s32, 1703936
 buffer_load_dwordx4 v11, s[12:15], s45 offen  lds
 s_add_u32 m0, s49, 114688
 s_add_u32 s45, s33, 1572864
 buffer_load_dwordx4 v11, s[16:19], s45 offen  lds
 s_add_u32 m0, s49, 118784
 s_add_u32 s45, s33, 1703936
 buffer_load_dwordx4 v11, s[16:19], s45 offen  lds
 ds_read_b64_tr_b16 a[12:13], v8 offset:49152
 ds_read_b64_tr_b16 a[14:15], v8 offset:50176
 ds_read_b64_tr_b16 a[84:85], v9 offset:49152
 ds_read_b64_tr_b16 a[86:87], v9 offset:50176
 ds_read_b64_tr_b16 a[156:157], v8 offset:57344
 ds_read_b64_tr_b16 a[158:159], v8 offset:58368
 ds_read_b64_tr_b16 a[228:229], v9 offset:57344
 ds_read_b64_tr_b16 a[230:231], v9 offset:58368
 s_waitcnt vmcnt(8) lgkmcnt(0)
 s_barrier
 s_add_u32 m0, s49, 122880
 s_add_u32 s45, s32, 1835008
 buffer_load_dwordx4 v11, s[12:15], s45 offen  lds
 s_add_u32 m0, s49, 126976
 s_add_u32 s45, s32, 1966080
 buffer_load_dwordx4 v11, s[12:15], s45 offen  lds
 s_add_u32 m0, s49, 131072
 s_add_u32 s45, s33, 1835008
 buffer_load_dwordx4 v11, s[16:19], s45 offen  lds
 s_add_u32 m0, s49, 135168
 s_add_u32 s45, s33, 1966080
 buffer_load_dwordx4 v11, s[16:19], s45 offen  lds
 ds_read_b64_tr_b16 a[16:17], v8 offset:0
 ds_read_b64_tr_b16 a[18:19], v8 offset:1024
 ds_read_b64_tr_b16 a[88:89], v9 offset:0
 ds_read_b64_tr_b16 a[90:91], v9 offset:1024
 ds_read_b64_tr_b16 a[160:161], v8 offset:8192
 ds_read_b64_tr_b16 a[162:163], v8 offset:9216
 ds_read_b64_tr_b16 a[232:233], v9 offset:8192
 ds_read_b64_tr_b16 a[234:235], v9 offset:9216
 s_waitcnt vmcnt(8) lgkmcnt(0)
 s_barrier
 s_add_u32 m0, s49, 73728
 s_add_u32 s45, s32, 2097152
 buffer_load_dwordx4 v11, s[12:15], s45 offen  lds
 s_add_u32 m0, s49, 77824
 s_add_u32 s45, s32, 2228224
 buffer_load_dwordx4 v11, s[12:15], s45 offen  lds
 s_add_u32 m0, s49, 81920
 s_add_u32 s45, s33, 2097152
 buffer_load_dwordx4 v11, s[16:19], s45 offen  lds
 s_add_u32 m0, s49, 86016
 s_add_u32 s45, s33, 2228224
 buffer_load_dwordx4 v11, s[16:19], s45 offen  lds
 ds_read_b64_tr_b16 a[20:21], v8 offset:16384
 ds_read_b64_tr_b16 a[22:23], v8 offset:17408
 ds_read_b64_tr_b16 a[92:93], v9 offset:16384
 ds_read_b64_tr_b16 a[94:95], v9 offset:17408
 ds_read_b64_tr_b16 a[164:165], v8 offset:24576
 ds_read_b64_tr_b16 a[166:167], v8 offset:25600
 ds_read_b64_tr_b16 a[236:237], v9 offset:24576
 ds_read_b64_tr_b16 a[238:239], v9 offset:25600
 s_waitcnt vmcnt(8) lgkmcnt(0)
 s_barrier
 s_add_u32 m0, s49, 90112
 s_add_u32 s45, s32, 2359296
 buffer_load_dwordx4 v11, s[12:15], s45 offen  lds
 s_add_u32 m0, s49, 94208
 s_add_u32 s45, s32, 2490368
 buffer_load_dwordx4 v11, s[12:15], s45 offen  lds
 s_add_u32 m0, s49, 98304
 s_add_u32 s45, s33, 2359296
 buffer_load_dwordx4 v11, s[16:19], s45 offen  lds
 s_add_u32 m0, s49, 102400
 s_add_u32 s45, s33, 2490368
 buffer_load_dwordx4 v11, s[16:19], s45 offen  lds
 ds_read_b64_tr_b16 a[24:25], v8 offset:32768
 ds_read_b64_tr_b16 a[26:27], v8 offset:33792
 ds_read_b64_tr_b16 a[96:97], v9 offset:32768
 ds_read_b64_tr_b16 a[98:99], v9 offset:33792
 ds_read_b64_tr_b16 a[168:169], v8 offset:40960
 ds_read_b64_tr_b16 a[170:171], v8 offset:41984
 ds_read_b64_tr_b16 a[240:241], v9 offset:40960
 ds_read_b64_tr_b16 a[242:243], v9 offset:41984
 s_waitcnt vmcnt(8) lgkmcnt(0)
 s_barrier
 s_add_u32 m0, s49, 106496
 s_add_u32 s45, s32, 2621440
 buffer_load_dwordx4 v11, s[12:15], s45 offen  lds
 s_add_u32 m0, s49, 110592
 s_add_u32 s45, s32, 2752512
 buffer_load_dwordx4 v11, s[12:15], s45 offen  lds
 s_add_u32 m0, s49, 114688
 s_add_u32 s45, s33, 2621440
 buffer_load_dwordx4 v11, s[16:19], s45 offen  lds
 s_add_u32 m0, s49, 118784
 s_add_u32 s45, s33, 2752512
 buffer_load_dwordx4 v11, s[16:19], s45 offen  lds
 ds_read_b64_tr_b16 a[28:29], v8 offset:49152
 ds_read_b64_tr_b16 a[30:31], v8 offset:50176
 ds_read_b64_tr_b16 a[100:101], v9 offset:49152
 ds_read_b64_tr_b16 a[102:103], v9 offset:50176
 ds_read_b64_tr_b16 a[172:173], v8 offset:57344
 ds_read_b64_tr_b16 a[174:175], v8 offset:58368
 ds_read_b64_tr_b16 a[244:245], v9 offset:57344
 ds_read_b64_tr_b16 a[246:247], v9 offset:58368
 s_waitcnt vmcnt(8) lgkmcnt(0)
 s_barrier
 s_add_u32 m0, s49, 122880
 s_add_u32 s45, s32, 2883584
 buffer_load_dwordx4 v11, s[12:15], s45 offen  lds
 s_add_u32 m0, s49, 126976
 s_add_u32 s45, s32, 3014656
 buffer_load_dwordx4 v11, s[12:15], s45 offen  lds
 s_add_u32 m0, s49, 131072
 s_add_u32 s45, s33, 2883584
 buffer_load_dwordx4 v11, s[16:19], s45 offen  lds
 s_add_u32 m0, s49, 135168
 s_add_u32 s45, s33, 3014656
 buffer_load_dwordx4 v11, s[16:19], s45 offen  lds
 ds_read_b64_tr_b16 a[32:33], v8 offset:0
 ds_read_b64_tr_b16 a[34:35], v8 offset:1024
 ds_read_b64_tr_b16 a[104:105], v9 offset:0
 ds_read_b64_tr_b16 a[106:107], v9 offset:1024
 ds_read_b64_tr_b16 a[176:177], v8 offset:8192
 ds_read_b64_tr_b16 a[178:179], v8 offset:9216
 ds_read_b64_tr_b16 a[248:249], v9 offset:8192
 ds_read_b64_tr_b16 a[250:251], v9 offset:9216
 s_waitcnt vmcnt(8) lgkmcnt(0)
 s_barrier
 s_add_u32 m0, s49, 73728
 s_add_u32 s45, s32, 3145728
 buffer_load_dwordx4 v11, s[12:15], s45 offen  lds
 s_add_u32 m0, s49, 77824
 s_add_u32 s45, s32, 3276800
 buffer_load_dwordx4 v11, s[12:15], s45 offen  lds
 s_add_u32 m0, s49, 81920
 s_add_u32 s45, s33, 3145728
 buffer_load_dwordx4 v11, s[16:19], s45 offen  lds
 s_add_u32 m0, s49, 86016
 s_add_u32 s45, s33, 3276800
 buffer_load_dwordx4 v11, s[16:19], s45 offen  lds
 ds_read_b64_tr_b16 a[36:37], v8 offset:16384
 ds_read_b64_tr_b16 a[38:39], v8 offset:17408
 ds_read_b64_tr_b16 a[108:109], v9 offset:16384
 ds_read_b64_tr_b16 a[110:111], v9 offset:17408
 ds_read_b64_tr_b16 a[180:181], v8 offset:24576
 ds_read_b64_tr_b16 a[182:183], v8 offset:25600
 ds_read_b64_tr_b16 a[252:253], v9 offset:24576
 ds_read_b64_tr_b16 a[254:255], v9 offset:25600
 s_waitcnt vmcnt(8) lgkmcnt(0)
 s_barrier
 s_add_u32 m0, s49, 90112
 s_add_u32 s45, s32, 3407872
 buffer_load_dwordx4 v11, s[12:15], s45 offen  lds
 s_add_u32 m0, s49, 94208
 s_add_u32 s45, s32, 3538944
 buffer_load_dwordx4 v11, s[12:15], s45 offen  lds
 s_add_u32 m0, s49, 98304
 s_add_u32 s45, s33, 3407872
 buffer_load_dwordx4 v11, s[16:19], s45 offen  lds
 s_add_u32 m0, s49, 102400
 s_add_u32 s45, s33, 3538944
 buffer_load_dwordx4 v11, s[16:19], s45 offen  lds
 ds_read_b64_tr_b16 a[40:41], v8 offset:32768
 ds_read_b64_tr_b16 a[42:43], v8 offset:33792
 ds_read_b64_tr_b16 a[112:113], v9 offset:32768
 ds_read_b64_tr_b16 a[114:115], v9 offset:33792
 ds_read_b64_tr_b16 a[184:185], v8 offset:40960
 ds_read_b64_tr_b16 a[186:187], v8 offset:41984
 ds_read_b64_tr_b16 v[224:225], v9 offset:40960
 ds_read_b64_tr_b16 v[226:227], v9 offset:41984
 s_waitcnt vmcnt(8) lgkmcnt(0)
 s_barrier
 s_add_u32 m0, s49, 106496
 s_add_u32 s45, s32, 3670016
 buffer_load_dwordx4 v11, s[12:15], s45 offen  lds
 s_add_u32 m0, s49, 110592
 s_add_u32 s45, s32, 3801088
 buffer_load_dwordx4 v11, s[12:15], s45 offen  lds
 s_add_u32 m0, s49, 114688
 s_add_u32 s45, s33, 3670016
 buffer_load_dwordx4 v11, s[16:19], s45 offen  lds
 s_add_u32 m0, s49, 118784
 s_add_u32 s45, s33, 3801088
 buffer_load_dwordx4 v11, s[16:19], s45 offen  lds
 ds_read_b64_tr_b16 a[44:45], v8 offset:49152
 ds_read_b64_tr_b16 a[46:47], v8 offset:50176
 ds_read_b64_tr_b16 a[116:117], v9 offset:49152
 ds_read_b64_tr_b16 a[118:119], v9 offset:50176
 ds_read_b64_tr_b16 a[188:189], v8 offset:57344
 ds_read_b64_tr_b16 a[190:191], v8 offset:58368
 ds_read_b64_tr_b16 v[228:229], v9 offset:57344
 ds_read_b64_tr_b16 v[230:231], v9 offset:58368
 s_waitcnt vmcnt(8) lgkmcnt(0)
 s_barrier
 s_add_u32 m0, s49, 122880
 s_add_u32 s45, s32, 3932160
 buffer_load_dwordx4 v11, s[12:15], s45 offen  lds
 s_add_u32 m0, s49, 126976
 s_add_u32 s45, s32, 4063232
 buffer_load_dwordx4 v11, s[12:15], s45 offen  lds
 s_add_u32 m0, s49, 131072
 s_add_u32 s45, s33, 3932160
 buffer_load_dwordx4 v11, s[16:19], s45 offen  lds
 s_add_u32 m0, s49, 135168
 s_add_u32 s45, s33, 4063232
 buffer_load_dwordx4 v11, s[16:19], s45 offen  lds
 ds_read_b64_tr_b16 a[48:49], v8 offset:0
 ds_read_b64_tr_b16 a[50:51], v8 offset:1024
 ds_read_b64_tr_b16 a[120:121], v9 offset:0
 ds_read_b64_tr_b16 a[122:123], v9 offset:1024
 ds_read_b64_tr_b16 a[192:193], v8 offset:8192
 ds_read_b64_tr_b16 a[194:195], v8 offset:9216
 ds_read_b64_tr_b16 v[232:233], v9 offset:8192
 ds_read_b64_tr_b16 v[234:235], v9 offset:9216
 s_waitcnt vmcnt(8) lgkmcnt(0)
 s_barrier
 s_add_u32 m0, s49, 73728
 s_add_u32 s45, s32, 4194304
 buffer_load_dwordx4 v11, s[12:15], s45 offen  lds
 s_add_u32 m0, s49, 77824
 s_add_u32 s45, s32, 4325376
 buffer_load_dwordx4 v11, s[12:15], s45 offen  lds
 s_add_u32 m0, s49, 81920
 s_add_u32 s45, s33, 4194304
 buffer_load_dwordx4 v11, s[16:19], s45 offen  lds
 s_add_u32 m0, s49, 86016
 s_add_u32 s45, s33, 4325376
 buffer_load_dwordx4 v11, s[16:19], s45 offen  lds
 ds_read_b64_tr_b16 a[52:53], v8 offset:16384
 ds_read_b64_tr_b16 a[54:55], v8 offset:17408
 ds_read_b64_tr_b16 a[124:125], v9 offset:16384
 ds_read_b64_tr_b16 a[126:127], v9 offset:17408
 ds_read_b64_tr_b16 a[196:197], v8 offset:24576
 ds_read_b64_tr_b16 a[198:199], v8 offset:25600
 ds_read_b64_tr_b16 v[236:237], v9 offset:24576
 ds_read_b64_tr_b16 v[238:239], v9 offset:25600
 s_waitcnt vmcnt(8) lgkmcnt(0)
 s_barrier
 s_add_u32 m0, s49, 90112
 s_add_u32 s45, s32, 4456448
 buffer_load_dwordx4 v11, s[12:15], s45 offen  lds
 s_add_u32 m0, s49, 94208
 s_add_u32 s45, s32, 4587520
 buffer_load_dwordx4 v11, s[12:15], s45 offen  lds
 s_add_u32 m0, s49, 98304
 s_add_u32 s45, s33, 4456448
 buffer_load_dwordx4 v11, s[16:19], s45 offen  lds
 s_add_u32 m0, s49, 102400
 s_add_u32 s45, s33, 4587520
 buffer_load_dwordx4 v11, s[16:19], s45 offen  lds
 ds_read_b64_tr_b16 a[56:57], v8 offset:32768
 ds_read_b64_tr_b16 a[58:59], v8 offset:33792
 ds_read_b64_tr_b16 a[128:129], v9 offset:32768
 ds_read_b64_tr_b16 a[130:131], v9 offset:33792
 ds_read_b64_tr_b16 a[200:201], v8 offset:40960
 ds_read_b64_tr_b16 a[202:203], v8 offset:41984
 ds_read_b64_tr_b16 v[240:241], v9 offset:40960
 ds_read_b64_tr_b16 v[242:243], v9 offset:41984
 s_waitcnt vmcnt(8) lgkmcnt(0)
 s_barrier
 ds_read_b64_tr_b16 a[60:61], v8 offset:49152
 ds_read_b64_tr_b16 a[62:63], v8 offset:50176
 ds_read_b64_tr_b16 a[132:133], v9 offset:49152
 ds_read_b64_tr_b16 a[134:135], v9 offset:50176
 ds_read_b64_tr_b16 a[204:205], v8 offset:57344
 ds_read_b64_tr_b16 a[206:207], v8 offset:58368
 ds_read_b64_tr_b16 v[244:245], v9 offset:57344
 ds_read_b64_tr_b16 v[246:247], v9 offset:58368
 s_waitcnt vmcnt(4) lgkmcnt(0)
 s_barrier
 ds_read_b64_tr_b16 a[64:65], v8 offset:0
 ds_read_b64_tr_b16 a[66:67], v8 offset:1024
 ds_read_b64_tr_b16 a[136:137], v9 offset:0
 ds_read_b64_tr_b16 a[138:139], v9 offset:1024
 ds_read_b64_tr_b16 a[208:209], v8 offset:8192
 ds_read_b64_tr_b16 a[210:211], v8 offset:9216
 ds_read_b64_tr_b16 v[248:249], v9 offset:8192
 ds_read_b64_tr_b16 v[250:251], v9 offset:9216
 s_waitcnt vmcnt(0) lgkmcnt(0)
 s_barrier
 ds_read_b64_tr_b16 a[68:69], v8 offset:16384
 ds_read_b64_tr_b16 a[70:71], v8 offset:17408
 ds_read_b64_tr_b16 a[140:141], v9 offset:16384
 ds_read_b64_tr_b16 a[142:143], v9 offset:17408
 ds_read_b64_tr_b16 a[212:213], v8 offset:24576
 ds_read_b64_tr_b16 a[214:215], v8 offset:25600
 ds_read_b64_tr_b16 v[252:253], v9 offset:24576
 ds_read_b64_tr_b16 v[254:255], v9 offset:25600
 s_mov_b32 s50, 0x3e0293ee
 s_mov_b32 s42, 0
 s_mov_b32 s43, 0
 s_mov_b32 s44, 73728
 v_mov_b32 v6, v4
 v_mov_b32 v7, v5
Lrh_34:
 v_mbcnt_lo_u32_b32 v21, -1, 0
 v_min_u32 v21, 1, v21
 v_lshlrev_b32 v21, 28, v21
 buffer_load_dword v20, v21, s[28:31], 0 offen offset:4 sc1
 s_waitcnt vmcnt(0)
Lrhc_35:
 v_readfirstlane_b32 s89, v20
 s_cmp_eq_u32 s89, s88
 s_cbranch_scc1 Lrhk_36
 s_cmp_lg_u32 s89, 0
 s_cbranch_scc1 Lredo
 s_sub_u32 s95, s95, 1
 s_cbranch_scc0 Lrh_34
 s_endpgm
Lrhk_36:
 s_cmp_lg_u32 s4, 0
 s_cbranch_scc1 Lfrk_33
 v_min_u32 v21, 1, v0
 v_lshlrev_b32 v21, 28, v21
Lfr_32:
 buffer_load_dword v20, v21, s[28:31], 0 offen offset:0 sc1
 s_waitcnt vmcnt(0)
 v_cmp_eq_u32 vcc, 1, v20
 s_cbranch_vccnz Lfrk_33
 s_sub_u32 s95, s95, 1
 s_cbranch_scc0 Lfr_32
 s_endpgm
Lfrk_33:
 s_lshl_b32 s47, s2, 13
 s_add_u32 s47, s47, 0x8000000
 s_mov_b32 s48, s47
 v_mov_b32 v14, 0
 s_waitcnt vmcnt(0) lgkmcnt(0)
 s_barrier
 ds_read_b128 v[32:35], v6 offset:0
 ds_read_b128 v[36:39], v6 offset:2048
 ds_read_b128 v[40:43], v7 offset:0
 ds_read_b128 v[44:47], v7 offset:2048
 s_mul_i32 s45, s86, 4608
 v_lshl_add_u32 v1, v0, 7, s45
 v_add_u32 v1, 294912, v1
 v_mov_b32 v2, 0x7ff00000
 v_cmp_gt_u32 vcc, 36, v0
 s_nop 1
 v_cndmask_b32 v1, v2, v1, vcc
 s_waitcnt lgkmcnt(2)
Lps_loop_37:
 v_mfma_f32_16x16x32_bf16 v[64:67], a[0:3], v[32:35], 0
 ds_read_b128 v[48:51], v6 offset:4096
 v_mfma_f32_16x16x32_bf16 v[72:75], a[72:75], v[32:35], 0
 ds_read_b128 v[52:55], v6 offset:6144
 v_mfma_f32_16x16x32_bf16 v[80:83], a[144:147], v[32:35], 0
 s_add_u32 s41, s40, 4
 v_mfma_f32_16x16x32_bf16 v[88:91], a[216:219], v[32:35], 0
 s_add_u32 s45, s42, 2
 s_mul_i32 s46, s41, 36864
 v_mfma_f32_16x16x32_bf16 v[68:71], a[0:3], v[36:39], 0
 s_cmp_lt_u32 s45, s36
 s_cselect_b32 s46, s46, 0
 v_mfma_f32_16x16x32_bf16 v[76:79], a[72:75], v[36:39], 0
 s_lshl_b32 s49, s4, 10
 s_add_u32 s49, s49, s44
 v_mfma_f32_16x16x32_bf16 v[84:87], a[144:147], v[36:39], 0
 v_mfma_f32_16x16x32_bf16 v[92:95], a[216:219], v[36:39], 0
 s_waitcnt lgkmcnt(2)
 v_mfma_f32_16x16x32_bf16 v[64:67], a[4:7], v[40:43], v[64:67]
 ds_read_b128 v[56:59], v7 offset:4096
 v_mfma_f32_16x16x32_bf16 v[72:75], a[76:79], v[40:43], v[72:75]
 ds_read_b128 v[60:63], v7 offset:6144
 v_mfma_f32_16x16x32_bf16 v[80:83], a[148:151], v[40:43], v[80:83]
 s_add_u32 m0, s49, 0
 v_mfma_f32_16x16x32_bf16 v[88:91], a[220:223], v[40:43], v[88:91]
 buffer_load_dwordx4 v10, s[8:11], s46 offen offset:0  lds
 v_mfma_f32_16x16x32_bf16 v[68:71], a[4:7], v[44:47], v[68:71]
 s_add_u32 m0, s49, 3968
 v_mfma_f32_16x16x32_bf16 v[76:79], a[76:79], v[44:47], v[76:79]
 buffer_load_dwordx4 v10, s[8:11], s46 offen offset:128  lds
 v_mfma_f32_16x16x32_bf16 v[84:87], a[148:151], v[44:47], v[84:87]
 v_mfma_f32_16x16x32_bf16 v[92:95], a[220:223], v[44:47], v[92:95]
 s_waitcnt lgkmcnt(2)
 v_mfma_f32_16x16x32_bf16 v[64:67], a[8:11], v[48:51], v[64:67]
 ds_read_b128 v[32:35], v6 offset:8192
 v_mfma_f32_16x16x32_bf16 v[72:75], a[80:83], v[48:51], v[72:75]
 ds_read_b128 v[36:39], v6 offset:10240
 v_mfma_f32_16x16x32_bf16 v[80:83], a[152:155], v[48:51], v[80:83]
 s_add_u32 m0, s49, 7936
 v_mfma_f32_16x16x32_bf16 v[88:91], a[224:227], v[48:51], v[88:91]
 buffer_load_dwordx4 v10, s[8:11], s46 offen offset:256  lds
 v_mfma_f32_16x16x32_bf16 v[68:71], a[8:11], v[52:55], v[68:71]
 s_add_u32 m0, s49, 11904
 v_mfma_f32_16x16x32_bf16 v[76:79], a[80:83], v[52:55], v[76:79]
 buffer_load_dwordx4 v10, s[8:11], s46 offen offset:384  lds
 v_mfma_f32_16x16x32_bf16 v[84:87], a[152:155], v[52:55], v[84:87]
 v_mfma_f32_16x16x32_bf16 v[92:95], a[224:227], v[52:55], v[92:95]
 s_waitcnt lgkmcnt(2)
 v_mfma_f32_16x16x32_bf16 v[64:67], a[12:15], v[56:59], v[64:67]
 ds_read_b128 v[40:43], v7 offset:8192
 v_mfma_f32_16x16x32_bf16 v[72:75], a[84:87], v[56:59], v[72:75]
 ds_read_b128 v[44:47], v7 offset:10240
 v_mfma_f32_16x16x32_bf16 v[80:83], a[156:159], v[56:59], v[80:83]
 s_add_u32 m0, s49, 15872
 v_mfma_f32_16x16x32_bf16 v[88:91], a[228:231], v[56:59], v[88:91]
 buffer_load_dwordx4 v10, s[8:11], s46 offen offset:512  lds
 v_mfma_f32_16x16x32_bf16 v[68:71], a[12:15], v[60:63], v[68:71]
 s_add_u32 m0, s49, 19840
 v_mfma_f32_16x16x32_bf16 v[76:79], a[84:87], v[60:63], v[76:79]
 buffer_load_dwordx4 v10, s[8:11], s46 offen offset:640  lds
 v_mfma_f32_16x16x32_bf16 v[84:87], a[156:159], v[60:63], v[84:87]
 v_mfma_f32_16x16x32_bf16 v[92:95], a[228:231], v[60:63], v[92:95]
 s_waitcnt lgkmcnt(2)
 v_mfma_f32_16x16x32_bf16 v[64:67], a[16:19], v[32:35], v[64:67]
 ds_read_b128 v[48:51], v6 offset:12288
 v_mfma_f32_16x16x32_bf16 v[72:75], a[88:91], v[32:35], v[72:75]
 ds_read_b128 v[52:55], v6 offset:14336
 v_mfma_f32_16x16x32_bf16 v[80:83], a[160:163], v[32:35], v[80:83]
 s_add_u32 m0, s49, 23808
 v_mfma_f32_16x16x32_bf16 v[88:91], a[232:235], v[32:35], v[88:91]
 buffer_load_dwordx4 v10, s[8:11], s46 offen offset:768  lds
 v_mfma_f32_16x16x32_bf16 v[68:71], a[16:19], v[36:39], v[68:71]
 s_add_u32 m0, s49, 27776
 v_mfma_f32_16x16x32_bf16 v[76:79], a[88:91], v[36:39], v[76:79]
 buffer_load_dwordx4 v10, s[8:11], s46 offen offset:896  lds
 v_mfma_f32_16x16x32_bf16 v[84:87], a[160:163], v[36:39], v[84:87]
 v_mfma_f32_16x16x32_bf16 v[92:95], a[232:235], v[36:39], v[92:95]
 s_waitcnt lgkmcnt(2)
 v_mfma_f32_16x16x32_bf16 v[64:67], a[20:23], v[40:43], v[64:67]
 ds_read_b128 v[56:59], v7 offset:12288
 v_mfma_f32_16x16x32_bf16 v[72:75], a[92:95], v[40:43], v[72:75]
 ds_read_b128 v[60:63], v7 offset:14336
 v_mfma_f32_16x16x32_bf16 v[80:83], a[164:167], v[40:43], v[80:83]
 s_add_u32 m0, s49, 31744
 v_mfma_f32_16x16x32_bf16 v[88:91], a[236:239], v[40:43], v[88:91]
 buffer_load_dwordx4 v10, s[8:11], s46 offen offset:1024  lds
 v_mfma_f32_16x16x32_bf16 v[68:71], a[20:23], v[44:47], v[68:71]
 v_add_u32 v2, s46, v1
 v_mfma_f32_16x16x32_bf16 v[76:79], a[92:95], v[44:47], v[76:79]
 buffer_load_dword v15, v2, s[8:11], 0 offen
 v_mfma_f32_16x16x32_bf16 v[84:87], a[164:167], v[44:47], v[84:87]
 v_mfma_f32_16x16x32_bf16 v[92:95], a[236:239], v[44:47], v[92:95]
 s_waitcnt lgkmcnt(2)
 v_mfma_f32_16x16x32_bf16 v[64:67], a[24:27], v[48:51], v[64:67]
 ds_read_b128 v[32:35], v6 offset:16384
 v_mul_f32 v96, s50, v96
 v_mfma_f32_16x16x32_bf16 v[72:75], a[96:99], v[48:51], v[72:75]
 ds_read_b128 v[36:39], v6 offset:18432
 v_mfma_f32_16x16x32_bf16 v[80:83], a[168:171], v[48:51], v[80:83]
 v_mul_f32 v97, s50, v97
 v_mfma_f32_16x16x32_bf16 v[88:91], a[240:243], v[48:51], v[88:91]
 v_mul_f32 v98, s50, v98
 v_mfma_f32_16x16x32_bf16 v[68:71], a[24:27], v[52:55], v[68:71]
 v_mul_f32 v99, s50, v99
 v_mfma_f32_16x16x32_bf16 v[76:79], a[96:99], v[52:55], v[76:79]
 v_mul_f32 v104, s50, v104
 v_mfma_f32_16x16x32_bf16 v[84:87], a[168:171], v[52:55], v[84:87]
 v_mul_f32 v105, s50, v105
 v_mfma_f32_16x16x32_bf16 v[92:95], a[240:243], v[52:55], v[92:95]
 s_waitcnt lgkmcnt(2)
 v_mfma_f32_16x16x32_bf16 v[64:67], a[28:31], v[56:59], v[64:67]
 ds_read_b128 v[40:43], v7 offset:16384
 v_mfma_f32_16x16x32_bf16 v[72:75], a[100:103], v[56:59], v[72:75]
 ds_read_b128 v[44:47], v7 offset:18432
 v_mul_f32 v106, s50, v106
 v_mfma_f32_16x16x32_bf16 v[80:83], a[172:175], v[56:59], v[80:83]
 v_mul_f32 v107, s50, v107
 v_mfma_f32_16x16x32_bf16 v[88:91], a[244:247], v[56:59], v[88:91]
 v_cvt_pk_bf16_f32 v16, v96, v97
 v_mfma_f32_16x16x32_bf16 v[68:71], a[28:31], v[60:63], v[68:71]
 v_mfma_f32_16x16x32_bf16 v[76:79], a[100:103], v[60:63], v[76:79]
 v_cvt_pk_bf16_f32 v17, v104, v105
 v_mfma_f32_16x16x32_bf16 v[84:87], a[172:175], v[60:63], v[84:87]
 v_cvt_pk_bf16_f32 v18, v98, v99
 v_mfma_f32_16x16x32_bf16 v[92:95], a[244:247], v[60:63], v[92:95]
 s_waitcnt lgkmcnt(2)
 v_cvt_pk_bf16_f32 v19, v106, v107
 v_mfma_f32_16x16x32_bf16 v[64:67], a[32:35], v[32:35], v[64:67]
 ds_read_b128 v[48:51], v6 offset:20480
 v_mfma_f32_16x16x32_bf16 v[72:75], a[104:107], v[32:35], v[72:75]
 ds_read_b128 v[52:55], v6 offset:22528
 v_mfma_f32_16x16x32_bf16 v[80:83], a[176:179], v[32:35], v[80:83]
 buffer_store_dwordx4 v[16:19], v12, s[20:23], s47 offen offset:0 sc1
 v_mfma_f32_16x16x32_bf16 v[88:91], a[248:251], v[32:35], v[88:91]
 v_mul_f32 v100, s50, v100
 v_mfma_f32_16x16x32_bf16 v[68:71], a[32:35], v[36:39], v[68:71]
 v_mul_f32 v101, s50, v101
 v_mfma_f32_16x16x32_bf16 v[76:79], a[104:107], v[36:39], v[76:79]
 v_mul_f32 v102, s50, v102
 v_mfma_f32_16x16x32_bf16 v[84:87], a[176:179], v[36:39], v[84:87]
 v_mul_f32 v103, s50, v103
 v_mfma_f32_16x16x32_bf16 v[92:95], a[248:251], v[36:39], v[92:95]
 s_waitcnt lgkmcnt(2)
 v_mfma_f32_16x16x32_bf16 v[64:67], a[36:39], v[40:43], v[64:67]
 ds_read_b128 v[56:59], v7 offset:20480
 v_mul_f32 v108, s50, v108
 v_mfma_f32_16x16x32_bf16 v[72:75], a[108:111], v[40:43], v[72:75]
 ds_read_b128 v[60:63], v7 offset:22528
 v_mfma_f32_16x16x32_bf16 v[80:83], a[180:183], v[40:43], v[80:83]
 v_mul_f32 v109, s50, v109
 v_mfma_f32_16x16x32_bf16 v[88:91], a[252:255], v[40:43], v[88:91]
 v_mul_f32 v110, s50, v110
 v_mfma_f32_16x16x32_bf16 v[68:71], a[36:39], v[44:47], v[68:71]
 v_mul_f32 v111, s50, v111
 v_mfma_f32_16x16x32_bf16 v[76:79], a[108:111], v[44:47], v[76:79]
 v_mfma_f32_16x16x32_bf16 v[84:87], a[180:183], v[44:47], v[84:87]
 v_cvt_pk_bf16_f32 v20, v100, v101
 v_mfma_f32_16x16x32_bf16 v[92:95], a[252:255], v[44:47], v[92:95]
 s_waitcnt lgkmcnt(2)
 v_cvt_pk_bf16_f32 v21, v108, v109
 v_mfma_f32_16x16x32_bf16 v[64:67], a[40:43], v[48:51], v[64:67]
 ds_read_b128 v[32:35], v6 offset:24576
 v_mfma_f32_16x16x32_bf16 v[72:75], a[112:115], v[48:51], v[72:75]
 ds_read_b128 v[36:39], v6 offset:26624
 v_cvt_pk_bf16_f32 v22, v102, v103
 v_mfma_f32_16x16x32_bf16 v[80:83], a[184:187], v[48:51], v[80:83]
 v_mfma_f32_16x16x32_bf16 v[88:91], v[224:227], v[48:51], v[88:91]
 v_cvt_pk_bf16_f32 v23, v110, v111
 v_mfma_f32_16x16x32_bf16 v[68:71], a[40:43], v[52:55], v[68:71]
 buffer_store_dwordx4 v[20:23], v12, s[20:23], s47 offen offset:1024 sc1
 v_mfma_f32_16x16x32_bf16 v[76:79], a[112:115], v[52:55], v[76:79]
 v_mul_f32 v112, s50, v112
 v_mfma_f32_16x16x32_bf16 v[84:87], a[184:187], v[52:55], v[84:87]
 v_mul_f32 v113, s50, v113
 v_mfma_f32_16x16x32_bf16 v[92:95], v[224:227], v[52:55], v[92:95]
 s_waitcnt lgkmcnt(2)
 v_mfma_f32_16x16x32_bf16 v[64:67], a[44:47], v[56:59], v[64:67]
 ds_read_b128 v[40:43], v7 offset:24576
 v_mul_f32 v114, s50, v114
 v_mfma_f32_16x16x32_bf16 v[72:75], a[116:119], v[56:59], v[72:75]
 ds_read_b128 v[44:47], v7 offset:26624
 v_mfma_f32_16x16x32_bf16 v[80:83], a[188:191], v[56:59], v[80:83]
 v_mul_f32 v115, s50, v115
 v_mfma_f32_16x16x32_bf16 v[88:91], v[228:231], v[56:59], v[88:91]
 v_mul_f32 v120, s50, v120
 v_mfma_f32_16x16x32_bf16 v[68:71], a[44:47], v[60:63], v[68:71]
 v_mul_f32 v121, s50, v121
 v_mfma_f32_16x16x32_bf16 v[76:79], a[116:119], v[60:63], v[76:79]
 v_mfma_f32_16x16x32_bf16 v[84:87], a[188:191], v[60:63], v[84:87]
 v_mul_f32 v122, s50, v122
 v_mfma_f32_16x16x32_bf16 v[92:95], v[228:231], v[60:63], v[92:95]
 s_waitcnt lgkmcnt(2)
 v_mul_f32 v123, s50, v123
 v_mfma_f32_16x16x32_bf16 v[64:67], a[48:51], v[32:35], v[64:67]
 ds_read_b128 v[48:51], v6 offset:28672
 v_mfma_f32_16x16x32_bf16 v[72:75], a[120:123], v[32:35], v[72:75]
 ds_read_b128 v[52:55], v6 offset:30720
 v_cvt_pk_bf16_f32 v24, v112, v113
 v_mfma_f32_16x16x32_bf16 v[80:83], a[192:195], v[32:35], v[80:83]
 v_mfma_f32_16x16x32_bf16 v[88:91], v[232:235], v[32:35], v[88:91]
 v_cvt_pk_bf16_f32 v25, v120, v121
 v_mfma_f32_16x16x32_bf16 v[68:71], a[48:51], v[36:39], v[68:71]
 v_cvt_pk_bf16_f32 v26, v114, v115
 v_mfma_f32_16x16x32_bf16 v[76:79], a[120:123], v[36:39], v[76:79]
 v_cvt_pk_bf16_f32 v27, v122, v123
 v_mfma_f32_16x16x32_bf16 v[84:87], a[192:195], v[36:39], v[84:87]
 buffer_store_dwordx4 v[24:27], v12, s[20:23], s48 offen offset:0 sc1
 v_mfma_f32_16x16x32_bf16 v[92:95], v[232:235], v[36:39], v[92:95]
 s_waitcnt lgkmcnt(2)
 v_mfma_f32_16x16x32_bf16 v[64:67], a[52:55], v[40:43], v[64:67]
 ds_read_b128 v[56:59], v7 offset:28672
 v_mul_f32 v116, s50, v116
 v_mfma_f32_16x16x32_bf16 v[72:75], a[124:127], v[40:43], v[72:75]
 ds_read_b128 v[60:63], v7 offset:30720
 v_mfma_f32_16x16x32_bf16 v[80:83], a[196:199], v[40:43], v[80:83]
 s_add_u32 s43, s43, 36864
 s_cmp_eq_u32 s43, 147456
 v_mfma_f32_16x16x32_bf16 v[88:91], v[236:239], v[40:43], v[88:91]
 s_cselect_b32 s43, 0, s43
 s_add_u32 s44, s44, 36864
 v_mfma_f32_16x16x32_bf16 v[68:71], a[52:55], v[44:47], v[68:71]
 s_cmp_eq_u32 s44, 147456
 s_cselect_b32 s44, 0, s44
 v_mfma_f32_16x16x32_bf16 v[76:79], a[124:127], v[44:47], v[76:79]
 v_mul_f32 v117, s50, v117
 v_mfma_f32_16x16x32_bf16 v[84:87], a[196:199], v[44:47], v[84:87]
 v_mul_f32 v118, s50, v118
 v_mfma_f32_16x16x32_bf16 v[92:95], v[236:239], v[44:47], v[92:95]
 s_waitcnt lgkmcnt(2)
 v_mfma_f32_16x16x32_bf16 v[64:67], a[56:59], v[48:51], v[64:67]
 ds_read_b128 v[32:35], v6 offset:32768
 v_mul_f32 v119, s50, v119
 v_mfma_f32_16x16x32_bf16 v[72:75], a[128:131], v[48:51], v[72:75]
 ds_read_b128 v[36:39], v6 offset:34816
 v_mfma_f32_16x16x32_bf16 v[80:83], a[200:203], v[48:51], v[80:83]
 v_add_u32 v6, s43, v4
 v_mul_f32 v124, s50, v124
 v_mfma_f32_16x16x32_bf16 v[88:91], v[240:243], v[48:51], v[88:91]
 v_mfma_f32_16x16x32_bf16 v[68:71], a[56:59], v[52:55], v[68:71]
 v_mul_f32 v125, s50, v125
 v_mfma_f32_16x16x32_bf16 v[76:79], a[128:131], v[52:55], v[76:79]
 v_mul_f32 v126, s50, v126
 v_mfma_f32_16x16x32_bf16 v[84:87], a[200:203], v[52:55], v[84:87]
 v_mul_f32 v127, s50, v127
 v_mfma_f32_16x16x32_bf16 v[92:95], v[240:243], v[52:55], v[92:95]
 s_waitcnt lgkmcnt(2)
 v_mfma_f32_16x16x32_bf16 v[64:67], a[60:63], v[56:59], v[64:67]
 ds_read_b128 v[40:43], v7 offset:32768
 v_cvt_pk_bf16_f32 v28, v116, v117
 v_mfma_f32_16x16x32_bf16 v[72:75], a[132:135], v[56:59], v[72:75]
 ds_read_b128 v[44:47], v7 offset:34816
 v_mfma_f32_16x16x32_bf16 v[80:83], a[204:207], v[56:59], v[80:83]
 v_add_u32 v7, s43, v5
 v_cvt_pk_bf16_f32 v29, v124, v125
 v_mfma_f32_16x16x32_bf16 v[88:91], v[244:247], v[56:59], v[88:91]
 v_cvt_pk_bf16_f32 v30, v118, v119
 v_mfma_f32_16x16x32_bf16 v[68:71], a[60:63], v[60:63], v[68:71]
 v_mfma_f32_16x16x32_bf16 v[76:79], a[132:135], v[60:63], v[76:79]
 v_cvt_pk_bf16_f32 v31, v126, v127
 v_mfma_f32_16x16x32_bf16 v[84:87], a[204:207], v[60:63], v[84:87]
 buffer_store_dwordx4 v[28:31], v12, s[20:23], s48 offen offset:1024 sc1
 v_mfma_f32_16x16x32_bf16 v[92:95], v[244:247], v[60:63], v[92:95]
 s_waitcnt lgkmcnt(2)
 v_mfma_f32_16x16x32_bf16 v[64:67], a[64:67], v[32:35], v[64:67]
 s_waitcnt vmcnt(14)
 s_barrier
 ds_read_b128 v[48:51], v6 offset:0
 v_mfma_f32_16x16x32_bf16 v[72:75], a[136:139], v[32:35], v[72:75]
 ds_read_b128 v[52:55], v6 offset:2048
 v_mfma_f32_16x16x32_bf16 v[80:83], a[208:211], v[32:35], v[80:83]
 buffer_store_dword v14, v13, s[20:23], 0 offen sc1
 v_mfma_f32_16x16x32_bf16 v[88:91], v[248:251], v[32:35], v[88:91]
 v_mfma_f32_16x16x32_bf16 v[68:71], a[64:67], v[36:39], v[68:71]
 v_mfma_f32_16x16x32_bf16 v[76:79], a[136:139], v[36:39], v[76:79]
 v_mfma_f32_16x16x32_bf16 v[84:87], a[208:211], v[36:39], v[84:87]
 v_mfma_f32_16x16x32_bf16 v[92:95], v[248:251], v[36:39], v[92:95]
 s_waitcnt lgkmcnt(2)
 v_mfma_f32_16x16x32_bf16 v[64:67], a[68:71], v[40:43], v[64:67]
 ds_read_b128 v[56:59], v7 offset:0
 v_mfma_f32_16x16x32_bf16 v[72:75], a[140:143], v[40:43], v[72:75]
 ds_read_b128 v[60:63], v7 offset:2048
 v_mfma_f32_16x16x32_bf16 v[80:83], a[212:215], v[40:43], v[80:83]
 s_mul_i32 s45, s39, 262144
 s_add_u32 s47, s34, s45
 v_mfma_f32_16x16x32_bf16 v[88:91], v[252:255], v[40:43], v[88:91]
 s_add_u32 s48, s35, s45
 v_mov_b32 v14, s42
 v_mfma_f32_16x16x32_bf16 v[68:71], a[68:71], v[44:47], v[68:71]
 s_mov_b32 s39, s40
 s_mov_b32 s40, s41
 v_mfma_f32_16x16x32_bf16 v[76:79], a[140:143], v[44:47], v[76:79]
 s_add_u32 s42, s42, 1
 v_mfma_f32_16x16x32_bf16 v[84:87], a[212:215], v[44:47], v[84:87]
 v_mfma_f32_16x16x32_bf16 v[92:95], v[252:255], v[44:47], v[92:95]
 s_waitcnt lgkmcnt(2)
 v_mfma_f32_16x16x32_bf16 v[96:99], a[0:3], v[48:51], 0
 ds_read_b128 v[32:35], v6 offset:4096
 v_mfma_f32_16x16x32_bf16 v[104:107], a[72:75], v[48:51], 0
 ds_read_b128 v[36:39], v6 offset:6144
 v_mfma_f32_16x16x32_bf16 v[112:115], a[144:147], v[48:51], 0
 s_add_u32 s41, s40, 4
 v_mfma_f32_16x16x32_bf16 v[120:123], a[216:219], v[48:51], 0
 s_add_u32 s45, s42, 2
 s_mul_i32 s46, s41, 36864
 v_mfma_f32_16x16x32_bf16 v[100:103], a[0:3], v[52:55], 0
 s_cmp_lt_u32 s45, s36
 s_cselect_b32 s46, s46, 0
 v_mfma_f32_16x16x32_bf16 v[108:111], a[72:75], v[52:55], 0
 s_lshl_b32 s49, s4, 10
 s_add_u32 s49, s49, s44
 v_mfma_f32_16x16x32_bf16 v[116:119], a[144:147], v[52:55], 0
 v_mfma_f32_16x16x32_bf16 v[124:127], a[216:219], v[52:55], 0
 s_waitcnt lgkmcnt(2)
 v_mfma_f32_16x16x32_bf16 v[96:99], a[4:7], v[56:59], v[96:99]
 ds_read_b128 v[40:43], v7 offset:4096
 v_mfma_f32_16x16x32_bf16 v[104:107], a[76:79], v[56:59], v[104:107]
 ds_read_b128 v[44:47], v7 offset:6144
 v_mfma_f32_16x16x32_bf16 v[112:115], a[148:151], v[56:59], v[112:115]
 s_add_u32 m0, s49, 0
 v_mfma_f32_16x16x32_bf16 v[120:123], a[220:223], v[56:59], v[120:123]
 buffer_load_dwordx4 v10, s[8:11], s46 offen offset:0  lds
 v_mfma_f32_16x16x32_bf16 v[100:103], a[4:7], v[60:63], v[100:103]
 s_add_u32 m0, s49, 3968
 v_mfma_f32_16x16x32_bf16 v[108:111], a[76:79], v[60:63], v[108:111]
 buffer_load_dwordx4 v10, s[8:11], s46 offen offset:128  lds
 v_mfma_f32_16x16x32_bf16 v[116:119], a[148:151], v[60:63], v[116:119]
 v_mfma_f32_16x16x32_bf16 v[124:127], a[220:223], v[60:63], v[124:127]
 s_waitcnt lgkmcnt(2)
 v_mfma_f32_16x16x32_bf16 v[96:99], a[8:11], v[32:35], v[96:99]
 ds_read_b128 v[48:51], v6 offset:8192
 v_mfma_f32_16x16x32_bf16 v[104:107], a[80:83], v[32:35], v[104:107]
 ds_read_b128 v[52:55], v6 offset:10240
 v_mfma_f32_16x16x32_bf16 v[112:115], a[152:155], v[32:35], v[112:115]
 s_add_u32 m0, s49, 7936
 v_mfma_f32_16x16x32_bf16 v[120:123], a[224:227], v[32:35], v[120:123]
 buffer_load_dwordx4 v10, s[8:11], s46 offen offset:256  lds
 v_mfma_f32_16x16x32_bf16 v[100:103], a[8:11], v[36:39], v[100:103]
 s_add_u32 m0, s49, 11904
 v_mfma_f32_16x16x32_bf16 v[108:111], a[80:83], v[36:39], v[108:111]
 buffer_load_dwordx4 v10, s[8:11], s46 offen offset:384  lds
 v_mfma_f32_16x16x32_bf16 v[116:119], a[152:155], v[36:39], v[116:119]
 v_mfma_f32_16x16x32_bf16 v[124:127], a[224:227], v[36:39], v[124:127]
 s_waitcnt lgkmcnt(2)
 v_mfma_f32_16x16x32_bf16 v[96:99], a[12:15], v[40:43], v[96:99]
 ds_read_b128 v[56:59], v7 offset:8192
 v_mfma_f32_16x16x32_bf16 v[104:107], a[84:87], v[40:43], v[104:107]
 ds_read_b128 v[60:63], v7 offset:10240
 v_mfma_f32_16x16x32_bf16 v[112:115], a[156:159], v[40:43], v[112:115]
 s_add_u32 m0, s49, 15872
 v_mfma_f32_16x16x32_bf16 v[120:123], a[228:231], v[40:43], v[120:123]
 buffer_load_dwordx4 v10, s[8:11], s46 offen offset:512  lds
 v_mfma_f32_16x16x32_bf16 v[100:103], a[12:15], v[44:47], v[100:103]
 s_add_u32 m0, s49, 19840
 v_mfma_f32_16x16x32_bf16 v[108:111], a[84:87], v[44:47], v[108:111]
 buffer_load_dwordx4 v10, s[8:11], s46 offen offset:640  lds
 v_mfma_f32_16x16x32_bf16 v[116:119], a[156:159], v[44:47], v[116:119]
 v_mfma_f32_16x16x32_bf16 v[124:127], a[228:231], v[44:47], v[124:127]
 s_waitcnt lgkmcnt(2)
 v_mfma_f32_16x16x32_bf16 v[96:99], a[16:19], v[48:51], v[96:99]
 ds_read_b128 v[32:35], v6 offset:12288
 v_mfma_f32_16x16x32_bf16 v[104:107], a[88:91], v[48:51], v[104:107]
 ds_read_b128 v[36:39], v6 offset:14336
 v_mfma_f32_16x16x32_bf16 v[112:115], a[160:163], v[48:51], v[112:115]
 s_add_u32 m0, s49, 23808
 v_mfma_f32_16x16x32_bf16 v[120:123], a[232:235], v[48:51], v[120:123]
 buffer_load_dwordx4 v10, s[8:11], s46 offen offset:768  lds
 v_mfma_f32_16x16x32_bf16 v[100:103], a[16:19], v[52:55], v[100:103]
 s_add_u32 m0, s49, 27776
 v_mfma_f32_16x16x32_bf16 v[108:111], a[88:91], v[52:55], v[108:111]
 buffer_load_dwordx4 v10, s[8:11], s46 offen offset:896  lds
 v_mfma_f32_16x16x32_bf16 v[116:119], a[160:163], v[52:55], v[116:119]
 v_mfma_f32_16x16x32_bf16 v[124:127], a[232:235], v[52:55], v[124:127]
 s_waitcnt lgkmcnt(2)
 v_mfma_f32_16x16x32_bf16 v[96:99], a[20:23], v[56:59], v[96:99]
 ds_read_b128 v[40:43], v7 offset:12288
 v_mfma_f32_16x16x32_bf16 v[104:107], a[92:95], v[56:59], v[104:107]
 ds_read_b128 v[44:47], v7 offset:14336
 v_mfma_f32_16x16x32_bf16 v[112:115], a[164:167], v[56:59], v[112:115]
 s_add_u32 m0, s49, 31744
 v_mfma_f32_16x16x32_bf16 v[120:123], a[236:239], v[56:59], v[120:123]
 buffer_load_dwordx4 v10, s[8:11], s46 offen offset:1024  lds
 v_mfma_f32_16x16x32_bf16 v[100:103], a[20:23], v[60:63], v[100:103]
 v_add_u32 v2, s46, v1
 v_mfma_f32_16x16x32_bf16 v[108:111], a[92:95], v[60:63], v[108:111]
 buffer_load_dword v15, v2, s[8:11], 0 offen
 v_mfma_f32_16x16x32_bf16 v[116:119], a[164:167], v[60:63], v[116:119]
 v_mfma_f32_16x16x32_bf16 v[124:127], a[236:239], v[60:63], v[124:127]
 s_waitcnt lgkmcnt(2)
 v_mfma_f32_16x16x32_bf16 v[96:99], a[24:27], v[32:35], v[96:99]
 ds_read_b128 v[48:51], v6 offset:16384
 v_mul_f32 v64, s50, v64
 v_mfma_f32_16x16x32_bf16 v[104:107], a[96:99], v[32:35], v[104:107]
 ds_read_b128 v[52:55], v6 offset:18432
 v_mfma_f32_16x16x32_bf16 v[112:115], a[168:171], v[32:35], v[112:115]
 v_mul_f32 v65, s50, v65
 v_mfma_f32_16x16x32_bf16 v[120:123], a[240:243], v[32:35], v[120:123]
 v_mul_f32 v66, s50, v66
 v_mfma_f32_16x16x32_bf16 v[100:103], a[24:27], v[36:39], v[100:103]
 v_mul_f32 v67, s50, v67
 v_mfma_f32_16x16x32_bf16 v[108:111], a[96:99], v[36:39], v[108:111]
 v_mul_f32 v72, s50, v72
 v_mfma_f32_16x16x32_bf16 v[116:119], a[168:171], v[36:39], v[116:119]
 v_mul_f32 v73, s50, v73
 v_mfma_f32_16x16x32_bf16 v[124:127], a[240:243], v[36:39], v[124:127]
 s_waitcnt lgkmcnt(2)
 v_mfma_f32_16x16x32_bf16 v[96:99], a[28:31], v[40:43], v[96:99]
 ds_read_b128 v[56:59], v7 offset:16384
 v_mfma_f32_16x16x32_bf16 v[104:107], a[100:103], v[40:43], v[104:107]
 ds_read_b128 v[60:63], v7 offset:18432
 v_mul_f32 v74, s50, v74
 v_mfma_f32_16x16x32_bf16 v[112:115], a[172:175], v[40:43], v[112:115]
 v_mul_f32 v75, s50, v75
 v_mfma_f32_16x16x32_bf16 v[120:123], a[244:247], v[40:43], v[120:123]
 v_cvt_pk_bf16_f32 v16, v64, v65
 v_mfma_f32_16x16x32_bf16 v[100:103], a[28:31], v[44:47], v[100:103]
 v_mfma_f32_16x16x32_bf16 v[108:111], a[100:103], v[44:47], v[108:111]
 v_cvt_pk_bf16_f32 v17, v72, v73
 v_mfma_f32_16x16x32_bf16 v[116:119], a[172:175], v[44:47], v[116:119]
 v_cvt_pk_bf16_f32 v18, v66, v67
 v_mfma_f32_16x16x32_bf16 v[124:127], a[244:247], v[44:47], v[124:127]
 s_waitcnt lgkmcnt(2)
 v_cvt_pk_bf16_f32 v19, v74, v75
 v_mfma_f32_16x16x32_bf16 v[96:99], a[32:35], v[48:51], v[96:99]
 ds_read_b128 v[32:35], v6 offset:20480
 v_mfma_f32_16x16x32_bf16 v[104:107], a[104:107], v[48:51], v[104:107]
 ds_read_b128 v[36:39], v6 offset:22528
 v_mfma_f32_16x16x32_bf16 v[112:115], a[176:179], v[48:51], v[112:115]
 buffer_store_dwordx4 v[16:19], v12, s[20:23], s47 offen offset:0 sc1
 v_mfma_f32_16x16x32_bf16 v[120:123], a[248:251], v[48:51], v[120:123]
 v_mul_f32 v68, s50, v68
 v_mfma_f32_16x16x32_bf16 v[100:103], a[32:35], v[52:55], v[100:103]
 v_mul_f32 v69, s50, v69
 v_mfma_f32_16x16x32_bf16 v[108:111], a[104:107], v[52:55], v[108:111]
 v_mul_f32 v70, s50, v70
 v_mfma_f32_16x16x32_bf16 v[116:119], a[176:179], v[52:55], v[116:119]
 v_mul_f32 v71, s50, v71
 v_mfma_f32_16x16x32_bf16 v[124:127], a[248:251], v[52:55], v[124:127]
 s_waitcnt lgkmcnt(2)
 v_mfma_f32_16x16x32_bf16 v[96:99], a[36:39], v[56:59], v[96:99]
 ds_read_b128 v[40:43], v7 offset:20480
 v_mul_f32 v76, s50, v76
 v_mfma_f32_16x16x32_bf16 v[104:107], a[108:111], v[56:59], v[104:107]
 ds_read_b128 v[44:47], v7 offset:22528
 v_mfma_f32_16x16x32_bf16 v[112:115], a[180:183], v[56:59], v[112:115]
 v_mul_f32 v77, s50, v77
 v_mfma_f32_16x16x32_bf16 v[120:123], a[252:255], v[56:59], v[120:123]
 v_mul_f32 v78, s50, v78
 v_mfma_f32_16x16x32_bf16 v[100:103], a[36:39], v[60:63], v[100:103]
 v_mul_f32 v79, s50, v79
 v_mfma_f32_16x16x32_bf16 v[108:111], a[108:111], v[60:63], v[108:111]
 v_mfma_f32_16x16x32_bf16 v[116:119], a[180:183], v[60:63], v[116:119]
 v_cvt_pk_bf16_f32 v20, v68, v69
 v_mfma_f32_16x16x32_bf16 v[124:127], a[252:255], v[60:63], v[124:127]
 s_waitcnt lgkmcnt(2)
 v_cvt_pk_bf16_f32 v21, v76, v77
 v_mfma_f32_16x16x32_bf16 v[96:99], a[40:43], v[32:35], v[96:99]
 ds_read_b128 v[48:51], v6 offset:24576
 v_mfma_f32_16x16x32_bf16 v[104:107], a[112:115], v[32:35], v[104:107]
 ds_read_b128 v[52:55], v6 offset:26624
 v_cvt_pk_bf16_f32 v22, v70, v71
 v_mfma_f32_16x16x32_bf16 v[112:115], a[184:187], v[32:35], v[112:115]
 v_mfma_f32_16x16x32_bf16 v[120:123], v[224:227], v[32:35], v[120:123]
 v_cvt_pk_bf16_f32 v23, v78, v79
 v_mfma_f32_16x16x32_bf16 v[100:103], a[40:43], v[36:39], v[100:103]
 buffer_store_dwordx4 v[20:23], v12, s[20:23], s47 offen offset:1024 sc1
 v_mfma_f32_16x16x32_bf16 v[108:111], a[112:115], v[36:39], v[108:111]
 v_mul_f32 v80, s50, v80
 v_mfma_f32_16x16x32_bf16 v[116:119], a[184:187], v[36:39], v[116:119]
 v_mul_f32 v81, s50, v81
 v_mfma_f32_16x16x32_bf16 v[124:127], v[224:227], v[36:39], v[124:127]
 s_waitcnt lgkmcnt(2)
 v_mfma_f32_16x16x32_bf16 v[96:99], a[44:47], v[40:43], v[96:99]
 ds_read_b128 v[56:59], v7 offset:24576
 v_mul_f32 v82, s50, v82
 v_mfma_f32_16x16x32_bf16 v[104:107], a[116:119], v[40:43], v[104:107]
 ds_read_b128 v[60:63], v7 offset:26624
 v_mfma_f32_16x16x32_bf16 v[112:115], a[188:191], v[40:43], v[112:115]
 v_mul_f32 v83, s50, v83
 v_mfma_f32_16x16x32_bf16 v[120:123], v[228:231], v[40:43], v[120:123]
 v_mul_f32 v88, s50, v88
 v_mfma_f32_16x16x32_bf16 v[100:103], a[44:47], v[44:47], v[100:103]
 v_mul_f32 v89, s50, v89
 v_mfma_f32_16x16x32_bf16 v[108:111], a[116:119], v[44:47], v[108:111]
 v_mfma_f32_16x16x32_bf16 v[116:119], a[188:191], v[44:47], v[116:119]
 v_mul_f32 v90, s50, v90
 v_mfma_f32_16x16x32_bf16 v[124:127], v[228:231], v[44:47], v[124:127]
 s_waitcnt lgkmcnt(2)
 v_mul_f32 v91, s50, v91
 v_mfma_f32_16x16x32_bf16 v[96:99], a[48:51], v[48:51], v[96:99]
 ds_read_b128 v[32:35], v6 offset:28672
 v_mfma_f32_16x16x32_bf16 v[104:107], a[120:123], v[48:51], v[104:107]
 ds_read_b128 v[36:39], v6 offset:30720
 v_cvt_pk_bf16_f32 v24, v80, v81
 v_mfma_f32_16x16x32_bf16 v[112:115], a[192:195], v[48:51], v[112:115]
 v_mfma_f32_16x16x32_bf16 v[120:123], v[232:235], v[48:51], v[120:123]
 v_cvt_pk_bf16_f32 v25, v88, v89
 v_mfma_f32_16x16x32_bf16 v[100:103], a[48:51], v[52:55], v[100:103]
 v_cvt_pk_bf16_f32 v26, v82, v83
 v_mfma_f32_16x16x32_bf16 v[108:111], a[120:123], v[52:55], v[108:111]
 v_cvt_pk_bf16_f32 v27, v90, v91
 v_mfma_f32_16x16x32_bf16 v[116:119], a[192:195], v[52:55], v[116:119]
 buffer_store_dwordx4 v[24:27], v12, s[20:23], s48 offen offset:0 sc1
 v_mfma_f32_16x16x32_bf16 v[124:127], v[232:235], v[52:55], v[124:127]
 s_waitcnt lgkmcnt(2)
 v_mfma_f32_16x16x32_bf16 v[96:99], a[52:55], v[56:59], v[96:99]
 ds_read_b128 v[40:43], v7 offset:28672
 v_mul_f32 v84, s50, v84
 v_mfma_f32_16x16x32_bf16 v[104:107], a[124:127], v[56:59], v[104:107]
 ds_read_b128 v[44:47], v7 offset:30720
 v_mfma_f32_16x16x32_bf16 v[112:115], a[196:199], v[56:59], v[112:115]
 s_add_u32 s43, s43, 36864
 s_cmp_eq_u32 s43, 147456
 v_mfma_f32_16x16x32_bf16 v[120:123], v[236:239], v[56:59], v[120:123]
 s_cselect_b32 s43, 0, s43
 s_add_u32 s44, s44, 36864
 v_mfma_f32_16x16x32_bf16 v[100:103], a[52:55], v[60:63], v[100:103]
 s_cmp_eq_u32 s44, 147456
 s_cselect_b32 s44, 0, s44
 v_mfma_f32_16x16x32_bf16 v[108:111], a[124:127], v[60:63], v[108:111]
 v_mul_f32 v85, s50, v85
 v_mfma_f32_16x16x32_bf16 v[116:119], a[196:199], v[60:63], v[116:119]
 v_mul_f32 v86, s50, v86
 v_mfma_f32_16x16x32_bf16 v[124:127], v[236:239], v[60:63], v[124:127]
 s_waitcnt lgkmcnt(2)
 v_mfma_f32_16x16x32_bf16 v[96:99], a[56:59], v[32:35], v[96:99]
 ds_read_b128 v[48:51], v6 offset:32768
 v_mul_f32 v87, s50, v87
 v_mfma_f32_16x16x32_bf16 v[104:107], a[128:131], v[32:35], v[104:107]
 ds_read_b128 v[52:55], v6 offset:34816
 v_mfma_f32_16x16x32_bf16 v[112:115], a[200:203], v[32:35], v[112:115]
 v_add_u32 v6, s43, v4
 v_mul_f32 v92, s50, v92
 v_mfma_f32_16x16x32_bf16 v[120:123], v[240:243], v[32:35], v[120:123]
 v_mfma_f32_16x16x32_bf16 v[100:103], a[56:59], v[36:39], v[100:103]
 v_mul_f32 v93, s50, v93
 v_mfma_f32_16x16x32_bf16 v[108:111], a[128:131], v[36:39], v[108:111]
 v_mul_f32 v94, s50, v94
 v_mfma_f32_16x16x32_bf16 v[116:119], a[200:203], v[36:39], v[116:119]
 v_mul_f32 v95, s50, v95
 v_mfma_f32_16x16x32_bf16 v[124:127], v[240:243], v[36:39], v[124:127]
 s_waitcnt lgkmcnt(2)
 v_mfma_f32_16x16x32_bf16 v[96:99], a[60:63], v[40:43], v[96:99]
 ds_read_b128 v[56:59], v7 offset:32768
 v_cvt_pk_bf16_f32 v28, v84, v85
 v_mfma_f32_16x16x32_bf16 v[104:107], a[132:135], v[40:43], v[104:107]
 ds_read_b128 v[60:63], v7 offset:34816
 v_mfma_f32_16x16x32_bf16 v[112:115], a[204:207], v[40:43], v[112:115]
 v_add_u32 v7, s43, v5
 v_cvt_pk_bf16_f32 v29, v92, v93
 v_mfma_f32_16x16x32_bf16 v[120:123], v[244:247], v[40:43], v[120:123]
 v_cvt_pk_bf16_f32 v30, v86, v87
 v_mfma_f32_16x16x32_bf16 v[100:103], a[60:63], v[44:47], v[100:103]
 v_mfma_f32_16x16x32_bf16 v[108:111], a[132:135], v[44:47], v[108:111]
 v_cvt_pk_bf16_f32 v31, v94, v95
 v_mfma_f32_16x16x32_bf16 v[116:119], a[204:207], v[44:47], v[116:119]
 buffer_store_dwordx4 v[28:31], v12, s[20:23], s48 offen offset:1024 sc1
 v_mfma_f32_16x16x32_bf16 v[124:127], v[244:247], v[44:47], v[124:127]
 s_waitcnt lgkmcnt(2)
 v_mfma_f32_16x16x32_bf16 v[96:99], a[64:67], v[48:51], v[96:99]
 s_waitcnt vmcnt(14)
 s_barrier
 ds_read_b128 v[32:35], v6 offset:0
 v_mfma_f32_16x16x32_bf16 v[104:107], a[136:139], v[48:51], v[104:107]
 ds_read_b128 v[36:39], v6 offset:2048
 v_mfma_f32_16x16x32_bf16 v[112:115], a[208:211], v[48:51], v[112:115]
 buffer_store_dword v14, v13, s[20:23], 0 offen sc1
 v_mfma_f32_16x16x32_bf16 v[120:123], v[248:251], v[48:51], v[120:123]
 v_mfma_f32_16x16x32_bf16 v[100:103], a[64:67], v[52:55], v[100:103]
 v_mfma_f32_16x16x32_bf16 v[108:111], a[136:139], v[52:55], v[108:111]
 v_mfma_f32_16x16x32_bf16 v[116:119], a[208:211], v[52:55], v[116:119]
 v_mfma_f32_16x16x32_bf16 v[124:127], v[248:251], v[52:55], v[124:127]
 s_waitcnt lgkmcnt(2)
 v_mfma_f32_16x16x32_bf16 v[96:99], a[68:71], v[56:59], v[96:99]
 ds_read_b128 v[40:43], v7 offset:0
 v_mfma_f32_16x16x32_bf16 v[104:107], a[140:143], v[56:59], v[104:107]
 ds_read_b128 v[44:47], v7 offset:2048
 v_mfma_f32_16x16x32_bf16 v[112:115], a[212:215], v[56:59], v[112:115]
 s_mul_i32 s45, s39, 262144
 s_add_u32 s47, s34, s45
 v_mfma_f32_16x16x32_bf16 v[120:123], v[252:255], v[56:59], v[120:123]
 s_add_u32 s48, s35, s45
 v_mov_b32 v14, s42
 v_mfma_f32_16x16x32_bf16 v[100:103], a[68:71], v[60:63], v[100:103]
 s_mov_b32 s39, s40
 s_mov_b32 s40, s41
 v_mfma_f32_16x16x32_bf16 v[108:111], a[140:143], v[60:63], v[108:111]
 s_add_u32 s42, s42, 1
 s_cmp_lt_u32 s42, s36
 v_mfma_f32_16x16x32_bf16 v[116:119], a[212:215], v[60:63], v[116:119]
 v_mfma_f32_16x16x32_bf16 v[124:127], v[252:255], v[60:63], v[124:127]
 s_waitcnt lgkmcnt(2)
 s_cbranch_scc1 Lps_loop_37
 s_nop 7
 v_mul_f32 v96, s50, v96
 v_mul_f32 v97, s50, v97
 v_mul_f32 v98, s50, v98
 v_mul_f32 v99, s50, v99
 v_mul_f32 v104, s50, v104
 v_mul_f32 v105, s50, v105
 v_mul_f32 v106, s50, v106
 v_mul_f32 v107, s50, v107
 v_cvt_pk_bf16_f32 v16, v96, v97
 v_cvt_pk_bf16_f32 v17, v104, v105
 v_cvt_pk_bf16_f32 v18, v98, v99
 v_cvt_pk_bf16_f32 v19, v106, v107
 buffer_store_dwordx4 v[16:19], v12, s[20:23], s47 offen offset:0 sc1
 v_mul_f32 v100, s50, v100
 v_mul_f32 v101, s50, v101
 v_mul_f32 v102, s50, v102
 v_mul_f32 v103, s50, v103
 v_mul_f32 v108, s50, v108
 v_mul_f32 v109, s50, v109
 v_mul_f32 v110, s50, v110
 v_mul_f32 v111, s50, v111
 v_cvt_pk_bf16_f32 v20, v100, v101
 v_cvt_pk_bf16_f32 v21, v108, v109
 v_cvt_pk_bf16_f32 v22, v102, v103
 v_cvt_pk_bf16_f32 v23, v110, v111
 buffer_store_dwordx4 v[20:23], v12, s[20:23], s47 offen offset:1024 sc1
 v_mul_f32 v112, s50, v112
 v_mul_f32 v113, s50, v113
 v_mul_f32 v114, s50, v114
 v_mul_f32 v115, s50, v115
 v_mul_f32 v120, s50, v120
 v_mul_f32 v121, s50, v121
 v_mul_f32 v122, s50, v122
 v_mul_f32 v123, s50, v123
 v_cvt_pk_bf16_f32 v24, v112, v113
 v_cvt_pk_bf16_f32 v25, v120, v121
 v_cvt_pk_bf16_f32 v26, v114, v115
 v_cvt_pk_bf16_f32 v27, v122, v123
 buffer_store_dwordx4 v[24:27], v12, s[20:23], s48 offen offset:0 sc1
 v_mul_f32 v116, s50, v116
 v_mul_f32 v117, s50, v117
 v_mul_f32 v118, s50, v118
 v_mul_f32 v119, s50, v119
 v_mul_f32 v124, s50, v124
 v_mul_f32 v125, s50, v125
 v_mul_f32 v126, s50, v126
 v_mul_f32 v127, s50, v127
 v_cvt_pk_bf16_f32 v28, v116, v117
 v_cvt_pk_bf16_f32 v29, v124, v125
 v_cvt_pk_bf16_f32 v30, v118, v119
 v_cvt_pk_bf16_f32 v31, v126, v127
 buffer_store_dwordx4 v[28:31], v12, s[20:23], s48 offen offset:1024 sc1
 s_waitcnt vmcnt(0) lgkmcnt(0)
 s_barrier
 v_mov_b32 v14, s36
 buffer_store_dword v14, v13, s[20:23], 0 offen sc1
 s_sub_u32 s3, s5, 2
 s_add_u32 s7, s6, s3
 s_cmp_ge_u32 s7, 30
 s_cbranch_scc1 Lfin
Lqb:
 s_cmp_ge_u32 s6, 16
 s_cbranch_scc1 Lob
 s_load_dwordx2 s[8:9], s[0:1], 48
 s_mov_b32 s10, 0x240000
 s_mov_b32 s11, 0x20000
 s_load_dwordx2 s[12:13], s[0:1], 64
 s_mov_b32 s14, 0x480000
 s_mov_b32 s15, 0x20000
 s_load_dwordx2 s[16:17], s[0:1], 64
 s_mov_b32 s18, 0x480000
 s_mov_b32 s19, 0x20000
 s_lshl_b32 s32, s6, 9
 s_add_u32 s33, s32, 256
 s_sub_u32 s36, 32, s3
 s_cmp_eq_u32 s3, 2
 s_cselect_b32 s36, 1, s36
 s_cselect_b32 s37, 63, s3
 s_lshl_b32 s52, s6, 1
 s_lshl_b32 s7, s3, 4
 s_add_u32 s7, s7, s6
 s_and_b32 s94, s7, 3
 s_lshr_b32 s7, s7, 2
 s_lshl_b32 s7, s7, 5
 s_add_u32 s7, s7, s94
 s_lshl_b32 s7, s7, 2
 s_add_u32 s59, s7, 0x3800
 s_waitcnt lgkmcnt(0)
 v_and_b32 v1, 63, v0
 v_lshrrev_b32 v2, 3, v0
 v_mul_u32_u24 v10, 1152, v2
 v_lshrrev_b32 v2, 4, v0
 v_xor_b32 v2, v2, v0
 v_and_b32 v2, 7, v2
 v_lshl_add_u32 v10, v2, 4, v10
 v_lshrrev_b32 v2, 4, v1
 v_bfe_u32 v3, v1, 1, 3
 v_xor_b32 v2, v2, v3
 v_and_b32 v3, 15, v1
 v_lshlrev_b32 v3, 7, v3
 v_lshl_add_u32 v4, v2, 4, v3
 v_xor_b32 v5, 64, v4
 v_lshrrev_b32 v2, 4, v0
 v_lshlrev_b32 v11, 13, v2
 v_lshrrev_b32 v2, 7, v0
 v_lshrrev_b32 v3, 4, v1
 v_lshl_add_u32 v3, v2, 2, v3
 v_bfe_u32 v2, v1, 1, 3
 v_xor_b32 v2, v2, v3
 v_lshl_add_u32 v11, v2, 5, v11
 v_and_b32 v2, 1, v1
 v_lshl_add_u32 v11, v2, 4, v11
 v_bfe_u32 v2, v1, 2, 3
 v_xor_b32 v3, s4, v2
 v_lshlrev_b32 v3, 5, v3
 v_and_b32 v2, 3, v2
 v_lshl_add_u32 v3, v2, 8, v3
 v_lshrrev_b32 v2, 4, v1
 v_lshl_add_u32 v3, v2, 11, v3
 v_and_b32 v2, 3, v1
 v_lshl_add_u32 v3, v2, 3, v3
 v_add_u32 v8, 73728, v3
 v_xor_b32 v3, 0x80, v3
 v_add_u32 v9, 73728, v3
 s_lshl_b32 s45, s4, 11
 v_lshl_add_u32 v12, v1, 4, s45
 s_mov_b32 s39, s37
 s_add_u32 s40, s39, 2
 s_min_u32 s40, s40, 63
 s_lshl_b32 s49, s4, 10
 s_mul_i32 s46, s39, 36864
 s_add_u32 m0, s49, 0
 s_nop 0
 buffer_load_dwordx4 v10, s[8:11], s46 offen offset:0  lds
 s_add_u32 m0, s49, 3968
 s_nop 0
 buffer_load_dwordx4 v10, s[8:11], s46 offen offset:128  lds
 s_add_u32 m0, s49, 7936
 s_nop 0
 buffer_load_dwordx4 v10, s[8:11], s46 offen offset:256  lds
 s_add_u32 m0, s49, 11904
 s_nop 0
 buffer_load_dwordx4 v10, s[8:11], s46 offen offset:384  lds
 s_add_u32 m0, s49, 15872
 s_nop 0
 buffer_load_dwordx4 v10, s[8:11], s46 offen offset:512  lds
 s_add_u32 m0, s49, 19840
 s_nop 0
 buffer_load_dwordx4 v10, s[8:11], s46 offen offset:640  lds
 s_add_u32 m0, s49, 23808
 s_nop 0
 buffer_load_dwordx4 v10, s[8:11], s46 offen offset:768  lds
 s_add_u32 m0, s49, 27776
 s_nop 0
 buffer_load_dwordx4 v10, s[8:11], s46 offen offset:896  lds
 s_add_u32 m0, s49, 31744
 s_nop 0
 buffer_load_dwordx4 v10, s[8:11], s46 offen offset:1024  lds
 s_lshl_b32 s49, s4, 10
 s_add_u32 s49, s49, 36864
 s_mul_i32 s46, s40, 36864
 s_add_u32 m0, s49, 0
 s_nop 0
 buffer_load_dwordx4 v10, s[8:11], s46 offen offset:0  lds
 s_add_u32 m0, s49, 3968
 s_nop 0
 buffer_load_dwordx4 v10, s[8:11], s46 offen offset:128  lds
 s_add_u32 m0, s49, 7936
 s_nop 0
 buffer_load_dwordx4 v10, s[8:11], s46 offen offset:256  lds
 s_add_u32 m0, s49, 11904
 s_nop 0
 buffer_load_dwordx4 v10, s[8:11], s46 offen offset:384  lds
 s_add_u32 m0, s49, 15872
 s_nop 0
 buffer_load_dwordx4 v10, s[8:11], s46 offen offset:512  lds
 s_add_u32 m0, s49, 19840
 s_nop 0
 buffer_load_dwordx4 v10, s[8:11], s46 offen offset:640  lds
 s_add_u32 m0, s49, 23808
 s_nop 0
 buffer_load_dwordx4 v10, s[8:11], s46 offen offset:768  lds
 s_add_u32 m0, s49, 27776
 s_nop 0
 buffer_load_dwordx4 v10, s[8:11], s46 offen offset:896  lds
 s_add_u32 m0, s49, 31744
 s_nop 0
 buffer_load_dwordx4 v10, s[8:11], s46 offen offset:1024  lds
 s_lshl_b32 s49, s4, 10
 s_add_u32 m0, s49, 73728
 s_add_u32 s45, s32, 0
 buffer_load_dwordx4 v11, s[12:15], s45 offen  lds
 s_add_u32 m0, s49, 77824
 s_add_u32 s45, s32, 131072
 buffer_load_dwordx4 v11, s[12:15], s45 offen  lds
 s_add_u32 m0, s49, 81920
 s_add_u32 s45, s33, 0
 buffer_load_dwordx4 v11, s[16:19], s45 offen  lds
 s_add_u32 m0, s49, 86016
 s_add_u32 s45, s33, 131072
 buffer_load_dwordx4 v11, s[16:19], s45 offen  lds
 s_add_u32 m0, s49, 90112
 s_add_u32 s45, s32, 262144
 buffer_load_dwordx4 v11, s[12:15], s45 offen  lds
 s_add_u32 m0, s49, 94208
 s_add_u32 s45, s32, 393216
 buffer_load_dwordx4 v11, s[12:15], s45 offen  lds
 s_add_u32 m0, s49, 98304
 s_add_u32 s45, s33, 262144
 buffer_load_dwordx4 v11, s[16:19], s45 offen  lds
 s_add_u32 m0, s49, 102400
 s_add_u32 s45, s33, 393216
 buffer_load_dwordx4 v11, s[16:19], s45 offen  lds
 s_add_u32 m0, s49, 106496
 s_add_u32 s45, s32, 524288
 buffer_load_dwordx4 v11, s[12:15], s45 offen  lds
 s_add_u32 m0, s49, 110592
 s_add_u32 s45, s32, 655360
 buffer_load_dwordx4 v11, s[12:15], s45 offen  lds
 s_add_u32 m0, s49, 114688
 s_add_u32 s45, s33, 524288
 buffer_load_dwordx4 v11, s[16:19], s45 offen  lds
 s_add_u32 m0, s49, 118784
 s_add_u32 s45, s33, 655360
 buffer_load_dwordx4 v11, s[16:19], s45 offen  lds
 s_waitcnt vmcnt(8) lgkmcnt(0)
 s_barrier
 s_add_u32 m0, s49, 122880
 s_add_u32 s45, s32, 786432
 buffer_load_dwordx4 v11, s[12:15], s45 offen  lds
 s_add_u32 m0, s49, 126976
 s_add_u32 s45, s32, 917504
 buffer_load_dwordx4 v11, s[12:15], s45 offen  lds
 s_add_u32 m0, s49, 131072
 s_add_u32 s45, s33, 786432
 buffer_load_dwordx4 v11, s[16:19], s45 offen  lds
 s_add_u32 m0, s49, 135168
 s_add_u32 s45, s33, 917504
 buffer_load_dwordx4 v11, s[16:19], s45 offen  lds
 ds_read_b64_tr_b16 a[0:1], v8 offset:0
 ds_read_b64_tr_b16 a[2:3], v8 offset:1024
 ds_read_b64_tr_b16 a[72:73], v9 offset:0
 ds_read_b64_tr_b16 a[74:75], v9 offset:1024
 ds_read_b64_tr_b16 a[144:145], v8 offset:8192
 ds_read_b64_tr_b16 a[146:147], v8 offset:9216
 ds_read_b64_tr_b16 a[216:217], v9 offset:8192
 ds_read_b64_tr_b16 a[218:219], v9 offset:9216
 s_waitcnt vmcnt(8) lgkmcnt(0)
 s_barrier
 s_add_u32 m0, s49, 73728
 s_add_u32 s45, s32, 1048576
 buffer_load_dwordx4 v11, s[12:15], s45 offen  lds
 s_add_u32 m0, s49, 77824
 s_add_u32 s45, s32, 1179648
 buffer_load_dwordx4 v11, s[12:15], s45 offen  lds
 s_add_u32 m0, s49, 81920
 s_add_u32 s45, s33, 1048576
 buffer_load_dwordx4 v11, s[16:19], s45 offen  lds
 s_add_u32 m0, s49, 86016
 s_add_u32 s45, s33, 1179648
 buffer_load_dwordx4 v11, s[16:19], s45 offen  lds
 ds_read_b64_tr_b16 a[4:5], v8 offset:16384
 ds_read_b64_tr_b16 a[6:7], v8 offset:17408
 ds_read_b64_tr_b16 a[76:77], v9 offset:16384
 ds_read_b64_tr_b16 a[78:79], v9 offset:17408
 ds_read_b64_tr_b16 a[148:149], v8 offset:24576
 ds_read_b64_tr_b16 a[150:151], v8 offset:25600
 ds_read_b64_tr_b16 a[220:221], v9 offset:24576
 ds_read_b64_tr_b16 a[222:223], v9 offset:25600
 s_waitcnt vmcnt(8) lgkmcnt(0)
 s_barrier
 s_add_u32 m0, s49, 90112
 s_add_u32 s45, s32, 1310720
 buffer_load_dwordx4 v11, s[12:15], s45 offen  lds
 s_add_u32 m0, s49, 94208
 s_add_u32 s45, s32, 1441792
 buffer_load_dwordx4 v11, s[12:15], s45 offen  lds
 s_add_u32 m0, s49, 98304
 s_add_u32 s45, s33, 1310720
 buffer_load_dwordx4 v11, s[16:19], s45 offen  lds
 s_add_u32 m0, s49, 102400
 s_add_u32 s45, s33, 1441792
 buffer_load_dwordx4 v11, s[16:19], s45 offen  lds
 ds_read_b64_tr_b16 a[8:9], v8 offset:32768
 ds_read_b64_tr_b16 a[10:11], v8 offset:33792
 ds_read_b64_tr_b16 a[80:81], v9 offset:32768
 ds_read_b64_tr_b16 a[82:83], v9 offset:33792
 ds_read_b64_tr_b16 a[152:153], v8 offset:40960
 ds_read_b64_tr_b16 a[154:155], v8 offset:41984
 ds_read_b64_tr_b16 a[224:225], v9 offset:40960
 ds_read_b64_tr_b16 a[226:227], v9 offset:41984
 s_waitcnt vmcnt(8) lgkmcnt(0)
 s_barrier
 s_add_u32 m0, s49, 106496
 s_add_u32 s45, s32, 1572864
 buffer_load_dwordx4 v11, s[12:15], s45 offen  lds
 s_add_u32 m0, s49, 110592
 s_add_u32 s45, s32, 1703936
 buffer_load_dwordx4 v11, s[12:15], s45 offen  lds
 s_add_u32 m0, s49, 114688
 s_add_u32 s45, s33, 1572864
 buffer_load_dwordx4 v11, s[16:19], s45 offen  lds
 s_add_u32 m0, s49, 118784
 s_add_u32 s45, s33, 1703936
 buffer_load_dwordx4 v11, s[16:19], s45 offen  lds
 ds_read_b64_tr_b16 a[12:13], v8 offset:49152
 ds_read_b64_tr_b16 a[14:15], v8 offset:50176
 ds_read_b64_tr_b16 a[84:85], v9 offset:49152
 ds_read_b64_tr_b16 a[86:87], v9 offset:50176
 ds_read_b64_tr_b16 a[156:157], v8 offset:57344
 ds_read_b64_tr_b16 a[158:159], v8 offset:58368
 ds_read_b64_tr_b16 a[228:229], v9 offset:57344
 ds_read_b64_tr_b16 a[230:231], v9 offset:58368
 s_waitcnt vmcnt(8) lgkmcnt(0)
 s_barrier
 s_add_u32 m0, s49, 122880
 s_add_u32 s45, s32, 1835008
 buffer_load_dwordx4 v11, s[12:15], s45 offen  lds
 s_add_u32 m0, s49, 126976
 s_add_u32 s45, s32, 1966080
 buffer_load_dwordx4 v11, s[12:15], s45 offen  lds
 s_add_u32 m0, s49, 131072
 s_add_u32 s45, s33, 1835008
 buffer_load_dwordx4 v11, s[16:19], s45 offen  lds
 s_add_u32 m0, s49, 135168
 s_add_u32 s45, s33, 1966080
 buffer_load_dwordx4 v11, s[16:19], s45 offen  lds
 ds_read_b64_tr_b16 a[16:17], v8 offset:0
 ds_read_b64_tr_b16 a[18:19], v8 offset:1024
 ds_read_b64_tr_b16 a[88:89], v9 offset:0
 ds_read_b64_tr_b16 a[90:91], v9 offset:1024
 ds_read_b64_tr_b16 a[160:161], v8 offset:8192
 ds_read_b64_tr_b16 a[162:163], v8 offset:9216
 ds_read_b64_tr_b16 a[232:233], v9 offset:8192
 ds_read_b64_tr_b16 a[234:235], v9 offset:9216
 s_waitcnt vmcnt(8) lgkmcnt(0)
 s_barrier
 s_add_u32 m0, s49, 73728
 s_add_u32 s45, s32, 2097152
 buffer_load_dwordx4 v11, s[12:15], s45 offen  lds
 s_add_u32 m0, s49, 77824
 s_add_u32 s45, s32, 2228224
 buffer_load_dwordx4 v11, s[12:15], s45 offen  lds
 s_add_u32 m0, s49, 81920
 s_add_u32 s45, s33, 2097152
 buffer_load_dwordx4 v11, s[16:19], s45 offen  lds
 s_add_u32 m0, s49, 86016
 s_add_u32 s45, s33, 2228224
 buffer_load_dwordx4 v11, s[16:19], s45 offen  lds
 ds_read_b64_tr_b16 a[20:21], v8 offset:16384
 ds_read_b64_tr_b16 a[22:23], v8 offset:17408
 ds_read_b64_tr_b16 a[92:93], v9 offset:16384
 ds_read_b64_tr_b16 a[94:95], v9 offset:17408
 ds_read_b64_tr_b16 a[164:165], v8 offset:24576
 ds_read_b64_tr_b16 a[166:167], v8 offset:25600
 ds_read_b64_tr_b16 a[236:237], v9 offset:24576
 ds_read_b64_tr_b16 a[238:239], v9 offset:25600
 s_waitcnt vmcnt(8) lgkmcnt(0)
 s_barrier
 s_add_u32 m0, s49, 90112
 s_add_u32 s45, s32, 2359296
 buffer_load_dwordx4 v11, s[12:15], s45 offen  lds
 s_add_u32 m0, s49, 94208
 s_add_u32 s45, s32, 2490368
 buffer_load_dwordx4 v11, s[12:15], s45 offen  lds
 s_add_u32 m0, s49, 98304
 s_add_u32 s45, s33, 2359296
 buffer_load_dwordx4 v11, s[16:19], s45 offen  lds
 s_add_u32 m0, s49, 102400
 s_add_u32 s45, s33, 2490368
 buffer_load_dwordx4 v11, s[16:19], s45 offen  lds
 ds_read_b64_tr_b16 a[24:25], v8 offset:32768
 ds_read_b64_tr_b16 a[26:27], v8 offset:33792
 ds_read_b64_tr_b16 a[96:97], v9 offset:32768
 ds_read_b64_tr_b16 a[98:99], v9 offset:33792
 ds_read_b64_tr_b16 a[168:169], v8 offset:40960
 ds_read_b64_tr_b16 a[170:171], v8 offset:41984
 ds_read_b64_tr_b16 a[240:241], v9 offset:40960
 ds_read_b64_tr_b16 a[242:243], v9 offset:41984
 s_waitcnt vmcnt(8) lgkmcnt(0)
 s_barrier
 s_add_u32 m0, s49, 106496
 s_add_u32 s45, s32, 2621440
 buffer_load_dwordx4 v11, s[12:15], s45 offen  lds
 s_add_u32 m0, s49, 110592
 s_add_u32 s45, s32, 2752512
 buffer_load_dwordx4 v11, s[12:15], s45 offen  lds
 s_add_u32 m0, s49, 114688
 s_add_u32 s45, s33, 2621440
 buffer_load_dwordx4 v11, s[16:19], s45 offen  lds
 s_add_u32 m0, s49, 118784
 s_add_u32 s45, s33, 2752512
 buffer_load_dwordx4 v11, s[16:19], s45 offen  lds
 ds_read_b64_tr_b16 a[28:29], v8 offset:49152
 ds_read_b64_tr_b16 a[30:31], v8 offset:50176
 ds_read_b64_tr_b16 a[100:101], v9 offset:49152
 ds_read_b64_tr_b16 a[102:103], v9 offset:50176
 ds_read_b64_tr_b16 a[172:173], v8 offset:57344
 ds_read_b64_tr_b16 a[174:175], v8 offset:58368
 ds_read_b64_tr_b16 a[244:245], v9 offset:57344
 ds_read_b64_tr_b16 a[246:247], v9 offset:58368
 s_waitcnt vmcnt(8) lgkmcnt(0)
 s_barrier
 s_add_u32 m0, s49, 122880
 s_add_u32 s45, s32, 2883584
 buffer_load_dwordx4 v11, s[12:15], s45 offen  lds
 s_add_u32 m0, s49, 126976
 s_add_u32 s45, s32, 3014656
 buffer_load_dwordx4 v11, s[12:15], s45 offen  lds
 s_add_u32 m0, s49, 131072
 s_add_u32 s45, s33, 2883584
 buffer_load_dwordx4 v11, s[16:19], s45 offen  lds
 s_add_u32 m0, s49, 135168
 s_add_u32 s45, s33, 3014656
 buffer_load_dwordx4 v11, s[16:19], s45 offen  lds
 ds_read_b64_tr_b16 a[32:33], v8 offset:0
 ds_read_b64_tr_b16 a[34:35], v8 offset:1024
 ds_read_b64_tr_b16 a[104:105], v9 offset:0
 ds_read_b64_tr_b16 a[106:107], v9 offset:1024
 ds_read_b64_tr_b16 a[176:177], v8 offset:8192
 ds_read_b64_tr_b16 a[178:179], v8 offset:9216
 ds_read_b64_tr_b16 a[248:249], v9 offset:8192
 ds_read_b64_tr_b16 a[250:251], v9 offset:9216
 s_waitcnt vmcnt(8) lgkmcnt(0)
 s_barrier
 s_add_u32 m0, s49, 73728
 s_add_u32 s45, s32, 3145728
 buffer_load_dwordx4 v11, s[12:15], s45 offen  lds
 s_add_u32 m0, s49, 77824
 s_add_u32 s45, s32, 3276800
 buffer_load_dwordx4 v11, s[12:15], s45 offen  lds
 s_add_u32 m0, s49, 81920
 s_add_u32 s45, s33, 3145728
 buffer_load_dwordx4 v11, s[16:19], s45 offen  lds
 s_add_u32 m0, s49, 86016
 s_add_u32 s45, s33, 3276800
 buffer_load_dwordx4 v11, s[16:19], s45 offen  lds
 ds_read_b64_tr_b16 a[36:37], v8 offset:16384
 ds_read_b64_tr_b16 a[38:39], v8 offset:17408
 ds_read_b64_tr_b16 a[108:109], v9 offset:16384
 ds_read_b64_tr_b16 a[110:111], v9 offset:17408
 ds_read_b64_tr_b16 a[180:181], v8 offset:24576
 ds_read_b64_tr_b16 a[182:183], v8 offset:25600
 ds_read_b64_tr_b16 a[252:253], v9 offset:24576
 ds_read_b64_tr_b16 a[254:255], v9 offset:25600
 s_waitcnt vmcnt(8) lgkmcnt(0)
 s_barrier
 s_add_u32 m0, s49, 90112
 s_add_u32 s45, s32, 3407872
 buffer_load_dwordx4 v11, s[12:15], s45 offen  lds
 s_add_u32 m0, s49, 94208
 s_add_u32 s45, s32, 3538944
 buffer_load_dwordx4 v11, s[12:15], s45 offen  lds
 s_add_u32 m0, s49, 98304
 s_add_u32 s45, s33, 3407872
 buffer_load_dwordx4 v11, s[16:19], s45 offen  lds
 s_add_u32 m0, s49, 102400
 s_add_u32 s45, s33, 3538944
 buffer_load_dwordx4 v11, s[16:19], s45 offen  lds
 ds_read_b64_tr_b16 a[40:41], v8 offset:32768
 ds_read_b64_tr_b16 a[42:43], v8 offset:33792
 ds_read_b64_tr_b16 a[112:113], v9 offset:32768
 ds_read_b64_tr_b16 a[114:115], v9 offset:33792
 ds_read_b64_tr_b16 a[184:185], v8 offset:40960
 ds_read_b64_tr_b16 a[186:187], v8 offset:41984
 ds_read_b64_tr_b16 v[224:225], v9 offset:40960
 ds_read_b64_tr_b16 v[226:227], v9 offset:41984
 s_waitcnt vmcnt(8) lgkmcnt(0)
 s_barrier
 s_add_u32 m0, s49, 106496
 s_add_u32 s45, s32, 3670016
 buffer_load_dwordx4 v11, s[12:15], s45 offen  lds
 s_add_u32 m0, s49, 110592
 s_add_u32 s45, s32, 3801088
 buffer_load_dwordx4 v11, s[12:15], s45 offen  lds
 s_add_u32 m0, s49, 114688
 s_add_u32 s45, s33, 3670016
 buffer_load_dwordx4 v11, s[16:19], s45 offen  lds
 s_add_u32 m0, s49, 118784
 s_add_u32 s45, s33, 3801088
 buffer_load_dwordx4 v11, s[16:19], s45 offen  lds
 ds_read_b64_tr_b16 a[44:45], v8 offset:49152
 ds_read_b64_tr_b16 a[46:47], v8 offset:50176
 ds_read_b64_tr_b16 a[116:117], v9 offset:49152
 ds_read_b64_tr_b16 a[118:119], v9 offset:50176
 ds_read_b64_tr_b16 a[188:189], v8 offset:57344
 ds_read_b64_tr_b16 a[190:191], v8 offset:58368
 ds_read_b64_tr_b16 v[228:229], v9 offset:57344
 ds_read_b64_tr_b16 v[230:231], v9 offset:58368
 s_waitcnt vmcnt(8) lgkmcnt(0)
 s_barrier
 s_add_u32 m0, s49, 122880
 s_add_u32 s45, s32, 3932160
 buffer_load_dwordx4 v11, s[12:15], s45 offen  lds
 s_add_u32 m0, s49, 126976
 s_add_u32 s45, s32, 4063232
 buffer_load_dwordx4 v11, s[12:15], s45 offen  lds
 s_add_u32 m0, s49, 131072
 s_add_u32 s45, s33, 3932160
 buffer_load_dwordx4 v11, s[16:19], s45 offen  lds
 s_add_u32 m0, s49, 135168
 s_add_u32 s45, s33, 4063232
 buffer_load_dwordx4 v11, s[16:19], s45 offen  lds
 ds_read_b64_tr_b16 a[48:49], v8 offset:0
 ds_read_b64_tr_b16 a[50:51], v8 offset:1024
 ds_read_b64_tr_b16 a[120:121], v9 offset:0
 ds_read_b64_tr_b16 a[122:123], v9 offset:1024
 ds_read_b64_tr_b16 a[192:193], v8 offset:8192
 ds_read_b64_tr_b16 a[194:195], v8 offset:9216
 ds_read_b64_tr_b16 v[232:233], v9 offset:8192
 ds_read_b64_tr_b16 v[234:235], v9 offset:9216
 s_waitcnt vmcnt(8) lgkmcnt(0)
 s_barrier
 s_add_u32 m0, s49, 73728
 s_add_u32 s45, s32, 4194304
 buffer_load_dwordx4 v11, s[12:15], s45 offen  lds
 s_add_u32 m0, s49, 77824
 s_add_u32 s45, s32, 4325376
 buffer_load_dwordx4 v11, s[12:15], s45 offen  lds
 s_add_u32 m0, s49, 81920
 s_add_u32 s45, s33, 4194304
 buffer_load_dwordx4 v11, s[16:19], s45 offen  lds
 s_add_u32 m0, s49, 86016
 s_add_u32 s45, s33, 4325376
 buffer_load_dwordx4 v11, s[16:19], s45 offen  lds
 ds_read_b64_tr_b16 a[52:53], v8 offset:16384
 ds_read_b64_tr_b16 a[54:55], v8 offset:17408
 ds_read_b64_tr_b16 a[124:125], v9 offset:16384
 ds_read_b64_tr_b16 a[126:127], v9 offset:17408
 ds_read_b64_tr_b16 a[196:197], v8 offset:24576
 ds_read_b64_tr_b16 a[198:199], v8 offset:25600
 ds_read_b64_tr_b16 v[236:237], v9 offset:24576
 ds_read_b64_tr_b16 v[238:239], v9 offset:25600
 s_waitcnt vmcnt(8) lgkmcnt(0)
 s_barrier
 s_add_u32 m0, s49, 90112
 s_add_u32 s45, s32, 4456448
 buffer_load_dwordx4 v11, s[12:15], s45 offen  lds
 s_add_u32 m0, s49, 94208
 s_add_u32 s45, s32, 4587520
 buffer_load_dwordx4 v11, s[12:15], s45 offen  lds
 s_add_u32 m0, s49, 98304
 s_add_u32 s45, s33, 4456448
 buffer_load_dwordx4 v11, s[16:19], s45 offen  lds
 s_add_u32 m0, s49, 102400
 s_add_u32 s45, s33, 4587520
 buffer_load_dwordx4 v11, s[16:19], s45 offen  lds
 ds_read_b64_tr_b16 a[56:57], v8 offset:32768
 ds_read_b64_tr_b16 a[58:59], v8 offset:33792
 ds_read_b64_tr_b16 a[128:129], v9 offset:32768
 ds_read_b64_tr_b16 a[130:131], v9 offset:33792
 ds_read_b64_tr_b16 a[200:201], v8 offset:40960
 ds_read_b64_tr_b16 a[202:203], v8 offset:41984
 ds_read_b64_tr_b16 v[240:241], v9 offset:40960
 ds_read_b64_tr_b16 v[242:243], v9 offset:41984
 s_waitcnt vmcnt(8) lgkmcnt(0)
 s_barrier
 ds_read_b64_tr_b16 a[60:61], v8 offset:49152
 ds_read_b64_tr_b16 a[62:63], v8 offset:50176
 ds_read_b64_tr_b16 a[132:133], v9 offset:49152
 ds_read_b64_tr_b16 a[134:135], v9 offset:50176
 ds_read_b64_tr_b16 a[204:205], v8 offset:57344
 ds_read_b64_tr_b16 a[206:207], v8 offset:58368
 ds_read_b64_tr_b16 v[244:245], v9 offset:57344
 ds_read_b64_tr_b16 v[246:247], v9 offset:58368
 s_waitcnt vmcnt(4) lgkmcnt(0)
 s_barrier
 ds_read_b64_tr_b16 a[64:65], v8 offset:0
 ds_read_b64_tr_b16 a[66:67], v8 offset:1024
 ds_read_b64_tr_b16 a[136:137], v9 offset:0
 ds_read_b64_tr_b16 a[138:139], v9 offset:1024
 ds_read_b64_tr_b16 a[208:209], v8 offset:8192
 ds_read_b64_tr_b16 a[210:211], v8 offset:9216
 ds_read_b64_tr_b16 v[248:249], v9 offset:8192
 ds_read_b64_tr_b16 v[250:251], v9 offset:9216
 s_waitcnt vmcnt(0) lgkmcnt(0)
 s_barrier
 ds_read_b64_tr_b16 a[68:69], v8 offset:16384
 ds_read_b64_tr_b16 a[70:71], v8 offset:17408
 ds_read_b64_tr_b16 a[140:141], v9 offset:16384
 ds_read_b64_tr_b16 a[142:143], v9 offset:17408
 ds_read_b64_tr_b16 a[212:213], v8 offset:24576
 ds_read_b64_tr_b16 a[214:215], v8 offset:25600
 ds_read_b64_tr_b16 v[252:253], v9 offset:24576
 ds_read_b64_tr_b16 v[254:255], v9 offset:25600
 s_mov_b32 s50, 0x3e0293ee
 s_mov_b32 s42, 0
 s_mov_b32 s43, 0
 s_mov_b32 s44, 73728
 v_mov_b32 v6, v4
 v_mov_b32 v7, v5
 v_and_b32 v17, 63, v0
 v_lshlrev_b32 v1, 4, v17
 s_lshl_b32 s45, s4, 11
 s_add_u32 s45, s45, 147456
 v_add_u32 v2, s45, v1
 s_lshr_b32 s53, s4, 1
 s_and_b32 s54, s4, 1
 s_add_u32 s52, s52, s53
 s_lshl_b32 s53, s53, 13
 s_lshl_b32 s54, s54, 10
 s_add_u32 s45, s53, s54
 s_add_u32 s45, s45, 147456
 v_add_u32 v3, s45, v1
 s_lshl_b32 s63, s52, 13
 s_add_u32 s63, s63, s54
 s_add_u32 s63, s63, 0x7000000
 s_lshl_b32 s61, s52, 14
 s_add_u32 s61, s61, 0x3000000
 s_lshl_b32 s62, s52, 12
 s_add_u32 s62, s62, 0x400000
 s_lshl_b32 s57, s52, 7
 s_add_u32 s57, s57, 0x1000
 s_waitcnt lgkmcnt(0)
 v_min_u32 v8, 1, v0
 v_lshlrev_b32 v8, 28, v8
 s_mov_b32 s58, 0x40000
 v_mov_b32 v13, 0
 v_mov_b32 v14, 0
 v_min_u32 v15, 1, v17
 v_lshlrev_b32 v15, 28, v15
 v_bfe_u32 v18, v17, 3, 2
 v_and_b32 v19, 7, v17
 v_lshlrev_b32 v19, 7, v19
 v_lshl_add_u32 v18, v18, 11, v19
 v_lshrrev_b32 v19, 5, v17
 v_lshl_or_b32 v11, v19, 28, v18
 s_mov_b32 s56, s61
 v_mov_b32 v18, 0x44444444
 v_mov_b32 v19, 0xeeeeeeee
 v_and_b32 v20, 2, v17
 v_cmp_eq_u32 vcc, 0, v20
 s_nop 1
 v_cndmask_b32 v12, v19, v18, vcc
 v_mov_b32 v217, 0
 v_mov_b32 v218, 0
 v_mov_b32 v220, 0x3f803f80
 v_mov_b32 v221, 0x3f803f80
 v_mov_b32 v222, 0x3f803f80
 v_mov_b32 v223, 0x3f803f80
 v_and_b32 v18, 15, v17
 v_lshrrev_b32 v19, 4, v17
 v_lshlrev_b32 v19, 2, v19
 v_sub_u32 v18, v18, v19
 s_lshr_b32 s45, s54, 6
 v_add_u32 v18, s45, v18
 v_mov_b32 v19, 0xff800000
 v_cmp_le_i32 vcc, 0, v18
 s_nop 1
 v_cndmask_b32 v208, v19, v13, vcc
 v_cmp_le_i32 vcc, 1, v18
 s_nop 1
 v_cndmask_b32 v209, v19, v13, vcc
 v_cmp_le_i32 vcc, 2, v18
 s_nop 1
 v_cndmask_b32 v210, v19, v13, vcc
 v_cmp_le_i32 vcc, 3, v18
 s_nop 1
 v_cndmask_b32 v211, v19, v13, vcc
 v_cmp_le_i32 vcc, 16, v18
 s_nop 1
 v_cndmask_b32 v212, v19, v13, vcc
 v_cmp_le_i32 vcc, 17, v18
 s_nop 1
 v_cndmask_b32 v213, v19, v13, vcc
 v_cmp_le_i32 vcc, 18, v18
 s_nop 1
 v_cndmask_b32 v214, v19, v13, vcc
 v_cmp_le_i32 vcc, 19, v18
 s_nop 1
 v_cndmask_b32 v215, v19, v13, vcc
 s_sub_u32 s53, s57, 4096
 s_add_u32 s60, s39, 1
Lqs_38:
 buffer_load_dword v16, v15, s[20:23], s53 offen sc1
 s_waitcnt vmcnt(0)
 v_cmp_le_u32 vcc, s60, v16
 s_cbranch_vccnz Lqsk_39
 s_sleep 2
 s_sub_u32 s58, s58, 1
 s_cbranch_scc0 Lqs_38
 s_endpgm
Lqsk_39:
 s_waitcnt vmcnt(0) lgkmcnt(0)
 s_barrier
 ds_read_b128 v[32:35], v6 offset:0
 ds_read_b128 v[36:39], v6 offset:2048
 ds_read_b128 v[40:43], v7 offset:0
 ds_read_b128 v[44:47], v7 offset:2048
 s_waitcnt lgkmcnt(2)
Lqb_loop_40:
 v_mfma_f32_16x16x32_bf16 v[64:67], a[0:3], v[32:35], 0
 ds_read_b128 v[48:51], v6 offset:4096
 v_mfma_f32_16x16x32_bf16 v[72:75], a[72:75], v[32:35], 0
 ds_read_b128 v[52:55], v6 offset:6144
 v_mfma_f32_16x16x32_bf16 v[80:83], a[144:147], v[32:35], 0
 s_add_u32 s41, s40, 2
 v_mfma_f32_16x16x32_bf16 v[88:91], a[216:219], v[32:35], 0
 s_add_u32 s45, s42, 2
 s_mul_i32 s46, s41, 36864
 v_mfma_f32_16x16x32_bf16 v[68:71], a[0:3], v[36:39], 0
 s_cmp_lt_u32 s45, s36
 s_cselect_b32 s46, s46, 0
 v_mfma_f32_16x16x32_bf16 v[76:79], a[72:75], v[36:39], 0
 s_lshl_b32 s49, s4, 10
 s_add_u32 s49, s49, s44
 v_mfma_f32_16x16x32_bf16 v[84:87], a[144:147], v[36:39], 0
 s_lshl_b32 s53, s39, 19
 s_add_u32 s53, s53, s61
 v_mfma_f32_16x16x32_bf16 v[92:95], a[216:219], v[36:39], 0
 s_waitcnt lgkmcnt(2)
 v_mfma_f32_16x16x32_bf16 v[64:67], a[4:7], v[40:43], v[64:67]
 ds_read_b128 v[56:59], v7 offset:4096
 v_mfma_f32_16x16x32_bf16 v[72:75], a[76:79], v[40:43], v[72:75]
 ds_read_b128 v[60:63], v7 offset:6144
 v_mfma_f32_16x16x32_bf16 v[80:83], a[148:151], v[40:43], v[80:83]
 s_add_u32 m0, s49, 0
 v_mfma_f32_16x16x32_bf16 v[88:91], a[220:223], v[40:43], v[88:91]
 buffer_load_dwordx4 v10, s[8:11], s46 offen offset:0  lds
 v_mfma_f32_16x16x32_bf16 v[68:71], a[4:7], v[44:47], v[68:71]
 s_add_u32 m0, s49, 3968
 v_mfma_f32_16x16x32_bf16 v[76:79], a[76:79], v[44:47], v[76:79]
 buffer_load_dwordx4 v10, s[8:11], s46 offen offset:128  lds
 v_mfma_f32_16x16x32_bf16 v[84:87], a[148:151], v[44:47], v[84:87]
 s_lshl_b32 s55, s39, 17
 s_add_u32 s55, s55, s62
 v_mfma_f32_16x16x32_bf16 v[92:95], a[220:223], v[44:47], v[92:95]
 s_waitcnt lgkmcnt(2)
 v_mfma_f32_16x16x32_bf16 v[64:67], a[8:11], v[48:51], v[64:67]
 ds_read_b128 v[32:35], v6 offset:8192
 v_mfma_f32_16x16x32_bf16 v[72:75], a[80:83], v[48:51], v[72:75]
 ds_read_b128 v[36:39], v6 offset:10240
 v_mfma_f32_16x16x32_bf16 v[80:83], a[152:155], v[48:51], v[80:83]
 s_add_u32 m0, s49, 7936
 v_mfma_f32_16x16x32_bf16 v[88:91], a[224:227], v[48:51], v[88:91]
 buffer_load_dwordx4 v10, s[8:11], s46 offen offset:256  lds
 v_mfma_f32_16x16x32_bf16 v[68:71], a[8:11], v[52:55], v[68:71]
 s_add_u32 m0, s49, 11904
 v_mfma_f32_16x16x32_bf16 v[76:79], a[80:83], v[52:55], v[76:79]
 buffer_load_dwordx4 v10, s[8:11], s46 offen offset:384  lds
 v_mfma_f32_16x16x32_bf16 v[84:87], a[152:155], v[52:55], v[84:87]
 v_mfma_f32_16x16x32_bf16 v[92:95], a[224:227], v[52:55], v[92:95]
 s_waitcnt lgkmcnt(2)
 v_mfma_f32_16x16x32_bf16 v[64:67], a[12:15], v[56:59], v[64:67]
 ds_read_b128 v[40:43], v7 offset:8192
 v_mfma_f32_16x16x32_bf16 v[72:75], a[84:87], v[56:59], v[72:75]
 ds_read_b128 v[44:47], v7 offset:10240
 v_mfma_f32_16x16x32_bf16 v[80:83], a[156:159], v[56:59], v[80:83]
 s_add_u32 m0, s49, 15872
 v_mfma_f32_16x16x32_bf16 v[88:91], a[228:231], v[56:59], v[88:91]
 buffer_load_dwordx4 v10, s[8:11], s46 offen offset:512  lds
 v_mfma_f32_16x16x32_bf16 v[68:71], a[12:15], v[60:63], v[68:71]
 s_add_u32 m0, s49, 19840
 v_mfma_f32_16x16x32_bf16 v[76:79], a[84:87], v[60:63], v[76:79]
 buffer_load_dwordx4 v10, s[8:11], s46 offen offset:640  lds
 v_mfma_f32_16x16x32_bf16 v[84:87], a[156:159], v[60:63], v[84:87]
 s_add_u32 s60, s39, 1
 v_mfma_f32_16x16x32_bf16 v[92:95], a[228:231], v[60:63], v[92:95]
 s_waitcnt lgkmcnt(2)
 v_mfma_f32_16x16x32_bf16 v[64:67], a[16:19], v[32:35], v[64:67]
 ds_read_b128 v[48:51], v6 offset:12288
 v_mfma_f32_16x16x32_bf16 v[72:75], a[88:91], v[32:35], v[72:75]
 ds_read_b128 v[52:55], v6 offset:14336
 v_mfma_f32_16x16x32_bf16 v[80:83], a[160:163], v[32:35], v[80:83]
 s_add_u32 m0, s49, 23808
 v_mfma_f32_16x16x32_bf16 v[88:91], a[232:235], v[32:35], v[88:91]
 buffer_load_dwordx4 v10, s[8:11], s46 offen offset:768  lds
 v_mfma_f32_16x16x32_bf16 v[68:71], a[16:19], v[36:39], v[68:71]
 s_add_u32 m0, s49, 27776
 v_mfma_f32_16x16x32_bf16 v[76:79], a[88:91], v[36:39], v[76:79]
 buffer_load_dwordx4 v10, s[8:11], s46 offen offset:896  lds
 v_mfma_f32_16x16x32_bf16 v[84:87], a[160:163], v[36:39], v[84:87]
 v_mfma_f32_16x16x32_bf16 v[92:95], a[232:235], v[36:39], v[92:95]
 s_waitcnt lgkmcnt(2)
 v_mfma_f32_16x16x32_bf16 v[64:67], a[20:23], v[40:43], v[64:67]
 ds_read_b128 v[56:59], v7 offset:12288
 v_mfma_f32_16x16x32_bf16 v[72:75], a[92:95], v[40:43], v[72:75]
 ds_read_b128 v[60:63], v7 offset:14336
 v_mfma_f32_16x16x32_bf16 v[80:83], a[164:167], v[40:43], v[80:83]
 s_add_u32 m0, s49, 31744
 v_mfma_f32_16x16x32_bf16 v[88:91], a[236:239], v[40:43], v[88:91]
 buffer_load_dwordx4 v10, s[8:11], s46 offen offset:1024  lds
 v_mfma_f32_16x16x32_bf16 v[68:71], a[20:23], v[44:47], v[68:71]
 v_mfma_f32_16x16x32_bf16 v[76:79], a[92:95], v[44:47], v[76:79]
 v_mfma_f32_16x16x32_bf16 v[84:87], a[164:167], v[44:47], v[84:87]
 v_mfma_f32_16x16x32_bf16 v[92:95], a[236:239], v[44:47], v[92:95]
 s_waitcnt lgkmcnt(2)
 v_mfma_f32_16x16x32_bf16 v[64:67], a[24:27], v[48:51], v[64:67]
 ds_read_b128 v[32:35], v6 offset:16384
 v_mfma_f32_16x16x32_bf16 v[72:75], a[96:99], v[48:51], v[72:75]
 ds_read_b128 v[36:39], v6 offset:18432
 v_mfma_f32_16x16x32_bf16 v[80:83], a[168:171], v[48:51], v[80:83]
 s_waitcnt vmcnt(9)
 buffer_load_dword v17, v11, s[20:23], s56 offen sc1
 v_mfma_f32_16x16x32_bf16 v[88:91], a[240:243], v[48:51], v[88:91]
 s_barrier
 buffer_store_dword v14, v8, s[20:23], s59 offen sc1
 v_mfma_f32_16x16x32_bf16 v[68:71], a[24:27], v[52:55], v[68:71]
 buffer_load_dword v16, v15, s[20:23], s57 offen sc1
 v_mfma_f32_16x16x32_bf16 v[76:79], a[96:99], v[52:55], v[76:79]
 v_mfma_f32_16x16x32_bf16 v[84:87], a[168:171], v[52:55], v[84:87]
 s_lshl_b32 s56, s39, 18
 s_add_u32 s56, s56, s63
 v_mfma_f32_16x16x32_bf16 v[92:95], a[240:243], v[52:55], v[92:95]
 s_waitcnt lgkmcnt(2)
 v_mfma_f32_16x16x32_bf16 v[64:67], a[28:31], v[56:59], v[64:67]
 ds_read_b128 v[40:43], v7 offset:16384
 v_mfma_f32_16x16x32_bf16 v[72:75], a[100:103], v[56:59], v[72:75]
 ds_read_b128 v[44:47], v7 offset:18432
 v_mfma_f32_16x16x32_bf16 v[80:83], a[172:175], v[56:59], v[80:83]
 buffer_load_dwordx4 v[128:131], v1, s[20:23], s53 offen offset:0 sc1
 v_mfma_f32_16x16x32_bf16 v[88:91], a[244:247], v[56:59], v[88:91]
 v_mfma_f32_16x16x32_bf16 v[68:71], a[28:31], v[60:63], v[68:71]
 buffer_load_dwordx4 v[132:135], v1, s[20:23], s53 offen offset:1024 sc1
 v_mfma_f32_16x16x32_bf16 v[76:79], a[100:103], v[60:63], v[76:79]
 v_mfma_f32_16x16x32_bf16 v[84:87], a[172:175], v[60:63], v[84:87]
 v_mfma_f32_16x16x32_bf16 v[92:95], a[244:247], v[60:63], v[92:95]
 s_waitcnt lgkmcnt(2)
 v_mfma_f32_16x16x32_bf16 v[64:67], a[32:35], v[32:35], v[64:67]
 ds_read_b128 v[48:51], v6 offset:20480
 v_mfma_f32_16x16x32_bf16 v[72:75], a[104:107], v[32:35], v[72:75]
 ds_read_b128 v[52:55], v6 offset:22528
 v_mfma_f32_16x16x32_bf16 v[80:83], a[176:179], v[32:35], v[80:83]
 buffer_load_dwordx4 v[136:139], v1, s[20:23], s53 offen offset:2048 sc1
 v_mfma_f32_16x16x32_bf16 v[88:91], a[248:251], v[32:35], v[88:91]
 v_mfma_f32_16x16x32_bf16 v[68:71], a[32:35], v[36:39], v[68:71]
 buffer_load_dwordx4 v[140:143], v1, s[20:23], s53 offen offset:3072 sc1
 v_mfma_f32_16x16x32_bf16 v[76:79], a[104:107], v[36:39], v[76:79]
 v_mfma_f32_16x16x32_bf16 v[84:87], a[176:179], v[36:39], v[84:87]
 s_add_u32 s53, s53, 4096
 v_mfma_f32_16x16x32_bf16 v[92:95], a[248:251], v[36:39], v[92:95]
 s_waitcnt lgkmcnt(2)
 v_mfma_f32_16x16x32_bf16 v[64:67], a[36:39], v[40:43], v[64:67]
 ds_read_b128 v[56:59], v7 offset:20480
 v_mfma_f32_16x16x32_bf16 v[72:75], a[108:111], v[40:43], v[72:75]
 ds_read_b128 v[60:63], v7 offset:22528
 v_mfma_f32_16x16x32_bf16 v[80:83], a[180:183], v[40:43], v[80:83]
 buffer_load_dwordx4 v[144:147], v1, s[20:23], s53 offen offset:0 sc1
 v_mfma_f32_16x16x32_bf16 v[88:91], a[252:255], v[40:43], v[88:91]
 v_mfma_f32_16x16x32_bf16 v[68:71], a[36:39], v[44:47], v[68:71]
 buffer_load_dwordx4 v[148:151], v1, s[20:23], s53 offen offset:1024 sc1
 v_mfma_f32_16x16x32_bf16 v[76:79], a[108:111], v[44:47], v[76:79]
 v_mfma_f32_16x16x32_bf16 v[84:87], a[180:183], v[44:47], v[84:87]
 v_mfma_f32_16x16x32_bf16 v[92:95], a[252:255], v[44:47], v[92:95]
 s_waitcnt lgkmcnt(2)
 v_mfma_f32_16x16x32_bf16 v[64:67], a[40:43], v[48:51], v[64:67]
 ds_read_b128 v[32:35], v6 offset:24576
 v_mfma_f32_16x16x32_bf16 v[72:75], a[112:115], v[48:51], v[72:75]
 ds_read_b128 v[36:39], v6 offset:26624
 v_mfma_f32_16x16x32_bf16 v[80:83], a[184:187], v[48:51], v[80:83]
 buffer_load_dwordx4 v[152:155], v1, s[20:23], s53 offen offset:2048 sc1
 v_mfma_f32_16x16x32_bf16 v[88:91], v[224:227], v[48:51], v[88:91]
 v_mfma_f32_16x16x32_bf16 v[68:71], a[40:43], v[52:55], v[68:71]
 buffer_load_dwordx4 v[156:159], v1, s[20:23], s53 offen offset:3072 sc1
 v_mfma_f32_16x16x32_bf16 v[76:79], a[112:115], v[52:55], v[76:79]
 v_mfma_f32_16x16x32_bf16 v[84:87], a[184:187], v[52:55], v[84:87]
 s_add_u32 s53, s53, 4096
 v_mfma_f32_16x16x32_bf16 v[92:95], v[224:227], v[52:55], v[92:95]
 s_waitcnt lgkmcnt(2)
 v_mfma_f32_16x16x32_bf16 v[64:67], a[44:47], v[56:59], v[64:67]
 ds_read_b128 v[40:43], v7 offset:24576
 v_mfma_f32_16x16x32_bf16 v[72:75], a[116:119], v[56:59], v[72:75]
 ds_read_b128 v[44:47], v7 offset:26624
 v_mfma_f32_16x16x32_bf16 v[80:83], a[188:191], v[56:59], v[80:83]
 buffer_load_dwordx4 v[160:163], v1, s[20:23], s53 offen offset:0 sc1
 v_mfma_f32_16x16x32_bf16 v[88:91], v[228:231], v[56:59], v[88:91]
 v_mfma_f32_16x16x32_bf16 v[68:71], a[44:47], v[60:63], v[68:71]
 buffer_load_dwordx4 v[164:167], v1, s[20:23], s53 offen offset:1024 sc1
 v_mfma_f32_16x16x32_bf16 v[76:79], a[116:119], v[60:63], v[76:79]
 v_mfma_f32_16x16x32_bf16 v[84:87], a[188:191], v[60:63], v[84:87]
 v_mfma_f32_16x16x32_bf16 v[92:95], v[228:231], v[60:63], v[92:95]
 s_waitcnt lgkmcnt(2)
 v_mfma_f32_16x16x32_bf16 v[64:67], a[48:51], v[32:35], v[64:67]
 ds_read_b128 v[48:51], v6 offset:28672
 v_mfma_f32_16x16x32_bf16 v[72:75], a[120:123], v[32:35], v[72:75]
 ds_read_b128 v[52:55], v6 offset:30720
 v_mfma_f32_16x16x32_bf16 v[80:83], a[192:195], v[32:35], v[80:83]
 buffer_load_dwordx4 v[168:171], v1, s[20:23], s53 offen offset:2048 sc1
 v_mfma_f32_16x16x32_bf16 v[88:91], v[232:235], v[32:35], v[88:91]
 v_mfma_f32_16x16x32_bf16 v[68:71], a[48:51], v[36:39], v[68:71]
 buffer_load_dwordx4 v[172:175], v1, s[20:23], s53 offen offset:3072 sc1
 v_mfma_f32_16x16x32_bf16 v[76:79], a[120:123], v[36:39], v[76:79]
 v_mfma_f32_16x16x32_bf16 v[84:87], a[192:195], v[36:39], v[84:87]
 s_add_u32 s53, s53, 4096
 v_mfma_f32_16x16x32_bf16 v[92:95], v[232:235], v[36:39], v[92:95]
 s_waitcnt lgkmcnt(2)
 v_mfma_f32_16x16x32_bf16 v[64:67], a[52:55], v[40:43], v[64:67]
 ds_read_b128 v[56:59], v7 offset:28672
 v_mfma_f32_16x16x32_bf16 v[72:75], a[124:127], v[40:43], v[72:75]
 ds_read_b128 v[60:63], v7 offset:30720
 v_mfma_f32_16x16x32_bf16 v[80:83], a[196:199], v[40:43], v[80:83]
 s_add_u32 s43, s43, 36864
 s_cmp_eq_u32 s43, 147456
 buffer_load_dwordx4 v[176:179], v1, s[20:23], s53 offen offset:0 sc1
 v_mfma_f32_16x16x32_bf16 v[88:91], v[236:239], v[40:43], v[88:91]
 s_cselect_b32 s43, 0, s43
 s_add_u32 s44, s44, 36864
 v_mfma_f32_16x16x32_bf16 v[68:71], a[52:55], v[44:47], v[68:71]
 s_cmp_eq_u32 s44, 147456
 s_cselect_b32 s44, 0, s44
 buffer_load_dwordx4 v[180:183], v1, s[20:23], s53 offen offset:1024 sc1
 v_mfma_f32_16x16x32_bf16 v[76:79], a[124:127], v[44:47], v[76:79]
 v_mfma_f32_16x16x32_bf16 v[84:87], a[196:199], v[44:47], v[84:87]
 v_mfma_f32_16x16x32_bf16 v[92:95], v[236:239], v[44:47], v[92:95]
 s_waitcnt lgkmcnt(2)
 v_mfma_f32_16x16x32_bf16 v[64:67], a[56:59], v[48:51], v[64:67]
 ds_read_b128 v[32:35], v6 offset:32768
 v_mfma_f32_16x16x32_bf16 v[72:75], a[128:131], v[48:51], v[72:75]
 ds_read_b128 v[36:39], v6 offset:34816
 v_mfma_f32_16x16x32_bf16 v[80:83], a[200:203], v[48:51], v[80:83]
 v_add_u32 v6, s43, v4
 buffer_load_dwordx4 v[184:187], v1, s[20:23], s53 offen offset:2048 sc1
 v_mfma_f32_16x16x32_bf16 v[88:91], v[240:243], v[48:51], v[88:91]
 v_mfma_f32_16x16x32_bf16 v[68:71], a[56:59], v[52:55], v[68:71]
 buffer_load_dwordx4 v[188:191], v1, s[20:23], s53 offen offset:3072 sc1
 v_mfma_f32_16x16x32_bf16 v[76:79], a[128:131], v[52:55], v[76:79]
 v_mfma_f32_16x16x32_bf16 v[84:87], a[200:203], v[52:55], v[84:87]
 v_mfma_f32_16x16x32_bf16 v[92:95], v[240:243], v[52:55], v[92:95]
 s_waitcnt lgkmcnt(2)
 v_mfma_f32_16x16x32_bf16 v[64:67], a[60:63], v[56:59], v[64:67]
 ds_read_b128 v[40:43], v7 offset:32768
 v_mfma_f32_16x16x32_bf16 v[72:75], a[132:135], v[56:59], v[72:75]
 ds_read_b128 v[44:47], v7 offset:34816
 v_mfma_f32_16x16x32_bf16 v[80:83], a[204:207], v[56:59], v[80:83]
 v_add_u32 v7, s43, v5
 v_mfma_f32_16x16x32_bf16 v[88:91], v[244:247], v[56:59], v[88:91]
 v_mfma_f32_16x16x32_bf16 v[68:71], a[60:63], v[60:63], v[68:71]
 v_mfma_f32_16x16x32_bf16 v[76:79], a[132:135], v[60:63], v[76:79]
 v_mfma_f32_16x16x32_bf16 v[84:87], a[204:207], v[60:63], v[84:87]
 v_mfma_f32_16x16x32_bf16 v[92:95], v[244:247], v[60:63], v[92:95]
 s_waitcnt lgkmcnt(2)
 v_mfma_f32_16x16x32_bf16 v[64:67], a[64:67], v[32:35], v[64:67]
 s_waitcnt vmcnt(28)
 s_barrier
 ds_read_b128 v[48:51], v6 offset:0
 v_mfma_f32_16x16x32_bf16 v[72:75], a[136:139], v[32:35], v[72:75]
 ds_read_b128 v[52:55], v6 offset:2048
 v_mfma_f32_16x16x32_bf16 v[80:83], a[208:211], v[32:35], v[80:83]
 v_mfma_f32_16x16x32_bf16 v[88:91], v[248:251], v[32:35], v[88:91]
 s_waitcnt vmcnt(16)
 v_cmp_le_u32 vcc, s60, v16
 v_mfma_f32_16x16x32_bf16 v[68:71], a[64:67], v[36:39], v[68:71]
 v_mfma_f32_16x16x32_bf16 v[76:79], a[136:139], v[36:39], v[76:79]
 s_and_b32 s64, vcc_lo, 1
 s_cbranch_scc0 Lqsk_42
 buffer_load_dwordx4 v[192:195], v1, s[20:23], s55 offen offset:0 sc1
 buffer_load_dwordx4 v[196:199], v1, s[20:23], s55 offen offset:1024 sc1
 buffer_load_dwordx4 v[200:203], v1, s[20:23], s55 offen offset:2048 sc1
 buffer_load_dwordx4 v[204:207], v1, s[20:23], s55 offen offset:3072 sc1
Lqsk_42:
 v_mfma_f32_16x16x32_bf16 v[84:87], a[208:211], v[36:39], v[84:87]
 v_mfma_f32_16x16x32_bf16 v[92:95], v[248:251], v[36:39], v[92:95]
 s_waitcnt lgkmcnt(2)
 v_mfma_f32_16x16x32_bf16 v[64:67], a[68:71], v[40:43], v[64:67]
 ds_read_b128 v[56:59], v7 offset:0
 v_mfma_f32_16x16x32_bf16 v[72:75], a[140:143], v[40:43], v[72:75]
 ds_read_b128 v[60:63], v7 offset:2048
 v_mfma_f32_16x16x32_bf16 v[80:83], a[212:215], v[40:43], v[80:83]
 v_mfma_f32_16x16x32_bf16 v[88:91], v[252:255], v[40:43], v[88:91]
 s_mov_b32 s39, s40
 s_mov_b32 s40, s41
 v_mfma_f32_16x16x32_bf16 v[68:71], a[68:71], v[44:47], v[68:71]
 s_add_u32 s42, s42, 1
 v_mov_b32 v14, s42
 v_mfma_f32_16x16x32_bf16 v[76:79], a[140:143], v[44:47], v[76:79]
 v_mfma_f32_16x16x32_bf16 v[84:87], a[212:215], v[44:47], v[84:87]
 v_mfma_f32_16x16x32_bf16 v[92:95], v[252:255], v[44:47], v[92:95]
 s_waitcnt lgkmcnt(2)
 s_nop 7
 v_cvt_pk_bf16_f32 v16, v64, v72
 v_cvt_pk_bf16_f32 v17, v65, v73
 v_cvt_pk_bf16_f32 v18, v66, v74
 v_cvt_pk_bf16_f32 v19, v67, v75
 ds_write_b128 v2, v[16:19] offset:0
 v_cvt_pk_bf16_f32 v20, v68, v76
 v_cvt_pk_bf16_f32 v21, v69, v77
 v_cvt_pk_bf16_f32 v22, v70, v78
 v_cvt_pk_bf16_f32 v23, v71, v79
 ds_write_b128 v2, v[20:23] offset:1024
 v_cvt_pk_bf16_f32 v24, v80, v88
 v_cvt_pk_bf16_f32 v25, v81, v89
 v_cvt_pk_bf16_f32 v26, v82, v90
 v_cvt_pk_bf16_f32 v27, v83, v91
 ds_write_b128 v2, v[24:27] offset:8192
 v_cvt_pk_bf16_f32 v28, v84, v92
 v_cvt_pk_bf16_f32 v29, v85, v93
 v_cvt_pk_bf16_f32 v30, v86, v94
 v_cvt_pk_bf16_f32 v31, v87, v95
 ds_write_b128 v2, v[28:31] offset:9216
 v_mov_b64 v[120:121], 0
 v_mov_b64 v[122:123], 0
 s_waitcnt lgkmcnt(0)
 s_barrier
 ds_read_b128 v[96:99], v3 offset:0
 ds_read_b128 v[100:103], v3 offset:2048
 ds_read_b128 v[104:107], v3 offset:4096
 ds_read_b128 v[108:111], v3 offset:6144
 s_cmp_lg_u32 s64, 0
 s_cbranch_scc1 Lqpre_43
Lqs_44:
 buffer_load_dword v16, v15, s[20:23], s57 offen sc1
 s_waitcnt vmcnt(0)
 v_cmp_le_u32 vcc, s60, v16
 s_cbranch_vccnz Lqsk_45
 s_sleep 2
 s_sub_u32 s58, s58, 1
 s_cbranch_scc0 Lqs_44
 s_endpgm
Lqsk_45:
 buffer_load_dwordx4 v[192:195], v1, s[20:23], s55 offen offset:0 sc1
 buffer_load_dwordx4 v[196:199], v1, s[20:23], s55 offen offset:1024 sc1
 buffer_load_dwordx4 v[200:203], v1, s[20:23], s55 offen offset:2048 sc1
 buffer_load_dwordx4 v[204:207], v1, s[20:23], s55 offen offset:3072 sc1
Lqpre_43:
 s_waitcnt vmcnt(4) lgkmcnt(0)
 v_mfma_f32_16x16x32_bf16 v[112:115], v[128:131], v[96:99], v[208:211]
 v_mfma_f32_16x16x32_bf16 v[116:119], v[132:135], v[96:99], v[212:215]
 v_mfma_f32_16x16x32_bf16 v[112:115], v[136:139], v[100:103], v[112:115]
 v_mfma_f32_16x16x32_bf16 v[116:119], v[140:143], v[100:103], v[116:119]
 v_mfma_f32_16x16x32_bf16 v[112:115], v[144:147], v[104:107], v[112:115]
 v_mfma_f32_16x16x32_bf16 v[116:119], v[148:151], v[104:107], v[116:119]
 v_mfma_f32_16x16x32_bf16 v[112:115], v[152:155], v[108:111], v[112:115]
 v_mfma_f32_16x16x32_bf16 v[116:119], v[156:159], v[108:111], v[116:119]
 s_nop 7
 v_max3_f32 v24, v112, v113, v114
 v_max3_f32 v24, v24, v115, v116
 v_max3_f32 v24, v24, v117, v118
 v_max_f32 v24, v24, v119
 s_waitcnt vmcnt(2)
 v_mov_b64 v[16:17], v[192:193]
 v_mov_b64 v[18:19], v[196:197]
 s_nop 1
 v_smfmac_f32_16x16x64_bf16 v[120:123], v[16:19], v[96:103], v12
 s_waitcnt vmcnt(0)
 v_mov_b64 v[20:21], v[200:201]
 v_mov_b64 v[22:23], v[204:205]
 s_nop 1
 v_smfmac_f32_16x16x64_bf16 v[120:123], v[20:23], v[104:111], v12
 s_nop 7
 v_add_f32 v120, v120, v122
 v_add_f32 v121, v121, v123
 v_mul_f32 v120, s50, v120
 v_mul_f32 v121, s50, v121
 v_max3_f32 v24, v24, v120, v121
 v_mov_b32 v25, v24
 s_nop 1
 v_permlane16_swap_b32 v24, v25
 v_max_f32 v24, v24, v25
 v_mov_b32 v25, v24
 s_nop 1
 v_permlane32_swap_b32 v24, v25
 v_max_f32 v24, v24, v25
 v_sub_f32 v112, v112, v24
 v_sub_f32 v113, v113, v24
 v_sub_f32 v114, v114, v24
 v_sub_f32 v115, v115, v24
 v_sub_f32 v116, v116, v24
 v_sub_f32 v117, v117, v24
 v_sub_f32 v118, v118, v24
 v_sub_f32 v119, v119, v24
 v_sub_f32 v120, v120, v24
 v_sub_f32 v121, v121, v24
 v_exp_f32 v120, v120
 v_exp_f32 v121, v121
 v_exp_f32 v112, v112
 v_exp_f32 v113, v113
 v_exp_f32 v114, v114
 v_exp_f32 v115, v115
 v_exp_f32 v116, v116
 v_exp_f32 v117, v117
 v_exp_f32 v118, v118
 v_exp_f32 v119, v119
 v_cvt_pk_bf16_f32 v216, v120, v121
 v_cvt_pk_bf16_f32 v219, v120, v121
 v_cvt_pk_bf16_f32 v28, v112, v113
 v_cvt_pk_bf16_f32 v29, v116, v117
 v_cvt_pk_bf16_f32 v30, v114, v115
 v_cvt_pk_bf16_f32 v31, v118, v119
 v_mfma_f32_16x16x16_bf16 v[124:127], v[220:221], v[216:217], 0
 v_mfma_f32_16x16x16_bf16 v[64:67], v[194:195], v[216:217], 0
 v_mfma_f32_16x16x16_bf16 v[68:71], v[194:195], v[218:219], 0
 v_mfma_f32_16x16x16_bf16 v[72:75], v[198:199], v[216:217], 0
 v_mfma_f32_16x16x16_bf16 v[76:79], v[198:199], v[218:219], 0
 v_mfma_f32_16x16x16_bf16 v[80:83], v[202:203], v[216:217], 0
 v_mfma_f32_16x16x16_bf16 v[84:87], v[202:203], v[218:219], 0
 v_mfma_f32_16x16x16_bf16 v[88:91], v[206:207], v[216:217], 0
 v_mfma_f32_16x16x16_bf16 v[92:95], v[206:207], v[218:219], 0
 v_mfma_f32_16x16x32_bf16 v[124:127], v[220:223], v[28:31], v[124:127]
 v_mfma_f32_16x16x32_bf16 v[64:67], v[160:163], v[28:31], v[64:67]
 v_mfma_f32_16x16x32_bf16 v[68:71], v[164:167], v[28:31], v[68:71]
 v_mfma_f32_16x16x32_bf16 v[72:75], v[168:171], v[28:31], v[72:75]
 v_mfma_f32_16x16x32_bf16 v[76:79], v[172:175], v[28:31], v[76:79]
 v_mfma_f32_16x16x32_bf16 v[80:83], v[176:179], v[28:31], v[80:83]
 v_mfma_f32_16x16x32_bf16 v[84:87], v[180:183], v[28:31], v[84:87]
 v_mfma_f32_16x16x32_bf16 v[88:91], v[184:187], v[28:31], v[88:91]
 v_mfma_f32_16x16x32_bf16 v[92:95], v[188:191], v[28:31], v[92:95]
 v_rcp_f32 v124, v124
 s_add_u32 s45, s56, 4096
 v_mul_f32 v64, v64, v124
 v_mul_f32 v65, v65, v124
 v_mul_f32 v66, v66, v124
 v_mul_f32 v67, v67, v124
 v_mul_f32 v68, v68, v124
 v_mul_f32 v69, v69, v124
 v_mul_f32 v70, v70, v124
 v_mul_f32 v71, v71, v124
 v_cvt_pk_bf16_f32 v96, v64, v65
 v_cvt_pk_bf16_f32 v97, v68, v69
 v_cvt_pk_bf16_f32 v98, v66, v67
 v_cvt_pk_bf16_f32 v99, v70, v71
 buffer_store_dwordx4 v[96:99], v1, s[20:23], s56 offen offset:0 sc1
 v_mul_f32 v72, v72, v124
 v_mul_f32 v73, v73, v124
 v_mul_f32 v74, v74, v124
 v_mul_f32 v75, v75, v124
 v_mul_f32 v76, v76, v124
 v_mul_f32 v77, v77, v124
 v_mul_f32 v78, v78, v124
 v_mul_f32 v79, v79, v124
 v_cvt_pk_bf16_f32 v100, v72, v73
 v_cvt_pk_bf16_f32 v101, v76, v77
 v_cvt_pk_bf16_f32 v102, v74, v75
 v_cvt_pk_bf16_f32 v103, v78, v79
 buffer_store_dwordx4 v[100:103], v1, s[20:23], s56 offen offset:2048 sc1
 v_mul_f32 v80, v80, v124
 v_mul_f32 v81, v81, v124
 v_mul_f32 v82, v82, v124
 v_mul_f32 v83, v83, v124
 v_mul_f32 v84, v84, v124
 v_mul_f32 v85, v85, v124
 v_mul_f32 v86, v86, v124
 v_mul_f32 v87, v87, v124
 v_cvt_pk_bf16_f32 v104, v80, v81
 v_cvt_pk_bf16_f32 v105, v84, v85
 v_cvt_pk_bf16_f32 v106, v82, v83
 v_cvt_pk_bf16_f32 v107, v86, v87
 buffer_store_dwordx4 v[104:107], v1, s[20:23], s45 offen offset:0 sc1
 v_mul_f32 v88, v88, v124
 v_mul_f32 v89, v89, v124
 v_mul_f32 v90, v90, v124
 v_mul_f32 v91, v91, v124
 v_mul_f32 v92, v92, v124
 v_mul_f32 v93, v93, v124
 v_mul_f32 v94, v94, v124
 v_mul_f32 v95, v95, v124
 v_cvt_pk_bf16_f32 v108, v88, v89
 v_cvt_pk_bf16_f32 v109, v92, v93
 v_cvt_pk_bf16_f32 v110, v90, v91
 v_cvt_pk_bf16_f32 v111, v94, v95
 buffer_store_dwordx4 v[108:111], v1, s[20:23], s45 offen offset:2048 sc1
 s_cmp_lt_u32 s42, s36
 s_cbranch_scc0 Lqb_out_41
 v_mfma_f32_16x16x32_bf16 v[64:67], a[0:3], v[48:51], 0
 ds_read_b128 v[32:35], v6 offset:4096
 v_mfma_f32_16x16x32_bf16 v[72:75], a[72:75], v[48:51], 0
 ds_read_b128 v[36:39], v6 offset:6144
 v_mfma_f32_16x16x32_bf16 v[80:83], a[144:147], v[48:51], 0
 s_add_u32 s41, s40, 2
 v_mfma_f32_16x16x32_bf16 v[88:91], a[216:219], v[48:51], 0
 s_add_u32 s45, s42, 2
 s_mul_i32 s46, s41, 36864
 v_mfma_f32_16x16x32_bf16 v[68:71], a[0:3], v[52:55], 0
 s_cmp_lt_u32 s45, s36
 s_cselect_b32 s46, s46, 0
 v_mfma_f32_16x16x32_bf16 v[76:79], a[72:75], v[52:55], 0
 s_lshl_b32 s49, s4, 10
 s_add_u32 s49, s49, s44
 v_mfma_f32_16x16x32_bf16 v[84:87], a[144:147], v[52:55], 0
 s_lshl_b32 s53, s39, 19
 s_add_u32 s53, s53, s61
 v_mfma_f32_16x16x32_bf16 v[92:95], a[216:219], v[52:55], 0
 s_waitcnt lgkmcnt(2)
 v_mfma_f32_16x16x32_bf16 v[64:67], a[4:7], v[56:59], v[64:67]
 ds_read_b128 v[40:43], v7 offset:4096
 v_mfma_f32_16x16x32_bf16 v[72:75], a[76:79], v[56:59], v[72:75]
 ds_read_b128 v[44:47], v7 offset:6144
 v_mfma_f32_16x16x32_bf16 v[80:83], a[148:151], v[56:59], v[80:83]
 s_add_u32 m0, s49, 0
 v_mfma_f32_16x16x32_bf16 v[88:91], a[220:223], v[56:59], v[88:91]
 buffer_load_dwordx4 v10, s[8:11], s46 offen offset:0  lds
 v_mfma_f32_16x16x32_bf16 v[68:71], a[4:7], v[60:63], v[68:71]
 s_add_u32 m0, s49, 3968
 v_mfma_f32_16x16x32_bf16 v[76:79], a[76:79], v[60:63], v[76:79]
 buffer_load_dwordx4 v10, s[8:11], s46 offen offset:128  lds
 v_mfma_f32_16x16x32_bf16 v[84:87], a[148:151], v[60:63], v[84:87]
 s_lshl_b32 s55, s39, 17
 s_add_u32 s55, s55, s62
 v_mfma_f32_16x16x32_bf16 v[92:95], a[220:223], v[60:63], v[92:95]
 s_waitcnt lgkmcnt(2)
 v_mfma_f32_16x16x32_bf16 v[64:67], a[8:11], v[32:35], v[64:67]
 ds_read_b128 v[48:51], v6 offset:8192
 v_mfma_f32_16x16x32_bf16 v[72:75], a[80:83], v[32:35], v[72:75]
 ds_read_b128 v[52:55], v6 offset:10240
 v_mfma_f32_16x16x32_bf16 v[80:83], a[152:155], v[32:35], v[80:83]
 s_add_u32 m0, s49, 7936
 v_mfma_f32_16x16x32_bf16 v[88:91], a[224:227], v[32:35], v[88:91]
 buffer_load_dwordx4 v10, s[8:11], s46 offen offset:256  lds
 v_mfma_f32_16x16x32_bf16 v[68:71], a[8:11], v[36:39], v[68:71]
 s_add_u32 m0, s49, 11904
 v_mfma_f32_16x16x32_bf16 v[76:79], a[80:83], v[36:39], v[76:79]
 buffer_load_dwordx4 v10, s[8:11], s46 offen offset:384  lds
 v_mfma_f32_16x16x32_bf16 v[84:87], a[152:155], v[36:39], v[84:87]
 v_mfma_f32_16x16x32_bf16 v[92:95], a[224:227], v[36:39], v[92:95]
 s_waitcnt lgkmcnt(2)
 v_mfma_f32_16x16x32_bf16 v[64:67], a[12:15], v[40:43], v[64:67]
 ds_read_b128 v[56:59], v7 offset:8192
 v_mfma_f32_16x16x32_bf16 v[72:75], a[84:87], v[40:43], v[72:75]
 ds_read_b128 v[60:63], v7 offset:10240
 v_mfma_f32_16x16x32_bf16 v[80:83], a[156:159], v[40:43], v[80:83]
 s_add_u32 m0, s49, 15872
 v_mfma_f32_16x16x32_bf16 v[88:91], a[228:231], v[40:43], v[88:91]
 buffer_load_dwordx4 v10, s[8:11], s46 offen offset:512  lds
 v_mfma_f32_16x16x32_bf16 v[68:71], a[12:15], v[44:47], v[68:71]
 s_add_u32 m0, s49, 19840
 v_mfma_f32_16x16x32_bf16 v[76:79], a[84:87], v[44:47], v[76:79]
 buffer_load_dwordx4 v10, s[8:11], s46 offen offset:640  lds
 v_mfma_f32_16x16x32_bf16 v[84:87], a[156:159], v[44:47], v[84:87]
 s_add_u32 s60, s39, 1
 v_mfma_f32_16x16x32_bf16 v[92:95], a[228:231], v[44:47], v[92:95]
 s_waitcnt lgkmcnt(2)
 v_mfma_f32_16x16x32_bf16 v[64:67], a[16:19], v[48:51], v[64:67]
 ds_read_b128 v[32:35], v6 offset:12288
 v_mfma_f32_16x16x32_bf16 v[72:75], a[88:91], v[48:51], v[72:75]
 ds_read_b128 v[36:39], v6 offset:14336
 v_mfma_f32_16x16x32_bf16 v[80:83], a[160:163], v[48:51], v[80:83]
 s_add_u32 m0, s49, 23808
 v_mfma_f32_16x16x32_bf16 v[88:91], a[232:235], v[48:51], v[88:91]
 buffer_load_dwordx4 v10, s[8:11], s46 offen offset:768  lds
 v_mfma_f32_16x16x32_bf16 v[68:71], a[16:19], v[52:55], v[68:71]
 s_add_u32 m0, s49, 27776
 v_mfma_f32_16x16x32_bf16 v[76:79], a[88:91], v[52:55], v[76:79]
 buffer_load_dwordx4 v10, s[8:11], s46 offen offset:896  lds
 v_mfma_f32_16x16x32_bf16 v[84:87], a[160:163], v[52:55], v[84:87]
 v_mfma_f32_16x16x32_bf16 v[92:95], a[232:235], v[52:55], v[92:95]
 s_waitcnt lgkmcnt(2)
 v_mfma_f32_16x16x32_bf16 v[64:67], a[20:23], v[56:59], v[64:67]
 ds_read_b128 v[40:43], v7 offset:12288
 v_mfma_f32_16x16x32_bf16 v[72:75], a[92:95], v[56:59], v[72:75]
 ds_read_b128 v[44:47], v7 offset:14336
 v_mfma_f32_16x16x32_bf16 v[80:83], a[164:167], v[56:59], v[80:83]
 s_add_u32 m0, s49, 31744
 v_mfma_f32_16x16x32_bf16 v[88:91], a[236:239], v[56:59], v[88:91]
 buffer_load_dwordx4 v10, s[8:11], s46 offen offset:1024  lds
 v_mfma_f32_16x16x32_bf16 v[68:71], a[20:23], v[60:63], v[68:71]
 v_mfma_f32_16x16x32_bf16 v[76:79], a[92:95], v[60:63], v[76:79]
 v_mfma_f32_16x16x32_bf16 v[84:87], a[164:167], v[60:63], v[84:87]
 v_mfma_f32_16x16x32_bf16 v[92:95], a[236:239], v[60:63], v[92:95]
 s_waitcnt lgkmcnt(2)
 v_mfma_f32_16x16x32_bf16 v[64:67], a[24:27], v[32:35], v[64:67]
 ds_read_b128 v[48:51], v6 offset:16384
 v_mfma_f32_16x16x32_bf16 v[72:75], a[96:99], v[32:35], v[72:75]
 ds_read_b128 v[52:55], v6 offset:18432
 v_mfma_f32_16x16x32_bf16 v[80:83], a[168:171], v[32:35], v[80:83]
 s_waitcnt vmcnt(9)
 buffer_load_dword v17, v11, s[20:23], s56 offen sc1
 v_mfma_f32_16x16x32_bf16 v[88:91], a[240:243], v[32:35], v[88:91]
 s_barrier
 buffer_store_dword v14, v8, s[20:23], s59 offen sc1
 v_mfma_f32_16x16x32_bf16 v[68:71], a[24:27], v[36:39], v[68:71]
 buffer_load_dword v16, v15, s[20:23], s57 offen sc1
 v_mfma_f32_16x16x32_bf16 v[76:79], a[96:99], v[36:39], v[76:79]
 v_mfma_f32_16x16x32_bf16 v[84:87], a[168:171], v[36:39], v[84:87]
 s_lshl_b32 s56, s39, 18
 s_add_u32 s56, s56, s63
 v_mfma_f32_16x16x32_bf16 v[92:95], a[240:243], v[36:39], v[92:95]
 s_waitcnt lgkmcnt(2)
 v_mfma_f32_16x16x32_bf16 v[64:67], a[28:31], v[40:43], v[64:67]
 ds_read_b128 v[56:59], v7 offset:16384
 v_mfma_f32_16x16x32_bf16 v[72:75], a[100:103], v[40:43], v[72:75]
 ds_read_b128 v[60:63], v7 offset:18432
 v_mfma_f32_16x16x32_bf16 v[80:83], a[172:175], v[40:43], v[80:83]
 buffer_load_dwordx4 v[128:131], v1, s[20:23], s53 offen offset:0 sc1
 v_mfma_f32_16x16x32_bf16 v[88:91], a[244:247], v[40:43], v[88:91]
 v_mfma_f32_16x16x32_bf16 v[68:71], a[28:31], v[44:47], v[68:71]
 buffer_load_dwordx4 v[132:135], v1, s[20:23], s53 offen offset:1024 sc1
 v_mfma_f32_16x16x32_bf16 v[76:79], a[100:103], v[44:47], v[76:79]
 v_mfma_f32_16x16x32_bf16 v[84:87], a[172:175], v[44:47], v[84:87]
 v_mfma_f32_16x16x32_bf16 v[92:95], a[244:247], v[44:47], v[92:95]
 s_waitcnt lgkmcnt(2)
 v_mfma_f32_16x16x32_bf16 v[64:67], a[32:35], v[48:51], v[64:67]
 ds_read_b128 v[32:35], v6 offset:20480
 v_mfma_f32_16x16x32_bf16 v[72:75], a[104:107], v[48:51], v[72:75]
 ds_read_b128 v[36:39], v6 offset:22528
 v_mfma_f32_16x16x32_bf16 v[80:83], a[176:179], v[48:51], v[80:83]
 buffer_load_dwordx4 v[136:139], v1, s[20:23], s53 offen offset:2048 sc1
 v_mfma_f32_16x16x32_bf16 v[88:91], a[248:251], v[48:51], v[88:91]
 v_mfma_f32_16x16x32_bf16 v[68:71], a[32:35], v[52:55], v[68:71]
 buffer_load_dwordx4 v[140:143], v1, s[20:23], s53 offen offset:3072 sc1
 v_mfma_f32_16x16x32_bf16 v[76:79], a[104:107], v[52:55], v[76:79]
 v_mfma_f32_16x16x32_bf16 v[84:87], a[176:179], v[52:55], v[84:87]
 s_add_u32 s53, s53, 4096
 v_mfma_f32_16x16x32_bf16 v[92:95], a[248:251], v[52:55], v[92:95]
 s_waitcnt lgkmcnt(2)
 v_mfma_f32_16x16x32_bf16 v[64:67], a[36:39], v[56:59], v[64:67]
 ds_read_b128 v[40:43], v7 offset:20480
 v_mfma_f32_16x16x32_bf16 v[72:75], a[108:111], v[56:59], v[72:75]
 ds_read_b128 v[44:47], v7 offset:22528
 v_mfma_f32_16x16x32_bf16 v[80:83], a[180:183], v[56:59], v[80:83]
 buffer_load_dwordx4 v[144:147], v1, s[20:23], s53 offen offset:0 sc1
 v_mfma_f32_16x16x32_bf16 v[88:91], a[252:255], v[56:59], v[88:91]
 v_mfma_f32_16x16x32_bf16 v[68:71], a[36:39], v[60:63], v[68:71]
 buffer_load_dwordx4 v[148:151], v1, s[20:23], s53 offen offset:1024 sc1
 v_mfma_f32_16x16x32_bf16 v[76:79], a[108:111], v[60:63], v[76:79]
 v_mfma_f32_16x16x32_bf16 v[84:87], a[180:183], v[60:63], v[84:87]
 v_mfma_f32_16x16x32_bf16 v[92:95], a[252:255], v[60:63], v[92:95]
 s_waitcnt lgkmcnt(2)
 v_mfma_f32_16x16x32_bf16 v[64:67], a[40:43], v[32:35], v[64:67]
 ds_read_b128 v[48:51], v6 offset:24576
 v_mfma_f32_16x16x32_bf16 v[72:75], a[112:115], v[32:35], v[72:75]
 ds_read_b128 v[52:55], v6 offset:26624
 v_mfma_f32_16x16x32_bf16 v[80:83], a[184:187], v[32:35], v[80:83]
 buffer_load_dwordx4 v[152:155], v1, s[20:23], s53 offen offset:2048 sc1
 v_mfma_f32_16x16x32_bf16 v[88:91], v[224:227], v[32:35], v[88:91]
 v_mfma_f32_16x16x32_bf16 v[68:71], a[40:43], v[36:39], v[68:71]
 buffer_load_dwordx4 v[156:159], v1, s[20:23], s53 offen offset:3072 sc1
 v_mfma_f32_16x16x32_bf16 v[76:79], a[112:115], v[36:39], v[76:79]
 v_mfma_f32_16x16x32_bf16 v[84:87], a[184:187], v[36:39], v[84:87]
 s_add_u32 s53, s53, 4096
 v_mfma_f32_16x16x32_bf16 v[92:95], v[224:227], v[36:39], v[92:95]
 s_waitcnt lgkmcnt(2)
 v_mfma_f32_16x16x32_bf16 v[64:67], a[44:47], v[40:43], v[64:67]
 ds_read_b128 v[56:59], v7 offset:24576
 v_mfma_f32_16x16x32_bf16 v[72:75], a[116:119], v[40:43], v[72:75]
 ds_read_b128 v[60:63], v7 offset:26624
 v_mfma_f32_16x16x32_bf16 v[80:83], a[188:191], v[40:43], v[80:83]
 buffer_load_dwordx4 v[160:163], v1, s[20:23], s53 offen offset:0 sc1
 v_mfma_f32_16x16x32_bf16 v[88:91], v[228:231], v[40:43], v[88:91]
 v_mfma_f32_16x16x32_bf16 v[68:71], a[44:47], v[44:47], v[68:71]
 buffer_load_dwordx4 v[164:167], v1, s[20:23], s53 offen offset:1024 sc1
 v_mfma_f32_16x16x32_bf16 v[76:79], a[116:119], v[44:47], v[76:79]
 v_mfma_f32_16x16x32_bf16 v[84:87], a[188:191], v[44:47], v[84:87]
 v_mfma_f32_16x16x32_bf16 v[92:95], v[228:231], v[44:47], v[92:95]
 s_waitcnt lgkmcnt(2)
 v_mfma_f32_16x16x32_bf16 v[64:67], a[48:51], v[48:51], v[64:67]
 ds_read_b128 v[32:35], v6 offset:28672
 v_mfma_f32_16x16x32_bf16 v[72:75], a[120:123], v[48:51], v[72:75]
 ds_read_b128 v[36:39], v6 offset:30720
 v_mfma_f32_16x16x32_bf16 v[80:83], a[192:195], v[48:51], v[80:83]
 buffer_load_dwordx4 v[168:171], v1, s[20:23], s53 offen offset:2048 sc1
 v_mfma_f32_16x16x32_bf16 v[88:91], v[232:235], v[48:51], v[88:91]
 v_mfma_f32_16x16x32_bf16 v[68:71], a[48:51], v[52:55], v[68:71]
 buffer_load_dwordx4 v[172:175], v1, s[20:23], s53 offen offset:3072 sc1
 v_mfma_f32_16x16x32_bf16 v[76:79], a[120:123], v[52:55], v[76:79]
 v_mfma_f32_16x16x32_bf16 v[84:87], a[192:195], v[52:55], v[84:87]
 s_add_u32 s53, s53, 4096
 v_mfma_f32_16x16x32_bf16 v[92:95], v[232:235], v[52:55], v[92:95]
 s_waitcnt lgkmcnt(2)
 v_mfma_f32_16x16x32_bf16 v[64:67], a[52:55], v[56:59], v[64:67]
 ds_read_b128 v[40:43], v7 offset:28672
 v_mfma_f32_16x16x32_bf16 v[72:75], a[124:127], v[56:59], v[72:75]
 ds_read_b128 v[44:47], v7 offset:30720
 v_mfma_f32_16x16x32_bf16 v[80:83], a[196:199], v[56:59], v[80:83]
 s_add_u32 s43, s43, 36864
 s_cmp_eq_u32 s43, 147456
 buffer_load_dwordx4 v[176:179], v1, s[20:23], s53 offen offset:0 sc1
 v_mfma_f32_16x16x32_bf16 v[88:91], v[236:239], v[56:59], v[88:91]
 s_cselect_b32 s43, 0, s43
 s_add_u32 s44, s44, 36864
 v_mfma_f32_16x16x32_bf16 v[68:71], a[52:55], v[60:63], v[68:71]
 s_cmp_eq_u32 s44, 147456
 s_cselect_b32 s44, 0, s44
 buffer_load_dwordx4 v[180:183], v1, s[20:23], s53 offen offset:1024 sc1
 v_mfma_f32_16x16x32_bf16 v[76:79], a[124:127], v[60:63], v[76:79]
 v_mfma_f32_16x16x32_bf16 v[84:87], a[196:199], v[60:63], v[84:87]
 v_mfma_f32_16x16x32_bf16 v[92:95], v[236:239], v[60:63], v[92:95]
 s_waitcnt lgkmcnt(2)
 v_mfma_f32_16x16x32_bf16 v[64:67], a[56:59], v[32:35], v[64:67]
 ds_read_b128 v[48:51], v6 offset:32768
 v_mfma_f32_16x16x32_bf16 v[72:75], a[128:131], v[32:35], v[72:75]
 ds_read_b128 v[52:55], v6 offset:34816
 v_mfma_f32_16x16x32_bf16 v[80:83], a[200:203], v[32:35], v[80:83]
 v_add_u32 v6, s43, v4
 buffer_load_dwordx4 v[184:187], v1, s[20:23], s53 offen offset:2048 sc1
 v_mfma_f32_16x16x32_bf16 v[88:91], v[240:243], v[32:35], v[88:91]
 v_mfma_f32_16x16x32_bf16 v[68:71], a[56:59], v[36:39], v[68:71]
 buffer_load_dwordx4 v[188:191], v1, s[20:23], s53 offen offset:3072 sc1
 v_mfma_f32_16x16x32_bf16 v[76:79], a[128:131], v[36:39], v[76:79]
 v_mfma_f32_16x16x32_bf16 v[84:87], a[200:203], v[36:39], v[84:87]
 v_mfma_f32_16x16x32_bf16 v[92:95], v[240:243], v[36:39], v[92:95]
 s_waitcnt lgkmcnt(2)
 v_mfma_f32_16x16x32_bf16 v[64:67], a[60:63], v[40:43], v[64:67]
 ds_read_b128 v[56:59], v7 offset:32768
 v_mfma_f32_16x16x32_bf16 v[72:75], a[132:135], v[40:43], v[72:75]
 ds_read_b128 v[60:63], v7 offset:34816
 v_mfma_f32_16x16x32_bf16 v[80:83], a[204:207], v[40:43], v[80:83]
 v_add_u32 v7, s43, v5
 v_mfma_f32_16x16x32_bf16 v[88:91], v[244:247], v[40:43], v[88:91]
 v_mfma_f32_16x16x32_bf16 v[68:71], a[60:63], v[44:47], v[68:71]
 v_mfma_f32_16x16x32_bf16 v[76:79], a[132:135], v[44:47], v[76:79]
 v_mfma_f32_16x16x32_bf16 v[84:87], a[204:207], v[44:47], v[84:87]
 v_mfma_f32_16x16x32_bf16 v[92:95], v[244:247], v[44:47], v[92:95]
 s_waitcnt lgkmcnt(2)
 v_mfma_f32_16x16x32_bf16 v[64:67], a[64:67], v[48:51], v[64:67]
 s_waitcnt vmcnt(28)
 s_barrier
 ds_read_b128 v[32:35], v6 offset:0
 v_mfma_f32_16x16x32_bf16 v[72:75], a[136:139], v[48:51], v[72:75]
 ds_read_b128 v[36:39], v6 offset:2048
 v_mfma_f32_16x16x32_bf16 v[80:83], a[208:211], v[48:51], v[80:83]
 v_mfma_f32_16x16x32_bf16 v[88:91], v[248:251], v[48:51], v[88:91]
 s_waitcnt vmcnt(16)
 v_cmp_le_u32 vcc, s60, v16
 v_mfma_f32_16x16x32_bf16 v[68:71], a[64:67], v[52:55], v[68:71]
 v_mfma_f32_16x16x32_bf16 v[76:79], a[136:139], v[52:55], v[76:79]
 s_and_b32 s64, vcc_lo, 1
 s_cbranch_scc0 Lqsk_46
 buffer_load_dwordx4 v[192:195], v1, s[20:23], s55 offen offset:0 sc1
 buffer_load_dwordx4 v[196:199], v1, s[20:23], s55 offen offset:1024 sc1
 buffer_load_dwordx4 v[200:203], v1, s[20:23], s55 offen offset:2048 sc1
 buffer_load_dwordx4 v[204:207], v1, s[20:23], s55 offen offset:3072 sc1
Lqsk_46:
 v_mfma_f32_16x16x32_bf16 v[84:87], a[208:211], v[52:55], v[84:87]
 v_mfma_f32_16x16x32_bf16 v[92:95], v[248:251], v[52:55], v[92:95]
 s_waitcnt lgkmcnt(2)
 v_mfma_f32_16x16x32_bf16 v[64:67], a[68:71], v[56:59], v[64:67]
 ds_read_b128 v[40:43], v7 offset:0
 v_mfma_f32_16x16x32_bf16 v[72:75], a[140:143], v[56:59], v[72:75]
 ds_read_b128 v[44:47], v7 offset:2048
 v_mfma_f32_16x16x32_bf16 v[80:83], a[212:215], v[56:59], v[80:83]
 v_mfma_f32_16x16x32_bf16 v[88:91], v[252:255], v[56:59], v[88:91]
 s_mov_b32 s39, s40
 s_mov_b32 s40, s41
 v_mfma_f32_16x16x32_bf16 v[68:71], a[68:71], v[60:63], v[68:71]
 s_add_u32 s42, s42, 1
 v_mov_b32 v14, s42
 v_mfma_f32_16x16x32_bf16 v[76:79], a[140:143], v[60:63], v[76:79]
 v_mfma_f32_16x16x32_bf16 v[84:87], a[212:215], v[60:63], v[84:87]
 v_mfma_f32_16x16x32_bf16 v[92:95], v[252:255], v[60:63], v[92:95]
 s_waitcnt lgkmcnt(2)
 s_nop 7
 v_cvt_pk_bf16_f32 v16, v64, v72
 v_cvt_pk_bf16_f32 v17, v65, v73
 v_cvt_pk_bf16_f32 v18, v66, v74
 v_cvt_pk_bf16_f32 v19, v67, v75
 ds_write_b128 v2, v[16:19] offset:0
 v_cvt_pk_bf16_f32 v20, v68, v76
 v_cvt_pk_bf16_f32 v21, v69, v77
 v_cvt_pk_bf16_f32 v22, v70, v78
 v_cvt_pk_bf16_f32 v23, v71, v79
 ds_write_b128 v2, v[20:23] offset:1024
 v_cvt_pk_bf16_f32 v24, v80, v88
 v_cvt_pk_bf16_f32 v25, v81, v89
 v_cvt_pk_bf16_f32 v26, v82, v90
 v_cvt_pk_bf16_f32 v27, v83, v91
 ds_write_b128 v2, v[24:27] offset:8192
 v_cvt_pk_bf16_f32 v28, v84, v92
 v_cvt_pk_bf16_f32 v29, v85, v93
 v_cvt_pk_bf16_f32 v30, v86, v94
 v_cvt_pk_bf16_f32 v31, v87, v95
 ds_write_b128 v2, v[28:31] offset:9216
 v_mov_b64 v[120:121], 0
 v_mov_b64 v[122:123], 0
 s_waitcnt lgkmcnt(0)
 s_barrier
 ds_read_b128 v[96:99], v3 offset:0
 ds_read_b128 v[100:103], v3 offset:2048
 ds_read_b128 v[104:107], v3 offset:4096
 ds_read_b128 v[108:111], v3 offset:6144
 s_cmp_lg_u32 s64, 0
 s_cbranch_scc1 Lqpre_47
Lqs_48:
 buffer_load_dword v16, v15, s[20:23], s57 offen sc1
 s_waitcnt vmcnt(0)
 v_cmp_le_u32 vcc, s60, v16
 s_cbranch_vccnz Lqsk_49
 s_sleep 2
 s_sub_u32 s58, s58, 1
 s_cbranch_scc0 Lqs_48
 s_endpgm
Lqsk_49:
 buffer_load_dwordx4 v[192:195], v1, s[20:23], s55 offen offset:0 sc1
 buffer_load_dwordx4 v[196:199], v1, s[20:23], s55 offen offset:1024 sc1
 buffer_load_dwordx4 v[200:203], v1, s[20:23], s55 offen offset:2048 sc1
 buffer_load_dwordx4 v[204:207], v1, s[20:23], s55 offen offset:3072 sc1
Lqpre_47:
 s_waitcnt vmcnt(4) lgkmcnt(0)
 v_mfma_f32_16x16x32_bf16 v[112:115], v[128:131], v[96:99], v[208:211]
 v_mfma_f32_16x16x32_bf16 v[116:119], v[132:135], v[96:99], v[212:215]
 v_mfma_f32_16x16x32_bf16 v[112:115], v[136:139], v[100:103], v[112:115]
 v_mfma_f32_16x16x32_bf16 v[116:119], v[140:143], v[100:103], v[116:119]
 v_mfma_f32_16x16x32_bf16 v[112:115], v[144:147], v[104:107], v[112:115]
 v_mfma_f32_16x16x32_bf16 v[116:119], v[148:151], v[104:107], v[116:119]
 v_mfma_f32_16x16x32_bf16 v[112:115], v[152:155], v[108:111], v[112:115]
 v_mfma_f32_16x16x32_bf16 v[116:119], v[156:159], v[108:111], v[116:119]
 s_nop 7
 v_max3_f32 v24, v112, v113, v114
 v_max3_f32 v24, v24, v115, v116
 v_max3_f32 v24, v24, v117, v118
 v_max_f32 v24, v24, v119
 s_waitcnt vmcnt(2)
 v_mov_b64 v[16:17], v[192:193]
 v_mov_b64 v[18:19], v[196:197]
 s_nop 1
 v_smfmac_f32_16x16x64_bf16 v[120:123], v[16:19], v[96:103], v12
 s_waitcnt vmcnt(0)
 v_mov_b64 v[20:21], v[200:201]
 v_mov_b64 v[22:23], v[204:205]
 s_nop 1
 v_smfmac_f32_16x16x64_bf16 v[120:123], v[20:23], v[104:111], v12
 s_nop 7
 v_add_f32 v120, v120, v122
 v_add_f32 v121, v121, v123
 v_mul_f32 v120, s50, v120
 v_mul_f32 v121, s50, v121
 v_max3_f32 v24, v24, v120, v121
 v_mov_b32 v25, v24
 s_nop 1
 v_permlane16_swap_b32 v24, v25
 v_max_f32 v24, v24, v25
 v_mov_b32 v25, v24
 s_nop 1
 v_permlane32_swap_b32 v24, v25
 v_max_f32 v24, v24, v25
 v_sub_f32 v112, v112, v24
 v_sub_f32 v113, v113, v24
 v_sub_f32 v114, v114, v24
 v_sub_f32 v115, v115, v24
 v_sub_f32 v116, v116, v24
 v_sub_f32 v117, v117, v24
 v_sub_f32 v118, v118, v24
 v_sub_f32 v119, v119, v24
 v_sub_f32 v120, v120, v24
 v_sub_f32 v121, v121, v24
 v_exp_f32 v120, v120
 v_exp_f32 v121, v121
 v_exp_f32 v112, v112
 v_exp_f32 v113, v113
 v_exp_f32 v114, v114
 v_exp_f32 v115, v115
 v_exp_f32 v116, v116
 v_exp_f32 v117, v117
 v_exp_f32 v118, v118
 v_exp_f32 v119, v119
 v_cvt_pk_bf16_f32 v216, v120, v121
 v_cvt_pk_bf16_f32 v219, v120, v121
 v_cvt_pk_bf16_f32 v28, v112, v113
 v_cvt_pk_bf16_f32 v29, v116, v117
 v_cvt_pk_bf16_f32 v30, v114, v115
 v_cvt_pk_bf16_f32 v31, v118, v119
 v_mfma_f32_16x16x16_bf16 v[124:127], v[220:221], v[216:217], 0
 v_mfma_f32_16x16x16_bf16 v[64:67], v[194:195], v[216:217], 0
 v_mfma_f32_16x16x16_bf16 v[68:71], v[194:195], v[218:219], 0
 v_mfma_f32_16x16x16_bf16 v[72:75], v[198:199], v[216:217], 0
 v_mfma_f32_16x16x16_bf16 v[76:79], v[198:199], v[218:219], 0
 v_mfma_f32_16x16x16_bf16 v[80:83], v[202:203], v[216:217], 0
 v_mfma_f32_16x16x16_bf16 v[84:87], v[202:203], v[218:219], 0
 v_mfma_f32_16x16x16_bf16 v[88:91], v[206:207], v[216:217], 0
 v_mfma_f32_16x16x16_bf16 v[92:95], v[206:207], v[218:219], 0
 v_mfma_f32_16x16x32_bf16 v[124:127], v[220:223], v[28:31], v[124:127]
 v_mfma_f32_16x16x32_bf16 v[64:67], v[160:163], v[28:31], v[64:67]
 v_mfma_f32_16x16x32_bf16 v[68:71], v[164:167], v[28:31], v[68:71]
 v_mfma_f32_16x16x32_bf16 v[72:75], v[168:171], v[28:31], v[72:75]
 v_mfma_f32_16x16x32_bf16 v[76:79], v[172:175], v[28:31], v[76:79]
 v_mfma_f32_16x16x32_bf16 v[80:83], v[176:179], v[28:31], v[80:83]
 v_mfma_f32_16x16x32_bf16 v[84:87], v[180:183], v[28:31], v[84:87]
 v_mfma_f32_16x16x32_bf16 v[88:91], v[184:187], v[28:31], v[88:91]
 v_mfma_f32_16x16x32_bf16 v[92:95], v[188:191], v[28:31], v[92:95]
 v_rcp_f32 v124, v124
 s_add_u32 s45, s56, 4096
 v_mul_f32 v64, v64, v124
 v_mul_f32 v65, v65, v124
 v_mul_f32 v66, v66, v124
 v_mul_f32 v67, v67, v124
 v_mul_f32 v68, v68, v124
 v_mul_f32 v69, v69, v124
 v_mul_f32 v70, v70, v124
 v_mul_f32 v71, v71, v124
 v_cvt_pk_bf16_f32 v96, v64, v65
 v_cvt_pk_bf16_f32 v97, v68, v69
 v_cvt_pk_bf16_f32 v98, v66, v67
 v_cvt_pk_bf16_f32 v99, v70, v71
 buffer_store_dwordx4 v[96:99], v1, s[20:23], s56 offen offset:0 sc1
 v_mul_f32 v72, v72, v124
 v_mul_f32 v73, v73, v124
 v_mul_f32 v74, v74, v124
 v_mul_f32 v75, v75, v124
 v_mul_f32 v76, v76, v124
 v_mul_f32 v77, v77, v124
 v_mul_f32 v78, v78, v124
 v_mul_f32 v79, v79, v124
 v_cvt_pk_bf16_f32 v100, v72, v73
 v_cvt_pk_bf16_f32 v101, v76, v77
 v_cvt_pk_bf16_f32 v102, v74, v75
 v_cvt_pk_bf16_f32 v103, v78, v79
 buffer_store_dwordx4 v[100:103], v1, s[20:23], s56 offen offset:2048 sc1
 v_mul_f32 v80, v80, v124
 v_mul_f32 v81, v81, v124
 v_mul_f32 v82, v82, v124
 v_mul_f32 v83, v83, v124
 v_mul_f32 v84, v84, v124
 v_mul_f32 v85, v85, v124
 v_mul_f32 v86, v86, v124
 v_mul_f32 v87, v87, v124
 v_cvt_pk_bf16_f32 v104, v80, v81
 v_cvt_pk_bf16_f32 v105, v84, v85
 v_cvt_pk_bf16_f32 v106, v82, v83
 v_cvt_pk_bf16_f32 v107, v86, v87
 buffer_store_dwordx4 v[104:107], v1, s[20:23], s45 offen offset:0 sc1
 v_mul_f32 v88, v88, v124
 v_mul_f32 v89, v89, v124
 v_mul_f32 v90, v90, v124
 v_mul_f32 v91, v91, v124
 v_mul_f32 v92, v92, v124
 v_mul_f32 v93, v93, v124
 v_mul_f32 v94, v94, v124
 v_mul_f32 v95, v95, v124
 v_cvt_pk_bf16_f32 v108, v88, v89
 v_cvt_pk_bf16_f32 v109, v92, v93
 v_cvt_pk_bf16_f32 v110, v90, v91
 v_cvt_pk_bf16_f32 v111, v94, v95
 buffer_store_dwordx4 v[108:111], v1, s[20:23], s45 offen offset:2048 sc1
 s_cmp_lt_u32 s42, s36
 s_cbranch_scc1 Lqb_loop_40
Lqb_out_41:
 s_waitcnt vmcnt(0)
 buffer_load_dword v17, v11, s[20:23], s56 offen sc1
 s_barrier
 buffer_store_dword v14, v8, s[20:23], s59 offen sc1
 s_branch Lfin
Lob:
 s_load_dwordx2 s[8:9], s[0:1], 88
 s_mov_b32 s10, 0x480000
 s_mov_b32 s11, 0x20000
 s_sub_u32 s32, s6, 16
 s_mul_i32 s7, s3, 5
 s_add_u32 s7, s7, s6
 s_sub_u32 s7, s7, 25
 s_sub_u32 s33, 2, s3
 s_lshl_b32 s34, 2, s3
 s_cmp_lt_u32 s6, 25
 s_cselect_b32 s32, s32, s7
 s_cselect_b32 s33, s33, 0
 s_cselect_b32 s34, s34, 3
 s_cselect_b32 s39, 6, 0
 s_cselect_b32 s40, 0, 4
 s_cmp_eq_u32 s3, 2
 s_cselect_b32 s33, 63, s33
 s_cselect_b32 s35, 1, 21
 s_cselect_b32 s90, 31, 1
 s_cselect_b32 s91, 10, 9
 s_mov_b32 s36, 0x7000000
 s_mov_b32 s37, 1152
 s_lshl_b32 s7, s4, 7
 s_add_u32 s38, s7, 0x3800
 s_mov_b32 s93, 1
 s_mov_b32 s92, 3
Los:
 s_load_dwordx2 s[24:25], s[0:1], 104
 s_mov_b32 s26, 0x480000
 s_mov_b32 s27, 0x20000
 s_waitcnt lgkmcnt(0)
 v_and_b32 v15, 63, v0
 v_lshlrev_b32 v1, 4, v15
 v_and_b32 v3, s92, v15
 v_lshlrev_b32 v3, 2, v3
 v_lshrrev_b32 v14, 4, v15
 v_min_u32 v14, 1, v14
 v_lshl_or_b32 v3, v14, 28, v3
 s_add_u32 s44, s32, s40
 s_and_b32 s44, s44, 7
 s_mov_b32 s50, 0x40000
 s_mul_i32 s49, s4, 40960
 v_add_u32 v5, s49, v1
 v_bfe_u32 v14, v15, 5, 1
 v_bfe_u32 v16, v15, 3, 1
 v_lshl_add_u32 v14, v14, 1, v16
 v_bfe_u32 v16, v15, 4, 1
 v_lshl_add_u32 v14, v16, 6, v14
 v_mul_u32_u24 v14, 1152, v14
 v_bfe_u32 v17, v15, 1, 2
 v_xor_b32 v17, v17, v16
 v_lshlrev_b32 v17, 5, v17
 v_and_b32 v16, 1, v15
 v_lshl_add_u32 v17, v16, 4, v17
 v_add_u32 v8, v14, v17
 v_xor_b32 v17, 64, v17
 v_add_u32 v9, v14, v17
 v_lshrrev_b32 v14, 4, v15
 v_bfe_u32 v16, v15, 2, 2
 v_lshl_add_u32 v14, v14, 3, v16
 v_lshlrev_b32 v14, 7, v14
 v_bfe_u32 v16, v15, 3, 2
 v_lshl_add_u32 v14, v16, 5, v14
 v_and_b32 v16, 3, v15
 v_lshl_add_u32 v14, v16, 3, v14
 v_xor_b32 v16, 0, v14
 v_add_u32 v10, s49, v16
 v_xor_b32 v16, 32, v14
 v_add_u32 v11, s49, v16
 v_xor_b32 v16, 64, v14
 v_add_u32 v12, s49, v16
 v_xor_b32 v16, 96, v14
 v_add_u32 v13, s49, v16
 s_lshl_b32 s47, s32, 7
 s_add_u32 s46, s44, 0
 s_and_b32 s46, s46, 7
 s_lshl_b32 s45, s4, 3
 s_add_u32 s46, s46, s45
 s_mul_i32 s46, s46, 147456
 s_add_u32 s46, s46, s47
 s_add_u32 m0, s49, 8192
 s_add_u32 s45, s46, 0
 buffer_load_dwordx4 v8, s[8:11], s45 offen  lds
 s_add_u32 m0, s49, 9216
 s_add_u32 s45, s46, 4608
 buffer_load_dwordx4 v9, s[8:11], s45 offen  lds
 s_add_u32 m0, s49, 10240
 s_add_u32 s45, s46, 9216
 buffer_load_dwordx4 v8, s[8:11], s45 offen  lds
 s_add_u32 m0, s49, 11264
 s_add_u32 s45, s46, 13824
 buffer_load_dwordx4 v9, s[8:11], s45 offen  lds
 s_waitcnt vmcnt(0) lgkmcnt(0)
 s_add_u32 m0, s49, 12288
 s_add_u32 s45, s46, 18432
 buffer_load_dwordx4 v8, s[8:11], s45 offen  lds
 s_add_u32 m0, s49, 13312
 s_add_u32 s45, s46, 23040
 buffer_load_dwordx4 v9, s[8:11], s45 offen  lds
 s_add_u32 m0, s49, 14336
 s_add_u32 s45, s46, 27648
 buffer_load_dwordx4 v8, s[8:11], s45 offen  lds
 s_add_u32 m0, s49, 15360
 s_add_u32 s45, s46, 32256
 buffer_load_dwordx4 v9, s[8:11], s45 offen  lds
 ds_read_b64_tr_b16 a[0:1], v10 offset:8192
 ds_read_b64_tr_b16 a[2:3], v10 offset:8704
 ds_read_b64_tr_b16 a[4:5], v11 offset:8192
 ds_read_b64_tr_b16 a[6:7], v11 offset:8704
 ds_read_b64_tr_b16 a[8:9], v12 offset:8192
 ds_read_b64_tr_b16 a[10:11], v12 offset:8704
 ds_read_b64_tr_b16 v[16:17], v13 offset:8192
 ds_read_b64_tr_b16 v[18:19], v13 offset:8704
 s_waitcnt vmcnt(0) lgkmcnt(0)
 s_add_u32 m0, s49, 16384
 s_add_u32 s45, s46, 36864
 buffer_load_dwordx4 v8, s[8:11], s45 offen  lds
 s_add_u32 m0, s49, 17408
 s_add_u32 s45, s46, 41472
 buffer_load_dwordx4 v9, s[8:11], s45 offen  lds
 s_add_u32 m0, s49, 18432
 s_add_u32 s45, s46, 46080
 buffer_load_dwordx4 v8, s[8:11], s45 offen  lds
 s_add_u32 m0, s49, 19456
 s_add_u32 s45, s46, 50688
 buffer_load_dwordx4 v9, s[8:11], s45 offen  lds
 ds_write_b128 v5, v[16:19] offset:0
 ds_read_b64_tr_b16 a[12:13], v10 offset:12288
 ds_read_b64_tr_b16 a[14:15], v10 offset:12800
 ds_read_b64_tr_b16 a[16:17], v11 offset:12288
 ds_read_b64_tr_b16 a[18:19], v11 offset:12800
 ds_read_b64_tr_b16 a[20:21], v12 offset:12288
 ds_read_b64_tr_b16 a[22:23], v12 offset:12800
 ds_read_b64_tr_b16 v[20:21], v13 offset:12288
 ds_read_b64_tr_b16 v[22:23], v13 offset:12800
 s_waitcnt vmcnt(0) lgkmcnt(0)
 s_add_u32 m0, s49, 20480
 s_add_u32 s45, s46, 55296
 buffer_load_dwordx4 v8, s[8:11], s45 offen  lds
 s_add_u32 m0, s49, 21504
 s_add_u32 s45, s46, 59904
 buffer_load_dwordx4 v9, s[8:11], s45 offen  lds
 s_add_u32 m0, s49, 22528
 s_add_u32 s45, s46, 64512
 buffer_load_dwordx4 v8, s[8:11], s45 offen  lds
 s_add_u32 m0, s49, 23552
 s_add_u32 s45, s46, 69120
 buffer_load_dwordx4 v9, s[8:11], s45 offen  lds
 ds_write_b128 v5, v[20:23] offset:1024
 ds_read_b64_tr_b16 a[24:25], v10 offset:16384
 ds_read_b64_tr_b16 a[26:27], v10 offset:16896
 ds_read_b64_tr_b16 a[28:29], v11 offset:16384
 ds_read_b64_tr_b16 a[30:31], v11 offset:16896
 ds_read_b64_tr_b16 a[32:33], v12 offset:16384
 ds_read_b64_tr_b16 a[34:35], v12 offset:16896
 ds_read_b64_tr_b16 v[16:17], v13 offset:16384
 ds_read_b64_tr_b16 v[18:19], v13 offset:16896
 s_waitcnt vmcnt(0) lgkmcnt(0)
 s_add_u32 s46, s44, 1
 s_and_b32 s46, s46, 7
 s_lshl_b32 s45, s4, 3
 s_add_u32 s46, s46, s45
 s_mul_i32 s46, s46, 147456
 s_add_u32 s46, s46, s47
 s_add_u32 m0, s49, 24576
 s_add_u32 s45, s46, 0
 buffer_load_dwordx4 v8, s[8:11], s45 offen  lds
 s_add_u32 m0, s49, 25600
 s_add_u32 s45, s46, 4608
 buffer_load_dwordx4 v9, s[8:11], s45 offen  lds
 s_add_u32 m0, s49, 26624
 s_add_u32 s45, s46, 9216
 buffer_load_dwordx4 v8, s[8:11], s45 offen  lds
 s_add_u32 m0, s49, 27648
 s_add_u32 s45, s46, 13824
 buffer_load_dwordx4 v9, s[8:11], s45 offen  lds
 ds_write_b128 v5, v[16:19] offset:2048
 ds_read_b64_tr_b16 a[36:37], v10 offset:20480
 ds_read_b64_tr_b16 a[38:39], v10 offset:20992
 ds_read_b64_tr_b16 a[40:41], v11 offset:20480
 ds_read_b64_tr_b16 a[42:43], v11 offset:20992
 ds_read_b64_tr_b16 a[44:45], v12 offset:20480
 ds_read_b64_tr_b16 a[46:47], v12 offset:20992
 ds_read_b64_tr_b16 v[20:21], v13 offset:20480
 ds_read_b64_tr_b16 v[22:23], v13 offset:20992
 s_waitcnt vmcnt(0) lgkmcnt(0)
 s_add_u32 m0, s49, 28672
 s_add_u32 s45, s46, 18432
 buffer_load_dwordx4 v8, s[8:11], s45 offen  lds
 s_add_u32 m0, s49, 29696
 s_add_u32 s45, s46, 23040
 buffer_load_dwordx4 v9, s[8:11], s45 offen  lds
 s_add_u32 m0, s49, 30720
 s_add_u32 s45, s46, 27648
 buffer_load_dwordx4 v8, s[8:11], s45 offen  lds
 s_add_u32 m0, s49, 31744
 s_add_u32 s45, s46, 32256
 buffer_load_dwordx4 v9, s[8:11], s45 offen  lds
 ds_write_b128 v5, v[20:23] offset:3072
 ds_read_b64_tr_b16 a[48:49], v10 offset:24576
 ds_read_b64_tr_b16 a[50:51], v10 offset:25088
 ds_read_b64_tr_b16 a[52:53], v11 offset:24576
 ds_read_b64_tr_b16 a[54:55], v11 offset:25088
 ds_read_b64_tr_b16 a[56:57], v12 offset:24576
 ds_read_b64_tr_b16 a[58:59], v12 offset:25088
 ds_read_b64_tr_b16 v[16:17], v13 offset:24576
 ds_read_b64_tr_b16 v[18:19], v13 offset:25088
 s_waitcnt vmcnt(0) lgkmcnt(0)
 s_add_u32 m0, s49, 32768
 s_add_u32 s45, s46, 36864
 buffer_load_dwordx4 v8, s[8:11], s45 offen  lds
 s_add_u32 m0, s49, 33792
 s_add_u32 s45, s46, 41472
 buffer_load_dwordx4 v9, s[8:11], s45 offen  lds
 s_add_u32 m0, s49, 34816
 s_add_u32 s45, s46, 46080
 buffer_load_dwordx4 v8, s[8:11], s45 offen  lds
 s_add_u32 m0, s49, 35840
 s_add_u32 s45, s46, 50688
 buffer_load_dwordx4 v9, s[8:11], s45 offen  lds
 ds_write_b128 v5, v[16:19] offset:4096
 ds_read_b64_tr_b16 a[60:61], v10 offset:28672
 ds_read_b64_tr_b16 a[62:63], v10 offset:29184
 ds_read_b64_tr_b16 a[64:65], v11 offset:28672
 ds_read_b64_tr_b16 a[66:67], v11 offset:29184
 ds_read_b64_tr_b16 a[68:69], v12 offset:28672
 ds_read_b64_tr_b16 a[70:71], v12 offset:29184
 ds_read_b64_tr_b16 v[20:21], v13 offset:28672
 ds_read_b64_tr_b16 v[22:23], v13 offset:29184
 s_waitcnt vmcnt(0) lgkmcnt(0)
 s_add_u32 m0, s49, 36864
 s_add_u32 s45, s46, 55296
 buffer_load_dwordx4 v8, s[8:11], s45 offen  lds
 s_add_u32 m0, s49, 37888
 s_add_u32 s45, s46, 59904
 buffer_load_dwordx4 v9, s[8:11], s45 offen  lds
 s_add_u32 m0, s49, 38912
 s_add_u32 s45, s46, 64512
 buffer_load_dwordx4 v8, s[8:11], s45 offen  lds
 s_add_u32 m0, s49, 39936
 s_add_u32 s45, s46, 69120
 buffer_load_dwordx4 v9, s[8:11], s45 offen  lds
 ds_write_b128 v5, v[20:23] offset:5120
 ds_read_b64_tr_b16 a[72:73], v10 offset:32768
 ds_read_b64_tr_b16 a[74:75], v10 offset:33280
 ds_read_b64_tr_b16 a[76:77], v11 offset:32768
 ds_read_b64_tr_b16 a[78:79], v11 offset:33280
 ds_read_b64_tr_b16 a[80:81], v12 offset:32768
 ds_read_b64_tr_b16 a[82:83], v12 offset:33280
 ds_read_b64_tr_b16 v[16:17], v13 offset:32768
 ds_read_b64_tr_b16 v[18:19], v13 offset:33280
 s_waitcnt vmcnt(0) lgkmcnt(0)
 s_add_u32 s46, s44, 2
 s_and_b32 s46, s46, 7
 s_lshl_b32 s45, s4, 3
 s_add_u32 s46, s46, s45
 s_mul_i32 s46, s46, 147456
 s_add_u32 s46, s46, s47
 s_add_u32 m0, s49, 8192
 s_add_u32 s45, s46, 0
 buffer_load_dwordx4 v8, s[8:11], s45 offen  lds
 s_add_u32 m0, s49, 9216
 s_add_u32 s45, s46, 4608
 buffer_load_dwordx4 v9, s[8:11], s45 offen  lds
 s_add_u32 m0, s49, 10240
 s_add_u32 s45, s46, 9216
 buffer_load_dwordx4 v8, s[8:11], s45 offen  lds
 s_add_u32 m0, s49, 11264
 s_add_u32 s45, s46, 13824
 buffer_load_dwordx4 v9, s[8:11], s45 offen  lds
 ds_write_b128 v5, v[16:19] offset:6144
 ds_read_b64_tr_b16 a[84:85], v10 offset:36864
 ds_read_b64_tr_b16 a[86:87], v10 offset:37376
 ds_read_b64_tr_b16 a[88:89], v11 offset:36864
 ds_read_b64_tr_b16 a[90:91], v11 offset:37376
 ds_read_b64_tr_b16 a[92:93], v12 offset:36864
 ds_read_b64_tr_b16 a[94:95], v12 offset:37376
 ds_read_b64_tr_b16 v[20:21], v13 offset:36864
 ds_read_b64_tr_b16 v[22:23], v13 offset:37376
 s_waitcnt vmcnt(0) lgkmcnt(0)
 s_add_u32 m0, s49, 12288
 s_add_u32 s45, s46, 18432
 buffer_load_dwordx4 v8, s[8:11], s45 offen  lds
 s_add_u32 m0, s49, 13312
 s_add_u32 s45, s46, 23040
 buffer_load_dwordx4 v9, s[8:11], s45 offen  lds
 s_add_u32 m0, s49, 14336
 s_add_u32 s45, s46, 27648
 buffer_load_dwordx4 v8, s[8:11], s45 offen  lds
 s_add_u32 m0, s49, 15360
 s_add_u32 s45, s46, 32256
 buffer_load_dwordx4 v9, s[8:11], s45 offen  lds
 ds_write_b128 v5, v[20:23] offset:7168
 ds_read_b64_tr_b16 a[96:97], v10 offset:8192
 ds_read_b64_tr_b16 a[98:99], v10 offset:8704
 ds_read_b64_tr_b16 a[100:101], v11 offset:8192
 ds_read_b64_tr_b16 a[102:103], v11 offset:8704
 ds_read_b64_tr_b16 a[104:105], v12 offset:8192
 ds_read_b64_tr_b16 a[106:107], v12 offset:8704
 ds_read_b64_tr_b16 v[32:33], v13 offset:8192
 ds_read_b64_tr_b16 v[34:35], v13 offset:8704
 s_waitcnt vmcnt(0) lgkmcnt(0)
 s_add_u32 m0, s49, 16384
 s_add_u32 s45, s46, 36864
 buffer_load_dwordx4 v8, s[8:11], s45 offen  lds
 s_add_u32 m0, s49, 17408
 s_add_u32 s45, s46, 41472
 buffer_load_dwordx4 v9, s[8:11], s45 offen  lds
 s_add_u32 m0, s49, 18432
 s_add_u32 s45, s46, 46080
 buffer_load_dwordx4 v8, s[8:11], s45 offen  lds
 s_add_u32 m0, s49, 19456
 s_add_u32 s45, s46, 50688
 buffer_load_dwordx4 v9, s[8:11], s45 offen  lds
 ds_read_b64_tr_b16 a[108:109], v10 offset:12288
 ds_read_b64_tr_b16 a[110:111], v10 offset:12800
 ds_read_b64_tr_b16 a[112:113], v11 offset:12288
 ds_read_b64_tr_b16 a[114:115], v11 offset:12800
 ds_read_b64_tr_b16 a[116:117], v12 offset:12288
 ds_read_b64_tr_b16 a[118:119], v12 offset:12800
 ds_read_b64_tr_b16 v[36:37], v13 offset:12288
 ds_read_b64_tr_b16 v[38:39], v13 offset:12800
 s_waitcnt vmcnt(0) lgkmcnt(0)
 s_add_u32 m0, s49, 20480
 s_add_u32 s45, s46, 55296
 buffer_load_dwordx4 v8, s[8:11], s45 offen  lds
 s_add_u32 m0, s49, 21504
 s_add_u32 s45, s46, 59904
 buffer_load_dwordx4 v9, s[8:11], s45 offen  lds
 s_add_u32 m0, s49, 22528
 s_add_u32 s45, s46, 64512
 buffer_load_dwordx4 v8, s[8:11], s45 offen  lds
 s_add_u32 m0, s49, 23552
 s_add_u32 s45, s46, 69120
 buffer_load_dwordx4 v9, s[8:11], s45 offen  lds
 ds_read_b64_tr_b16 a[120:121], v10 offset:16384
 ds_read_b64_tr_b16 a[122:123], v10 offset:16896
 ds_read_b64_tr_b16 a[124:125], v11 offset:16384
 ds_read_b64_tr_b16 a[126:127], v11 offset:16896
 ds_read_b64_tr_b16 a[128:129], v12 offset:16384
 ds_read_b64_tr_b16 a[130:131], v12 offset:16896
 ds_read_b64_tr_b16 v[40:41], v13 offset:16384
 ds_read_b64_tr_b16 v[42:43], v13 offset:16896
 s_waitcnt vmcnt(0) lgkmcnt(0)
 s_add_u32 s46, s44, 3
 s_and_b32 s46, s46, 7
 s_lshl_b32 s45, s4, 3
 s_add_u32 s46, s46, s45
 s_mul_i32 s46, s46, 147456
 s_add_u32 s46, s46, s47
 s_add_u32 m0, s49, 24576
 s_add_u32 s45, s46, 0
 buffer_load_dwordx4 v8, s[8:11], s45 offen  lds
 s_add_u32 m0, s49, 25600
 s_add_u32 s45, s46, 4608
 buffer_load_dwordx4 v9, s[8:11], s45 offen  lds
 s_add_u32 m0, s49, 26624
 s_add_u32 s45, s46, 9216
 buffer_load_dwordx4 v8, s[8:11], s45 offen  lds
 s_add_u32 m0, s49, 27648
 s_add_u32 s45, s46, 13824
 buffer_load_dwordx4 v9, s[8:11], s45 offen  lds
 ds_read_b64_tr_b16 a[132:133], v10 offset:20480
 ds_read_b64_tr_b16 a[134:135], v10 offset:20992
 ds_read_b64_tr_b16 a[136:137], v11 offset:20480
 ds_read_b64_tr_b16 a[138:139], v11 offset:20992
 ds_read_b64_tr_b16 a[140:141], v12 offset:20480
 ds_read_b64_tr_b16 a[142:143], v12 offset:20992
 ds_read_b64_tr_b16 v[44:45], v13 offset:20480
 ds_read_b64_tr_b16 v[46:47], v13 offset:20992
 s_waitcnt vmcnt(0) lgkmcnt(0)
 s_add_u32 m0, s49, 28672
 s_add_u32 s45, s46, 18432
 buffer_load_dwordx4 v8, s[8:11], s45 offen  lds
 s_add_u32 m0, s49, 29696
 s_add_u32 s45, s46, 23040
 buffer_load_dwordx4 v9, s[8:11], s45 offen  lds
 s_add_u32 m0, s49, 30720
 s_add_u32 s45, s46, 27648
 buffer_load_dwordx4 v8, s[8:11], s45 offen  lds
 s_add_u32 m0, s49, 31744
 s_add_u32 s45, s46, 32256
 buffer_load_dwordx4 v9, s[8:11], s45 offen  lds
 ds_read_b64_tr_b16 a[144:145], v10 offset:24576
 ds_read_b64_tr_b16 a[146:147], v10 offset:25088
 ds_read_b64_tr_b16 a[148:149], v11 offset:24576
 ds_read_b64_tr_b16 a[150:151], v11 offset:25088
 ds_read_b64_tr_b16 a[152:153], v12 offset:24576
 ds_read_b64_tr_b16 a[154:155], v12 offset:25088
 ds_read_b64_tr_b16 v[48:49], v13 offset:24576
 ds_read_b64_tr_b16 v[50:51], v13 offset:25088
 s_waitcnt vmcnt(0) lgkmcnt(0)
 s_add_u32 m0, s49, 32768
 s_add_u32 s45, s46, 36864
 buffer_load_dwordx4 v8, s[8:11], s45 offen  lds
 s_add_u32 m0, s49, 33792
 s_add_u32 s45, s46, 41472
 buffer_load_dwordx4 v9, s[8:11], s45 offen  lds
 s_add_u32 m0, s49, 34816
 s_add_u32 s45, s46, 46080
 buffer_load_dwordx4 v8, s[8:11], s45 offen  lds
 s_add_u32 m0, s49, 35840
 s_add_u32 s45, s46, 50688
 buffer_load_dwordx4 v9, s[8:11], s45 offen  lds
 ds_read_b64_tr_b16 a[156:157], v10 offset:28672
 ds_read_b64_tr_b16 a[158:159], v10 offset:29184
 ds_read_b64_tr_b16 a[160:161], v11 offset:28672
 ds_read_b64_tr_b16 a[162:163], v11 offset:29184
 ds_read_b64_tr_b16 a[164:165], v12 offset:28672
 ds_read_b64_tr_b16 a[166:167], v12 offset:29184
 ds_read_b64_tr_b16 v[52:53], v13 offset:28672
 ds_read_b64_tr_b16 v[54:55], v13 offset:29184
 s_waitcnt vmcnt(0) lgkmcnt(0)
 s_add_u32 m0, s49, 36864
 s_add_u32 s45, s46, 55296
 buffer_load_dwordx4 v8, s[8:11], s45 offen  lds
 s_add_u32 m0, s49, 37888
 s_add_u32 s45, s46, 59904
 buffer_load_dwordx4 v9, s[8:11], s45 offen  lds
 s_add_u32 m0, s49, 38912
 s_add_u32 s45, s46, 64512
 buffer_load_dwordx4 v8, s[8:11], s45 offen  lds
 s_add_u32 m0, s49, 39936
 s_add_u32 s45, s46, 69120
 buffer_load_dwordx4 v9, s[8:11], s45 offen  lds
 ds_read_b64_tr_b16 a[168:169], v10 offset:32768
 ds_read_b64_tr_b16 a[170:171], v10 offset:33280
 ds_read_b64_tr_b16 a[172:173], v11 offset:32768
 ds_read_b64_tr_b16 a[174:175], v11 offset:33280
 ds_read_b64_tr_b16 a[176:177], v12 offset:32768
 ds_read_b64_tr_b16 a[178:179], v12 offset:33280
 ds_read_b64_tr_b16 v[56:57], v13 offset:32768
 ds_read_b64_tr_b16 v[58:59], v13 offset:33280
 s_waitcnt vmcnt(0) lgkmcnt(0)
 s_add_u32 s46, s44, 4
 s_and_b32 s46, s46, 7
 s_lshl_b32 s45, s4, 3
 s_add_u32 s46, s46, s45
 s_mul_i32 s46, s46, 147456
 s_add_u32 s46, s46, s47
 s_add_u32 m0, s49, 8192
 s_add_u32 s45, s46, 0
 buffer_load_dwordx4 v8, s[8:11], s45 offen  lds
 s_add_u32 m0, s49, 9216
 s_add_u32 s45, s46, 4608
 buffer_load_dwordx4 v9, s[8:11], s45 offen  lds
 s_add_u32 m0, s49, 10240
 s_add_u32 s45, s46, 9216
 buffer_load_dwordx4 v8, s[8:11], s45 offen  lds
 s_add_u32 m0, s49, 11264
 s_add_u32 s45, s46, 13824
 buffer_load_dwordx4 v9, s[8:11], s45 offen  lds
 ds_read_b64_tr_b16 a[180:181], v10 offset:36864
 ds_read_b64_tr_b16 a[182:183], v10 offset:37376
 ds_read_b64_tr_b16 a[184:185], v11 offset:36864
 ds_read_b64_tr_b16 a[186:187], v11 offset:37376
 ds_read_b64_tr_b16 a[188:189], v12 offset:36864
 ds_read_b64_tr_b16 a[190:191], v12 offset:37376
 ds_read_b64_tr_b16 v[60:61], v13 offset:36864
 ds_read_b64_tr_b16 v[62:63], v13 offset:37376
 s_waitcnt vmcnt(0) lgkmcnt(0)
 s_add_u32 m0, s49, 12288
 s_add_u32 s45, s46, 18432
 buffer_load_dwordx4 v8, s[8:11], s45 offen  lds
 s_add_u32 m0, s49, 13312
 s_add_u32 s45, s46, 23040
 buffer_load_dwordx4 v9, s[8:11], s45 offen  lds
 s_add_u32 m0, s49, 14336
 s_add_u32 s45, s46, 27648
 buffer_load_dwordx4 v8, s[8:11], s45 offen  lds
 s_add_u32 m0, s49, 15360
 s_add_u32 s45, s46, 32256
 buffer_load_dwordx4 v9, s[8:11], s45 offen  lds
 ds_read_b64_tr_b16 a[192:193], v10 offset:8192
 ds_read_b64_tr_b16 a[194:195], v10 offset:8704
 ds_read_b64_tr_b16 a[196:197], v11 offset:8192
 ds_read_b64_tr_b16 a[198:199], v11 offset:8704
 ds_read_b64_tr_b16 a[200:201], v12 offset:8192
 ds_read_b64_tr_b16 a[202:203], v12 offset:8704
 ds_read_b64_tr_b16 v[64:65], v13 offset:8192
 ds_read_b64_tr_b16 v[66:67], v13 offset:8704
 s_waitcnt vmcnt(0) lgkmcnt(0)
 s_add_u32 m0, s49, 16384
 s_add_u32 s45, s46, 36864
 buffer_load_dwordx4 v8, s[8:11], s45 offen  lds
 s_add_u32 m0, s49, 17408
 s_add_u32 s45, s46, 41472
 buffer_load_dwordx4 v9, s[8:11], s45 offen  lds
 s_add_u32 m0, s49, 18432
 s_add_u32 s45, s46, 46080
 buffer_load_dwordx4 v8, s[8:11], s45 offen  lds
 s_add_u32 m0, s49, 19456
 s_add_u32 s45, s46, 50688
 buffer_load_dwordx4 v9, s[8:11], s45 offen  lds
 ds_read_b64_tr_b16 a[204:205], v10 offset:12288
 ds_read_b64_tr_b16 a[206:207], v10 offset:12800
 ds_read_b64_tr_b16 a[208:209], v11 offset:12288
 ds_read_b64_tr_b16 a[210:211], v11 offset:12800
 ds_read_b64_tr_b16 a[212:213], v12 offset:12288
 ds_read_b64_tr_b16 a[214:215], v12 offset:12800
 ds_read_b64_tr_b16 v[68:69], v13 offset:12288
 ds_read_b64_tr_b16 v[70:71], v13 offset:12800
 s_waitcnt vmcnt(0) lgkmcnt(0)
 s_add_u32 m0, s49, 20480
 s_add_u32 s45, s46, 55296
 buffer_load_dwordx4 v8, s[8:11], s45 offen  lds
 s_add_u32 m0, s49, 21504
 s_add_u32 s45, s46, 59904
 buffer_load_dwordx4 v9, s[8:11], s45 offen  lds
 s_add_u32 m0, s49, 22528
 s_add_u32 s45, s46, 64512
 buffer_load_dwordx4 v8, s[8:11], s45 offen  lds
 s_add_u32 m0, s49, 23552
 s_add_u32 s45, s46, 69120
 buffer_load_dwordx4 v9, s[8:11], s45 offen  lds
 ds_read_b64_tr_b16 a[216:217], v10 offset:16384
 ds_read_b64_tr_b16 a[218:219], v10 offset:16896
 ds_read_b64_tr_b16 a[220:221], v11 offset:16384
 ds_read_b64_tr_b16 a[222:223], v11 offset:16896
 ds_read_b64_tr_b16 a[224:225], v12 offset:16384
 ds_read_b64_tr_b16 a[226:227], v12 offset:16896
 ds_read_b64_tr_b16 v[72:73], v13 offset:16384
 ds_read_b64_tr_b16 v[74:75], v13 offset:16896
 s_waitcnt vmcnt(0) lgkmcnt(0)
 s_add_u32 s46, s44, 5
 s_and_b32 s46, s46, 7
 s_lshl_b32 s45, s4, 3
 s_add_u32 s46, s46, s45
 s_mul_i32 s46, s46, 147456
 s_add_u32 s46, s46, s47
 s_add_u32 m0, s49, 24576
 s_add_u32 s45, s46, 0
 buffer_load_dwordx4 v8, s[8:11], s45 offen  lds
 s_add_u32 m0, s49, 25600
 s_add_u32 s45, s46, 4608
 buffer_load_dwordx4 v9, s[8:11], s45 offen  lds
 s_add_u32 m0, s49, 26624
 s_add_u32 s45, s46, 9216
 buffer_load_dwordx4 v8, s[8:11], s45 offen  lds
 s_add_u32 m0, s49, 27648
 s_add_u32 s45, s46, 13824
 buffer_load_dwordx4 v9, s[8:11], s45 offen  lds
 ds_read_b64_tr_b16 a[228:229], v10 offset:20480
 ds_read_b64_tr_b16 a[230:231], v10 offset:20992
 ds_read_b64_tr_b16 a[232:233], v11 offset:20480
 ds_read_b64_tr_b16 a[234:235], v11 offset:20992
 ds_read_b64_tr_b16 a[236:237], v12 offset:20480
 ds_read_b64_tr_b16 a[238:239], v12 offset:20992
 ds_read_b64_tr_b16 v[76:77], v13 offset:20480
 ds_read_b64_tr_b16 v[78:79], v13 offset:20992
 s_waitcnt vmcnt(0) lgkmcnt(0)
 s_add_u32 m0, s49, 28672
 s_add_u32 s45, s46, 18432
 buffer_load_dwordx4 v8, s[8:11], s45 offen  lds
 s_add_u32 m0, s49, 29696
 s_add_u32 s45, s46, 23040
 buffer_load_dwordx4 v9, s[8:11], s45 offen  lds
 s_add_u32 m0, s49, 30720
 s_add_u32 s45, s46, 27648
 buffer_load_dwordx4 v8, s[8:11], s45 offen  lds
 s_add_u32 m0, s49, 31744
 s_add_u32 s45, s46, 32256
 buffer_load_dwordx4 v9, s[8:11], s45 offen  lds
 ds_read_b64_tr_b16 a[240:241], v10 offset:24576
 ds_read_b64_tr_b16 a[242:243], v10 offset:25088
 ds_read_b64_tr_b16 a[244:245], v11 offset:24576
 ds_read_b64_tr_b16 a[246:247], v11 offset:25088
 ds_read_b64_tr_b16 a[248:249], v12 offset:24576
 ds_read_b64_tr_b16 a[250:251], v12 offset:25088
 ds_read_b64_tr_b16 v[80:81], v13 offset:24576
 ds_read_b64_tr_b16 v[82:83], v13 offset:25088
 s_waitcnt vmcnt(0) lgkmcnt(0)
 s_add_u32 m0, s49, 32768
 s_add_u32 s45, s46, 36864
 buffer_load_dwordx4 v8, s[8:11], s45 offen  lds
 s_add_u32 m0, s49, 33792
 s_add_u32 s45, s46, 41472
 buffer_load_dwordx4 v9, s[8:11], s45 offen  lds
 s_add_u32 m0, s49, 34816
 s_add_u32 s45, s46, 46080
 buffer_load_dwordx4 v8, s[8:11], s45 offen  lds
 s_add_u32 m0, s49, 35840
 s_add_u32 s45, s46, 50688
 buffer_load_dwordx4 v9, s[8:11], s45 offen  lds
 ds_read_b64_tr_b16 a[252:253], v10 offset:28672
 ds_read_b64_tr_b16 a[254:255], v10 offset:29184
 ds_read_b64_tr_b16 v[128:129], v11 offset:28672
 ds_read_b64_tr_b16 v[130:131], v11 offset:29184
 ds_read_b64_tr_b16 v[132:133], v12 offset:28672
 ds_read_b64_tr_b16 v[134:135], v12 offset:29184
 ds_read_b64_tr_b16 v[84:85], v13 offset:28672
 ds_read_b64_tr_b16 v[86:87], v13 offset:29184
 s_waitcnt vmcnt(0) lgkmcnt(0)
 s_add_u32 m0, s49, 36864
 s_add_u32 s45, s46, 55296
 buffer_load_dwordx4 v8, s[8:11], s45 offen  lds
 s_add_u32 m0, s49, 37888
 s_add_u32 s45, s46, 59904
 buffer_load_dwordx4 v9, s[8:11], s45 offen  lds
 s_add_u32 m0, s49, 38912
 s_add_u32 s45, s46, 64512
 buffer_load_dwordx4 v8, s[8:11], s45 offen  lds
 s_add_u32 m0, s49, 39936
 s_add_u32 s45, s46, 69120
 buffer_load_dwordx4 v9, s[8:11], s45 offen  lds
 ds_read_b64_tr_b16 v[136:137], v10 offset:32768
 ds_read_b64_tr_b16 v[138:139], v10 offset:33280
 ds_read_b64_tr_b16 v[140:141], v11 offset:32768
 ds_read_b64_tr_b16 v[142:143], v11 offset:33280
 ds_read_b64_tr_b16 v[144:145], v12 offset:32768
 ds_read_b64_tr_b16 v[146:147], v12 offset:33280
 ds_read_b64_tr_b16 v[88:89], v13 offset:32768
 ds_read_b64_tr_b16 v[90:91], v13 offset:33280
 s_waitcnt vmcnt(0) lgkmcnt(0)
 s_add_u32 s46, s44, 6
 s_and_b32 s46, s46, 7
 s_lshl_b32 s45, s4, 3
 s_add_u32 s46, s46, s45
 s_mul_i32 s46, s46, 147456
 s_add_u32 s46, s46, s47
 s_add_u32 m0, s49, 8192
 s_add_u32 s45, s46, 0
 buffer_load_dwordx4 v8, s[8:11], s45 offen  lds
 s_add_u32 m0, s49, 9216
 s_add_u32 s45, s46, 4608
 buffer_load_dwordx4 v9, s[8:11], s45 offen  lds
 s_add_u32 m0, s49, 10240
 s_add_u32 s45, s46, 9216
 buffer_load_dwordx4 v8, s[8:11], s45 offen  lds
 s_add_u32 m0, s49, 11264
 s_add_u32 s45, s46, 13824
 buffer_load_dwordx4 v9, s[8:11], s45 offen  lds
 ds_read_b64_tr_b16 v[148:149], v10 offset:36864
 ds_read_b64_tr_b16 v[150:151], v10 offset:37376
 ds_read_b64_tr_b16 v[152:153], v11 offset:36864
 ds_read_b64_tr_b16 v[154:155], v11 offset:37376
 ds_read_b64_tr_b16 v[156:157], v12 offset:36864
 ds_read_b64_tr_b16 v[158:159], v12 offset:37376
 ds_read_b64_tr_b16 v[92:93], v13 offset:36864
 ds_read_b64_tr_b16 v[94:95], v13 offset:37376
 s_waitcnt vmcnt(0) lgkmcnt(0)
 s_add_u32 m0, s49, 12288
 s_add_u32 s45, s46, 18432
 buffer_load_dwordx4 v8, s[8:11], s45 offen  lds
 s_add_u32 m0, s49, 13312
 s_add_u32 s45, s46, 23040
 buffer_load_dwordx4 v9, s[8:11], s45 offen  lds
 s_add_u32 m0, s49, 14336
 s_add_u32 s45, s46, 27648
 buffer_load_dwordx4 v8, s[8:11], s45 offen  lds
 s_add_u32 m0, s49, 15360
 s_add_u32 s45, s46, 32256
 buffer_load_dwordx4 v9, s[8:11], s45 offen  lds
 ds_read_b64_tr_b16 v[160:161], v10 offset:8192
 ds_read_b64_tr_b16 v[162:163], v10 offset:8704
 ds_read_b64_tr_b16 v[164:165], v11 offset:8192
 ds_read_b64_tr_b16 v[166:167], v11 offset:8704
 ds_read_b64_tr_b16 v[168:169], v12 offset:8192
 ds_read_b64_tr_b16 v[170:171], v12 offset:8704
 ds_read_b64_tr_b16 v[96:97], v13 offset:8192
 ds_read_b64_tr_b16 v[98:99], v13 offset:8704
 s_waitcnt vmcnt(0) lgkmcnt(0)
 s_add_u32 m0, s49, 16384
 s_add_u32 s45, s46, 36864
 buffer_load_dwordx4 v8, s[8:11], s45 offen  lds
 s_add_u32 m0, s49, 17408
 s_add_u32 s45, s46, 41472
 buffer_load_dwordx4 v9, s[8:11], s45 offen  lds
 s_add_u32 m0, s49, 18432
 s_add_u32 s45, s46, 46080
 buffer_load_dwordx4 v8, s[8:11], s45 offen  lds
 s_add_u32 m0, s49, 19456
 s_add_u32 s45, s46, 50688
 buffer_load_dwordx4 v9, s[8:11], s45 offen  lds
 ds_read_b64_tr_b16 v[172:173], v10 offset:12288
 ds_read_b64_tr_b16 v[174:175], v10 offset:12800
 ds_read_b64_tr_b16 v[176:177], v11 offset:12288
 ds_read_b64_tr_b16 v[178:179], v11 offset:12800
 ds_read_b64_tr_b16 v[180:181], v12 offset:12288
 ds_read_b64_tr_b16 v[182:183], v12 offset:12800
 ds_read_b64_tr_b16 v[100:101], v13 offset:12288
 ds_read_b64_tr_b16 v[102:103], v13 offset:12800
 s_waitcnt vmcnt(0) lgkmcnt(0)
 s_add_u32 m0, s49, 20480
 s_add_u32 s45, s46, 55296
 buffer_load_dwordx4 v8, s[8:11], s45 offen  lds
 s_add_u32 m0, s49, 21504
 s_add_u32 s45, s46, 59904
 buffer_load_dwordx4 v9, s[8:11], s45 offen  lds
 s_add_u32 m0, s49, 22528
 s_add_u32 s45, s46, 64512
 buffer_load_dwordx4 v8, s[8:11], s45 offen  lds
 s_add_u32 m0, s49, 23552
 s_add_u32 s45, s46, 69120
 buffer_load_dwordx4 v9, s[8:11], s45 offen  lds
 ds_read_b64_tr_b16 v[184:185], v10 offset:16384
 ds_read_b64_tr_b16 v[186:187], v10 offset:16896
 ds_read_b64_tr_b16 v[188:189], v11 offset:16384
 ds_read_b64_tr_b16 v[190:191], v11 offset:16896
 ds_read_b64_tr_b16 v[192:193], v12 offset:16384
 ds_read_b64_tr_b16 v[194:195], v12 offset:16896
 ds_read_b64_tr_b16 v[104:105], v13 offset:16384
 ds_read_b64_tr_b16 v[106:107], v13 offset:16896
 s_waitcnt vmcnt(0) lgkmcnt(0)
 s_add_u32 s46, s44, 7
 s_and_b32 s46, s46, 7
 s_lshl_b32 s45, s4, 3
 s_add_u32 s46, s46, s45
 s_mul_i32 s46, s46, 147456
 s_add_u32 s46, s46, s47
 s_add_u32 m0, s49, 24576
 s_add_u32 s45, s46, 0
 buffer_load_dwordx4 v8, s[8:11], s45 offen  lds
 s_add_u32 m0, s49, 25600
 s_add_u32 s45, s46, 4608
 buffer_load_dwordx4 v9, s[8:11], s45 offen  lds
 s_add_u32 m0, s49, 26624
 s_add_u32 s45, s46, 9216
 buffer_load_dwordx4 v8, s[8:11], s45 offen  lds
 s_add_u32 m0, s49, 27648
 s_add_u32 s45, s46, 13824
 buffer_load_dwordx4 v9, s[8:11], s45 offen  lds
 ds_read_b64_tr_b16 v[196:197], v10 offset:20480
 ds_read_b64_tr_b16 v[198:199], v10 offset:20992
 ds_read_b64_tr_b16 v[200:201], v11 offset:20480
 ds_read_b64_tr_b16 v[202:203], v11 offset:20992
 ds_read_b64_tr_b16 v[204:205], v12 offset:20480
 ds_read_b64_tr_b16 v[206:207], v12 offset:20992
 ds_read_b64_tr_b16 v[108:109], v13 offset:20480
 ds_read_b64_tr_b16 v[110:111], v13 offset:20992
 s_waitcnt vmcnt(0) lgkmcnt(0)
 s_add_u32 m0, s49, 28672
 s_add_u32 s45, s46, 18432
 buffer_load_dwordx4 v8, s[8:11], s45 offen  lds
 s_add_u32 m0, s49, 29696
 s_add_u32 s45, s46, 23040
 buffer_load_dwordx4 v9, s[8:11], s45 offen  lds
 s_add_u32 m0, s49, 30720
 s_add_u32 s45, s46, 27648
 buffer_load_dwordx4 v8, s[8:11], s45 offen  lds
 s_add_u32 m0, s49, 31744
 s_add_u32 s45, s46, 32256
 buffer_load_dwordx4 v9, s[8:11], s45 offen  lds
 ds_read_b64_tr_b16 v[208:209], v10 offset:24576
 ds_read_b64_tr_b16 v[210:211], v10 offset:25088
 ds_read_b64_tr_b16 v[212:213], v11 offset:24576
 ds_read_b64_tr_b16 v[214:215], v11 offset:25088
 ds_read_b64_tr_b16 v[216:217], v12 offset:24576
 ds_read_b64_tr_b16 v[218:219], v12 offset:25088
 ds_read_b64_tr_b16 v[112:113], v13 offset:24576
 ds_read_b64_tr_b16 v[114:115], v13 offset:25088
 s_waitcnt vmcnt(0) lgkmcnt(0)
 s_add_u32 m0, s49, 32768
 s_add_u32 s45, s46, 36864
 buffer_load_dwordx4 v8, s[8:11], s45 offen  lds
 s_add_u32 m0, s49, 33792
 s_add_u32 s45, s46, 41472
 buffer_load_dwordx4 v9, s[8:11], s45 offen  lds
 s_add_u32 m0, s49, 34816
 s_add_u32 s45, s46, 46080
 buffer_load_dwordx4 v8, s[8:11], s45 offen  lds
 s_add_u32 m0, s49, 35840
 s_add_u32 s45, s46, 50688
 buffer_load_dwordx4 v9, s[8:11], s45 offen  lds
 ds_read_b64_tr_b16 v[220:221], v10 offset:28672
 ds_read_b64_tr_b16 v[222:223], v10 offset:29184
 ds_read_b64_tr_b16 v[224:225], v11 offset:28672
 ds_read_b64_tr_b16 v[226:227], v11 offset:29184
 ds_read_b64_tr_b16 v[228:229], v12 offset:28672
 ds_read_b64_tr_b16 v[230:231], v12 offset:29184
 ds_read_b64_tr_b16 v[116:117], v13 offset:28672
 ds_read_b64_tr_b16 v[118:119], v13 offset:29184
 s_waitcnt vmcnt(0) lgkmcnt(0)
 s_add_u32 m0, s49, 36864
 s_add_u32 s45, s46, 55296
 buffer_load_dwordx4 v8, s[8:11], s45 offen  lds
 s_add_u32 m0, s49, 37888
 s_add_u32 s45, s46, 59904
 buffer_load_dwordx4 v9, s[8:11], s45 offen  lds
 s_add_u32 m0, s49, 38912
 s_add_u32 s45, s46, 64512
 buffer_load_dwordx4 v8, s[8:11], s45 offen  lds
 s_add_u32 m0, s49, 39936
 s_add_u32 s45, s46, 69120
 buffer_load_dwordx4 v9, s[8:11], s45 offen  lds
 ds_read_b64_tr_b16 v[232:233], v10 offset:32768
 ds_read_b64_tr_b16 v[234:235], v10 offset:33280
 ds_read_b64_tr_b16 v[236:237], v11 offset:32768
 ds_read_b64_tr_b16 v[238:239], v11 offset:33280
 ds_read_b64_tr_b16 v[240:241], v12 offset:32768
 ds_read_b64_tr_b16 v[242:243], v12 offset:33280
 ds_read_b64_tr_b16 v[120:121], v13 offset:32768
 ds_read_b64_tr_b16 v[122:123], v13 offset:33280
 s_waitcnt vmcnt(0) lgkmcnt(0)
 ds_read_b64_tr_b16 v[244:245], v10 offset:36864
 ds_read_b64_tr_b16 v[246:247], v10 offset:37376
 ds_read_b64_tr_b16 v[248:249], v11 offset:36864
 ds_read_b64_tr_b16 v[250:251], v11 offset:37376
 ds_read_b64_tr_b16 v[252:253], v12 offset:36864
 ds_read_b64_tr_b16 v[254:255], v12 offset:37376
 ds_read_b64_tr_b16 v[124:125], v13 offset:36864
 ds_read_b64_tr_b16 v[126:127], v13 offset:37376
 s_waitcnt lgkmcnt(0)
 ds_write_b128 v5, v[32:35] offset:8192
 ds_write_b128 v5, v[36:39] offset:9216
 ds_write_b128 v5, v[40:43] offset:10240
 ds_write_b128 v5, v[44:47] offset:11264
 ds_write_b128 v5, v[48:51] offset:12288
 ds_write_b128 v5, v[52:55] offset:13312
 ds_write_b128 v5, v[56:59] offset:14336
 ds_write_b128 v5, v[60:63] offset:15360
 ds_write_b128 v5, v[64:67] offset:16384
 ds_write_b128 v5, v[68:71] offset:17408
 ds_write_b128 v5, v[72:75] offset:18432
 ds_write_b128 v5, v[76:79] offset:19456
 ds_write_b128 v5, v[80:83] offset:20480
 ds_write_b128 v5, v[84:87] offset:21504
 ds_write_b128 v5, v[88:91] offset:22528
 ds_write_b128 v5, v[92:95] offset:23552
 ds_write_b128 v5, v[96:99] offset:24576
 ds_write_b128 v5, v[100:103] offset:25600
 ds_write_b128 v5, v[104:107] offset:26624
 ds_write_b128 v5, v[108:111] offset:27648
 ds_write_b128 v5, v[112:115] offset:28672
 ds_write_b128 v5, v[116:119] offset:29696
 ds_write_b128 v5, v[120:123] offset:30720
 ds_write_b128 v5, v[124:127] offset:31744
 s_waitcnt lgkmcnt(0)
 v_lshrrev_b32 v13, 2, v15
 v_and_b32 v14, 3, v15
 s_lshr_b32 s45, s4, 1
 s_mul_i32 s45, s45, 36864
 s_and_b32 s46, s4, 1
 s_lshl_b32 s46, s46, 6
 s_add_u32 s45, s45, s46
 s_add_u32 s37, s37, s45
 v_mul_u32_u24 v6, 2304, v13
 v_lshl_add_u32 v6, v14, 4, v6
 v_lshl_add_u32 v13, v14, 2, v13
 v_and_b32 v13, 15, v13
 v_lshlrev_b32 v13, 4, v13
 s_lshl_b32 s45, s4, 11
 v_lshl_add_u32 v12, v14, 9, v13
 v_add_u32 v12, s45, v12
 v_lshrrev_b32 v13, 5, v15
 v_lshl_add_u32 v13, v13, 2, v15
 v_and_b32 v13, 15, v13
 v_and_or_b32 v13, v15, 48, v13
 v_lshlrev_b32 v13, 4, v13
 v_xor_b32 v14, 0x80, v13
 v_add_u32 v15, s49, v14
 v_add_u32 v14, s49, v13
 v_add_u32 v4, 32768, v12
 v_add_u32 v7, 114688, v12
 s_lshl_b32 s45, s32, 7
 s_add_u32 s37, s37, s45
 s_lshl_b32 s45, s4, 16
 s_add_u32 s36, s36, s45
 s_mov_b32 s42, s33
 s_mov_b32 s43, 0
 s_and_b32 s53, s42, s93
 s_lshl_b32 s53, s53, s91
 s_add_u32 s53, s53, s38
 s_lshr_b32 s51, s42, s90
 s_add_u32 s51, s51, 1
 ds_read_b128 v[16:19], v5 offset:0
 ds_read_b128 v[20:23], v5 offset:1024
Los0_50:
 buffer_load_dword v2, v3, s[20:23], s53 offen sc1
 s_waitcnt vmcnt(0)
 v_cmp_gt_u32 vcc, s51, v2
 s_and_b32 s52, vcc_lo, 0xffff
 s_cbranch_scc0 Los0k_51
 s_sleep 4
 s_sub_u32 s50, s50, 1
 s_cbranch_scc0 Los0_50
 s_endpgm
Los0k_51:
 s_lshl_b32 s48, s42, 18
 s_add_u32 s48, s48, s36
 s_add_u32 s52, s44, 0
 s_and_b32 s52, s52, 7
 s_lshl_b32 s52, s52, 13
 s_add_u32 s46, s48, s52
 s_add_u32 s47, s46, 4096
 buffer_load_dwordx4 v[32:35], v1, s[20:23], s46 offen offset:0 sc1
 buffer_load_dwordx4 v[36:39], v1, s[20:23], s46 offen offset:1024 sc1
 buffer_load_dwordx4 v[40:43], v1, s[20:23], s46 offen offset:2048 sc1
 buffer_load_dwordx4 v[44:47], v1, s[20:23], s46 offen offset:3072 sc1
 buffer_load_dwordx4 v[48:51], v1, s[20:23], s47 offen offset:0 sc1
 buffer_load_dwordx4 v[52:55], v1, s[20:23], s47 offen offset:1024 sc1
 buffer_load_dwordx4 v[56:59], v1, s[20:23], s47 offen offset:2048 sc1
 buffer_load_dwordx4 v[60:63], v1, s[20:23], s47 offen offset:3072 sc1
 s_add_u32 s52, s44, 1
 s_and_b32 s52, s52, 7
 s_lshl_b32 s52, s52, 13
 s_add_u32 s46, s48, s52
 s_add_u32 s47, s46, 4096
 buffer_load_dwordx4 v[64:67], v1, s[20:23], s46 offen offset:0 sc1
 buffer_load_dwordx4 v[68:71], v1, s[20:23], s46 offen offset:1024 sc1
 buffer_load_dwordx4 v[72:75], v1, s[20:23], s46 offen offset:2048 sc1
 buffer_load_dwordx4 v[76:79], v1, s[20:23], s46 offen offset:3072 sc1
 buffer_load_dwordx4 v[80:83], v1, s[20:23], s47 offen offset:0 sc1
 buffer_load_dwordx4 v[84:87], v1, s[20:23], s47 offen offset:1024 sc1
 buffer_load_dwordx4 v[88:91], v1, s[20:23], s47 offen offset:2048 sc1
 buffer_load_dwordx4 v[92:95], v1, s[20:23], s47 offen offset:3072 sc1
 .p2align 3
Losl_52:
 s_waitcnt vmcnt(14) lgkmcnt(1)
 v_mfma_f32_16x16x32_bf16 v[96:99], a[0:3], v[32:35], 0
 s_add_u32 s52, s44, 2
 s_and_b32 s52, s52, 7
 v_mfma_f32_16x16x32_bf16 v[100:103], a[4:7], v[32:35], 0
 s_lshl_b32 s52, s52, 13
 s_add_u32 s46, s48, s52
 v_mfma_f32_16x16x32_bf16 v[104:107], a[8:11], v[32:35], 0
 s_add_u32 s47, s46, 4096
 v_mfma_f32_16x16x32_bf16 v[108:111], v[16:19], v[32:35], 0
 buffer_load_dwordx4 v[32:35], v1, s[20:23], s46 offen offset:0 sc1
 v_mfma_f32_16x16x32_bf16 v[112:115], a[0:3], v[36:39], 0
 ds_read_b128 v[24:27], v5 offset:2048
 v_mfma_f32_16x16x32_bf16 v[116:119], a[4:7], v[36:39], 0
 v_mfma_f32_16x16x32_bf16 v[120:123], a[8:11], v[36:39], 0
 v_mfma_f32_16x16x32_bf16 v[124:127], v[16:19], v[36:39], 0
 buffer_load_dwordx4 v[36:39], v1, s[20:23], s46 offen offset:1024 sc1
 s_waitcnt vmcnt(14) lgkmcnt(1)
 v_mfma_f32_16x16x32_bf16 v[96:99], a[12:15], v[40:43], v[96:99]
 s_mov_b32 s41, s42
 s_add_u32 s43, s43, 1
 v_mfma_f32_16x16x32_bf16 v[100:103], a[16:19], v[40:43], v[100:103]
 s_cmp_lt_u32 s43, s35
 s_cselect_b32 s45, s34, 0
 v_mfma_f32_16x16x32_bf16 v[104:107], a[20:23], v[40:43], v[104:107]
 s_xor_b32 s34, s34, s39
 s_add_u32 s42, s42, s45
 v_mfma_f32_16x16x32_bf16 v[108:111], v[20:23], v[40:43], v[108:111]
 buffer_load_dwordx4 v[40:43], v1, s[20:23], s46 offen offset:2048 sc1
 v_mfma_f32_16x16x32_bf16 v[112:115], a[12:15], v[44:47], v[112:115]
 ds_read_b128 v[28:31], v5 offset:3072
 v_mfma_f32_16x16x32_bf16 v[116:119], a[16:19], v[44:47], v[116:119]
 v_mfma_f32_16x16x32_bf16 v[120:123], a[20:23], v[44:47], v[120:123]
 v_mfma_f32_16x16x32_bf16 v[124:127], v[20:23], v[44:47], v[124:127]
 buffer_load_dwordx4 v[44:47], v1, s[20:23], s46 offen offset:3072 sc1
 s_waitcnt vmcnt(14) lgkmcnt(1)
 v_mfma_f32_16x16x32_bf16 v[96:99], a[24:27], v[48:51], v[96:99]
 s_and_b32 s53, s42, s93
 s_lshl_b32 s53, s53, s91
 v_mfma_f32_16x16x32_bf16 v[100:103], a[28:31], v[48:51], v[100:103]
 s_add_u32 s53, s53, s38
 s_lshr_b32 s51, s42, s90
 v_mfma_f32_16x16x32_bf16 v[104:107], a[32:35], v[48:51], v[104:107]
 s_add_u32 s51, s51, 1
 v_mfma_f32_16x16x32_bf16 v[108:111], v[24:27], v[48:51], v[108:111]
 buffer_load_dwordx4 v[48:51], v1, s[20:23], s47 offen offset:0 sc1
 v_mfma_f32_16x16x32_bf16 v[112:115], a[24:27], v[52:55], v[112:115]
 ds_read_b128 v[16:19], v5 offset:4096
 v_mfma_f32_16x16x32_bf16 v[116:119], a[28:31], v[52:55], v[116:119]
 v_mfma_f32_16x16x32_bf16 v[120:123], a[32:35], v[52:55], v[120:123]
 v_mfma_f32_16x16x32_bf16 v[124:127], v[24:27], v[52:55], v[124:127]
 buffer_load_dwordx4 v[52:55], v1, s[20:23], s47 offen offset:1024 sc1
 s_waitcnt vmcnt(14) lgkmcnt(1)
 v_mfma_f32_16x16x32_bf16 v[96:99], a[36:39], v[56:59], v[96:99]
 s_mul_i32 s54, s41, 73728
 s_add_u32 s54, s54, s37
 v_mfma_f32_16x16x32_bf16 v[100:103], a[40:43], v[56:59], v[100:103]
 s_cmp_lt_u32 s43, s35
 s_cselect_b32 s51, s51, -1
 v_mfma_f32_16x16x32_bf16 v[104:107], a[44:47], v[56:59], v[104:107]
 v_mfma_f32_16x16x32_bf16 v[108:111], v[28:31], v[56:59], v[108:111]
 buffer_load_dwordx4 v[56:59], v1, s[20:23], s47 offen offset:2048 sc1
 v_mfma_f32_16x16x32_bf16 v[112:115], a[36:39], v[60:63], v[112:115]
 ds_read_b128 v[20:23], v5 offset:5120
 v_mfma_f32_16x16x32_bf16 v[116:119], a[40:43], v[60:63], v[116:119]
 v_mfma_f32_16x16x32_bf16 v[120:123], a[44:47], v[60:63], v[120:123]
 v_mfma_f32_16x16x32_bf16 v[124:127], v[28:31], v[60:63], v[124:127]
 buffer_load_dwordx4 v[60:63], v1, s[20:23], s47 offen offset:3072 sc1
 s_waitcnt vmcnt(14) lgkmcnt(1)
 v_mfma_f32_16x16x32_bf16 v[96:99], a[48:51], v[64:67], v[96:99]
 s_add_u32 s52, s44, 3
 s_and_b32 s52, s52, 7
 v_mfma_f32_16x16x32_bf16 v[100:103], a[52:55], v[64:67], v[100:103]
 s_lshl_b32 s52, s52, 13
 s_add_u32 s46, s48, s52
 v_mfma_f32_16x16x32_bf16 v[104:107], a[56:59], v[64:67], v[104:107]
 s_add_u32 s47, s46, 4096
 v_mfma_f32_16x16x32_bf16 v[108:111], v[16:19], v[64:67], v[108:111]
 buffer_load_dwordx4 v[64:67], v1, s[20:23], s46 offen offset:0 sc1
 v_mfma_f32_16x16x32_bf16 v[112:115], a[48:51], v[68:71], v[112:115]
 ds_read_b128 v[24:27], v5 offset:6144
 v_mfma_f32_16x16x32_bf16 v[116:119], a[52:55], v[68:71], v[116:119]
 v_mfma_f32_16x16x32_bf16 v[120:123], a[56:59], v[68:71], v[120:123]
 v_mfma_f32_16x16x32_bf16 v[124:127], v[16:19], v[68:71], v[124:127]
 buffer_load_dwordx4 v[68:71], v1, s[20:23], s46 offen offset:1024 sc1
 s_waitcnt vmcnt(14) lgkmcnt(1)
 v_mfma_f32_16x16x32_bf16 v[96:99], a[60:63], v[72:75], v[96:99]
 v_mfma_f32_16x16x32_bf16 v[100:103], a[64:67], v[72:75], v[100:103]
 v_mfma_f32_16x16x32_bf16 v[104:107], a[68:71], v[72:75], v[104:107]
 v_mfma_f32_16x16x32_bf16 v[108:111], v[20:23], v[72:75], v[108:111]
 buffer_load_dwordx4 v[72:75], v1, s[20:23], s46 offen offset:2048 sc1
 v_mfma_f32_16x16x32_bf16 v[112:115], a[60:63], v[76:79], v[112:115]
 ds_read_b128 v[28:31], v5 offset:7168
 v_mfma_f32_16x16x32_bf16 v[116:119], a[64:67], v[76:79], v[116:119]
 v_mfma_f32_16x16x32_bf16 v[120:123], a[68:71], v[76:79], v[120:123]
 v_mfma_f32_16x16x32_bf16 v[124:127], v[20:23], v[76:79], v[124:127]
 buffer_load_dwordx4 v[76:79], v1, s[20:23], s46 offen offset:3072 sc1
 s_waitcnt vmcnt(14) lgkmcnt(1)
 v_mfma_f32_16x16x32_bf16 v[96:99], a[72:75], v[80:83], v[96:99]
 v_mfma_f32_16x16x32_bf16 v[100:103], a[76:79], v[80:83], v[100:103]
 v_mfma_f32_16x16x32_bf16 v[104:107], a[80:83], v[80:83], v[104:107]
 v_mfma_f32_16x16x32_bf16 v[108:111], v[24:27], v[80:83], v[108:111]
 buffer_load_dwordx4 v[80:83], v1, s[20:23], s47 offen offset:0 sc1
 v_mfma_f32_16x16x32_bf16 v[112:115], a[72:75], v[84:87], v[112:115]
 ds_read_b128 v[16:19], v5 offset:8192
 v_mfma_f32_16x16x32_bf16 v[116:119], a[76:79], v[84:87], v[116:119]
 v_mfma_f32_16x16x32_bf16 v[120:123], a[80:83], v[84:87], v[120:123]
 v_mfma_f32_16x16x32_bf16 v[124:127], v[24:27], v[84:87], v[124:127]
 buffer_load_dwordx4 v[84:87], v1, s[20:23], s47 offen offset:1024 sc1
 s_waitcnt vmcnt(14) lgkmcnt(1)
 v_mfma_f32_16x16x32_bf16 v[96:99], a[84:87], v[88:91], v[96:99]
 v_mfma_f32_16x16x32_bf16 v[100:103], a[88:91], v[88:91], v[100:103]
 v_mfma_f32_16x16x32_bf16 v[104:107], a[92:95], v[88:91], v[104:107]
 v_mfma_f32_16x16x32_bf16 v[108:111], v[28:31], v[88:91], v[108:111]
 buffer_load_dwordx4 v[88:91], v1, s[20:23], s47 offen offset:2048 sc1
 v_mfma_f32_16x16x32_bf16 v[112:115], a[84:87], v[92:95], v[112:115]
 ds_read_b128 v[20:23], v5 offset:9216
 v_mfma_f32_16x16x32_bf16 v[116:119], a[88:91], v[92:95], v[116:119]
 v_mfma_f32_16x16x32_bf16 v[120:123], a[92:95], v[92:95], v[120:123]
 v_mfma_f32_16x16x32_bf16 v[124:127], v[28:31], v[92:95], v[124:127]
 buffer_load_dwordx4 v[92:95], v1, s[20:23], s47 offen offset:3072 sc1
 s_waitcnt vmcnt(14) lgkmcnt(1)
 v_mfma_f32_16x16x32_bf16 v[96:99], a[96:99], v[32:35], v[96:99]
 s_add_u32 s52, s44, 4
 s_and_b32 s52, s52, 7
 v_mfma_f32_16x16x32_bf16 v[100:103], a[100:103], v[32:35], v[100:103]
 s_lshl_b32 s52, s52, 13
 s_add_u32 s46, s48, s52
 v_mfma_f32_16x16x32_bf16 v[104:107], a[104:107], v[32:35], v[104:107]
 s_add_u32 s47, s46, 4096
 v_mfma_f32_16x16x32_bf16 v[108:111], v[16:19], v[32:35], v[108:111]
 buffer_load_dwordx4 v[32:35], v1, s[20:23], s46 offen offset:0 sc1
 v_mfma_f32_16x16x32_bf16 v[112:115], a[96:99], v[36:39], v[112:115]
 ds_read_b128 v[24:27], v5 offset:10240
 v_mfma_f32_16x16x32_bf16 v[116:119], a[100:103], v[36:39], v[116:119]
 v_mfma_f32_16x16x32_bf16 v[120:123], a[104:107], v[36:39], v[120:123]
 v_mfma_f32_16x16x32_bf16 v[124:127], v[16:19], v[36:39], v[124:127]
 buffer_load_dwordx4 v[36:39], v1, s[20:23], s46 offen offset:1024 sc1
 s_waitcnt vmcnt(14) lgkmcnt(1)
 v_mfma_f32_16x16x32_bf16 v[96:99], a[108:111], v[40:43], v[96:99]
 v_mfma_f32_16x16x32_bf16 v[100:103], a[112:115], v[40:43], v[100:103]
 v_mfma_f32_16x16x32_bf16 v[104:107], a[116:119], v[40:43], v[104:107]
 v_mfma_f32_16x16x32_bf16 v[108:111], v[20:23], v[40:43], v[108:111]
 buffer_load_dwordx4 v[40:43], v1, s[20:23], s46 offen offset:2048 sc1
 v_mfma_f32_16x16x32_bf16 v[112:115], a[108:111], v[44:47], v[112:115]
 ds_read_b128 v[28:31], v5 offset:11264
 v_mfma_f32_16x16x32_bf16 v[116:119], a[112:115], v[44:47], v[116:119]
 v_mfma_f32_16x16x32_bf16 v[120:123], a[116:119], v[44:47], v[120:123]
 v_mfma_f32_16x16x32_bf16 v[124:127], v[20:23], v[44:47], v[124:127]
 buffer_load_dwordx4 v[44:47], v1, s[20:23], s46 offen offset:3072 sc1
 s_waitcnt vmcnt(14) lgkmcnt(1)
 v_mfma_f32_16x16x32_bf16 v[96:99], a[120:123], v[48:51], v[96:99]
 s_barrier
 v_mfma_f32_16x16x32_bf16 v[100:103], a[124:127], v[48:51], v[100:103]
 v_mfma_f32_16x16x32_bf16 v[104:107], a[128:131], v[48:51], v[104:107]
 v_mfma_f32_16x16x32_bf16 v[108:111], v[24:27], v[48:51], v[108:111]
 buffer_load_dwordx4 v[48:51], v1, s[20:23], s47 offen offset:0 sc1
 v_mfma_f32_16x16x32_bf16 v[112:115], a[120:123], v[52:55], v[112:115]
 ds_read_b128 v[16:19], v5 offset:12288
 v_mfma_f32_16x16x32_bf16 v[116:119], a[124:127], v[52:55], v[116:119]
 v_mfma_f32_16x16x32_bf16 v[120:123], a[128:131], v[52:55], v[120:123]
 v_mfma_f32_16x16x32_bf16 v[124:127], v[24:27], v[52:55], v[124:127]
 buffer_load_dwordx4 v[52:55], v1, s[20:23], s47 offen offset:1024 sc1
 s_waitcnt vmcnt(14) lgkmcnt(1)
 v_mfma_f32_16x16x32_bf16 v[96:99], a[132:135], v[56:59], v[96:99]
 v_mfma_f32_16x16x32_bf16 v[100:103], a[136:139], v[56:59], v[100:103]
 v_mfma_f32_16x16x32_bf16 v[104:107], a[140:143], v[56:59], v[104:107]
 v_mfma_f32_16x16x32_bf16 v[108:111], v[28:31], v[56:59], v[108:111]
 buffer_load_dwordx4 v[56:59], v1, s[20:23], s47 offen offset:2048 sc1
 v_mfma_f32_16x16x32_bf16 v[112:115], a[132:135], v[60:63], v[112:115]
 ds_read_b128 v[20:23], v5 offset:13312
 v_mfma_f32_16x16x32_bf16 v[116:119], a[136:139], v[60:63], v[116:119]
 v_mfma_f32_16x16x32_bf16 v[120:123], a[140:143], v[60:63], v[120:123]
 v_mfma_f32_16x16x32_bf16 v[124:127], v[28:31], v[60:63], v[124:127]
 buffer_load_dwordx4 v[60:63], v1, s[20:23], s47 offen offset:3072 sc1
 s_waitcnt vmcnt(14) lgkmcnt(1)
 v_mfma_f32_16x16x32_bf16 v[96:99], a[144:147], v[64:67], v[96:99]
 s_add_u32 s52, s44, 5
 s_and_b32 s52, s52, 7
 v_mfma_f32_16x16x32_bf16 v[100:103], a[148:151], v[64:67], v[100:103]
 s_lshl_b32 s52, s52, 13
 s_add_u32 s46, s48, s52
 v_mfma_f32_16x16x32_bf16 v[104:107], a[152:155], v[64:67], v[104:107]
 s_add_u32 s47, s46, 4096
 v_mfma_f32_16x16x32_bf16 v[108:111], v[16:19], v[64:67], v[108:111]
 buffer_load_dwordx4 v[64:67], v1, s[20:23], s46 offen offset:0 sc1
 v_mfma_f32_16x16x32_bf16 v[112:115], a[144:147], v[68:71], v[112:115]
 ds_read_b128 v[24:27], v5 offset:14336
 v_mfma_f32_16x16x32_bf16 v[116:119], a[148:151], v[68:71], v[116:119]
 v_mfma_f32_16x16x32_bf16 v[120:123], a[152:155], v[68:71], v[120:123]
 v_mfma_f32_16x16x32_bf16 v[124:127], v[16:19], v[68:71], v[124:127]
 buffer_load_dwordx4 v[68:71], v1, s[20:23], s46 offen offset:1024 sc1
 s_waitcnt vmcnt(14) lgkmcnt(1)
 v_mfma_f32_16x16x32_bf16 v[96:99], a[156:159], v[72:75], v[96:99]
 buffer_load_dword v2, v3, s[20:23], s53 offen sc1
 v_mfma_f32_16x16x32_bf16 v[100:103], a[160:163], v[72:75], v[100:103]
 v_mfma_f32_16x16x32_bf16 v[104:107], a[164:167], v[72:75], v[104:107]
 v_mfma_f32_16x16x32_bf16 v[108:111], v[20:23], v[72:75], v[108:111]
 buffer_load_dwordx4 v[72:75], v1, s[20:23], s46 offen offset:2048 sc1
 v_mfma_f32_16x16x32_bf16 v[112:115], a[156:159], v[76:79], v[112:115]
 ds_read_b128 v[28:31], v5 offset:15360
 v_mfma_f32_16x16x32_bf16 v[116:119], a[160:163], v[76:79], v[116:119]
 v_mfma_f32_16x16x32_bf16 v[120:123], a[164:167], v[76:79], v[120:123]
 v_mfma_f32_16x16x32_bf16 v[124:127], v[20:23], v[76:79], v[124:127]
 buffer_load_dwordx4 v[76:79], v1, s[20:23], s46 offen offset:3072 sc1
 s_waitcnt vmcnt(14) lgkmcnt(1)
 v_mfma_f32_16x16x32_bf16 v[96:99], a[168:171], v[80:83], v[96:99]
 v_mfma_f32_16x16x32_bf16 v[100:103], a[172:175], v[80:83], v[100:103]
 v_mfma_f32_16x16x32_bf16 v[104:107], a[176:179], v[80:83], v[104:107]
 v_mfma_f32_16x16x32_bf16 v[108:111], v[24:27], v[80:83], v[108:111]
 buffer_load_dwordx4 v[80:83], v1, s[20:23], s47 offen offset:0 sc1
 v_mfma_f32_16x16x32_bf16 v[112:115], a[168:171], v[84:87], v[112:115]
 ds_read_b128 v[16:19], v5 offset:16384
 v_mfma_f32_16x16x32_bf16 v[116:119], a[172:175], v[84:87], v[116:119]
 v_mfma_f32_16x16x32_bf16 v[120:123], a[176:179], v[84:87], v[120:123]
 v_mfma_f32_16x16x32_bf16 v[124:127], v[24:27], v[84:87], v[124:127]
 buffer_load_dwordx4 v[84:87], v1, s[20:23], s47 offen offset:1024 sc1
 s_waitcnt vmcnt(14) lgkmcnt(1)
 v_mfma_f32_16x16x32_bf16 v[96:99], a[180:183], v[88:91], v[96:99]
 v_mfma_f32_16x16x32_bf16 v[100:103], a[184:187], v[88:91], v[100:103]
 v_mfma_f32_16x16x32_bf16 v[104:107], a[188:191], v[88:91], v[104:107]
 v_mfma_f32_16x16x32_bf16 v[108:111], v[28:31], v[88:91], v[108:111]
 buffer_load_dwordx4 v[88:91], v1, s[20:23], s47 offen offset:2048 sc1
 v_mfma_f32_16x16x32_bf16 v[112:115], a[180:183], v[92:95], v[112:115]
 ds_read_b128 v[20:23], v5 offset:17408
 v_mfma_f32_16x16x32_bf16 v[116:119], a[184:187], v[92:95], v[116:119]
 v_mfma_f32_16x16x32_bf16 v[120:123], a[188:191], v[92:95], v[120:123]
 v_mfma_f32_16x16x32_bf16 v[124:127], v[28:31], v[92:95], v[124:127]
 buffer_load_dwordx4 v[92:95], v1, s[20:23], s47 offen offset:3072 sc1
 s_waitcnt vmcnt(14) lgkmcnt(1)
 v_mfma_f32_16x16x32_bf16 v[96:99], a[192:195], v[32:35], v[96:99]
 s_add_u32 s52, s44, 6
 s_and_b32 s52, s52, 7
 v_mfma_f32_16x16x32_bf16 v[100:103], a[196:199], v[32:35], v[100:103]
 s_lshl_b32 s52, s52, 13
 s_add_u32 s46, s48, s52
 v_mfma_f32_16x16x32_bf16 v[104:107], a[200:203], v[32:35], v[104:107]
 s_add_u32 s47, s46, 4096
 v_mfma_f32_16x16x32_bf16 v[108:111], v[16:19], v[32:35], v[108:111]
 buffer_load_dwordx4 v[32:35], v1, s[20:23], s46 offen offset:0 sc1
 v_mfma_f32_16x16x32_bf16 v[112:115], a[192:195], v[36:39], v[112:115]
 ds_read_b128 v[24:27], v5 offset:18432
 v_mfma_f32_16x16x32_bf16 v[116:119], a[196:199], v[36:39], v[116:119]
 v_mfma_f32_16x16x32_bf16 v[120:123], a[200:203], v[36:39], v[120:123]
 v_mfma_f32_16x16x32_bf16 v[124:127], v[16:19], v[36:39], v[124:127]
 buffer_load_dwordx4 v[36:39], v1, s[20:23], s46 offen offset:1024 sc1
 s_waitcnt vmcnt(14) lgkmcnt(1)
 v_mfma_f32_16x16x32_bf16 v[96:99], a[204:207], v[40:43], v[96:99]
 v_mfma_f32_16x16x32_bf16 v[100:103], a[208:211], v[40:43], v[100:103]
 v_mfma_f32_16x16x32_bf16 v[104:107], a[212:215], v[40:43], v[104:107]
 v_mfma_f32_16x16x32_bf16 v[108:111], v[20:23], v[40:43], v[108:111]
 buffer_load_dwordx4 v[40:43], v1, s[20:23], s46 offen offset:2048 sc1
 v_mfma_f32_16x16x32_bf16 v[112:115], a[204:207], v[44:47], v[112:115]
 ds_read_b128 v[28:31], v5 offset:19456
 v_mfma_f32_16x16x32_bf16 v[116:119], a[208:211], v[44:47], v[116:119]
 v_mfma_f32_16x16x32_bf16 v[120:123], a[212:215], v[44:47], v[120:123]
 v_mfma_f32_16x16x32_bf16 v[124:127], v[20:23], v[44:47], v[124:127]
 buffer_load_dwordx4 v[44:47], v1, s[20:23], s46 offen offset:3072 sc1
 s_waitcnt vmcnt(14) lgkmcnt(1)
 v_mfma_f32_16x16x32_bf16 v[96:99], a[216:219], v[48:51], v[96:99]
 v_mfma_f32_16x16x32_bf16 v[100:103], a[220:223], v[48:51], v[100:103]
 v_mfma_f32_16x16x32_bf16 v[104:107], a[224:227], v[48:51], v[104:107]
 v_mfma_f32_16x16x32_bf16 v[108:111], v[24:27], v[48:51], v[108:111]
 buffer_load_dwordx4 v[48:51], v1, s[20:23], s47 offen offset:0 sc1
 v_mfma_f32_16x16x32_bf16 v[112:115], a[216:219], v[52:55], v[112:115]
 ds_read_b128 v[16:19], v5 offset:20480
 v_mfma_f32_16x16x32_bf16 v[116:119], a[220:223], v[52:55], v[116:119]
 v_mfma_f32_16x16x32_bf16 v[120:123], a[224:227], v[52:55], v[120:123]
 v_mfma_f32_16x16x32_bf16 v[124:127], v[24:27], v[52:55], v[124:127]
 buffer_load_dwordx4 v[52:55], v1, s[20:23], s47 offen offset:1024 sc1
 s_waitcnt vmcnt(14) lgkmcnt(1)
 v_mfma_f32_16x16x32_bf16 v[96:99], a[228:231], v[56:59], v[96:99]
 v_mfma_f32_16x16x32_bf16 v[100:103], a[232:235], v[56:59], v[100:103]
 v_mfma_f32_16x16x32_bf16 v[104:107], a[236:239], v[56:59], v[104:107]
 v_mfma_f32_16x16x32_bf16 v[108:111], v[28:31], v[56:59], v[108:111]
 buffer_load_dwordx4 v[56:59], v1, s[20:23], s47 offen offset:2048 sc1
 v_mfma_f32_16x16x32_bf16 v[112:115], a[228:231], v[60:63], v[112:115]
 ds_read_b128 v[20:23], v5 offset:21504
 v_mfma_f32_16x16x32_bf16 v[116:119], a[232:235], v[60:63], v[116:119]
 v_mfma_f32_16x16x32_bf16 v[120:123], a[236:239], v[60:63], v[120:123]
 v_mfma_f32_16x16x32_bf16 v[124:127], v[28:31], v[60:63], v[124:127]
 buffer_load_dwordx4 v[60:63], v1, s[20:23], s47 offen offset:3072 sc1
 s_waitcnt vmcnt(14) lgkmcnt(1)
 v_mfma_f32_16x16x32_bf16 v[96:99], a[240:243], v[64:67], v[96:99]
 s_add_u32 s52, s44, 7
 s_and_b32 s52, s52, 7
 v_mfma_f32_16x16x32_bf16 v[100:103], a[244:247], v[64:67], v[100:103]
 s_lshl_b32 s52, s52, 13
 s_add_u32 s46, s48, s52
 v_mfma_f32_16x16x32_bf16 v[104:107], a[248:251], v[64:67], v[104:107]
 s_add_u32 s47, s46, 4096
 v_mfma_f32_16x16x32_bf16 v[108:111], v[16:19], v[64:67], v[108:111]
 buffer_load_dwordx4 v[64:67], v1, s[20:23], s46 offen offset:0 sc1
 v_mfma_f32_16x16x32_bf16 v[112:115], a[240:243], v[68:71], v[112:115]
 ds_read_b128 v[24:27], v5 offset:22528
 v_mfma_f32_16x16x32_bf16 v[116:119], a[244:247], v[68:71], v[116:119]
 v_mfma_f32_16x16x32_bf16 v[120:123], a[248:251], v[68:71], v[120:123]
 v_mfma_f32_16x16x32_bf16 v[124:127], v[16:19], v[68:71], v[124:127]
 buffer_load_dwordx4 v[68:71], v1, s[20:23], s46 offen offset:1024 sc1
 s_waitcnt vmcnt(14) lgkmcnt(1)
 v_mfma_f32_16x16x32_bf16 v[96:99], a[252:255], v[72:75], v[96:99]
 v_mfma_f32_16x16x32_bf16 v[100:103], v[128:131], v[72:75], v[100:103]
 v_mfma_f32_16x16x32_bf16 v[104:107], v[132:135], v[72:75], v[104:107]
 v_mfma_f32_16x16x32_bf16 v[108:111], v[20:23], v[72:75], v[108:111]
 buffer_load_dwordx4 v[72:75], v1, s[20:23], s46 offen offset:2048 sc1
 v_mfma_f32_16x16x32_bf16 v[112:115], a[252:255], v[76:79], v[112:115]
 ds_read_b128 v[28:31], v5 offset:23552
 v_mfma_f32_16x16x32_bf16 v[116:119], v[128:131], v[76:79], v[116:119]
 v_mfma_f32_16x16x32_bf16 v[120:123], v[132:135], v[76:79], v[120:123]
 v_mfma_f32_16x16x32_bf16 v[124:127], v[20:23], v[76:79], v[124:127]
 buffer_load_dwordx4 v[76:79], v1, s[20:23], s46 offen offset:3072 sc1
 s_waitcnt vmcnt(14) lgkmcnt(1)
 v_mfma_f32_16x16x32_bf16 v[96:99], v[136:139], v[80:83], v[96:99]
 v_cmp_gt_u32 vcc, s51, v2
 v_mfma_f32_16x16x32_bf16 v[100:103], v[140:143], v[80:83], v[100:103]
 v_mfma_f32_16x16x32_bf16 v[104:107], v[144:147], v[80:83], v[104:107]
 v_mfma_f32_16x16x32_bf16 v[108:111], v[24:27], v[80:83], v[108:111]
 buffer_load_dwordx4 v[80:83], v1, s[20:23], s47 offen offset:0 sc1
 v_mfma_f32_16x16x32_bf16 v[112:115], v[136:139], v[84:87], v[112:115]
 ds_read_b128 v[16:19], v5 offset:24576
 v_mfma_f32_16x16x32_bf16 v[116:119], v[140:143], v[84:87], v[116:119]
 v_mfma_f32_16x16x32_bf16 v[120:123], v[144:147], v[84:87], v[120:123]
 v_mfma_f32_16x16x32_bf16 v[124:127], v[24:27], v[84:87], v[124:127]
 buffer_load_dwordx4 v[84:87], v1, s[20:23], s47 offen offset:1024 sc1
 s_waitcnt vmcnt(14) lgkmcnt(1)
 v_mfma_f32_16x16x32_bf16 v[96:99], v[148:151], v[88:91], v[96:99]
 s_lshl_b32 s48, s42, 18
 s_add_u32 s48, s48, s36
 v_mfma_f32_16x16x32_bf16 v[100:103], v[152:155], v[88:91], v[100:103]
 s_and_b32 s52, vcc_lo, 0xffff
 v_mfma_f32_16x16x32_bf16 v[104:107], v[156:159], v[88:91], v[104:107]
 v_mfma_f32_16x16x32_bf16 v[108:111], v[28:31], v[88:91], v[108:111]
 buffer_load_dwordx4 v[88:91], v1, s[20:23], s47 offen offset:2048 sc1
 v_mfma_f32_16x16x32_bf16 v[112:115], v[148:151], v[92:95], v[112:115]
 ds_read_b128 v[20:23], v5 offset:25600
 v_mfma_f32_16x16x32_bf16 v[116:119], v[152:155], v[92:95], v[116:119]
 v_mfma_f32_16x16x32_bf16 v[120:123], v[156:159], v[92:95], v[120:123]
 v_mfma_f32_16x16x32_bf16 v[124:127], v[28:31], v[92:95], v[124:127]
 buffer_load_dwordx4 v[92:95], v1, s[20:23], s47 offen offset:3072 sc1
 s_cbranch_scc1 Losw_53
 s_waitcnt vmcnt(14) lgkmcnt(1)
 v_mfma_f32_16x16x32_bf16 v[96:99], v[160:163], v[32:35], v[96:99]
 s_add_u32 s52, s44, 0
 s_and_b32 s52, s52, 7
 v_mfma_f32_16x16x32_bf16 v[100:103], v[164:167], v[32:35], v[100:103]
 s_lshl_b32 s52, s52, 13
 s_add_u32 s46, s48, s52
 v_mfma_f32_16x16x32_bf16 v[104:107], v[168:171], v[32:35], v[104:107]
 s_add_u32 s47, s46, 4096
 v_mfma_f32_16x16x32_bf16 v[108:111], v[16:19], v[32:35], v[108:111]
 buffer_load_dwordx4 v[32:35], v1, s[20:23], s46 offen offset:0 sc1
 v_mfma_f32_16x16x32_bf16 v[112:115], v[160:163], v[36:39], v[112:115]
 ds_read_b128 v[24:27], v5 offset:26624
 v_mfma_f32_16x16x32_bf16 v[116:119], v[164:167], v[36:39], v[116:119]
 v_mfma_f32_16x16x32_bf16 v[120:123], v[168:171], v[36:39], v[120:123]
 v_mfma_f32_16x16x32_bf16 v[124:127], v[16:19], v[36:39], v[124:127]
 buffer_load_dwordx4 v[36:39], v1, s[20:23], s46 offen offset:1024 sc1
 s_waitcnt vmcnt(14) lgkmcnt(1)
 v_mfma_f32_16x16x32_bf16 v[96:99], v[172:175], v[40:43], v[96:99]
 v_mfma_f32_16x16x32_bf16 v[100:103], v[176:179], v[40:43], v[100:103]
 v_mfma_f32_16x16x32_bf16 v[104:107], v[180:183], v[40:43], v[104:107]
 v_mfma_f32_16x16x32_bf16 v[108:111], v[20:23], v[40:43], v[108:111]
 buffer_load_dwordx4 v[40:43], v1, s[20:23], s46 offen offset:2048 sc1
 v_mfma_f32_16x16x32_bf16 v[112:115], v[172:175], v[44:47], v[112:115]
 ds_read_b128 v[28:31], v5 offset:27648
 v_mfma_f32_16x16x32_bf16 v[116:119], v[176:179], v[44:47], v[116:119]
 v_mfma_f32_16x16x32_bf16 v[120:123], v[180:183], v[44:47], v[120:123]
 v_mfma_f32_16x16x32_bf16 v[124:127], v[20:23], v[44:47], v[124:127]
 buffer_load_dwordx4 v[44:47], v1, s[20:23], s46 offen offset:3072 sc1
 s_waitcnt vmcnt(14) lgkmcnt(1)
 v_mfma_f32_16x16x32_bf16 v[96:99], v[184:187], v[48:51], v[96:99]
 v_mfma_f32_16x16x32_bf16 v[100:103], v[188:191], v[48:51], v[100:103]
 v_mfma_f32_16x16x32_bf16 v[104:107], v[192:195], v[48:51], v[104:107]
 v_mfma_f32_16x16x32_bf16 v[108:111], v[24:27], v[48:51], v[108:111]
 buffer_load_dwordx4 v[48:51], v1, s[20:23], s47 offen offset:0 sc1
 v_mfma_f32_16x16x32_bf16 v[112:115], v[184:187], v[52:55], v[112:115]
 ds_read_b128 v[16:19], v5 offset:28672
 v_mfma_f32_16x16x32_bf16 v[116:119], v[188:191], v[52:55], v[116:119]
 v_mfma_f32_16x16x32_bf16 v[120:123], v[192:195], v[52:55], v[120:123]
 v_mfma_f32_16x16x32_bf16 v[124:127], v[24:27], v[52:55], v[124:127]
 buffer_load_dwordx4 v[52:55], v1, s[20:23], s47 offen offset:1024 sc1
 s_waitcnt vmcnt(14) lgkmcnt(1)
 v_mfma_f32_16x16x32_bf16 v[96:99], v[196:199], v[56:59], v[96:99]
 v_mfma_f32_16x16x32_bf16 v[100:103], v[200:203], v[56:59], v[100:103]
 v_mfma_f32_16x16x32_bf16 v[104:107], v[204:207], v[56:59], v[104:107]
 v_mfma_f32_16x16x32_bf16 v[108:111], v[28:31], v[56:59], v[108:111]
 buffer_load_dwordx4 v[56:59], v1, s[20:23], s47 offen offset:2048 sc1
 v_mfma_f32_16x16x32_bf16 v[112:115], v[196:199], v[60:63], v[112:115]
 ds_read_b128 v[20:23], v5 offset:29696
 v_mfma_f32_16x16x32_bf16 v[116:119], v[200:203], v[60:63], v[116:119]
 v_mfma_f32_16x16x32_bf16 v[120:123], v[204:207], v[60:63], v[120:123]
 v_mfma_f32_16x16x32_bf16 v[124:127], v[28:31], v[60:63], v[124:127]
 buffer_load_dwordx4 v[60:63], v1, s[20:23], s47 offen offset:3072 sc1
 s_waitcnt vmcnt(14) lgkmcnt(1)
 v_mfma_f32_16x16x32_bf16 v[96:99], v[208:211], v[64:67], v[96:99]
 s_add_u32 s52, s44, 1
 s_and_b32 s52, s52, 7
 v_mfma_f32_16x16x32_bf16 v[100:103], v[212:215], v[64:67], v[100:103]
 s_lshl_b32 s52, s52, 13
 s_add_u32 s46, s48, s52
 v_mfma_f32_16x16x32_bf16 v[104:107], v[216:219], v[64:67], v[104:107]
 s_add_u32 s47, s46, 4096
 v_mfma_f32_16x16x32_bf16 v[108:111], v[16:19], v[64:67], v[108:111]
 buffer_load_dwordx4 v[64:67], v1, s[20:23], s46 offen offset:0 sc1
 v_mfma_f32_16x16x32_bf16 v[112:115], v[208:211], v[68:71], v[112:115]
 ds_read_b128 v[24:27], v5 offset:30720
 v_mfma_f32_16x16x32_bf16 v[116:119], v[212:215], v[68:71], v[116:119]
 v_mfma_f32_16x16x32_bf16 v[120:123], v[216:219], v[68:71], v[120:123]
 v_mfma_f32_16x16x32_bf16 v[124:127], v[16:19], v[68:71], v[124:127]
 buffer_load_dwordx4 v[68:71], v1, s[20:23], s46 offen offset:1024 sc1
 s_waitcnt vmcnt(14) lgkmcnt(1)
 v_mfma_f32_16x16x32_bf16 v[96:99], v[220:223], v[72:75], v[96:99]
 v_mfma_f32_16x16x32_bf16 v[100:103], v[224:227], v[72:75], v[100:103]
 v_mfma_f32_16x16x32_bf16 v[104:107], v[228:231], v[72:75], v[104:107]
 v_mfma_f32_16x16x32_bf16 v[108:111], v[20:23], v[72:75], v[108:111]
 buffer_load_dwordx4 v[72:75], v1, s[20:23], s46 offen offset:2048 sc1
 v_mfma_f32_16x16x32_bf16 v[112:115], v[220:223], v[76:79], v[112:115]
 ds_read_b128 v[28:31], v5 offset:31744
 v_mfma_f32_16x16x32_bf16 v[116:119], v[224:227], v[76:79], v[116:119]
 v_mfma_f32_16x16x32_bf16 v[120:123], v[228:231], v[76:79], v[120:123]
 v_mfma_f32_16x16x32_bf16 v[124:127], v[20:23], v[76:79], v[124:127]
 buffer_load_dwordx4 v[76:79], v1, s[20:23], s46 offen offset:3072 sc1
 s_waitcnt vmcnt(14) lgkmcnt(1)
 v_mfma_f32_16x16x32_bf16 v[96:99], v[232:235], v[80:83], v[96:99]
 v_mfma_f32_16x16x32_bf16 v[100:103], v[236:239], v[80:83], v[100:103]
 v_mfma_f32_16x16x32_bf16 v[104:107], v[240:243], v[80:83], v[104:107]
 v_mfma_f32_16x16x32_bf16 v[108:111], v[24:27], v[80:83], v[108:111]
 buffer_load_dwordx4 v[80:83], v1, s[20:23], s47 offen offset:0 sc1
 v_mfma_f32_16x16x32_bf16 v[112:115], v[232:235], v[84:87], v[112:115]
 ds_read_b128 v[16:19], v5 offset:0
 v_mfma_f32_16x16x32_bf16 v[116:119], v[236:239], v[84:87], v[116:119]
 v_mfma_f32_16x16x32_bf16 v[120:123], v[240:243], v[84:87], v[120:123]
 v_mfma_f32_16x16x32_bf16 v[124:127], v[24:27], v[84:87], v[124:127]
 buffer_load_dwordx4 v[84:87], v1, s[20:23], s47 offen offset:1024 sc1
 s_waitcnt vmcnt(14) lgkmcnt(1)
 v_mfma_f32_16x16x32_bf16 v[96:99], v[244:247], v[88:91], v[96:99]
 v_mfma_f32_16x16x32_bf16 v[100:103], v[248:251], v[88:91], v[100:103]
 v_mfma_f32_16x16x32_bf16 v[104:107], v[252:255], v[88:91], v[104:107]
 v_mfma_f32_16x16x32_bf16 v[108:111], v[28:31], v[88:91], v[108:111]
 buffer_load_dwordx4 v[88:91], v1, s[20:23], s47 offen offset:2048 sc1
 v_mfma_f32_16x16x32_bf16 v[112:115], v[244:247], v[92:95], v[112:115]
 ds_read_b128 v[20:23], v5 offset:1024
 v_mfma_f32_16x16x32_bf16 v[116:119], v[248:251], v[92:95], v[116:119]
 v_mfma_f32_16x16x32_bf16 v[120:123], v[252:255], v[92:95], v[120:123]
 v_mfma_f32_16x16x32_bf16 v[124:127], v[28:31], v[92:95], v[124:127]
 buffer_load_dwordx4 v[92:95], v1, s[20:23], s47 offen offset:3072 sc1
 s_nop 0
 ds_write_b128 v14, v[96:99] offset:32768
 ds_write_b128 v15, v[100:103] offset:33792
 ds_write_b128 v14, v[104:107] offset:34816
 ds_write_b128 v15, v[108:111] offset:35840
 ds_write_b128 v14, v[112:115] offset:36864
 ds_write_b128 v15, v[116:119] offset:37888
 ds_write_b128 v14, v[120:123] offset:38912
 ds_write_b128 v15, v[124:127] offset:39936
 s_waitcnt lgkmcnt(0)
 s_barrier
 ds_read_b128 v[96:99], v4 offset:0
 ds_read_b128 v[100:103], v4 offset:256
 ds_read_b128 v[104:107], v4 offset:40960
 ds_read_b128 v[108:111], v4 offset:41216
 ds_read_b128 v[112:115], v7 offset:0
 ds_read_b128 v[116:119], v7 offset:256
 ds_read_b128 v[120:123], v7 offset:40960
 ds_read_b128 v[124:127], v7 offset:41216
 s_waitcnt lgkmcnt(4)
 v_pk_add_f32 v[96:97], v[96:97], v[104:105]
 v_pk_add_f32 v[98:99], v[98:99], v[106:107]
 v_pk_add_f32 v[100:101], v[100:101], v[108:109]
 v_pk_add_f32 v[102:103], v[102:103], v[110:111]
 s_waitcnt lgkmcnt(2)
 v_pk_add_f32 v[96:97], v[96:97], v[112:113]
 v_pk_add_f32 v[98:99], v[98:99], v[114:115]
 v_pk_add_f32 v[100:101], v[100:101], v[116:117]
 v_pk_add_f32 v[102:103], v[102:103], v[118:119]
 s_waitcnt lgkmcnt(0)
 v_pk_add_f32 v[96:97], v[96:97], v[120:121]
 v_pk_add_f32 v[98:99], v[98:99], v[122:123]
 v_pk_add_f32 v[100:101], v[100:101], v[124:125]
 v_pk_add_f32 v[102:103], v[102:103], v[126:127]
 v_cvt_pk_bf16_f32 v8, v96, v97
 v_cvt_pk_bf16_f32 v9, v98, v99
 v_cvt_pk_bf16_f32 v10, v100, v101
 v_cvt_pk_bf16_f32 v11, v102, v103
 buffer_store_dwordx4 v[8:11], v6, s[24:27], s54 offen
 s_branch Losl_52
Losw_53:
 s_waitcnt vmcnt(14) lgkmcnt(1)
 v_mfma_f32_16x16x32_bf16 v[96:99], v[160:163], v[32:35], v[96:99]
 v_mfma_f32_16x16x32_bf16 v[100:103], v[164:167], v[32:35], v[100:103]
 v_mfma_f32_16x16x32_bf16 v[104:107], v[168:171], v[32:35], v[104:107]
 v_mfma_f32_16x16x32_bf16 v[108:111], v[16:19], v[32:35], v[108:111]
 v_mfma_f32_16x16x32_bf16 v[112:115], v[160:163], v[36:39], v[112:115]
 ds_read_b128 v[24:27], v5 offset:26624
 v_mfma_f32_16x16x32_bf16 v[116:119], v[164:167], v[36:39], v[116:119]
 v_mfma_f32_16x16x32_bf16 v[120:123], v[168:171], v[36:39], v[120:123]
 v_mfma_f32_16x16x32_bf16 v[124:127], v[16:19], v[36:39], v[124:127]
 s_waitcnt vmcnt(12) lgkmcnt(1)
 v_mfma_f32_16x16x32_bf16 v[96:99], v[172:175], v[40:43], v[96:99]
 v_mfma_f32_16x16x32_bf16 v[100:103], v[176:179], v[40:43], v[100:103]
 v_mfma_f32_16x16x32_bf16 v[104:107], v[180:183], v[40:43], v[104:107]
 v_mfma_f32_16x16x32_bf16 v[108:111], v[20:23], v[40:43], v[108:111]
 v_mfma_f32_16x16x32_bf16 v[112:115], v[172:175], v[44:47], v[112:115]
 ds_read_b128 v[28:31], v5 offset:27648
 v_mfma_f32_16x16x32_bf16 v[116:119], v[176:179], v[44:47], v[116:119]
 v_mfma_f32_16x16x32_bf16 v[120:123], v[180:183], v[44:47], v[120:123]
 v_mfma_f32_16x16x32_bf16 v[124:127], v[20:23], v[44:47], v[124:127]
 s_waitcnt vmcnt(10) lgkmcnt(1)
 v_mfma_f32_16x16x32_bf16 v[96:99], v[184:187], v[48:51], v[96:99]
 v_mfma_f32_16x16x32_bf16 v[100:103], v[188:191], v[48:51], v[100:103]
 v_mfma_f32_16x16x32_bf16 v[104:107], v[192:195], v[48:51], v[104:107]
 v_mfma_f32_16x16x32_bf16 v[108:111], v[24:27], v[48:51], v[108:111]
 v_mfma_f32_16x16x32_bf16 v[112:115], v[184:187], v[52:55], v[112:115]
 ds_read_b128 v[16:19], v5 offset:28672
 v_mfma_f32_16x16x32_bf16 v[116:119], v[188:191], v[52:55], v[116:119]
 v_mfma_f32_16x16x32_bf16 v[120:123], v[192:195], v[52:55], v[120:123]
 v_mfma_f32_16x16x32_bf16 v[124:127], v[24:27], v[52:55], v[124:127]
 s_waitcnt vmcnt(8) lgkmcnt(1)
 v_mfma_f32_16x16x32_bf16 v[96:99], v[196:199], v[56:59], v[96:99]
 v_mfma_f32_16x16x32_bf16 v[100:103], v[200:203], v[56:59], v[100:103]
 v_mfma_f32_16x16x32_bf16 v[104:107], v[204:207], v[56:59], v[104:107]
 v_mfma_f32_16x16x32_bf16 v[108:111], v[28:31], v[56:59], v[108:111]
 v_mfma_f32_16x16x32_bf16 v[112:115], v[196:199], v[60:63], v[112:115]
 ds_read_b128 v[20:23], v5 offset:29696
 v_mfma_f32_16x16x32_bf16 v[116:119], v[200:203], v[60:63], v[116:119]
 v_mfma_f32_16x16x32_bf16 v[120:123], v[204:207], v[60:63], v[120:123]
 v_mfma_f32_16x16x32_bf16 v[124:127], v[28:31], v[60:63], v[124:127]
 s_waitcnt vmcnt(6) lgkmcnt(1)
 v_mfma_f32_16x16x32_bf16 v[96:99], v[208:211], v[64:67], v[96:99]
 v_mfma_f32_16x16x32_bf16 v[100:103], v[212:215], v[64:67], v[100:103]
 v_mfma_f32_16x16x32_bf16 v[104:107], v[216:219], v[64:67], v[104:107]
 v_mfma_f32_16x16x32_bf16 v[108:111], v[16:19], v[64:67], v[108:111]
 v_mfma_f32_16x16x32_bf16 v[112:115], v[208:211], v[68:71], v[112:115]
 ds_read_b128 v[24:27], v5 offset:30720
 v_mfma_f32_16x16x32_bf16 v[116:119], v[212:215], v[68:71], v[116:119]
 v_mfma_f32_16x16x32_bf16 v[120:123], v[216:219], v[68:71], v[120:123]
 v_mfma_f32_16x16x32_bf16 v[124:127], v[16:19], v[68:71], v[124:127]
 s_waitcnt vmcnt(4) lgkmcnt(1)
 v_mfma_f32_16x16x32_bf16 v[96:99], v[220:223], v[72:75], v[96:99]
 v_mfma_f32_16x16x32_bf16 v[100:103], v[224:227], v[72:75], v[100:103]
 v_mfma_f32_16x16x32_bf16 v[104:107], v[228:231], v[72:75], v[104:107]
 v_mfma_f32_16x16x32_bf16 v[108:111], v[20:23], v[72:75], v[108:111]
 v_mfma_f32_16x16x32_bf16 v[112:115], v[220:223], v[76:79], v[112:115]
 ds_read_b128 v[28:31], v5 offset:31744
 v_mfma_f32_16x16x32_bf16 v[116:119], v[224:227], v[76:79], v[116:119]
 v_mfma_f32_16x16x32_bf16 v[120:123], v[228:231], v[76:79], v[120:123]
 v_mfma_f32_16x16x32_bf16 v[124:127], v[20:23], v[76:79], v[124:127]
 s_waitcnt vmcnt(2) lgkmcnt(1)
 v_mfma_f32_16x16x32_bf16 v[96:99], v[232:235], v[80:83], v[96:99]
 v_mfma_f32_16x16x32_bf16 v[100:103], v[236:239], v[80:83], v[100:103]
 v_mfma_f32_16x16x32_bf16 v[104:107], v[240:243], v[80:83], v[104:107]
 v_mfma_f32_16x16x32_bf16 v[108:111], v[24:27], v[80:83], v[108:111]
 v_mfma_f32_16x16x32_bf16 v[112:115], v[232:235], v[84:87], v[112:115]
 ds_read_b128 v[16:19], v5 offset:0
 v_mfma_f32_16x16x32_bf16 v[116:119], v[236:239], v[84:87], v[116:119]
 v_mfma_f32_16x16x32_bf16 v[120:123], v[240:243], v[84:87], v[120:123]
 v_mfma_f32_16x16x32_bf16 v[124:127], v[24:27], v[84:87], v[124:127]
 s_waitcnt vmcnt(0) lgkmcnt(1)
 v_mfma_f32_16x16x32_bf16 v[96:99], v[244:247], v[88:91], v[96:99]
 v_mfma_f32_16x16x32_bf16 v[100:103], v[248:251], v[88:91], v[100:103]
 v_mfma_f32_16x16x32_bf16 v[104:107], v[252:255], v[88:91], v[104:107]
 v_mfma_f32_16x16x32_bf16 v[108:111], v[28:31], v[88:91], v[108:111]
 v_mfma_f32_16x16x32_bf16 v[112:115], v[244:247], v[92:95], v[112:115]
 ds_read_b128 v[20:23], v5 offset:1024
 v_mfma_f32_16x16x32_bf16 v[116:119], v[248:251], v[92:95], v[116:119]
 v_mfma_f32_16x16x32_bf16 v[120:123], v[252:255], v[92:95], v[120:123]
 v_mfma_f32_16x16x32_bf16 v[124:127], v[28:31], v[92:95], v[124:127]
 s_cmp_lt_u32 s43, s35
 ds_write_b128 v14, v[96:99] offset:32768
 ds_write_b128 v15, v[100:103] offset:33792
 ds_write_b128 v14, v[104:107] offset:34816
 ds_write_b128 v15, v[108:111] offset:35840
 ds_write_b128 v14, v[112:115] offset:36864
 ds_write_b128 v15, v[116:119] offset:37888
 ds_write_b128 v14, v[120:123] offset:38912
 ds_write_b128 v15, v[124:127] offset:39936
 s_waitcnt lgkmcnt(0)
 s_barrier
 ds_read_b128 v[96:99], v4 offset:0
 ds_read_b128 v[100:103], v4 offset:256
 ds_read_b128 v[104:107], v4 offset:40960
 ds_read_b128 v[108:111], v4 offset:41216
 ds_read_b128 v[112:115], v7 offset:0
 ds_read_b128 v[116:119], v7 offset:256
 ds_read_b128 v[120:123], v7 offset:40960
 ds_read_b128 v[124:127], v7 offset:41216
 s_waitcnt lgkmcnt(4)
 v_pk_add_f32 v[96:97], v[96:97], v[104:105]
 v_pk_add_f32 v[98:99], v[98:99], v[106:107]
 v_pk_add_f32 v[100:101], v[100:101], v[108:109]
 v_pk_add_f32 v[102:103], v[102:103], v[110:111]
 s_waitcnt lgkmcnt(2)
 v_pk_add_f32 v[96:97], v[96:97], v[112:113]
 v_pk_add_f32 v[98:99], v[98:99], v[114:115]
 v_pk_add_f32 v[100:101], v[100:101], v[116:117]
 v_pk_add_f32 v[102:103], v[102:103], v[118:119]
 s_waitcnt lgkmcnt(0)
 v_pk_add_f32 v[96:97], v[96:97], v[120:121]
 v_pk_add_f32 v[98:99], v[98:99], v[122:123]
 v_pk_add_f32 v[100:101], v[100:101], v[124:125]
 v_pk_add_f32 v[102:103], v[102:103], v[126:127]
 v_cvt_pk_bf16_f32 v8, v96, v97
 v_cvt_pk_bf16_f32 v9, v98, v99
 v_cvt_pk_bf16_f32 v10, v100, v101
 v_cvt_pk_bf16_f32 v11, v102, v103
 buffer_store_dwordx4 v[8:11], v6, s[24:27], s54 offen
 s_cbranch_scc1 Los0_50
 s_branch Lfin
Lchain:
 s_load_dwordx2 s[8:9], s[0:1], 64
 s_mov_b32 s10, 0x480000
 s_mov_b32 s11, 0x20000
 s_load_dwordx2 s[12:13], s[0:1], 72
 s_mov_b32 s14, 0x480000
 s_mov_b32 s15, 0x20000
 s_load_dwordx2 s[16:17], s[0:1], 80
 s_mov_b32 s18, 0x480000
 s_mov_b32 s19, 0x20000
 s_load_dwordx2 s[24:25], s[0:1], 88
 s_mov_b32 s26, 0x480000
 s_mov_b32 s27, 0x20000
 s_load_dwordx2 s[28:29], s[0:1], 112
 s_mov_b32 s30, 0x100
 s_mov_b32 s31, 0x20000
 s_load_dwordx2 s[32:33], s[0:1], 56
 s_mov_b32 s34, 0x2400
 s_mov_b32 s35, 0x20000
 v_and_b32 v30, 63, v0
 v_bfe_u32 v31, v30, 1, 2
 v_lshrrev_b32 v32, 5, v30
 v_xor_b32 v31, v31, v32
 v_lshlrev_b32 v31, 5, v31
 v_and_b32 v32, 1, v30
 v_lshl_add_u32 v31, v32, 4, v31
 v_xor_b32 v33, 64, v31
 v_lshrrev_b32 v32, 3, v30
 s_lshl_b32 s47, s4, 4
 v_and_b32 v34, 3, v32
 v_lshrrev_b32 v35, 2, v32
 v_lshl_add_u32 v34, v34, 1, v35
 v_add_u32 v34, s47, v34
 v_lshl_add_u32 v12, v34, 13, v31
 v_add_u32 v34, 8, v34
 v_lshl_add_u32 v13, v34, 13, v33
 v_and_b32 v34, 1, v32
 v_lshlrev_b32 v34, 6, v34
 v_and_b32 v35, 6, v32
 s_lshl_b32 s47, s4, 3
 v_add3_u32 v34, v34, v35, s47
 v_lshl_add_u32 v56, v34, 13, v31
 v_mul_u32_u24 v35, 1152, v34
 v_add_u32 v14, v35, v31
 v_add_u32 v34, 1, v34
 v_lshl_add_u32 v57, v34, 13, v33
 v_mul_u32_u24 v35, 1152, v34
 v_add_u32 v15, v35, v33
 v_bfe_u32 v31, v30, 4, 1
 v_bfe_u32 v32, v30, 3, 1
 v_lshl_add_u32 v33, v32, 1, v31
 v_xor_b32 v33, s4, v33
 v_lshlrev_b32 v33, 5, v33
 v_lshl_add_u32 v33, v31, 9, v33
 v_lshl_add_u32 v33, v32, 10, v33
 v_bfe_u32 v31, v30, 2, 1
 v_lshl_add_u32 v33, v31, 7, v33
 v_lshrrev_b32 v31, 5, v30
 v_lshl_add_u32 v33, v31, 11, v33
 v_and_b32 v31, 3, v30
 v_lshl_add_u32 v16, v31, 3, v33
 v_add_u32 v17, 0x10000, v16
 v_add_u32 v18, 0x20000, v16
 v_lshlrev_b32 v60, 4, v0
 v_add_u32 v61, 0x10000, v60
 v_add_u32 v62, 0x20000, v60
 s_lshl_b32 s70, s6, 8
 s_mul_i32 s71, s6, 147456
 s_lshl_b32 s72, s4, 11
 s_lshl_b32 s47, s4, 4
 v_add_u32 v31, s47, v30
 s_lshr_b32 s47, s4, 1
 s_lshl_b32 s47, s47, 5
 v_add_u32 v32, s47, v31
 v_lshrrev_b32 v33, 4, v30
 v_lshlrev_b32 v33, 28, v33
 v_lshl_or_b32 v58, v31, 13, v33
 v_lshl_or_b32 v19, v32, 13, v33
 v_mul_u32_u24 v32, 1152, v32
 v_or_b32 v59, v32, v33
 s_waitcnt lgkmcnt(0)
 s_add_u32 m0, s72, 24576
 s_add_u32 s47, s70, 0
 buffer_load_dwordx4 v56, s[8:11], s47 offen  lds
 s_add_u32 m0, s72, 25600
 s_nop 0
 buffer_load_dwordx4 v57, s[8:11], s47 offen  lds
 s_add_u32 m0, s72, 32768
 s_add_u32 s47, s70, 128
 buffer_load_dwordx4 v56, s[8:11], s47 offen  lds
 s_add_u32 m0, s72, 33792
 s_nop 0
 buffer_load_dwordx4 v57, s[8:11], s47 offen  lds
 s_add_u32 m0, s72, 40960
 s_add_u32 s47, s70, 0
 buffer_load_dwordx4 v56, s[12:15], s47 offen  lds
 s_add_u32 m0, s72, 41984
 s_nop 0
 buffer_load_dwordx4 v57, s[12:15], s47 offen  lds
 s_add_u32 m0, s72, 49152
 s_add_u32 s47, s70, 0
 buffer_load_dwordx4 v56, s[16:19], s47 offen  lds
 s_add_u32 m0, s72, 50176
 s_nop 0
 buffer_load_dwordx4 v57, s[16:19], s47 offen  lds
 s_add_u32 m0, s72, 57344
 s_add_u32 s47, s70, 128
 buffer_load_dwordx4 v56, s[16:19], s47 offen  lds
 s_add_u32 m0, s72, 58368
 s_nop 0
 buffer_load_dwordx4 v57, s[16:19], s47 offen  lds
 v_and_b32 v20, 63, v0
 v_lshlrev_b32 v3, 4, v20
 v_mov_b32 v7, 0
 s_mov_b32 s48, 0xcccccccc
 s_mov_b32 s49, 0xcccccccc
 v_mov_b32 v21, 0x44444444
 v_mov_b32 v22, 0xeeeeeeee
 v_cndmask_b32 v5, v21, v22, s[48:49]
 s_lshl_b32 s47, s4, 10
 s_add_u32 s47, s47, 19456
 v_and_b32 v21, 48, v20
 v_lshl_add_u32 v21, v21, 3, s47
 v_and_b32 v22, 8, v20
 v_lshl_add_u32 v21, v22, 2, v21
 v_and_b32 v22, 1, v20
 v_lshl_add_u32 v21, v22, 4, v21
 v_and_b32 v22, 6, v20
 v_lshl_add_u32 v8, v22, 1, v21
 v_and_b32 v21, 32, v20
 v_lshlrev_b32 v21, 5, v21
 v_and_b32 v22, 12, v20
 v_lshl_add_u32 v21, v22, 5, v21
 v_and_b32 v22, 1, v20
 v_lshl_add_u32 v21, v22, 6, v21
 v_and_b32 v22, 16, v20
 v_lshl_add_u32 v21, v22, 1, v21
 v_and_b32 v22, 2, v20
 v_lshl_add_u32 v9, v22, 3, v21
 v_lshrrev_b32 v21, 4, v0
 v_lshlrev_b32 v21, 7, v21
 v_and_b32 v22, 15, v20
 v_lshl_add_u32 v21, v22, 2, v21
 v_add_u32 v10, 17408, v21
 v_and_b32 v22, 1, v20
 v_and_b32 v21, 12, v20
 v_lshlrev_b32 v21, 5, v21
 v_lshl_add_u32 v21, v22, 6, v21
 v_and_b32 v22, 48, v20
 v_add_u32 v11, v21, v22
 s_mov_b32 s55, 0x3e0293ee
 s_mov_b32 s54, 0x40000
 s_lshl_b32 s47, s6, 6
 s_add_u32 s60, s47, 0x100000
 s_add_u32 s61, s47, 0x101000
 s_add_u32 s62, s47, 0x102000
 s_lshl_b32 s47, s6, 7
 s_add_u32 s56, s47, 0x0
 s_add_u32 s57, s47, 0x1000
 s_mul_i32 s47, s6, 10496
 s_add_u32 s40, s47, 0x102000
 s_lshl_b32 s58, s4, 11
 s_add_u32 s47, s47, s58
 s_add_u32 s39, s47, 0x100000
 s_lshl_b32 s42, s4, 11
 s_add_u32 s41, s42, 0x1e0000
 s_mov_b32 s43, 0x1e2000
 s_lshr_b32 s69, s4, 1
 s_lshl_b32 s69, s69, 11
 s_and_b32 s47, s4, 1
 s_lshl_b32 s47, s47, 3
 s_add_u32 s69, s69, s47
 s_lshl_b32 s47, s6, 5
 s_add_u32 s65, s47, 0x1e2000
 s_add_u32 s66, s47, 0x162000
 s_lshr_b32 s47, s6, 3
 s_lshl_b32 s47, s47, 9
 s_and_b32 s58, s6, 1
 s_lshl_b32 s58, s58, 8
 s_add_u32 s47, s47, s58
 s_and_b32 s58, s6, 6
 s_lshl_b32 s58, s58, 5
 s_add_u32 s47, s47, s58
 s_lshl_b32 s58, s4, 11
 s_add_u32 s47, s47, s58
 s_add_u32 s44, s47, 0x1e0000
 s_add_u32 s45, s47, 0x160000
 s_lshl_b32 s47, s6, 14
 s_add_u32 s37, s47, 0x3000000
 s_add_u32 s67, s37, s58
 s_add_u32 s59, s67, 8192
 s_lshl_b32 s47, s6, 12
 s_add_u32 s38, s47, 0x3e0000
 s_mov_b32 s36, 0
 s_mov_b32 s46, 0
 s_mov_b32 s50, 0
 s_waitcnt vmcnt(8)
 s_waitcnt lgkmcnt(0)
 s_barrier
 s_add_u32 m0, s72, 65536
 s_add_u32 s47, s70, 262144
 buffer_load_dwordx4 v56, s[8:11], s47 offen  lds
 s_add_u32 m0, s72, 66560
 s_nop 0
 buffer_load_dwordx4 v57, s[8:11], s47 offen  lds
 v_mbcnt_lo_u32_b32 v69, -1, 0
 v_min_u32 v69, 1, v69
 v_lshlrev_b32 v69, 28, v69
 buffer_load_dword v68, v69, s[28:31], 0 offen offset:4 sc1
 ds_read_b64_tr_b16 v[72:73], v16 offset:24576
 ds_read_b64_tr_b16 v[74:75], v16 offset:24832
 ds_read_b64_tr_b16 v[76:77], v16 offset:28672
 ds_read_b64_tr_b16 v[78:79], v16 offset:28928
 s_waitcnt vmcnt(9)
 s_waitcnt lgkmcnt(0)
 s_barrier
 s_add_u32 m0, s72, 73728
 s_add_u32 s47, s70, 262272
 buffer_load_dwordx4 v56, s[8:11], s47 offen  lds
 s_add_u32 m0, s72, 74752
 s_nop 0
 buffer_load_dwordx4 v57, s[8:11], s47 offen  lds
 ds_read_b64_tr_b16 v[80:81], v16 offset:32768
 ds_read_b64_tr_b16 v[82:83], v16 offset:33024
 ds_read_b64_tr_b16 v[84:85], v16 offset:36864
 ds_read_b64_tr_b16 v[86:87], v16 offset:37120
 s_waitcnt vmcnt(9)
 s_waitcnt lgkmcnt(0)
 s_barrier
 s_add_u32 m0, s72, 81920
 s_add_u32 s47, s70, 262144
 buffer_load_dwordx4 v56, s[12:15], s47 offen  lds
 s_add_u32 m0, s72, 82944
 s_nop 0
 buffer_load_dwordx4 v57, s[12:15], s47 offen  lds
 ds_read_b64_tr_b16 v[88:89], v16 offset:40960
 ds_read_b64_tr_b16 v[90:91], v16 offset:41216
 ds_read_b64_tr_b16 v[92:93], v16 offset:45056
 ds_read_b64_tr_b16 v[94:95], v16 offset:45312
 s_waitcnt vmcnt(9)
 s_waitcnt lgkmcnt(0)
 s_barrier
 s_add_u32 m0, s72, 90112
 s_add_u32 s47, s70, 262144
 buffer_load_dwordx4 v56, s[16:19], s47 offen  lds
 s_add_u32 m0, s72, 91136
 s_nop 0
 buffer_load_dwordx4 v57, s[16:19], s47 offen  lds
 ds_read_b64_tr_b16 v[96:97], v16 offset:49152
 ds_read_b64_tr_b16 v[98:99], v16 offset:49408
 ds_read_b64_tr_b16 v[100:101], v16 offset:53248
 ds_read_b64_tr_b16 v[102:103], v16 offset:53504
 s_waitcnt vmcnt(9)
 s_waitcnt lgkmcnt(0)
 s_barrier
 s_add_u32 m0, s72, 98304
 s_add_u32 s47, s70, 262272
 buffer_load_dwordx4 v56, s[16:19], s47 offen  lds
 s_add_u32 m0, s72, 99328
 s_nop 0
 buffer_load_dwordx4 v57, s[16:19], s47 offen  lds
 ds_read_b64_tr_b16 v[104:105], v16 offset:57344
 ds_read_b64_tr_b16 v[106:107], v16 offset:57600
 ds_read_b64_tr_b16 v[108:109], v16 offset:61440
 ds_read_b64_tr_b16 v[110:111], v16 offset:61696
 s_waitcnt vmcnt(9)
 s_waitcnt lgkmcnt(0)
 s_barrier
 s_add_u32 m0, s72, 106496
 s_add_u32 s47, s70, 1048576
 buffer_load_dwordx4 v56, s[8:11], s47 offen  lds
 s_add_u32 m0, s72, 107520
 s_nop 0
 buffer_load_dwordx4 v57, s[8:11], s47 offen  lds
 ds_read_b64_tr_b16 v[112:113], v17 offset:0
 ds_read_b64_tr_b16 v[114:115], v17 offset:256
 ds_read_b64_tr_b16 v[116:117], v17 offset:4096
 ds_read_b64_tr_b16 v[118:119], v17 offset:4352
 s_waitcnt vmcnt(8)
 s_waitcnt lgkmcnt(0)
 s_barrier
 s_add_u32 m0, s72, 114688
 s_add_u32 s47, s70, 1048704
 buffer_load_dwordx4 v56, s[8:11], s47 offen  lds
 s_add_u32 m0, s72, 115712
 s_nop 0
 buffer_load_dwordx4 v57, s[8:11], s47 offen  lds
 ds_read_b64_tr_b16 v[120:121], v17 offset:8192
 ds_read_b64_tr_b16 v[122:123], v17 offset:8448
 ds_read_b64_tr_b16 v[124:125], v17 offset:12288
 ds_read_b64_tr_b16 v[126:127], v17 offset:12544
 s_waitcnt vmcnt(8)
 s_waitcnt lgkmcnt(0)
 s_barrier
 s_add_u32 m0, s72, 122880
 s_add_u32 s47, s70, 1048576
 buffer_load_dwordx4 v56, s[12:15], s47 offen  lds
 s_add_u32 m0, s72, 123904
 s_nop 0
 buffer_load_dwordx4 v57, s[12:15], s47 offen  lds
 ds_read_b64_tr_b16 v[128:129], v17 offset:16384
 ds_read_b64_tr_b16 v[130:131], v17 offset:16640
 ds_read_b64_tr_b16 v[132:133], v17 offset:20480
 ds_read_b64_tr_b16 v[134:135], v17 offset:20736
 s_waitcnt vmcnt(8)
 s_waitcnt lgkmcnt(0)
 s_barrier
 s_add_u32 m0, s72, 131072
 s_add_u32 s47, s70, 1048576
 buffer_load_dwordx4 v56, s[16:19], s47 offen  lds
 s_add_u32 m0, s72, 132096
 s_nop 0
 buffer_load_dwordx4 v57, s[16:19], s47 offen  lds
 ds_read_b64_tr_b16 v[136:137], v17 offset:24576
 ds_read_b64_tr_b16 v[138:139], v17 offset:24832
 ds_read_b64_tr_b16 v[140:141], v17 offset:28672
 ds_read_b64_tr_b16 v[142:143], v17 offset:28928
 s_waitcnt vmcnt(8)
 s_waitcnt lgkmcnt(0)
 s_barrier
 s_add_u32 m0, s72, 139264
 s_add_u32 s47, s70, 1048704
 buffer_load_dwordx4 v56, s[16:19], s47 offen  lds
 s_add_u32 m0, s72, 140288
 s_nop 0
 buffer_load_dwordx4 v57, s[16:19], s47 offen  lds
 s_branch Lrhc_56
Lrh_55:
 v_mbcnt_lo_u32_b32 v69, -1, 0
 v_min_u32 v69, 1, v69
 v_lshlrev_b32 v69, 28, v69
 buffer_load_dword v68, v69, s[28:31], 0 offen offset:4 sc1
 s_waitcnt vmcnt(0)
Lrhc_56:
 v_readfirstlane_b32 s89, v68
 s_cmp_eq_u32 s89, s88
 s_cbranch_scc1 Lrhk_57
 s_cmp_lg_u32 s89, 0
 s_cbranch_scc1 Lredo
 s_sub_u32 s95, s95, 1
 s_cbranch_scc0 Lrh_55
 s_endpgm
Lrhk_57:
 v_mov_b32 v20, 0
 v_mov_b32 v21, 0
 v_mov_b32 v22, 0
 v_mov_b32 v23, 0
 v_mov_b32 v27, -1
 v_bfe_u32 v24, v3, 8, 1
 v_bfe_u32 v25, v3, 9, 1
 v_lshl_or_b32 v24, v24, 1, v25
 v_bfe_u32 v25, v3, 5, 1
 v_lshl_or_b32 v24, v24, 1, v25
 v_and_b32 v25, 0xd0, v3
 v_lshlrev_b32 v25, 24, v25
 v_lshl_or_b32 v24, v24, 2, v25
 v_bfe_u32 v26, v3, 8, 2
 v_bfe_u32 v25, v3, 2, 4
 v_lshl_or_b32 v26, v26, 4, v25
 v_and_b32 v25, 0xc0, v3
 v_lshl_or_b32 v26, v25, 24, v26
 buffer_store_dwordx4 v[20:23], v3, s[20:23], s39 offen offset:0 sc1
 buffer_store_dwordx4 v[20:23], v3, s[20:23], s39 offen offset:1024 sc1
 buffer_store_dwordx4 v[20:23], v3, s[20:23], s40 offen offset:0 sc1
 buffer_store_dwordx4 v[20:23], v3, s[20:23], s40 offen offset:1024 sc1
 buffer_store_dword v27, v26, s[20:23], s44 offen sc1
 buffer_store_dword v27, v26, s[20:23], s45 offen sc1
 buffer_store_dword v27, v24, s[20:23], s65 offen sc1
 buffer_store_dword v27, v24, s[20:23], s66 offen sc1
 ds_read_b64_tr_b16 v[144:145], v17 offset:32768
 ds_read_b64_tr_b16 v[146:147], v17 offset:33024
 ds_read_b64_tr_b16 v[148:149], v17 offset:36864
 ds_read_b64_tr_b16 v[150:151], v17 offset:37120
 s_waitcnt vmcnt(16)
 s_waitcnt lgkmcnt(0)
 s_barrier
 s_add_u32 m0, s72, 147456
 s_add_u32 s47, s70, 1310720
 buffer_load_dwordx4 v56, s[8:11], s47 offen  lds
 s_add_u32 m0, s72, 148480
 s_nop 0
 buffer_load_dwordx4 v57, s[8:11], s47 offen  lds
 ds_read_b64_tr_b16 v[152:153], v17 offset:40960
 ds_read_b64_tr_b16 v[154:155], v17 offset:41216
 ds_read_b64_tr_b16 v[156:157], v17 offset:45056
 ds_read_b64_tr_b16 v[158:159], v17 offset:45312
 s_waitcnt vmcnt(16)
 s_waitcnt lgkmcnt(0)
 s_barrier
 s_add_u32 m0, s72, 155648
 s_add_u32 s47, s70, 1310848
 buffer_load_dwordx4 v56, s[8:11], s47 offen  lds
 s_add_u32 m0, s72, 156672
 s_nop 0
 buffer_load_dwordx4 v57, s[8:11], s47 offen  lds
 v_lshrrev_b32 v68, 4, v3
 v_bfe_u32 v69, v68, 2, 2
 v_and_b32 v70, 1, v68
 v_lshl_add_u32 v69, v69, 1, v70
 v_mul_u32_u24 v69, 1152, v69
 v_and_b32 v70, 48, v68
 v_and_b32 v71, 2, v68
 v_lshl_add_u32 v71, v71, 2, v70
 v_lshl_add_u32 v71, v71, 1, v69
 v_add_u32 v69, v70, v69
 s_lshr_b32 s47, s4, 1
 s_lshl_b32 s47, s47, 8
 s_and_b32 s58, s4, 1
 s_lshl_b32 s58, s58, 6
 s_add_u32 s47, s47, s58
 buffer_load_dwordx4 v[20:23], v69, s[32:35], s47 offen offset:0
 buffer_load_dwordx4 v[24:27], v69, s[32:35], s47 offen offset:128
 buffer_load_dwordx4 v[28:31], v69, s[32:35], s47 offen offset:512
 buffer_load_dwordx4 v[32:35], v69, s[32:35], s47 offen offset:640
 buffer_load_dwordx4 v[36:39], v71, s[32:35], 0 offen offset:1024
 ds_read_b64_tr_b16 v[160:161], v17 offset:49152
 ds_read_b64_tr_b16 v[162:163], v17 offset:49408
 ds_read_b64_tr_b16 v[164:165], v17 offset:53248
 ds_read_b64_tr_b16 v[166:167], v17 offset:53504
 s_waitcnt vmcnt(21)
 s_waitcnt lgkmcnt(0)
 s_barrier
 s_add_u32 m0, s72, 24576
 s_add_u32 s47, s70, 1310720
 buffer_load_dwordx4 v56, s[12:15], s47 offen  lds
 s_add_u32 m0, s72, 25600
 s_nop 0
 buffer_load_dwordx4 v57, s[12:15], s47 offen  lds
 ds_read_b64_tr_b16 v[168:169], v17 offset:57344
 ds_read_b64_tr_b16 v[170:171], v17 offset:57600
 ds_read_b64_tr_b16 v[172:173], v17 offset:61440
 ds_read_b64_tr_b16 v[174:175], v17 offset:61696
 s_waitcnt vmcnt(21)
 s_waitcnt lgkmcnt(0)
 s_barrier
 s_add_u32 m0, s72, 32768
 s_add_u32 s47, s70, 1310720
 buffer_load_dwordx4 v56, s[16:19], s47 offen  lds
 s_add_u32 m0, s72, 33792
 s_nop 0
 buffer_load_dwordx4 v57, s[16:19], s47 offen  lds
 ds_read_b64_tr_b16 v[176:177], v18 offset:0
 ds_read_b64_tr_b16 v[178:179], v18 offset:256
 ds_read_b64_tr_b16 v[180:181], v18 offset:4096
 ds_read_b64_tr_b16 v[182:183], v18 offset:4352
 s_waitcnt vmcnt(21)
 s_waitcnt lgkmcnt(0)
 s_barrier
 s_add_u32 m0, s72, 40960
 s_add_u32 s47, s70, 1310848
 buffer_load_dwordx4 v56, s[16:19], s47 offen  lds
 s_add_u32 m0, s72, 41984
 s_nop 0
 buffer_load_dwordx4 v57, s[16:19], s47 offen  lds
 ds_read_b64_tr_b16 v[184:185], v18 offset:8192
 ds_read_b64_tr_b16 v[186:187], v18 offset:8448
 ds_read_b64_tr_b16 v[188:189], v18 offset:12288
 ds_read_b64_tr_b16 v[190:191], v18 offset:12544
 s_waitcnt vmcnt(13)
 s_waitcnt lgkmcnt(0)
 s_barrier
 s_add_u32 m0, s72, 49152
 s_add_u32 s47, s70, 2097152
 buffer_load_dwordx4 v56, s[8:11], s47 offen  lds
 s_add_u32 m0, s72, 50176
 s_nop 0
 buffer_load_dwordx4 v57, s[8:11], s47 offen  lds
 ds_read_b64_tr_b16 v[192:193], v18 offset:16384
 ds_read_b64_tr_b16 v[194:195], v18 offset:16640
 ds_read_b64_tr_b16 v[196:197], v18 offset:20480
 ds_read_b64_tr_b16 v[198:199], v18 offset:20736
 s_waitcnt vmcnt(13)
 s_waitcnt lgkmcnt(0)
 s_barrier
 s_add_u32 m0, s72, 57344
 s_add_u32 s47, s70, 2097280
 buffer_load_dwordx4 v56, s[8:11], s47 offen  lds
 s_add_u32 m0, s72, 58368
 s_nop 0
 buffer_load_dwordx4 v57, s[8:11], s47 offen  lds
 ds_read_b64_tr_b16 v[200:201], v18 offset:24576
 ds_read_b64_tr_b16 v[202:203], v18 offset:24832
 ds_read_b64_tr_b16 v[204:205], v18 offset:28672
 ds_read_b64_tr_b16 v[206:207], v18 offset:28928
 s_waitcnt vmcnt(8)
 s_waitcnt lgkmcnt(0)
 s_barrier
 s_add_u32 m0, s72, 65536
 s_add_u32 s47, s70, 2097152
 buffer_load_dwordx4 v56, s[12:15], s47 offen  lds
 s_add_u32 m0, s72, 66560
 s_nop 0
 buffer_load_dwordx4 v57, s[12:15], s47 offen  lds
 ds_read_b64_tr_b16 v[208:209], v16 offset:24576
 ds_read_b64_tr_b16 v[210:211], v16 offset:24832
 ds_read_b64_tr_b16 v[212:213], v16 offset:28672
 ds_read_b64_tr_b16 v[214:215], v16 offset:28928
 s_waitcnt vmcnt(8)
 s_waitcnt lgkmcnt(0)
 s_barrier
 s_add_u32 m0, s72, 73728
 s_add_u32 s47, s70, 2097152
 buffer_load_dwordx4 v56, s[16:19], s47 offen  lds
 s_add_u32 m0, s72, 74752
 s_nop 0
 buffer_load_dwordx4 v57, s[16:19], s47 offen  lds
 ds_read_b64_tr_b16 v[216:217], v16 offset:32768
 ds_read_b64_tr_b16 v[218:219], v16 offset:33024
 ds_read_b64_tr_b16 v[220:221], v16 offset:36864
 ds_read_b64_tr_b16 v[222:223], v16 offset:37120
 s_waitcnt vmcnt(8)
 s_waitcnt lgkmcnt(0)
 s_barrier
 s_add_u32 m0, s72, 81920
 s_add_u32 s47, s70, 2097280
 buffer_load_dwordx4 v56, s[16:19], s47 offen  lds
 s_add_u32 m0, s72, 82944
 s_nop 0
 buffer_load_dwordx4 v57, s[16:19], s47 offen  lds
 ds_read_b64_tr_b16 v[224:225], v16 offset:40960
 ds_read_b64_tr_b16 v[226:227], v16 offset:41216
 ds_read_b64_tr_b16 v[228:229], v16 offset:45056
 ds_read_b64_tr_b16 v[230:231], v16 offset:45312
 s_waitcnt vmcnt(8)
 s_waitcnt lgkmcnt(0)
 s_barrier
 s_add_u32 m0, s72, 90112
 s_add_u32 s47, s70, 2359296
 buffer_load_dwordx4 v56, s[8:11], s47 offen  lds
 s_add_u32 m0, s72, 91136
 s_nop 0
 buffer_load_dwordx4 v57, s[8:11], s47 offen  lds
 s_getreg_b32 s73, hwreg(HW_REG_XCC_ID, 0, 3)
 s_lshl_b32 s73, s73, 3
 s_lshl_b64 s[74:75], 1, s73
 v_mov_b32 v64, s74
 v_mov_b32 v65, s75
 v_mov_b32 v66, 0x7ff00000
 v_cmp_eq_u32 vcc, 0, v0
 s_nop 1
 v_cndmask_b32 v66, v66, v7, vcc
 buffer_atomic_add_x2 v[64:65], v66, s[28:31], 0 offen offset:8
 ds_read_b64_tr_b16 v[232:233], v16 offset:49152
 ds_read_b64_tr_b16 v[234:235], v16 offset:49408
 ds_read_b64_tr_b16 v[236:237], v16 offset:53248
 ds_read_b64_tr_b16 v[238:239], v16 offset:53504
 s_waitcnt vmcnt(9)
 s_waitcnt lgkmcnt(0)
 s_barrier
 s_add_u32 m0, s72, 98304
 s_add_u32 s47, s70, 2359424
 buffer_load_dwordx4 v56, s[8:11], s47 offen  lds
 s_add_u32 m0, s72, 99328
 s_nop 0
 buffer_load_dwordx4 v57, s[8:11], s47 offen  lds
 v_mov_b32 v68, 0x05040100
 v_mov_b32 v69, 0x07060302
 v_cndmask_b32 v70, v68, v69, s[48:49]
 v_perm_b32 v20, v24, v20, v70
 v_perm_b32 v21, v25, v21, v70
 v_perm_b32 v22, v26, v22, v70
 v_perm_b32 v23, v27, v23, v70
 v_perm_b32 v28, v32, v28, v70
 v_perm_b32 v29, v33, v29, v70
 v_perm_b32 v30, v34, v30, v70
 v_perm_b32 v31, v35, v31, v70
 v_perm_b32 v24, v37, v36, v68
 v_perm_b32 v25, v39, v38, v68
 v_perm_b32 v26, v37, v36, v69
 v_perm_b32 v27, v39, v38, v69
 v_min_u32 v20, -2, v20
 v_min_u32 v21, -2, v21
 v_min_u32 v22, -2, v22
 v_min_u32 v23, -2, v23
 v_min_u32 v24, -2, v24
 v_min_u32 v25, -2, v25
 v_min_u32 v26, -2, v26
 v_min_u32 v27, -2, v27
 v_min_u32 v28, -2, v28
 v_min_u32 v29, -2, v29
 v_min_u32 v30, -2, v30
 v_min_u32 v31, -2, v31
 ds_write_b128 v60, v[20:23]
 ds_write_b128 v60, v[28:31] offset:4096
 ds_write_b128 v3, v[24:27] offset:8192
 ds_read_b64_tr_b16 v[240:241], v16 offset:57344
 ds_read_b64_tr_b16 v[242:243], v16 offset:57600
 ds_read_b64_tr_b16 v[244:245], v16 offset:61440
 ds_read_b64_tr_b16 v[246:247], v16 offset:61696
 s_waitcnt vmcnt(9)
 s_waitcnt lgkmcnt(0)
 s_barrier
 s_add_u32 m0, s72, 106496
 s_add_u32 s47, s70, 2359296
 buffer_load_dwordx4 v56, s[12:15], s47 offen  lds
 s_add_u32 m0, s72, 107520
 s_nop 0
 buffer_load_dwordx4 v57, s[12:15], s47 offen  lds
 ds_read_b64_tr_b16 v[248:249], v17 offset:0
 ds_read_b64_tr_b16 v[250:251], v17 offset:256
 ds_read_b64_tr_b16 v[252:253], v17 offset:4096
 ds_read_b64_tr_b16 v[254:255], v17 offset:4352
 s_waitcnt vmcnt(9)
 s_waitcnt lgkmcnt(0)
 s_barrier
 s_add_u32 m0, s72, 114688
 s_add_u32 s47, s70, 2359296
 buffer_load_dwordx4 v56, s[16:19], s47 offen  lds
 s_add_u32 m0, s72, 115712
 s_nop 0
 buffer_load_dwordx4 v57, s[16:19], s47 offen  lds
 ds_read_b64_tr_b16 a[0:1], v17 offset:8192
 ds_read_b64_tr_b16 a[2:3], v17 offset:8448
 ds_read_b64_tr_b16 a[4:5], v17 offset:12288
 ds_read_b64_tr_b16 a[6:7], v17 offset:12544
 s_waitcnt vmcnt(9)
 s_waitcnt lgkmcnt(0)
 s_barrier
 s_add_u32 m0, s72, 122880
 s_add_u32 s47, s70, 2359424
 buffer_load_dwordx4 v56, s[16:19], s47 offen  lds
 s_add_u32 m0, s72, 123904
 s_nop 0
 buffer_load_dwordx4 v57, s[16:19], s47 offen  lds
 ds_read_b64_tr_b16 a[8:9], v17 offset:16384
 ds_read_b64_tr_b16 a[10:11], v17 offset:16640
 ds_read_b64_tr_b16 a[12:13], v17 offset:20480
 ds_read_b64_tr_b16 a[14:15], v17 offset:20736
 s_waitcnt vmcnt(9)
 s_waitcnt lgkmcnt(0)
 s_barrier
 s_add_u32 m0, s72, 131072
 s_add_u32 s47, s70, 3145728
 buffer_load_dwordx4 v56, s[8:11], s47 offen  lds
 s_add_u32 m0, s72, 132096
 s_nop 0
 buffer_load_dwordx4 v57, s[8:11], s47 offen  lds
 ds_read_b64_tr_b16 a[16:17], v17 offset:24576
 ds_read_b64_tr_b16 a[18:19], v17 offset:24832
 ds_read_b64_tr_b16 a[20:21], v17 offset:28672
 ds_read_b64_tr_b16 a[22:23], v17 offset:28928
 s_waitcnt vmcnt(8)
 s_waitcnt lgkmcnt(0)
 s_barrier
 s_add_u32 m0, s72, 139264
 s_add_u32 s47, s70, 3145856
 buffer_load_dwordx4 v56, s[8:11], s47 offen  lds
 s_add_u32 m0, s72, 140288
 s_nop 0
 buffer_load_dwordx4 v57, s[8:11], s47 offen  lds
 ds_read_b64_tr_b16 a[24:25], v17 offset:32768
 ds_read_b64_tr_b16 a[26:27], v17 offset:33024
 ds_read_b64_tr_b16 a[28:29], v17 offset:36864
 ds_read_b64_tr_b16 a[30:31], v17 offset:37120
 s_waitcnt vmcnt(8)
 s_waitcnt lgkmcnt(0)
 s_barrier
 s_add_u32 m0, s72, 147456
 s_add_u32 s47, s70, 3145728
 buffer_load_dwordx4 v56, s[12:15], s47 offen  lds
 s_add_u32 m0, s72, 148480
 s_nop 0
 buffer_load_dwordx4 v57, s[12:15], s47 offen  lds
 ds_read_b64_tr_b16 a[32:33], v17 offset:40960
 ds_read_b64_tr_b16 a[34:35], v17 offset:41216
 ds_read_b64_tr_b16 a[36:37], v17 offset:45056
 ds_read_b64_tr_b16 a[38:39], v17 offset:45312
 s_waitcnt vmcnt(8)
 s_waitcnt lgkmcnt(0)
 s_barrier
 s_add_u32 m0, s72, 155648
 s_add_u32 s47, s70, 3145728
 buffer_load_dwordx4 v56, s[16:19], s47 offen  lds
 s_add_u32 m0, s72, 156672
 s_nop 0
 buffer_load_dwordx4 v57, s[16:19], s47 offen  lds
 ds_read_b64_tr_b16 a[40:41], v17 offset:49152
 ds_read_b64_tr_b16 a[42:43], v17 offset:49408
 ds_read_b64_tr_b16 a[44:45], v17 offset:53248
 ds_read_b64_tr_b16 a[46:47], v17 offset:53504
 s_waitcnt vmcnt(8)
 s_waitcnt lgkmcnt(0)
 s_barrier
 s_add_u32 m0, s72, 24576
 s_add_u32 s47, s70, 3145856
 buffer_load_dwordx4 v56, s[16:19], s47 offen  lds
 s_add_u32 m0, s72, 25600
 s_nop 0
 buffer_load_dwordx4 v57, s[16:19], s47 offen  lds
 ds_read_b64_tr_b16 a[48:49], v17 offset:57344
 ds_read_b64_tr_b16 a[50:51], v17 offset:57600
 ds_read_b64_tr_b16 a[52:53], v17 offset:61440
 ds_read_b64_tr_b16 a[54:55], v17 offset:61696
 s_waitcnt vmcnt(8)
 s_waitcnt lgkmcnt(0)
 s_barrier
 s_add_u32 m0, s72, 32768
 s_add_u32 s47, s70, 3407872
 buffer_load_dwordx4 v56, s[8:11], s47 offen  lds
 s_add_u32 m0, s72, 33792
 s_nop 0
 buffer_load_dwordx4 v57, s[8:11], s47 offen  lds
 ds_read_b64_tr_b16 a[56:57], v18 offset:0
 ds_read_b64_tr_b16 a[58:59], v18 offset:256
 ds_read_b64_tr_b16 a[60:61], v18 offset:4096
 ds_read_b64_tr_b16 a[62:63], v18 offset:4352
 s_waitcnt vmcnt(8)
 s_waitcnt lgkmcnt(0)
 s_barrier
 s_add_u32 m0, s72, 40960
 s_add_u32 s47, s70, 3408000
 buffer_load_dwordx4 v56, s[8:11], s47 offen  lds
 s_add_u32 m0, s72, 41984
 s_nop 0
 buffer_load_dwordx4 v57, s[8:11], s47 offen  lds
 ds_read_b64_tr_b16 a[64:65], v18 offset:8192
 ds_read_b64_tr_b16 a[66:67], v18 offset:8448
 ds_read_b64_tr_b16 a[68:69], v18 offset:12288
 ds_read_b64_tr_b16 a[70:71], v18 offset:12544
 s_waitcnt vmcnt(8)
 s_waitcnt lgkmcnt(0)
 s_barrier
 s_add_u32 m0, s72, 49152
 s_add_u32 s47, s70, 3407872
 buffer_load_dwordx4 v56, s[12:15], s47 offen  lds
 s_add_u32 m0, s72, 50176
 s_nop 0
 buffer_load_dwordx4 v57, s[12:15], s47 offen  lds
 ds_read_b64_tr_b16 a[72:73], v18 offset:16384
 ds_read_b64_tr_b16 a[74:75], v18 offset:16640
 ds_read_b64_tr_b16 a[76:77], v18 offset:20480
 ds_read_b64_tr_b16 a[78:79], v18 offset:20736
 s_waitcnt vmcnt(8)
 s_waitcnt lgkmcnt(0)
 s_barrier
 s_add_u32 m0, s72, 57344
 s_add_u32 s47, s70, 3407872
 buffer_load_dwordx4 v56, s[16:19], s47 offen  lds
 s_add_u32 m0, s72, 58368
 s_nop 0
 buffer_load_dwordx4 v57, s[16:19], s47 offen  lds
 ds_read_b64_tr_b16 a[80:81], v18 offset:24576
 ds_read_b64_tr_b16 a[82:83], v18 offset:24832
 ds_read_b64_tr_b16 a[84:85], v18 offset:28672
 ds_read_b64_tr_b16 a[86:87], v18 offset:28928
 s_waitcnt vmcnt(8)
 s_waitcnt lgkmcnt(0)
 s_barrier
 s_add_u32 m0, s72, 65536
 s_add_u32 s47, s70, 3408000
 buffer_load_dwordx4 v56, s[16:19], s47 offen  lds
 s_add_u32 m0, s72, 66560
 s_nop 0
 buffer_load_dwordx4 v57, s[16:19], s47 offen  lds
 v_min_u32 v65, 16, v3
 v_lshlrev_b32 v65, 24, v65
 buffer_load_dwordx4 v[68:71], v65, s[28:31], 0 offen sc1
 ds_read_b64_tr_b16 a[88:89], v16 offset:24576
 ds_read_b64_tr_b16 a[90:91], v16 offset:24832
 ds_read_b64_tr_b16 a[92:93], v16 offset:28672
 ds_read_b64_tr_b16 a[94:95], v16 offset:28928
 s_waitcnt vmcnt(9)
 s_waitcnt lgkmcnt(0)
 s_barrier
 s_add_u32 m0, s72, 73728
 s_add_u32 s47, s70, 4194304
 buffer_load_dwordx4 v12, s[8:11], s47 offen  lds
 s_add_u32 m0, s72, 74752
 s_nop 0
 buffer_load_dwordx4 v13, s[8:11], s47 offen  lds
 ds_read_b64_tr_b16 a[96:97], v16 offset:32768
 ds_read_b64_tr_b16 a[98:99], v16 offset:33024
 ds_read_b64_tr_b16 a[100:101], v16 offset:36864
 ds_read_b64_tr_b16 a[102:103], v16 offset:37120
 s_waitcnt vmcnt(9)
 s_waitcnt lgkmcnt(0)
 s_barrier
 s_add_u32 m0, s72, 81920
 s_add_u32 s47, s70, 4194432
 buffer_load_dwordx4 v12, s[8:11], s47 offen  lds
 s_add_u32 m0, s72, 82944
 s_nop 0
 buffer_load_dwordx4 v13, s[8:11], s47 offen  lds
 ds_read_b64_tr_b16 a[104:105], v16 offset:40960
 ds_read_b64_tr_b16 a[106:107], v16 offset:41216
 ds_read_b64_tr_b16 a[108:109], v16 offset:45056
 ds_read_b64_tr_b16 a[110:111], v16 offset:45312
 s_waitcnt vmcnt(9)
 s_waitcnt lgkmcnt(0)
 s_barrier
 s_add_u32 m0, s72, 90112
 s_add_u32 s47, s70, 4194304
 buffer_load_dwordx4 v12, s[12:15], s47 offen  lds
 s_add_u32 m0, s72, 91136
 s_nop 0
 buffer_load_dwordx4 v13, s[12:15], s47 offen  lds
 ds_read_b64_tr_b16 a[112:113], v16 offset:49152
 ds_read_b64_tr_b16 a[114:115], v16 offset:49408
 ds_read_b64_tr_b16 a[116:117], v16 offset:53248
 ds_read_b64_tr_b16 a[118:119], v16 offset:53504
 s_waitcnt vmcnt(9)
 s_waitcnt lgkmcnt(0)
 s_barrier
 s_add_u32 m0, s72, 98304
 s_add_u32 s47, s70, 4194304
 buffer_load_dwordx4 v12, s[16:19], s47 offen  lds
 s_add_u32 m0, s72, 99328
 s_nop 0
 buffer_load_dwordx4 v13, s[16:19], s47 offen  lds
 ds_read_b64_tr_b16 a[120:121], v16 offset:57344
 ds_read_b64_tr_b16 a[122:123], v16 offset:57600
 ds_read_b64_tr_b16 a[124:125], v16 offset:61440
 ds_read_b64_tr_b16 a[126:127], v16 offset:61696
 s_waitcnt vmcnt(9)
 s_waitcnt lgkmcnt(0)
 s_barrier
 s_add_u32 m0, s72, 106496
 s_add_u32 s47, s70, 4194432
 buffer_load_dwordx4 v12, s[16:19], s47 offen  lds
 s_add_u32 m0, s72, 107520
 s_nop 0
 buffer_load_dwordx4 v13, s[16:19], s47 offen  lds
 ds_read_b64_tr_b16 a[128:129], v17 offset:0
 ds_read_b64_tr_b16 a[130:131], v17 offset:256
 ds_read_b64_tr_b16 a[132:133], v17 offset:4096
 ds_read_b64_tr_b16 a[134:135], v17 offset:4352
 s_waitcnt vmcnt(8)
 s_waitcnt lgkmcnt(0)
 s_barrier
 s_add_u32 m0, s72, 114688
 s_add_u32 s47, s71, 0
 buffer_load_dwordx4 v14, s[24:27], s47 offen  lds
 s_add_u32 m0, s72, 115712
 s_nop 0
 buffer_load_dwordx4 v15, s[24:27], s47 offen  lds
 ds_read_b64_tr_b16 a[136:137], v17 offset:8192
 ds_read_b64_tr_b16 a[138:139], v17 offset:8448
 ds_read_b64_tr_b16 a[140:141], v17 offset:12288
 ds_read_b64_tr_b16 a[142:143], v17 offset:12544
 s_waitcnt vmcnt(8)
 s_waitcnt lgkmcnt(0)
 s_barrier
 s_add_u32 m0, s72, 122880
 s_add_u32 s47, s71, 128
 buffer_load_dwordx4 v14, s[24:27], s47 offen  lds
 s_add_u32 m0, s72, 123904
 s_nop 0
 buffer_load_dwordx4 v15, s[24:27], s47 offen  lds
 ds_read_b64_tr_b16 a[144:145], v17 offset:16384
 ds_read_b64_tr_b16 a[146:147], v17 offset:16640
 ds_read_b64_tr_b16 a[148:149], v17 offset:20480
 ds_read_b64_tr_b16 a[150:151], v17 offset:20736
 s_waitcnt vmcnt(8)
 s_waitcnt lgkmcnt(0)
 s_barrier
 s_add_u32 m0, s72, 131072
 s_add_u32 s47, s71, 256
 buffer_load_dwordx4 v14, s[24:27], s47 offen  lds
 s_add_u32 m0, s72, 132096
 s_nop 0
 buffer_load_dwordx4 v15, s[24:27], s47 offen  lds
 ds_read_b64_tr_b16 a[152:153], v17 offset:24576
 ds_read_b64_tr_b16 a[154:155], v17 offset:24832
 ds_read_b64_tr_b16 a[156:157], v17 offset:28672
 ds_read_b64_tr_b16 a[158:159], v17 offset:28928
 s_waitcnt vmcnt(8)
 s_waitcnt lgkmcnt(0)
 s_barrier
 s_add_u32 m0, s72, 139264
 s_add_u32 s47, s71, 384
 buffer_load_dwordx4 v14, s[24:27], s47 offen  lds
 s_add_u32 m0, s72, 140288
 s_nop 0
 buffer_load_dwordx4 v15, s[24:27], s47 offen  lds
 ds_read_b64_tr_b16 a[160:161], v17 offset:32768
 ds_read_b64_tr_b16 a[162:163], v17 offset:33024
 ds_read_b64_tr_b16 a[164:165], v17 offset:36864
 ds_read_b64_tr_b16 a[166:167], v17 offset:37120
 s_waitcnt vmcnt(8)
 s_waitcnt lgkmcnt(0)
 s_barrier
 s_add_u32 m0, s72, 147456
 s_add_u32 s47, s71, 512
 buffer_load_dwordx4 v14, s[24:27], s47 offen  lds
 s_add_u32 m0, s72, 148480
 s_nop 0
 buffer_load_dwordx4 v15, s[24:27], s47 offen  lds
 s_branch Lhsc_60
Lhs_59:
 buffer_load_dwordx4 v[68:71], v65, s[28:31], 0 offen sc1
 s_waitcnt vmcnt(0)
Lhsc_60:
 v_sad_u8 v69, v70, 0, 0
 v_sad_u8 v69, v71, 0, v69
 v_lshrrev_b32 v69, 5, v69
 v_min_u32 v68, v68, v69
 v_cmp_ne_u32 vcc, 0, v68
 s_cbranch_vccnz Lhsok_61
 s_sub_u32 s54, s54, 1
 s_cbranch_scc0 Lhs_59
 s_endpgm
Lhsok_61:
 v_readfirstlane_b32 s74, v70
 v_readfirstlane_b32 s75, v71
 buffer_load_dwordx4 v[20:23], v3, s[20:23], s39 offen offset:0 sc1
 buffer_load_dwordx4 v[20:23], v3, s[20:23], s39 offen offset:1024 sc1
 buffer_load_dwordx4 v[20:23], v3, s[20:23], s40 offen offset:0 sc1
 buffer_load_dwordx4 v[20:23], v3, s[20:23], s40 offen offset:1024 sc1
 v_min_u32 v67, 3, v0
 v_add_u32 v68, 1, v67
 v_and_b32 v68, 4, v68
 v_lshlrev_b32 v68, 26, v68
 v_lshl_or_b32 v68, v67, 7, v68
 s_mul_i32 s47, s6, 384
 s_add_u32 s47, s47, 0x160000
 buffer_load_dword v20, v68, s[20:23], s47 offen sc1
 s_mul_i32 s47, s6, 384
 s_add_u32 s47, s47, 0x1e0000
 buffer_load_dword v20, v68, s[20:23], s47 offen sc1
 v_lshlrev_b32 v67, 6, v0
 ds_read_b64_tr_b16 a[168:169], v17 offset:40960
 ds_read_b64_tr_b16 a[170:171], v17 offset:41216
 ds_read_b64_tr_b16 a[172:173], v17 offset:45056
 ds_read_b64_tr_b16 a[174:175], v17 offset:45312
 s_waitcnt vmcnt(14)
 s_waitcnt lgkmcnt(0)
 s_barrier
 s_add_u32 m0, s72, 155648
 s_add_u32 s47, s71, 640
 buffer_load_dwordx4 v14, s[24:27], s47 offen  lds
 s_add_u32 m0, s72, 156672
 s_nop 0
 buffer_load_dwordx4 v15, s[24:27], s47 offen  lds
 ds_read_b64_tr_b16 a[176:177], v17 offset:49152
 ds_read_b64_tr_b16 a[178:179], v17 offset:49408
 ds_read_b64_tr_b16 a[180:181], v17 offset:53248
 ds_read_b64_tr_b16 a[182:183], v17 offset:53504
 s_waitcnt vmcnt(14)
 s_waitcnt lgkmcnt(0)
 s_barrier
 s_add_u32 m0, s72, 24576
 s_add_u32 s47, s71, 768
 buffer_load_dwordx4 v14, s[24:27], s47 offen  lds
 s_add_u32 m0, s72, 25600
 s_nop 0
 buffer_load_dwordx4 v15, s[24:27], s47 offen  lds
 ds_read_b64_tr_b16 a[184:185], v17 offset:57344
 ds_read_b64_tr_b16 a[186:187], v17 offset:57600
 ds_read_b64_tr_b16 a[188:189], v17 offset:61440
 ds_read_b64_tr_b16 a[190:191], v17 offset:61696
 s_waitcnt vmcnt(14)
 s_waitcnt lgkmcnt(0)
 s_barrier
 s_add_u32 m0, s72, 32768
 s_add_u32 s47, s71, 896
 buffer_load_dwordx4 v14, s[24:27], s47 offen  lds
 s_add_u32 m0, s72, 33792
 s_nop 0
 buffer_load_dwordx4 v15, s[24:27], s47 offen  lds
 ds_read_b64_tr_b16 a[192:193], v18 offset:0
 ds_read_b64_tr_b16 a[194:195], v18 offset:256
 ds_read_b64_tr_b16 a[196:197], v18 offset:4096
 ds_read_b64_tr_b16 a[198:199], v18 offset:4352
 s_waitcnt vmcnt(14)
 s_waitcnt lgkmcnt(0)
 s_barrier
 s_add_u32 m0, s72, 40960
 s_add_u32 s47, s71, 37760
 buffer_load_dwordx4 v14, s[24:27], s47 offen  lds
 s_add_u32 m0, s72, 41984
 s_nop 0
 buffer_load_dwordx4 v15, s[24:27], s47 offen  lds
 ds_read_b64_tr_b16 a[200:201], v18 offset:8192
 ds_read_b64_tr_b16 a[202:203], v18 offset:8448
 ds_read_b64_tr_b16 a[204:205], v18 offset:12288
 ds_read_b64_tr_b16 a[206:207], v18 offset:12544
 s_waitcnt vmcnt(14)
 s_waitcnt lgkmcnt(0)
 s_barrier
 s_add_u32 m0, s72, 49152
 s_add_u32 s47, s71, 1024
 buffer_load_dwordx4 v14, s[24:27], s47 offen  lds
 s_add_u32 m0, s72, 50176
 s_nop 0
 buffer_load_dwordx4 v15, s[24:27], s47 offen  lds
 ds_read_b64_tr_b16 a[208:209], v18 offset:16384
 ds_read_b64_tr_b16 a[210:211], v18 offset:16640
 ds_read_b64_tr_b16 a[212:213], v18 offset:20480
 ds_read_b64_tr_b16 a[214:215], v18 offset:20736
 s_waitcnt vmcnt(8)
 s_waitcnt lgkmcnt(0)
 s_barrier
 s_add_u32 m0, s72, 57344
 s_add_u32 s47, s70, 1310848
 buffer_load_dwordx4 v56, s[12:15], s47 offen  lds
 s_add_u32 m0, s72, 58368
 s_nop 0
 buffer_load_dwordx4 v57, s[12:15], s47 offen  lds
 s_lshl_b32 s47, s6, 2
 s_add_u32 s47, s47, 0x4400
 v_mov_b32 v64, 1
 buffer_store_dword v64, v66, s[20:23], s47 offen
 ds_read_b64_tr_b16 a[216:217], v18 offset:24576
 ds_read_b64_tr_b16 a[218:219], v18 offset:24832
 ds_read_b64_tr_b16 a[220:221], v18 offset:28672
 ds_read_b64_tr_b16 a[222:223], v18 offset:28928
 s_waitcnt vmcnt(9)
 s_waitcnt lgkmcnt(0)
 s_barrier
 s_add_u32 m0, s72, 65536
 s_add_u32 s47, s70, 2097280
 buffer_load_dwordx4 v56, s[12:15], s47 offen  lds
 s_add_u32 m0, s72, 66560
 s_nop 0
 buffer_load_dwordx4 v57, s[12:15], s47 offen  lds
 ds_read_b64_tr_b16 a[224:225], v16 offset:24576
 ds_read_b64_tr_b16 a[226:227], v16 offset:24832
 ds_read_b64_tr_b16 a[228:229], v16 offset:28672
 ds_read_b64_tr_b16 a[230:231], v16 offset:28928
 s_waitcnt vmcnt(9)
 s_waitcnt lgkmcnt(0)
 s_barrier
 s_add_u32 m0, s72, 73728
 s_add_u32 s47, s70, 2359424
 buffer_load_dwordx4 v56, s[12:15], s47 offen  lds
 s_add_u32 m0, s72, 74752
 s_nop 0
 buffer_load_dwordx4 v57, s[12:15], s47 offen  lds
 s_and_b32 s47, s6, 29
 s_cbranch_scc1 Lgt_62
 buffer_store_dword v64, v66, s[28:31], 0 offen offset:128 sc1
Lgt_62:
 ds_read_b64_tr_b16 a[232:233], v16 offset:32768
 ds_read_b64_tr_b16 a[234:235], v16 offset:33024
 ds_read_b64_tr_b16 a[236:237], v16 offset:36864
 ds_read_b64_tr_b16 a[238:239], v16 offset:37120
 s_waitcnt vmcnt(9)
 s_waitcnt lgkmcnt(0)
 s_barrier
 s_add_u32 m0, s72, 81920
 s_add_u32 s47, s70, 3145856
 buffer_load_dwordx4 v56, s[12:15], s47 offen  lds
 s_add_u32 m0, s72, 82944
 s_nop 0
 buffer_load_dwordx4 v57, s[12:15], s47 offen  lds
 ds_read_b64_tr_b16 a[240:241], v16 offset:40960
 ds_read_b64_tr_b16 a[242:243], v16 offset:41216
 ds_read_b64_tr_b16 a[244:245], v16 offset:45056
 ds_read_b64_tr_b16 a[246:247], v16 offset:45312
 s_waitcnt vmcnt(9)
 s_waitcnt lgkmcnt(0)
 s_barrier
 s_add_u32 m0, s72, 90112
 s_add_u32 s47, s70, 3408000
 buffer_load_dwordx4 v56, s[12:15], s47 offen  lds
 s_add_u32 m0, s72, 91136
 s_nop 0
 buffer_load_dwordx4 v57, s[12:15], s47 offen  lds
 ds_read_b64_tr_b16 a[248:249], v16 offset:49152
 ds_read_b64_tr_b16 a[250:251], v16 offset:49408
 ds_read_b64_tr_b16 a[252:253], v16 offset:53248
 ds_read_b64_tr_b16 a[254:255], v16 offset:53504
 s_waitcnt vmcnt(9)
 s_waitcnt lgkmcnt(0)
 s_barrier
 s_add_u32 m0, s72, 98304
 s_add_u32 s47, s71, 37888
 buffer_load_dwordx4 v14, s[24:27], s47 offen  lds
 s_add_u32 m0, s72, 99328
 s_nop 0
 buffer_load_dwordx4 v15, s[24:27], s47 offen  lds
 ds_read_b64_tr_b16 v[48:49], v16 offset:57344
 ds_read_b64_tr_b16 v[50:51], v16 offset:57600
 ds_read_b64_tr_b16 v[52:53], v16 offset:61440
 ds_read_b64_tr_b16 v[54:55], v16 offset:61696
 s_waitcnt vmcnt(8)
 s_waitcnt lgkmcnt(0)
 s_barrier
 s_add_u32 m0, s72, 106496
 s_add_u32 s47, s71, 36864
 buffer_load_dwordx4 v14, s[24:27], s47 offen  lds
 s_add_u32 m0, s72, 107520
 s_nop 0
 buffer_load_dwordx4 v15, s[24:27], s47 offen  lds
 v_lshrrev_b32 v68, 2, v3
 s_mov_b32 s47, 0x4400
 buffer_load_dword v68, v68, s[20:23], s47 offen sc1
 ds_write_b128 v60, v[48:51] offset:57344
 ds_write_b128 v60, v[52:55] offset:61440
 ds_read_b64_tr_b16 v[40:41], v17 offset:0
 ds_read_b64_tr_b16 v[42:43], v17 offset:256
 ds_read_b64_tr_b16 v[44:45], v17 offset:4096
 ds_read_b64_tr_b16 v[46:47], v17 offset:4352
 s_waitcnt vmcnt(9)
 s_waitcnt lgkmcnt(0)
 s_barrier
 s_add_u32 m0, s72, 114688
 s_add_u32 s47, s71, 36992
 buffer_load_dwordx4 v14, s[24:27], s47 offen  lds
 s_add_u32 m0, s72, 115712
 s_nop 0
 buffer_load_dwordx4 v15, s[24:27], s47 offen  lds
 ds_write_b128 v61, v[40:43] offset:0
 ds_write_b128 v61, v[44:47] offset:4096
 ds_read_b64_tr_b16 v[48:49], v17 offset:8192
 ds_read_b64_tr_b16 v[50:51], v17 offset:8448
 ds_read_b64_tr_b16 v[52:53], v17 offset:12288
 ds_read_b64_tr_b16 v[54:55], v17 offset:12544
 s_waitcnt vmcnt(9)
 s_waitcnt lgkmcnt(0)
 s_barrier
 s_add_u32 m0, s72, 122880
 s_add_u32 s47, s71, 37120
 buffer_load_dwordx4 v14, s[24:27], s47 offen  lds
 s_add_u32 m0, s72, 123904
 s_nop 0
 buffer_load_dwordx4 v15, s[24:27], s47 offen  lds
 ds_write_b128 v61, v[48:51] offset:8192
 ds_write_b128 v61, v[52:55] offset:12288
 ds_read_b64_tr_b16 v[40:41], v17 offset:16384
 ds_read_b64_tr_b16 v[42:43], v17 offset:16640
 ds_read_b64_tr_b16 v[44:45], v17 offset:20480
 ds_read_b64_tr_b16 v[46:47], v17 offset:20736
 s_waitcnt vmcnt(9)
 s_waitcnt lgkmcnt(0)
 s_barrier
 s_add_u32 m0, s72, 131072
 s_add_u32 s47, s71, 37248
 buffer_load_dwordx4 v14, s[24:27], s47 offen  lds
 s_add_u32 m0, s72, 132096
 s_nop 0
 buffer_load_dwordx4 v15, s[24:27], s47 offen  lds
 ds_write_b128 v61, v[40:43] offset:16384
 ds_write_b128 v61, v[44:47] offset:20480
 ds_read_b64_tr_b16 v[48:49], v17 offset:24576
 ds_read_b64_tr_b16 v[50:51], v17 offset:24832
 ds_read_b64_tr_b16 v[52:53], v17 offset:28672
 ds_read_b64_tr_b16 v[54:55], v17 offset:28928
 s_waitcnt vmcnt(9)
 s_waitcnt lgkmcnt(0)
 s_barrier
 s_add_u32 m0, s72, 139264
 s_add_u32 s47, s71, 37376
 buffer_load_dwordx4 v14, s[24:27], s47 offen  lds
 s_add_u32 m0, s72, 140288
 s_nop 0
 buffer_load_dwordx4 v15, s[24:27], s47 offen  lds
 ds_write_b128 v61, v[48:51] offset:24576
 ds_write_b128 v61, v[52:55] offset:28672
 ds_read_b64_tr_b16 v[40:41], v17 offset:32768
 ds_read_b64_tr_b16 v[42:43], v17 offset:33024
 ds_read_b64_tr_b16 v[44:45], v17 offset:36864
 ds_read_b64_tr_b16 v[46:47], v17 offset:37120
 s_waitcnt vmcnt(9)
 s_waitcnt lgkmcnt(0)
 s_barrier
 s_add_u32 m0, s72, 147456
 s_add_u32 s47, s71, 37504
 buffer_load_dwordx4 v14, s[24:27], s47 offen  lds
 s_add_u32 m0, s72, 148480
 s_nop 0
 buffer_load_dwordx4 v15, s[24:27], s47 offen  lds
 ds_write_b128 v61, v[40:43] offset:32768
 ds_write_b128 v61, v[44:47] offset:36864
 ds_read_b64_tr_b16 v[48:49], v17 offset:40960
 ds_read_b64_tr_b16 v[50:51], v17 offset:41216
 ds_read_b64_tr_b16 v[52:53], v17 offset:45056
 ds_read_b64_tr_b16 v[54:55], v17 offset:45312
 s_waitcnt vmcnt(8)
 s_waitcnt lgkmcnt(0)
 s_barrier
 s_add_u32 m0, s72, 155648
 s_add_u32 s47, s71, 37632
 buffer_load_dwordx4 v14, s[24:27], s47 offen  lds
 s_add_u32 m0, s72, 156672
 s_nop 0
 buffer_load_dwordx4 v15, s[24:27], s47 offen  lds
 v_cmp_ne_u32 vcc, 0, v68
 s_mov_b32 s77, vcc_lo
 s_add_u32 s58, s6, 1
 s_and_b32 s58, s58, 31
 s_bitcmp1_b32 s77, s58
 s_cbranch_scc1 Lhlp_63
 s_lshl_b32 s76, s58, 8
 s_mul_i32 s80, s58, 147456
 s_add_u32 s47, s76, 2359424
 buffer_load_dword v63, v19, s[12:15], s47 offen
 s_add_u32 s47, s80, 37888
 buffer_load_dword v63, v59, s[24:27], s47 offen
 s_add_u32 s47, s80, 37120
 buffer_load_dword v63, v59, s[24:27], s47 offen
 s_add_u32 s47, s80, 37504
 buffer_load_dword v63, v59, s[24:27], s47 offen
 s_add_u32 s47, s76, 128
 buffer_load_dword v63, v19, s[12:15], s47 offen
Lhlp_63:
 s_add_u32 s58, s6, 2
 s_and_b32 s58, s58, 31
 s_bitcmp1_b32 s77, s58
 s_cbranch_scc1 Lhlp_64
 s_lshl_b32 s76, s58, 8
 s_mul_i32 s80, s58, 147456
 s_add_u32 s47, s76, 3145856
 buffer_load_dword v63, v19, s[12:15], s47 offen
 s_add_u32 s47, s80, 36864
 buffer_load_dword v63, v59, s[24:27], s47 offen
 s_add_u32 s47, s80, 37248
 buffer_load_dword v63, v59, s[24:27], s47 offen
 s_add_u32 s47, s80, 37632
 buffer_load_dword v63, v59, s[24:27], s47 offen
 s_add_u32 s47, s76, 262272
 buffer_load_dword v63, v19, s[12:15], s47 offen
Lhlp_64:
 s_add_u32 s58, s6, 3
 s_and_b32 s58, s58, 31
 s_bitcmp1_b32 s77, s58
 s_cbranch_scc1 Lhlp_65
 s_lshl_b32 s76, s58, 8
 s_mul_i32 s80, s58, 147456
 s_add_u32 s47, s76, 3408000
 buffer_load_dword v63, v19, s[12:15], s47 offen
 s_add_u32 s47, s80, 36992
 buffer_load_dword v63, v59, s[24:27], s47 offen
 s_add_u32 s47, s80, 37376
 buffer_load_dword v63, v59, s[24:27], s47 offen
 s_add_u32 s47, s76, 4194432
 buffer_load_dword v63, v58, s[12:15], s47 offen
 s_add_u32 s47, s76, 1048704
 buffer_load_dword v63, v19, s[12:15], s47 offen
Lhlp_65:
 ds_write_b128 v61, v[48:51] offset:40960
 ds_write_b128 v61, v[52:55] offset:45056
 ds_read_b64_tr_b16 v[40:41], v17 offset:49152
 ds_read_b64_tr_b16 v[42:43], v17 offset:49408
 ds_read_b64_tr_b16 v[44:45], v17 offset:53248
 ds_read_b64_tr_b16 v[46:47], v17 offset:53504
 s_waitcnt vmcnt(8)
 s_waitcnt lgkmcnt(0)
 s_barrier
 s_add_u32 m0, s72, 24576
 s_add_u32 s47, s70, 4194432
 buffer_load_dwordx4 v12, s[12:15], s47 offen  lds
 s_add_u32 m0, s72, 25600
 s_nop 0
 buffer_load_dwordx4 v13, s[12:15], s47 offen  lds
 ds_write_b128 v61, v[40:43] offset:49152
 ds_write_b128 v61, v[44:47] offset:53248
 ds_read_b64_tr_b16 v[48:49], v17 offset:57344
 ds_read_b64_tr_b16 v[50:51], v17 offset:57600
 ds_read_b64_tr_b16 v[52:53], v17 offset:61440
 ds_read_b64_tr_b16 v[54:55], v17 offset:61696
 s_waitcnt vmcnt(8)
 s_waitcnt lgkmcnt(0)
 s_barrier
 s_add_u32 m0, s72, 32768
 s_add_u32 s47, s70, 128
 buffer_load_dwordx4 v56, s[12:15], s47 offen  lds
 s_add_u32 m0, s72, 33792
 s_nop 0
 buffer_load_dwordx4 v57, s[12:15], s47 offen  lds
 ds_write_b128 v61, v[48:51] offset:57344
 ds_write_b128 v61, v[52:55] offset:61440
 ds_read_b64_tr_b16 v[40:41], v18 offset:0
 ds_read_b64_tr_b16 v[42:43], v18 offset:256
 ds_read_b64_tr_b16 v[44:45], v18 offset:4096
 ds_read_b64_tr_b16 v[46:47], v18 offset:4352
 s_waitcnt vmcnt(8)
 s_waitcnt lgkmcnt(0)
 s_barrier
 s_add_u32 m0, s72, 40960
 s_add_u32 s47, s70, 262272
 buffer_load_dwordx4 v56, s[12:15], s47 offen  lds
 s_add_u32 m0, s72, 41984
 s_nop 0
 buffer_load_dwordx4 v57, s[12:15], s47 offen  lds
 ds_write_b128 v62, v[40:43] offset:0
 ds_write_b128 v62, v[44:47] offset:4096
 ds_read_b64_tr_b16 v[48:49], v18 offset:8192
 ds_read_b64_tr_b16 v[50:51], v18 offset:8448
 ds_read_b64_tr_b16 v[52:53], v18 offset:12288
 ds_read_b64_tr_b16 v[54:55], v18 offset:12544
 s_waitcnt vmcnt(8)
 s_waitcnt lgkmcnt(0)
 s_barrier
 s_add_u32 m0, s72, 49152
 s_add_u32 s47, s70, 1048704
 buffer_load_dwordx4 v56, s[12:15], s47 offen  lds
 s_add_u32 m0, s72, 50176
 s_nop 0
 buffer_load_dwordx4 v57, s[12:15], s47 offen  lds
 buffer_load_dword v1, v65, s[20:23], s56 offen sc1
 ds_write_b128 v62, v[48:51] offset:8192
 ds_write_b128 v62, v[52:55] offset:12288
 ds_read_b64_tr_b16 v[40:41], v18 offset:16384
 ds_read_b64_tr_b16 v[42:43], v18 offset:16640
 ds_read_b64_tr_b16 v[44:45], v18 offset:20480
 ds_read_b64_tr_b16 v[46:47], v18 offset:20736
 s_waitcnt vmcnt(9)
 s_waitcnt lgkmcnt(0)
 s_barrier
 ds_write_b128 v62, v[40:43] offset:16384
 ds_write_b128 v62, v[44:47] offset:20480
 ds_read_b64_tr_b16 v[48:49], v18 offset:24576
 ds_read_b64_tr_b16 v[50:51], v18 offset:24832
 ds_read_b64_tr_b16 v[52:53], v18 offset:28672
 ds_read_b64_tr_b16 v[54:55], v18 offset:28928
 s_waitcnt vmcnt(7)
 s_waitcnt lgkmcnt(0)
 s_barrier
 ds_write_b128 v62, v[48:51] offset:24576
 ds_write_b128 v62, v[52:55] offset:28672
 ds_read_b64_tr_b16 v[40:41], v16 offset:24576
 ds_read_b64_tr_b16 v[42:43], v16 offset:24832
 ds_read_b64_tr_b16 v[44:45], v16 offset:28672
 ds_read_b64_tr_b16 v[46:47], v16 offset:28928
 s_waitcnt vmcnt(5)
 s_waitcnt lgkmcnt(0)
 s_barrier
 ds_write_b128 v60, v[40:43] offset:24576
 ds_write_b128 v60, v[44:47] offset:28672
 ds_read_b64_tr_b16 v[48:49], v16 offset:32768
 ds_read_b64_tr_b16 v[50:51], v16 offset:33024
 ds_read_b64_tr_b16 v[52:53], v16 offset:36864
 ds_read_b64_tr_b16 v[54:55], v16 offset:37120
 s_waitcnt vmcnt(3)
 s_waitcnt lgkmcnt(0)
 s_barrier
 ds_write_b128 v60, v[48:51] offset:32768
 ds_write_b128 v60, v[52:55] offset:36864
 ds_read_b64_tr_b16 v[40:41], v16 offset:40960
 ds_read_b64_tr_b16 v[42:43], v16 offset:41216
 ds_read_b64_tr_b16 v[44:45], v16 offset:45056
 ds_read_b64_tr_b16 v[46:47], v16 offset:45312
 s_waitcnt vmcnt(1)
 s_waitcnt lgkmcnt(0)
 s_barrier
 ds_write_b128 v60, v[40:43] offset:40960
 ds_write_b128 v60, v[44:47] offset:45056
 ds_read_b64_tr_b16 v[48:49], v16 offset:49152
 ds_read_b64_tr_b16 v[50:51], v16 offset:49408
 ds_read_b64_tr_b16 v[52:53], v16 offset:53248
 ds_read_b64_tr_b16 v[54:55], v16 offset:53504
 s_waitcnt lgkmcnt(0)
 s_barrier
 ds_write_b128 v60, v[48:51] offset:49152
 ds_write_b128 v60, v[52:55] offset:53248
 v_lshlrev_b32 v0, 4, v0
 s_waitcnt vmcnt(0)
 v_cmp_le_u32 vcc, 2, v1
 s_cbranch_vccnz Lpbk_66
Lpb0_67:
 buffer_load_dword v1, v7, s[20:23], s56 offen sc1
 s_waitcnt vmcnt(0)
 v_cmp_le_u32 vcc, 2, v1
 s_cbranch_vccnz Lpb0ok_68
 s_sub_u32 s54, s54, 1
 s_cbranch_scc0 Lpb0_67
 s_endpgm
Lpb0ok_68:
Lpbk_66:
 s_lshl_b32 s47, s4, 11
 s_add_u32 m0, s47, 9216
 s_add_u32 s68, s37, 0x80000
 buffer_load_dwordx4 v3, s[20:23], s67 offen offset:0 sc1 lds
 buffer_load_dwordx4 v3, s[20:23], s67 offen offset:1024 sc1 lds
 buffer_load_dword v12, v67, s[20:23], s37 offen sc1
 v_mov_b64 v[64:65], 0
 v_mov_b64 v[66:67], 0
 v_mov_b64 v[68:69], 0
 v_mov_b64 v[70:71], 0
 s_mov_b32 s24, 0xf000f
 s_mov_b32 s25, 0xf000f
 s_mov_b32 s26, 0xf000f0
 s_mov_b32 s27, 0xf000f0
 s_mov_b32 s28, 0xf000f00
 s_mov_b32 s29, 0xf000f00
 s_mov_b32 s30, 0xf000f000
 s_mov_b32 s31, 0xf000f000
 s_mov_b32 s32, 0xaaaaaaaa
 s_mov_b32 s33, 0xaaaaaaaa
 s_mov_b32 s34, 0x3f803f80
 s_mov_b32 s35, 0x3f803f80
 s_mov_b32 s70, -1
 s_mov_b32 s71, 0
 s_lshl_b32 s47, s4, 12
 s_add_u32 s68, s68, s47
 v_mov_b32 v2, 0
 v_mov_b32 v4, 0
 s_waitcnt lgkmcnt(0)
 ds_read_b128 v[20:23], v0 offset:24576
 ds_read_b128 v[24:27], v0 offset:28672
 ds_read_b128 v[28:31], v0 offset:32768
 ds_read_b128 v[32:35], v0 offset:36864
 v_mov_b64 v[36:37], 0
 v_mov_b64 v[38:39], 0
 v_mov_b64 v[40:41], 0
 v_mov_b64 v[42:43], 0
 v_mov_b64 v[44:45], 0
 v_mov_b64 v[46:47], 0
 v_mov_b64 v[48:49], 0
 v_mov_b64 v[50:51], 0
 v_lshl_add_u32 v1, v3, 3, s68
 v_cndmask_b32 v1, -16, v1, s[70:71]
 v_writelane_b32 v1, s56, 63
 v_min_u32 v6, 16, v0
 v_lshlrev_b32 v6, 24, v6
 s_max_u32 s47, s36, 1
 v_add_u32 v2, -1, s47
 s_mov_b32 s70, 0xffffffff
 s_xor_b32 s44, s44, 0x80000
 s_xor_b32 s45, s45, 0x80000
 s_xor_b32 s65, s65, 0x80000
 s_xor_b32 s66, s66, 0x80000
 s_xor_b32 s41, s41, 0x80000
 s_xor_b32 s43, s43, 0x80000
 s_lshr_b64 s[74:75], s[74:75], s73
 s_and_b32 s74, s74, 0xff
 s_cmp_eq_u32 s74, 32
 s_waitcnt vmcnt(1)
 s_cbranch_scc0 Lslow_69
 s_branch Lstep_71
 .p2align 3
LstepB_73:
 s_mov_b64 exec, -1
 s_cmp_lg_u32 s50, 0
 s_cbranch_scc1 Lsure_74
Lsureb_75:
 buffer_load_dwordx4 v3, s[20:23], s41 offen offset:0 sc1 lds
 buffer_load_dwordx4 v3, s[20:23], s41 offen offset:1024 sc1 lds
Lstep_71:
 s_mov_b64 exec, -1
 s_waitcnt lgkmcnt(0)
 buffer_load_dwordx4 v[12:15], v3, s[20:23], s59 offen offset:0 sc1
 buffer_load_dwordx4 v[16:19], v3, s[20:23], s59 offen offset:1024 sc1
 s_barrier
 ds_read_b128 v[52:55], v3 offset:8192
 ds_read_b128 v[56:59], v3 offset:0
 ds_read_b128 v[60:63], v3 offset:1024
 buffer_store_dwordx4 v[64:67], v0, s[20:23], s38 offen sc1
 s_waitcnt lgkmcnt(2)
 v_smfmac_f32_16x16x64_bf16 v[36:39], v[52:55], a[136:143], v5
 v_smfmac_f32_16x16x64_bf16 v[40:43], v[52:55], a[144:151], v5
 buffer_store_dword v2, v6, s[20:23], s57 offen sc1
 v_smfmac_f32_16x16x64_bf16 v[44:47], v[52:55], a[152:159], v5
 s_waitcnt lgkmcnt(1)
 v_smfmac_f32_16x16x64_bf16 v[48:51], v[52:55], v[20:27], v5
 buffer_load_dword v1, v1, s[20:23], 0 offen sc1
 v_smfmac_f32_16x16x64_bf16 v[36:39], v[56:59], v[72:79], v5
 ds_read_b128 v[20:23], v0 offset:40960
 v_mov_b64 v[64:65], 0
 v_smfmac_f32_16x16x64_bf16 v[40:43], v[56:59], v[80:87], v5
 ds_read_b128 v[24:27], v0 offset:45056
 v_mov_b64 v[66:67], 0
 v_smfmac_f32_16x16x64_bf16 v[44:47], v[56:59], v[88:95], v5
 ds_read_b128 v[52:55], v3 offset:2048
 s_waitcnt lgkmcnt(3)
 v_smfmac_f32_16x16x64_bf16 v[48:51], v[56:59], v[28:35], v5
 v_smfmac_f32_16x16x64_bf16 v[36:39], v[60:63], v[112:119], v5
 ds_read_b128 v[28:31], v0 offset:49152
 v_smfmac_f32_16x16x64_bf16 v[40:43], v[60:63], v[120:127], v5
 ds_read_b128 v[32:35], v0 offset:53248
 v_smfmac_f32_16x16x64_bf16 v[44:47], v[60:63], v[128:135], v5
 ds_read_b128 v[56:59], v3 offset:3072
 v_smfmac_f32_16x16x64_bf16 v[64:67], v[60:63], v[136:143], v5
 s_waitcnt vmcnt(5)
 v_smfmac_f32_16x16x64_bf16 v[68:71], v[60:63], v[144:151], v5
 s_waitcnt lgkmcnt(3)
 v_smfmac_f32_16x16x64_bf16 v[48:51], v[60:63], v[20:27], v5
 s_barrier
 v_smfmac_f32_16x16x64_bf16 v[36:39], v[52:55], v[152:159], v5
 ds_read_b128 v[20:23], v0 offset:57344
 v_smfmac_f32_16x16x64_bf16 v[40:43], v[52:55], v[160:167], v5
 ds_read_b128 v[24:27], v0 offset:61440
 v_smfmac_f32_16x16x64_bf16 v[44:47], v[52:55], v[168:175], v5
 ds_read_b128 v[60:63], v3 offset:4096
 v_smfmac_f32_16x16x64_bf16 v[64:67], v[52:55], v[176:183], v5
 v_smfmac_f32_16x16x64_bf16 v[68:71], v[52:55], v[184:191], v5
 s_waitcnt lgkmcnt(3)
 v_add_u32 v0, 0x10000, v0
 v_smfmac_f32_16x16x64_bf16 v[48:51], v[52:55], v[28:35], v5
 ds_read_b128 v[52:55], v3 offset:5120
 v_smfmac_f32_16x16x64_bf16 v[36:39], v[56:59], v[192:199], v5
 ds_read_b128 v[28:31], v0 offset:0
 v_smfmac_f32_16x16x64_bf16 v[40:43], v[56:59], v[200:207], v5
 ds_read_b128 v[32:35], v0 offset:4096
 v_smfmac_f32_16x16x64_bf16 v[44:47], v[56:59], v[208:215], v5
 v_smfmac_f32_16x16x64_bf16 v[64:67], v[56:59], v[216:223], v5
 s_waitcnt lgkmcnt(2)
 v_max_u32 v4, v63, v55
 v_cmp_eq_u32 vcc, -1, v4
 v_smfmac_f32_16x16x64_bf16 v[68:71], v[56:59], v[224:231], v5
 v_smfmac_f32_16x16x64_bf16 v[48:51], v[56:59], v[20:27], v5
 ds_read_b128 v[56:59], v3 offset:6144
 s_cbranch_vccnz Lfx_76
Lfxb_77:
 v_smfmac_f32_16x16x64_bf16 v[36:39], v[60:63], v[232:239], v5
 ds_read_b128 v[20:23], v0 offset:8192
 v_smfmac_f32_16x16x64_bf16 v[40:43], v[60:63], v[240:247], v5
 ds_read_b128 v[24:27], v0 offset:12288
 v_smfmac_f32_16x16x64_bf16 v[44:47], v[60:63], v[248:255], v5
 s_waitcnt lgkmcnt(3)
 v_smfmac_f32_16x16x64_bf16 v[48:51], v[60:63], v[28:35], v5
 ds_read_b128 v[60:63], v3 offset:7168
 v_smfmac_f32_16x16x64_bf16 v[36:39], v[52:55], a[16:23], v5
 ds_read_b128 v[28:31], v0 offset:16384
 v_smfmac_f32_16x16x64_bf16 v[40:43], v[52:55], a[24:31], v5
 ds_read_b128 v[32:35], v0 offset:20480
 v_smfmac_f32_16x16x64_bf16 v[44:47], v[52:55], a[32:39], v5
 s_waitcnt lgkmcnt(3)
 v_smfmac_f32_16x16x64_bf16 v[48:51], v[52:55], v[20:27], v5
 s_waitcnt lgkmcnt(2)
 v_max_u32 v4, v59, v63
 v_cmp_eq_u32 vcc, -1, v4
 v_smfmac_f32_16x16x64_bf16 v[64:67], v[52:55], a[40:47], v5
 ds_read_b128 v[20:23], v0 offset:24576
 v_smfmac_f32_16x16x64_bf16 v[68:71], v[52:55], a[48:55], v5
 s_cbranch_vccnz Lfx_78
Lfxb_79:
 v_smfmac_f32_16x16x64_bf16 v[36:39], v[56:59], a[56:63], v5
 ds_read_b128 v[24:27], v0 offset:28672
 v_smfmac_f32_16x16x64_bf16 v[40:43], v[56:59], a[64:71], v5
 ds_read_b128 v[52:55], v3 offset:8192
 v_smfmac_f32_16x16x64_bf16 v[36:39], v[60:63], a[96:103], v5
 v_smfmac_f32_16x16x64_bf16 v[40:43], v[60:63], a[104:111], v5
 v_smfmac_f32_16x16x64_bf16 v[44:47], v[56:59], a[72:79], v5
 s_waitcnt lgkmcnt(1)
 v_add_f32 v36, v36, v38
 v_add_f32 v37, v37, v39
 v_smfmac_f32_16x16x64_bf16 v[48:51], v[56:59], v[28:35], v5
 ds_read_b128 v[32:35], v3 offset:11264
 v_add_f32 v40, v40, v42
 v_add_f32 v41, v41, v43
 v_smfmac_f32_16x16x64_bf16 v[44:47], v[60:63], a[112:119], v5
 v_cvt_pk_bf16_f32 v36, v36, v40
 v_cvt_pk_bf16_f32 v37, v37, v41
 v_smfmac_f32_16x16x64_bf16 v[48:51], v[60:63], v[20:27], v5
 ds_write2_b32 v10, v36, v37 offset0:0 offset1:16
 v_smfmac_f32_16x16x64_bf16 v[64:67], v[56:59], a[80:87], v5
 ds_read_b128 v[20:23], v3 offset:9216
 v_add_f32 v44, v44, v46
 v_add_f32 v45, v45, v47
 v_smfmac_f32_16x16x64_bf16 v[68:71], v[56:59], a[88:95], v5
 s_waitcnt lgkmcnt(3)
 v_add_f32 v48, v48, v50
 v_add_f32 v49, v49, v51
 v_cvt_pk_bf16_f32 v44, v44, v48
 v_cvt_pk_bf16_f32 v45, v45, v49
 ds_write2_b32 v8, v44, v45 offset0:0 offset1:16
 v_smfmac_f32_16x16x64_bf16 v[64:67], v[52:55], a[160:167], v5
 ds_read_b128 v[56:59], v3 offset:0
 v_mov_b64 v[28:29], 0
 v_smfmac_f32_16x16x64_bf16 v[68:71], v[52:55], a[168:175], v5
 ds_read_b128 v[52:55], v3 offset:4096
 v_mov_b64 v[30:31], 0
 v_smfmac_f32_16x16x64_bf16 v[64:67], v[60:63], a[120:127], v5
 ds_read_b128 v[24:27], v3 offset:10240
 v_smfmac_f32_16x16x64_bf16 v[68:71], v[60:63], a[128:135], v5
 s_waitcnt lgkmcnt(3)
 s_barrier
 ds_read_b128 v[36:39], v11 offset:17408
 s_waitcnt lgkmcnt(3)
 v_smfmac_f32_16x16x64_bf16 v[64:67], v[56:59], v[96:103], v5
 ds_read_b128 v[40:43], v11 offset:17920
 s_waitcnt lgkmcnt(3)
 v_smfmac_f32_16x16x64_bf16 v[68:71], v[56:59], v[104:111], v5
 ds_read_b128 v[60:63], v9 offset:19456
 ds_read_b128 v[44:47], v11 offset:18432
 v_smfmac_f32_16x16x64_bf16 v[64:67], v[52:55], a[0:7], v5
 ds_read_b128 v[48:51], v11 offset:18944
 v_smfmac_f32_16x16x64_bf16 v[68:71], v[52:55], a[8:15], v5
 ds_read_b128 v[52:55], v3 offset:12288
 s_waitcnt lgkmcnt(5)
 v_mfma_f32_16x16x32_bf16 v[20:23], v[20:23], v[36:39], 0
 ds_read_b128 v[56:59], v9 offset:21504
 v_mfma_f32_16x16x32_bf16 v[24:27], v[24:27], v[36:39], 0
 v_add_f32 v64, v64, v66
 v_add_f32 v65, v65, v67
 s_waitcnt lgkmcnt(5)
 v_mfma_f32_16x16x32_bf16 v[20:23], v[32:35], v[40:43], v[20:23]
 ds_read_b128 v[32:35], v3 offset:13312
 v_cvt_pk_bf16_f32 v2, v64, v65
 v_add_f32 v68, v68, v70
 s_waitcnt lgkmcnt(5)
 v_smfmac_f32_16x16x64_bf16 v[28:31], v[60:63], v[36:43], v5
 ds_read_b128 v[60:63], v3 offset:14336
 ds_read_b128 v[36:39], v3 offset:15360
 v_add_f32 v69, v69, v71
 s_waitcnt lgkmcnt(4)
 v_mfma_f32_16x16x32_bf16 v[24:27], v[52:55], v[40:43], v[24:27]
 ds_read_b128 v[52:55], v3 offset:16384
 v_cvt_pk_bf16_f32 v4, v68, v69
 s_waitcnt lgkmcnt(4)
 v_smfmac_f32_16x16x64_bf16 v[28:31], v[56:59], v[44:51], v5
 ds_read_b128 v[40:43], v0 offset:36864
 s_waitcnt lgkmcnt(4)
 v_mfma_f32_16x16x32_bf16 v[20:23], v[32:35], v[44:47], v[20:23]
 v_mov_b64 v[32:33], s[34:35]
 v_mov_b64 v[34:35], s[34:35]
 s_waitcnt lgkmcnt(3)
 v_mfma_f32_16x16x32_bf16 v[24:27], v[60:63], v[44:47], v[24:27]
 ds_read_b128 v[44:47], v0 offset:40960
 v_add_f32 v28, v28, v30
 v_add_f32 v29, v29, v31
 s_waitcnt lgkmcnt(3)
 v_mfma_f32_16x16x32_bf16 v[20:23], v[36:39], v[48:51], v[20:23]
 ds_read_b128 v[36:39], v0 offset:32768
 v_cndmask_b32 v28, v28, v29, s[48:49]
 v_mul_f32 v28, s55, v28
 s_waitcnt lgkmcnt(3)
 v_mfma_f32_16x16x32_bf16 v[24:27], v[52:55], v[48:51], v[24:27]
 ds_read_b128 v[48:51], v0 offset:45056
 v_exp_f32 v28, v28
 v_mov_b64 v[64:65], 0
 v_cndmask_b32 v29, 0, v28, s[48:49]
 v_cndmask_b32 v28, v28, 0, s[48:49]
 v_cvt_pk_bf16_f32 v6, v28, v29
 v_mov_b64 v[66:67], 0
 v_mov_b64 v[68:69], 0
 v_cndmask_b32 v20, v20, v24, s[48:49]
 v_cndmask_b32 v21, v21, v25, s[48:49]
 v_cndmask_b32 v22, v22, v26, s[48:49]
 v_cndmask_b32 v23, v23, v27, s[48:49]
 v_mfma_f32_16x16x16_bf16 v[60:63], v[6:7], v[32:33], 0
 s_waitcnt vmcnt(3)
 v_exp_f32 v20, v20
 v_mfma_f32_16x16x16_bf16 v[52:55], v[6:7], v[2:3], 0
 s_cmp_eq_u32 s36, 63
 v_exp_f32 v21, v21
 v_mfma_f32_16x16x16_bf16 v[56:59], v[6:7], v[4:5], 0
 v_exp_f32 v22, v22
 v_exp_f32 v23, v23
 v_cvt_pk_bf16_f32 v30, v20, v21
 v_cvt_pk_bf16_f32 v31, v22, v23
 v_mov_b64 v[70:71], 0
 v_mov_b64 v[20:21], 0
 v_smfmac_f32_16x16x32_bf16 v[60:63], v[30:31], v[32:35], v5
 v_mov_b64 v[22:23], 0
 v_mov_b64 v[24:25], 0
 v_smfmac_f32_16x16x32_bf16 v[52:55], v[30:31], v[12:15], v5
 v_mov_b64 v[26:27], 0
 v_smfmac_f32_16x16x32_bf16 v[56:59], v[30:31], v[16:19], v5
 s_nop 0
 v_add_f32 v60, v60, v62
 v_add_f32 v61, v61, v63
 v_rcp_f32 v60, v60
 v_rcp_f32 v61, v61
 v_add_f32 v52, v52, v54
 v_add_f32 v53, v53, v55
 v_mul_f32 v52, v52, v60
 v_mul_f32 v53, v53, v61
 v_add_f32 v56, v56, v58
 v_add_f32 v57, v57, v59
 v_mul_f32 v56, v56, v60
 v_mul_f32 v57, v57, v61
 v_cvt_pk_bf16_f32 v52, v52, v56
 v_cvt_pk_bf16_f32 v53, v53, v57
 ds_write2_b32 v8, v52, v53 offset0:128 offset1:144
 v_subrev_u32 v60, 0x21800000, v60
 v_subrev_u32 v61, 0x21800000, v61
 v_max_u32 v60, v60, v61
 v_cmp_lt_u32 vcc, 0x3c000000, v60
 s_cbranch_scc1 Lchexit_70
 v_mov_b64 v[28:29], 0
 v_mov_b64 v[30:31], 0
 v_mov_b64 v[32:33], 0
 v_mov_b64 v[34:35], 0
 s_cbranch_vccnz Lmx_80
Lmxb_81:
 s_waitcnt lgkmcnt(0)
 v_bfe_u32 v6, v0, 7, 5
 s_barrier
 ds_read_b128 v[52:55], v9 offset:19968
 v_mul_u32_u24 v6, 10496, v6
 ds_read_b128 v[56:59], v9 offset:22016
 ds_read_b128 v[12:15], v0 offset:49152
 v_bfe_u32 v60, v3, 4, 3
 ds_read_b128 v[16:19], v0 offset:53248
 s_add_u32 s67, s67, 0x80000
 v_lshl_add_u32 v6, v60, 3, v6
 s_add_u32 m0, s42, 9216
 s_xor_b32 s46, s46, 0x1
 v_mov_b64 v[60:61], 0
 s_add_u32 s59, s59, 0x80000
 v_mov_b64 v[62:63], 0
 s_waitcnt lgkmcnt(3)
 v_smfmac_f32_16x16x64_bf16 v[64:67], v[52:55], a[248:255], v5
 buffer_load_dwordx4 v3, s[20:23], s67 offen offset:0 sc1 lds
 v_smfmac_f32_16x16x64_bf16 v[68:71], v[52:55], a[176:183], v5
 s_waitcnt lgkmcnt(2)
 s_add_u32 s38, s38, 0x20000
 v_smfmac_f32_16x16x64_bf16 v[64:67], v[56:59], v[36:43], v5
 ds_read_b128 v[36:39], v0 offset:57344
 buffer_load_dwordx4 v3, s[20:23], s67 offen offset:1024 sc1 lds
 v_smfmac_f32_16x16x64_bf16 v[20:23], v[52:55], a[184:191], v5
 ds_read_b128 v[40:43], v0 offset:61440
 s_cmp_lt_u32 s36, 62
 v_add_u32 v0, 0x10000, v0
 v_smfmac_f32_16x16x64_bf16 v[68:71], v[56:59], v[44:51], v5
 ds_read_b128 v[44:47], v0 offset:0
 s_cselect_b32 s47, 0x80000, 0
 v_add_f32 v64, v64, v66
 v_add_f32 v65, v65, v67
 v_cvt_pk_bf16_f32 v65, v65, v65
 v_smfmac_f32_16x16x64_bf16 v[24:27], v[52:55], a[192:199], v5
 ds_read_b128 v[48:51], v0 offset:4096
 s_waitcnt lgkmcnt(4)
 v_cvt_pk_bf16_f32 v64, v64, v64
 v_and_or_b32 v65, v65, -2, s46
 v_smfmac_f32_16x16x64_bf16 v[20:23], v[56:59], v[12:19], v5
 ds_read_b128 v[12:15], v0 offset:8192
 buffer_store_dwordx2 v[64:65], v6, s[20:23], s62 offen
 v_add_f32 v68, v68, v70
 v_add_f32 v69, v69, v71
 v_smfmac_f32_16x16x64_bf16 v[28:31], v[52:55], a[200:207], v5
 ds_read_b128 v[16:19], v0 offset:12288
 s_waitcnt lgkmcnt(4)
 v_mov_b64 v[64:65], 0
 v_mov_b64 v[66:67], 0
 v_smfmac_f32_16x16x64_bf16 v[24:27], v[56:59], v[36:43], v5
 ds_read_b128 v[36:39], v0 offset:16384
 s_add_u32 s68, s68, s47
 v_add_f32 v20, v20, v22
 v_add_f32 v21, v21, v23
 v_cvt_pk_bf16_f32 v69, v69, v21
 v_smfmac_f32_16x16x64_bf16 v[32:35], v[52:55], a[208:215], v5
 ds_read_b128 v[40:43], v0 offset:20480
 s_waitcnt lgkmcnt(4)
 v_cvt_pk_bf16_f32 v68, v68, v20
 v_and_or_b32 v69, v69, -2, s46
 v_smfmac_f32_16x16x64_bf16 v[28:31], v[56:59], v[44:51], v5
 ds_read_b128 v[44:47], v0 offset:24576
 buffer_store_dwordx2 v[68:69], v6, s[20:23], s60 offen offset:0
 v_add_f32 v24, v24, v26
 v_add_f32 v25, v25, v27
 v_smfmac_f32_16x16x64_bf16 v[60:63], v[52:55], a[216:223], v5
 ds_read_b128 v[48:51], v0 offset:28672
 s_waitcnt lgkmcnt(4)
 v_mov_b64 v[20:21], 0
 v_mov_b64 v[22:23], 0
 v_smfmac_f32_16x16x64_bf16 v[32:35], v[56:59], v[12:19], v5
 s_add_u32 s36, s36, 1
 s_add_u32 s58, s36, 2
 v_add_f32 v28, v28, v30
 v_add_f32 v29, v29, v31
 v_cvt_pk_bf16_f32 v25, v25, v29
 v_smfmac_f32_16x16x64_bf16 v[64:67], v[52:55], a[224:231], v5
 s_waitcnt lgkmcnt(2)
 s_min_u32 s58, s58, 64
 v_cvt_pk_bf16_f32 v24, v24, v28
 v_and_or_b32 v25, v25, -2, s46
 v_smfmac_f32_16x16x64_bf16 v[60:63], v[56:59], v[36:43], v5
 buffer_store_dwordx2 v[24:25], v6, s[20:23], s60 offen offset:2048
 v_add_f32 v32, v32, v34
 v_smfmac_f32_16x16x64_bf16 v[20:23], v[52:55], a[232:239], v5
 s_waitcnt lgkmcnt(0)
 s_xor_b32 s44, s44, 0x80000
 v_add_f32 v33, v33, v35
 v_smfmac_f32_16x16x64_bf16 v[64:67], v[56:59], v[44:51], v5
 s_xor_b32 s45, s45, 0x80000
 s_xor_b32 s65, s65, 0x80000
 v_add_f32 v60, v60, v62
 v_add_f32 v61, v61, v63
 v_smfmac_f32_16x16x64_bf16 v[20:23], v[56:59], a[240:247], v5
 s_cmp_eq_u32 s4, 0
 v_cvt_pk_bf16_f32 v33, v33, v61
 v_cvt_pk_bf16_f32 v32, v32, v60
 v_and_or_b32 v33, v33, -2, s46
 buffer_store_dwordx2 v[32:33], v6, s[20:23], s61 offen offset:0
 v_add_f32 v64, v64, v66
 v_add_f32 v65, v65, v67
 s_nop 0
 v_add_f32 v20, v20, v22
 v_add_f32 v21, v21, v23
 v_cvt_pk_bf16_f32 v65, v65, v21
 v_cvt_pk_bf16_f32 v64, v64, v20
 v_and_or_b32 v65, v65, -2, s46
 buffer_store_dwordx2 v[64:65], v6, s[20:23], s61 offen offset:2048
 s_cbranch_scc1 LwH_82
 s_cmp_eq_u32 s4, 1
 s_cbranch_scc1 Lw_83
 s_cmp_eq_u32 s4, 2
 s_cbranch_scc1 Lw_84
 s_xor_b32 s66, s66, 0x80000
 s_xor_b32 s41, s41, 0x80000
 s_xor_b32 s43, s43, 0x80000
 v_mov_b32 v47, 0x3f80
 v_cndmask_b32 v47, v47, 1.0, s[32:33]
 v_cndmask_b32 v44, 0, v47, s[24:25]
 v_cndmask_b32 v45, 0, v47, s[26:27]
 v_cndmask_b32 v46, 0, v47, s[28:29]
 v_cndmask_b32 v47, 0, v47, s[30:31]
 v_bfe_u32 v52, v3, 8, 2
 v_bfe_u32 v58, v3, 2, 4
 v_lshl_or_b32 v52, v52, 4, v58
 v_and_b32 v58, 0xc0, v3
 v_lshl_or_b32 v52, v58, 24, v52
 v_subrev_u32 v0, 0x20000, v0
 v_mov_b32 v59, -1
 v_add_u32 v54, s42, v3
 v_add_u32 v58, s69, v9
 ds_read_b64 v[64:65], v58 offset:19456
 v_mov_b32 v66, v2
 v_mov_b32 v67, v4
 v_mov_b64 v[68:69], 0
 v_mov_b64 v[70:71], 0
 ds_read_b128 v[20:23], v0 offset:24576
 ds_read_b128 v[24:27], v0 offset:28672
 ds_read_b128 v[28:31], v0 offset:32768
 ds_read_b128 v[32:35], v0 offset:36864
 s_waitcnt vmcnt(0)
 buffer_load_dwordx4 v[36:39], v3, s[20:23], s39 offen offset:0 sc1
 buffer_load_dwordx4 v[40:43], v3, s[20:23], s39 offen offset:1024 sc1
 s_nop 15
 s_nop 10
 buffer_load_dwordx4 v[12:15], v3, s[20:23], s39 offen offset:0 sc1
 buffer_load_dwordx4 v[16:19], v3, s[20:23], s39 offen offset:1024 sc1
 s_waitcnt vmcnt(3)
 v_mfma_f32_16x16x32_bf16 v[48:51], v[44:47], v[36:39], 0
 s_waitcnt vmcnt(2)
 v_mfma_f32_16x16x32_bf16 v[48:51], v[44:47], v[40:43], v[48:51]
 v_bitop3_b32 v55, v37, v39, s46 bitop3:0x7e
 v_bitop3_b32 v56, v41, v43, s46 bitop3:0x7e
 v_bitop3_b32 v55, v55, 1, v56 bitop3:0xc8
 v_cmp_ne_u32 vcc, 0, v55
 s_nop 3
 v_add_f32_dpp v48, v48, v48 row_ror:4 row_mask:0xf bank_mask:0xf
 v_add_f32_dpp v49, v49, v49 row_ror:4 row_mask:0xf bank_mask:0xf
 s_cbranch_vccnz Lr2_86
 v_add_f32_dpp v48, v48, v48 row_ror:8 row_mask:0xf bank_mask:0xf
 v_add_f32_dpp v49, v49, v49 row_ror:8 row_mask:0xf bank_mask:0xf
 v_cvt_pk_bf16_f32 v48, v48, v49
 buffer_store_dword v48, v52, s[20:23], s44 offen
Lb1_87:
 buffer_store_dword v59, v52, s[20:23], s45 offen
 v_cmp_gt_u32 vcc, s58, v1
 v_mov_b64 v[36:37], 0
 v_mov_b64 v[38:39], 0
 v_mov_b64 v[40:41], 0
 v_mov_b64 v[42:43], 0
 v_mov_b64 v[44:45], 0
 v_mov_b64 v[46:47], 0
 v_mov_b64 v[48:49], 0
 v_mov_b64 v[50:51], 0
 s_bitcmp1_b32 vcc_hi, 31
 s_cbranch_scc1 Lfw_89
Lfok_88:
 v_lshl_add_u32 v1, v3, 3, s68
 v_cndmask_b32 v1, -16, v1, s[70:71]
 v_writelane_b32 v1, s56, 63
 v_min_u32 v6, 16, v0
 v_lshlrev_b32 v6, 24, v6
 s_max_u32 s47, s36, 1
 v_add_u32 v2, -1, s47
 s_add_u32 m0, s42, 0
 s_waitcnt vmcnt(0)
 s_cmp_lg_u32 s50, 0
 s_cbranch_scc1 Lsure_74
 s_nop 15
 s_nop 15
 s_nop 7
 s_branch LstepB_73
Lw_84:
 s_xor_b32 s66, s66, 0x80000
 s_xor_b32 s41, s41, 0x80000
 s_xor_b32 s43, s43, 0x80000
 v_mov_b32 v47, 0x3f80
 v_cndmask_b32 v47, v47, 1.0, s[32:33]
 v_cndmask_b32 v44, 0, v47, s[24:25]
 v_cndmask_b32 v45, 0, v47, s[26:27]
 v_cndmask_b32 v46, 0, v47, s[28:29]
 v_cndmask_b32 v47, 0, v47, s[30:31]
 v_bfe_u32 v52, v3, 8, 2
 v_bfe_u32 v58, v3, 2, 4
 v_lshl_or_b32 v52, v52, 4, v58
 v_and_b32 v58, 0xc0, v3
 v_lshl_or_b32 v52, v58, 24, v52
 v_subrev_u32 v0, 0x20000, v0
 v_mov_b32 v59, -1
 v_add_u32 v54, s42, v3
 v_add_u32 v58, s69, v9
 ds_read_b64 v[64:65], v58 offset:19456
 v_mov_b32 v66, v2
 v_mov_b32 v67, v4
 v_mov_b64 v[68:69], 0
 v_mov_b64 v[70:71], 0
 ds_read_b128 v[20:23], v0 offset:24576
 ds_read_b128 v[24:27], v0 offset:28672
 ds_read_b128 v[28:31], v0 offset:32768
 ds_read_b128 v[32:35], v0 offset:36864
 s_waitcnt vmcnt(1)
 buffer_load_dwordx4 v[36:39], v3, s[20:23], s39 offen offset:0 sc1
 buffer_load_dwordx4 v[40:43], v3, s[20:23], s39 offen offset:1024 sc1
 s_nop 15
 s_nop 10
 buffer_load_dwordx4 v[12:15], v3, s[20:23], s39 offen offset:0 sc1
 buffer_load_dwordx4 v[16:19], v3, s[20:23], s39 offen offset:1024 sc1
 s_waitcnt vmcnt(3)
 v_mfma_f32_16x16x32_bf16 v[48:51], v[44:47], v[36:39], 0
 s_waitcnt vmcnt(2)
 v_mfma_f32_16x16x32_bf16 v[48:51], v[44:47], v[40:43], v[48:51]
 v_bitop3_b32 v55, v37, v39, s46 bitop3:0x7e
 v_bitop3_b32 v56, v41, v43, s46 bitop3:0x7e
 v_bitop3_b32 v55, v55, 1, v56 bitop3:0xc8
 v_cmp_ne_u32 vcc, 0, v55
 s_nop 3
 v_add_f32_dpp v48, v48, v48 row_ror:4 row_mask:0xf bank_mask:0xf
 v_add_f32_dpp v49, v49, v49 row_ror:4 row_mask:0xf bank_mask:0xf
 s_cbranch_vccnz Lr2_92
 v_add_f32_dpp v48, v48, v48 row_ror:8 row_mask:0xf bank_mask:0xf
 v_add_f32_dpp v49, v49, v49 row_ror:8 row_mask:0xf bank_mask:0xf
 v_cvt_pk_bf16_f32 v48, v48, v49
 buffer_store_dword v48, v52, s[20:23], s44 offen
Lb1_93:
 buffer_store_dword v59, v52, s[20:23], s45 offen
 v_cmp_gt_u32 vcc, s58, v1
 v_mov_b64 v[36:37], 0
 v_mov_b64 v[38:39], 0
 v_mov_b64 v[40:41], 0
 v_mov_b64 v[42:43], 0
 v_mov_b64 v[44:45], 0
 v_mov_b64 v[46:47], 0
 v_mov_b64 v[48:49], 0
 v_mov_b64 v[50:51], 0
 s_bitcmp1_b32 vcc_hi, 31
 s_cbranch_scc1 Lfw_95
Lfok_94:
 v_lshl_add_u32 v1, v3, 3, s68
 v_cndmask_b32 v1, -16, v1, s[70:71]
 v_writelane_b32 v1, s56, 63
 v_min_u32 v6, 16, v0
 v_lshlrev_b32 v6, 24, v6
 s_max_u32 s47, s36, 1
 v_add_u32 v2, -1, s47
 s_add_u32 m0, s42, 0
 s_nop 4
 buffer_load_dwordx4 v[12:15], v3, s[20:23], s43 offen offset:0 sc1
 s_nop 15
 s_nop 7
Lp2_96:
 buffer_load_dwordx4 v[12:15], v3, s[20:23], s43 offen offset:0 sc1
 s_waitcnt vmcnt(1)
 v_max3_u32 v55, v12, v13, v14
 v_max_u32 v55, v55, v15
 ds_write_b128 v3, v[12:15] offset:8192
 v_cmpx_eq_u32 vcc, -1, v55
 s_cbranch_execz LstepB_73
 buffer_load_dwordx4 v[12:15], v3, s[20:23], s43 offen offset:0 sc1
 s_waitcnt vmcnt(1)
 v_max3_u32 v55, v12, v13, v14
 v_max_u32 v55, v55, v15
 ds_write_b128 v3, v[12:15] offset:8192
 v_cmpx_eq_u32 vcc, -1, v55
 s_cbranch_execz LstepB_73
 buffer_load_dwordx4 v[12:15], v3, s[20:23], s43 offen offset:0 sc1
 s_waitcnt vmcnt(1)
 v_max3_u32 v55, v12, v13, v14
 v_max_u32 v55, v55, v15
 ds_write_b128 v3, v[12:15] offset:8192
 v_cmpx_eq_u32 vcc, -1, v55
 s_cbranch_execz LstepB_73
 s_sub_u32 s54, s54, 1
 s_cbranch_scc0 Lp2_96
 s_endpgm
Lw_83:
 s_waitcnt vmcnt(2)
 buffer_load_dwordx4 v[36:39], v3, s[20:23], s39 offen offset:0 sc1
 buffer_load_dwordx4 v[40:43], v3, s[20:23], s39 offen offset:1024 sc1
 s_xor_b32 s66, s66, 0x80000
 s_xor_b32 s41, s41, 0x80000
 s_xor_b32 s43, s43, 0x80000
 v_mov_b32 v47, 0x3f80
 v_cndmask_b32 v47, v47, 1.0, s[32:33]
 v_cndmask_b32 v44, 0, v47, s[24:25]
 v_cndmask_b32 v45, 0, v47, s[26:27]
 v_cndmask_b32 v46, 0, v47, s[28:29]
 v_cndmask_b32 v47, 0, v47, s[30:31]
 v_bfe_u32 v52, v3, 8, 2
 v_bfe_u32 v58, v3, 2, 4
 v_lshl_or_b32 v52, v52, 4, v58
 v_and_b32 v58, 0xc0, v3
 v_lshl_or_b32 v52, v58, 24, v52
 v_subrev_u32 v0, 0x20000, v0
 v_mov_b32 v59, -1
 v_add_u32 v54, s42, v3
 v_add_u32 v58, s69, v9
 ds_read_b64 v[64:65], v58 offset:19456
 v_mov_b32 v66, v2
 v_mov_b32 v67, v4
 v_mov_b64 v[68:69], 0
 v_mov_b64 v[70:71], 0
 ds_read_b128 v[20:23], v0 offset:24576
 ds_read_b128 v[24:27], v0 offset:28672
 ds_read_b128 v[28:31], v0 offset:32768
 ds_read_b128 v[32:35], v0 offset:36864
 s_nop 3
 buffer_load_dwordx4 v[12:15], v3, s[20:23], s39 offen offset:0 sc1
 buffer_load_dwordx4 v[16:19], v3, s[20:23], s39 offen offset:1024 sc1
 s_waitcnt vmcnt(3)
 v_mfma_f32_16x16x32_bf16 v[48:51], v[44:47], v[36:39], 0
 s_waitcnt vmcnt(2)
 v_mfma_f32_16x16x32_bf16 v[48:51], v[44:47], v[40:43], v[48:51]
 v_bitop3_b32 v55, v37, v39, s46 bitop3:0x7e
 v_bitop3_b32 v56, v41, v43, s46 bitop3:0x7e
 v_bitop3_b32 v55, v55, 1, v56 bitop3:0xc8
 v_cmp_ne_u32 vcc, 0, v55
 s_nop 3
 v_add_f32_dpp v48, v48, v48 row_ror:4 row_mask:0xf bank_mask:0xf
 v_add_f32_dpp v49, v49, v49 row_ror:4 row_mask:0xf bank_mask:0xf
 s_cbranch_vccnz Lr2_98
 v_add_f32_dpp v48, v48, v48 row_ror:8 row_mask:0xf bank_mask:0xf
 v_add_f32_dpp v49, v49, v49 row_ror:8 row_mask:0xf bank_mask:0xf
 v_cvt_pk_bf16_f32 v48, v48, v49
 buffer_store_dword v48, v52, s[20:23], s44 offen
Lb1_99:
 buffer_store_dword v59, v52, s[20:23], s45 offen
 v_cmp_gt_u32 vcc, s58, v1
 v_mov_b64 v[36:37], 0
 v_mov_b64 v[38:39], 0
 v_mov_b64 v[40:41], 0
 v_mov_b64 v[42:43], 0
 v_mov_b64 v[44:45], 0
 v_mov_b64 v[46:47], 0
 v_mov_b64 v[48:49], 0
 v_mov_b64 v[50:51], 0
 s_bitcmp1_b32 vcc_hi, 31
 s_cbranch_scc1 Lfw_101
Lfok_100:
 v_lshl_add_u32 v1, v3, 3, s68
 v_cndmask_b32 v1, -16, v1, s[70:71]
 v_writelane_b32 v1, s56, 63
 v_min_u32 v6, 16, v0
 v_lshlrev_b32 v6, 24, v6
 s_max_u32 s47, s36, 1
 v_add_u32 v2, -1, s47
 s_nop 15
 s_nop 0
 buffer_load_dwordx4 v[12:15], v3, s[20:23], s41 offen offset:0 sc1
 buffer_load_dwordx4 v[16:19], v3, s[20:23], s41 offen offset:1024 sc1
 s_nop 15
 s_nop 7
Lp2_102:
 buffer_load_dwordx4 v[12:15], v3, s[20:23], s41 offen offset:0 sc1
 buffer_load_dwordx4 v[16:19], v3, s[20:23], s41 offen offset:1024 sc1
 s_waitcnt vmcnt(2)
 v_max3_u32 v55, v12, v13, v14
 v_max3_u32 v55, v55, v15, v16
 v_max3_u32 v55, v55, v17, v18
 v_max_u32 v55, v55, v19
 ds_write_b128 v54, v[12:15] offset:0
 ds_write_b128 v54, v[16:19] offset:1024
 v_cmpx_eq_u32 vcc, -1, v55
 s_cbranch_execz Lstep_71
 buffer_load_dwordx4 v[12:15], v3, s[20:23], s41 offen offset:0 sc1
 buffer_load_dwordx4 v[16:19], v3, s[20:23], s41 offen offset:1024 sc1
 s_waitcnt vmcnt(2)
 v_max3_u32 v55, v12, v13, v14
 v_max3_u32 v55, v55, v15, v16
 v_max3_u32 v55, v55, v17, v18
 v_max_u32 v55, v55, v19
 ds_write_b128 v54, v[12:15] offset:0
 ds_write_b128 v54, v[16:19] offset:1024
 v_cmpx_eq_u32 vcc, -1, v55
 s_cbranch_execz Lstep_71
 buffer_load_dwordx4 v[12:15], v3, s[20:23], s41 offen offset:0 sc1
 buffer_load_dwordx4 v[16:19], v3, s[20:23], s41 offen offset:1024 sc1
 s_waitcnt vmcnt(2)
 v_max3_u32 v55, v12, v13, v14
 v_max3_u32 v55, v55, v15, v16
 v_max3_u32 v55, v55, v17, v18
 v_max_u32 v55, v55, v19
 ds_write_b128 v54, v[12:15] offset:0
 ds_write_b128 v54, v[16:19] offset:1024
 v_cmpx_eq_u32 vcc, -1, v55
 s_cbranch_execz Lstep_71
 s_sub_u32 s54, s54, 1
 s_cbranch_scc0 Lp2_102
 s_endpgm
LwH_82:
 v_bfe_u32 v53, v3, 8, 1
 v_bfe_u32 v58, v3, 9, 1
 v_lshl_or_b32 v53, v53, 1, v58
 v_bfe_u32 v58, v3, 5, 1
 v_lshl_or_b32 v53, v53, 1, v58
 v_and_b32 v58, 0xd0, v3
 v_lshlrev_b32 v58, 24, v58
 v_lshl_or_b32 v53, v53, 2, v58
 s_waitcnt vmcnt(3)
 s_nop 7
 buffer_load_dwordx4 v[20:23], v3, s[20:23], s40 offen offset:0 sc1
 buffer_load_dwordx4 v[24:27], v3, s[20:23], s40 offen offset:1024 sc1
 buffer_load_dwordx4 v[36:39], v3, s[20:23], s39 offen offset:0 sc1
 buffer_load_dwordx4 v[40:43], v3, s[20:23], s39 offen offset:1024 sc1
 s_xor_b32 s66, s66, 0x80000
 s_xor_b32 s41, s41, 0x80000
 s_xor_b32 s43, s43, 0x80000
 v_mov_b32 v47, 0x3f80
 v_cndmask_b32 v47, v47, 1.0, s[32:33]
 v_cndmask_b32 v44, 0, v47, s[24:25]
 v_cndmask_b32 v45, 0, v47, s[26:27]
 v_cndmask_b32 v46, 0, v47, s[28:29]
 v_cndmask_b32 v47, 0, v47, s[30:31]
 v_bfe_u32 v52, v3, 8, 2
 v_bfe_u32 v58, v3, 2, 4
 v_lshl_or_b32 v52, v52, 4, v58
 v_and_b32 v58, 0xc0, v3
 v_lshl_or_b32 v52, v58, 24, v52
 v_subrev_u32 v0, 0x20000, v0
 v_mov_b32 v59, -1
 v_add_u32 v54, s42, v3
 v_add_u32 v58, s69, v9
 ds_read_b64 v[64:65], v58 offset:19456
 v_mov_b32 v66, v2
 v_mov_b32 v67, v4
 v_mov_b64 v[68:69], 0
 v_mov_b64 v[70:71], 0
 s_waitcnt vmcnt(2)
 v_mfma_f32_16x16x32_bf16 v[28:31], v[44:47], v[20:23], 0
 v_mfma_f32_16x16x32_bf16 v[28:31], v[44:47], v[24:27], v[28:31]
 s_waitcnt vmcnt(1)
 v_mfma_f32_16x16x32_bf16 v[48:51], v[44:47], v[36:39], 0
 s_waitcnt vmcnt(0)
 v_mfma_f32_16x16x32_bf16 v[48:51], v[44:47], v[40:43], v[48:51]
 v_bitop3_b32 v55, v37, v39, s46 bitop3:0x7e
 v_bitop3_b32 v56, v41, v43, s46 bitop3:0x7e
 v_bitop3_b32 v57, v21, v23, s46 bitop3:0x7e
 v_or3_b32 v55, v55, v56, v57
 v_bitop3_b32 v56, v25, v27, s46 bitop3:0x7e
 v_bitop3_b32 v55, v55, 1, v56 bitop3:0xc8
 v_cmp_ne_u32 vcc, 0, v55
 v_add_f32_dpp v29, v29, v29 row_ror:4 row_mask:0xf bank_mask:0xf
 v_add_f32_dpp v48, v48, v48 row_ror:4 row_mask:0xf bank_mask:0xf
 v_add_f32_dpp v49, v49, v49 row_ror:4 row_mask:0xf bank_mask:0xf
 v_add_f32_dpp v29, v29, v29 row_ror:8 row_mask:0xf bank_mask:0xf
 v_add_f32_dpp v48, v48, v48 row_ror:8 row_mask:0xf bank_mask:0xf
 v_add_f32_dpp v49, v49, v49 row_ror:8 row_mask:0xf bank_mask:0xf
 s_cbranch_vccnz Lr1_103
 v_cvt_pk_bf16_f32 v48, v48, v49
 buffer_store_dword v48, v52, s[20:23], s44 offen
 v_mov_b32_dpp v30, v29 quad_perm:[1,0,3,2] row_mask:0xf bank_mask:0xf
 v_cvt_pk_bf16_f32 v29, v29, v30
 buffer_store_dword v29, v53, s[20:23], s65 offen
Lb1_104:
 buffer_store_dword v59, v52, s[20:23], s45 offen
 buffer_store_dword v59, v53, s[20:23], s66 offen
 v_cmp_gt_u32 vcc, s58, v1
 ds_read_b128 v[20:23], v0 offset:24576
 ds_read_b128 v[24:27], v0 offset:28672
 ds_read_b128 v[28:31], v0 offset:32768
 ds_read_b128 v[32:35], v0 offset:36864
 v_mov_b64 v[36:37], 0
 v_mov_b64 v[38:39], 0
 v_mov_b64 v[40:41], 0
 v_mov_b64 v[42:43], 0
 v_mov_b64 v[44:45], 0
 v_mov_b64 v[46:47], 0
 v_mov_b64 v[48:49], 0
 v_mov_b64 v[50:51], 0
 s_bitcmp1_b32 vcc_hi, 31
 s_cbranch_scc1 Lfw_106
Lfok_105:
 v_lshl_add_u32 v1, v3, 3, s68
 v_cndmask_b32 v1, -16, v1, s[70:71]
 v_writelane_b32 v1, s56, 63
 v_min_u32 v6, 16, v0
 v_lshlrev_b32 v6, 24, v6
 s_max_u32 s47, s36, 1
 v_add_u32 v2, -1, s47
 s_nop 10
 buffer_load_dwordx4 v[12:15], v3, s[20:23], s41 offen offset:0 sc1
 buffer_load_dwordx4 v[16:19], v3, s[20:23], s41 offen offset:1024 sc1
 s_nop 15
 s_nop 7
Lp2_107:
 buffer_load_dwordx4 v[12:15], v3, s[20:23], s41 offen offset:0 sc1
 buffer_load_dwordx4 v[16:19], v3, s[20:23], s41 offen offset:1024 sc1
 s_waitcnt vmcnt(2)
 v_max3_u32 v55, v12, v13, v14
 v_max3_u32 v55, v55, v15, v16
 v_max3_u32 v55, v55, v17, v18
 v_max_u32 v55, v55, v19
 ds_write_b128 v54, v[12:15] offset:0
 ds_write_b128 v54, v[16:19] offset:1024
 v_cmpx_eq_u32 vcc, -1, v55
 s_cbranch_execz Lstep_71
 buffer_load_dwordx4 v[12:15], v3, s[20:23], s41 offen offset:0 sc1
 buffer_load_dwordx4 v[16:19], v3, s[20:23], s41 offen offset:1024 sc1
 s_waitcnt vmcnt(2)
 v_max3_u32 v55, v12, v13, v14
 v_max3_u32 v55, v55, v15, v16
 v_max3_u32 v55, v55, v17, v18
 v_max_u32 v55, v55, v19
 ds_write_b128 v54, v[12:15] offset:0
 ds_write_b128 v54, v[16:19] offset:1024
 v_cmpx_eq_u32 vcc, -1, v55
 s_cbranch_execz Lstep_71
 buffer_load_dwordx4 v[12:15], v3, s[20:23], s41 offen offset:0 sc1
 buffer_load_dwordx4 v[16:19], v3, s[20:23], s41 offen offset:1024 sc1
 s_waitcnt vmcnt(2)
 v_max3_u32 v55, v12, v13, v14
 v_max3_u32 v55, v55, v15, v16
 v_max3_u32 v55, v55, v17, v18
 v_max_u32 v55, v55, v19
 ds_write_b128 v54, v[12:15] offset:0
 ds_write_b128 v54, v[16:19] offset:1024
 v_cmpx_eq_u32 vcc, -1, v55
 s_cbranch_execz Lstep_71
 s_sub_u32 s54, s54, 1
 s_cbranch_scc0 Lp2_107
 s_endpgm
Lr1_103:
 s_mov_b64 exec, vcc
Lrt_108:
 buffer_load_dwordx4 v[20:23], v3, s[20:23], s40 offen offset:0 sc1
 buffer_load_dwordx4 v[24:27], v3, s[20:23], s40 offen offset:1024 sc1
 buffer_load_dwordx4 v[36:39], v3, s[20:23], s39 offen offset:0 sc1
 buffer_load_dwordx4 v[40:43], v3, s[20:23], s39 offen offset:1024 sc1
 s_waitcnt vmcnt(4)
 v_bitop3_b32 v55, v37, v39, s46 bitop3:0x7e
 v_bitop3_b32 v56, v41, v43, s46 bitop3:0x7e
 v_bitop3_b32 v57, v21, v23, s46 bitop3:0x7e
 v_or3_b32 v55, v55, v56, v57
 v_bitop3_b32 v56, v25, v27, s46 bitop3:0x7e
 v_bitop3_b32 v55, v55, 1, v56 bitop3:0xc8
 v_cmpx_ne_u32 vcc, 0, v55
 s_cbranch_execz Lrte_109
 buffer_load_dwordx4 v[20:23], v3, s[20:23], s40 offen offset:0 sc1
 buffer_load_dwordx4 v[24:27], v3, s[20:23], s40 offen offset:1024 sc1
 buffer_load_dwordx4 v[36:39], v3, s[20:23], s39 offen offset:0 sc1
 buffer_load_dwordx4 v[40:43], v3, s[20:23], s39 offen offset:1024 sc1
 s_waitcnt vmcnt(4)
 v_bitop3_b32 v55, v37, v39, s46 bitop3:0x7e
 v_bitop3_b32 v56, v41, v43, s46 bitop3:0x7e
 v_bitop3_b32 v57, v21, v23, s46 bitop3:0x7e
 v_or3_b32 v55, v55, v56, v57
 v_bitop3_b32 v56, v25, v27, s46 bitop3:0x7e
 v_bitop3_b32 v55, v55, 1, v56 bitop3:0xc8
 v_cmpx_ne_u32 vcc, 0, v55
 s_cbranch_execz Lrte_109
 buffer_load_dwordx4 v[20:23], v3, s[20:23], s40 offen offset:0 sc1
 buffer_load_dwordx4 v[24:27], v3, s[20:23], s40 offen offset:1024 sc1
 buffer_load_dwordx4 v[36:39], v3, s[20:23], s39 offen offset:0 sc1
 buffer_load_dwordx4 v[40:43], v3, s[20:23], s39 offen offset:1024 sc1
 s_waitcnt vmcnt(4)
 v_bitop3_b32 v55, v37, v39, s46 bitop3:0x7e
 v_bitop3_b32 v56, v41, v43, s46 bitop3:0x7e
 v_bitop3_b32 v57, v21, v23, s46 bitop3:0x7e
 v_or3_b32 v55, v55, v56, v57
 v_bitop3_b32 v56, v25, v27, s46 bitop3:0x7e
 v_bitop3_b32 v55, v55, 1, v56 bitop3:0xc8
 v_cmpx_ne_u32 vcc, 0, v55
 s_cbranch_execz Lrte_109
 s_sub_u32 s54, s54, 1
 s_cbranch_scc0 Lrt_108
 s_endpgm
Lrte_109:
 s_mov_b64 exec, -1
 s_nop 2
 v_mfma_f32_16x16x32_bf16 v[28:31], v[44:47], v[20:23], 0
 v_mfma_f32_16x16x32_bf16 v[28:31], v[44:47], v[24:27], v[28:31]
 v_mfma_f32_16x16x32_bf16 v[48:51], v[44:47], v[36:39], 0
 v_mfma_f32_16x16x32_bf16 v[48:51], v[44:47], v[40:43], v[48:51]
 s_nop 6
 v_add_f32_dpp v29, v29, v29 row_ror:4 row_mask:0xf bank_mask:0xf
 v_add_f32_dpp v48, v48, v48 row_ror:4 row_mask:0xf bank_mask:0xf
 v_add_f32_dpp v49, v49, v49 row_ror:4 row_mask:0xf bank_mask:0xf
 v_add_f32_dpp v29, v29, v29 row_ror:8 row_mask:0xf bank_mask:0xf
 v_add_f32_dpp v48, v48, v48 row_ror:8 row_mask:0xf bank_mask:0xf
 v_add_f32_dpp v49, v49, v49 row_ror:8 row_mask:0xf bank_mask:0xf
 v_cvt_pk_bf16_f32 v48, v48, v49
 buffer_store_dword v48, v52, s[20:23], s44 offen
 v_mov_b32_dpp v30, v29 quad_perm:[1,0,3,2] row_mask:0xf bank_mask:0xf
 v_cvt_pk_bf16_f32 v29, v29, v30
 buffer_store_dword v29, v53, s[20:23], s65 offen
 s_waitcnt vmcnt(2)
 s_branch Lb1_104
Lsure_74:
 s_mov_b32 s50, 0
 s_waitcnt lgkmcnt(0)
 buffer_load_dwordx4 v[12:15], v3, s[20:23], s41 offen offset:0 sc1
 buffer_load_dwordx4 v[16:19], v3, s[20:23], s41 offen offset:1024 sc1
 s_sub_u32 s54, s54, 1
 s_cbranch_scc1 Lfail_72
 s_waitcnt vmcnt(0)
 v_max3_u32 v4, v12, v13, v14
 v_max3_u32 v4, v4, v15, v16
 v_max3_u32 v4, v4, v17, v18
 v_max_u32 v4, v4, v19
 v_cmp_eq_u32 vcc, -1, v4
 s_cbranch_vccnz Lsure_74
 s_branch Lsureb_75
Lfx_76:
 s_add_u32 s47, s43, -4096
 buffer_load_dwordx4 v[60:63], v3, s[20:23], s47 offen offset:0 sc1
 buffer_load_dwordx4 v[52:55], v3, s[20:23], s47 offen offset:1024 sc1
 s_sub_u32 s54, s54, 1
 s_cbranch_scc1 Lfail_72
 s_waitcnt vmcnt(0)
 v_max3_u32 v4, v60, v61, v62
 v_max3_u32 v4, v4, v63, v52
 v_max3_u32 v4, v4, v53, v54
 v_max_u32 v4, v4, v55
 v_cmp_eq_u32 vcc, -1, v4
 s_cbranch_vccnz Lfx_76
 ds_write_b128 v3, v[60:63] offset:4096
 s_waitcnt lgkmcnt(0)
 s_branch Lfxb_77
Lfx_78:
 s_add_u32 s47, s43, -2048
 buffer_load_dwordx4 v[56:59], v3, s[20:23], s47 offen offset:0 sc1
 buffer_load_dwordx4 v[60:63], v3, s[20:23], s47 offen offset:1024 sc1
 s_sub_u32 s54, s54, 1
 s_cbranch_scc1 Lfail_72
 s_waitcnt vmcnt(0)
 v_max3_u32 v4, v56, v57, v58
 v_max3_u32 v4, v4, v59, v60
 v_max3_u32 v4, v4, v61, v62
 v_max_u32 v4, v4, v63
 v_cmp_eq_u32 vcc, -1, v4
 s_cbranch_vccnz Lfx_78
 ds_write_b128 v3, v[56:59] offset:6144
 s_waitcnt lgkmcnt(0)
 s_branch Lfxb_79
Lmx_80:
 s_waitcnt lgkmcnt(0)
 ds_read_b128 v[36:39], v11 offset:17408
 ds_read_b128 v[40:43], v11 offset:17920
 ds_read_b128 v[44:47], v11 offset:18432
 ds_read_b128 v[48:51], v11 offset:18944
 v_mov_b64 v[28:29], 0
 v_mov_b64 v[30:31], 0
 ds_read_b128 v[52:55], v3 offset:9216
 ds_read_b128 v[56:59], v3 offset:10240
 s_waitcnt lgkmcnt(0)
 v_mfma_f32_16x16x32_bf16 v[20:23], v[52:55], v[36:39], 0
 v_mfma_f32_16x16x32_bf16 v[24:27], v[56:59], v[36:39], 0
 ds_read_b128 v[52:55], v3 offset:11264
 ds_read_b128 v[56:59], v3 offset:12288
 s_waitcnt lgkmcnt(0)
 v_mfma_f32_16x16x32_bf16 v[20:23], v[52:55], v[40:43], v[20:23]
 v_mfma_f32_16x16x32_bf16 v[24:27], v[56:59], v[40:43], v[24:27]
 ds_read_b128 v[52:55], v3 offset:13312
 ds_read_b128 v[56:59], v3 offset:14336
 s_waitcnt lgkmcnt(0)
 v_mfma_f32_16x16x32_bf16 v[20:23], v[52:55], v[44:47], v[20:23]
 v_mfma_f32_16x16x32_bf16 v[24:27], v[56:59], v[44:47], v[24:27]
 ds_read_b128 v[52:55], v3 offset:15360
 ds_read_b128 v[56:59], v3 offset:16384
 s_waitcnt lgkmcnt(0)
 v_mfma_f32_16x16x32_bf16 v[20:23], v[52:55], v[48:51], v[20:23]
 v_mfma_f32_16x16x32_bf16 v[24:27], v[56:59], v[48:51], v[24:27]
 ds_read_b128 v[52:55], v9 offset:19456
 ds_read_b128 v[56:59], v9 offset:21504
 s_waitcnt lgkmcnt(0)
 v_smfmac_f32_16x16x64_bf16 v[28:31], v[52:55], v[36:43], v5
 v_smfmac_f32_16x16x64_bf16 v[28:31], v[56:59], v[44:51], v5
 ds_read_b128 v[36:39], v0 offset:32768
 ds_read_b128 v[40:43], v0 offset:36864
 ds_read_b128 v[44:47], v0 offset:40960
 ds_read_b128 v[48:51], v0 offset:45056
 v_mov_b64 v[32:33], s[34:35]
 v_mov_b64 v[34:35], s[34:35]
 s_nop 1
 v_add_f32 v28, v28, v30
 v_add_f32 v29, v29, v31
 v_mul_f32 v28, s55, v28
 v_mul_f32 v29, s55, v29
 v_max_f32 v30, v28, v29
 v_cndmask_b32 v28, v28, v29, s[48:49]
 v_max3_f32 v30, v30, v20, v21
 v_max3_f32 v30, v30, v22, v23
 v_max3_f32 v30, v30, v24, v25
 v_max3_f32 v31, v30, v26, v27
 v_max3_f32 v29, v30, v26, v27
 v_cndmask_b32 v20, v20, v24, s[48:49]
 v_cndmask_b32 v21, v21, v25, s[48:49]
 v_permlane16_swap_b32 v31, v29
 v_max_f32 v30, v31, v29
 v_max_f32 v6, v31, v29
 v_cndmask_b32 v22, v22, v26, s[48:49]
 v_cndmask_b32 v23, v23, v27, s[48:49]
 v_permlane32_swap_b32 v30, v6
 v_max_f32 v30, v30, v6
 v_sub_f32 v28, v28, v30
 v_sub_f32 v20, v20, v30
 v_sub_f32 v21, v21, v30
 v_sub_f32 v22, v22, v30
 v_sub_f32 v23, v23, v30
 v_exp_f32 v28, v28
 v_exp_f32 v20, v20
 v_exp_f32 v21, v21
 v_exp_f32 v22, v22
 v_exp_f32 v23, v23
 v_cndmask_b32 v29, 0, v28, s[48:49]
 v_cndmask_b32 v28, v28, 0, s[48:49]
 v_cvt_pk_bf16_f32 v6, v28, v29
 v_cvt_pk_bf16_f32 v30, v20, v21
 v_cvt_pk_bf16_f32 v31, v22, v23
 v_mfma_f32_16x16x16_bf16 v[60:63], v[6:7], v[32:33], 0
 v_mfma_f32_16x16x16_bf16 v[52:55], v[6:7], v[2:3], 0
 v_mfma_f32_16x16x16_bf16 v[56:59], v[6:7], v[4:5], 0
 v_smfmac_f32_16x16x32_bf16 v[60:63], v[30:31], v[32:35], v5
 v_smfmac_f32_16x16x32_bf16 v[52:55], v[30:31], v[12:15], v5
 v_smfmac_f32_16x16x32_bf16 v[56:59], v[30:31], v[16:19], v5
 s_nop 0
 v_add_f32 v60, v60, v62
 v_add_f32 v61, v61, v63
 v_rcp_f32 v60, v60
 v_rcp_f32 v61, v61
 v_add_f32 v52, v52, v54
 v_add_f32 v53, v53, v55
 v_mul_f32 v52, v52, v60
 v_mul_f32 v53, v53, v61
 v_add_f32 v56, v56, v58
 v_add_f32 v57, v57, v59
 v_mul_f32 v56, v56, v60
 v_mul_f32 v57, v57, v61
 v_cvt_pk_bf16_f32 v52, v52, v56
 v_cvt_pk_bf16_f32 v53, v53, v57
 ds_write2_b32 v8, v52, v53 offset0:128 offset1:144
 v_mov_b64 v[20:21], 0
 v_mov_b64 v[22:23], 0
 v_mov_b64 v[24:25], 0
 v_mov_b64 v[26:27], 0
 v_mov_b64 v[28:29], 0
 v_mov_b64 v[30:31], 0
 v_mov_b64 v[32:33], 0
 v_mov_b64 v[34:35], 0
 s_waitcnt lgkmcnt(0)
 s_branch Lmxb_81
Lr2_86:
 s_waitcnt vmcnt(1)
 v_mfma_f32_16x16x32_bf16 v[48:51], v[44:47], v[12:15], 0
 s_waitcnt vmcnt(0)
 v_mfma_f32_16x16x32_bf16 v[48:51], v[44:47], v[16:19], v[48:51]
 v_bitop3_b32 v55, v13, v15, s46 bitop3:0x7e
 v_bitop3_b32 v56, v17, v19, s46 bitop3:0x7e
 v_bitop3_b32 v55, v55, 1, v56 bitop3:0xc8
 v_cmp_ne_u32 vcc, 0, v55
 s_nop 3
 v_add_f32_dpp v48, v48, v48 row_ror:4 row_mask:0xf bank_mask:0xf
 v_add_f32_dpp v49, v49, v49 row_ror:4 row_mask:0xf bank_mask:0xf
 s_cbranch_vccnz Lr1_85
 v_add_f32_dpp v48, v48, v48 row_ror:8 row_mask:0xf bank_mask:0xf
 v_add_f32_dpp v49, v49, v49 row_ror:8 row_mask:0xf bank_mask:0xf
 v_cvt_pk_bf16_f32 v48, v48, v49
 buffer_store_dword v48, v52, s[20:23], s44 offen
 s_branch Lb1_87
Lr1_85:
 s_mov_b64 exec, vcc
Lrt_110:
 buffer_load_dwordx4 v[12:15], v3, s[20:23], s39 offen offset:0 sc1
 buffer_load_dwordx4 v[16:19], v3, s[20:23], s39 offen offset:1024 sc1
 s_waitcnt vmcnt(2)
 v_bitop3_b32 v55, v13, v15, s46 bitop3:0x7e
 v_bitop3_b32 v56, v17, v19, s46 bitop3:0x7e
 v_bitop3_b32 v55, v55, 1, v56 bitop3:0xc8
 v_cmpx_ne_u32 vcc, 0, v55
 s_cbranch_execz Lrte_111
 buffer_load_dwordx4 v[12:15], v3, s[20:23], s39 offen offset:0 sc1
 buffer_load_dwordx4 v[16:19], v3, s[20:23], s39 offen offset:1024 sc1
 s_waitcnt vmcnt(2)
 v_bitop3_b32 v55, v13, v15, s46 bitop3:0x7e
 v_bitop3_b32 v56, v17, v19, s46 bitop3:0x7e
 v_bitop3_b32 v55, v55, 1, v56 bitop3:0xc8
 v_cmpx_ne_u32 vcc, 0, v55
 s_cbranch_execz Lrte_111
 buffer_load_dwordx4 v[12:15], v3, s[20:23], s39 offen offset:0 sc1
 buffer_load_dwordx4 v[16:19], v3, s[20:23], s39 offen offset:1024 sc1
 s_waitcnt vmcnt(2)
 v_bitop3_b32 v55, v13, v15, s46 bitop3:0x7e
 v_bitop3_b32 v56, v17, v19, s46 bitop3:0x7e
 v_bitop3_b32 v55, v55, 1, v56 bitop3:0xc8
 v_cmpx_ne_u32 vcc, 0, v55
 s_cbranch_execz Lrte_111
 s_sub_u32 s54, s54, 1
 s_cbranch_scc0 Lrt_110
 s_endpgm
Lrte_111:
 s_mov_b64 exec, -1
 s_mov_b32 s50, 0
 s_nop 1
 v_mfma_f32_16x16x32_bf16 v[48:51], v[44:47], v[12:15], 0
 v_mfma_f32_16x16x32_bf16 v[48:51], v[44:47], v[16:19], v[48:51]
 s_nop 7
 v_add_f32_dpp v48, v48, v48 row_ror:4 row_mask:0xf bank_mask:0xf
 v_add_f32_dpp v49, v49, v49 row_ror:4 row_mask:0xf bank_mask:0xf
 s_nop 0
 v_add_f32_dpp v48, v48, v48 row_ror:8 row_mask:0xf bank_mask:0xf
 v_add_f32_dpp v49, v49, v49 row_ror:8 row_mask:0xf bank_mask:0xf
 v_cvt_pk_bf16_f32 v48, v48, v49
 buffer_store_dword v48, v52, s[20:23], s44 offen
 s_branch Lb1_87
Lr2_92:
 s_waitcnt vmcnt(1)
 v_mfma_f32_16x16x32_bf16 v[48:51], v[44:47], v[12:15], 0
 s_waitcnt vmcnt(0)
 v_mfma_f32_16x16x32_bf16 v[48:51], v[44:47], v[16:19], v[48:51]
 v_bitop3_b32 v55, v13, v15, s46 bitop3:0x7e
 v_bitop3_b32 v56, v17, v19, s46 bitop3:0x7e
 v_bitop3_b32 v55, v55, 1, v56 bitop3:0xc8
 v_cmp_ne_u32 vcc, 0, v55
 s_nop 3
 v_add_f32_dpp v48, v48, v48 row_ror:4 row_mask:0xf bank_mask:0xf
 v_add_f32_dpp v49, v49, v49 row_ror:4 row_mask:0xf bank_mask:0xf
 s_cbranch_vccnz Lr1_91
 v_add_f32_dpp v48, v48, v48 row_ror:8 row_mask:0xf bank_mask:0xf
 v_add_f32_dpp v49, v49, v49 row_ror:8 row_mask:0xf bank_mask:0xf
 v_cvt_pk_bf16_f32 v48, v48, v49
 buffer_store_dword v48, v52, s[20:23], s44 offen
 s_branch Lb1_93
Lr1_91:
 s_mov_b64 exec, vcc
Lrt_112:
 buffer_load_dwordx4 v[12:15], v3, s[20:23], s39 offen offset:0 sc1
 buffer_load_dwordx4 v[16:19], v3, s[20:23], s39 offen offset:1024 sc1
 s_waitcnt vmcnt(2)
 v_bitop3_b32 v55, v13, v15, s46 bitop3:0x7e
 v_bitop3_b32 v56, v17, v19, s46 bitop3:0x7e
 v_bitop3_b32 v55, v55, 1, v56 bitop3:0xc8
 v_cmpx_ne_u32 vcc, 0, v55
 s_cbranch_execz Lrte_113
 buffer_load_dwordx4 v[12:15], v3, s[20:23], s39 offen offset:0 sc1
 buffer_load_dwordx4 v[16:19], v3, s[20:23], s39 offen offset:1024 sc1
 s_waitcnt vmcnt(2)
 v_bitop3_b32 v55, v13, v15, s46 bitop3:0x7e
 v_bitop3_b32 v56, v17, v19, s46 bitop3:0x7e
 v_bitop3_b32 v55, v55, 1, v56 bitop3:0xc8
 v_cmpx_ne_u32 vcc, 0, v55
 s_cbranch_execz Lrte_113
 buffer_load_dwordx4 v[12:15], v3, s[20:23], s39 offen offset:0 sc1
 buffer_load_dwordx4 v[16:19], v3, s[20:23], s39 offen offset:1024 sc1
 s_waitcnt vmcnt(2)
 v_bitop3_b32 v55, v13, v15, s46 bitop3:0x7e
 v_bitop3_b32 v56, v17, v19, s46 bitop3:0x7e
 v_bitop3_b32 v55, v55, 1, v56 bitop3:0xc8
 v_cmpx_ne_u32 vcc, 0, v55
 s_cbranch_execz Lrte_113
 s_sub_u32 s54, s54, 1
 s_cbranch_scc0 Lrt_112
 s_endpgm
Lrte_113:
 s_mov_b64 exec, -1
 s_mov_b32 s50, 0
 s_nop 1
 v_mfma_f32_16x16x32_bf16 v[48:51], v[44:47], v[12:15], 0
 v_mfma_f32_16x16x32_bf16 v[48:51], v[44:47], v[16:19], v[48:51]
 s_nop 7
 v_add_f32_dpp v48, v48, v48 row_ror:4 row_mask:0xf bank_mask:0xf
 v_add_f32_dpp v49, v49, v49 row_ror:4 row_mask:0xf bank_mask:0xf
 s_nop 0
 v_add_f32_dpp v48, v48, v48 row_ror:8 row_mask:0xf bank_mask:0xf
 v_add_f32_dpp v49, v49, v49 row_ror:8 row_mask:0xf bank_mask:0xf
 v_cvt_pk_bf16_f32 v48, v48, v49
 buffer_store_dword v48, v52, s[20:23], s44 offen
 s_branch Lb1_93
Lr2_98:
 s_waitcnt vmcnt(1)
 v_mfma_f32_16x16x32_bf16 v[48:51], v[44:47], v[12:15], 0
 s_waitcnt vmcnt(0)
 v_mfma_f32_16x16x32_bf16 v[48:51], v[44:47], v[16:19], v[48:51]
 v_bitop3_b32 v55, v13, v15, s46 bitop3:0x7e
 v_bitop3_b32 v56, v17, v19, s46 bitop3:0x7e
 v_bitop3_b32 v55, v55, 1, v56 bitop3:0xc8
 v_cmp_ne_u32 vcc, 0, v55
 s_nop 3
 v_add_f32_dpp v48, v48, v48 row_ror:4 row_mask:0xf bank_mask:0xf
 v_add_f32_dpp v49, v49, v49 row_ror:4 row_mask:0xf bank_mask:0xf
 s_cbranch_vccnz Lr1_97
 v_add_f32_dpp v48, v48, v48 row_ror:8 row_mask:0xf bank_mask:0xf
 v_add_f32_dpp v49, v49, v49 row_ror:8 row_mask:0xf bank_mask:0xf
 v_cvt_pk_bf16_f32 v48, v48, v49
 buffer_store_dword v48, v52, s[20:23], s44 offen
 s_branch Lb1_99
Lr1_97:
 s_mov_b64 exec, vcc
Lrt_114:
 buffer_load_dwordx4 v[12:15], v3, s[20:23], s39 offen offset:0 sc1
 buffer_load_dwordx4 v[16:19], v3, s[20:23], s39 offen offset:1024 sc1
 s_waitcnt vmcnt(2)
 v_bitop3_b32 v55, v13, v15, s46 bitop3:0x7e
 v_bitop3_b32 v56, v17, v19, s46 bitop3:0x7e
 v_bitop3_b32 v55, v55, 1, v56 bitop3:0xc8
 v_cmpx_ne_u32 vcc, 0, v55
 s_cbranch_execz Lrte_115
 buffer_load_dwordx4 v[12:15], v3, s[20:23], s39 offen offset:0 sc1
 buffer_load_dwordx4 v[16:19], v3, s[20:23], s39 offen offset:1024 sc1
 s_waitcnt vmcnt(2)
 v_bitop3_b32 v55, v13, v15, s46 bitop3:0x7e
 v_bitop3_b32 v56, v17, v19, s46 bitop3:0x7e
 v_bitop3_b32 v55, v55, 1, v56 bitop3:0xc8
 v_cmpx_ne_u32 vcc, 0, v55
 s_cbranch_execz Lrte_115
 buffer_load_dwordx4 v[12:15], v3, s[20:23], s39 offen offset:0 sc1
 buffer_load_dwordx4 v[16:19], v3, s[20:23], s39 offen offset:1024 sc1
 s_waitcnt vmcnt(2)
 v_bitop3_b32 v55, v13, v15, s46 bitop3:0x7e
 v_bitop3_b32 v56, v17, v19, s46 bitop3:0x7e
 v_bitop3_b32 v55, v55, 1, v56 bitop3:0xc8
 v_cmpx_ne_u32 vcc, 0, v55
 s_cbranch_execz Lrte_115
 s_sub_u32 s54, s54, 1
 s_cbranch_scc0 Lrt_114
 s_endpgm
Lrte_115:
 s_mov_b64 exec, -1
 s_mov_b32 s50, 0
 s_nop 1
 v_mfma_f32_16x16x32_bf16 v[48:51], v[44:47], v[12:15], 0
 v_mfma_f32_16x16x32_bf16 v[48:51], v[44:47], v[16:19], v[48:51]
 s_nop 7
 v_add_f32_dpp v48, v48, v48 row_ror:4 row_mask:0xf bank_mask:0xf
 v_add_f32_dpp v49, v49, v49 row_ror:4 row_mask:0xf bank_mask:0xf
 s_nop 0
 v_add_f32_dpp v48, v48, v48 row_ror:8 row_mask:0xf bank_mask:0xf
 v_add_f32_dpp v49, v49, v49 row_ror:8 row_mask:0xf bank_mask:0xf
 v_cvt_pk_bf16_f32 v48, v48, v49
 buffer_store_dword v48, v52, s[20:23], s44 offen
 s_branch Lb1_99
Lfw_89:
Lpb_116:
 buffer_load_dword v1, v7, s[20:23], s56 offen sc1
 s_waitcnt vmcnt(0)
 v_cmp_le_u32 vcc, s58, v1
 s_cbranch_vccnz Lpbok_117
 s_sub_u32 s54, s54, 1
 s_cbranch_scc0 Lpb_116
 s_endpgm
Lpbok_117:
 s_branch Lfok_88
Lfw_95:
Lpb_118:
 buffer_load_dword v1, v7, s[20:23], s56 offen sc1
 s_waitcnt vmcnt(0)
 v_cmp_le_u32 vcc, s58, v1
 s_cbranch_vccnz Lpbok_119
 s_sub_u32 s54, s54, 1
 s_cbranch_scc0 Lpb_118
 s_endpgm
Lpbok_119:
 s_branch Lfok_94
Lfw_101:
Lpb_120:
 buffer_load_dword v1, v7, s[20:23], s56 offen sc1
 s_waitcnt vmcnt(0)
 v_cmp_le_u32 vcc, s58, v1
 s_cbranch_vccnz Lpbok_121
 s_sub_u32 s54, s54, 1
 s_cbranch_scc0 Lpb_120
 s_endpgm
Lpbok_121:
 s_branch Lfok_100
Lfw_106:
Lpb_122:
 buffer_load_dword v1, v7, s[20:23], s56 offen sc1
 s_waitcnt vmcnt(0)
 v_cmp_le_u32 vcc, s58, v1
 s_cbranch_vccnz Lpbok_123
 s_sub_u32 s54, s54, 1
 s_cbranch_scc0 Lpb_122
 s_endpgm
Lpbok_123:
 s_branch Lfok_105
Lfail_72:
 s_endpgm
Lslow_69:
 s_branch Lstep_124
 .p2align 3
LstepB_126:
 s_mov_b64 exec, -1
 s_cmp_lg_u32 s50, 0
 s_cbranch_scc1 Lsure_127
Lsureb_128:
 buffer_load_dwordx4 v3, s[20:23], s41 offen offset:0 sc1 lds
 buffer_load_dwordx4 v3, s[20:23], s41 offen offset:1024 sc1 lds
Lstep_124:
 s_mov_b64 exec, -1
 s_waitcnt lgkmcnt(0)
 buffer_load_dwordx4 v[12:15], v3, s[20:23], s59 offen offset:0 sc1
 buffer_load_dwordx4 v[16:19], v3, s[20:23], s59 offen offset:1024 sc1
 s_barrier
 ds_read_b128 v[52:55], v3 offset:8192
 ds_read_b128 v[56:59], v3 offset:0
 ds_read_b128 v[60:63], v3 offset:1024
 buffer_store_dwordx4 v[64:67], v0, s[20:23], s38 offen sc1
 s_waitcnt lgkmcnt(2)
 v_smfmac_f32_16x16x64_bf16 v[36:39], v[52:55], a[136:143], v5
 v_smfmac_f32_16x16x64_bf16 v[40:43], v[52:55], a[144:151], v5
 buffer_store_dword v2, v6, s[20:23], s57 offen sc1
 v_smfmac_f32_16x16x64_bf16 v[44:47], v[52:55], a[152:159], v5
 s_waitcnt lgkmcnt(1)
 v_smfmac_f32_16x16x64_bf16 v[48:51], v[52:55], v[20:27], v5
 buffer_load_dword v1, v1, s[20:23], 0 offen sc1
 v_smfmac_f32_16x16x64_bf16 v[36:39], v[56:59], v[72:79], v5
 ds_read_b128 v[20:23], v0 offset:40960
 v_mov_b64 v[64:65], 0
 v_smfmac_f32_16x16x64_bf16 v[40:43], v[56:59], v[80:87], v5
 ds_read_b128 v[24:27], v0 offset:45056
 v_mov_b64 v[66:67], 0
 v_smfmac_f32_16x16x64_bf16 v[44:47], v[56:59], v[88:95], v5
 ds_read_b128 v[52:55], v3 offset:2048
 s_waitcnt lgkmcnt(3)
 v_smfmac_f32_16x16x64_bf16 v[48:51], v[56:59], v[28:35], v5
 v_smfmac_f32_16x16x64_bf16 v[36:39], v[60:63], v[112:119], v5
 ds_read_b128 v[28:31], v0 offset:49152
 v_smfmac_f32_16x16x64_bf16 v[40:43], v[60:63], v[120:127], v5
 ds_read_b128 v[32:35], v0 offset:53248
 v_smfmac_f32_16x16x64_bf16 v[44:47], v[60:63], v[128:135], v5
 ds_read_b128 v[56:59], v3 offset:3072
 v_smfmac_f32_16x16x64_bf16 v[64:67], v[60:63], v[136:143], v5
 s_waitcnt vmcnt(5)
 v_smfmac_f32_16x16x64_bf16 v[68:71], v[60:63], v[144:151], v5
 s_waitcnt lgkmcnt(3)
 v_smfmac_f32_16x16x64_bf16 v[48:51], v[60:63], v[20:27], v5
 s_barrier
 v_smfmac_f32_16x16x64_bf16 v[36:39], v[52:55], v[152:159], v5
 ds_read_b128 v[20:23], v0 offset:57344
 v_smfmac_f32_16x16x64_bf16 v[40:43], v[52:55], v[160:167], v5
 ds_read_b128 v[24:27], v0 offset:61440
 v_smfmac_f32_16x16x64_bf16 v[44:47], v[52:55], v[168:175], v5
 ds_read_b128 v[60:63], v3 offset:4096
 v_smfmac_f32_16x16x64_bf16 v[64:67], v[52:55], v[176:183], v5
 v_smfmac_f32_16x16x64_bf16 v[68:71], v[52:55], v[184:191], v5
 s_waitcnt lgkmcnt(3)
 v_add_u32 v0, 0x10000, v0
 v_smfmac_f32_16x16x64_bf16 v[48:51], v[52:55], v[28:35], v5
 ds_read_b128 v[52:55], v3 offset:5120
 v_smfmac_f32_16x16x64_bf16 v[36:39], v[56:59], v[192:199], v5
 ds_read_b128 v[28:31], v0 offset:0
 v_smfmac_f32_16x16x64_bf16 v[40:43], v[56:59], v[200:207], v5
 ds_read_b128 v[32:35], v0 offset:4096
 v_smfmac_f32_16x16x64_bf16 v[44:47], v[56:59], v[208:215], v5
 v_smfmac_f32_16x16x64_bf16 v[64:67], v[56:59], v[216:223], v5
 s_waitcnt lgkmcnt(2)
 v_max3_u32 v4, v60, v61, v62
 v_max3_u32 v4, v4, v63, v52
 v_max3_u32 v4, v4, v53, v54
 v_max_u32 v4, v4, v55
 v_cmp_eq_u32 vcc, -1, v4
 v_smfmac_f32_16x16x64_bf16 v[68:71], v[56:59], v[224:231], v5
 v_smfmac_f32_16x16x64_bf16 v[48:51], v[56:59], v[20:27], v5
 ds_read_b128 v[56:59], v3 offset:6144
 s_cbranch_vccnz Lfx_129
Lfxb_130:
 v_smfmac_f32_16x16x64_bf16 v[36:39], v[60:63], v[232:239], v5
 ds_read_b128 v[20:23], v0 offset:8192
 v_smfmac_f32_16x16x64_bf16 v[40:43], v[60:63], v[240:247], v5
 ds_read_b128 v[24:27], v0 offset:12288
 v_smfmac_f32_16x16x64_bf16 v[44:47], v[60:63], v[248:255], v5
 s_waitcnt lgkmcnt(3)
 v_smfmac_f32_16x16x64_bf16 v[48:51], v[60:63], v[28:35], v5
 ds_read_b128 v[60:63], v3 offset:7168
 v_smfmac_f32_16x16x64_bf16 v[36:39], v[52:55], a[16:23], v5
 ds_read_b128 v[28:31], v0 offset:16384
 v_smfmac_f32_16x16x64_bf16 v[40:43], v[52:55], a[24:31], v5
 ds_read_b128 v[32:35], v0 offset:20480
 v_smfmac_f32_16x16x64_bf16 v[44:47], v[52:55], a[32:39], v5
 s_waitcnt lgkmcnt(3)
 v_smfmac_f32_16x16x64_bf16 v[48:51], v[52:55], v[20:27], v5
 s_waitcnt lgkmcnt(2)
 v_max3_u32 v4, v56, v57, v58
 v_max3_u32 v4, v4, v59, v60
 v_max3_u32 v4, v4, v61, v62
 v_max_u32 v4, v4, v63
 v_cmp_eq_u32 vcc, -1, v4
 v_smfmac_f32_16x16x64_bf16 v[64:67], v[52:55], a[40:47], v5
 ds_read_b128 v[20:23], v0 offset:24576
 v_smfmac_f32_16x16x64_bf16 v[68:71], v[52:55], a[48:55], v5
 s_cbranch_vccnz Lfx_131
Lfxb_132:
 v_smfmac_f32_16x16x64_bf16 v[36:39], v[56:59], a[56:63], v5
 ds_read_b128 v[24:27], v0 offset:28672
 v_smfmac_f32_16x16x64_bf16 v[40:43], v[56:59], a[64:71], v5
 ds_read_b128 v[52:55], v3 offset:8192
 v_smfmac_f32_16x16x64_bf16 v[36:39], v[60:63], a[96:103], v5
 v_smfmac_f32_16x16x64_bf16 v[40:43], v[60:63], a[104:111], v5
 v_smfmac_f32_16x16x64_bf16 v[44:47], v[56:59], a[72:79], v5
 s_waitcnt lgkmcnt(1)
 v_add_f32 v36, v36, v38
 v_add_f32 v37, v37, v39
 v_smfmac_f32_16x16x64_bf16 v[48:51], v[56:59], v[28:35], v5
 ds_read_b128 v[32:35], v3 offset:11264
 v_add_f32 v40, v40, v42
 v_add_f32 v41, v41, v43
 v_smfmac_f32_16x16x64_bf16 v[44:47], v[60:63], a[112:119], v5
 v_cvt_pk_bf16_f32 v36, v36, v40
 v_cvt_pk_bf16_f32 v37, v37, v41
 v_smfmac_f32_16x16x64_bf16 v[48:51], v[60:63], v[20:27], v5
 ds_write2_b32 v10, v36, v37 offset0:0 offset1:16
 v_smfmac_f32_16x16x64_bf16 v[64:67], v[56:59], a[80:87], v5
 ds_read_b128 v[20:23], v3 offset:9216
 v_add_f32 v44, v44, v46
 v_add_f32 v45, v45, v47
 v_smfmac_f32_16x16x64_bf16 v[68:71], v[56:59], a[88:95], v5
 s_waitcnt lgkmcnt(3)
 v_add_f32 v48, v48, v50
 v_add_f32 v49, v49, v51
 v_cvt_pk_bf16_f32 v44, v44, v48
 v_cvt_pk_bf16_f32 v45, v45, v49
 ds_write2_b32 v8, v44, v45 offset0:0 offset1:16
 v_smfmac_f32_16x16x64_bf16 v[64:67], v[52:55], a[160:167], v5
 ds_read_b128 v[56:59], v3 offset:0
 v_mov_b64 v[28:29], 0
 v_smfmac_f32_16x16x64_bf16 v[68:71], v[52:55], a[168:175], v5
 ds_read_b128 v[52:55], v3 offset:4096
 v_mov_b64 v[30:31], 0
 v_smfmac_f32_16x16x64_bf16 v[64:67], v[60:63], a[120:127], v5
 ds_read_b128 v[24:27], v3 offset:10240
 v_smfmac_f32_16x16x64_bf16 v[68:71], v[60:63], a[128:135], v5
 s_waitcnt lgkmcnt(3)
 s_barrier
 ds_read_b128 v[36:39], v11 offset:17408
 s_waitcnt lgkmcnt(3)
 v_smfmac_f32_16x16x64_bf16 v[64:67], v[56:59], v[96:103], v5
 ds_read_b128 v[40:43], v11 offset:17920
 s_waitcnt lgkmcnt(3)
 v_smfmac_f32_16x16x64_bf16 v[68:71], v[56:59], v[104:111], v5
 ds_read_b128 v[60:63], v9 offset:19456
 ds_read_b128 v[44:47], v11 offset:18432
 v_smfmac_f32_16x16x64_bf16 v[64:67], v[52:55], a[0:7], v5
 ds_read_b128 v[48:51], v11 offset:18944
 v_smfmac_f32_16x16x64_bf16 v[68:71], v[52:55], a[8:15], v5
 ds_read_b128 v[52:55], v3 offset:12288
 s_waitcnt lgkmcnt(5)
 v_mfma_f32_16x16x32_bf16 v[20:23], v[20:23], v[36:39], 0
 ds_read_b128 v[56:59], v9 offset:21504
 v_mfma_f32_16x16x32_bf16 v[24:27], v[24:27], v[36:39], 0
 v_add_f32 v64, v64, v66
 v_add_f32 v65, v65, v67
 s_waitcnt lgkmcnt(5)
 v_mfma_f32_16x16x32_bf16 v[20:23], v[32:35], v[40:43], v[20:23]
 ds_read_b128 v[32:35], v3 offset:13312
 v_cvt_pk_bf16_f32 v2, v64, v65
 v_add_f32 v68, v68, v70
 s_waitcnt lgkmcnt(5)
 v_smfmac_f32_16x16x64_bf16 v[28:31], v[60:63], v[36:43], v5
 ds_read_b128 v[60:63], v3 offset:14336
 ds_read_b128 v[36:39], v3 offset:15360
 v_add_f32 v69, v69, v71
 s_waitcnt lgkmcnt(4)
 v_mfma_f32_16x16x32_bf16 v[24:27], v[52:55], v[40:43], v[24:27]
 ds_read_b128 v[52:55], v3 offset:16384
 v_cvt_pk_bf16_f32 v4, v68, v69
 s_waitcnt lgkmcnt(4)
 v_smfmac_f32_16x16x64_bf16 v[28:31], v[56:59], v[44:51], v5
 ds_read_b128 v[40:43], v0 offset:36864
 s_waitcnt lgkmcnt(4)
 v_mfma_f32_16x16x32_bf16 v[20:23], v[32:35], v[44:47], v[20:23]
 v_mov_b64 v[32:33], s[34:35]
 v_mov_b64 v[34:35], s[34:35]
 s_waitcnt lgkmcnt(3)
 v_mfma_f32_16x16x32_bf16 v[24:27], v[60:63], v[44:47], v[24:27]
 ds_read_b128 v[44:47], v0 offset:40960
 v_add_f32 v28, v28, v30
 v_add_f32 v29, v29, v31
 s_waitcnt lgkmcnt(3)
 v_mfma_f32_16x16x32_bf16 v[20:23], v[36:39], v[48:51], v[20:23]
 ds_read_b128 v[36:39], v0 offset:32768
 v_cndmask_b32 v28, v28, v29, s[48:49]
 v_mul_f32 v28, s55, v28
 s_waitcnt lgkmcnt(3)
 v_mfma_f32_16x16x32_bf16 v[24:27], v[52:55], v[48:51], v[24:27]
 ds_read_b128 v[48:51], v0 offset:45056
 v_exp_f32 v28, v28
 v_mov_b64 v[64:65], 0
 v_cndmask_b32 v29, 0, v28, s[48:49]
 v_cndmask_b32 v28, v28, 0, s[48:49]
 v_cvt_pk_bf16_f32 v6, v28, v29
 v_mov_b64 v[66:67], 0
 v_mov_b64 v[68:69], 0
 v_cndmask_b32 v20, v20, v24, s[48:49]
 v_cndmask_b32 v21, v21, v25, s[48:49]
 v_cndmask_b32 v22, v22, v26, s[48:49]
 v_cndmask_b32 v23, v23, v27, s[48:49]
 v_mfma_f32_16x16x16_bf16 v[60:63], v[6:7], v[32:33], 0
 s_waitcnt vmcnt(3)
 v_exp_f32 v20, v20
 v_mfma_f32_16x16x16_bf16 v[52:55], v[6:7], v[2:3], 0
 s_cmp_eq_u32 s36, 63
 v_exp_f32 v21, v21
 v_mfma_f32_16x16x16_bf16 v[56:59], v[6:7], v[4:5], 0
 v_exp_f32 v22, v22
 v_exp_f32 v23, v23
 v_cvt_pk_bf16_f32 v30, v20, v21
 v_cvt_pk_bf16_f32 v31, v22, v23
 v_mov_b64 v[70:71], 0
 v_mov_b64 v[20:21], 0
 v_smfmac_f32_16x16x32_bf16 v[60:63], v[30:31], v[32:35], v5
 v_mov_b64 v[22:23], 0
 v_mov_b64 v[24:25], 0
 v_smfmac_f32_16x16x32_bf16 v[52:55], v[30:31], v[12:15], v5
 v_mov_b64 v[26:27], 0
 v_smfmac_f32_16x16x32_bf16 v[56:59], v[30:31], v[16:19], v5
 s_nop 0
 v_add_f32 v60, v60, v62
 v_add_f32 v61, v61, v63
 v_rcp_f32 v60, v60
 v_rcp_f32 v61, v61
 v_add_f32 v52, v52, v54
 v_add_f32 v53, v53, v55
 v_mul_f32 v52, v52, v60
 v_mul_f32 v53, v53, v61
 v_add_f32 v56, v56, v58
 v_add_f32 v57, v57, v59
 v_mul_f32 v56, v56, v60
 v_mul_f32 v57, v57, v61
 v_cvt_pk_bf16_f32 v52, v52, v56
 v_cvt_pk_bf16_f32 v53, v53, v57
 ds_write2_b32 v8, v52, v53 offset0:128 offset1:144
 v_subrev_u32 v60, 0x21800000, v60
 v_subrev_u32 v61, 0x21800000, v61
 v_max_u32 v60, v60, v61
 v_cmp_lt_u32 vcc, 0x3c000000, v60
 s_cbranch_scc1 Lchexit_70
 v_mov_b64 v[28:29], 0
 v_mov_b64 v[30:31], 0
 v_mov_b64 v[32:33], 0
 v_mov_b64 v[34:35], 0
 s_cbranch_vccnz Lmx_133
Lmxb_134:
 s_waitcnt lgkmcnt(0)
 v_bfe_u32 v6, v0, 7, 5
 s_barrier
 ds_read_b128 v[52:55], v9 offset:19968
 v_mul_u32_u24 v6, 10496, v6
 ds_read_b128 v[56:59], v9 offset:22016
 ds_read_b128 v[12:15], v0 offset:49152
 v_bfe_u32 v60, v3, 4, 3
 ds_read_b128 v[16:19], v0 offset:53248
 s_add_u32 s67, s67, 0x80000
 v_lshl_add_u32 v6, v60, 3, v6
 s_add_u32 m0, s42, 9216
 s_xor_b32 s46, s46, 0x1
 v_mov_b64 v[60:61], 0
 s_add_u32 s59, s59, 0x80000
 v_mov_b64 v[62:63], 0
 s_waitcnt lgkmcnt(3)
 v_smfmac_f32_16x16x64_bf16 v[64:67], v[52:55], a[248:255], v5
 buffer_load_dwordx4 v3, s[20:23], s67 offen offset:0 sc1 lds
 v_smfmac_f32_16x16x64_bf16 v[68:71], v[52:55], a[176:183], v5
 s_waitcnt lgkmcnt(2)
 s_add_u32 s38, s38, 0x20000
 v_smfmac_f32_16x16x64_bf16 v[64:67], v[56:59], v[36:43], v5
 ds_read_b128 v[36:39], v0 offset:57344
 buffer_load_dwordx4 v3, s[20:23], s67 offen offset:1024 sc1 lds
 v_smfmac_f32_16x16x64_bf16 v[20:23], v[52:55], a[184:191], v5
 ds_read_b128 v[40:43], v0 offset:61440
 s_cmp_lt_u32 s36, 62
 v_add_u32 v0, 0x10000, v0
 v_smfmac_f32_16x16x64_bf16 v[68:71], v[56:59], v[44:51], v5
 ds_read_b128 v[44:47], v0 offset:0
 s_cselect_b32 s47, 0x80000, 0
 v_add_f32 v64, v64, v66
 v_add_f32 v65, v65, v67
 v_cvt_pk_bf16_f32 v65, v65, v65
 v_smfmac_f32_16x16x64_bf16 v[24:27], v[52:55], a[192:199], v5
 ds_read_b128 v[48:51], v0 offset:4096
 s_waitcnt lgkmcnt(4)
 v_cvt_pk_bf16_f32 v64, v64, v64
 v_and_or_b32 v65, v65, -2, s46
 v_smfmac_f32_16x16x64_bf16 v[20:23], v[56:59], v[12:19], v5
 ds_read_b128 v[12:15], v0 offset:8192
 buffer_store_dwordx2 v[64:65], v6, s[20:23], s62 offen sc1
 v_add_f32 v68, v68, v70
 v_add_f32 v69, v69, v71
 v_smfmac_f32_16x16x64_bf16 v[28:31], v[52:55], a[200:207], v5
 ds_read_b128 v[16:19], v0 offset:12288
 s_waitcnt lgkmcnt(4)
 v_mov_b64 v[64:65], 0
 v_mov_b64 v[66:67], 0
 v_smfmac_f32_16x16x64_bf16 v[24:27], v[56:59], v[36:43], v5
 ds_read_b128 v[36:39], v0 offset:16384
 s_add_u32 s68, s68, s47
 v_add_f32 v20, v20, v22
 v_add_f32 v21, v21, v23
 v_cvt_pk_bf16_f32 v69, v69, v21
 v_smfmac_f32_16x16x64_bf16 v[32:35], v[52:55], a[208:215], v5
 ds_read_b128 v[40:43], v0 offset:20480
 s_waitcnt lgkmcnt(4)
 v_cvt_pk_bf16_f32 v68, v68, v20
 v_and_or_b32 v69, v69, -2, s46
 v_smfmac_f32_16x16x64_bf16 v[28:31], v[56:59], v[44:51], v5
 ds_read_b128 v[44:47], v0 offset:24576
 buffer_store_dwordx2 v[68:69], v6, s[20:23], s60 offen offset:0 sc1
 v_add_f32 v24, v24, v26
 v_add_f32 v25, v25, v27
 v_smfmac_f32_16x16x64_bf16 v[60:63], v[52:55], a[216:223], v5
 ds_read_b128 v[48:51], v0 offset:28672
 s_waitcnt lgkmcnt(4)
 v_mov_b64 v[20:21], 0
 v_mov_b64 v[22:23], 0
 v_smfmac_f32_16x16x64_bf16 v[32:35], v[56:59], v[12:19], v5
 s_add_u32 s36, s36, 1
 s_add_u32 s58, s36, 2
 v_add_f32 v28, v28, v30
 v_add_f32 v29, v29, v31
 v_cvt_pk_bf16_f32 v25, v25, v29
 v_smfmac_f32_16x16x64_bf16 v[64:67], v[52:55], a[224:231], v5
 s_waitcnt lgkmcnt(2)
 s_min_u32 s58, s58, 64
 v_cvt_pk_bf16_f32 v24, v24, v28
 v_and_or_b32 v25, v25, -2, s46
 v_smfmac_f32_16x16x64_bf16 v[60:63], v[56:59], v[36:43], v5
 buffer_store_dwordx2 v[24:25], v6, s[20:23], s60 offen offset:2048 sc1
 v_add_f32 v32, v32, v34
 v_smfmac_f32_16x16x64_bf16 v[20:23], v[52:55], a[232:239], v5
 s_waitcnt lgkmcnt(0)
 s_xor_b32 s44, s44, 0x80000
 v_add_f32 v33, v33, v35
 v_smfmac_f32_16x16x64_bf16 v[64:67], v[56:59], v[44:51], v5
 s_xor_b32 s45, s45, 0x80000
 s_xor_b32 s65, s65, 0x80000
 v_add_f32 v60, v60, v62
 v_add_f32 v61, v61, v63
 v_smfmac_f32_16x16x64_bf16 v[20:23], v[56:59], a[240:247], v5
 s_cmp_eq_u32 s4, 0
 v_cvt_pk_bf16_f32 v33, v33, v61
 v_cvt_pk_bf16_f32 v32, v32, v60
 v_and_or_b32 v33, v33, -2, s46
 buffer_store_dwordx2 v[32:33], v6, s[20:23], s61 offen offset:0 sc1
 v_add_f32 v64, v64, v66
 v_add_f32 v65, v65, v67
 s_nop 0
 v_add_f32 v20, v20, v22
 v_add_f32 v21, v21, v23
 v_cvt_pk_bf16_f32 v65, v65, v21
 v_cvt_pk_bf16_f32 v64, v64, v20
 v_and_or_b32 v65, v65, -2, s46
 buffer_store_dwordx2 v[64:65], v6, s[20:23], s61 offen offset:2048 sc1
 s_cbranch_scc1 LwH_135
 s_cmp_eq_u32 s4, 1
 s_cbranch_scc1 Lw_136
 s_cmp_eq_u32 s4, 2
 s_cbranch_scc1 Lw_137
 s_xor_b32 s66, s66, 0x80000
 s_xor_b32 s41, s41, 0x80000
 s_xor_b32 s43, s43, 0x80000
 v_mov_b32 v47, 0x3f80
 v_cndmask_b32 v47, v47, 1.0, s[32:33]
 v_cndmask_b32 v44, 0, v47, s[24:25]
 v_cndmask_b32 v45, 0, v47, s[26:27]
 v_cndmask_b32 v46, 0, v47, s[28:29]
 v_cndmask_b32 v47, 0, v47, s[30:31]
 v_bfe_u32 v52, v3, 8, 2
 v_bfe_u32 v58, v3, 2, 4
 v_lshl_or_b32 v52, v52, 4, v58
 v_and_b32 v58, 0xc0, v3
 v_lshl_or_b32 v52, v58, 24, v52
 v_subrev_u32 v0, 0x20000, v0
 v_mov_b32 v59, -1
 v_add_u32 v54, s42, v3
 v_add_u32 v58, s69, v9
 ds_read_b64 v[64:65], v58 offset:19456
 v_mov_b32 v66, v2
 v_mov_b32 v67, v4
 v_mov_b64 v[68:69], 0
 v_mov_b64 v[70:71], 0
 ds_read_b128 v[20:23], v0 offset:24576
 ds_read_b128 v[24:27], v0 offset:28672
 ds_read_b128 v[28:31], v0 offset:32768
 ds_read_b128 v[32:35], v0 offset:36864
 s_waitcnt vmcnt(0)
 buffer_load_dwordx4 v[36:39], v3, s[20:23], s39 offen offset:0 sc1
 buffer_load_dwordx4 v[40:43], v3, s[20:23], s39 offen offset:1024 sc1
 s_nop 15
 s_nop 10
 buffer_load_dwordx4 v[12:15], v3, s[20:23], s39 offen offset:0 sc1
 buffer_load_dwordx4 v[16:19], v3, s[20:23], s39 offen offset:1024 sc1
 s_waitcnt vmcnt(3)
 v_mfma_f32_16x16x32_bf16 v[48:51], v[44:47], v[36:39], 0
 s_waitcnt vmcnt(2)
 v_mfma_f32_16x16x32_bf16 v[48:51], v[44:47], v[40:43], v[48:51]
 v_bitop3_b32 v55, v37, v39, s46 bitop3:0x7e
 v_bitop3_b32 v56, v41, v43, s46 bitop3:0x7e
 v_bitop3_b32 v55, v55, 1, v56 bitop3:0xc8
 v_cmp_ne_u32 vcc, 0, v55
 s_nop 3
 v_add_f32_dpp v48, v48, v48 row_ror:4 row_mask:0xf bank_mask:0xf
 v_add_f32_dpp v49, v49, v49 row_ror:4 row_mask:0xf bank_mask:0xf
 s_cbranch_vccnz Lr2_139
 v_add_f32_dpp v48, v48, v48 row_ror:8 row_mask:0xf bank_mask:0xf
 v_add_f32_dpp v49, v49, v49 row_ror:8 row_mask:0xf bank_mask:0xf
 v_cvt_pk_bf16_f32 v48, v48, v49
 buffer_store_dword v48, v52, s[20:23], s44 offen sc1
Lb1_140:
 buffer_store_dword v59, v52, s[20:23], s45 offen sc1
 v_cmp_gt_u32 vcc, s58, v1
 v_mov_b64 v[36:37], 0
 v_mov_b64 v[38:39], 0
 v_mov_b64 v[40:41], 0
 v_mov_b64 v[42:43], 0
 v_mov_b64 v[44:45], 0
 v_mov_b64 v[46:47], 0
 v_mov_b64 v[48:49], 0
 v_mov_b64 v[50:51], 0
 s_bitcmp1_b32 vcc_hi, 31
 s_cbranch_scc1 Lfw_142
Lfok_141:
 v_lshl_add_u32 v1, v3, 3, s68
 v_cndmask_b32 v1, -16, v1, s[70:71]
 v_writelane_b32 v1, s56, 63
 v_min_u32 v6, 16, v0
 v_lshlrev_b32 v6, 24, v6
 s_max_u32 s47, s36, 1
 v_add_u32 v2, -1, s47
 s_add_u32 m0, s42, 0
 s_waitcnt vmcnt(0)
 s_cmp_lg_u32 s50, 0
 s_cbranch_scc1 Lsure_127
 s_nop 15
 s_nop 15
 s_nop 7
 s_branch LstepB_126
Lw_137:
 s_xor_b32 s66, s66, 0x80000
 s_xor_b32 s41, s41, 0x80000
 s_xor_b32 s43, s43, 0x80000
 v_mov_b32 v47, 0x3f80
 v_cndmask_b32 v47, v47, 1.0, s[32:33]
 v_cndmask_b32 v44, 0, v47, s[24:25]
 v_cndmask_b32 v45, 0, v47, s[26:27]
 v_cndmask_b32 v46, 0, v47, s[28:29]
 v_cndmask_b32 v47, 0, v47, s[30:31]
 v_bfe_u32 v52, v3, 8, 2
 v_bfe_u32 v58, v3, 2, 4
 v_lshl_or_b32 v52, v52, 4, v58
 v_and_b32 v58, 0xc0, v3
 v_lshl_or_b32 v52, v58, 24, v52
 v_subrev_u32 v0, 0x20000, v0
 v_mov_b32 v59, -1
 v_add_u32 v54, s42, v3
 v_add_u32 v58, s69, v9
 ds_read_b64 v[64:65], v58 offset:19456
 v_mov_b32 v66, v2
 v_mov_b32 v67, v4
 v_mov_b64 v[68:69], 0
 v_mov_b64 v[70:71], 0
 ds_read_b128 v[20:23], v0 offset:24576
 ds_read_b128 v[24:27], v0 offset:28672
 ds_read_b128 v[28:31], v0 offset:32768
 ds_read_b128 v[32:35], v0 offset:36864
 s_waitcnt vmcnt(1)
 buffer_load_dwordx4 v[36:39], v3, s[20:23], s39 offen offset:0 sc1
 buffer_load_dwordx4 v[40:43], v3, s[20:23], s39 offen offset:1024 sc1
 s_nop 15
 s_nop 10
 buffer_load_dwordx4 v[12:15], v3, s[20:23], s39 offen offset:0 sc1
 buffer_load_dwordx4 v[16:19], v3, s[20:23], s39 offen offset:1024 sc1
 s_waitcnt vmcnt(3)
 v_mfma_f32_16x16x32_bf16 v[48:51], v[44:47], v[36:39], 0
 s_waitcnt vmcnt(2)
 v_mfma_f32_16x16x32_bf16 v[48:51], v[44:47], v[40:43], v[48:51]
 v_bitop3_b32 v55, v37, v39, s46 bitop3:0x7e
 v_bitop3_b32 v56, v41, v43, s46 bitop3:0x7e
 v_bitop3_b32 v55, v55, 1, v56 bitop3:0xc8
 v_cmp_ne_u32 vcc, 0, v55
 s_nop 3
 v_add_f32_dpp v48, v48, v48 row_ror:4 row_mask:0xf bank_mask:0xf
 v_add_f32_dpp v49, v49, v49 row_ror:4 row_mask:0xf bank_mask:0xf
 s_cbranch_vccnz Lr2_145
 v_add_f32_dpp v48, v48, v48 row_ror:8 row_mask:0xf bank_mask:0xf
 v_add_f32_dpp v49, v49, v49 row_ror:8 row_mask:0xf bank_mask:0xf
 v_cvt_pk_bf16_f32 v48, v48, v49
 buffer_store_dword v48, v52, s[20:23], s44 offen sc1
Lb1_146:
 buffer_store_dword v59, v52, s[20:23], s45 offen sc1
 v_cmp_gt_u32 vcc, s58, v1
 v_mov_b64 v[36:37], 0
 v_mov_b64 v[38:39], 0
 v_mov_b64 v[40:41], 0
 v_mov_b64 v[42:43], 0
 v_mov_b64 v[44:45], 0
 v_mov_b64 v[46:47], 0
 v_mov_b64 v[48:49], 0
 v_mov_b64 v[50:51], 0
 s_bitcmp1_b32 vcc_hi, 31
 s_cbranch_scc1 Lfw_148
Lfok_147:
 v_lshl_add_u32 v1, v3, 3, s68
 v_cndmask_b32 v1, -16, v1, s[70:71]
 v_writelane_b32 v1, s56, 63
 v_min_u32 v6, 16, v0
 v_lshlrev_b32 v6, 24, v6
 s_max_u32 s47, s36, 1
 v_add_u32 v2, -1, s47
 s_add_u32 m0, s42, 0
 s_nop 4
 buffer_load_dwordx4 v[12:15], v3, s[20:23], s43 offen offset:0 sc1
 s_nop 15
 s_nop 7
Lp2_149:
 buffer_load_dwordx4 v[12:15], v3, s[20:23], s43 offen offset:0 sc1
 s_waitcnt vmcnt(1)
 v_max3_u32 v55, v12, v13, v14
 v_max_u32 v55, v55, v15
 ds_write_b128 v3, v[12:15] offset:8192
 v_cmpx_eq_u32 vcc, -1, v55
 s_cbranch_execz LstepB_126
 buffer_load_dwordx4 v[12:15], v3, s[20:23], s43 offen offset:0 sc1
 s_waitcnt vmcnt(1)
 v_max3_u32 v55, v12, v13, v14
 v_max_u32 v55, v55, v15
 ds_write_b128 v3, v[12:15] offset:8192
 v_cmpx_eq_u32 vcc, -1, v55
 s_cbranch_execz LstepB_126
 buffer_load_dwordx4 v[12:15], v3, s[20:23], s43 offen offset:0 sc1
 s_waitcnt vmcnt(1)
 v_max3_u32 v55, v12, v13, v14
 v_max_u32 v55, v55, v15
 ds_write_b128 v3, v[12:15] offset:8192
 v_cmpx_eq_u32 vcc, -1, v55
 s_cbranch_execz LstepB_126
 s_sub_u32 s54, s54, 1
 s_cbranch_scc0 Lp2_149
 s_endpgm
Lw_136:
 s_waitcnt vmcnt(2)
 buffer_load_dwordx4 v[36:39], v3, s[20:23], s39 offen offset:0 sc1
 buffer_load_dwordx4 v[40:43], v3, s[20:23], s39 offen offset:1024 sc1
 s_xor_b32 s66, s66, 0x80000
 s_xor_b32 s41, s41, 0x80000
 s_xor_b32 s43, s43, 0x80000
 v_mov_b32 v47, 0x3f80
 v_cndmask_b32 v47, v47, 1.0, s[32:33]
 v_cndmask_b32 v44, 0, v47, s[24:25]
 v_cndmask_b32 v45, 0, v47, s[26:27]
 v_cndmask_b32 v46, 0, v47, s[28:29]
 v_cndmask_b32 v47, 0, v47, s[30:31]
 v_bfe_u32 v52, v3, 8, 2
 v_bfe_u32 v58, v3, 2, 4
 v_lshl_or_b32 v52, v52, 4, v58
 v_and_b32 v58, 0xc0, v3
 v_lshl_or_b32 v52, v58, 24, v52
 v_subrev_u32 v0, 0x20000, v0
 v_mov_b32 v59, -1
 v_add_u32 v54, s42, v3
 v_add_u32 v58, s69, v9
 ds_read_b64 v[64:65], v58 offset:19456
 v_mov_b32 v66, v2
 v_mov_b32 v67, v4
 v_mov_b64 v[68:69], 0
 v_mov_b64 v[70:71], 0
 ds_read_b128 v[20:23], v0 offset:24576
 ds_read_b128 v[24:27], v0 offset:28672
 ds_read_b128 v[28:31], v0 offset:32768
 ds_read_b128 v[32:35], v0 offset:36864
 s_nop 3
 buffer_load_dwordx4 v[12:15], v3, s[20:23], s39 offen offset:0 sc1
 buffer_load_dwordx4 v[16:19], v3, s[20:23], s39 offen offset:1024 sc1
 s_waitcnt vmcnt(3)
 v_mfma_f32_16x16x32_bf16 v[48:51], v[44:47], v[36:39], 0
 s_waitcnt vmcnt(2)
 v_mfma_f32_16x16x32_bf16 v[48:51], v[44:47], v[40:43], v[48:51]
 v_bitop3_b32 v55, v37, v39, s46 bitop3:0x7e
 v_bitop3_b32 v56, v41, v43, s46 bitop3:0x7e
 v_bitop3_b32 v55, v55, 1, v56 bitop3:0xc8
 v_cmp_ne_u32 vcc, 0, v55
 s_nop 3
 v_add_f32_dpp v48, v48, v48 row_ror:4 row_mask:0xf bank_mask:0xf
 v_add_f32_dpp v49, v49, v49 row_ror:4 row_mask:0xf bank_mask:0xf
 s_cbranch_vccnz Lr2_151
 v_add_f32_dpp v48, v48, v48 row_ror:8 row_mask:0xf bank_mask:0xf
 v_add_f32_dpp v49, v49, v49 row_ror:8 row_mask:0xf bank_mask:0xf
 v_cvt_pk_bf16_f32 v48, v48, v49
 buffer_store_dword v48, v52, s[20:23], s44 offen sc1
Lb1_152:
 buffer_store_dword v59, v52, s[20:23], s45 offen sc1
 v_cmp_gt_u32 vcc, s58, v1
 v_mov_b64 v[36:37], 0
 v_mov_b64 v[38:39], 0
 v_mov_b64 v[40:41], 0
 v_mov_b64 v[42:43], 0
 v_mov_b64 v[44:45], 0
 v_mov_b64 v[46:47], 0
 v_mov_b64 v[48:49], 0
 v_mov_b64 v[50:51], 0
 s_bitcmp1_b32 vcc_hi, 31
 s_cbranch_scc1 Lfw_154
Lfok_153:
 v_lshl_add_u32 v1, v3, 3, s68
 v_cndmask_b32 v1, -16, v1, s[70:71]
 v_writelane_b32 v1, s56, 63
 v_min_u32 v6, 16, v0
 v_lshlrev_b32 v6, 24, v6
 s_max_u32 s47, s36, 1
 v_add_u32 v2, -1, s47
 s_nop 15
 s_nop 0
 buffer_load_dwordx4 v[12:15], v3, s[20:23], s41 offen offset:0 sc1
 buffer_load_dwordx4 v[16:19], v3, s[20:23], s41 offen offset:1024 sc1
 s_nop 15
 s_nop 7
Lp2_155:
 buffer_load_dwordx4 v[12:15], v3, s[20:23], s41 offen offset:0 sc1
 buffer_load_dwordx4 v[16:19], v3, s[20:23], s41 offen offset:1024 sc1
 s_waitcnt vmcnt(2)
 v_max3_u32 v55, v12, v13, v14
 v_max3_u32 v55, v55, v15, v16
 v_max3_u32 v55, v55, v17, v18
 v_max_u32 v55, v55, v19
 ds_write_b128 v54, v[12:15] offset:0
 ds_write_b128 v54, v[16:19] offset:1024
 v_cmpx_eq_u32 vcc, -1, v55
 s_cbranch_execz Lstep_124
 buffer_load_dwordx4 v[12:15], v3, s[20:23], s41 offen offset:0 sc1
 buffer_load_dwordx4 v[16:19], v3, s[20:23], s41 offen offset:1024 sc1
 s_waitcnt vmcnt(2)
 v_max3_u32 v55, v12, v13, v14
 v_max3_u32 v55, v55, v15, v16
 v_max3_u32 v55, v55, v17, v18
 v_max_u32 v55, v55, v19
 ds_write_b128 v54, v[12:15] offset:0
 ds_write_b128 v54, v[16:19] offset:1024
 v_cmpx_eq_u32 vcc, -1, v55
 s_cbranch_execz Lstep_124
 buffer_load_dwordx4 v[12:15], v3, s[20:23], s41 offen offset:0 sc1
 buffer_load_dwordx4 v[16:19], v3, s[20:23], s41 offen offset:1024 sc1
 s_waitcnt vmcnt(2)
 v_max3_u32 v55, v12, v13, v14
 v_max3_u32 v55, v55, v15, v16
 v_max3_u32 v55, v55, v17, v18
 v_max_u32 v55, v55, v19
 ds_write_b128 v54, v[12:15] offset:0
 ds_write_b128 v54, v[16:19] offset:1024
 v_cmpx_eq_u32 vcc, -1, v55
 s_cbranch_execz Lstep_124
 s_sub_u32 s54, s54, 1
 s_cbranch_scc0 Lp2_155
 s_endpgm
LwH_135:
 v_bfe_u32 v53, v3, 8, 1
 v_bfe_u32 v58, v3, 9, 1
 v_lshl_or_b32 v53, v53, 1, v58
 v_bfe_u32 v58, v3, 5, 1
 v_lshl_or_b32 v53, v53, 1, v58
 v_and_b32 v58, 0xd0, v3
 v_lshlrev_b32 v58, 24, v58
 v_lshl_or_b32 v53, v53, 2, v58
 s_waitcnt vmcnt(3)
 s_nop 7
 buffer_load_dwordx4 v[20:23], v3, s[20:23], s40 offen offset:0 sc1
 buffer_load_dwordx4 v[24:27], v3, s[20:23], s40 offen offset:1024 sc1
 buffer_load_dwordx4 v[36:39], v3, s[20:23], s39 offen offset:0 sc1
 buffer_load_dwordx4 v[40:43], v3, s[20:23], s39 offen offset:1024 sc1
 s_xor_b32 s66, s66, 0x80000
 s_xor_b32 s41, s41, 0x80000
 s_xor_b32 s43, s43, 0x80000
 v_mov_b32 v47, 0x3f80
 v_cndmask_b32 v47, v47, 1.0, s[32:33]
 v_cndmask_b32 v44, 0, v47, s[24:25]
 v_cndmask_b32 v45, 0, v47, s[26:27]
 v_cndmask_b32 v46, 0, v47, s[28:29]
 v_cndmask_b32 v47, 0, v47, s[30:31]
 v_bfe_u32 v52, v3, 8, 2
 v_bfe_u32 v58, v3, 2, 4
 v_lshl_or_b32 v52, v52, 4, v58
 v_and_b32 v58, 0xc0, v3
 v_lshl_or_b32 v52, v58, 24, v52
 v_subrev_u32 v0, 0x20000, v0
 v_mov_b32 v59, -1
 v_add_u32 v54, s42, v3
 v_add_u32 v58, s69, v9
 ds_read_b64 v[64:65], v58 offset:19456
 v_mov_b32 v66, v2
 v_mov_b32 v67, v4
 v_mov_b64 v[68:69], 0
 v_mov_b64 v[70:71], 0
 s_waitcnt vmcnt(2)
 v_mfma_f32_16x16x32_bf16 v[28:31], v[44:47], v[20:23], 0
 v_mfma_f32_16x16x32_bf16 v[28:31], v[44:47], v[24:27], v[28:31]
 s_waitcnt vmcnt(1)
 v_mfma_f32_16x16x32_bf16 v[48:51], v[44:47], v[36:39], 0
 s_waitcnt vmcnt(0)
 v_mfma_f32_16x16x32_bf16 v[48:51], v[44:47], v[40:43], v[48:51]
 v_bitop3_b32 v55, v37, v39, s46 bitop3:0x7e
 v_bitop3_b32 v56, v41, v43, s46 bitop3:0x7e
 v_bitop3_b32 v57, v21, v23, s46 bitop3:0x7e
 v_or3_b32 v55, v55, v56, v57
 v_bitop3_b32 v56, v25, v27, s46 bitop3:0x7e
 v_bitop3_b32 v55, v55, 1, v56 bitop3:0xc8
 v_cmp_ne_u32 vcc, 0, v55
 v_add_f32_dpp v29, v29, v29 row_ror:4 row_mask:0xf bank_mask:0xf
 v_add_f32_dpp v48, v48, v48 row_ror:4 row_mask:0xf bank_mask:0xf
 v_add_f32_dpp v49, v49, v49 row_ror:4 row_mask:0xf bank_mask:0xf
 v_add_f32_dpp v29, v29, v29 row_ror:8 row_mask:0xf bank_mask:0xf
 v_add_f32_dpp v48, v48, v48 row_ror:8 row_mask:0xf bank_mask:0xf
 v_add_f32_dpp v49, v49, v49 row_ror:8 row_mask:0xf bank_mask:0xf
 s_cbranch_vccnz Lr1_156
 v_cvt_pk_bf16_f32 v48, v48, v49
 buffer_store_dword v48, v52, s[20:23], s44 offen sc1
 v_mov_b32_dpp v30, v29 quad_perm:[1,0,3,2] row_mask:0xf bank_mask:0xf
 v_cvt_pk_bf16_f32 v29, v29, v30
 buffer_store_dword v29, v53, s[20:23], s65 offen sc1
Lb1_157:
 buffer_store_dword v59, v52, s[20:23], s45 offen sc1
 buffer_store_dword v59, v53, s[20:23], s66 offen sc1
 v_cmp_gt_u32 vcc, s58, v1
 ds_read_b128 v[20:23], v0 offset:24576
 ds_read_b128 v[24:27], v0 offset:28672
 ds_read_b128 v[28:31], v0 offset:32768
 ds_read_b128 v[32:35], v0 offset:36864
 v_mov_b64 v[36:37], 0
 v_mov_b64 v[38:39], 0
 v_mov_b64 v[40:41], 0
 v_mov_b64 v[42:43], 0
 v_mov_b64 v[44:45], 0
 v_mov_b64 v[46:47], 0
 v_mov_b64 v[48:49], 0
 v_mov_b64 v[50:51], 0
 s_bitcmp1_b32 vcc_hi, 31
 s_cbranch_scc1 Lfw_159
Lfok_158:
 v_lshl_add_u32 v1, v3, 3, s68
 v_cndmask_b32 v1, -16, v1, s[70:71]
 v_writelane_b32 v1, s56, 63
 v_min_u32 v6, 16, v0
 v_lshlrev_b32 v6, 24, v6
 s_max_u32 s47, s36, 1
 v_add_u32 v2, -1, s47
 s_nop 10
 buffer_load_dwordx4 v[12:15], v3, s[20:23], s41 offen offset:0 sc1
 buffer_load_dwordx4 v[16:19], v3, s[20:23], s41 offen offset:1024 sc1
 s_nop 15
 s_nop 7
Lp2_160:
 buffer_load_dwordx4 v[12:15], v3, s[20:23], s41 offen offset:0 sc1
 buffer_load_dwordx4 v[16:19], v3, s[20:23], s41 offen offset:1024 sc1
 s_waitcnt vmcnt(2)
 v_max3_u32 v55, v12, v13, v14
 v_max3_u32 v55, v55, v15, v16
 v_max3_u32 v55, v55, v17, v18
 v_max_u32 v55, v55, v19
 ds_write_b128 v54, v[12:15] offset:0
 ds_write_b128 v54, v[16:19] offset:1024
 v_cmpx_eq_u32 vcc, -1, v55
 s_cbranch_execz Lstep_124
 buffer_load_dwordx4 v[12:15], v3, s[20:23], s41 offen offset:0 sc1
 buffer_load_dwordx4 v[16:19], v3, s[20:23], s41 offen offset:1024 sc1
 s_waitcnt vmcnt(2)
 v_max3_u32 v55, v12, v13, v14
 v_max3_u32 v55, v55, v15, v16
 v_max3_u32 v55, v55, v17, v18
 v_max_u32 v55, v55, v19
 ds_write_b128 v54, v[12:15] offset:0
 ds_write_b128 v54, v[16:19] offset:1024
 v_cmpx_eq_u32 vcc, -1, v55
 s_cbranch_execz Lstep_124
 buffer_load_dwordx4 v[12:15], v3, s[20:23], s41 offen offset:0 sc1
 buffer_load_dwordx4 v[16:19], v3, s[20:23], s41 offen offset:1024 sc1
 s_waitcnt vmcnt(2)
 v_max3_u32 v55, v12, v13, v14
 v_max3_u32 v55, v55, v15, v16
 v_max3_u32 v55, v55, v17, v18
 v_max_u32 v55, v55, v19
 ds_write_b128 v54, v[12:15] offset:0
 ds_write_b128 v54, v[16:19] offset:1024
 v_cmpx_eq_u32 vcc, -1, v55
 s_cbranch_execz Lstep_124
 s_sub_u32 s54, s54, 1
 s_cbranch_scc0 Lp2_160
 s_endpgm
Lr1_156:
 s_mov_b64 exec, vcc
Lrt_161:
 buffer_load_dwordx4 v[20:23], v3, s[20:23], s40 offen offset:0 sc1
 buffer_load_dwordx4 v[24:27], v3, s[20:23], s40 offen offset:1024 sc1
 buffer_load_dwordx4 v[36:39], v3, s[20:23], s39 offen offset:0 sc1
 buffer_load_dwordx4 v[40:43], v3, s[20:23], s39 offen offset:1024 sc1
 s_waitcnt vmcnt(4)
 v_bitop3_b32 v55, v37, v39, s46 bitop3:0x7e
 v_bitop3_b32 v56, v41, v43, s46 bitop3:0x7e
 v_bitop3_b32 v57, v21, v23, s46 bitop3:0x7e
 v_or3_b32 v55, v55, v56, v57
 v_bitop3_b32 v56, v25, v27, s46 bitop3:0x7e
 v_bitop3_b32 v55, v55, 1, v56 bitop3:0xc8
 v_cmpx_ne_u32 vcc, 0, v55
 s_cbranch_execz Lrte_162
 buffer_load_dwordx4 v[20:23], v3, s[20:23], s40 offen offset:0 sc1
 buffer_load_dwordx4 v[24:27], v3, s[20:23], s40 offen offset:1024 sc1
 buffer_load_dwordx4 v[36:39], v3, s[20:23], s39 offen offset:0 sc1
 buffer_load_dwordx4 v[40:43], v3, s[20:23], s39 offen offset:1024 sc1
 s_waitcnt vmcnt(4)
 v_bitop3_b32 v55, v37, v39, s46 bitop3:0x7e
 v_bitop3_b32 v56, v41, v43, s46 bitop3:0x7e
 v_bitop3_b32 v57, v21, v23, s46 bitop3:0x7e
 v_or3_b32 v55, v55, v56, v57
 v_bitop3_b32 v56, v25, v27, s46 bitop3:0x7e
 v_bitop3_b32 v55, v55, 1, v56 bitop3:0xc8
 v_cmpx_ne_u32 vcc, 0, v55
 s_cbranch_execz Lrte_162
 buffer_load_dwordx4 v[20:23], v3, s[20:23], s40 offen offset:0 sc1
 buffer_load_dwordx4 v[24:27], v3, s[20:23], s40 offen offset:1024 sc1
 buffer_load_dwordx4 v[36:39], v3, s[20:23], s39 offen offset:0 sc1
 buffer_load_dwordx4 v[40:43], v3, s[20:23], s39 offen offset:1024 sc1
 s_waitcnt vmcnt(4)
 v_bitop3_b32 v55, v37, v39, s46 bitop3:0x7e
 v_bitop3_b32 v56, v41, v43, s46 bitop3:0x7e
 v_bitop3_b32 v57, v21, v23, s46 bitop3:0x7e
 v_or3_b32 v55, v55, v56, v57
 v_bitop3_b32 v56, v25, v27, s46 bitop3:0x7e
 v_bitop3_b32 v55, v55, 1, v56 bitop3:0xc8
 v_cmpx_ne_u32 vcc, 0, v55
 s_cbranch_execz Lrte_162
 s_sub_u32 s54, s54, 1
 s_cbranch_scc0 Lrt_161
 s_endpgm
Lrte_162:
 s_mov_b64 exec, -1
 s_nop 2
 v_mfma_f32_16x16x32_bf16 v[28:31], v[44:47], v[20:23], 0
 v_mfma_f32_16x16x32_bf16 v[28:31], v[44:47], v[24:27], v[28:31]
 v_mfma_f32_16x16x32_bf16 v[48:51], v[44:47], v[36:39], 0
 v_mfma_f32_16x16x32_bf16 v[48:51], v[44:47], v[40:43], v[48:51]
 s_nop 6
 v_add_f32_dpp v29, v29, v29 row_ror:4 row_mask:0xf bank_mask:0xf
 v_add_f32_dpp v48, v48, v48 row_ror:4 row_mask:0xf bank_mask:0xf
 v_add_f32_dpp v49, v49, v49 row_ror:4 row_mask:0xf bank_mask:0xf
 v_add_f32_dpp v29, v29, v29 row_ror:8 row_mask:0xf bank_mask:0xf
 v_add_f32_dpp v48, v48, v48 row_ror:8 row_mask:0xf bank_mask:0xf
 v_add_f32_dpp v49, v49, v49 row_ror:8 row_mask:0xf bank_mask:0xf
 v_cvt_pk_bf16_f32 v48, v48, v49
 buffer_store_dword v48, v52, s[20:23], s44 offen sc1
 v_mov_b32_dpp v30, v29 quad_perm:[1,0,3,2] row_mask:0xf bank_mask:0xf
 v_cvt_pk_bf16_f32 v29, v29, v30
 buffer_store_dword v29, v53, s[20:23], s65 offen sc1
 s_waitcnt vmcnt(2)
 s_branch Lb1_157
Lsure_127:
 s_mov_b32 s50, 0
 s_waitcnt lgkmcnt(0)
 buffer_load_dwordx4 v[12:15], v3, s[20:23], s41 offen offset:0 sc1
 buffer_load_dwordx4 v[16:19], v3, s[20:23], s41 offen offset:1024 sc1
 s_sub_u32 s54, s54, 1
 s_cbranch_scc1 Lfail_125
 s_waitcnt vmcnt(0)
 v_max3_u32 v4, v12, v13, v14
 v_max3_u32 v4, v4, v15, v16
 v_max3_u32 v4, v4, v17, v18
 v_max_u32 v4, v4, v19
 v_cmp_eq_u32 vcc, -1, v4
 s_cbranch_vccnz Lsure_127
 s_branch Lsureb_128
Lfx_129:
 s_add_u32 s47, s43, -4096
 buffer_load_dwordx4 v[60:63], v3, s[20:23], s47 offen offset:0 sc1
 buffer_load_dwordx4 v[52:55], v3, s[20:23], s47 offen offset:1024 sc1
 s_sub_u32 s54, s54, 1
 s_cbranch_scc1 Lfail_125
 s_waitcnt vmcnt(0)
 v_max3_u32 v4, v60, v61, v62
 v_max3_u32 v4, v4, v63, v52
 v_max3_u32 v4, v4, v53, v54
 v_max_u32 v4, v4, v55
 v_cmp_eq_u32 vcc, -1, v4
 s_cbranch_vccnz Lfx_129
 ds_write_b128 v3, v[60:63] offset:4096
 s_waitcnt lgkmcnt(0)
 s_branch Lfxb_130
Lfx_131:
 s_add_u32 s47, s43, -2048
 buffer_load_dwordx4 v[56:59], v3, s[20:23], s47 offen offset:0 sc1
 buffer_load_dwordx4 v[60:63], v3, s[20:23], s47 offen offset:1024 sc1
 s_sub_u32 s54, s54, 1
 s_cbranch_scc1 Lfail_125
 s_waitcnt vmcnt(0)
 v_max3_u32 v4, v56, v57, v58
 v_max3_u32 v4, v4, v59, v60
 v_max3_u32 v4, v4, v61, v62
 v_max_u32 v4, v4, v63
 v_cmp_eq_u32 vcc, -1, v4
 s_cbranch_vccnz Lfx_131
 ds_write_b128 v3, v[56:59] offset:6144
 s_waitcnt lgkmcnt(0)
 s_branch Lfxb_132
Lmx_133:
 s_waitcnt lgkmcnt(0)
 ds_read_b128 v[36:39], v11 offset:17408
 ds_read_b128 v[40:43], v11 offset:17920
 ds_read_b128 v[44:47], v11 offset:18432
 ds_read_b128 v[48:51], v11 offset:18944
 v_mov_b64 v[28:29], 0
 v_mov_b64 v[30:31], 0
 ds_read_b128 v[52:55], v3 offset:9216
 ds_read_b128 v[56:59], v3 offset:10240
 s_waitcnt lgkmcnt(0)
 v_mfma_f32_16x16x32_bf16 v[20:23], v[52:55], v[36:39], 0
 v_mfma_f32_16x16x32_bf16 v[24:27], v[56:59], v[36:39], 0
 ds_read_b128 v[52:55], v3 offset:11264
 ds_read_b128 v[56:59], v3 offset:12288
 s_waitcnt lgkmcnt(0)
 v_mfma_f32_16x16x32_bf16 v[20:23], v[52:55], v[40:43], v[20:23]
 v_mfma_f32_16x16x32_bf16 v[24:27], v[56:59], v[40:43], v[24:27]
 ds_read_b128 v[52:55], v3 offset:13312
 ds_read_b128 v[56:59], v3 offset:14336
 s_waitcnt lgkmcnt(0)
 v_mfma_f32_16x16x32_bf16 v[20:23], v[52:55], v[44:47], v[20:23]
 v_mfma_f32_16x16x32_bf16 v[24:27], v[56:59], v[44:47], v[24:27]
 ds_read_b128 v[52:55], v3 offset:15360
 ds_read_b128 v[56:59], v3 offset:16384
 s_waitcnt lgkmcnt(0)
 v_mfma_f32_16x16x32_bf16 v[20:23], v[52:55], v[48:51], v[20:23]
 v_mfma_f32_16x16x32_bf16 v[24:27], v[56:59], v[48:51], v[24:27]
 ds_read_b128 v[52:55], v9 offset:19456
 ds_read_b128 v[56:59], v9 offset:21504
 s_waitcnt lgkmcnt(0)
 v_smfmac_f32_16x16x64_bf16 v[28:31], v[52:55], v[36:43], v5
 v_smfmac_f32_16x16x64_bf16 v[28:31], v[56:59], v[44:51], v5
 ds_read_b128 v[36:39], v0 offset:32768
 ds_read_b128 v[40:43], v0 offset:36864
 ds_read_b128 v[44:47], v0 offset:40960
 ds_read_b128 v[48:51], v0 offset:45056
 v_mov_b64 v[32:33], s[34:35]
 v_mov_b64 v[34:35], s[34:35]
 s_nop 1
 v_add_f32 v28, v28, v30
 v_add_f32 v29, v29, v31
 v_mul_f32 v28, s55, v28
 v_mul_f32 v29, s55, v29
 v_max_f32 v30, v28, v29
 v_cndmask_b32 v28, v28, v29, s[48:49]
 v_max3_f32 v30, v30, v20, v21
 v_max3_f32 v30, v30, v22, v23
 v_max3_f32 v30, v30, v24, v25
 v_max3_f32 v31, v30, v26, v27
 v_max3_f32 v29, v30, v26, v27
 v_cndmask_b32 v20, v20, v24, s[48:49]
 v_cndmask_b32 v21, v21, v25, s[48:49]
 v_permlane16_swap_b32 v31, v29
 v_max_f32 v30, v31, v29
 v_max_f32 v6, v31, v29
 v_cndmask_b32 v22, v22, v26, s[48:49]
 v_cndmask_b32 v23, v23, v27, s[48:49]
 v_permlane32_swap_b32 v30, v6
 v_max_f32 v30, v30, v6
 v_sub_f32 v28, v28, v30
 v_sub_f32 v20, v20, v30
 v_sub_f32 v21, v21, v30
 v_sub_f32 v22, v22, v30
 v_sub_f32 v23, v23, v30
 v_exp_f32 v28, v28
 v_exp_f32 v20, v20
 v_exp_f32 v21, v21
 v_exp_f32 v22, v22
 v_exp_f32 v23, v23
 v_cndmask_b32 v29, 0, v28, s[48:49]
 v_cndmask_b32 v28, v28, 0, s[48:49]
 v_cvt_pk_bf16_f32 v6, v28, v29
 v_cvt_pk_bf16_f32 v30, v20, v21
 v_cvt_pk_bf16_f32 v31, v22, v23
 v_mfma_f32_16x16x16_bf16 v[60:63], v[6:7], v[32:33], 0
 v_mfma_f32_16x16x16_bf16 v[52:55], v[6:7], v[2:3], 0
 v_mfma_f32_16x16x16_bf16 v[56:59], v[6:7], v[4:5], 0
 v_smfmac_f32_16x16x32_bf16 v[60:63], v[30:31], v[32:35], v5
 v_smfmac_f32_16x16x32_bf16 v[52:55], v[30:31], v[12:15], v5
 v_smfmac_f32_16x16x32_bf16 v[56:59], v[30:31], v[16:19], v5
 s_nop 0
 v_add_f32 v60, v60, v62
 v_add_f32 v61, v61, v63
 v_rcp_f32 v60, v60
 v_rcp_f32 v61, v61
 v_add_f32 v52, v52, v54
 v_add_f32 v53, v53, v55
 v_mul_f32 v52, v52, v60
 v_mul_f32 v53, v53, v61
 v_add_f32 v56, v56, v58
 v_add_f32 v57, v57, v59
 v_mul_f32 v56, v56, v60
 v_mul_f32 v57, v57, v61
 v_cvt_pk_bf16_f32 v52, v52, v56
 v_cvt_pk_bf16_f32 v53, v53, v57
 ds_write2_b32 v8, v52, v53 offset0:128 offset1:144
 v_mov_b64 v[20:21], 0
 v_mov_b64 v[22:23], 0
 v_mov_b64 v[24:25], 0
 v_mov_b64 v[26:27], 0
 v_mov_b64 v[28:29], 0
 v_mov_b64 v[30:31], 0
 v_mov_b64 v[32:33], 0
 v_mov_b64 v[34:35], 0
 s_waitcnt lgkmcnt(0)
 s_branch Lmxb_134
Lr2_139:
 s_waitcnt vmcnt(1)
 v_mfma_f32_16x16x32_bf16 v[48:51], v[44:47], v[12:15], 0
 s_waitcnt vmcnt(0)
 v_mfma_f32_16x16x32_bf16 v[48:51], v[44:47], v[16:19], v[48:51]
 v_bitop3_b32 v55, v13, v15, s46 bitop3:0x7e
 v_bitop3_b32 v56, v17, v19, s46 bitop3:0x7e
 v_bitop3_b32 v55, v55, 1, v56 bitop3:0xc8
 v_cmp_ne_u32 vcc, 0, v55
 s_nop 3
 v_add_f32_dpp v48, v48, v48 row_ror:4 row_mask:0xf bank_mask:0xf
 v_add_f32_dpp v49, v49, v49 row_ror:4 row_mask:0xf bank_mask:0xf
 s_cbranch_vccnz Lr1_138
 v_add_f32_dpp v48, v48, v48 row_ror:8 row_mask:0xf bank_mask:0xf
 v_add_f32_dpp v49, v49, v49 row_ror:8 row_mask:0xf bank_mask:0xf
 v_cvt_pk_bf16_f32 v48, v48, v49
 buffer_store_dword v48, v52, s[20:23], s44 offen sc1
 s_branch Lb1_140
Lr1_138:
 s_mov_b64 exec, vcc
Lrt_163:
 buffer_load_dwordx4 v[12:15], v3, s[20:23], s39 offen offset:0 sc1
 buffer_load_dwordx4 v[16:19], v3, s[20:23], s39 offen offset:1024 sc1
 s_waitcnt vmcnt(2)
 v_bitop3_b32 v55, v13, v15, s46 bitop3:0x7e
 v_bitop3_b32 v56, v17, v19, s46 bitop3:0x7e
 v_bitop3_b32 v55, v55, 1, v56 bitop3:0xc8
 v_cmpx_ne_u32 vcc, 0, v55
 s_cbranch_execz Lrte_164
 buffer_load_dwordx4 v[12:15], v3, s[20:23], s39 offen offset:0 sc1
 buffer_load_dwordx4 v[16:19], v3, s[20:23], s39 offen offset:1024 sc1
 s_waitcnt vmcnt(2)
 v_bitop3_b32 v55, v13, v15, s46 bitop3:0x7e
 v_bitop3_b32 v56, v17, v19, s46 bitop3:0x7e
 v_bitop3_b32 v55, v55, 1, v56 bitop3:0xc8
 v_cmpx_ne_u32 vcc, 0, v55
 s_cbranch_execz Lrte_164
 buffer_load_dwordx4 v[12:15], v3, s[20:23], s39 offen offset:0 sc1
 buffer_load_dwordx4 v[16:19], v3, s[20:23], s39 offen offset:1024 sc1
 s_waitcnt vmcnt(2)
 v_bitop3_b32 v55, v13, v15, s46 bitop3:0x7e
 v_bitop3_b32 v56, v17, v19, s46 bitop3:0x7e
 v_bitop3_b32 v55, v55, 1, v56 bitop3:0xc8
 v_cmpx_ne_u32 vcc, 0, v55
 s_cbranch_execz Lrte_164
 s_sub_u32 s54, s54, 1
 s_cbranch_scc0 Lrt_163
 s_endpgm
Lrte_164:
 s_mov_b64 exec, -1
 s_mov_b32 s50, 0
 s_nop 1
 v_mfma_f32_16x16x32_bf16 v[48:51], v[44:47], v[12:15], 0
 v_mfma_f32_16x16x32_bf16 v[48:51], v[44:47], v[16:19], v[48:51]
 s_nop 7
 v_add_f32_dpp v48, v48, v48 row_ror:4 row_mask:0xf bank_mask:0xf
 v_add_f32_dpp v49, v49, v49 row_ror:4 row_mask:0xf bank_mask:0xf
 s_nop 0
 v_add_f32_dpp v48, v48, v48 row_ror:8 row_mask:0xf bank_mask:0xf
 v_add_f32_dpp v49, v49, v49 row_ror:8 row_mask:0xf bank_mask:0xf
 v_cvt_pk_bf16_f32 v48, v48, v49
 buffer_store_dword v48, v52, s[20:23], s44 offen sc1
 s_branch Lb1_140
Lr2_145:
 s_waitcnt vmcnt(1)
 v_mfma_f32_16x16x32_bf16 v[48:51], v[44:47], v[12:15], 0
 s_waitcnt vmcnt(0)
 v_mfma_f32_16x16x32_bf16 v[48:51], v[44:47], v[16:19], v[48:51]
 v_bitop3_b32 v55, v13, v15, s46 bitop3:0x7e
 v_bitop3_b32 v56, v17, v19, s46 bitop3:0x7e
 v_bitop3_b32 v55, v55, 1, v56 bitop3:0xc8
 v_cmp_ne_u32 vcc, 0, v55
 s_nop 3
 v_add_f32_dpp v48, v48, v48 row_ror:4 row_mask:0xf bank_mask:0xf
 v_add_f32_dpp v49, v49, v49 row_ror:4 row_mask:0xf bank_mask:0xf
 s_cbranch_vccnz Lr1_144
 v_add_f32_dpp v48, v48, v48 row_ror:8 row_mask:0xf bank_mask:0xf
 v_add_f32_dpp v49, v49, v49 row_ror:8 row_mask:0xf bank_mask:0xf
 v_cvt_pk_bf16_f32 v48, v48, v49
 buffer_store_dword v48, v52, s[20:23], s44 offen sc1
 s_branch Lb1_146
Lr1_144:
 s_mov_b64 exec, vcc
Lrt_165:
 buffer_load_dwordx4 v[12:15], v3, s[20:23], s39 offen offset:0 sc1
 buffer_load_dwordx4 v[16:19], v3, s[20:23], s39 offen offset:1024 sc1
 s_waitcnt vmcnt(2)
 v_bitop3_b32 v55, v13, v15, s46 bitop3:0x7e
 v_bitop3_b32 v56, v17, v19, s46 bitop3:0x7e
 v_bitop3_b32 v55, v55, 1, v56 bitop3:0xc8
 v_cmpx_ne_u32 vcc, 0, v55
 s_cbranch_execz Lrte_166
 buffer_load_dwordx4 v[12:15], v3, s[20:23], s39 offen offset:0 sc1
 buffer_load_dwordx4 v[16:19], v3, s[20:23], s39 offen offset:1024 sc1
 s_waitcnt vmcnt(2)
 v_bitop3_b32 v55, v13, v15, s46 bitop3:0x7e
 v_bitop3_b32 v56, v17, v19, s46 bitop3:0x7e
 v_bitop3_b32 v55, v55, 1, v56 bitop3:0xc8
 v_cmpx_ne_u32 vcc, 0, v55
 s_cbranch_execz Lrte_166
 buffer_load_dwordx4 v[12:15], v3, s[20:23], s39 offen offset:0 sc1
 buffer_load_dwordx4 v[16:19], v3, s[20:23], s39 offen offset:1024 sc1
 s_waitcnt vmcnt(2)
 v_bitop3_b32 v55, v13, v15, s46 bitop3:0x7e
 v_bitop3_b32 v56, v17, v19, s46 bitop3:0x7e
 v_bitop3_b32 v55, v55, 1, v56 bitop3:0xc8
 v_cmpx_ne_u32 vcc, 0, v55
 s_cbranch_execz Lrte_166
 s_sub_u32 s54, s54, 1
 s_cbranch_scc0 Lrt_165
 s_endpgm
Lrte_166:
 s_mov_b64 exec, -1
 s_mov_b32 s50, 0
 s_nop 1
 v_mfma_f32_16x16x32_bf16 v[48:51], v[44:47], v[12:15], 0
 v_mfma_f32_16x16x32_bf16 v[48:51], v[44:47], v[16:19], v[48:51]
 s_nop 7
 v_add_f32_dpp v48, v48, v48 row_ror:4 row_mask:0xf bank_mask:0xf
 v_add_f32_dpp v49, v49, v49 row_ror:4 row_mask:0xf bank_mask:0xf
 s_nop 0
 v_add_f32_dpp v48, v48, v48 row_ror:8 row_mask:0xf bank_mask:0xf
 v_add_f32_dpp v49, v49, v49 row_ror:8 row_mask:0xf bank_mask:0xf
 v_cvt_pk_bf16_f32 v48, v48, v49
 buffer_store_dword v48, v52, s[20:23], s44 offen sc1
 s_branch Lb1_146
Lr2_151:
 s_waitcnt vmcnt(1)
 v_mfma_f32_16x16x32_bf16 v[48:51], v[44:47], v[12:15], 0
 s_waitcnt vmcnt(0)
 v_mfma_f32_16x16x32_bf16 v[48:51], v[44:47], v[16:19], v[48:51]
 v_bitop3_b32 v55, v13, v15, s46 bitop3:0x7e
 v_bitop3_b32 v56, v17, v19, s46 bitop3:0x7e
 v_bitop3_b32 v55, v55, 1, v56 bitop3:0xc8
 v_cmp_ne_u32 vcc, 0, v55
 s_nop 3
 v_add_f32_dpp v48, v48, v48 row_ror:4 row_mask:0xf bank_mask:0xf
 v_add_f32_dpp v49, v49, v49 row_ror:4 row_mask:0xf bank_mask:0xf
 s_cbranch_vccnz Lr1_150
 v_add_f32_dpp v48, v48, v48 row_ror:8 row_mask:0xf bank_mask:0xf
 v_add_f32_dpp v49, v49, v49 row_ror:8 row_mask:0xf bank_mask:0xf
 v_cvt_pk_bf16_f32 v48, v48, v49
 buffer_store_dword v48, v52, s[20:23], s44 offen sc1
 s_branch Lb1_152
Lr1_150:
 s_mov_b64 exec, vcc
Lrt_167:
 buffer_load_dwordx4 v[12:15], v3, s[20:23], s39 offen offset:0 sc1
 buffer_load_dwordx4 v[16:19], v3, s[20:23], s39 offen offset:1024 sc1
 s_waitcnt vmcnt(2)
 v_bitop3_b32 v55, v13, v15, s46 bitop3:0x7e
 v_bitop3_b32 v56, v17, v19, s46 bitop3:0x7e
 v_bitop3_b32 v55, v55, 1, v56 bitop3:0xc8
 v_cmpx_ne_u32 vcc, 0, v55
 s_cbranch_execz Lrte_168
 buffer_load_dwordx4 v[12:15], v3, s[20:23], s39 offen offset:0 sc1
 buffer_load_dwordx4 v[16:19], v3, s[20:23], s39 offen offset:1024 sc1
 s_waitcnt vmcnt(2)
 v_bitop3_b32 v55, v13, v15, s46 bitop3:0x7e
 v_bitop3_b32 v56, v17, v19, s46 bitop3:0x7e
 v_bitop3_b32 v55, v55, 1, v56 bitop3:0xc8
 v_cmpx_ne_u32 vcc, 0, v55
 s_cbranch_execz Lrte_168
 buffer_load_dwordx4 v[12:15], v3, s[20:23], s39 offen offset:0 sc1
 buffer_load_dwordx4 v[16:19], v3, s[20:23], s39 offen offset:1024 sc1
 s_waitcnt vmcnt(2)
 v_bitop3_b32 v55, v13, v15, s46 bitop3:0x7e
 v_bitop3_b32 v56, v17, v19, s46 bitop3:0x7e
 v_bitop3_b32 v55, v55, 1, v56 bitop3:0xc8
 v_cmpx_ne_u32 vcc, 0, v55
 s_cbranch_execz Lrte_168
 s_sub_u32 s54, s54, 1
 s_cbranch_scc0 Lrt_167
 s_endpgm
Lrte_168:
 s_mov_b64 exec, -1
 s_mov_b32 s50, 0
 s_nop 1
 v_mfma_f32_16x16x32_bf16 v[48:51], v[44:47], v[12:15], 0
 v_mfma_f32_16x16x32_bf16 v[48:51], v[44:47], v[16:19], v[48:51]
 s_nop 7
 v_add_f32_dpp v48, v48, v48 row_ror:4 row_mask:0xf bank_mask:0xf
 v_add_f32_dpp v49, v49, v49 row_ror:4 row_mask:0xf bank_mask:0xf
 s_nop 0
 v_add_f32_dpp v48, v48, v48 row_ror:8 row_mask:0xf bank_mask:0xf
 v_add_f32_dpp v49, v49, v49 row_ror:8 row_mask:0xf bank_mask:0xf
 v_cvt_pk_bf16_f32 v48, v48, v49
 buffer_store_dword v48, v52, s[20:23], s44 offen sc1
 s_branch Lb1_152
Lfw_142:
Lpb_169:
 buffer_load_dword v1, v7, s[20:23], s56 offen sc1
 s_waitcnt vmcnt(0)
 v_cmp_le_u32 vcc, s58, v1
 s_cbranch_vccnz Lpbok_170
 s_sub_u32 s54, s54, 1
 s_cbranch_scc0 Lpb_169
 s_endpgm
Lpbok_170:
 s_branch Lfok_141
Lfw_148:
Lpb_171:
 buffer_load_dword v1, v7, s[20:23], s56 offen sc1
 s_waitcnt vmcnt(0)
 v_cmp_le_u32 vcc, s58, v1
 s_cbranch_vccnz Lpbok_172
 s_sub_u32 s54, s54, 1
 s_cbranch_scc0 Lpb_171
 s_endpgm
Lpbok_172:
 s_branch Lfok_147
Lfw_154:
Lpb_173:
 buffer_load_dword v1, v7, s[20:23], s56 offen sc1
 s_waitcnt vmcnt(0)
 v_cmp_le_u32 vcc, s58, v1
 s_cbranch_vccnz Lpbok_174
 s_sub_u32 s54, s54, 1
 s_cbranch_scc0 Lpb_173
 s_endpgm
Lpbok_174:
 s_branch Lfok_153
Lfw_159:
Lpb_175:
 buffer_load_dword v1, v7, s[20:23], s56 offen sc1
 s_waitcnt vmcnt(0)
 v_cmp_le_u32 vcc, s58, v1
 s_cbranch_vccnz Lpbok_176
 s_sub_u32 s54, s54, 1
 s_cbranch_scc0 Lpb_175
 s_endpgm
Lpbok_176:
 s_branch Lfok_158
Lfail_125:
 s_endpgm
Lchexit_70:
 s_add_u32 s38, s38, 0x10000
 v_add_u32 v6, s69, v9
 ds_read_b64 v[64:65], v6 offset:19456
 v_mov_b32 v66, v2
 v_mov_b32 v67, v4
 s_waitcnt lgkmcnt(0)
 buffer_store_dwordx4 v[64:67], v0, s[20:23], s38 offen sc1
 s_waitcnt vmcnt(0) lgkmcnt(0)
 s_barrier
 v_subrev_u32 v0, 0x10000, v0
 v_min_u32 v0, 16, v0
 v_lshlrev_b32 v0, 24, v0
 v_mov_b32 v6, 64
 buffer_store_dword v6, v0, s[20:23], s57 offen sc1
Lfin:
Lend:
 s_endpgm
Lredo:
 s_mov_b32 s88, s89
 s_waitcnt vmcnt(0) lgkmcnt(0)
 s_barrier
 s_branch Lrole
.section .rodata,"a"
.p2align 6
.amdhsa_kernel concat_heads__compressed_kv_cla__memory_aug_recurrent_mem_tr__prompt_kernel
  .amdhsa_next_free_vgpr 512
  .amdhsa_next_free_sgpr 102
  .amdhsa_accum_offset 256
  .amdhsa_group_segment_fixed_size 0
  .amdhsa_kernarg_size 128
  .amdhsa_user_sgpr_count 2
  .amdhsa_user_sgpr_kernarg_segment_ptr 1
  .amdhsa_system_sgpr_workgroup_id_x 1
  .amdhsa_float_denorm_mode_32 3
.end_amdhsa_kernel
```
